```python
import torch

def _softmax(x, axis=-1):
    return torch.softmax(x, dim=axis)
def _gelu(x):
    return torch.nn.functional.gelu(x, approximate="tanh")
def _silu(x):
    return torch.nn.functional.silu(x)
def _sigmoid(x):
    return torch.sigmoid(x)
def _layernorm(x, axis=-1, eps=1e-5):
    m = x.mean(dim=axis, keepdim=True)
    v = x.var(dim=axis, keepdim=True, unbiased=False)
    return (x - m) / torch.sqrt(v + eps)
def _scatter_add(tgt, idx, src, axis=0):
    return tgt.clone().index_add_(axis, idx, src)
def _segment_sum(src, seg, n):
    out = torch.zeros((n,) + src.shape[1:], dtype=src.dtype)
    return out.index_add_(0, seg, src)
def _pad(x, pw):
    flat = tuple(v for pair in reversed(pw) for v in pair)
    return torch.nn.functional.pad(x, flat)

kernel_name = 'standalone__kv_cache_quant_int4_int2_kv_with_per_channel_or_per_token_scales__prompt'

def setup_inputs():

    _w = (lambda a: (lambda t: t.to(torch.bfloat16) if t.is_floating_point() else t)(torch.as_tensor(a)))
    B = 1
    Sq = 2048
    Skv = 2048
    Hq = 32
    Hkv = 32
    Dh = 192
    bits = 8
    G = 64
    if G <= 0 or G >= Skv:
        G = max(1, Skv // 2)
    Skv = (Skv // G) * G
    ngk = Skv // G
    qmax = (1 << bits) - 1
    return {
        "q": _w((lambda *s: torch.randn(*s, dtype=torch.bfloat16) * 0.2)(B, Hq, Sq, Dh)),
        "qk": _w(torch.randint(0, qmax + 1, (B, Hkv, Skv, Dh)).to(torch.int32)),
        "qv": _w(torch.randint(0, qmax + 1, (B, Hkv, Skv, Dh)).to(torch.int32)),
        "k_scales": _w(torch.abs((lambda *s: torch.randn(*s, dtype=torch.bfloat16) * 0.2)(B, Hkv, ngk, Dh)) * 0.05 + 0.02),
        "k_zeros": _w((lambda *s: torch.randn(*s, dtype=torch.bfloat16) * 0.2)(B, Hkv, ngk, Dh) + float(qmax) / 2.0),
        "v_scales": _w(torch.abs((lambda *s: torch.randn(*s, dtype=torch.bfloat16) * 0.05)(B, Hkv, Skv, 1)) * 0.05 + 0.02),
        "v_zeros": _w((lambda *s: torch.randn(*s, dtype=torch.bfloat16) * 0.05)(B, Hkv, Skv, 1) + float(qmax) / 2.0),
    }

def reference(q, qk, qv, k_scales, k_zeros, v_scales, v_zeros):
    B, Hq, Sq, Dh = q.shape
    Hkv, Skv = qk.shape[1], qk.shape[2]
    ngk = k_scales.shape[2]
    G = Skv // ngk
    ks = (lambda x, n, axis: torch.repeat_interleave(x, n, dim=axis))(k_scales, G, axis=2)
    kz = (lambda x, n, axis: torch.repeat_interleave(x, n, dim=axis))(k_zeros, G, axis=2)
    k = ((lambda x, dt: x.to(dt))(qk, q.dtype) - kz) * ks
    v = ((lambda x, dt: x.to(dt))(qv, q.dtype) - v_zeros) * v_scales
    rep = Hq // Hkv
    if rep > 1:
        k = (lambda x, n, axis: torch.repeat_interleave(x, n, dim=axis))(k, rep, axis=1)
        v = (lambda x, n, axis: torch.repeat_interleave(x, n, dim=axis))(v, rep, axis=1)
    scale = float(Dh) ** -0.5
    logits = torch.einsum("bhqd,bhkd->bhqk", q, k) * scale
    p = _softmax(logits, axis=-1)
    o = torch.einsum("bhqk,bhkd->bhqd", p, v)
    return o
```

```asm
; @launch grid=(256,1,1) block=(256,1,1) lds=161920
.amdgcn_target "amdgcn-amd-amdhsa--gfx950"
.text
.globl standalone__kv_cache_quant_int4_int2_kv_with_per_channel_or_per_token_scales__prompt_kernel
.p2align 8
.type standalone__kv_cache_quant_int4_int2_kv_with_per_channel_or_per_token_scales__prompt_kernel,@function
standalone__kv_cache_quant_int4_int2_kv_with_per_channel_or_per_token_scales__prompt_kernel:
    s_load_dwordx16 s[40:55], s[0:1], 0
    s_getpc_b64 s[60:61]
L_pc:
    s_movk_i32 s62, 0x4000
    s_lshl_b32 s63, 1, 17
    v_lshlrev_b32 v31, 6, v0
    buffer_load_dword v15, v31, s[60:63], 0 offen
    s_lshr_b32 s24, s2, 8
    s_cbranch_scc1 L_done
    s_load_dwordx4 s[16:19], s[0:1], 64
    v_lshlrev_b32 v30, 4, v0
    v_and_b32 v25, 63, v0
    v_lshrrev_b32 v24, 6, v0
    s_movk_i32 s24, 5120
    v_mul_u32_u24 v26, 43, v25
    v_mad_u32_u24 v12, v24, s24, v30
    s_movk_i32 s24, 384
    v_lshrrev_b32 v26, 10, v26
    s_and_b32 s22, s2, 7
    s_mul_i32 s29, s22, 264
    v_mad_u32_u24 v9, v26, s24, v12
    s_andn2_b32 s23, s2, 63
    s_bfe_u32 s95, s2, 0x30003
    s_add_u32 s29, s29, s23
    s_add_u32 s29, s29, s95
    s_lshr_b32 s23, s29, 1
    s_mulk_i32 s23, 384
    s_mul_i32 s24, s29, 24576
    v_lshl_add_u32 v27, v25, 3, s23
    s_addk_i32 s24, 2048
    s_mov_b32 exec_hi, 0xffff
    s_waitcnt lgkmcnt(0)
    global_load_dwordx2 v[32:33], v27, s[46:47]
    global_load_dwordx2 v[34:35], v27, s[48:49]
    s_add_u32 s56, s42, s24
    s_addc_u32 s57, s43, 0
    global_load_dwordx4 v[64:67], v9, s[56:57] offset:-2048 nt
    global_load_dwordx4 v[68:71], v9, s[56:57] offset:-512 nt
    global_load_dwordx4 v[72:75], v9, s[56:57] offset:1024 nt
    global_load_dwordx4 v[76:79], v9, s[56:57] offset:2560 nt
    global_load_dwordx4 v[80:83], v9, s[56:57] offset:-1664 nt
    global_load_dwordx4 v[84:87], v9, s[56:57] offset:-128 nt
    global_load_dwordx4 v[88:91], v9, s[56:57] offset:1408 nt
    global_load_dwordx4 v[92:95], v9, s[56:57] offset:2944 nt
    s_add_u32 s58, s44, s24
    s_addc_u32 s59, s45, 0
    global_load_dwordx4 v[96:99], v12, s[58:59] offset:-2048 nt
    global_load_dwordx4 v[100:103], v12, s[58:59] offset:-1280 nt
    v_readfirstlane_b32 s25, v24
    s_lshl_b32 s23, s29, 6
    s_lshr_b32 s94, s29, 6
    s_lshl4_add_u32 s23, s25, s23
    s_load_dwordx4 s[64:67], s[50:51], s23
    s_load_dwordx4 s[68:71], s[52:53], s23
    s_lshl_b32 s22, s94, 10
    s_add_u32 s22, s22, 67108864
    s_or_b32 s83, s95, s25
    s_cbranch_scc1 L_notleader0
    s_load_dwordx8 s[72:79], s[18:19], s22 glc
L_notleader0:
    s_mov_b32 exec_hi, -1
    s_mov_b32 exec_hi, 0xffff
    global_load_dwordx4 v[104:107], v12, s[58:59] offset:-512 nt
    s_mov_b32 exec_hi, -1
    s_mul_i32 s24, s94, 786432
    s_add_u32 s8, s40, s24
    s_addc_u32 s9, s41, 0
    s_mov_b32 s10, 786432
    s_mov_b32 s11, 0x20000
    s_add_u32 s12, s54, s24
    s_addc_u32 s13, s55, 0
    s_mov_b32 s14, 786432
    s_mov_b32 s15, 0x20000
    s_lshl2_add_u32 s24, s95, s25
    s_mul_i32 s24, s24, 24576
    s_mul_i32 s82, s25, 18432
    s_add_u32 s82, s82, 73728
    v_add_u32 v232, 0, v25
    v_add_u32 v233, 64, v25
    v_add_u32 v234, 128, v25
    s_mov_b32 exec_hi, 0xffff
    global_load_dwordx4 v[108:111], v12, s[58:59] offset:256 nt
    s_mov_b32 exec_hi, -1
    v_add_u32 v235, 192, v25
    v_add_u32 v236, 256, v25
    v_add_u32 v237, 320, v25
    v_mul_u32_u24 v240, 2731, v232
    v_mul_u32_u24 v241, 2731, v233
    v_mul_u32_u24 v242, 2731, v234
    v_mul_u32_u24 v243, 2731, v235
    v_mul_u32_u24 v244, 2731, v236
    v_mul_u32_u24 v245, 2731, v237
    v_bfe_u32 v240, v240, 17, 3
    v_bfe_u32 v241, v241, 17, 3
    v_bfe_u32 v242, v242, 17, 3
    v_bfe_u32 v243, v243, 17, 3
    v_bfe_u32 v244, v244, 17, 3
    v_bfe_u32 v245, v245, 17, 3
    v_xor_b32 v232, v232, v240
    v_xor_b32 v233, v233, v241
    s_mov_b32 exec_hi, 0xffff
    global_load_dwordx4 v[112:115], v12, s[58:59] offset:1024 nt
    s_mov_b32 exec_hi, -1
    v_xor_b32 v234, v234, v242
    v_xor_b32 v235, v235, v243
    v_xor_b32 v236, v236, v244
    v_xor_b32 v237, v237, v245
    v_lshl_add_u32 v232, v232, 4, s24
    v_lshl_add_u32 v233, v233, 4, s24
    v_lshl_add_u32 v234, v234, 4, s24
    v_lshl_add_u32 v235, v235, 4, s24
    v_lshl_add_u32 v236, v236, 4, s24
    v_lshl_add_u32 v237, v237, 4, s24
    v_mov_b32 v16, 0
    v_mov_b32 v17, 147456
    ds_write_b32 v17, v16
    s_mov_b32 s97, 0xffff0000
    s_mov_b32 s38, 0x3dd53b95
    v_mul_u32_u24 v27, 24, v26
    s_mov_b32 exec_hi, 0xffff
    global_load_dwordx4 v[116:119], v12, s[58:59] offset:1792 nt
    s_mov_b32 exec_hi, -1
    v_sub_u32 v27, v25, v27
    v_lshlrev_b32 v10, 4, v27
    v_add_u32 v10, 147584, v10
    v_mul_u32_u24 v36, 768, v26
    v_add_u32 v36, v36, v10
    s_waitcnt vmcnt(14)
    v_lshlrev_b32 v128, 16, v32
    v_and_b32 v129, s97, v32
    v_lshlrev_b32 v130, 16, v34
    v_and_b32 v131, s97, v34
    v_lshlrev_b32 v132, 16, v33
    v_and_b32 v133, s97, v33
    v_lshlrev_b32 v134, 16, v35
    v_and_b32 v135, s97, v35
    v_mul_f32 v128, s38, v128
    v_mul_f32 v129, s38, v129
    v_mul_f32 v132, s38, v132
    s_mov_b32 exec_hi, 0xffff
    global_load_dwordx4 v[120:123], v12, s[58:59] offset:2560 nt
    s_mov_b32 exec_hi, -1
    v_mul_f32 v133, s38, v133
    v_mul_f32_e64 v130, -v130, v128
    v_mul_f32_e64 v131, -v131, v129
    v_mul_f32_e64 v134, -v134, v132
    v_mul_f32_e64 v135, -v135, v133
    s_mov_b32 exec_hi, 0xffff
    ds_write_b128 v36, v[128:131] offset:0
    ds_write_b128 v36, v[132:135] offset:384
    s_mov_b32 exec_hi, -1
    ds_read_b128 v[128:131], v10 offset:0
    ds_read_b128 v[132:135], v10 offset:384
    ds_read_b128 v[136:139], v10 offset:768
    ds_read_b128 v[140:143], v10 offset:1152
    v_lshrrev_b32 v48, 1, v26
    v_lshlrev_b32 v48, 30, v48
    v_lshlrev_b32 v31, 4, v25
    v_mul_u32_u24 v30, 3072, v24
    v_add_u32 v4, v30, v31
    v_lshl_add_u32 v49, v24, 2, v26
    s_mov_b32 exec_hi, 0xffff
    global_load_dwordx4 v[124:127], v12, s[58:59] offset:3328 nt
    s_mov_b32 exec_hi, -1
    v_mul_u32_u24 v49, 384, v49
    v_lshlrev_b32 v50, 1, v24
    v_xor_b32 v50, v27, v50
    v_lshl_add_u32 v49, v50, 4, v49
    v_or_b32 v11, v49, v48
    v_xor_b32 v54, 16, v11
    v_lshrrev_b32 v49, 5, v25
    v_sub_u32 v49, 1, v49
    v_and_b32 v49, v49, v24
    v_lshlrev_b32 v49, 4, v49
    v_xor_b32 v49, v49, v4
    v_add_u32 v49, 12288, v49
    v_or_b32 v20, v49, v48
    s_mul_i32 s37, s95, 24576
    s_add_u32 s80, s37, 6144
    s_mov_b32 s81, s37
    s_mul_i32 s39, s94, 1769472
    v_or_b32 v9, v9, v48
    v_or_b32 v12, v12, v48
    s_waitcnt lgkmcnt(0)
    s_add_u32 s4, s18, s39
    s_addc_u32 s5, s19, 0
    s_mov_b32 s6, 1572864
    s_mov_b32 s7, 0x20000
    s_add_u32 s20, s18, s22
    s_addc_u32 s21, s19, 0
    s_mov_b32 s22, 32
    s_mov_b32 s23, 0x20000
    s_mov_b32 s88, s16
    s_mov_b32 s89, s17
    s_movk_i32 s90, 256
    s_mov_b32 s91, s63
    s_lshl_b32 s93, s94, 3
    s_cmp_lg_u32 s83, 0
    s_cbranch_scc1 L_notleader
    s_mov_b32 s24, 1
    s_lshr_b32 s72, s72, 8
    s_min_u32 s72, s72, 31
    s_bitset1_b32 s24, s72
    s_lshr_b32 s73, s73, 8
    s_min_u32 s73, s73, 31
    s_bitset1_b32 s24, s73
    s_lshr_b32 s74, s74, 8
    s_min_u32 s74, s74, 31
    s_bitset1_b32 s24, s74
    s_lshr_b32 s75, s75, 8
    s_min_u32 s75, s75, 31
    s_bitset1_b32 s24, s75
    s_lshr_b32 s76, s76, 8
    s_min_u32 s76, s76, 31
    s_bitset1_b32 s24, s76
    s_lshr_b32 s77, s77, 8
    s_min_u32 s77, s77, 31
    s_bitset1_b32 s24, s77
    s_lshr_b32 s78, s78, 8
    s_min_u32 s78, s78, 31
    s_bitset1_b32 s24, s78
    s_lshr_b32 s79, s79, 8
    s_min_u32 s79, s79, 31
    s_bitset1_b32 s24, s79
    s_ff0_i32_b32 s24, s24
    s_lshl_b32 s24, s24, 8
    v_mov_b32 v52, s24
    s_mov_b64 exec, 1
    buffer_store_dword v52, off, s[88:91], s93 sc1
    s_mov_b64 exec, -1
L_notleader:
    s_add_u32 m0, s82, 0
    s_movk_i32 s24, 0
    buffer_load_dwordx4 v232, s[8:11], s24 offen nt lds
    s_waitcnt vmcnt(15)
    v_cvt_f32_i32 v64, v64
    v_cvt_f32_i32 v65, v65
    v_cvt_f32_i32 v68, v68
    v_cvt_f32_i32 v69, v69
    v_fma_f32 v64, v64, v128, v130
    v_fma_f32 v65, v65, v129, v131
    v_fma_f32 v68, v68, v128, v130
    v_fma_f32 v69, v69, v129, v131
    v_cvt_pk_bf16_f32 v64, v64, v65
    v_cvt_pk_bf16_f32 v68, v68, v69
    v_cvt_f32_i32 v66, v66
    v_cvt_f32_i32 v67, v67
    v_cvt_f32_i32 v70, v70
    v_cvt_f32_i32 v71, v71
    v_fma_f32 v66, v66, v132, v134
    v_fma_f32 v67, v67, v133, v135
    v_fma_f32 v70, v70, v132, v134
    v_fma_f32 v71, v71, v133, v135
    v_cvt_pk_bf16_f32 v65, v66, v67
    v_cvt_pk_bf16_f32 v69, v70, v71
    s_add_u32 m0, s82, 1024
    s_movk_i32 s24, 0
    buffer_load_dwordx4 v233, s[8:11], s24 offen nt lds
    s_waitcnt vmcnt(14)
    v_cvt_f32_i32 v72, v72
    v_cvt_f32_i32 v73, v73
    v_cvt_f32_i32 v76, v76
    v_cvt_f32_i32 v77, v77
    v_fma_f32 v72, v72, v128, v130
    v_fma_f32 v73, v73, v129, v131
    v_fma_f32 v76, v76, v128, v130
    v_fma_f32 v77, v77, v129, v131
    v_cvt_pk_bf16_f32 v72, v72, v73
    v_cvt_pk_bf16_f32 v76, v76, v77
    v_cvt_f32_i32 v74, v74
    v_cvt_f32_i32 v75, v75
    v_cvt_f32_i32 v78, v78
    v_cvt_f32_i32 v79, v79
    v_fma_f32 v74, v74, v132, v134
    v_fma_f32 v75, v75, v133, v135
    v_fma_f32 v78, v78, v132, v134
    v_fma_f32 v79, v79, v133, v135
    v_cvt_pk_bf16_f32 v73, v74, v75
    v_cvt_pk_bf16_f32 v77, v78, v79
    s_add_u32 m0, s82, 2048
    s_movk_i32 s24, 0
    buffer_load_dwordx4 v234, s[8:11], s24 offen nt lds
    s_waitcnt vmcnt(13)
    v_cvt_f32_i32 v80, v80
    v_cvt_f32_i32 v81, v81
    v_cvt_f32_i32 v84, v84
    v_cvt_f32_i32 v85, v85
    v_fma_f32 v80, v80, v136, v138
    v_fma_f32 v81, v81, v137, v139
    v_fma_f32 v84, v84, v136, v138
    v_fma_f32 v85, v85, v137, v139
    v_cvt_pk_bf16_f32 v66, v80, v81
    v_cvt_pk_bf16_f32 v70, v84, v85
    v_cvt_f32_i32 v82, v82
    v_cvt_f32_i32 v83, v83
    v_cvt_f32_i32 v86, v86
    v_cvt_f32_i32 v87, v87
    v_fma_f32 v82, v82, v140, v142
    v_fma_f32 v83, v83, v141, v143
    v_fma_f32 v86, v86, v140, v142
    v_fma_f32 v87, v87, v141, v143
    v_cvt_pk_bf16_f32 v67, v82, v83
    v_cvt_pk_bf16_f32 v71, v86, v87
    s_add_u32 m0, s82, 3072
    s_movk_i32 s24, 0
    buffer_load_dwordx4 v235, s[8:11], s24 offen nt lds
    s_waitcnt vmcnt(12)
    v_cvt_f32_i32 v88, v88
    v_cvt_f32_i32 v89, v89
    v_cvt_f32_i32 v92, v92
    v_cvt_f32_i32 v93, v93
    v_fma_f32 v88, v88, v136, v138
    v_fma_f32 v89, v89, v137, v139
    v_fma_f32 v92, v92, v136, v138
    v_fma_f32 v93, v93, v137, v139
    v_cvt_pk_bf16_f32 v74, v88, v89
    v_cvt_pk_bf16_f32 v78, v92, v93
    v_cvt_f32_i32 v90, v90
    v_cvt_f32_i32 v91, v91
    v_cvt_f32_i32 v94, v94
    v_cvt_f32_i32 v95, v95
    v_fma_f32 v90, v90, v140, v142
    v_fma_f32 v91, v91, v141, v143
    v_fma_f32 v94, v94, v140, v142
    v_fma_f32 v95, v95, v141, v143
    v_cvt_pk_bf16_f32 v75, v90, v91
    v_cvt_pk_bf16_f32 v79, v94, v95
    buffer_store_dwordx4 v[64:67], v11, s[4:7], s37 offen offset:0 sc1
    buffer_store_dwordx4 v[68:71], v54, s[4:7], s37 offen offset:768 sc1
    buffer_store_dwordx4 v[72:75], v11, s[4:7], s80 offen offset:0 sc1
    buffer_store_dwordx4 v[76:79], v54, s[4:7], s80 offen offset:768 sc1
    s_mov_b32 exec_hi, 0xffff
    ds_write_b128 v11, v[64:67] offset:0
    ds_write_b128 v54, v[68:71] offset:768
    ds_write_b128 v11, v[72:75] offset:6144
    ds_write_b128 v54, v[76:79] offset:6912
    s_mov_b32 exec_hi, -1
    s_add_u32 m0, s82, 4096
    s_movk_i32 s24, 0
    buffer_load_dwordx4 v236, s[8:11], s24 offen nt lds
    s_lshl_b32 s57, s64, 16
    s_and_b32 s58, s64, s97
    v_mov_b32 v128, s57
    v_mov_b32 v129, s58
    s_lshl_b32 s57, s68, 16
    s_and_b32 s58, s68, s97
    v_mul_f32_e64 v130, -s57, v128
    v_mul_f32_e64 v131, -s58, v129
    s_lshl_b32 s57, s65, 16
    s_and_b32 s58, s65, s97
    v_mov_b32 v132, s57
    v_mov_b32 v133, s58
    s_lshl_b32 s57, s69, 16
    s_and_b32 s58, s69, s97
    v_mul_f32_e64 v134, -s57, v132
    v_mul_f32_e64 v135, -s58, v133
    s_lshl_b32 s57, s66, 16
    s_and_b32 s58, s66, s97
    v_mov_b32 v136, s57
    v_mov_b32 v137, s58
    s_lshl_b32 s57, s70, 16
    s_and_b32 s58, s70, s97
    v_mul_f32_e64 v138, -s57, v136
    v_mul_f32_e64 v139, -s58, v137
    s_lshl_b32 s57, s67, 16
    s_and_b32 s58, s67, s97
    v_mov_b32 v140, s57
    v_mov_b32 v141, s58
    s_lshl_b32 s57, s71, 16
    s_add_u32 m0, s82, 5120
    s_movk_i32 s24, 0
    buffer_load_dwordx4 v237, s[8:11], s24 offen nt lds
    s_and_b32 s58, s71, s97
    v_mul_f32_e64 v142, -s57, v140
    v_mul_f32_e64 v143, -s58, v141
    s_waitcnt vmcnt(16)
    v_cvt_f32_i32 v96, v96
    v_cvt_f32_i32 v100, v100
    v_cvt_f32_i32 v97, v97
    v_cvt_f32_i32 v101, v101
    v_fma_f32 v96, v96, v128, v130
    v_fma_f32 v100, v100, v129, v131
    v_fma_f32 v97, v97, v128, v130
    v_fma_f32 v101, v101, v129, v131
    v_cvt_f32_i32 v98, v98
    v_cvt_f32_i32 v102, v102
    v_cvt_f32_i32 v99, v99
    v_cvt_f32_i32 v103, v103
    v_fma_f32 v98, v98, v128, v130
    v_fma_f32 v102, v102, v129, v131
    v_fma_f32 v99, v99, v128, v130
    v_fma_f32 v103, v103, v129, v131
    s_waitcnt vmcnt(14)
    v_cvt_f32_i32 v104, v104
    v_cvt_f32_i32 v108, v108
    v_cvt_f32_i32 v105, v105
    v_cvt_f32_i32 v109, v109
    v_fma_f32 v104, v104, v132, v134
    v_fma_f32 v108, v108, v133, v135
    v_fma_f32 v105, v105, v132, v134
    v_fma_f32 v109, v109, v133, v135
    s_add_u32 m0, s82, 6144
    s_movk_i32 s24, 6144
    buffer_load_dwordx4 v232, s[8:11], s24 offen nt lds
    v_cvt_f32_i32 v106, v106
    v_cvt_f32_i32 v110, v110
    v_cvt_f32_i32 v107, v107
    v_cvt_f32_i32 v111, v111
    v_fma_f32 v106, v106, v132, v134
    v_fma_f32 v110, v110, v133, v135
    v_fma_f32 v107, v107, v132, v134
    v_fma_f32 v111, v111, v133, v135
    v_cvt_pk_bf16_f32 v96, v96, v100
    v_cvt_pk_bf16_f32 v100, v97, v101
    v_cvt_pk_bf16_f32 v97, v104, v108
    v_cvt_pk_bf16_f32 v101, v105, v109
    v_cvt_pk_bf16_f32 v104, v98, v102
    v_cvt_pk_bf16_f32 v105, v106, v110
    v_cvt_pk_bf16_f32 v108, v99, v103
    v_cvt_pk_bf16_f32 v109, v107, v111
    s_waitcnt vmcnt(13)
    v_cvt_f32_i32 v112, v112
    v_cvt_f32_i32 v116, v116
    v_cvt_f32_i32 v113, v113
    v_cvt_f32_i32 v117, v117
    v_fma_f32 v112, v112, v136, v138
    v_fma_f32 v116, v116, v137, v139
    v_fma_f32 v113, v113, v136, v138
    v_fma_f32 v117, v117, v137, v139
    v_cvt_f32_i32 v114, v114
    v_cvt_f32_i32 v118, v118
    v_cvt_f32_i32 v115, v115
    v_cvt_f32_i32 v119, v119
    s_add_u32 m0, s82, 7168
    s_movk_i32 s24, 6144
    buffer_load_dwordx4 v233, s[8:11], s24 offen nt lds
    v_fma_f32 v114, v114, v136, v138
    v_fma_f32 v118, v118, v137, v139
    v_fma_f32 v115, v115, v136, v138
    v_fma_f32 v119, v119, v137, v139
    s_waitcnt vmcnt(12)
    v_cvt_f32_i32 v120, v120
    v_cvt_f32_i32 v124, v124
    v_cvt_f32_i32 v121, v121
    v_cvt_f32_i32 v125, v125
    v_fma_f32 v120, v120, v140, v142
    v_fma_f32 v124, v124, v141, v143
    v_fma_f32 v121, v121, v140, v142
    v_fma_f32 v125, v125, v141, v143
    v_cvt_f32_i32 v122, v122
    v_cvt_f32_i32 v126, v126
    v_cvt_f32_i32 v123, v123
    v_cvt_f32_i32 v127, v127
    v_fma_f32 v122, v122, v140, v142
    v_fma_f32 v126, v126, v141, v143
    v_fma_f32 v123, v123, v140, v142
    v_fma_f32 v127, v127, v141, v143
    v_cvt_pk_bf16_f32 v98, v112, v116
    v_cvt_pk_bf16_f32 v102, v113, v117
    v_cvt_pk_bf16_f32 v99, v120, v124
    v_cvt_pk_bf16_f32 v103, v121, v125
    v_cvt_pk_bf16_f32 v106, v114, v118
    v_cvt_pk_bf16_f32 v107, v122, v126
    v_cvt_pk_bf16_f32 v110, v115, v119
    v_cvt_pk_bf16_f32 v111, v123, v127
    buffer_store_dwordx4 v[96:99], v20, s[4:7], s81 offen offset:0 sc1
    buffer_store_dwordx4 v[100:103], v20, s[4:7], s81 offen offset:768 sc1
    buffer_store_dwordx4 v[104:107], v20, s[4:7], s81 offen offset:1536 sc1
    buffer_store_dwordx4 v[108:111], v20, s[4:7], s81 offen offset:2304 sc1
    s_mov_b32 exec_hi, 0xffff
    ds_write_b128 v20, v[96:99] offset:12288
    ds_write_b128 v20, v[100:103] offset:13056
    ds_write_b128 v20, v[104:107] offset:13824
    ds_write_b128 v20, v[108:111] offset:14592
    s_mov_b32 exec_hi, -1
    v_mov_b32 v52, 0
    buffer_load_dword v52, off, s[88:91], s93 sc1
    s_lshl_b32 s39, s95, 2
    v_lshl_add_u32 v13, v0, 2, s39
    v_cmp_lt_u32 vcc, 0, v0
    v_mov_b32 v30, 0x40000000
    s_mov_b32 s96, 100000
    v_cndmask_b32 v13, v13, v30, vcc
    s_mul_i32 s39, s94, 1572864
    s_add_u32 s64, s42, s39
    s_addc_u32 s65, s43, 0
    s_mov_b32 s66, 1572864
    s_mov_b32 s67, 0x20000
    s_add_u32 s68, s44, s39
    s_addc_u32 s69, s45, 0
    s_mov_b32 s70, 1572864
    s_mov_b32 s71, 0x20000
    s_and_b32 s33, s29, 63
    s_waitcnt vmcnt(8)
    s_add_u32 m0, s82, 8192
    s_movk_i32 s24, 6144
    buffer_load_dwordx4 v234, s[8:11], s24 offen nt lds
    s_mul_i32 s33, s33, 24576
    s_mov_b32 s35, s33
    s_mul_i32 s26, s25, 3072
    s_add_u32 s26, s26, 12288
    s_add_u32 s56, s26, 24576
    s_add_u32 s39, s95, 1
    s_and_b32 s39, s39, 7
    s_mul_i32 s32, s39, 24576
    s_add_u32 s27, s32, 12288
    s_mov_b32 s28, 0
    s_mov_b32 s30, 24576
    s_waitcnt vmcnt(8)
    s_add_u32 m0, s82, 9216
    s_movk_i32 s24, 6144
    buffer_load_dwordx4 v235, s[8:11], s24 offen nt lds
    v_and_b32 v26, 15, v25
    v_lshrrev_b32 v49, 4, v25
    v_bfe_u32 v28, v25, 1, 3
    v_xor_b32 v29, v49, v28
    v_mul_u32_u24 v30, 384, v26
    v_lshl_add_u32 v2, v29, 4, v30
    v_xor_b32 v3, 64, v2
    v_mul_u32_u24 v50, 3072, v49
    v_add_u32 v50, 24576, v50
    v_and_b32 v51, 1, v49
    s_waitcnt vmcnt(8)
    s_add_u32 m0, s82, 10240
    s_movk_i32 s24, 6144
    buffer_load_dwordx4 v236, s[8:11], s24 offen nt lds
    v_lshl_add_u32 v51, v26, 1, v51
    v_lshl_add_u32 v1, v51, 4, v50
    v_xor_b32 v21, 16, v1
    v_lshl_add_u32 v22, v26, 4, v50
    v_add_u32 v22, 512, v22
    v_lshrrev_b32 v29, 1, v49
    v_xor_b32 v29, v29, v28
    v_lshl_add_u32 v31, v29, 4, v30
    v_and_b32 v29, 1, v49
    v_lshl_add_u32 v31, v29, 3, v31
    v_xor_b32 v32, 0, v31
    s_waitcnt vmcnt(8)
    s_add_u32 m0, s82, 11264
    s_movk_i32 s24, 6144
    buffer_load_dwordx4 v237, s[8:11], s24 offen nt lds
    v_xor_b32 v33, 32, v31
    v_xor_b32 v34, 64, v31
    v_xor_b32 v35, 96, v31
    v_add_u32 v32, s82, v32
    v_add_u32 v33, s82, v33
    v_add_u32 v34, s82, v34
    v_add_u32 v35, s82, v35
    v_mov_b32 v5, 0
    v_mov_b32 v6, 0
    v_mov_b32 v7, 0
    v_mov_b32 v8, 0
    s_waitcnt vmcnt(11)
    ds_read_b64 a[192:193], v32 offset:0
    ds_read_b64 a[194:195], v34 offset:128
    ds_read_b64 a[196:197], v33 offset:0
    ds_read_b64 a[198:199], v35 offset:128
    ds_read_b64 a[200:201], v34 offset:0
    ds_read_b64 a[202:203], v32 offset:256
    ds_read_b64 a[204:205], v35 offset:0
    ds_read_b64 a[206:207], v33 offset:256
    ds_read_b64 a[208:209], v32 offset:128
    ds_read_b64 a[210:211], v34 offset:256
    ds_read_b64 a[212:213], v33 offset:128
    ds_read_b64 a[214:215], v35 offset:256
    s_waitcnt lgkmcnt(0)
    s_barrier
    s_waitcnt vmcnt(4)
    v_readfirstlane_b32 s92, v52
    s_mov_b32 s39, 100
L_tagretry:
    s_cmp_lg_u32 s92, 0
    s_cbranch_scc1 L_tagok
    s_sub_u32 s39, s39, 1
    s_cbranch_scc1 L_tagslow
    s_sleep 8
    s_buffer_load_dword s92, s[88:91], s93 glc
    s_waitcnt lgkmcnt(0)
    s_branch L_tagretry
L_tagok:
    s_add_u32 s92, s92, 1
    v_mov_b32 v55, s92
    s_mov_b64 exec, 1
    v_mov_b32 v16, 1
    v_mov_b32 v17, 147456
    ds_add_rtn_u32 v16, v17, v16
    s_waitcnt lgkmcnt(0)
    v_readfirstlane_b32 s24, v16
    s_nop 0
    s_cmp_lg_u32 s24, 3
    s_cbranch_scc1 L_nopost
    s_lshl_b32 s39, s95, 2
    buffer_store_dword v55, off, s[20:23], s39 sc1
L_nopost:
    s_mov_b64 exec, -1
    ds_read_b128 v[144:147], v2 offset:0
    ds_read_b128 v[148:151], v3 offset:0
    ds_read_b128 v[152:155], v2 offset:6144
    ds_read_b128 v[156:159], v3 offset:6144
    ds_read_b128 v[160:163], v2 offset:128
    ds_read_b128 v[164:167], v3 offset:128
    ds_read_b128 v[168:171], v2 offset:6272
    ds_read_b128 v[172:175], v3 offset:6272
    ds_read_b128 v[176:179], v2 offset:256
    ds_read_b128 v[180:183], v3 offset:256
    ds_read_b128 v[184:187], v2 offset:6400
    ds_read_b128 v[188:191], v3 offset:6400
    s_waitcnt lgkmcnt(0)
    v_mfma_f32_16x16x32_bf16 v[64:67], v[144:147], a[192:195], 0
    v_mfma_f32_16x16x32_bf16 v[64:67], v[148:151], a[196:199], v[64:67]
    v_mfma_f32_16x16x32_bf16 v[64:67], v[160:163], a[200:203], v[64:67]
    v_mfma_f32_16x16x32_bf16 v[64:67], v[164:167], a[204:207], v[64:67]
    v_mfma_f32_16x16x32_bf16 v[64:67], v[176:179], a[208:211], v[64:67]
    v_mfma_f32_16x16x32_bf16 v[64:67], v[180:183], a[212:215], v[64:67]
    v_mfma_f32_16x16x32_bf16 v[96:99], v[152:155], a[192:195], 0
    v_mfma_f32_16x16x32_bf16 v[96:99], v[156:159], a[196:199], v[96:99]
    v_mfma_f32_16x16x32_bf16 v[96:99], v[168:171], a[200:203], v[96:99]
    v_mfma_f32_16x16x32_bf16 v[96:99], v[172:175], a[204:207], v[96:99]
    v_mfma_f32_16x16x32_bf16 v[96:99], v[184:187], a[208:211], v[96:99]
    v_mfma_f32_16x16x32_bf16 v[96:99], v[188:191], a[212:215], v[96:99]
    s_nop 7
    s_waitcnt vmcnt(8)
    s_add_u32 m0, s82, 12288
    s_movk_i32 s24, 12288
    buffer_load_dwordx4 v232, s[8:11], s24 offen nt lds
    v_max3_f32 v48, v64, v65, v66
    v_max3_f32 v48, v48, v67, v96
    v_max3_f32 v48, v48, v97, v98
    v_max_f32 v48, v48, v99
    v_mov_b32 v49, v48
    s_nop 1
    v_permlane16_swap_b32 v48, v49
    s_nop 1
    v_max_f32 v48, v48, v49
    v_mov_b32 v49, v48
    s_nop 1
    s_waitcnt vmcnt(8)
    s_add_u32 m0, s82, 13312
    s_movk_i32 s24, 12288
    buffer_load_dwordx4 v233, s[8:11], s24 offen nt lds
    v_permlane32_swap_b32 v48, v49
    s_nop 1
    v_max_f32 v48, v48, v49
    v_sub_f32 v128, 0, v48
    v_sub_f32 v129, 0, v48
    v_sub_f32 v130, 0, v48
    v_sub_f32 v131, 0, v48
    v_sub_f32 v64, v64, v48
    v_sub_f32 v65, v65, v48
    v_sub_f32 v66, v66, v48
    v_sub_f32 v67, v67, v48
    v_sub_f32 v96, v96, v48
    s_waitcnt vmcnt(8)
    s_add_u32 m0, s82, 14336
    s_movk_i32 s24, 12288
    buffer_load_dwordx4 v234, s[8:11], s24 offen nt lds
    v_sub_f32 v97, v97, v48
    v_sub_f32 v98, v98, v48
    v_sub_f32 v99, v99, v48
    v_exp_f32 v64, v64
    v_exp_f32 v65, v65
    v_exp_f32 v66, v66
    v_exp_f32 v67, v67
    v_exp_f32 v96, v96
    v_exp_f32 v97, v97
    v_exp_f32 v98, v98
    v_exp_f32 v99, v99
    s_waitcnt vmcnt(8)
    s_add_u32 m0, s82, 15360
    s_movk_i32 s24, 12288
    buffer_load_dwordx4 v235, s[8:11], s24 offen nt lds
    v_add_f32 v5, v5, v64
    v_add_f32 v5, v5, v65
    v_add_f32 v5, v5, v66
    v_add_f32 v5, v5, v67
    v_add_f32 v5, v5, v96
    v_add_f32 v5, v5, v97
    v_add_f32 v5, v5, v98
    v_add_f32 v5, v5, v99
    v_cvt_pk_bf16_f32 v64, v64, v65
    v_cvt_pk_bf16_f32 v65, v66, v67
    v_cvt_pk_bf16_f32 v66, v96, v97
    v_cvt_pk_bf16_f32 v67, v98, v99
    s_waitcnt vmcnt(4)
    ds_read_b64 a[216:217], v32 offset:6144
    ds_read_b64 a[218:219], v34 offset:6272
    ds_read_b64 a[220:221], v33 offset:6144
    ds_read_b64 a[222:223], v35 offset:6272
    ds_read_b64 a[224:225], v34 offset:6144
    ds_read_b64 a[226:227], v32 offset:6400
    ds_read_b64 a[228:229], v35 offset:6144
    ds_read_b64 a[230:231], v33 offset:6400
    ds_read_b64 a[232:233], v32 offset:6272
    ds_read_b64 a[234:235], v34 offset:6400
    ds_read_b64 a[236:237], v33 offset:6272
    ds_read_b64 a[238:239], v35 offset:6400
    s_waitcnt lgkmcnt(0)
    v_mfma_f32_16x16x32_bf16 v[68:71], v[144:147], a[216:219], 0
    v_mfma_f32_16x16x32_bf16 v[68:71], v[148:151], a[220:223], v[68:71]
    v_mfma_f32_16x16x32_bf16 v[68:71], v[160:163], a[224:227], v[68:71]
    v_mfma_f32_16x16x32_bf16 v[68:71], v[164:167], a[228:231], v[68:71]
    v_mfma_f32_16x16x32_bf16 v[68:71], v[176:179], a[232:235], v[68:71]
    v_mfma_f32_16x16x32_bf16 v[68:71], v[180:183], a[236:239], v[68:71]
    v_mfma_f32_16x16x32_bf16 v[100:103], v[152:155], a[216:219], 0
    v_mfma_f32_16x16x32_bf16 v[100:103], v[156:159], a[220:223], v[100:103]
    v_mfma_f32_16x16x32_bf16 v[100:103], v[168:171], a[224:227], v[100:103]
    v_mfma_f32_16x16x32_bf16 v[100:103], v[172:175], a[228:231], v[100:103]
    v_mfma_f32_16x16x32_bf16 v[100:103], v[184:187], a[232:235], v[100:103]
    v_mfma_f32_16x16x32_bf16 v[100:103], v[188:191], a[236:239], v[100:103]
    s_nop 7
    s_waitcnt vmcnt(8)
    s_add_u32 m0, s82, 16384
    s_movk_i32 s24, 12288
    buffer_load_dwordx4 v236, s[8:11], s24 offen nt lds
    v_max3_f32 v48, v68, v69, v70
    v_max3_f32 v48, v48, v71, v100
    v_max3_f32 v48, v48, v101, v102
    v_max_f32 v48, v48, v103
    v_mov_b32 v49, v48
    s_nop 1
    v_permlane16_swap_b32 v48, v49
    s_nop 1
    v_max_f32 v48, v48, v49
    v_mov_b32 v49, v48
    s_nop 1
    s_waitcnt vmcnt(8)
    s_add_u32 m0, s82, 17408
    s_movk_i32 s24, 12288
    buffer_load_dwordx4 v237, s[8:11], s24 offen nt lds
    v_permlane32_swap_b32 v48, v49
    s_nop 1
    v_max_f32 v48, v48, v49
    v_sub_f32 v132, 0, v48
    v_sub_f32 v133, 0, v48
    v_sub_f32 v134, 0, v48
    v_sub_f32 v135, 0, v48
    v_sub_f32 v68, v68, v48
    v_sub_f32 v69, v69, v48
    v_sub_f32 v70, v70, v48
    v_sub_f32 v71, v71, v48
    v_sub_f32 v100, v100, v48
    s_waitcnt vmcnt(8)
    s_add_u32 m0, s82, 0
    s_movk_i32 s24, 18432
    buffer_load_dwordx4 v232, s[8:11], s24 offen nt lds
    v_sub_f32 v101, v101, v48
    v_sub_f32 v102, v102, v48
    v_sub_f32 v103, v103, v48
    v_exp_f32 v68, v68
    v_exp_f32 v69, v69
    v_exp_f32 v70, v70
    v_exp_f32 v71, v71
    v_exp_f32 v100, v100
    v_exp_f32 v101, v101
    v_exp_f32 v102, v102
    v_exp_f32 v103, v103
    s_waitcnt vmcnt(8)
    s_add_u32 m0, s82, 1024
    s_movk_i32 s24, 18432
    buffer_load_dwordx4 v233, s[8:11], s24 offen nt lds
    v_add_f32 v6, v6, v68
    v_add_f32 v6, v6, v69
    v_add_f32 v6, v6, v70
    v_add_f32 v6, v6, v71
    v_add_f32 v6, v6, v100
    v_add_f32 v6, v6, v101
    v_add_f32 v6, v6, v102
    v_add_f32 v6, v6, v103
    v_cvt_pk_bf16_f32 v68, v68, v69
    v_cvt_pk_bf16_f32 v69, v70, v71
    v_cvt_pk_bf16_f32 v70, v100, v101
    v_cvt_pk_bf16_f32 v71, v102, v103
    s_buffer_load_dwordx8 s[72:79], s[20:23], 0 glc
    s_waitcnt vmcnt(8)
    s_add_u32 m0, s82, 2048
    s_movk_i32 s24, 18432
    buffer_load_dwordx4 v234, s[8:11], s24 offen nt lds
    s_add_u32 s33, s33, 196608
    s_sub_u32 s34, s33, 1572864
    s_min_u32 s33, s33, s34
    s_add_u32 s34, s33, 3072
    s_add_u32 s37, s37, 196608
    s_add_u32 s80, s80, 196608
    s_add_u32 s35, s35, 196608
    s_sub_u32 s36, s35, 1572864
    s_min_u32 s35, s35, s36
    s_add_u32 s36, s35, 3072
    s_add_u32 s81, s81, 196608
    s_mov_b32 s88, s60
    s_waitcnt vmcnt(8)
    s_add_u32 m0, s82, 3072
    s_movk_i32 s24, 18432
    buffer_load_dwordx4 v235, s[8:11], s24 offen nt lds
    s_mov_b32 s89, s61
    s_mov_b32 s90, L_slow-L_pc
    s_lshr_b32 s59, s2, 3
    s_waitcnt vmcnt(8)
    s_add_u32 m0, s82, 4096
    s_movk_i32 s24, 18432
    buffer_load_dwordx4 v236, s[8:11], s24 offen nt lds
    s_mul_i32 s93, s59, 43
    s_lshr_b32 s93, s93, 7
    s_mul_i32 s39, s93, 3
    s_waitcnt vmcnt(8)
    s_add_u32 m0, s82, 5120
    s_movk_i32 s24, 18432
    buffer_load_dwordx4 v237, s[8:11], s24 offen nt lds
    s_sub_u32 s59, s59, s39
    s_lshl_b32 s59, s59, 10
    s_mul_i32 s93, s93, 12288
    s_add_u32 s93, s93, s59
    s_lshl_b32 s24, s25, 4
    s_add_u32 s24, s24, s29
    s_and_b32 s58, s24, 63
    s_add_u32 s24, s24, 8
    s_and_b32 s57, s24, 63
    s_andn2_b32 s24, s29, 63
    s_or_b32 s58, s58, s24
    s_or_b32 s57, s57, s24
    v_mov_b32 v37, s58
    v_mov_b32 v38, s57
    v_cmp_lt_u32 vcc, 15, v25
    s_lshr_b32 s58, s58, 1
    s_lshr_b32 s57, s57, 1
    s_mulk_i32 s58, 384
    s_mulk_i32 s57, 384
    v_cndmask_b32 v37, v37, v38, vcc
    v_lshl_add_u32 v38, v25, 3, s58
    v_lshl_add_u32 v39, v25, 3, s57
    v_lshlrev_b32 v37, 6, v37
    v_lshl_add_u32 v37, v26, 2, v37
    s_mov_b32 exec_hi, 0xffff
    global_load_dwordx2 v[80:81], v38, s[46:47]
    global_load_dwordx2 v[82:83], v38, s[48:49]
    global_load_dwordx2 v[84:85], v39, s[46:47]
    global_load_dwordx2 v[86:87], v39, s[48:49]
    s_mov_b32 exec_hi, 0
    global_load_dword v88, v37, s[50:51]
    global_load_dword v89, v37, s[52:53]
    s_mov_b32 exec_hi, -1
    v_bfe_u32 v53, v4, 4, 6
    v_lshlrev_b32 v53, 2, v53
    s_mov_b32 s39, 200
    s_waitcnt lgkmcnt(0)
    s_sub_u32 s72, s72, s92
    s_sub_u32 s73, s73, s92
    s_sub_u32 s74, s74, s92
    s_sub_u32 s75, s75, s92
    s_sub_u32 s76, s76, s92
    s_sub_u32 s77, s77, s92
    s_sub_u32 s78, s78, s92
    s_sub_u32 s79, s79, s92
    s_max_u32 s72, s72, s73
    s_max_u32 s72, s72, s74
    s_max_u32 s72, s72, s75
    s_max_u32 s72, s72, s76
    s_max_u32 s72, s72, s77
    s_max_u32 s72, s72, s78
    s_max_u32 s72, s72, s79
    s_cmp_lt_u32 s72, 16
    s_cbranch_scc1 L_pollokP
L_pollretry:
    s_buffer_load_dwordx8 s[48:55], s[20:23], 0 glc
    s_waitcnt lgkmcnt(0)
    s_sub_u32 s48, s48, s92
    s_sub_u32 s49, s49, s92
    s_sub_u32 s50, s50, s92
    s_sub_u32 s51, s51, s92
    s_sub_u32 s52, s52, s92
    s_sub_u32 s53, s53, s92
    s_sub_u32 s54, s54, s92
    s_sub_u32 s55, s55, s92
    s_max_u32 s48, s48, s49
    s_max_u32 s48, s48, s50
    s_max_u32 s48, s48, s51
    s_max_u32 s48, s48, s52
    s_max_u32 s48, s48, s53
    s_max_u32 s48, s48, s54
    s_max_u32 s48, s48, s55
    s_cmp_lt_u32 s48, 16
    s_cbranch_scc1 L_pollokP
    s_sub_u32 s39, s39, 1
    s_cbranch_scc1 L_pollslowP
    s_sleep 1
    s_branch L_pollretry
L_pollokP:
    s_add_u32 s92, s92, 1
    s_mov_b32 m0, s26
    s_nop 0
    buffer_load_dwordx4 v4, s[4:7], s32 offen offset:0 sc1 lds
    buffer_load_dwordx4 v4, s[4:7], s32 offen offset:1024 sc1 lds
    buffer_load_dwordx4 v4, s[4:7], s32 offen offset:2048 sc1 lds
    s_add_u32 s32, s32, 24576
    s_sub_u32 s57, s32, 196608
    s_min_u32 s32, s32, s57
    s_add_u32 s26, s26, 36864
    s_sub_u32 s57, s26, 147456
    s_min_u32 s26, s26, s57
    s_waitcnt vmcnt(15)
    ds_read_b64 a[240:241], v32 offset:12288
    ds_read_b64 a[242:243], v34 offset:12416
    ds_read_b64 a[244:245], v33 offset:12288
    ds_read_b64 a[246:247], v35 offset:12416
    ds_read_b64 a[248:249], v34 offset:12288
    ds_read_b64 a[250:251], v32 offset:12544
    ds_read_b64 a[252:253], v35 offset:12288
    ds_read_b64 a[254:255], v33 offset:12544
    ds_read_b64 v[192:193], v32 offset:12416
    ds_read_b64 v[194:195], v34 offset:12544
    ds_read_b64 v[196:197], v33 offset:12416
    ds_read_b64 v[198:199], v35 offset:12544
    s_waitcnt lgkmcnt(0)
    v_mfma_f32_16x16x32_bf16 v[72:75], v[144:147], a[240:243], 0
    v_mfma_f32_16x16x32_bf16 v[72:75], v[148:151], a[244:247], v[72:75]
    v_mfma_f32_16x16x32_bf16 v[72:75], v[160:163], a[248:251], v[72:75]
    v_mfma_f32_16x16x32_bf16 v[72:75], v[164:167], a[252:255], v[72:75]
    v_mfma_f32_16x16x32_bf16 v[72:75], v[176:179], v[192:195], v[72:75]
    v_mfma_f32_16x16x32_bf16 v[72:75], v[180:183], v[196:199], v[72:75]
    v_mfma_f32_16x16x32_bf16 v[104:107], v[152:155], a[240:243], 0
    v_mfma_f32_16x16x32_bf16 v[104:107], v[156:159], a[244:247], v[104:107]
    v_mfma_f32_16x16x32_bf16 v[104:107], v[168:171], a[248:251], v[104:107]
    v_mfma_f32_16x16x32_bf16 v[104:107], v[172:175], a[252:255], v[104:107]
    v_mfma_f32_16x16x32_bf16 v[104:107], v[184:187], v[192:195], v[104:107]
    v_mfma_f32_16x16x32_bf16 v[104:107], v[188:191], v[196:199], v[104:107]
    s_nop 7
    s_mov_b32 m0, s26
    s_nop 0
    buffer_load_dwordx4 v4, s[4:7], s32 offen offset:0 sc1 lds
    buffer_load_dwordx4 v4, s[4:7], s32 offen offset:1024 sc1 lds
    buffer_load_dwordx4 v4, s[4:7], s32 offen offset:2048 sc1 lds
    s_add_u32 s32, s32, 24576
    s_sub_u32 s57, s32, 196608
    s_min_u32 s32, s32, s57
    s_add_u32 s26, s26, 12288
    v_max3_f32 v48, v72, v73, v74
    v_max3_f32 v48, v48, v75, v104
    v_max3_f32 v48, v48, v105, v106
    v_max_f32 v48, v48, v107
    v_mov_b32 v49, v48
    s_nop 1
    v_permlane16_swap_b32 v48, v49
    s_nop 1
    v_max_f32 v48, v48, v49
    v_mov_b32 v49, v48
    s_nop 1
    s_mov_b32 m0, s26
    s_nop 0
    buffer_load_dwordx4 v4, s[4:7], s32 offen offset:0 sc1 lds
    buffer_load_dwordx4 v4, s[4:7], s32 offen offset:1024 sc1 lds
    buffer_load_dwordx4 v4, s[4:7], s32 offen offset:2048 sc1 lds
    s_add_u32 s32, s32, 24576
    s_sub_u32 s57, s32, 196608
    s_min_u32 s32, s32, s57
    s_add_u32 s26, s26, 36864
    s_sub_u32 s57, s26, 147456
    s_min_u32 s26, s26, s57
    v_permlane32_swap_b32 v48, v49
    s_nop 1
    v_max_f32 v48, v48, v49
    v_sub_f32 v136, 0, v48
    v_sub_f32 v137, 0, v48
    v_sub_f32 v138, 0, v48
    v_sub_f32 v139, 0, v48
    v_sub_f32 v72, v72, v48
    v_sub_f32 v73, v73, v48
    v_sub_f32 v74, v74, v48
    v_sub_f32 v75, v75, v48
    v_sub_f32 v104, v104, v48
    s_mov_b32 m0, s56
    s_nop 0
    buffer_load_dwordx4 v4, s[4:7], s27 offen offset:0 sc1 lds
    buffer_load_dwordx4 v4, s[4:7], s27 offen offset:1024 sc1 lds
    buffer_load_dwordx4 v4, s[4:7], s27 offen offset:2048 sc1 lds
    s_add_u32 s27, s27, 24576
    s_sub_u32 s58, s27, 196608
    s_min_u32 s27, s27, s58
    s_add_u32 s56, s56, 36864
    s_sub_u32 s58, s56, 147456
    s_min_u32 s56, s56, s58
    v_sub_f32 v105, v105, v48
    v_sub_f32 v106, v106, v48
    v_sub_f32 v107, v107, v48
    v_exp_f32 v72, v72
    v_exp_f32 v73, v73
    v_exp_f32 v74, v74
    v_exp_f32 v75, v75
    v_exp_f32 v104, v104
    v_exp_f32 v105, v105
    v_exp_f32 v106, v106
    v_exp_f32 v107, v107
    s_mov_b32 s62, L_slow-L_pc
    s_bfe_u32 s24, s2, 0x20003
    s_add_u32 s24, s24, 1
    s_lshl_b32 s24, s24, 14
    v_lshlrev_b32 v30, 6, v0
    buffer_load_dword v15, v30, s[60:63], s24 offen
    v_add_f32 v7, v7, v72
    v_add_f32 v7, v7, v73
    v_add_f32 v7, v7, v74
    v_add_f32 v7, v7, v75
    v_add_f32 v7, v7, v104
    v_add_f32 v7, v7, v105
    v_add_f32 v7, v7, v106
    v_add_f32 v7, v7, v107
    v_cvt_pk_bf16_f32 v72, v72, v73
    v_cvt_pk_bf16_f32 v73, v74, v75
    v_cvt_pk_bf16_f32 v74, v104, v105
    v_cvt_pk_bf16_f32 v75, v106, v107
    buffer_load_dwordx4 v[224:227], v9, s[64:67], s33 offen offset:0 nt
    s_waitcnt vmcnt(14)
    v_lshlrev_b32 v112, 16, v80
    v_and_b32 v113, s97, v80
    v_lshlrev_b32 v114, 16, v82
    v_and_b32 v115, s97, v82
    v_lshlrev_b32 v116, 16, v81
    buffer_load_dwordx4 v[228:231], v9, s[64:67], s33 offen offset:1536 nt
    v_and_b32 v117, s97, v81
    v_lshlrev_b32 v118, 16, v83
    v_and_b32 v119, s97, v83
    v_lshlrev_b32 v120, 16, v84
    v_and_b32 v121, s97, v84
    v_lshlrev_b32 v122, 16, v86
    buffer_load_dwordx4 v[232:235], v9, s[64:67], s34 offen offset:0 nt
    v_and_b32 v123, s97, v86
    v_lshlrev_b32 v124, 16, v85
    v_and_b32 v125, s97, v85
    v_lshlrev_b32 v126, 16, v87
    v_and_b32 v127, s97, v87
    v_lshlrev_b32 v92, 16, v88
    v_and_b32 v93, s97, v88
    buffer_load_dwordx4 v[236:239], v9, s[64:67], s34 offen offset:1536 nt
    v_lshlrev_b32 v94, 16, v89
    v_and_b32 v95, s97, v89
    v_mul_f32 v112, s38, v112
    v_mul_f32 v113, s38, v113
    v_mul_f32 v116, s38, v116
    v_mul_f32 v117, s38, v117
    buffer_load_dwordx4 v[240:243], v9, s[64:67], s33 offen offset:384 nt
    v_mul_f32 v120, s38, v120
    v_mul_f32 v121, s38, v121
    v_mul_f32 v124, s38, v124
    v_mul_f32 v125, s38, v125
    v_mul_f32_e64 v114, -v114, v112
    v_mul_f32_e64 v115, -v115, v113
    buffer_load_dwordx4 v[244:247], v9, s[64:67], s33 offen offset:1920 nt
    v_mul_f32_e64 v118, -v118, v116
    v_mul_f32_e64 v119, -v119, v117
    v_mul_f32_e64 v122, -v122, v120
    v_mul_f32_e64 v123, -v123, v121
    v_mul_f32_e64 v126, -v126, v124
    v_mul_f32_e64 v127, -v127, v125
    v_mul_f32_e64 v94, -v94, v92
    buffer_load_dwordx4 v[248:251], v9, s[64:67], s34 offen offset:384 nt
    v_mul_f32_e64 v95, -v95, v93
    s_mul_i32 s57, s25, 3584
    v_add_u32 v36, s57, v36
    s_add_u32 s57, s57, 147584
    v_lshrrev_b32 v37, 4, v25
    v_mul_u32_u24 v37, 1792, v37
    buffer_load_dwordx4 v[252:255], v9, s[64:67], s34 offen offset:1920 nt
    v_lshl_add_u32 v37, v26, 4, v37
    v_add_u32 v37, s57, v37
    s_mov_b32 exec_hi, 0xffff
    ds_write_b128 v36, v[112:115] offset:0
    ds_write_b128 v36, v[116:119] offset:384
    ds_write_b128 v36, v[120:123] offset:1792
    ds_write_b128 v36, v[124:127] offset:2176
    s_mov_b32 exec_hi, 0
    ds_write_b128 v37, v[92:95] offset:1536
    s_mov_b32 exec_hi, -1
    v_add_u32 v10, 1792, v10
    s_lshl_b32 s57, s25, 6
    s_add_u32 s57, s57, 150912
    v_mov_b32 v23, s57
    s_waitcnt vmcnt(27)
    ds_read_b64 v[200:201], v32 offset:0
    ds_read_b64 v[202:203], v34 offset:128
    ds_read_b64 v[204:205], v33 offset:0
    ds_read_b64 v[206:207], v35 offset:128
    ds_read_b64 v[208:209], v34 offset:0
    ds_read_b64 v[210:211], v32 offset:256
    ds_read_b64 v[212:213], v35 offset:0
    ds_read_b64 v[214:215], v33 offset:256
    ds_read_b64 v[216:217], v32 offset:128
    ds_read_b64 v[218:219], v34 offset:256
    ds_read_b64 v[220:221], v33 offset:128
    ds_read_b64 v[222:223], v35 offset:256
    s_waitcnt lgkmcnt(0)
    v_mfma_f32_16x16x32_bf16 v[76:79], v[144:147], v[200:203], 0
    v_mfma_f32_16x16x32_bf16 v[76:79], v[148:151], v[204:207], v[76:79]
    v_mfma_f32_16x16x32_bf16 v[76:79], v[160:163], v[208:211], v[76:79]
    v_mfma_f32_16x16x32_bf16 v[76:79], v[164:167], v[212:215], v[76:79]
    v_mfma_f32_16x16x32_bf16 v[76:79], v[176:179], v[216:219], v[76:79]
    v_mfma_f32_16x16x32_bf16 v[76:79], v[180:183], v[220:223], v[76:79]
    v_mfma_f32_16x16x32_bf16 v[108:111], v[152:155], v[200:203], 0
    v_mfma_f32_16x16x32_bf16 v[108:111], v[156:159], v[204:207], v[108:111]
    v_mfma_f32_16x16x32_bf16 v[108:111], v[168:171], v[208:211], v[108:111]
    v_mfma_f32_16x16x32_bf16 v[108:111], v[172:175], v[212:215], v[108:111]
    v_mfma_f32_16x16x32_bf16 v[108:111], v[184:187], v[216:219], v[108:111]
    v_mfma_f32_16x16x32_bf16 v[108:111], v[188:191], v[220:223], v[108:111]
    s_waitcnt vmcnt(18)
    s_waitcnt lgkmcnt(0)
    s_barrier
    ds_read_b128 v[24:27], v2 offset:12288
    ds_read_b128 v[28:31], v3 offset:12288
    ds_read_b128 v[32:35], v2 offset:18432
    ds_read_b128 v[36:39], v3 offset:18432
    ds_read_b128 v[40:43], v2 offset:12416
    ds_read_b128 v[44:47], v3 offset:12416
    v_max3_f32 v48, v76, v77, v78
    v_max3_f32 v48, v48, v79, v108
    v_max3_f32 v48, v48, v109, v110
    v_max_f32 v48, v48, v111
    v_mov_b32 v49, v48
    s_nop 1
    v_permlane16_swap_b32 v48, v49
    s_nop 1
    v_max_f32 v48, v48, v49
    v_mov_b32 v49, v48
    s_nop 1
    v_permlane32_swap_b32 v48, v49
    s_nop 1
    v_max_f32 v48, v48, v49
    v_sub_f32 v140, 0, v48
    v_sub_f32 v141, 0, v48
    v_sub_f32 v142, 0, v48
    v_sub_f32 v143, 0, v48
    s_nop 0
    s_waitcnt lgkmcnt(4)
    v_mfma_f32_16x16x32_bf16 v[80:83], v[24:27], a[192:195], v[128:131]
    v_sub_f32 v76, v76, v48
    v_sub_f32 v77, v77, v48
    v_mfma_f32_16x16x32_bf16 v[80:83], v[28:31], a[196:199], v[80:83]
    s_mov_b32 m0, s56
    v_sub_f32 v78, v78, v48
    v_sub_f32 v79, v79, v48
    v_mfma_f32_16x16x32_bf16 v[84:87], v[24:27], a[216:219], v[132:135]
    v_sub_f32 v108, v108, v48
    v_sub_f32 v109, v109, v48
    v_mfma_f32_16x16x32_bf16 v[84:87], v[28:31], a[220:223], v[84:87]
    v_sub_f32 v110, v110, v48
    v_sub_f32 v111, v111, v48
    v_mfma_f32_16x16x32_bf16 v[88:91], v[24:27], a[240:243], v[136:139]
    v_exp_f32 v76, v76
    v_mfma_f32_16x16x32_bf16 v[88:91], v[28:31], a[244:247], v[88:91]
    buffer_load_dwordx4 v4, s[4:7], s27 offen offset:0 sc1 lds
    v_mfma_f32_16x16x32_bf16 v[92:95], v[24:27], v[200:203], v[140:143]
    v_exp_f32 v77, v77
    v_mfma_f32_16x16x32_bf16 v[92:95], v[28:31], v[204:207], v[92:95]
    ds_read_b128 v[24:27], v2 offset:18560
    ds_read_b128 v[28:31], v3 offset:18560
    s_waitcnt lgkmcnt(4)
    v_mfma_f32_16x16x32_bf16 v[112:115], v[32:35], a[192:195], v[128:131]
    v_exp_f32 v78, v78
    v_mfma_f32_16x16x32_bf16 v[112:115], v[36:39], a[196:199], v[112:115]
    buffer_load_dwordx4 v4, s[4:7], s27 offen offset:1024 sc1 lds
    v_mfma_f32_16x16x32_bf16 v[116:119], v[32:35], a[216:219], v[132:135]
    v_exp_f32 v79, v79
    v_mfma_f32_16x16x32_bf16 v[116:119], v[36:39], a[220:223], v[116:119]
    v_exp_f32 v108, v108
    v_mfma_f32_16x16x32_bf16 v[120:123], v[32:35], a[240:243], v[136:139]
    v_exp_f32 v109, v109
    v_mfma_f32_16x16x32_bf16 v[120:123], v[36:39], a[244:247], v[120:123]
    buffer_load_dwordx4 v4, s[4:7], s27 offen offset:2048 sc1 lds
    v_mfma_f32_16x16x32_bf16 v[124:127], v[32:35], v[200:203], v[140:143]
    v_exp_f32 v110, v110
    v_mfma_f32_16x16x32_bf16 v[124:127], v[36:39], v[204:207], v[124:127]
    ds_read_b128 v[32:35], v2 offset:12544
    ds_read_b128 v[36:39], v3 offset:12544
    s_waitcnt lgkmcnt(4)
    v_mfma_f32_16x16x32_bf16 v[80:83], v[40:43], a[200:203], v[80:83]
    v_exp_f32 v111, v111
    v_mfma_f32_16x16x32_bf16 v[80:83], v[44:47], a[204:207], v[80:83]
    s_add_u32 s27, s27, 24576
    s_sub_u32 s58, s27, 196608
    s_min_u32 s27, s27, s58
    s_add_u32 s56, s56, 12288
    v_mfma_f32_16x16x32_bf16 v[84:87], v[40:43], a[224:227], v[84:87]
    v_add_f32 v8, v8, v76
    v_add_f32 v8, v8, v77
    v_mfma_f32_16x16x32_bf16 v[84:87], v[44:47], a[228:231], v[84:87]
    v_add_f32 v8, v8, v78
    v_add_f32 v8, v8, v79
    v_mfma_f32_16x16x32_bf16 v[88:91], v[40:43], a[248:251], v[88:91]
    v_add_f32 v8, v8, v108
    v_add_f32 v8, v8, v109
    v_mfma_f32_16x16x32_bf16 v[88:91], v[44:47], a[252:255], v[88:91]
    s_mov_b32 m0, s56
    v_add_f32 v8, v8, v110
    v_add_f32 v8, v8, v111
    v_mfma_f32_16x16x32_bf16 v[92:95], v[40:43], v[208:211], v[92:95]
    v_cvt_pk_bf16_f32 v76, v76, v77
    v_cvt_pk_bf16_f32 v77, v78, v79
    v_mfma_f32_16x16x32_bf16 v[92:95], v[44:47], v[212:215], v[92:95]
    ds_read_b128 v[40:43], v2 offset:18688
    ds_read_b128 v[44:47], v3 offset:18688
    s_waitcnt lgkmcnt(4)
    v_mfma_f32_16x16x32_bf16 v[112:115], v[24:27], a[200:203], v[112:115]
    v_cvt_pk_bf16_f32 v78, v108, v109
    v_cvt_pk_bf16_f32 v79, v110, v111
    v_mfma_f32_16x16x32_bf16 v[112:115], v[28:31], a[204:207], v[112:115]
    buffer_load_dwordx4 v4, s[4:7], s27 offen offset:0 sc1 lds
    v_mfma_f32_16x16x32_bf16 v[116:119], v[24:27], a[224:227], v[116:119]
    v_mfma_f32_16x16x32_bf16 v[116:119], v[28:31], a[228:231], v[116:119]
    v_mfma_f32_16x16x32_bf16 v[120:123], v[24:27], a[248:251], v[120:123]
    v_mfma_f32_16x16x32_bf16 v[120:123], v[28:31], a[252:255], v[120:123]
    buffer_load_dwordx4 v4, s[4:7], s27 offen offset:1024 sc1 lds
    v_mfma_f32_16x16x32_bf16 v[124:127], v[24:27], v[208:211], v[124:127]
    v_mfma_f32_16x16x32_bf16 v[124:127], v[28:31], v[212:215], v[124:127]
    s_waitcnt lgkmcnt(2)
    v_mfma_f32_16x16x32_bf16 v[80:83], v[32:35], a[208:211], v[80:83]
    v_mfma_f32_16x16x32_bf16 v[80:83], v[36:39], a[212:215], v[80:83]
    buffer_load_dwordx4 v4, s[4:7], s27 offen offset:2048 sc1 lds
    v_mfma_f32_16x16x32_bf16 v[84:87], v[32:35], a[232:235], v[84:87]
    v_mfma_f32_16x16x32_bf16 v[84:87], v[36:39], a[236:239], v[84:87]
    v_mfma_f32_16x16x32_bf16 v[88:91], v[32:35], v[192:195], v[88:91]
    v_mfma_f32_16x16x32_bf16 v[88:91], v[36:39], v[196:199], v[88:91]
    s_add_u32 s27, s27, 24576
    s_sub_u32 s58, s27, 196608
    s_min_u32 s27, s27, s58
    v_mfma_f32_16x16x32_bf16 v[92:95], v[32:35], v[216:219], v[92:95]
    v_mfma_f32_16x16x32_bf16 v[92:95], v[36:39], v[220:223], v[92:95]
    s_waitcnt lgkmcnt(0)
    v_mfma_f32_16x16x32_bf16 v[112:115], v[40:43], a[208:211], v[112:115]
    v_mfma_f32_16x16x32_bf16 v[112:115], v[44:47], a[212:215], v[112:115]
    s_add_u32 s56, s56, 36864
    s_sub_u32 s58, s56, 147456
    s_min_u32 s56, s56, s58
    v_mfma_f32_16x16x32_bf16 v[116:119], v[40:43], a[232:235], v[116:119]
    v_mfma_f32_16x16x32_bf16 v[116:119], v[44:47], a[236:239], v[116:119]
    v_mfma_f32_16x16x32_bf16 v[120:123], v[40:43], v[192:195], v[120:123]
    v_mfma_f32_16x16x32_bf16 v[120:123], v[44:47], v[196:199], v[120:123]
    v_mfma_f32_16x16x32_bf16 v[124:127], v[40:43], v[216:219], v[124:127]
    v_mfma_f32_16x16x32_bf16 v[124:127], v[44:47], v[220:223], v[124:127]
    s_add_u32 s29, s28, 49152
    s_sub_u32 s3, s29, 147456
    s_min_u32 s29, s29, s3
    s_sub_u32 s3, s29, s28
    s_mov_b32 s28, s29
    v_add_u32 v2, s3, v2
    v_add_u32 v3, s3, v3
    s_waitcnt vmcnt(18)
    s_barrier
    ds_read_b128 v[24:27], v2 offset:0
    ds_read_b128 v[28:31], v3 offset:0
    ds_read_b128 v[32:35], v2 offset:6144
    ds_read_b128 v[36:39], v3 offset:6144
    ds_read_b128 v[48:51], v10 offset:0
    s_mov_b32 s31, 5
    s_waitcnt lgkmcnt(3)
    v_mfma_f32_16x16x32_bf16 v[160:163], v[24:27], a[192:195], v[128:131]
    ds_read_b128 v[40:43], v2 offset:128
    v_mfma_f32_16x16x32_bf16 v[160:163], v[28:31], a[196:199], v[160:163]
    buffer_load_dwordx4 v[144:147], v12, s[68:71], s35 offen offset:0 nt
    v_mfma_f32_16x16x32_bf16 v[164:167], v[24:27], a[216:219], v[132:135]
    v_exp_f32 v16, v80
    v_mfma_f32_16x16x32_bf16 v[164:167], v[28:31], a[220:223], v[164:167]
    v_exp_f32 v17, v81
    v_mfma_f32_16x16x32_bf16 v[168:171], v[24:27], a[240:243], v[136:139]
    ds_read_b128 v[44:47], v3 offset:128
    v_mfma_f32_16x16x32_bf16 v[168:171], v[28:31], a[244:247], v[168:171]
    v_exp_f32 v18, v82
    v_add_f32 v5, v5, v16
    v_mfma_f32_16x16x32_bf16 v[172:175], v[24:27], v[200:203], v[140:143]
    v_add_f32 v5, v5, v17
    v_mfma_f32_16x16x32_bf16 v[172:175], v[28:31], v[204:207], v[172:175]
    s_waitcnt lgkmcnt(3)
    buffer_load_dwordx4 v[148:151], v12, s[68:71], s35 offen offset:768 nt
    v_mfma_f32_16x16x32_bf16 v[96:99], v[32:35], a[192:195], v[128:131]
    ds_read_b128 v[24:27], v2 offset:6272
    v_mfma_f32_16x16x32_bf16 v[96:99], v[36:39], a[196:199], v[96:99]
    v_exp_f32 v19, v83
    v_cvt_pk_bf16_f32 v80, v16, v17
    v_mfma_f32_16x16x32_bf16 v[100:103], v[32:35], a[216:219], v[132:135]
    v_exp_f32 v16, v112
    v_mfma_f32_16x16x32_bf16 v[100:103], v[36:39], a[220:223], v[100:103]
    v_add_f32 v5, v5, v18
    v_add_f32 v5, v5, v19
    v_mfma_f32_16x16x32_bf16 v[104:107], v[32:35], a[240:243], v[136:139]
    ds_read_b128 v[28:31], v3 offset:6272
    v_mfma_f32_16x16x32_bf16 v[104:107], v[36:39], a[244:247], v[104:107]
    v_exp_f32 v17, v113
    v_cvt_pk_bf16_f32 v81, v18, v19
    v_mfma_f32_16x16x32_bf16 v[108:111], v[32:35], v[200:203], v[140:143]
    v_exp_f32 v18, v114
    v_mfma_f32_16x16x32_bf16 v[108:111], v[36:39], v[204:207], v[108:111]
    s_waitcnt lgkmcnt(2)
    buffer_load_dwordx4 v[152:155], v12, s[68:71], s35 offen offset:1536 nt
    v_add_f32 v5, v5, v16
    v_mfma_f32_16x16x32_bf16 v[160:163], v[40:43], a[200:203], v[160:163]
    ds_read_b128 v[32:35], v2 offset:256
    v_add_f32 v5, v5, v17
    v_mfma_f32_16x16x32_bf16 v[160:163], v[44:47], a[204:207], v[160:163]
    v_exp_f32 v19, v115
    v_cvt_pk_bf16_f32 v82, v16, v17
    v_mfma_f32_16x16x32_bf16 v[164:167], v[40:43], a[224:227], v[164:167]
    v_exp_f32 v16, v84
    v_mfma_f32_16x16x32_bf16 v[164:167], v[44:47], a[228:231], v[164:167]
    v_add_f32 v5, v5, v18
    v_add_f32 v5, v5, v19
    v_mfma_f32_16x16x32_bf16 v[168:171], v[40:43], a[248:251], v[168:171]
    s_mov_b32 m0, s26
    ds_read_b128 v[36:39], v3 offset:256
    v_mfma_f32_16x16x32_bf16 v[168:171], v[44:47], a[252:255], v[168:171]
    v_exp_f32 v17, v85
    v_cvt_pk_bf16_f32 v83, v18, v19
    v_mfma_f32_16x16x32_bf16 v[172:175], v[40:43], v[208:211], v[172:175]
    v_exp_f32 v18, v86
    v_mfma_f32_16x16x32_bf16 v[172:175], v[44:47], v[212:215], v[172:175]
    s_waitcnt lgkmcnt(2)
    buffer_load_dwordx4 v[156:159], v12, s[68:71], s35 offen offset:2304 nt
    v_add_f32 v6, v6, v16
    v_mfma_f32_16x16x32_bf16 v[96:99], v[24:27], a[200:203], v[96:99]
    ds_read_b128 v[40:43], v2 offset:6400
    v_add_f32 v6, v6, v17
    v_mfma_f32_16x16x32_bf16 v[96:99], v[28:31], a[204:207], v[96:99]
    v_exp_f32 v19, v87
    v_cvt_pk_bf16_f32 v84, v16, v17
    v_mfma_f32_16x16x32_bf16 v[100:103], v[24:27], a[224:227], v[100:103]
    v_exp_f32 v16, v116
    v_mfma_f32_16x16x32_bf16 v[100:103], v[28:31], a[228:231], v[100:103]
    buffer_load_dwordx4 v4, s[4:7], s32 offen offset:0 sc1 lds
    v_add_f32 v6, v6, v18
    v_mfma_f32_16x16x32_bf16 v[104:107], v[24:27], a[248:251], v[104:107]
    ds_read_b128 v[44:47], v3 offset:6400
    v_add_f32 v6, v6, v19
    v_mfma_f32_16x16x32_bf16 v[104:107], v[28:31], a[252:255], v[104:107]
    v_exp_f32 v17, v117
    v_cvt_pk_bf16_f32 v85, v18, v19
    v_mfma_f32_16x16x32_bf16 v[108:111], v[24:27], v[208:211], v[108:111]
    v_exp_f32 v18, v118
    v_mfma_f32_16x16x32_bf16 v[108:111], v[28:31], v[212:215], v[108:111]
    s_waitcnt lgkmcnt(2)
    buffer_load_dwordx4 v4, s[4:7], s32 offen offset:1024 sc1 lds
    v_add_f32 v6, v6, v16
    v_mfma_f32_16x16x32_bf16 v[160:163], v[32:35], a[208:211], v[160:163]
    ds_read_b128 v[24:27], v2 offset:12288
    v_add_f32 v6, v6, v17
    v_mfma_f32_16x16x32_bf16 v[160:163], v[36:39], a[212:215], v[160:163]
    v_exp_f32 v19, v119
    v_cvt_pk_bf16_f32 v86, v16, v17
    v_mfma_f32_16x16x32_bf16 v[164:167], v[32:35], a[232:235], v[164:167]
    v_add_f32 v6, v6, v18
    v_add_f32 v6, v6, v19
    v_mfma_f32_16x16x32_bf16 v[164:167], v[36:39], a[236:239], v[164:167]
    buffer_load_dwordx4 v4, s[4:7], s32 offen offset:2048 sc1 lds
    v_cvt_pk_bf16_f32 v87, v18, v19
    v_mfma_f32_16x16x32_bf16 v[168:171], v[32:35], v[192:195], v[168:171]
    ds_read_b128 v[28:31], v3 offset:12288
    v_mfma_f32_16x16x32_bf16 v[168:171], v[36:39], v[196:199], v[168:171]
    v_exp_f32 v16, v88
    v_mfma_f32_16x16x32_bf16 v[172:175], v[32:35], v[216:219], v[172:175]
    v_exp_f32 v17, v89
    v_mfma_f32_16x16x32_bf16 v[172:175], v[36:39], v[220:223], v[172:175]
    s_waitcnt lgkmcnt(2)
    v_exp_f32 v18, v90
    v_add_f32 v7, v7, v16
    v_mfma_f32_16x16x32_bf16 v[96:99], v[40:43], a[208:211], v[96:99]
    s_add_u32 s32, s32, 24576
    ds_read_b128 v[32:35], v2 offset:18432
    v_add_f32 v7, v7, v17
    v_mfma_f32_16x16x32_bf16 v[96:99], v[44:47], a[212:215], v[96:99]
    v_exp_f32 v19, v91
    v_cvt_pk_bf16_f32 v88, v16, v17
    v_mfma_f32_16x16x32_bf16 v[100:103], v[40:43], a[232:235], v[100:103]
    s_sub_u32 s57, s32, 196608
    v_exp_f32 v16, v120
    v_mfma_f32_16x16x32_bf16 v[100:103], v[44:47], a[236:239], v[100:103]
    ds_read_b128 v[56:59], v10 offset:384
    v_add_f32 v7, v7, v18
    v_add_f32 v7, v7, v19
    v_mfma_f32_16x16x32_bf16 v[104:107], v[40:43], v[192:195], v[104:107]
    s_waitcnt vmcnt(19)
    ds_read_b128 v[36:39], v3 offset:18432
    v_cvt_f32_i32 v224, v224
    v_mfma_f32_16x16x32_bf16 v[104:107], v[44:47], v[196:199], v[104:107]
    v_exp_f32 v17, v121
    v_cvt_pk_bf16_f32 v89, v18, v19
    v_mfma_f32_16x16x32_bf16 v[108:111], v[40:43], v[216:219], v[108:111]
    s_min_u32 s32, s32, s57
    v_exp_f32 v18, v122
    v_mfma_f32_16x16x32_bf16 v[108:111], v[44:47], v[220:223], v[108:111]
    s_waitcnt lgkmcnt(3)
    v_add_f32 v7, v7, v16
    v_add_f32 v7, v7, v17
    v_cvt_f32_i32 v225, v225
    v_mfma_f32_16x16x32_bf16 v[176:179], v[24:27], a[192:195], v[128:131]
    ds_read_b128 v[40:43], v2 offset:12416
    v_cvt_f32_i32 v228, v228
    v_mfma_f32_16x16x32_bf16 v[176:179], v[28:31], a[196:199], v[176:179]
    v_exp_f32 v19, v123
    v_cvt_pk_bf16_f32 v90, v16, v17
    v_mfma_f32_16x16x32_bf16 v[180:183], v[24:27], a[216:219], v[132:135]
    v_exp_f32 v16, v92
    v_add_f32 v7, v7, v18
    v_add_f32 v7, v7, v19
    v_exp_f32 v17, v93
    v_cvt_pk_bf16_f32 v91, v18, v19
    v_exp_f32 v18, v94
    v_add_f32 v8, v8, v16
    v_add_f32 v8, v8, v17
    v_exp_f32 v19, v95
    v_cvt_pk_bf16_f32 v92, v16, v17
    v_exp_f32 v16, v124
    v_add_f32 v8, v8, v18
    v_add_f32 v8, v8, v19
    v_exp_f32 v17, v125
    v_cvt_pk_bf16_f32 v93, v18, v19
    v_exp_f32 v18, v126
    v_add_f32 v8, v8, v16
    v_add_f32 v8, v8, v17
    v_exp_f32 v19, v127
    v_cvt_pk_bf16_f32 v94, v16, v17
    v_add_f32 v8, v8, v18
    v_add_f32 v8, v8, v19
    v_cvt_pk_bf16_f32 v95, v18, v19
    v_mfma_f32_16x16x32_bf16 v[180:183], v[28:31], a[220:223], v[180:183]
    ds_read_b128 v[60:63], v10 offset:768
    v_cvt_f32_i32 v229, v229
    v_fma_f32 v224, v224, v48, v50
    v_mfma_f32_16x16x32_bf16 v[184:187], v[24:27], a[240:243], v[136:139]
    s_add_u32 s26, s26, 12288
    ds_read_b128 v[44:47], v3 offset:12416
    v_fma_f32 v225, v225, v49, v51
    v_mfma_f32_16x16x32_bf16 v[184:187], v[28:31], a[244:247], v[184:187]
    s_mov_b32 m0, s26
    v_fma_f32 v228, v228, v48, v50
    v_fma_f32 v229, v229, v49, v51
    v_mfma_f32_16x16x32_bf16 v[188:191], v[24:27], v[200:203], v[140:143]
    v_cvt_pk_bf16_f32 v224, v224, v225
    v_cvt_pk_bf16_f32 v228, v228, v229
    s_waitcnt lgkmcnt(4)
    v_mfma_f32_16x16x32_bf16 v[188:191], v[28:31], v[204:207], v[188:191]
    s_waitcnt lgkmcnt(3)
    v_exp_f32 v16, v160
    v_mfma_f32_16x16x32_bf16 v[112:115], v[32:35], a[192:195], v[128:131]
    ds_read_b128 v[24:27], v2 offset:18560
    v_cvt_f32_i32 v226, v226
    v_mfma_f32_16x16x32_bf16 v[112:115], v[36:39], a[196:199], v[112:115]
    buffer_load_dwordx4 v4, s[4:7], s32 offen offset:0 sc1 lds
    v_mfma_f32_16x16x32_bf16 v[116:119], v[32:35], a[216:219], v[132:135]
    v_exp_f32 v17, v161
    v_mfma_f32_16x16x32_bf16 v[116:119], v[36:39], a[220:223], v[116:119]
    v_exp_f32 v18, v162
    v_mfma_f32_16x16x32_bf16 v[120:123], v[32:35], a[240:243], v[136:139]
    ds_read_b128 v[28:31], v3 offset:18560
    v_cvt_f32_i32 v227, v227
    v_mfma_f32_16x16x32_bf16 v[120:123], v[36:39], a[244:247], v[120:123]
    v_add_f32 v5, v5, v16
    v_cvt_f32_i32 v230, v230
    v_mfma_f32_16x16x32_bf16 v[124:127], v[32:35], v[200:203], v[140:143]
    v_add_f32 v5, v5, v17
    v_cvt_f32_i32 v231, v231
    v_mfma_f32_16x16x32_bf16 v[124:127], v[36:39], v[204:207], v[124:127]
    s_waitcnt lgkmcnt(2)
    buffer_load_dwordx4 v4, s[4:7], s32 offen offset:1024 sc1 lds
    v_mfma_f32_16x16x32_bf16 v[176:179], v[40:43], a[200:203], v[176:179]
    ds_read_b128 v[32:35], v2 offset:12544
    v_fma_f32 v226, v226, v56, v58
    v_mfma_f32_16x16x32_bf16 v[176:179], v[44:47], a[204:207], v[176:179]
    v_exp_f32 v19, v163
    v_cvt_pk_bf16_f32 v160, v16, v17
    v_mfma_f32_16x16x32_bf16 v[180:183], v[40:43], a[224:227], v[180:183]
    v_exp_f32 v16, v96
    v_mfma_f32_16x16x32_bf16 v[180:183], v[44:47], a[228:231], v[180:183]
    v_add_f32 v5, v5, v18
    v_fma_f32 v227, v227, v57, v59
    v_add_f32 v5, v5, v19
    v_mfma_f32_16x16x32_bf16 v[184:187], v[40:43], a[248:251], v[184:187]
    ds_read_b128 v[36:39], v3 offset:12544
    v_fma_f32 v230, v230, v56, v58
    v_mfma_f32_16x16x32_bf16 v[184:187], v[44:47], a[252:255], v[184:187]
    buffer_load_dwordx4 v4, s[4:7], s32 offen offset:2048 sc1 lds
    v_fma_f32 v231, v231, v57, v59
    v_mfma_f32_16x16x32_bf16 v[188:191], v[40:43], v[208:211], v[188:191]
    v_exp_f32 v17, v97
    v_mfma_f32_16x16x32_bf16 v[188:191], v[44:47], v[212:215], v[188:191]
    s_waitcnt lgkmcnt(2)
    v_cvt_pk_bf16_f32 v161, v18, v19
    v_exp_f32 v18, v98
    v_mfma_f32_16x16x32_bf16 v[112:115], v[24:27], a[200:203], v[112:115]
    ds_read_b128 v[40:43], v2 offset:18688
    v_cvt_pk_bf16_f32 v225, v226, v227
    v_mfma_f32_16x16x32_bf16 v[112:115], v[28:31], a[204:207], v[112:115]
    v_add_f32 v5, v5, v16
    v_cvt_pk_bf16_f32 v229, v230, v231
    v_add_f32 v5, v5, v17
    v_mfma_f32_16x16x32_bf16 v[116:119], v[24:27], a[224:227], v[116:119]
    s_waitcnt vmcnt(20)
    v_exp_f32 v19, v99
    v_mfma_f32_16x16x32_bf16 v[116:119], v[28:31], a[228:231], v[116:119]
    s_add_u32 s32, s32, 24576
    v_cvt_f32_i32 v232, v232
    v_cvt_pk_bf16_f32 v162, v16, v17
    v_mfma_f32_16x16x32_bf16 v[120:123], v[24:27], a[248:251], v[120:123]
    s_sub_u32 s57, s32, 196608
    ds_read_b128 v[44:47], v3 offset:18688
    v_cvt_f32_i32 v233, v233
    v_mfma_f32_16x16x32_bf16 v[120:123], v[28:31], a[252:255], v[120:123]
    s_waitcnt lgkmcnt(2)
    v_exp_f32 v16, v164
    v_add_f32 v5, v5, v18
    v_mfma_f32_16x16x32_bf16 v[124:127], v[24:27], v[208:211], v[124:127]
    s_waitcnt vmcnt(25)
    v_cvt_f32_i32 v236, v236
    v_add_f32 v5, v5, v19
    v_mfma_f32_16x16x32_bf16 v[124:127], v[28:31], v[212:215], v[124:127]
    s_barrier
    v_exp_f32 v17, v165
    v_mfma_f32_16x16x32_bf16 v[176:179], v[32:35], a[208:211], v[176:179]
    s_min_u32 s32, s32, s57
    ds_read_b128 v[24:27], v1 offset:0
    v_cvt_f32_i32 v237, v237
    v_mfma_f32_16x16x32_bf16 v[176:179], v[36:39], a[212:215], v[176:179]
    s_add_u32 s26, s26, 36864
    v_cvt_pk_bf16_f32 v163, v18, v19
    v_fma_f32 v232, v232, v48, v50
    v_mfma_f32_16x16x32_bf16 v[180:183], v[32:35], a[232:235], v[180:183]
    s_sub_u32 s57, s26, 147456
    v_exp_f32 v18, v166
    v_mfma_f32_16x16x32_bf16 v[180:183], v[36:39], a[236:239], v[180:183]
    s_min_u32 s26, s26, s57
    v_fma_f32 v233, v233, v49, v51
    v_add_f32 v6, v6, v16
    v_mfma_f32_16x16x32_bf16 v[184:187], v[32:35], v[192:195], v[184:187]
    ds_read_b128 v[28:31], v1 offset:12288
    v_add_f32 v6, v6, v17
    v_mfma_f32_16x16x32_bf16 v[184:187], v[36:39], v[196:199], v[184:187]
    v_fma_f32 v236, v236, v48, v50
    v_exp_f32 v19, v167
    v_mfma_f32_16x16x32_bf16 v[188:191], v[32:35], v[216:219], v[188:191]
    v_fma_f32 v237, v237, v49, v51
    v_cvt_pk_bf16_f32 v164, v16, v17
    v_mfma_f32_16x16x32_bf16 v[188:191], v[36:39], v[220:223], v[188:191]
    s_waitcnt lgkmcnt(2)
    v_exp_f32 v16, v100
    v_cvt_pk_bf16_f32 v232, v232, v233
    v_mfma_f32_16x16x32_bf16 v[112:115], v[40:43], a[208:211], v[112:115]
    ds_read_b128 v[32:35], v1 offset:768
    v_cvt_pk_bf16_f32 v236, v236, v237
    v_mfma_f32_16x16x32_bf16 v[112:115], v[44:47], a[212:215], v[112:115]
    v_add_f32 v6, v6, v18
    v_add_f32 v6, v6, v19
    v_mfma_f32_16x16x32_bf16 v[116:119], v[40:43], a[232:235], v[116:119]
    v_cvt_f32_i32 v234, v234
    v_cvt_f32_i32 v235, v235
    v_mfma_f32_16x16x32_bf16 v[116:119], v[44:47], a[236:239], v[116:119]
    v_exp_f32 v17, v101
    v_mfma_f32_16x16x32_bf16 v[120:123], v[40:43], v[192:195], v[120:123]
    ds_read_b128 v[36:39], v1 offset:13056
    v_cvt_pk_bf16_f32 v165, v18, v19
    v_mfma_f32_16x16x32_bf16 v[120:123], v[44:47], v[196:199], v[120:123]
    v_exp_f32 v18, v102
    v_cvt_f32_i32 v238, v238
    v_mfma_f32_16x16x32_bf16 v[124:127], v[40:43], v[216:219], v[124:127]
    v_add_f32 v6, v6, v16
    v_cvt_f32_i32 v239, v239
    v_mfma_f32_16x16x32_bf16 v[124:127], v[44:47], v[220:223], v[124:127]
    s_waitcnt lgkmcnt(2)
    v_add_f32 v6, v6, v17
    v_exp_f32 v19, v103
    v_fma_f32 v234, v234, v56, v58
    v_fma_f32 v235, v235, v57, v59
    v_cvt_pk_bf16_f32 v166, v16, v17
    v_fma_f32 v238, v238, v56, v58
    v_add_f32 v6, v6, v18
    v_fma_f32 v239, v239, v57, v59
    v_add_f32 v6, v6, v19
    v_cvt_pk_bf16_f32 v233, v234, v235
    v_cvt_pk_bf16_f32 v167, v18, v19
    v_cvt_pk_bf16_f32 v237, v238, v239
    v_mfma_f32_16x16x32_bf16 a[0:3], v[64:67], v[24:27], 0
    s_mov_b32 m0, s26
    ds_read_b128 v[40:43], v1 offset:1536
    v_mfma_f32_16x16x32_bf16 a[0:3], v[80:83], v[28:31], a[0:3]
    buffer_load_dwordx4 v4, s[4:7], s32 offen offset:0 sc1 lds
    v_mfma_f32_16x16x32_bf16 a[48:51], v[68:71], v[24:27], 0
    v_exp_f32 v16, v168
    v_mfma_f32_16x16x32_bf16 a[48:51], v[84:87], v[28:31], a[48:51]
    ds_read_b128 v[48:51], v10 offset:1152
    s_waitcnt vmcnt(19)
    v_mfma_f32_16x16x32_bf16 a[96:99], v[72:75], v[24:27], 0
    ds_read_b128 v[44:47], v1 offset:13824
    v_cvt_f32_i32 v240, v240
    v_mfma_f32_16x16x32_bf16 a[96:99], v[88:91], v[28:31], a[96:99]
    buffer_load_dwordx4 v4, s[4:7], s32 offen offset:1024 sc1 lds
    v_mfma_f32_16x16x32_bf16 a[144:147], v[76:79], v[24:27], 0
    v_exp_f32 v17, v169
    v_mfma_f32_16x16x32_bf16 a[144:147], v[92:95], v[28:31], a[144:147]
    s_waitcnt lgkmcnt(3)
    v_exp_f32 v18, v170
    v_mfma_f32_16x16x32_bf16 a[4:7], v[64:67], v[32:35], 0
    ds_read_b128 v[24:27], v1 offset:2304
    v_cvt_f32_i32 v241, v241
    v_mfma_f32_16x16x32_bf16 a[4:7], v[80:83], v[36:39], a[4:7]
    buffer_load_dwordx4 v4, s[4:7], s32 offen offset:2048 sc1 lds
    v_mfma_f32_16x16x32_bf16 a[52:55], v[68:71], v[32:35], 0
    v_cvt_f32_i32 v244, v244
    v_add_f32 v7, v7, v16
    v_mfma_f32_16x16x32_bf16 a[52:55], v[84:87], v[36:39], a[52:55]
    s_add_u32 s32, s32, 24576
    ds_read_b128 v[56:59], v23 offset:0
    v_add_f32 v7, v7, v17
    v_mfma_f32_16x16x32_bf16 a[100:103], v[72:75], v[32:35], 0
    ds_read_b128 v[28:31], v1 offset:14592
    v_add_u32 v10, 1792, v10
    v_mfma_f32_16x16x32_bf16 a[100:103], v[88:91], v[36:39], a[100:103]
    v_exp_f32 v19, v171
    v_cvt_pk_bf16_f32 v168, v16, v17
    v_mfma_f32_16x16x32_bf16 a[148:151], v[76:79], v[32:35], 0
    s_sub_u32 s57, s32, 196608
    v_cvt_f32_i32 v245, v245
    v_fma_f32 v240, v240, v60, v62
    v_mfma_f32_16x16x32_bf16 a[148:151], v[92:95], v[36:39], a[148:151]
    s_waitcnt lgkmcnt(3)
    v_exp_f32 v16, v104
    v_mfma_f32_16x16x32_bf16 a[8:11], v[64:67], v[40:43], 0
    s_min_u32 s32, s32, s57
    ds_read_b128 v[32:35], v21 offset:0
    v_fma_f32 v241, v241, v61, v63
    v_mfma_f32_16x16x32_bf16 a[8:11], v[80:83], v[44:47], a[8:11]
    s_add_u32 s26, s26, 12288
    v_add_f32 v7, v7, v18
    v_add_f32 v7, v7, v19
    v_mfma_f32_16x16x32_bf16 a[56:59], v[68:71], v[40:43], 0
    v_fma_f32 v244, v244, v60, v62
    v_fma_f32 v245, v245, v61, v63
    v_mfma_f32_16x16x32_bf16 a[56:59], v[84:87], v[44:47], a[56:59]
    v_exp_f32 v17, v105
    v_cvt_pk_bf16_f32 v169, v18, v19
    v_mfma_f32_16x16x32_bf16 a[104:107], v[72:75], v[40:43], 0
    s_mov_b32 m0, s26
    ds_read_b128 v[36:39], v21 offset:12288
    v_cvt_pk_bf16_f32 v226, v240, v241
    v_mfma_f32_16x16x32_bf16 a[104:107], v[88:91], v[44:47], a[104:107]
    buffer_load_dwordx4 v4, s[4:7], s32 offen offset:0 sc1 lds
    v_mfma_f32_16x16x32_bf16 a[152:155], v[76:79], v[40:43], 0
    v_exp_f32 v18, v106
    v_mfma_f32_16x16x32_bf16 a[152:155], v[92:95], v[44:47], a[152:155]
    s_waitcnt lgkmcnt(2)
    v_cvt_pk_bf16_f32 v230, v244, v245
    v_cvt_f32_i32 v242, v242
    v_add_f32 v7, v7, v16
    v_mfma_f32_16x16x32_bf16 a[12:15], v[64:67], v[24:27], 0
    ds_read_b128 v[40:43], v21 offset:768
    v_cvt_f32_i32 v243, v243
    v_mfma_f32_16x16x32_bf16 a[12:15], v[80:83], v[28:31], a[12:15]
    buffer_load_dwordx4 v4, s[4:7], s32 offen offset:1024 sc1 lds
    v_add_f32 v7, v7, v17
    v_mfma_f32_16x16x32_bf16 a[60:63], v[68:71], v[24:27], 0
    v_exp_f32 v19, v107
    v_mfma_f32_16x16x32_bf16 a[60:63], v[84:87], v[28:31], a[60:63]
    v_cvt_f32_i32 v246, v246
    v_cvt_f32_i32 v247, v247
    v_cvt_pk_bf16_f32 v170, v16, v17
    v_mfma_f32_16x16x32_bf16 a[108:111], v[72:75], v[24:27], 0
    ds_read_b128 v[44:47], v21 offset:13056
    v_fma_f32 v242, v242, v48, v50
    v_mfma_f32_16x16x32_bf16 a[108:111], v[88:91], v[28:31], a[108:111]
    buffer_load_dwordx4 v4, s[4:7], s32 offen offset:2048 sc1 lds
    v_mfma_f32_16x16x32_bf16 a[156:159], v[76:79], v[24:27], 0
    s_add_u32 s29, s28, 49152
    v_exp_f32 v16, v172
    v_mfma_f32_16x16x32_bf16 a[156:159], v[92:95], v[28:31], a[156:159]
    s_waitcnt lgkmcnt(2)
    v_fma_f32 v243, v243, v49, v51
    v_add_f32 v7, v7, v18
    v_fma_f32 v246, v246, v48, v50
    v_mfma_f32_16x16x32_bf16 a[16:19], v[64:67], v[32:35], 0
    ds_read_b128 v[24:27], v21 offset:1536
    v_add_f32 v7, v7, v19
    v_mfma_f32_16x16x32_bf16 a[16:19], v[80:83], v[36:39], a[16:19]
    v_fma_f32 v247, v247, v49, v51
    v_exp_f32 v17, v173
    v_mfma_f32_16x16x32_bf16 a[64:67], v[68:71], v[32:35], 0
    s_mov_b32 s32, 196608
    v_cvt_pk_bf16_f32 v227, v242, v243
    v_cvt_pk_bf16_f32 v171, v18, v19
    v_mfma_f32_16x16x32_bf16 a[64:67], v[84:87], v[36:39], a[64:67]
    v_cvt_pk_bf16_f32 v231, v246, v247
    v_exp_f32 v18, v174
    v_mfma_f32_16x16x32_bf16 a[112:115], v[72:75], v[32:35], 0
    ds_read_b128 v[28:31], v21 offset:13824
    s_waitcnt vmcnt(22)
    v_mfma_f32_16x16x32_bf16 a[112:115], v[88:91], v[36:39], a[112:115]
    buffer_load_dwordx4 v[240:243], v12, s[68:71], s36 offen offset:0 nt
    v_cvt_f32_i32 v248, v248
    v_mfma_f32_16x16x32_bf16 a[160:163], v[76:79], v[32:35], 0
    s_add_u32 s26, s26, 36864
    v_add_f32 v8, v8, v16
    v_cvt_f32_i32 v249, v249
    v_mfma_f32_16x16x32_bf16 a[160:163], v[92:95], v[36:39], a[160:163]
    s_waitcnt lgkmcnt(2)
    v_add_f32 v8, v8, v17
    v_cvt_f32_i32 v252, v252
    v_mfma_f32_16x16x32_bf16 a[20:23], v[64:67], v[40:43], 0
    s_sub_u32 s57, s26, 147456
    ds_read_b128 v[32:35], v21 offset:2304
    v_cvt_f32_i32 v253, v253
    v_mfma_f32_16x16x32_bf16 a[20:23], v[80:83], v[44:47], a[20:23]
    v_exp_f32 v19, v175
    v_cvt_pk_bf16_f32 v172, v16, v17
    v_mfma_f32_16x16x32_bf16 a[68:71], v[68:71], v[40:43], 0
    s_min_u32 s26, s26, s57
    v_fma_f32 v248, v248, v60, v62
    v_fma_f32 v249, v249, v61, v63
    v_mfma_f32_16x16x32_bf16 a[68:71], v[84:87], v[44:47], a[68:71]
    s_sub_u32 s3, s29, 147456
    buffer_load_dwordx4 v[244:247], v12, s[68:71], s36 offen offset:768 nt
    v_mfma_f32_16x16x32_bf16 a[116:119], v[72:75], v[40:43], 0
    s_min_u32 s29, s29, s3
    ds_read_b128 v[36:39], v21 offset:14592
    v_fma_f32 v252, v252, v60, v62
    v_mfma_f32_16x16x32_bf16 a[116:119], v[88:91], v[44:47], a[116:119]
    v_exp_f32 v16, v108
    v_add_f32 v8, v8, v18
    v_mfma_f32_16x16x32_bf16 a[164:167], v[76:79], v[40:43], 0
    s_sub_u32 s3, s29, s28
    v_fma_f32 v253, v253, v61, v63
    v_cvt_pk_bf16_f32 v234, v248, v249
    v_mfma_f32_16x16x32_bf16 a[164:167], v[92:95], v[44:47], a[164:167]
    s_waitcnt lgkmcnt(2)
    v_add_f32 v8, v8, v19
    v_cvt_pk_bf16_f32 v238, v252, v253
    v_mfma_f32_16x16x32_bf16 a[24:27], v[64:67], v[24:27], 0
    ds_read_b128 v[40:43], v22 offset:0
    v_cvt_f32_i32 v250, v250
    v_mfma_f32_16x16x32_bf16 a[24:27], v[80:83], v[28:31], a[24:27]
    v_exp_f32 v17, v109
    v_cvt_pk_bf16_f32 v173, v18, v19
    v_mfma_f32_16x16x32_bf16 a[72:75], v[68:71], v[24:27], 0
    v_cvt_f32_i32 v251, v251
    v_cvt_f32_i32 v254, v254
    v_mfma_f32_16x16x32_bf16 a[72:75], v[84:87], v[28:31], a[72:75]
    v_cvt_f32_i32 v255, v255
    v_exp_f32 v18, v110
    v_mfma_f32_16x16x32_bf16 a[120:123], v[72:75], v[24:27], 0
    ds_read_b128 v[44:47], v22 offset:12288
    v_fma_f32 v250, v250, v48, v50
    v_mfma_f32_16x16x32_bf16 a[120:123], v[88:91], v[28:31], a[120:123]
    v_fma_f32 v251, v251, v49, v51
    v_add_f32 v8, v8, v16
    v_add_f32 v8, v8, v17
    v_mfma_f32_16x16x32_bf16 a[168:171], v[76:79], v[24:27], 0
    v_fma_f32 v254, v254, v48, v50
    v_fma_f32 v255, v255, v49, v51
    v_cvt_pk_bf16_f32 v235, v250, v251
    v_cvt_pk_bf16_f32 v239, v254, v255
    v_mfma_f32_16x16x32_bf16 a[168:171], v[92:95], v[28:31], a[168:171]
    s_waitcnt lgkmcnt(2)
    v_exp_f32 v19, v111
    v_cvt_pk_bf16_f32 v174, v16, v17
    v_mfma_f32_16x16x32_bf16 a[28:31], v[64:67], v[32:35], 0
    s_mov_b32 s28, s29
    ds_read_b128 v[24:27], v22 offset:768
    v_add_f32 v8, v8, v18
    v_mfma_f32_16x16x32_bf16 a[28:31], v[80:83], v[36:39], a[28:31]
    buffer_store_dwordx4 v[224:227], v11, s[4:7], s37 offen offset:0 sc1
    v_mfma_f32_16x16x32_bf16 a[76:79], v[68:71], v[32:35], 0
    v_add_f32 v8, v8, v19
    v_cvt_pk_bf16_f32 v175, v18, v19
    v_mfma_f32_16x16x32_bf16 a[76:79], v[84:87], v[36:39], a[76:79]
    v_exp_f32 v16, v176
    v_mfma_f32_16x16x32_bf16 a[124:127], v[72:75], v[32:35], 0
    ds_read_b128 v[28:31], v22 offset:13056
    v_add_u32 v2, s3, v2
    v_mfma_f32_16x16x32_bf16 a[124:127], v[88:91], v[36:39], a[124:127]
    v_exp_f32 v17, v177
    v_mfma_f32_16x16x32_bf16 a[172:175], v[76:79], v[32:35], 0
    v_exp_f32 v18, v178
    v_mfma_f32_16x16x32_bf16 a[172:175], v[92:95], v[36:39], a[172:175]
    s_waitcnt lgkmcnt(2)
    v_add_f32 v5, v5, v16
    v_add_f32 v5, v5, v17
    v_mfma_f32_16x16x32_bf16 a[32:35], v[64:67], v[40:43], 0
    ds_read_b128 v[32:35], v22 offset:1536
    v_mfma_f32_16x16x32_bf16 a[32:35], v[80:83], v[44:47], a[32:35]
    buffer_store_dwordx4 v[228:231], v54, s[4:7], s37 offen offset:768 sc1
    v_mfma_f32_16x16x32_bf16 a[80:83], v[68:71], v[40:43], 0
    v_exp_f32 v19, v179
    v_mfma_f32_16x16x32_bf16 a[80:83], v[84:87], v[44:47], a[80:83]
    v_cvt_pk_bf16_f32 v176, v16, v17
    v_exp_f32 v16, v112
    v_mfma_f32_16x16x32_bf16 a[128:131], v[72:75], v[40:43], 0
    ds_read_b128 v[36:39], v22 offset:13824
    v_add_f32 v5, v5, v18
    v_mfma_f32_16x16x32_bf16 a[128:131], v[88:91], v[44:47], a[128:131]
    v_add_f32 v5, v5, v19
    v_exp_f32 v17, v113
    v_mfma_f32_16x16x32_bf16 a[176:179], v[76:79], v[40:43], 0
    v_cvt_pk_bf16_f32 v177, v18, v19
    v_add_u32 v3, s3, v3
    v_mfma_f32_16x16x32_bf16 a[176:179], v[92:95], v[44:47], a[176:179]
    s_waitcnt lgkmcnt(2)
    v_exp_f32 v18, v114
    v_add_f32 v5, v5, v16
    v_mfma_f32_16x16x32_bf16 a[36:39], v[64:67], v[24:27], 0
    ds_read_b128 v[40:43], v22 offset:2304
    v_add_f32 v5, v5, v17
    v_mfma_f32_16x16x32_bf16 a[36:39], v[80:83], v[28:31], a[36:39]
    buffer_store_dwordx4 v[232:235], v11, s[4:7], s80 offen offset:0 sc1
    v_mfma_f32_16x16x32_bf16 a[84:87], v[68:71], v[24:27], 0
    v_exp_f32 v19, v115
    v_mfma_f32_16x16x32_bf16 a[84:87], v[84:87], v[28:31], a[84:87]
    v_cvt_pk_bf16_f32 v178, v16, v17
    v_exp_f32 v16, v180
    v_mfma_f32_16x16x32_bf16 a[132:135], v[72:75], v[24:27], 0
    ds_read_b128 v[44:47], v22 offset:14592
    v_add_f32 v5, v5, v18
    v_mfma_f32_16x16x32_bf16 a[132:135], v[88:91], v[28:31], a[132:135]
    s_waitcnt lgkmcnt(2)
    v_add_f32 v5, v5, v19
    v_mfma_f32_16x16x32_bf16 a[180:183], v[76:79], v[24:27], 0
    s_waitcnt vmcnt(11)
    v_exp_f32 v17, v181
    v_mfma_f32_16x16x32_bf16 a[180:183], v[92:95], v[28:31], a[180:183]
    s_barrier
    v_cvt_pk_bf16_f32 v179, v18, v19
    v_mfma_f32_16x16x32_bf16 a[40:43], v[64:67], v[32:35], 0
    ds_read_b128 v[24:27], v2 offset:0
    v_mfma_f32_16x16x32_bf16 a[40:43], v[80:83], v[36:39], a[40:43]
    v_exp_f32 v18, v182
    v_mfma_f32_16x16x32_bf16 a[88:91], v[68:71], v[32:35], 0
    v_add_f32 v6, v6, v16
    v_add_f32 v6, v6, v17
    v_mfma_f32_16x16x32_bf16 a[88:91], v[84:87], v[36:39], a[88:91]
    v_exp_f32 v19, v183
    v_mfma_f32_16x16x32_bf16 a[136:139], v[72:75], v[32:35], 0
    ds_read_b128 v[28:31], v3 offset:0
    v_cvt_pk_bf16_f32 v180, v16, v17
    v_mfma_f32_16x16x32_bf16 a[136:139], v[88:91], v[36:39], a[136:139]
    buffer_store_dwordx4 v[236:239], v54, s[4:7], s80 offen offset:768 sc1
    v_mfma_f32_16x16x32_bf16 a[184:187], v[76:79], v[32:35], 0
    v_exp_f32 v16, v116
    v_mfma_f32_16x16x32_bf16 a[184:187], v[92:95], v[36:39], a[184:187]
    s_waitcnt lgkmcnt(2)
    v_add_f32 v6, v6, v18
    v_add_f32 v6, v6, v19
    v_mfma_f32_16x16x32_bf16 a[44:47], v[64:67], v[40:43], 0
    ds_read_b128 v[32:35], v2 offset:6144
    v_mfma_f32_16x16x32_bf16 a[44:47], v[80:83], v[44:47], a[44:47]
    v_exp_f32 v17, v117
    v_mfma_f32_16x16x32_bf16 a[92:95], v[68:71], v[40:43], 0
    v_cvt_pk_bf16_f32 v181, v18, v19
    v_mfma_f32_16x16x32_bf16 a[92:95], v[84:87], v[44:47], a[92:95]
    v_exp_f32 v18, v118
    v_mfma_f32_16x16x32_bf16 a[140:143], v[72:75], v[40:43], 0
    ds_read_b128 v[36:39], v3 offset:6144
    v_add_f32 v6, v6, v16
    v_mfma_f32_16x16x32_bf16 a[140:143], v[88:91], v[44:47], a[140:143]
    v_add_f32 v6, v6, v17
    v_mfma_f32_16x16x32_bf16 a[188:191], v[76:79], v[40:43], 0
    v_exp_f32 v19, v119
    v_mfma_f32_16x16x32_bf16 a[188:191], v[92:95], v[44:47], a[188:191]
    s_waitcnt lgkmcnt(2)
    v_cvt_pk_bf16_f32 v182, v16, v17
    v_add_f32 v6, v6, v18
    v_add_f32 v6, v6, v19
    v_cvt_pk_bf16_f32 v183, v18, v19
    v_mfma_f32_16x16x32_bf16 v[64:67], v[24:27], a[192:195], v[128:131]
    ds_read_b128 v[40:43], v2 offset:128
    v_mfma_f32_16x16x32_bf16 v[64:67], v[28:31], a[196:199], v[64:67]
    buffer_load_dwordx4 v[248:251], v12, s[68:71], s36 offen offset:1536 nt
    v_mfma_f32_16x16x32_bf16 v[68:71], v[24:27], a[216:219], v[132:135]
    v_exp_f32 v16, v184
    v_mfma_f32_16x16x32_bf16 v[68:71], v[28:31], a[220:223], v[68:71]
    v_exp_f32 v17, v185
    v_mfma_f32_16x16x32_bf16 v[72:75], v[24:27], a[240:243], v[136:139]
    ds_read_b128 v[44:47], v3 offset:128
    v_mfma_f32_16x16x32_bf16 v[72:75], v[28:31], a[244:247], v[72:75]
    v_exp_f32 v18, v186
    v_mfma_f32_16x16x32_bf16 v[76:79], v[24:27], v[200:203], v[140:143]
    ds_read_b128 v[60:63], v23 offset:16
    v_add_f32 v7, v7, v16
    v_mfma_f32_16x16x32_bf16 v[76:79], v[28:31], v[204:207], v[76:79]
    s_waitcnt lgkmcnt(3)
    buffer_load_dwordx4 v[252:255], v12, s[68:71], s36 offen offset:2304 nt
    v_mfma_f32_16x16x32_bf16 v[96:99], v[32:35], a[192:195], v[128:131]
    s_waitcnt vmcnt(22)
    ds_read_b128 v[24:27], v2 offset:6272
    v_add_f32 v7, v7, v17
    v_mfma_f32_16x16x32_bf16 v[96:99], v[36:39], a[196:199], v[96:99]
    v_exp_f32 v19, v187
    v_mfma_f32_16x16x32_bf16 v[100:103], v[32:35], a[216:219], v[132:135]
    v_cvt_pk_bf16_f32 v184, v16, v17
    v_cvt_f32_i32 v144, v144
    v_mfma_f32_16x16x32_bf16 v[100:103], v[36:39], a[220:223], v[100:103]
    v_exp_f32 v16, v120
    v_mfma_f32_16x16x32_bf16 v[104:107], v[32:35], a[240:243], v[136:139]
    ds_read_b128 v[28:31], v3 offset:6272
    v_cvt_f32_i32 v148, v148
    v_mfma_f32_16x16x32_bf16 v[104:107], v[36:39], a[244:247], v[104:107]
    v_add_f32 v7, v7, v18
    v_add_f32 v7, v7, v19
    v_mfma_f32_16x16x32_bf16 v[108:111], v[32:35], v[200:203], v[140:143]
    v_exp_f32 v17, v121
    v_mfma_f32_16x16x32_bf16 v[108:111], v[36:39], v[204:207], v[108:111]
    s_waitcnt lgkmcnt(3)
    v_cvt_f32_i32 v145, v145
    s_add_u32 s33, s33, 196608
    v_mfma_f32_16x16x32_bf16 v[64:67], v[40:43], a[200:203], v[64:67]
    s_sub_u32 s34, s33, 1572864
    ds_read_b128 v[32:35], v2 offset:256
    v_cvt_pk_bf16_f32 v185, v18, v19
    v_mfma_f32_16x16x32_bf16 v[64:67], v[44:47], a[204:207], v[64:67]
    s_min_u32 s33, s33, s34
    v_exp_f32 v18, v122
    v_mfma_f32_16x16x32_bf16 v[68:71], v[40:43], a[224:227], v[68:71]
    s_add_u32 s34, s33, 3072
    ds_read_b128 v[48:51], v23 offset:32
    v_add_f32 v7, v7, v16
    v_mfma_f32_16x16x32_bf16 v[68:71], v[44:47], a[228:231], v[68:71]
    v_cvt_f32_i32 v149, v149
    v_add_f32 v7, v7, v17
    v_mfma_f32_16x16x32_bf16 v[72:75], v[40:43], a[248:251], v[72:75]
    s_add_u32 s37, s37, 196608
    ds_read_b128 v[36:39], v3 offset:256
    v_fma_f32 v144, v144, v56, v58
    v_mfma_f32_16x16x32_bf16 v[72:75], v[44:47], a[252:255], v[72:75]
    v_exp_f32 v19, v123
    v_mfma_f32_16x16x32_bf16 v[76:79], v[40:43], v[208:211], v[76:79]
    s_add_u32 s80, s80, 196608
    v_cvt_pk_bf16_f32 v186, v16, v17
    v_fma_f32 v148, v148, v57, v59
    v_mfma_f32_16x16x32_bf16 v[76:79], v[44:47], v[212:215], v[76:79]
    s_waitcnt lgkmcnt(3)
    v_exp_f32 v16, v188
    v_mfma_f32_16x16x32_bf16 v[96:99], v[24:27], a[200:203], v[96:99]
    ds_read_b128 v[40:43], v2 offset:6400
    v_add_f32 v7, v7, v18
    v_mfma_f32_16x16x32_bf16 v[96:99], v[28:31], a[204:207], v[96:99]
    buffer_load_dwordx4 v[224:227], v9, s[64:67], s33 offen offset:0 nt
    v_mfma_f32_16x16x32_bf16 v[100:103], v[24:27], a[224:227], v[100:103]
    v_add_f32 v7, v7, v19
    v_fma_f32 v145, v145, v56, v58
    v_mfma_f32_16x16x32_bf16 v[100:103], v[28:31], a[228:231], v[100:103]
    v_exp_f32 v17, v189
    v_mfma_f32_16x16x32_bf16 v[104:107], v[24:27], a[248:251], v[104:107]
    ds_read_b128 v[44:47], v3 offset:6400
    v_cvt_pk_bf16_f32 v187, v18, v19
    v_mfma_f32_16x16x32_bf16 v[104:107], v[28:31], a[252:255], v[104:107]
    buffer_load_dwordx4 v[228:231], v9, s[64:67], s33 offen offset:1536 nt
    v_mfma_f32_16x16x32_bf16 v[108:111], v[24:27], v[208:211], v[108:111]
    s_add_u32 s29, s30, 49152
    v_exp_f32 v18, v190
    v_mfma_f32_16x16x32_bf16 v[108:111], v[28:31], v[212:215], v[108:111]
    s_waitcnt lgkmcnt(2)
    v_fma_f32 v149, v149, v57, v59
    v_add_f32 v8, v8, v16
    v_mfma_f32_16x16x32_bf16 v[64:67], v[32:35], a[208:211], v[64:67]
    s_sub_u32 s3, s29, 147456
    ds_read_b128 v[24:27], v2 offset:12288
    v_add_f32 v8, v8, v17
    v_mfma_f32_16x16x32_bf16 v[64:67], v[36:39], a[212:215], v[64:67]
    buffer_load_dwordx4 v[232:235], v9, s[64:67], s34 offen offset:0 nt
    v_mfma_f32_16x16x32_bf16 v[68:71], v[32:35], a[232:235], v[68:71]
    v_exp_f32 v19, v191
    v_mfma_f32_16x16x32_bf16 v[68:71], v[36:39], a[236:239], v[68:71]
    v_cvt_pk_bf16_f32 v188, v16, v17
    v_cvt_f32_i32 v146, v146
    v_mfma_f32_16x16x32_bf16 v[72:75], v[32:35], v[192:195], v[72:75]
    ds_read_b128 v[28:31], v3 offset:12288
    v_cvt_f32_i32 v150, v150
    v_mfma_f32_16x16x32_bf16 v[72:75], v[36:39], v[196:199], v[72:75]
    buffer_load_dwordx4 v[236:239], v9, s[64:67], s34 offen offset:1536 nt
    v_mfma_f32_16x16x32_bf16 v[76:79], v[32:35], v[216:219], v[76:79]
    s_min_u32 s29, s29, s3
    v_exp_f32 v16, v124
    v_mfma_f32_16x16x32_bf16 v[76:79], v[36:39], v[220:223], v[76:79]
    s_waitcnt lgkmcnt(2)
    v_add_f32 v8, v8, v18
    v_add_f32 v8, v8, v19
    v_mfma_f32_16x16x32_bf16 v[96:99], v[40:43], a[208:211], v[96:99]
    s_mov_b32 m0, s56
    ds_read_b128 v[32:35], v2 offset:18432
    v_cvt_f32_i32 v147, v147
    v_mfma_f32_16x16x32_bf16 v[96:99], v[44:47], a[212:215], v[96:99]
    buffer_load_dwordx4 v4, s[4:7], s27 offen offset:0 sc1 lds
    v_mfma_f32_16x16x32_bf16 v[100:103], v[40:43], a[232:235], v[100:103]
    v_exp_f32 v17, v125
    v_mfma_f32_16x16x32_bf16 v[100:103], v[44:47], a[236:239], v[100:103]
    v_cvt_pk_bf16_f32 v189, v18, v19
    v_cvt_f32_i32 v151, v151
    v_mfma_f32_16x16x32_bf16 v[104:107], v[40:43], v[192:195], v[104:107]
    s_sub_u32 s3, s29, s30
    ds_read_b128 v[36:39], v3 offset:18432
    v_fma_f32 v146, v146, v56, v58
    v_mfma_f32_16x16x32_bf16 v[104:107], v[44:47], v[196:199], v[104:107]
    buffer_load_dwordx4 v4, s[4:7], s27 offen offset:1024 sc1 lds
    v_mfma_f32_16x16x32_bf16 v[108:111], v[40:43], v[216:219], v[108:111]
    v_exp_f32 v18, v126
    v_mfma_f32_16x16x32_bf16 v[108:111], v[44:47], v[220:223], v[108:111]
    s_waitcnt lgkmcnt(2)
    v_add_f32 v8, v8, v16
    v_add_f32 v8, v8, v17
    v_mfma_f32_16x16x32_bf16 v[80:83], v[24:27], a[192:195], v[128:131]
    ds_read_b128 v[40:43], v2 offset:12416
    v_fma_f32 v150, v150, v57, v59
    v_mfma_f32_16x16x32_bf16 v[80:83], v[28:31], a[196:199], v[80:83]
    buffer_load_dwordx4 v4, s[4:7], s27 offen offset:2048 sc1 lds
    v_mfma_f32_16x16x32_bf16 v[84:87], v[24:27], a[216:219], v[132:135]
    v_exp_f32 v19, v127
    v_cvt_pk_bf16_f32 v190, v16, v17
    v_add_f32 v8, v8, v18
    v_add_f32 v8, v8, v19
    v_cvt_pk_bf16_f32 v191, v18, v19
    v_mfma_f32_16x16x32_bf16 v[84:87], v[28:31], a[220:223], v[84:87]
    s_mov_b32 s30, s29
    v_fma_f32 v147, v147, v56, v58
    v_fma_f32 v151, v151, v57, v59
    v_mfma_f32_16x16x32_bf16 v[88:91], v[24:27], a[240:243], v[136:139]
    s_add_u32 s27, s27, 24576
    ds_read_b128 v[44:47], v3 offset:12416
    v_mfma_f32_16x16x32_bf16 v[88:91], v[28:31], a[244:247], v[88:91]
    v_exp_f32 v16, v64
    v_mfma_f32_16x16x32_bf16 v[92:95], v[24:27], v[200:203], v[140:143]
    s_sub_u32 s58, s27, 196608
    ds_read_b128 v[56:59], v23 offset:48
    s_waitcnt vmcnt(27)
    v_mfma_f32_16x16x32_bf16 v[92:95], v[28:31], v[204:207], v[92:95]
    s_waitcnt lgkmcnt(3)
    v_exp_f32 v17, v65
    v_mfma_f32_16x16x32_bf16 v[112:115], v[32:35], a[192:195], v[128:131]
    s_min_u32 s27, s27, s58
    ds_read_b128 v[24:27], v2 offset:18560
    v_cvt_f32_i32 v152, v152
    v_mfma_f32_16x16x32_bf16 v[112:115], v[36:39], a[196:199], v[112:115]
    v_exp_f32 v18, v66
    v_mfma_f32_16x16x32_bf16 v[116:119], v[32:35], a[216:219], v[132:135]
    s_add_u32 s56, s56, 12288
    v_add_f32 v5, v5, v16
    v_add_f32 v5, v5, v17
    v_mfma_f32_16x16x32_bf16 v[116:119], v[36:39], a[220:223], v[116:119]
    v_exp_f32 v19, v67
    v_mfma_f32_16x16x32_bf16 v[120:123], v[32:35], a[240:243], v[136:139]
    s_mov_b32 m0, s56
    ds_read_b128 v[28:31], v3 offset:18560
    v_cvt_f32_i32 v156, v156
    v_mfma_f32_16x16x32_bf16 v[120:123], v[36:39], a[244:247], v[120:123]
    v_cvt_pk_bf16_f32 v64, v16, v17
    v_cvt_f32_i32 v153, v153
    v_mfma_f32_16x16x32_bf16 v[124:127], v[32:35], v[200:203], v[140:143]
    v_exp_f32 v16, v96
    v_mfma_f32_16x16x32_bf16 v[124:127], v[36:39], v[204:207], v[124:127]
    s_waitcnt lgkmcnt(3)
    buffer_load_dwordx4 v4, s[4:7], s27 offen offset:0 sc1 lds
    v_mfma_f32_16x16x32_bf16 v[80:83], v[40:43], a[200:203], v[80:83]
    ds_read_b128 v[32:35], v2 offset:12544
    v_add_f32 v5, v5, v18
    v_mfma_f32_16x16x32_bf16 v[80:83], v[44:47], a[204:207], v[80:83]
    v_add_f32 v5, v5, v19
    v_add_u32 v1, s3, v1
    v_mfma_f32_16x16x32_bf16 v[84:87], v[40:43], a[224:227], v[84:87]
    v_exp_f32 v17, v97
    v_mfma_f32_16x16x32_bf16 v[84:87], v[44:47], a[228:231], v[84:87]
    buffer_load_dwordx4 v4, s[4:7], s27 offen offset:1024 sc1 lds
    v_mfma_f32_16x16x32_bf16 v[88:91], v[40:43], a[248:251], v[88:91]
    ds_read_b128 v[36:39], v3 offset:12544
    v_cvt_pk_bf16_f32 v65, v18, v19
    v_mfma_f32_16x16x32_bf16 v[88:91], v[44:47], a[252:255], v[88:91]
    v_exp_f32 v18, v98
    v_mfma_f32_16x16x32_bf16 v[92:95], v[40:43], v[208:211], v[92:95]
    v_add_f32 v5, v5, v16
    v_add_u32 v23, 1792, v23
    v_mfma_f32_16x16x32_bf16 v[92:95], v[44:47], v[212:215], v[92:95]
    s_waitcnt lgkmcnt(2)
    buffer_load_dwordx4 v4, s[4:7], s27 offen offset:2048 sc1 lds
    v_mfma_f32_16x16x32_bf16 v[112:115], v[24:27], a[200:203], v[112:115]
    ds_read_b128 v[40:43], v2 offset:18688
    v_add_f32 v5, v5, v17
    v_mfma_f32_16x16x32_bf16 v[112:115], v[28:31], a[204:207], v[112:115]
    v_exp_f32 v19, v99
    v_mfma_f32_16x16x32_bf16 v[116:119], v[24:27], a[224:227], v[116:119]
    v_cvt_pk_bf16_f32 v66, v16, v17
    v_add_u32 v21, s3, v21
    v_mfma_f32_16x16x32_bf16 v[116:119], v[28:31], a[228:231], v[116:119]
    s_add_u32 s27, s27, 24576
    v_exp_f32 v16, v68
    v_mfma_f32_16x16x32_bf16 v[120:123], v[24:27], a[248:251], v[120:123]
    s_sub_u32 s58, s27, 196608
    ds_read_b128 v[44:47], v3 offset:18688
    v_add_u32 v22, s3, v22
    v_mfma_f32_16x16x32_bf16 v[120:123], v[28:31], a[252:255], v[120:123]
    s_waitcnt lgkmcnt(2)
    v_add_f32 v5, v5, v18
    v_add_f32 v5, v5, v19
    v_mfma_f32_16x16x32_bf16 v[124:127], v[24:27], v[208:211], v[124:127]
    s_waitcnt vmcnt(12)
    v_cvt_f32_i32 v157, v157
    v_fma_f32 v152, v152, v60, v62
    v_mfma_f32_16x16x32_bf16 v[124:127], v[28:31], v[212:215], v[124:127]
    s_barrier
    v_exp_f32 v17, v69
    v_mfma_f32_16x16x32_bf16 v[80:83], v[32:35], a[208:211], v[80:83]
    s_min_u32 s27, s27, s58
    ds_read_b128 v[24:27], v1 offset:0
    v_cvt_pk_bf16_f32 v67, v18, v19
    v_mfma_f32_16x16x32_bf16 v[80:83], v[36:39], a[212:215], v[80:83]
    s_add_u32 s56, s56, 36864
    v_exp_f32 v18, v70
    v_mfma_f32_16x16x32_bf16 v[84:87], v[32:35], a[232:235], v[84:87]
    s_sub_u32 s58, s56, 147456
    v_add_f32 v6, v6, v16
    v_fma_f32 v156, v156, v61, v63
    v_mfma_f32_16x16x32_bf16 v[84:87], v[36:39], a[236:239], v[84:87]
    s_min_u32 s56, s56, s58
    v_add_f32 v6, v6, v17
    v_fma_f32 v153, v153, v60, v62
    v_mfma_f32_16x16x32_bf16 v[88:91], v[32:35], v[192:195], v[88:91]
    ds_read_b128 v[28:31], v1 offset:12288
    v_fma_f32 v157, v157, v61, v63
    v_mfma_f32_16x16x32_bf16 v[88:91], v[36:39], v[196:199], v[88:91]
    v_exp_f32 v19, v71
    v_mfma_f32_16x16x32_bf16 v[92:95], v[32:35], v[216:219], v[92:95]
    v_cvt_pk_bf16_f32 v68, v16, v17
    v_cvt_f32_i32 v154, v154
    v_mfma_f32_16x16x32_bf16 v[92:95], v[36:39], v[220:223], v[92:95]
    s_waitcnt lgkmcnt(2)
    v_exp_f32 v16, v100
    v_mfma_f32_16x16x32_bf16 v[112:115], v[40:43], a[208:211], v[112:115]
    ds_read_b128 v[32:35], v1 offset:768
    v_add_f32 v6, v6, v18
    v_mfma_f32_16x16x32_bf16 v[112:115], v[44:47], a[212:215], v[112:115]
    v_add_f32 v6, v6, v19
    v_cvt_f32_i32 v158, v158
    v_mfma_f32_16x16x32_bf16 v[116:119], v[40:43], a[232:235], v[116:119]
    v_exp_f32 v17, v101
    v_mfma_f32_16x16x32_bf16 v[116:119], v[44:47], a[236:239], v[116:119]
    v_cvt_pk_bf16_f32 v69, v18, v19
    v_cvt_f32_i32 v155, v155
    v_mfma_f32_16x16x32_bf16 v[120:123], v[40:43], v[192:195], v[120:123]
    ds_read_b128 v[36:39], v1 offset:13056
    v_add_u32 v55, 1, v55
    v_mfma_f32_16x16x32_bf16 v[120:123], v[44:47], v[196:199], v[120:123]
    buffer_store_dword v55, v13, s[20:23], 0 offen sc1
    v_mfma_f32_16x16x32_bf16 v[124:127], v[40:43], v[216:219], v[124:127]
    v_exp_f32 v18, v102
    v_mfma_f32_16x16x32_bf16 v[124:127], v[44:47], v[220:223], v[124:127]
    s_waitcnt lgkmcnt(2)
    v_add_f32 v6, v6, v16
    v_add_f32 v6, v6, v17
    v_exp_f32 v19, v103
    v_cvt_pk_bf16_f32 v70, v16, v17
    v_cvt_f32_i32 v159, v159
    v_add_f32 v6, v6, v18
    v_fma_f32 v154, v154, v60, v62
    v_add_f32 v6, v6, v19
    v_fma_f32 v158, v158, v61, v63
    v_cvt_pk_bf16_f32 v71, v18, v19
    v_fma_f32 v155, v155, v60, v62
    v_mfma_f32_16x16x32_bf16 a[0:3], v[160:163], v[24:27], a[0:3]
    s_mov_b32 m0, s56
    ds_read_b128 v[40:43], v1 offset:1536
    v_fma_f32 v159, v159, v61, v63
    v_mfma_f32_16x16x32_bf16 a[0:3], v[176:179], v[28:31], a[0:3]
    v_exp_f32 v16, v72
    v_mfma_f32_16x16x32_bf16 a[48:51], v[164:167], v[24:27], a[48:51]
    v_exp_f32 v17, v73
    v_mfma_f32_16x16x32_bf16 a[48:51], v[180:183], v[28:31], a[48:51]
    buffer_load_dwordx4 v4, s[4:7], s27 offen offset:0 sc1 lds
    v_mfma_f32_16x16x32_bf16 a[96:99], v[168:171], v[24:27], a[96:99]
    ds_read_b128 v[44:47], v1 offset:13824
    v_cvt_pk_bf16_f32 v144, v144, v148
    v_mfma_f32_16x16x32_bf16 a[96:99], v[184:187], v[28:31], a[96:99]
    v_exp_f32 v18, v74
    v_mfma_f32_16x16x32_bf16 a[144:147], v[172:175], v[24:27], a[144:147]
    v_add_f32 v7, v7, v16
    v_add_f32 v7, v7, v17
    v_mfma_f32_16x16x32_bf16 a[144:147], v[188:191], v[28:31], a[144:147]
    s_waitcnt lgkmcnt(2)
    v_exp_f32 v19, v75
    v_mfma_f32_16x16x32_bf16 a[4:7], v[160:163], v[32:35], a[4:7]
    ds_read_b128 v[24:27], v1 offset:2304
    v_cvt_pk_bf16_f32 v148, v145, v149
    v_mfma_f32_16x16x32_bf16 a[4:7], v[176:179], v[36:39], a[4:7]
    v_cvt_pk_bf16_f32 v72, v16, v17
    v_cvt_pk_bf16_f32 v145, v152, v156
    v_mfma_f32_16x16x32_bf16 a[52:55], v[164:167], v[32:35], a[52:55]
    v_exp_f32 v16, v104
    v_mfma_f32_16x16x32_bf16 a[52:55], v[180:183], v[36:39], a[52:55]
    buffer_load_dwordx4 v4, s[4:7], s27 offen offset:1024 sc1 lds
    v_mfma_f32_16x16x32_bf16 a[100:103], v[168:171], v[32:35], a[100:103]
    ds_read_b128 v[28:31], v1 offset:14592
    v_add_f32 v7, v7, v18
    v_mfma_f32_16x16x32_bf16 a[100:103], v[184:187], v[36:39], a[100:103]
    v_add_f32 v7, v7, v19
    v_cvt_pk_bf16_f32 v149, v153, v157
    v_mfma_f32_16x16x32_bf16 a[148:151], v[172:175], v[32:35], a[148:151]
    v_exp_f32 v17, v105
    v_mfma_f32_16x16x32_bf16 a[148:151], v[188:191], v[36:39], a[148:151]
    s_waitcnt lgkmcnt(2)
    v_cvt_pk_bf16_f32 v73, v18, v19
    v_cvt_pk_bf16_f32 v152, v146, v150
    v_mfma_f32_16x16x32_bf16 a[8:11], v[160:163], v[40:43], a[8:11]
    ds_read_b128 v[32:35], v21 offset:0
    v_cvt_pk_bf16_f32 v153, v154, v158
    v_mfma_f32_16x16x32_bf16 a[8:11], v[176:179], v[44:47], a[8:11]
    v_exp_f32 v18, v106
    v_mfma_f32_16x16x32_bf16 a[56:59], v[164:167], v[40:43], a[56:59]
    v_add_f32 v7, v7, v16
    v_add_f32 v7, v7, v17
    v_mfma_f32_16x16x32_bf16 a[56:59], v[180:183], v[44:47], a[56:59]
    buffer_load_dwordx4 v4, s[4:7], s27 offen offset:2048 sc1 lds
    v_mfma_f32_16x16x32_bf16 a[104:107], v[168:171], v[40:43], a[104:107]
    ds_read_b128 v[36:39], v21 offset:12288
    v_cvt_pk_bf16_f32 v156, v147, v151
    v_mfma_f32_16x16x32_bf16 a[104:107], v[184:187], v[44:47], a[104:107]
    v_exp_f32 v19, v107
    v_mfma_f32_16x16x32_bf16 a[152:155], v[172:175], v[40:43], a[152:155]
    v_cvt_pk_bf16_f32 v74, v16, v17
    v_cvt_pk_bf16_f32 v157, v155, v159
    v_mfma_f32_16x16x32_bf16 a[152:155], v[188:191], v[44:47], a[152:155]
    s_waitcnt lgkmcnt(2)
    v_exp_f32 v16, v76
    v_mfma_f32_16x16x32_bf16 a[12:15], v[160:163], v[24:27], a[12:15]
    s_waitcnt vmcnt(20)
    ds_read_b128 v[40:43], v21 offset:768
    v_add_f32 v7, v7, v18
    v_mfma_f32_16x16x32_bf16 a[12:15], v[176:179], v[28:31], a[12:15]
    s_add_u32 s27, s27, 24576
    v_add_f32 v7, v7, v19
    v_mfma_f32_16x16x32_bf16 a[60:63], v[164:167], v[24:27], a[60:63]
    v_exp_f32 v17, v77
    v_mfma_f32_16x16x32_bf16 a[60:63], v[180:183], v[28:31], a[60:63]
    s_sub_u32 s58, s27, 196608
    v_cvt_pk_bf16_f32 v75, v18, v19
    v_cvt_f32_i32 v240, v240
    v_mfma_f32_16x16x32_bf16 a[108:111], v[168:171], v[24:27], a[108:111]
    ds_read_b128 v[44:47], v21 offset:13056
    v_cvt_f32_i32 v244, v244
    v_mfma_f32_16x16x32_bf16 a[108:111], v[184:187], v[28:31], a[108:111]
    v_exp_f32 v18, v78
    v_mfma_f32_16x16x32_bf16 a[156:159], v[172:175], v[24:27], a[156:159]
    s_add_u32 s29, s28, 49152
    v_add_f32 v8, v8, v16
    v_add_f32 v8, v8, v17
    v_mfma_f32_16x16x32_bf16 a[156:159], v[188:191], v[28:31], a[156:159]
    s_waitcnt lgkmcnt(2)
    v_exp_f32 v19, v79
    v_mfma_f32_16x16x32_bf16 a[16:19], v[160:163], v[32:35], a[16:19]
    s_min_u32 s27, s27, s58
    ds_read_b128 v[24:27], v21 offset:1536
    v_cvt_pk_bf16_f32 v76, v16, v17
    v_mfma_f32_16x16x32_bf16 a[16:19], v[176:179], v[36:39], a[16:19]
    s_sub_u32 s3, s29, 147456
    v_exp_f32 v16, v108
    v_mfma_f32_16x16x32_bf16 a[64:67], v[164:167], v[32:35], a[64:67]
    v_cvt_f32_i32 v241, v241
    v_add_f32 v8, v8, v18
    v_mfma_f32_16x16x32_bf16 a[64:67], v[180:183], v[36:39], a[64:67]
    s_add_u32 s56, s56, 12288
    v_cvt_f32_i32 v245, v245
    v_add_f32 v8, v8, v19
    v_mfma_f32_16x16x32_bf16 a[112:115], v[168:171], v[32:35], a[112:115]
    ds_read_b128 v[28:31], v21 offset:13824
    v_mfma_f32_16x16x32_bf16 a[112:115], v[184:187], v[36:39], a[112:115]
    v_exp_f32 v17, v109
    v_mfma_f32_16x16x32_bf16 a[160:163], v[172:175], v[32:35], a[160:163]
    v_cvt_pk_bf16_f32 v77, v18, v19
    v_fma_f32 v240, v240, v48, v50
    v_mfma_f32_16x16x32_bf16 a[160:163], v[188:191], v[36:39], a[160:163]
    s_waitcnt lgkmcnt(2)
    v_exp_f32 v18, v110
    v_mfma_f32_16x16x32_bf16 a[20:23], v[160:163], v[40:43], a[20:23]
    s_mov_b32 m0, s56
    ds_read_b128 v[32:35], v21 offset:2304
    v_fma_f32 v244, v244, v49, v51
    v_mfma_f32_16x16x32_bf16 a[20:23], v[176:179], v[44:47], a[20:23]
    s_min_u32 s29, s29, s3
    v_add_f32 v8, v8, v16
    v_add_f32 v8, v8, v17
    v_mfma_f32_16x16x32_bf16 a[68:71], v[164:167], v[40:43], a[68:71]
    v_exp_f32 v19, v111
    v_mfma_f32_16x16x32_bf16 a[68:71], v[180:183], v[44:47], a[68:71]
    v_fma_f32 v241, v241, v48, v50
    v_mfma_f32_16x16x32_bf16 a[116:119], v[168:171], v[40:43], a[116:119]
    ds_read_b128 v[36:39], v21 offset:14592
    v_cvt_pk_bf16_f32 v78, v16, v17
    v_mfma_f32_16x16x32_bf16 a[116:119], v[184:187], v[44:47], a[116:119]
    buffer_load_dwordx4 v4, s[4:7], s27 offen offset:0 sc1 lds
    v_mfma_f32_16x16x32_bf16 a[164:167], v[172:175], v[40:43], a[164:167]
    s_sub_u32 s3, s29, s28
    v_add_f32 v8, v8, v18
    v_add_f32 v8, v8, v19
    v_mfma_f32_16x16x32_bf16 a[164:167], v[188:191], v[44:47], a[164:167]
    s_waitcnt lgkmcnt(2)
    v_cvt_pk_bf16_f32 v79, v18, v19
    v_fma_f32 v245, v245, v49, v51
    v_mfma_f32_16x16x32_bf16 a[24:27], v[160:163], v[24:27], a[24:27]
    ds_read_b128 v[40:43], v22 offset:0
    v_cvt_f32_i32 v242, v242
    v_mfma_f32_16x16x32_bf16 a[24:27], v[176:179], v[28:31], a[24:27]
    v_exp_f32 v16, v80
    v_mfma_f32_16x16x32_bf16 a[72:75], v[164:167], v[24:27], a[72:75]
    v_exp_f32 v17, v81
    v_mfma_f32_16x16x32_bf16 a[72:75], v[180:183], v[28:31], a[72:75]
    v_exp_f32 v18, v82
    v_mfma_f32_16x16x32_bf16 a[120:123], v[168:171], v[24:27], a[120:123]
    ds_read_b128 v[44:47], v22 offset:12288
    v_cvt_f32_i32 v246, v246
    v_mfma_f32_16x16x32_bf16 a[120:123], v[184:187], v[28:31], a[120:123]
    s_mov_b32 s28, s29
    buffer_load_dwordx4 v4, s[4:7], s27 offen offset:1024 sc1 lds
    v_mfma_f32_16x16x32_bf16 a[168:171], v[172:175], v[24:27], a[168:171]
    v_add_f32 v5, v5, v16
    v_add_f32 v5, v5, v17
    v_mfma_f32_16x16x32_bf16 a[168:171], v[188:191], v[28:31], a[168:171]
    s_waitcnt lgkmcnt(2)
    v_exp_f32 v19, v83
    v_mfma_f32_16x16x32_bf16 a[28:31], v[160:163], v[32:35], a[28:31]
    ds_read_b128 v[24:27], v22 offset:768
    v_cvt_f32_i32 v243, v243
    v_mfma_f32_16x16x32_bf16 a[28:31], v[176:179], v[36:39], a[28:31]
    v_cvt_pk_bf16_f32 v80, v16, v17
    v_cvt_f32_i32 v247, v247
    v_mfma_f32_16x16x32_bf16 a[76:79], v[164:167], v[32:35], a[76:79]
    v_exp_f32 v16, v112
    v_mfma_f32_16x16x32_bf16 a[76:79], v[180:183], v[36:39], a[76:79]
    buffer_load_dwordx4 v4, s[4:7], s27 offen offset:2048 sc1 lds
    v_mfma_f32_16x16x32_bf16 a[124:127], v[168:171], v[32:35], a[124:127]
    ds_read_b128 v[28:31], v22 offset:13056
    v_add_f32 v5, v5, v18
    v_mfma_f32_16x16x32_bf16 a[124:127], v[184:187], v[36:39], a[124:127]
    v_add_f32 v5, v5, v19
    v_fma_f32 v242, v242, v48, v50
    v_mfma_f32_16x16x32_bf16 a[172:175], v[172:175], v[32:35], a[172:175]
    v_exp_f32 v17, v113
    v_mfma_f32_16x16x32_bf16 a[172:175], v[188:191], v[36:39], a[172:175]
    s_waitcnt lgkmcnt(2)
    v_cvt_pk_bf16_f32 v81, v18, v19
    v_fma_f32 v246, v246, v49, v51
    v_mfma_f32_16x16x32_bf16 a[32:35], v[160:163], v[40:43], a[32:35]
    ds_read_b128 v[32:35], v22 offset:1536
    v_add_u32 v2, s3, v2
    v_mfma_f32_16x16x32_bf16 a[32:35], v[176:179], v[44:47], a[32:35]
    v_exp_f32 v18, v114
    v_mfma_f32_16x16x32_bf16 a[80:83], v[164:167], v[40:43], a[80:83]
    v_add_f32 v5, v5, v16
    v_add_f32 v5, v5, v17
    v_mfma_f32_16x16x32_bf16 a[80:83], v[180:183], v[44:47], a[80:83]
    s_mov_b32 s27, 208896
    v_exp_f32 v19, v115
    v_mfma_f32_16x16x32_bf16 a[128:131], v[168:171], v[40:43], a[128:131]
    s_add_u32 s56, s56, 36864
    ds_read_b128 v[36:39], v22 offset:13824
    v_fma_f32 v243, v243, v48, v50
    v_mfma_f32_16x16x32_bf16 a[128:131], v[184:187], v[44:47], a[128:131]
    v_cvt_pk_bf16_f32 v82, v16, v17
    v_fma_f32 v247, v247, v49, v51
    v_mfma_f32_16x16x32_bf16 a[176:179], v[172:175], v[40:43], a[176:179]
    v_exp_f32 v16, v84
    v_mfma_f32_16x16x32_bf16 a[176:179], v[188:191], v[44:47], a[176:179]
    s_waitcnt lgkmcnt(2)
    v_add_f32 v5, v5, v18
    v_add_u32 v3, s3, v3
    v_mfma_f32_16x16x32_bf16 a[36:39], v[160:163], v[24:27], a[36:39]
    s_sub_u32 s58, s56, 147456
    ds_read_b128 v[40:43], v22 offset:2304
    v_add_f32 v5, v5, v19
    v_mfma_f32_16x16x32_bf16 a[36:39], v[176:179], v[28:31], a[36:39]
    v_exp_f32 v17, v85
    v_mfma_f32_16x16x32_bf16 a[84:87], v[164:167], v[24:27], a[84:87]
    s_min_u32 s56, s56, s58
    ds_read_b128 v[48:51], v10 offset:0
    v_bfe_u32 v53, v4, 4, 6
    v_mfma_f32_16x16x32_bf16 a[84:87], v[180:183], v[28:31], a[84:87]
    v_cvt_pk_bf16_f32 v83, v18, v19
    v_cvt_pk_bf16_f32 v146, v240, v244
    v_mfma_f32_16x16x32_bf16 a[132:135], v[168:171], v[24:27], a[132:135]
    ds_read_b128 v[44:47], v22 offset:14592
    v_lshlrev_b32 v53, 2, v53
    v_mfma_f32_16x16x32_bf16 a[132:135], v[184:187], v[28:31], a[132:135]
    s_waitcnt lgkmcnt(3)
    v_exp_f32 v18, v86
    v_mfma_f32_16x16x32_bf16 a[180:183], v[172:175], v[24:27], a[180:183]
    s_waitcnt vmcnt(25)
    v_add_f32 v6, v6, v16
    v_add_f32 v6, v6, v17
    v_mfma_f32_16x16x32_bf16 a[180:183], v[188:191], v[28:31], a[180:183]
    s_barrier
    v_cvt_pk_bf16_f32 v150, v241, v245
    v_mfma_f32_16x16x32_bf16 a[40:43], v[160:163], v[32:35], a[40:43]
    ds_read_b128 v[24:27], v2 offset:0
    v_cvt_pk_bf16_f32 v154, v242, v246
    v_mfma_f32_16x16x32_bf16 a[40:43], v[176:179], v[36:39], a[40:43]
    buffer_load_dword v52, v53, s[20:23], 0 offen sc1
    v_mfma_f32_16x16x32_bf16 a[88:91], v[164:167], v[32:35], a[88:91]
    v_exp_f32 v19, v87
    v_mfma_f32_16x16x32_bf16 a[88:91], v[180:183], v[36:39], a[88:91]
    v_cvt_pk_bf16_f32 v84, v16, v17
    v_cvt_pk_bf16_f32 v158, v243, v247
    v_mfma_f32_16x16x32_bf16 a[136:139], v[168:171], v[32:35], a[136:139]
    s_waitcnt vmcnt(18)
    ds_read_b128 v[28:31], v3 offset:0
    v_mfma_f32_16x16x32_bf16 a[136:139], v[184:187], v[36:39], a[136:139]
    v_exp_f32 v16, v116
    v_mfma_f32_16x16x32_bf16 a[184:187], v[172:175], v[32:35], a[184:187]
    v_add_f32 v6, v6, v18
    v_add_f32 v6, v6, v19
    v_mfma_f32_16x16x32_bf16 a[184:187], v[188:191], v[36:39], a[184:187]
    s_waitcnt lgkmcnt(2)
    v_exp_f32 v17, v117
    v_mfma_f32_16x16x32_bf16 a[44:47], v[160:163], v[40:43], a[44:47]
    ds_read_b128 v[32:35], v2 offset:6144
    v_cvt_pk_bf16_f32 v85, v18, v19
    v_mfma_f32_16x16x32_bf16 a[44:47], v[176:179], v[44:47], a[44:47]
    v_exp_f32 v18, v118
    v_mfma_f32_16x16x32_bf16 a[92:95], v[164:167], v[40:43], a[92:95]
    v_add_f32 v6, v6, v16
    v_cvt_f32_i32 v248, v248
    v_mfma_f32_16x16x32_bf16 a[92:95], v[180:183], v[44:47], a[92:95]
    v_add_f32 v6, v6, v17
    v_cvt_f32_i32 v252, v252
    v_mfma_f32_16x16x32_bf16 a[140:143], v[168:171], v[40:43], a[140:143]
    ds_read_b128 v[36:39], v3 offset:6144
    v_cvt_f32_i32 v249, v249
    v_mfma_f32_16x16x32_bf16 a[140:143], v[184:187], v[44:47], a[140:143]
    v_exp_f32 v19, v119
    v_mfma_f32_16x16x32_bf16 a[188:191], v[172:175], v[40:43], a[188:191]
    v_cvt_pk_bf16_f32 v86, v16, v17
    v_add_f32 v6, v6, v18
    v_mfma_f32_16x16x32_bf16 a[188:191], v[188:191], v[44:47], a[188:191]
    s_waitcnt lgkmcnt(2)
    v_add_f32 v6, v6, v19
    v_cvt_pk_bf16_f32 v87, v18, v19
    v_mfma_f32_16x16x32_bf16 v[160:163], v[24:27], a[192:195], v[128:131]
    ds_read_b128 v[40:43], v2 offset:128
    v_cvt_f32_i32 v253, v253
    v_mfma_f32_16x16x32_bf16 v[160:163], v[28:31], a[196:199], v[160:163]
    s_waitcnt vmcnt(0)
    v_subrev_u32 v52, s92, v52
    v_cmp_lt_u32 vcc, 15, v52
    v_mfma_f32_16x16x32_bf16 v[164:167], v[24:27], a[216:219], v[132:135]
    v_exp_f32 v16, v88
    v_mfma_f32_16x16x32_bf16 v[164:167], v[28:31], a[220:223], v[164:167]
    v_exp_f32 v17, v89
    v_mfma_f32_16x16x32_bf16 v[168:171], v[24:27], a[240:243], v[136:139]
    s_and_b32 s59, vcc_lo, 0xff
    ds_read_b128 v[44:47], v3 offset:128
    v_fma_f32 v248, v248, v56, v58
    v_mfma_f32_16x16x32_bf16 v[168:171], v[28:31], a[244:247], v[168:171]
    s_cbranch_scc1 L_pollslow0
L_pollok0:
    v_mfma_f32_16x16x32_bf16 v[172:175], v[24:27], v[200:203], v[140:143]
    s_add_u32 s92, s92, 1
    v_exp_f32 v18, v90
    v_mfma_f32_16x16x32_bf16 v[172:175], v[28:31], v[204:207], v[172:175]
    s_waitcnt lgkmcnt(2)
    v_add_f32 v7, v7, v16
    v_add_f32 v7, v7, v17
    v_mfma_f32_16x16x32_bf16 v[96:99], v[32:35], a[192:195], v[128:131]
    s_mov_b32 m0, s26
    ds_read_b128 v[24:27], v2 offset:6272
    v_fma_f32 v252, v252, v57, v59
    v_mfma_f32_16x16x32_bf16 v[96:99], v[36:39], a[196:199], v[96:99]
    buffer_load_dwordx4 v4, s[4:7], s32 offen offset:0 sc1 lds
    v_mfma_f32_16x16x32_bf16 v[100:103], v[32:35], a[216:219], v[132:135]
    v_exp_f32 v19, v91
    v_mfma_f32_16x16x32_bf16 v[100:103], v[36:39], a[220:223], v[100:103]
    v_cvt_pk_bf16_f32 v88, v16, v17
    v_fma_f32 v249, v249, v56, v58
    v_mfma_f32_16x16x32_bf16 v[104:107], v[32:35], a[240:243], v[136:139]
    ds_read_b128 v[28:31], v3 offset:6272
    v_fma_f32 v253, v253, v57, v59
    v_mfma_f32_16x16x32_bf16 v[104:107], v[36:39], a[244:247], v[104:107]
    buffer_load_dwordx4 v4, s[4:7], s32 offen offset:1024 sc1 lds
    v_mfma_f32_16x16x32_bf16 v[108:111], v[32:35], v[200:203], v[140:143]
    v_exp_f32 v16, v120
    v_mfma_f32_16x16x32_bf16 v[108:111], v[36:39], v[204:207], v[108:111]
    s_waitcnt lgkmcnt(2)
    v_add_f32 v7, v7, v18
    v_add_f32 v7, v7, v19
    v_mfma_f32_16x16x32_bf16 v[160:163], v[40:43], a[200:203], v[160:163]
    ds_read_b128 v[32:35], v2 offset:256
    v_cvt_f32_i32 v250, v250
    v_mfma_f32_16x16x32_bf16 v[160:163], v[44:47], a[204:207], v[160:163]
    buffer_load_dwordx4 v4, s[4:7], s32 offen offset:2048 sc1 lds
    v_mfma_f32_16x16x32_bf16 v[164:167], v[40:43], a[224:227], v[164:167]
    s_add_u32 s32, s32, 24576
    v_exp_f32 v17, v121
    v_mfma_f32_16x16x32_bf16 v[164:167], v[44:47], a[228:231], v[164:167]
    v_cvt_pk_bf16_f32 v89, v18, v19
    v_cvt_f32_i32 v254, v254
    v_mfma_f32_16x16x32_bf16 v[168:171], v[40:43], a[248:251], v[168:171]
    s_add_u32 s26, s26, 12288
    ds_read_b128 v[36:39], v3 offset:256
    v_mfma_f32_16x16x32_bf16 v[168:171], v[44:47], a[252:255], v[168:171]
    s_mov_b32 m0, s26
    v_exp_f32 v18, v122
    v_mfma_f32_16x16x32_bf16 v[172:175], v[40:43], v[208:211], v[172:175]
    v_add_f32 v7, v7, v16
    v_add_f32 v7, v7, v17
    v_mfma_f32_16x16x32_bf16 v[172:175], v[44:47], v[212:215], v[172:175]
    s_waitcnt lgkmcnt(2)
    v_exp_f32 v19, v123
    v_mfma_f32_16x16x32_bf16 v[96:99], v[24:27], a[200:203], v[96:99]
    ds_read_b128 v[40:43], v2 offset:6400
    v_cvt_pk_bf16_f32 v90, v16, v17
    v_mfma_f32_16x16x32_bf16 v[96:99], v[28:31], a[204:207], v[96:99]
    buffer_load_dwordx4 v4, s[4:7], s32 offen offset:0 sc1 lds
    v_mfma_f32_16x16x32_bf16 v[100:103], v[24:27], a[224:227], v[100:103]
    v_exp_f32 v16, v92
    v_mfma_f32_16x16x32_bf16 v[100:103], v[28:31], a[228:231], v[100:103]
    v_add_f32 v7, v7, v18
    v_add_f32 v7, v7, v19
    v_mfma_f32_16x16x32_bf16 v[104:107], v[24:27], a[248:251], v[104:107]
    ds_read_b128 v[44:47], v3 offset:6400
    v_cvt_f32_i32 v251, v251
    v_mfma_f32_16x16x32_bf16 v[104:107], v[28:31], a[252:255], v[104:107]
    buffer_load_dwordx4 v4, s[4:7], s32 offen offset:1024 sc1 lds
    v_mfma_f32_16x16x32_bf16 v[108:111], v[24:27], v[208:211], v[108:111]
    s_add_u32 s29, s30, 49152
    v_exp_f32 v17, v93
    v_mfma_f32_16x16x32_bf16 v[108:111], v[28:31], v[212:215], v[108:111]
    s_waitcnt lgkmcnt(2)
    v_cvt_pk_bf16_f32 v91, v18, v19
    v_cvt_f32_i32 v255, v255
    v_mfma_f32_16x16x32_bf16 v[160:163], v[32:35], a[208:211], v[160:163]
    s_sub_u32 s3, s29, 147456
    ds_read_b128 v[24:27], v2 offset:12288
    v_fma_f32 v250, v250, v56, v58
    v_mfma_f32_16x16x32_bf16 v[160:163], v[36:39], a[212:215], v[160:163]
    buffer_load_dwordx4 v4, s[4:7], s32 offen offset:2048 sc1 lds
    v_mfma_f32_16x16x32_bf16 v[164:167], v[32:35], a[232:235], v[164:167]
    v_exp_f32 v18, v94
    v_mfma_f32_16x16x32_bf16 v[164:167], v[36:39], a[236:239], v[164:167]
    s_add_u32 s32, s32, 24576
    v_add_f32 v8, v8, v16
    v_add_f32 v8, v8, v17
    v_mfma_f32_16x16x32_bf16 v[168:171], v[32:35], v[192:195], v[168:171]
    ds_read_b128 v[28:31], v3 offset:12288
    v_fma_f32 v254, v254, v57, v59
    v_mfma_f32_16x16x32_bf16 v[168:171], v[36:39], v[196:199], v[168:171]
    s_add_u32 s26, s26, 36864
    buffer_load_dwordx4 v[240:243], v9, s[64:67], s33 offen offset:384 nt
    v_mfma_f32_16x16x32_bf16 v[172:175], v[32:35], v[216:219], v[172:175]
    s_min_u32 s29, s29, s3
    v_exp_f32 v19, v95
    v_mfma_f32_16x16x32_bf16 v[172:175], v[36:39], v[220:223], v[172:175]
    s_waitcnt lgkmcnt(2)
    v_cvt_pk_bf16_f32 v92, v16, v17
    v_fma_f32 v251, v251, v56, v58
    v_mfma_f32_16x16x32_bf16 v[96:99], v[40:43], a[208:211], v[96:99]
    s_sub_u32 s57, s26, 147456
    ds_read_b128 v[32:35], v2 offset:18432
    v_fma_f32 v255, v255, v57, v59
    v_mfma_f32_16x16x32_bf16 v[96:99], v[44:47], a[212:215], v[96:99]
    v_exp_f32 v16, v124
    v_mfma_f32_16x16x32_bf16 v[100:103], v[40:43], a[232:235], v[100:103]
    s_min_u32 s26, s26, s57
    v_add_f32 v8, v8, v18
    v_add_f32 v8, v8, v19
    v_mfma_f32_16x16x32_bf16 v[100:103], v[44:47], a[236:239], v[100:103]
    buffer_load_dwordx4 v[244:247], v9, s[64:67], s33 offen offset:1920 nt
    v_mfma_f32_16x16x32_bf16 v[104:107], v[40:43], v[192:195], v[104:107]
    s_sub_u32 s3, s29, s30
    ds_read_b128 v[36:39], v3 offset:18432
    v_cvt_pk_bf16_f32 v147, v248, v252
    v_mfma_f32_16x16x32_bf16 v[104:107], v[44:47], v[196:199], v[104:107]
    v_exp_f32 v17, v125
    v_mfma_f32_16x16x32_bf16 v[108:111], v[40:43], v[216:219], v[108:111]
    v_cvt_pk_bf16_f32 v93, v18, v19
    v_cvt_pk_bf16_f32 v151, v249, v253
    v_mfma_f32_16x16x32_bf16 v[108:111], v[44:47], v[220:223], v[108:111]
    s_waitcnt lgkmcnt(2)
    v_exp_f32 v18, v126
    v_mfma_f32_16x16x32_bf16 v[176:179], v[24:27], a[192:195], v[128:131]
    ds_read_b128 v[40:43], v2 offset:12416
    v_add_f32 v8, v8, v16
    v_mfma_f32_16x16x32_bf16 v[176:179], v[28:31], a[196:199], v[176:179]
    v_add_f32 v8, v8, v17
    v_cvt_pk_bf16_f32 v155, v250, v254
    v_mfma_f32_16x16x32_bf16 v[180:183], v[24:27], a[216:219], v[132:135]
    v_exp_f32 v19, v127
    v_cvt_pk_bf16_f32 v94, v16, v17
    v_add_f32 v8, v8, v18
    v_add_f32 v8, v8, v19
    v_cvt_pk_bf16_f32 v95, v18, v19
    v_mfma_f32_16x16x32_bf16 v[180:183], v[28:31], a[220:223], v[180:183]
    s_mov_b32 s30, s29
    v_cvt_pk_bf16_f32 v159, v251, v255
    v_mfma_f32_16x16x32_bf16 v[184:187], v[24:27], a[240:243], v[136:139]
    ds_read_b128 v[44:47], v3 offset:12416
    v_mfma_f32_16x16x32_bf16 v[184:187], v[28:31], a[244:247], v[184:187]
    v_exp_f32 v16, v160
    v_mfma_f32_16x16x32_bf16 v[188:191], v[24:27], v[200:203], v[140:143]
    v_exp_f32 v17, v161
    v_mfma_f32_16x16x32_bf16 v[188:191], v[28:31], v[204:207], v[188:191]
    s_waitcnt lgkmcnt(2)
    v_exp_f32 v18, v162
    v_mfma_f32_16x16x32_bf16 v[112:115], v[32:35], a[192:195], v[128:131]
    ds_read_b128 v[24:27], v2 offset:18560
    v_add_f32 v5, v5, v16
    v_mfma_f32_16x16x32_bf16 v[112:115], v[36:39], a[196:199], v[112:115]
    buffer_store_dwordx4 v[144:147], v20, s[4:7], s81 offen offset:0 sc1
    v_mfma_f32_16x16x32_bf16 v[116:119], v[32:35], a[216:219], v[132:135]
    v_add_f32 v5, v5, v17
    v_add_u32 v1, s3, v1
    v_mfma_f32_16x16x32_bf16 v[116:119], v[36:39], a[220:223], v[116:119]
    v_exp_f32 v19, v163
    v_mfma_f32_16x16x32_bf16 v[120:123], v[32:35], a[240:243], v[136:139]
    ds_read_b128 v[28:31], v3 offset:18560
    v_cvt_pk_bf16_f32 v160, v16, v17
    v_mfma_f32_16x16x32_bf16 v[120:123], v[36:39], a[244:247], v[120:123]
    v_exp_f32 v16, v96
    v_mfma_f32_16x16x32_bf16 v[124:127], v[32:35], v[200:203], v[140:143]
    v_add_f32 v5, v5, v18
    v_add_f32 v5, v5, v19
    v_mfma_f32_16x16x32_bf16 v[124:127], v[36:39], v[204:207], v[124:127]
    s_waitcnt lgkmcnt(2)
    ds_read_b128 v[56:59], v10 offset:384
    v_add_u32 v21, s3, v21
    v_mfma_f32_16x16x32_bf16 v[176:179], v[40:43], a[200:203], v[176:179]
    s_waitcnt vmcnt(25)
    ds_read_b128 v[32:35], v2 offset:12544
    v_mfma_f32_16x16x32_bf16 v[176:179], v[44:47], a[204:207], v[176:179]
    buffer_store_dwordx4 v[148:151], v20, s[4:7], s81 offen offset:768 sc1
    v_mfma_f32_16x16x32_bf16 v[180:183], v[40:43], a[224:227], v[180:183]
    v_exp_f32 v17, v97
    v_mfma_f32_16x16x32_bf16 v[180:183], v[44:47], a[228:231], v[180:183]
    v_cvt_pk_bf16_f32 v161, v18, v19
    v_cvt_f32_i32 v224, v224
    v_mfma_f32_16x16x32_bf16 v[184:187], v[40:43], a[248:251], v[184:187]
    ds_read_b128 v[36:39], v3 offset:12544
    v_add_u32 v22, s3, v22
    v_mfma_f32_16x16x32_bf16 v[184:187], v[44:47], a[252:255], v[184:187]
    v_exp_f32 v18, v98
    v_mfma_f32_16x16x32_bf16 v[188:191], v[40:43], v[208:211], v[188:191]
    v_add_f32 v5, v5, v16
    v_add_f32 v5, v5, v17
    v_mfma_f32_16x16x32_bf16 v[188:191], v[44:47], v[212:215], v[188:191]
    s_waitcnt lgkmcnt(3)
    v_exp_f32 v19, v99
    v_mfma_f32_16x16x32_bf16 v[112:115], v[24:27], a[200:203], v[112:115]
    ds_read_b128 v[40:43], v2 offset:18688
    v_cvt_pk_bf16_f32 v162, v16, v17
    v_mfma_f32_16x16x32_bf16 v[112:115], v[28:31], a[204:207], v[112:115]
    buffer_store_dwordx4 v[152:155], v20, s[4:7], s81 offen offset:1536 sc1
    v_mfma_f32_16x16x32_bf16 v[116:119], v[24:27], a[224:227], v[116:119]
    v_exp_f32 v16, v164
    v_mfma_f32_16x16x32_bf16 v[116:119], v[28:31], a[228:231], v[116:119]
    v_add_f32 v5, v5, v18
    v_add_f32 v5, v5, v19
    v_mfma_f32_16x16x32_bf16 v[120:123], v[24:27], a[248:251], v[120:123]
    ds_read_b128 v[44:47], v3 offset:18688
    v_cvt_f32_i32 v225, v225
    v_mfma_f32_16x16x32_bf16 v[120:123], v[28:31], a[252:255], v[120:123]
    s_waitcnt lgkmcnt(2)
    v_exp_f32 v17, v165
    v_mfma_f32_16x16x32_bf16 v[124:127], v[24:27], v[208:211], v[124:127]
    s_waitcnt vmcnt(19)
    v_cvt_pk_bf16_f32 v163, v18, v19
    v_cvt_f32_i32 v228, v228
    v_mfma_f32_16x16x32_bf16 v[124:127], v[28:31], v[212:215], v[124:127]
    s_barrier
    ds_read_b128 v[60:63], v10 offset:768
    v_mfma_f32_16x16x32_bf16 v[176:179], v[32:35], a[208:211], v[176:179]
    ds_read_b128 v[24:27], v1 offset:0
    v_cvt_f32_i32 v229, v229
    v_mfma_f32_16x16x32_bf16 v[176:179], v[36:39], a[212:215], v[176:179]
    v_exp_f32 v18, v166
    v_mfma_f32_16x16x32_bf16 v[180:183], v[32:35], a[232:235], v[180:183]
    v_add_f32 v6, v6, v16
    v_add_f32 v6, v6, v17
    v_mfma_f32_16x16x32_bf16 v[180:183], v[36:39], a[236:239], v[180:183]
    v_exp_f32 v19, v167
    v_mfma_f32_16x16x32_bf16 v[184:187], v[32:35], v[192:195], v[184:187]
    ds_read_b128 v[28:31], v1 offset:12288
    v_cvt_pk_bf16_f32 v164, v16, v17
    v_mfma_f32_16x16x32_bf16 v[184:187], v[36:39], v[196:199], v[184:187]
    buffer_store_dwordx4 v[156:159], v20, s[4:7], s81 offen offset:2304 sc1
    v_mfma_f32_16x16x32_bf16 v[188:191], v[32:35], v[216:219], v[188:191]
    v_exp_f32 v16, v100
    v_mfma_f32_16x16x32_bf16 v[188:191], v[36:39], v[220:223], v[188:191]
    s_waitcnt lgkmcnt(3)
    v_add_f32 v6, v6, v18
    v_add_f32 v6, v6, v19
    v_mfma_f32_16x16x32_bf16 v[112:115], v[40:43], a[208:211], v[112:115]
    ds_read_b128 v[32:35], v1 offset:768
    v_fma_f32 v224, v224, v48, v50
    v_mfma_f32_16x16x32_bf16 v[112:115], v[44:47], a[212:215], v[112:115]
    v_exp_f32 v17, v101
    v_mfma_f32_16x16x32_bf16 v[116:119], v[40:43], a[232:235], v[116:119]
    v_cvt_pk_bf16_f32 v165, v18, v19
    v_fma_f32 v225, v225, v49, v51
    v_mfma_f32_16x16x32_bf16 v[116:119], v[44:47], a[236:239], v[116:119]
    v_exp_f32 v18, v102
    v_mfma_f32_16x16x32_bf16 v[120:123], v[40:43], v[192:195], v[120:123]
    ds_read_b128 v[36:39], v1 offset:13056
    v_add_f32 v6, v6, v16
    v_mfma_f32_16x16x32_bf16 v[120:123], v[44:47], v[196:199], v[120:123]
    v_add_f32 v6, v6, v17
    v_fma_f32 v228, v228, v48, v50
    v_mfma_f32_16x16x32_bf16 v[124:127], v[40:43], v[216:219], v[124:127]
    v_exp_f32 v19, v103
    v_mfma_f32_16x16x32_bf16 v[124:127], v[44:47], v[220:223], v[124:127]
    s_waitcnt lgkmcnt(2)
    v_cvt_pk_bf16_f32 v166, v16, v17
    v_add_f32 v6, v6, v18
    v_fma_f32 v229, v229, v49, v51
    v_add_f32 v6, v6, v19
    v_cvt_pk_bf16_f32 v224, v224, v225
    v_cvt_pk_bf16_f32 v167, v18, v19
    v_cvt_pk_bf16_f32 v228, v228, v229
    v_mfma_f32_16x16x32_bf16 a[0:3], v[64:67], v[24:27], a[0:3]
    ds_read_b128 v[40:43], v1 offset:1536
    v_cvt_f32_i32 v226, v226
    v_mfma_f32_16x16x32_bf16 a[0:3], v[80:83], v[28:31], a[0:3]
    buffer_load_dwordx4 v[248:251], v9, s[64:67], s34 offen offset:384 nt
    v_mfma_f32_16x16x32_bf16 a[48:51], v[68:71], v[24:27], a[48:51]
    v_exp_f32 v16, v168
    v_mfma_f32_16x16x32_bf16 a[48:51], v[84:87], v[28:31], a[48:51]
    v_exp_f32 v17, v169
    v_mfma_f32_16x16x32_bf16 a[96:99], v[72:75], v[24:27], a[96:99]
    ds_read_b128 v[44:47], v1 offset:13824
    v_cvt_f32_i32 v227, v227
    v_mfma_f32_16x16x32_bf16 a[96:99], v[88:91], v[28:31], a[96:99]
    v_exp_f32 v18, v170
    v_mfma_f32_16x16x32_bf16 a[144:147], v[76:79], v[24:27], a[144:147]
    v_add_f32 v7, v7, v16
    v_add_f32 v7, v7, v17
    v_mfma_f32_16x16x32_bf16 a[144:147], v[92:95], v[28:31], a[144:147]
    s_waitcnt lgkmcnt(2)
    buffer_load_dwordx4 v[252:255], v9, s[64:67], s34 offen offset:1920 nt
    v_mfma_f32_16x16x32_bf16 a[4:7], v[64:67], v[32:35], a[4:7]
    ds_read_b128 v[24:27], v1 offset:2304
    v_cvt_f32_i32 v230, v230
    v_mfma_f32_16x16x32_bf16 a[4:7], v[80:83], v[36:39], a[4:7]
    v_exp_f32 v19, v171
    v_mfma_f32_16x16x32_bf16 a[52:55], v[68:71], v[32:35], a[52:55]
    v_cvt_pk_bf16_f32 v168, v16, v17
    v_cvt_f32_i32 v231, v231
    v_mfma_f32_16x16x32_bf16 a[52:55], v[84:87], v[36:39], a[52:55]
    v_exp_f32 v16, v104
    v_mfma_f32_16x16x32_bf16 a[100:103], v[72:75], v[32:35], a[100:103]
    ds_read_b128 v[28:31], v1 offset:14592
    v_add_f32 v7, v7, v18
    v_mfma_f32_16x16x32_bf16 a[100:103], v[88:91], v[36:39], a[100:103]
    v_add_f32 v7, v7, v19
    v_fma_f32 v226, v226, v56, v58
    v_mfma_f32_16x16x32_bf16 a[148:151], v[76:79], v[32:35], a[148:151]
    v_exp_f32 v17, v105
    v_mfma_f32_16x16x32_bf16 a[148:151], v[92:95], v[36:39], a[148:151]
    s_waitcnt lgkmcnt(2)
    s_add_u32 s35, s35, 196608
    v_cvt_pk_bf16_f32 v169, v18, v19
    v_mfma_f32_16x16x32_bf16 a[8:11], v[64:67], v[40:43], a[8:11]
    s_sub_u32 s36, s35, 1572864
    ds_read_b128 v[32:35], v21 offset:0
    v_fma_f32 v227, v227, v57, v59
    v_mfma_f32_16x16x32_bf16 a[8:11], v[80:83], v[44:47], a[8:11]
    s_min_u32 s35, s35, s36
    v_exp_f32 v18, v106
    v_mfma_f32_16x16x32_bf16 a[56:59], v[68:71], v[40:43], a[56:59]
    v_add_f32 v7, v7, v16
    v_add_f32 v7, v7, v17
    v_mfma_f32_16x16x32_bf16 a[56:59], v[84:87], v[44:47], a[56:59]
    s_add_u32 s36, s35, 3072
    v_exp_f32 v19, v107
    v_mfma_f32_16x16x32_bf16 a[104:107], v[72:75], v[40:43], a[104:107]
    ds_read_b128 v[36:39], v21 offset:12288
    v_cvt_pk_bf16_f32 v170, v16, v17
    v_mfma_f32_16x16x32_bf16 a[104:107], v[88:91], v[44:47], a[104:107]
    s_add_u32 s81, s81, 196608
    v_exp_f32 v16, v172
    v_mfma_f32_16x16x32_bf16 a[152:155], v[76:79], v[40:43], a[152:155]
    v_fma_f32 v230, v230, v56, v58
    v_fma_f32 v231, v231, v57, v59
    v_mfma_f32_16x16x32_bf16 a[152:155], v[92:95], v[44:47], a[152:155]
    s_waitcnt lgkmcnt(2)
    v_add_f32 v7, v7, v18
    v_add_f32 v7, v7, v19
    v_mfma_f32_16x16x32_bf16 a[12:15], v[64:67], v[24:27], a[12:15]
    ds_read_b128 v[40:43], v21 offset:768
    v_cvt_pk_bf16_f32 v225, v226, v227
    v_mfma_f32_16x16x32_bf16 a[12:15], v[80:83], v[28:31], a[12:15]
    buffer_load_dwordx4 v[144:147], v12, s[68:71], s35 offen offset:0 nt
    v_mfma_f32_16x16x32_bf16 a[60:63], v[68:71], v[24:27], a[60:63]
    v_exp_f32 v17, v173
    v_mfma_f32_16x16x32_bf16 a[60:63], v[84:87], v[28:31], a[60:63]
    v_cvt_pk_bf16_f32 v171, v18, v19
    v_mfma_f32_16x16x32_bf16 a[108:111], v[72:75], v[24:27], a[108:111]
    ds_read_b128 v[44:47], v21 offset:13056
    v_cvt_pk_bf16_f32 v229, v230, v231
    v_mfma_f32_16x16x32_bf16 a[108:111], v[88:91], v[28:31], a[108:111]
    buffer_load_dwordx4 v[148:151], v12, s[68:71], s35 offen offset:768 nt
    v_mfma_f32_16x16x32_bf16 a[156:159], v[76:79], v[24:27], a[156:159]
    s_add_u32 s29, s28, 49152
    v_exp_f32 v18, v174
    v_mfma_f32_16x16x32_bf16 a[156:159], v[92:95], v[28:31], a[156:159]
    s_waitcnt lgkmcnt(2)
    v_add_f32 v8, v8, v16
    v_add_f32 v8, v8, v17
    v_mfma_f32_16x16x32_bf16 a[16:19], v[64:67], v[32:35], a[16:19]
    s_waitcnt vmcnt(30)
    ds_read_b128 v[24:27], v21 offset:1536
    v_mfma_f32_16x16x32_bf16 a[16:19], v[80:83], v[36:39], a[16:19]
    s_sub_u32 s3, s29, 147456
    buffer_load_dwordx4 v[152:155], v12, s[68:71], s35 offen offset:1536 nt
    v_mfma_f32_16x16x32_bf16 a[64:67], v[68:71], v[32:35], a[64:67]
    v_exp_f32 v19, v175
    v_mfma_f32_16x16x32_bf16 a[64:67], v[84:87], v[36:39], a[64:67]
    v_cvt_pk_bf16_f32 v172, v16, v17
    v_cvt_f32_i32 v232, v232
    v_mfma_f32_16x16x32_bf16 a[112:115], v[72:75], v[32:35], a[112:115]
    ds_read_b128 v[28:31], v21 offset:13824
    v_mfma_f32_16x16x32_bf16 a[112:115], v[88:91], v[36:39], a[112:115]
    buffer_load_dwordx4 v[156:159], v12, s[68:71], s35 offen offset:2304 nt
    v_mfma_f32_16x16x32_bf16 a[160:163], v[76:79], v[32:35], a[160:163]
    v_exp_f32 v16, v108
    v_mfma_f32_16x16x32_bf16 a[160:163], v[92:95], v[36:39], a[160:163]
    s_waitcnt lgkmcnt(2)
    v_add_f32 v8, v8, v18
    v_add_f32 v8, v8, v19
    v_mfma_f32_16x16x32_bf16 a[20:23], v[64:67], v[40:43], a[20:23]
    s_mov_b32 m0, s26
    ds_read_b128 v[32:35], v21 offset:2304
    v_cvt_f32_i32 v233, v233
    v_mfma_f32_16x16x32_bf16 a[20:23], v[80:83], v[44:47], a[20:23]
    s_min_u32 s29, s29, s3
    v_exp_f32 v17, v109
    v_mfma_f32_16x16x32_bf16 a[68:71], v[68:71], v[40:43], a[68:71]
    v_cvt_pk_bf16_f32 v173, v18, v19
    v_cvt_f32_i32 v236, v236
    v_mfma_f32_16x16x32_bf16 a[68:71], v[84:87], v[44:47], a[68:71]
    buffer_load_dwordx4 v4, s[4:7], s32 offen offset:0 sc1 lds
    v_mfma_f32_16x16x32_bf16 a[116:119], v[72:75], v[40:43], a[116:119]
    ds_read_b128 v[36:39], v21 offset:14592
    v_cvt_f32_i32 v237, v237
    v_mfma_f32_16x16x32_bf16 a[116:119], v[88:91], v[44:47], a[116:119]
    v_exp_f32 v18, v110
    v_mfma_f32_16x16x32_bf16 a[164:167], v[76:79], v[40:43], a[164:167]
    s_sub_u32 s3, s29, s28
    v_add_f32 v8, v8, v16
    v_add_f32 v8, v8, v17
    v_mfma_f32_16x16x32_bf16 a[164:167], v[92:95], v[44:47], a[164:167]
    s_waitcnt lgkmcnt(2)
    buffer_load_dwordx4 v4, s[4:7], s32 offen offset:1024 sc1 lds
    v_mfma_f32_16x16x32_bf16 a[24:27], v[64:67], v[24:27], a[24:27]
    ds_read_b128 v[40:43], v22 offset:0
    v_fma_f32 v232, v232, v48, v50
    v_mfma_f32_16x16x32_bf16 a[24:27], v[80:83], v[28:31], a[24:27]
    v_exp_f32 v19, v111
    v_cvt_pk_bf16_f32 v174, v16, v17
    v_mfma_f32_16x16x32_bf16 a[72:75], v[68:71], v[24:27], a[72:75]
    v_add_f32 v8, v8, v18
    v_add_f32 v8, v8, v19
    v_mfma_f32_16x16x32_bf16 a[72:75], v[84:87], v[28:31], a[72:75]
    buffer_load_dwordx4 v4, s[4:7], s32 offen offset:2048 sc1 lds
    v_mfma_f32_16x16x32_bf16 a[120:123], v[72:75], v[24:27], a[120:123]
    ds_read_b128 v[44:47], v22 offset:12288
    v_cvt_pk_bf16_f32 v175, v18, v19
    v_mfma_f32_16x16x32_bf16 a[120:123], v[88:91], v[28:31], a[120:123]
    s_mov_b32 s28, s29
    v_exp_f32 v16, v176
    v_mfma_f32_16x16x32_bf16 a[168:171], v[76:79], v[24:27], a[168:171]
    s_add_u32 s32, s32, 24576
    v_exp_f32 v17, v177
    v_mfma_f32_16x16x32_bf16 a[168:171], v[92:95], v[28:31], a[168:171]
    s_waitcnt lgkmcnt(2)
    v_exp_f32 v18, v178
    v_mfma_f32_16x16x32_bf16 a[28:31], v[64:67], v[32:35], a[28:31]
    s_add_u32 s26, s26, 12288
    ds_read_b128 v[24:27], v22 offset:768
    v_add_f32 v5, v5, v16
    v_mfma_f32_16x16x32_bf16 a[28:31], v[80:83], v[36:39], a[28:31]
    v_add_f32 v5, v5, v17
    v_fma_f32 v233, v233, v49, v51
    v_mfma_f32_16x16x32_bf16 a[76:79], v[68:71], v[32:35], a[76:79]
    s_mov_b32 m0, s26
    v_exp_f32 v19, v179
    v_mfma_f32_16x16x32_bf16 a[76:79], v[84:87], v[36:39], a[76:79]
    v_cvt_pk_bf16_f32 v176, v16, v17
    v_fma_f32 v236, v236, v48, v50
    v_mfma_f32_16x16x32_bf16 a[124:127], v[72:75], v[32:35], a[124:127]
    ds_read_b128 v[28:31], v22 offset:13056
    v_fma_f32 v237, v237, v49, v51
    v_mfma_f32_16x16x32_bf16 a[124:127], v[88:91], v[36:39], a[124:127]
    buffer_load_dwordx4 v4, s[4:7], s32 offen offset:0 sc1 lds
    v_mfma_f32_16x16x32_bf16 a[172:175], v[76:79], v[32:35], a[172:175]
    v_exp_f32 v16, v112
    v_mfma_f32_16x16x32_bf16 a[172:175], v[92:95], v[36:39], a[172:175]
    s_waitcnt lgkmcnt(2)
    v_add_f32 v5, v5, v18
    v_add_f32 v5, v5, v19
    v_mfma_f32_16x16x32_bf16 a[32:35], v[64:67], v[40:43], a[32:35]
    ds_read_b128 v[32:35], v22 offset:1536
    v_cvt_pk_bf16_f32 v232, v232, v233
    v_mfma_f32_16x16x32_bf16 a[32:35], v[80:83], v[44:47], a[32:35]
    v_exp_f32 v17, v113
    v_mfma_f32_16x16x32_bf16 a[80:83], v[68:71], v[40:43], a[80:83]
    v_cvt_pk_bf16_f32 v177, v18, v19
    v_add_u32 v2, s3, v2
    v_mfma_f32_16x16x32_bf16 a[80:83], v[84:87], v[44:47], a[80:83]
    buffer_load_dwordx4 v4, s[4:7], s32 offen offset:1024 sc1 lds
    v_mfma_f32_16x16x32_bf16 a[128:131], v[72:75], v[40:43], a[128:131]
    ds_read_b128 v[36:39], v22 offset:13824
    v_cvt_pk_bf16_f32 v236, v236, v237
    v_mfma_f32_16x16x32_bf16 a[128:131], v[88:91], v[44:47], a[128:131]
    v_exp_f32 v18, v114
    v_mfma_f32_16x16x32_bf16 a[176:179], v[76:79], v[40:43], a[176:179]
    v_add_f32 v5, v5, v16
    v_add_f32 v5, v5, v17
    v_mfma_f32_16x16x32_bf16 a[176:179], v[92:95], v[44:47], a[176:179]
    s_waitcnt lgkmcnt(2)
    buffer_load_dwordx4 v4, s[4:7], s32 offen offset:2048 sc1 lds
    v_mfma_f32_16x16x32_bf16 a[36:39], v[64:67], v[24:27], a[36:39]
    ds_read_b128 v[40:43], v22 offset:2304
    v_cvt_f32_i32 v234, v234
    v_mfma_f32_16x16x32_bf16 a[36:39], v[80:83], v[28:31], a[36:39]
    v_exp_f32 v19, v115
    v_cvt_pk_bf16_f32 v178, v16, v17
    v_mfma_f32_16x16x32_bf16 a[84:87], v[68:71], v[24:27], a[84:87]
    v_exp_f32 v16, v180
    v_mfma_f32_16x16x32_bf16 a[84:87], v[84:87], v[28:31], a[84:87]
    s_add_u32 s32, s32, 24576
    v_add_f32 v5, v5, v18
    v_add_f32 v5, v5, v19
    v_mfma_f32_16x16x32_bf16 a[132:135], v[72:75], v[24:27], a[132:135]
    s_add_u32 s26, s26, 36864
    ds_read_b128 v[44:47], v22 offset:14592
    v_add_u32 v3, s3, v3
    v_mfma_f32_16x16x32_bf16 a[132:135], v[88:91], v[28:31], a[132:135]
    s_waitcnt lgkmcnt(2)
    v_exp_f32 v17, v181
    v_mfma_f32_16x16x32_bf16 a[180:183], v[76:79], v[24:27], a[180:183]
    s_waitcnt vmcnt(12)
    v_cvt_pk_bf16_f32 v179, v18, v19
    v_cvt_f32_i32 v235, v235
    v_mfma_f32_16x16x32_bf16 a[180:183], v[92:95], v[28:31], a[180:183]
    s_barrier
    v_cvt_f32_i32 v238, v238
    v_mfma_f32_16x16x32_bf16 a[40:43], v[64:67], v[32:35], a[40:43]
    s_sub_u32 s57, s26, 147456
    ds_read_b128 v[24:27], v2 offset:0
    v_cvt_f32_i32 v239, v239
    v_mfma_f32_16x16x32_bf16 a[40:43], v[80:83], v[36:39], a[40:43]
    v_exp_f32 v18, v182
    v_mfma_f32_16x16x32_bf16 a[88:91], v[68:71], v[32:35], a[88:91]
    s_min_u32 s26, s26, s57
    v_add_f32 v6, v6, v16
    v_add_f32 v6, v6, v17
    v_mfma_f32_16x16x32_bf16 a[88:91], v[84:87], v[36:39], a[88:91]
    v_exp_f32 v19, v183
    v_mfma_f32_16x16x32_bf16 a[136:139], v[72:75], v[32:35], a[136:139]
    ds_read_b128 v[28:31], v3 offset:0
    v_cvt_pk_bf16_f32 v180, v16, v17
    v_mfma_f32_16x16x32_bf16 a[136:139], v[88:91], v[36:39], a[136:139]
    v_exp_f32 v16, v116
    v_mfma_f32_16x16x32_bf16 a[184:187], v[76:79], v[32:35], a[184:187]
    v_add_f32 v6, v6, v18
    v_add_f32 v6, v6, v19
    v_mfma_f32_16x16x32_bf16 a[184:187], v[92:95], v[36:39], a[184:187]
    s_waitcnt lgkmcnt(2)
    v_exp_f32 v17, v117
    v_mfma_f32_16x16x32_bf16 a[44:47], v[64:67], v[40:43], a[44:47]
    ds_read_b128 v[32:35], v2 offset:6144
    v_cvt_pk_bf16_f32 v181, v18, v19
    v_mfma_f32_16x16x32_bf16 a[44:47], v[80:83], v[44:47], a[44:47]
    v_exp_f32 v18, v118
    v_mfma_f32_16x16x32_bf16 a[92:95], v[68:71], v[40:43], a[92:95]
    v_add_u32 v55, 1, v55
    v_fma_f32 v234, v234, v56, v58
    v_mfma_f32_16x16x32_bf16 a[92:95], v[84:87], v[44:47], a[92:95]
    buffer_store_dword v55, v13, s[20:23], 0 offen sc1
    v_mfma_f32_16x16x32_bf16 a[140:143], v[72:75], v[40:43], a[140:143]
    ds_read_b128 v[36:39], v3 offset:6144
    v_add_f32 v6, v6, v16
    v_mfma_f32_16x16x32_bf16 a[140:143], v[88:91], v[44:47], a[140:143]
    v_add_f32 v6, v6, v17
    v_fma_f32 v235, v235, v57, v59
    v_mfma_f32_16x16x32_bf16 a[188:191], v[76:79], v[40:43], a[188:191]
    v_exp_f32 v19, v119
    v_mfma_f32_16x16x32_bf16 a[188:191], v[92:95], v[44:47], a[188:191]
    s_waitcnt lgkmcnt(2)
    v_cvt_pk_bf16_f32 v182, v16, v17
    v_add_f32 v6, v6, v18
    v_add_f32 v6, v6, v19
    v_fma_f32 v238, v238, v56, v58
    v_cvt_pk_bf16_f32 v183, v18, v19
    v_fma_f32 v239, v239, v57, v59
    v_mfma_f32_16x16x32_bf16 v[64:67], v[24:27], a[192:195], v[128:131]
    s_mov_b32 m0, s26
    ds_read_b128 v[40:43], v2 offset:128
    v_cvt_pk_bf16_f32 v233, v234, v235
    v_mfma_f32_16x16x32_bf16 v[64:67], v[28:31], a[196:199], v[64:67]
    v_exp_f32 v16, v184
    v_mfma_f32_16x16x32_bf16 v[68:71], v[24:27], a[216:219], v[132:135]
    v_exp_f32 v17, v185
    v_mfma_f32_16x16x32_bf16 v[68:71], v[28:31], a[220:223], v[68:71]
    v_exp_f32 v18, v186
    v_mfma_f32_16x16x32_bf16 v[72:75], v[24:27], a[240:243], v[136:139]
    ds_read_b128 v[44:47], v3 offset:128
    v_cvt_pk_bf16_f32 v237, v238, v239
    v_mfma_f32_16x16x32_bf16 v[72:75], v[28:31], a[244:247], v[72:75]
    buffer_load_dwordx4 v4, s[4:7], s32 offen offset:0 sc1 lds
    v_mfma_f32_16x16x32_bf16 v[76:79], v[24:27], v[200:203], v[140:143]
    v_add_f32 v7, v7, v16
    v_add_f32 v7, v7, v17
    v_mfma_f32_16x16x32_bf16 v[76:79], v[28:31], v[204:207], v[76:79]
    s_waitcnt lgkmcnt(2)
    v_exp_f32 v19, v187
    v_mfma_f32_16x16x32_bf16 v[96:99], v[32:35], a[192:195], v[128:131]
    ds_read_b128 v[24:27], v2 offset:6272
    v_cvt_pk_bf16_f32 v184, v16, v17
    v_mfma_f32_16x16x32_bf16 v[96:99], v[36:39], a[196:199], v[96:99]
    ds_read_b128 v[48:51], v10 offset:1152
    s_waitcnt vmcnt(18)
    v_mfma_f32_16x16x32_bf16 v[100:103], v[32:35], a[216:219], v[132:135]
    v_exp_f32 v16, v120
    v_mfma_f32_16x16x32_bf16 v[100:103], v[36:39], a[220:223], v[100:103]
    v_add_f32 v7, v7, v18
    v_cvt_f32_i32 v240, v240
    v_mfma_f32_16x16x32_bf16 v[104:107], v[32:35], a[240:243], v[136:139]
    ds_read_b128 v[28:31], v3 offset:6272
    v_add_f32 v7, v7, v19
    v_mfma_f32_16x16x32_bf16 v[104:107], v[36:39], a[244:247], v[104:107]
    buffer_load_dwordx4 v4, s[4:7], s32 offen offset:1024 sc1 lds
    v_mfma_f32_16x16x32_bf16 v[108:111], v[32:35], v[200:203], v[140:143]
    v_exp_f32 v17, v121
    v_mfma_f32_16x16x32_bf16 v[108:111], v[36:39], v[204:207], v[108:111]
    s_waitcnt lgkmcnt(3)
    v_cvt_pk_bf16_f32 v185, v18, v19
    v_cvt_f32_i32 v241, v241
    v_mfma_f32_16x16x32_bf16 v[64:67], v[40:43], a[200:203], v[64:67]
    ds_read_b128 v[32:35], v2 offset:256
    v_cvt_f32_i32 v244, v244
    v_mfma_f32_16x16x32_bf16 v[64:67], v[44:47], a[204:207], v[64:67]
    v_exp_f32 v18, v122
    v_mfma_f32_16x16x32_bf16 v[68:71], v[40:43], a[224:227], v[68:71]
    v_add_f32 v7, v7, v16
    v_add_f32 v7, v7, v17
    v_mfma_f32_16x16x32_bf16 v[68:71], v[44:47], a[228:231], v[68:71]
    ds_read_b128 v[56:59], v23 offset:0
    v_mfma_f32_16x16x32_bf16 v[72:75], v[40:43], a[248:251], v[72:75]
    ds_read_b128 v[36:39], v3 offset:256
    v_mfma_f32_16x16x32_bf16 v[72:75], v[44:47], a[252:255], v[72:75]
    buffer_load_dwordx4 v4, s[4:7], s32 offen offset:2048 sc1 lds
    v_mfma_f32_16x16x32_bf16 v[76:79], v[40:43], v[208:211], v[76:79]
    v_exp_f32 v19, v123
    v_mfma_f32_16x16x32_bf16 v[76:79], v[44:47], v[212:215], v[76:79]
    s_waitcnt lgkmcnt(3)
    v_cvt_pk_bf16_f32 v186, v16, v17
    v_add_u32 v10, 1792, v10
    v_mfma_f32_16x16x32_bf16 v[96:99], v[24:27], a[200:203], v[96:99]
    ds_read_b128 v[40:43], v2 offset:6400
    v_mfma_f32_16x16x32_bf16 v[96:99], v[28:31], a[204:207], v[96:99]
    v_exp_f32 v16, v188
    v_mfma_f32_16x16x32_bf16 v[100:103], v[24:27], a[224:227], v[100:103]
    v_add_f32 v7, v7, v18
    v_add_f32 v7, v7, v19
    v_mfma_f32_16x16x32_bf16 v[100:103], v[28:31], a[228:231], v[100:103]
    s_add_u32 s32, s32, 24576
    v_exp_f32 v17, v189
    v_mfma_f32_16x16x32_bf16 v[104:107], v[24:27], a[248:251], v[104:107]
    ds_read_b128 v[44:47], v3 offset:6400
    v_cvt_pk_bf16_f32 v187, v18, v19
    v_mfma_f32_16x16x32_bf16 v[104:107], v[28:31], a[252:255], v[104:107]
    v_exp_f32 v18, v190
    v_mfma_f32_16x16x32_bf16 v[108:111], v[24:27], v[208:211], v[108:111]
    s_add_u32 s29, s30, 49152
    v_cvt_f32_i32 v245, v245
    v_fma_f32 v240, v240, v60, v62
    v_mfma_f32_16x16x32_bf16 v[108:111], v[28:31], v[212:215], v[108:111]
    s_waitcnt lgkmcnt(2)
    v_add_f32 v8, v8, v16
    v_add_f32 v8, v8, v17
    v_mfma_f32_16x16x32_bf16 v[64:67], v[32:35], a[208:211], v[64:67]
    s_add_u32 s26, s26, 12288
    ds_read_b128 v[24:27], v2 offset:12288
    v_fma_f32 v241, v241, v61, v63
    v_mfma_f32_16x16x32_bf16 v[64:67], v[36:39], a[212:215], v[64:67]
    s_sub_u32 s3, s29, 147456
    v_exp_f32 v19, v191
    v_mfma_f32_16x16x32_bf16 v[68:71], v[32:35], a[232:235], v[68:71]
    v_cvt_pk_bf16_f32 v188, v16, v17
    v_fma_f32 v244, v244, v60, v62
    v_mfma_f32_16x16x32_bf16 v[68:71], v[36:39], a[236:239], v[68:71]
    s_mov_b32 m0, s26
    v_exp_f32 v16, v124
    v_mfma_f32_16x16x32_bf16 v[72:75], v[32:35], v[192:195], v[72:75]
    ds_read_b128 v[28:31], v3 offset:12288
    v_add_f32 v8, v8, v18
    v_mfma_f32_16x16x32_bf16 v[72:75], v[36:39], v[196:199], v[72:75]
    v_fma_f32 v245, v245, v61, v63
    v_add_f32 v8, v8, v19
    v_mfma_f32_16x16x32_bf16 v[76:79], v[32:35], v[216:219], v[76:79]
    s_min_u32 s29, s29, s3
    v_mfma_f32_16x16x32_bf16 v[76:79], v[36:39], v[220:223], v[76:79]
    s_waitcnt lgkmcnt(2)
    v_exp_f32 v17, v125
    v_mfma_f32_16x16x32_bf16 v[96:99], v[40:43], a[208:211], v[96:99]
    ds_read_b128 v[32:35], v2 offset:18432
    v_cvt_pk_bf16_f32 v189, v18, v19
    v_mfma_f32_16x16x32_bf16 v[96:99], v[44:47], a[212:215], v[96:99]
    buffer_load_dwordx4 v4, s[4:7], s32 offen offset:0 sc1 lds
    v_mfma_f32_16x16x32_bf16 v[100:103], v[40:43], a[232:235], v[100:103]
    v_exp_f32 v18, v126
    v_mfma_f32_16x16x32_bf16 v[100:103], v[44:47], a[236:239], v[100:103]
    v_add_f32 v8, v8, v16
    v_cvt_pk_bf16_f32 v226, v240, v241
    v_mfma_f32_16x16x32_bf16 v[104:107], v[40:43], v[192:195], v[104:107]
    s_sub_u32 s3, s29, s30
    ds_read_b128 v[36:39], v3 offset:18432
    v_add_f32 v8, v8, v17
    v_mfma_f32_16x16x32_bf16 v[104:107], v[44:47], v[196:199], v[104:107]
    v_exp_f32 v19, v127
    v_mfma_f32_16x16x32_bf16 v[108:111], v[40:43], v[216:219], v[108:111]
    v_cvt_pk_bf16_f32 v230, v244, v245
    v_cvt_f32_i32 v242, v242
    v_mfma_f32_16x16x32_bf16 v[108:111], v[44:47], v[220:223], v[108:111]
    s_waitcnt lgkmcnt(2)
    v_cvt_pk_bf16_f32 v190, v16, v17
    v_add_f32 v8, v8, v18
    v_mfma_f32_16x16x32_bf16 v[80:83], v[24:27], a[192:195], v[128:131]
    ds_read_b128 v[40:43], v2 offset:12416
    v_add_f32 v8, v8, v19
    v_mfma_f32_16x16x32_bf16 v[80:83], v[28:31], a[196:199], v[80:83]
    v_cvt_f32_i32 v243, v243
    v_cvt_pk_bf16_f32 v191, v18, v19
    v_mfma_f32_16x16x32_bf16 v[84:87], v[24:27], a[216:219], v[132:135]
    s_mov_b32 s30, s29
    v_mfma_f32_16x16x32_bf16 v[84:87], v[28:31], a[220:223], v[84:87]
    buffer_load_dwordx4 v4, s[4:7], s32 offen offset:1024 sc1 lds
    v_mfma_f32_16x16x32_bf16 v[88:91], v[24:27], a[240:243], v[136:139]
    ds_read_b128 v[44:47], v3 offset:12416
    v_cvt_f32_i32 v246, v246
    v_mfma_f32_16x16x32_bf16 v[88:91], v[28:31], a[244:247], v[88:91]
    v_exp_f32 v16, v64
    v_mfma_f32_16x16x32_bf16 v[92:95], v[24:27], v[200:203], v[140:143]
    v_exp_f32 v17, v65
    v_mfma_f32_16x16x32_bf16 v[92:95], v[28:31], v[204:207], v[92:95]
    s_waitcnt lgkmcnt(2)
    v_exp_f32 v18, v66
    v_mfma_f32_16x16x32_bf16 v[112:115], v[32:35], a[192:195], v[128:131]
    ds_read_b128 v[24:27], v2 offset:18560
    v_add_f32 v5, v5, v16
    v_mfma_f32_16x16x32_bf16 v[112:115], v[36:39], a[196:199], v[112:115]
    v_add_f32 v5, v5, v17
    v_cvt_f32_i32 v247, v247
    v_mfma_f32_16x16x32_bf16 v[116:119], v[32:35], a[216:219], v[132:135]
    v_exp_f32 v19, v67
    v_mfma_f32_16x16x32_bf16 v[116:119], v[36:39], a[220:223], v[116:119]
    buffer_load_dwordx4 v4, s[4:7], s32 offen offset:2048 sc1 lds
    v_mfma_f32_16x16x32_bf16 v[120:123], v[32:35], a[240:243], v[136:139]
    ds_read_b128 v[28:31], v3 offset:18560
    v_cvt_pk_bf16_f32 v64, v16, v17
    v_mfma_f32_16x16x32_bf16 v[120:123], v[36:39], a[244:247], v[120:123]
    v_exp_f32 v16, v96
    v_mfma_f32_16x16x32_bf16 v[124:127], v[32:35], v[200:203], v[140:143]
    v_add_f32 v5, v5, v18
    v_fma_f32 v242, v242, v48, v50
    v_mfma_f32_16x16x32_bf16 v[124:127], v[36:39], v[204:207], v[124:127]
    s_waitcnt lgkmcnt(2)
    v_add_f32 v5, v5, v19
    v_add_u32 v1, s3, v1
    v_mfma_f32_16x16x32_bf16 v[80:83], v[40:43], a[200:203], v[80:83]
    ds_read_b128 v[32:35], v2 offset:12544
    v_fma_f32 v243, v243, v49, v51
    v_mfma_f32_16x16x32_bf16 v[80:83], v[44:47], a[204:207], v[80:83]
    v_exp_f32 v17, v97
    v_mfma_f32_16x16x32_bf16 v[84:87], v[40:43], a[224:227], v[84:87]
    v_cvt_pk_bf16_f32 v65, v18, v19
    v_add_u32 v21, s3, v21
    v_mfma_f32_16x16x32_bf16 v[84:87], v[44:47], a[228:231], v[84:87]
    s_add_u32 s32, s32, 24576
    v_exp_f32 v18, v98
    v_mfma_f32_16x16x32_bf16 v[88:91], v[40:43], a[248:251], v[88:91]
    s_add_u32 s26, s26, 36864
    ds_read_b128 v[36:39], v3 offset:12544
    v_add_f32 v5, v5, v16
    v_mfma_f32_16x16x32_bf16 v[88:91], v[44:47], a[252:255], v[88:91]
    v_add_f32 v5, v5, v17
    v_fma_f32 v246, v246, v48, v50
    v_mfma_f32_16x16x32_bf16 v[92:95], v[40:43], v[208:211], v[92:95]
    v_exp_f32 v19, v99
    v_mfma_f32_16x16x32_bf16 v[92:95], v[44:47], v[212:215], v[92:95]
    s_waitcnt lgkmcnt(2)
    v_cvt_pk_bf16_f32 v66, v16, v17
    v_fma_f32 v247, v247, v49, v51
    v_mfma_f32_16x16x32_bf16 v[112:115], v[24:27], a[200:203], v[112:115]
    s_sub_u32 s57, s26, 147456
    ds_read_b128 v[40:43], v2 offset:18688
    v_add_u32 v22, s3, v22
    v_mfma_f32_16x16x32_bf16 v[112:115], v[28:31], a[204:207], v[112:115]
    v_exp_f32 v16, v68
    v_mfma_f32_16x16x32_bf16 v[116:119], v[24:27], a[224:227], v[116:119]
    s_min_u32 s26, s26, s57
    v_add_f32 v5, v5, v18
    v_add_f32 v5, v5, v19
    v_mfma_f32_16x16x32_bf16 v[116:119], v[28:31], a[228:231], v[116:119]
    v_exp_f32 v17, v69
    v_mfma_f32_16x16x32_bf16 v[120:123], v[24:27], a[248:251], v[120:123]
    ds_read_b128 v[44:47], v3 offset:18688
    v_cvt_pk_bf16_f32 v227, v242, v243
    v_mfma_f32_16x16x32_bf16 v[120:123], v[28:31], a[252:255], v[120:123]
    s_waitcnt lgkmcnt(2)
    v_cvt_pk_bf16_f32 v67, v18, v19
    v_bfe_u32 v53, v4, 4, 6
    v_mfma_f32_16x16x32_bf16 v[124:127], v[24:27], v[208:211], v[124:127]
    s_waitcnt vmcnt(32)
    v_exp_f32 v18, v70
    v_mfma_f32_16x16x32_bf16 v[124:127], v[28:31], v[212:215], v[124:127]
    s_barrier
    v_cvt_pk_bf16_f32 v231, v246, v247
    v_mfma_f32_16x16x32_bf16 v[80:83], v[32:35], a[208:211], v[80:83]
    s_waitcnt vmcnt(17)
    ds_read_b128 v[24:27], v1 offset:0
    v_add_f32 v6, v6, v16
    v_mfma_f32_16x16x32_bf16 v[80:83], v[36:39], a[212:215], v[80:83]
    v_add_f32 v6, v6, v17
    v_lshlrev_b32 v53, 2, v53
    v_mfma_f32_16x16x32_bf16 v[84:87], v[32:35], a[232:235], v[84:87]
    v_exp_f32 v19, v71
    v_mfma_f32_16x16x32_bf16 v[84:87], v[36:39], a[236:239], v[84:87]
    buffer_load_dword v52, v53, s[20:23], 0 offen sc1
    v_mfma_f32_16x16x32_bf16 v[88:91], v[32:35], v[192:195], v[88:91]
    ds_read_b128 v[28:31], v1 offset:12288
    v_cvt_pk_bf16_f32 v68, v16, v17
    v_mfma_f32_16x16x32_bf16 v[88:91], v[36:39], v[196:199], v[88:91]
    v_exp_f32 v16, v100
    v_mfma_f32_16x16x32_bf16 v[92:95], v[32:35], v[216:219], v[92:95]
    v_add_f32 v6, v6, v18
    v_add_f32 v6, v6, v19
    v_mfma_f32_16x16x32_bf16 v[92:95], v[36:39], v[220:223], v[92:95]
    s_waitcnt lgkmcnt(2)
    v_exp_f32 v17, v101
    v_mfma_f32_16x16x32_bf16 v[112:115], v[40:43], a[208:211], v[112:115]
    ds_read_b128 v[32:35], v1 offset:768
    v_cvt_f32_i32 v248, v248
    v_mfma_f32_16x16x32_bf16 v[112:115], v[44:47], a[212:215], v[112:115]
    v_cvt_pk_bf16_f32 v69, v18, v19
    v_cvt_f32_i32 v249, v249
    v_mfma_f32_16x16x32_bf16 v[116:119], v[40:43], a[232:235], v[116:119]
    v_exp_f32 v18, v102
    v_mfma_f32_16x16x32_bf16 v[116:119], v[44:47], a[236:239], v[116:119]
    v_add_f32 v6, v6, v16
    v_add_f32 v6, v6, v17
    v_mfma_f32_16x16x32_bf16 v[120:123], v[40:43], v[192:195], v[120:123]
    ds_read_b128 v[36:39], v1 offset:13056
    v_cvt_f32_i32 v252, v252
    v_mfma_f32_16x16x32_bf16 v[120:123], v[44:47], v[196:199], v[120:123]
    v_exp_f32 v19, v103
    v_mfma_f32_16x16x32_bf16 v[124:127], v[40:43], v[216:219], v[124:127]
    v_cvt_pk_bf16_f32 v70, v16, v17
    v_add_f32 v6, v6, v18
    v_mfma_f32_16x16x32_bf16 v[124:127], v[44:47], v[220:223], v[124:127]
    s_waitcnt lgkmcnt(2)
    v_add_f32 v6, v6, v19
    v_cvt_f32_i32 v253, v253
    v_cvt_pk_bf16_f32 v71, v18, v19
    v_fma_f32 v248, v248, v60, v62
    v_mfma_f32_16x16x32_bf16 a[0:3], v[160:163], v[24:27], a[0:3]
    ds_read_b128 v[40:43], v1 offset:1536
    v_fma_f32 v249, v249, v61, v63
    v_mfma_f32_16x16x32_bf16 a[0:3], v[176:179], v[28:31], a[0:3]
    s_waitcnt vmcnt(0)
    v_subrev_u32 v52, s92, v52
    v_cmp_lt_u32 vcc, 15, v52
    v_mfma_f32_16x16x32_bf16 a[48:51], v[164:167], v[24:27], a[48:51]
    v_exp_f32 v16, v72
    v_mfma_f32_16x16x32_bf16 a[48:51], v[180:183], v[28:31], a[48:51]
    v_exp_f32 v17, v73
    v_mfma_f32_16x16x32_bf16 a[96:99], v[168:171], v[24:27], a[96:99]
    s_and_b32 s59, vcc_lo, 0xff
    ds_read_b128 v[44:47], v1 offset:13824
    v_fma_f32 v252, v252, v60, v62
    v_mfma_f32_16x16x32_bf16 a[96:99], v[184:187], v[28:31], a[96:99]
    s_cbranch_scc1 L_pollslow1
L_pollok1:
    v_mfma_f32_16x16x32_bf16 a[144:147], v[172:175], v[24:27], a[144:147]
    s_add_u32 s92, s92, 1
    v_exp_f32 v18, v74
    v_mfma_f32_16x16x32_bf16 a[144:147], v[188:191], v[28:31], a[144:147]
    s_waitcnt lgkmcnt(2)
    v_add_f32 v7, v7, v16
    v_add_f32 v7, v7, v17
    v_mfma_f32_16x16x32_bf16 a[4:7], v[160:163], v[32:35], a[4:7]
    s_mov_b32 m0, s56
    ds_read_b128 v[24:27], v1 offset:2304
    v_fma_f32 v253, v253, v61, v63
    v_mfma_f32_16x16x32_bf16 a[4:7], v[176:179], v[36:39], a[4:7]
    buffer_load_dwordx4 v4, s[4:7], s27 offen offset:0 sc1 lds
    v_mfma_f32_16x16x32_bf16 a[52:55], v[164:167], v[32:35], a[52:55]
    v_exp_f32 v19, v75
    v_mfma_f32_16x16x32_bf16 a[52:55], v[180:183], v[36:39], a[52:55]
    v_cvt_pk_bf16_f32 v72, v16, v17
    v_cvt_pk_bf16_f32 v234, v248, v249
    v_mfma_f32_16x16x32_bf16 a[100:103], v[168:171], v[32:35], a[100:103]
    ds_read_b128 v[28:31], v1 offset:14592
    v_cvt_pk_bf16_f32 v238, v252, v253
    v_mfma_f32_16x16x32_bf16 a[100:103], v[184:187], v[36:39], a[100:103]
    buffer_load_dwordx4 v4, s[4:7], s27 offen offset:1024 sc1 lds
    v_mfma_f32_16x16x32_bf16 a[148:151], v[172:175], v[32:35], a[148:151]
    v_exp_f32 v16, v104
    v_mfma_f32_16x16x32_bf16 a[148:151], v[188:191], v[36:39], a[148:151]
    s_waitcnt lgkmcnt(2)
    v_add_f32 v7, v7, v18
    v_add_f32 v7, v7, v19
    v_mfma_f32_16x16x32_bf16 a[8:11], v[160:163], v[40:43], a[8:11]
    ds_read_b128 v[32:35], v21 offset:0
    v_cvt_f32_i32 v250, v250
    v_mfma_f32_16x16x32_bf16 a[8:11], v[176:179], v[44:47], a[8:11]
    buffer_load_dwordx4 v4, s[4:7], s27 offen offset:2048 sc1 lds
    v_mfma_f32_16x16x32_bf16 a[56:59], v[164:167], v[40:43], a[56:59]
    s_add_u32 s27, s27, 24576
    v_exp_f32 v17, v105
    v_mfma_f32_16x16x32_bf16 a[56:59], v[180:183], v[44:47], a[56:59]
    v_cvt_pk_bf16_f32 v73, v18, v19
    v_mfma_f32_16x16x32_bf16 a[104:107], v[168:171], v[40:43], a[104:107]
    s_add_u32 s56, s56, 12288
    ds_read_b128 v[36:39], v21 offset:12288
    v_cvt_f32_i32 v251, v251
    v_mfma_f32_16x16x32_bf16 a[104:107], v[184:187], v[44:47], a[104:107]
    s_mov_b32 m0, s56
    v_exp_f32 v18, v106
    v_mfma_f32_16x16x32_bf16 a[152:155], v[172:175], v[40:43], a[152:155]
    v_add_f32 v7, v7, v16
    v_add_f32 v7, v7, v17
    v_mfma_f32_16x16x32_bf16 a[152:155], v[188:191], v[44:47], a[152:155]
    s_waitcnt lgkmcnt(2)
    v_exp_f32 v19, v107
    v_mfma_f32_16x16x32_bf16 a[12:15], v[160:163], v[24:27], a[12:15]
    ds_read_b128 v[40:43], v21 offset:768
    v_cvt_pk_bf16_f32 v74, v16, v17
    v_mfma_f32_16x16x32_bf16 a[12:15], v[176:179], v[28:31], a[12:15]
    buffer_load_dwordx4 v4, s[4:7], s27 offen offset:0 sc1 lds
    v_mfma_f32_16x16x32_bf16 a[60:63], v[164:167], v[24:27], a[60:63]
    v_exp_f32 v16, v76
    v_mfma_f32_16x16x32_bf16 a[60:63], v[180:183], v[28:31], a[60:63]
    v_add_f32 v7, v7, v18
    v_add_f32 v7, v7, v19
    v_mfma_f32_16x16x32_bf16 a[108:111], v[168:171], v[24:27], a[108:111]
    ds_read_b128 v[44:47], v21 offset:13056
    v_cvt_f32_i32 v254, v254
    v_mfma_f32_16x16x32_bf16 a[108:111], v[184:187], v[28:31], a[108:111]
    buffer_load_dwordx4 v4, s[4:7], s27 offen offset:1024 sc1 lds
    v_mfma_f32_16x16x32_bf16 a[156:159], v[172:175], v[24:27], a[156:159]
    s_add_u32 s29, s28, 49152
    v_exp_f32 v17, v77
    v_mfma_f32_16x16x32_bf16 a[156:159], v[188:191], v[28:31], a[156:159]
    s_waitcnt lgkmcnt(2)
    v_cvt_pk_bf16_f32 v75, v18, v19
    v_cvt_f32_i32 v255, v255
    v_mfma_f32_16x16x32_bf16 a[16:19], v[160:163], v[32:35], a[16:19]
    ds_read_b128 v[24:27], v21 offset:1536
    v_fma_f32 v250, v250, v48, v50
    v_mfma_f32_16x16x32_bf16 a[16:19], v[176:179], v[36:39], a[16:19]
    s_sub_u32 s3, s29, 147456
    buffer_load_dwordx4 v4, s[4:7], s27 offen offset:2048 sc1 lds
    v_mfma_f32_16x16x32_bf16 a[64:67], v[164:167], v[32:35], a[64:67]
    v_exp_f32 v18, v78
    v_mfma_f32_16x16x32_bf16 a[64:67], v[180:183], v[36:39], a[64:67]
    s_add_u32 s27, s27, 24576
    v_add_f32 v8, v8, v16
    v_add_f32 v8, v8, v17
    v_mfma_f32_16x16x32_bf16 a[112:115], v[168:171], v[32:35], a[112:115]
    ds_read_b128 v[28:31], v21 offset:13824
    v_fma_f32 v251, v251, v49, v51
    v_mfma_f32_16x16x32_bf16 a[112:115], v[184:187], v[36:39], a[112:115]
    s_add_u32 s56, s56, 36864
    buffer_load_dwordx4 v[240:243], v12, s[68:71], s36 offen offset:0 nt
    v_mfma_f32_16x16x32_bf16 a[160:163], v[172:175], v[32:35], a[160:163]
    v_exp_f32 v19, v79
    v_mfma_f32_16x16x32_bf16 a[160:163], v[188:191], v[36:39], a[160:163]
    s_waitcnt lgkmcnt(2)
    v_cvt_pk_bf16_f32 v76, v16, v17
    v_exp_f32 v16, v108
    v_mfma_f32_16x16x32_bf16 a[20:23], v[160:163], v[40:43], a[20:23]
    s_sub_u32 s58, s56, 147456
    ds_read_b128 v[32:35], v21 offset:2304
    v_add_f32 v8, v8, v18
    v_mfma_f32_16x16x32_bf16 a[20:23], v[176:179], v[44:47], a[20:23]
    s_min_u32 s29, s29, s3
    v_add_f32 v8, v8, v19
    v_fma_f32 v254, v254, v48, v50
    v_mfma_f32_16x16x32_bf16 a[68:71], v[164:167], v[40:43], a[68:71]
    s_min_u32 s56, s56, s58
    v_exp_f32 v17, v109
    v_mfma_f32_16x16x32_bf16 a[68:71], v[180:183], v[44:47], a[68:71]
    buffer_load_dwordx4 v[244:247], v12, s[68:71], s36 offen offset:768 nt
    v_cvt_pk_bf16_f32 v77, v18, v19
    v_mfma_f32_16x16x32_bf16 a[116:119], v[168:171], v[40:43], a[116:119]
    ds_read_b128 v[36:39], v21 offset:14592
    v_fma_f32 v255, v255, v49, v51
    v_mfma_f32_16x16x32_bf16 a[116:119], v[184:187], v[44:47], a[116:119]
    v_exp_f32 v18, v110
    v_mfma_f32_16x16x32_bf16 a[164:167], v[172:175], v[40:43], a[164:167]
    s_sub_u32 s3, s29, s28
    v_add_f32 v8, v8, v16
    v_add_f32 v8, v8, v17
    v_mfma_f32_16x16x32_bf16 a[164:167], v[188:191], v[44:47], a[164:167]
    s_waitcnt lgkmcnt(2)
    v_exp_f32 v19, v111
    v_mfma_f32_16x16x32_bf16 a[24:27], v[160:163], v[24:27], a[24:27]
    ds_read_b128 v[40:43], v22 offset:0
    v_cvt_pk_bf16_f32 v78, v16, v17
    v_mfma_f32_16x16x32_bf16 a[24:27], v[176:179], v[28:31], a[24:27]
    v_add_f32 v8, v8, v18
    v_add_f32 v8, v8, v19
    v_mfma_f32_16x16x32_bf16 a[72:75], v[164:167], v[24:27], a[72:75]
    v_cvt_pk_bf16_f32 v79, v18, v19
    v_cvt_pk_bf16_f32 v235, v250, v251
    v_mfma_f32_16x16x32_bf16 a[72:75], v[180:183], v[28:31], a[72:75]
    v_exp_f32 v16, v80
    v_mfma_f32_16x16x32_bf16 a[120:123], v[168:171], v[24:27], a[120:123]
    ds_read_b128 v[44:47], v22 offset:12288
    v_cvt_pk_bf16_f32 v239, v254, v255
    v_mfma_f32_16x16x32_bf16 a[120:123], v[184:187], v[28:31], a[120:123]
    s_mov_b32 s28, s29
    v_exp_f32 v17, v81
    v_mfma_f32_16x16x32_bf16 a[168:171], v[172:175], v[24:27], a[168:171]
    v_exp_f32 v18, v82
    v_mfma_f32_16x16x32_bf16 a[168:171], v[188:191], v[28:31], a[168:171]
    s_waitcnt lgkmcnt(2)
    v_add_f32 v5, v5, v16
    v_add_f32 v5, v5, v17
    v_mfma_f32_16x16x32_bf16 a[28:31], v[160:163], v[32:35], a[28:31]
    ds_read_b128 v[24:27], v22 offset:768
    v_mfma_f32_16x16x32_bf16 a[28:31], v[176:179], v[36:39], a[28:31]
    buffer_store_dwordx4 v[224:227], v11, s[4:7], s37 offen offset:0 sc1
    v_mfma_f32_16x16x32_bf16 a[76:79], v[164:167], v[32:35], a[76:79]
    v_exp_f32 v19, v83
    v_mfma_f32_16x16x32_bf16 a[76:79], v[180:183], v[36:39], a[76:79]
    v_cvt_pk_bf16_f32 v80, v16, v17
    v_mfma_f32_16x16x32_bf16 a[124:127], v[168:171], v[32:35], a[124:127]
    ds_read_b128 v[28:31], v22 offset:13056
    v_add_u32 v2, s3, v2
    v_mfma_f32_16x16x32_bf16 a[124:127], v[184:187], v[36:39], a[124:127]
    v_exp_f32 v16, v112
    v_mfma_f32_16x16x32_bf16 a[172:175], v[172:175], v[32:35], a[172:175]
    v_add_f32 v5, v5, v18
    v_add_f32 v5, v5, v19
    v_mfma_f32_16x16x32_bf16 a[172:175], v[188:191], v[36:39], a[172:175]
    s_waitcnt lgkmcnt(2)
    v_exp_f32 v17, v113
    v_mfma_f32_16x16x32_bf16 a[32:35], v[160:163], v[40:43], a[32:35]
    ds_read_b128 v[32:35], v22 offset:1536
    v_cvt_pk_bf16_f32 v81, v18, v19
    v_mfma_f32_16x16x32_bf16 a[32:35], v[176:179], v[44:47], a[32:35]
    buffer_store_dwordx4 v[228:231], v54, s[4:7], s37 offen offset:768 sc1
    v_mfma_f32_16x16x32_bf16 a[80:83], v[164:167], v[40:43], a[80:83]
    v_exp_f32 v18, v114
    v_mfma_f32_16x16x32_bf16 a[80:83], v[180:183], v[44:47], a[80:83]
    v_add_f32 v5, v5, v16
    v_add_f32 v5, v5, v17
    v_mfma_f32_16x16x32_bf16 a[128:131], v[168:171], v[40:43], a[128:131]
    ds_read_b128 v[36:39], v22 offset:13824
    v_add_u32 v3, s3, v3
    v_mfma_f32_16x16x32_bf16 a[128:131], v[184:187], v[44:47], a[128:131]
    v_exp_f32 v19, v115
    v_mfma_f32_16x16x32_bf16 a[176:179], v[172:175], v[40:43], a[176:179]
    ds_read_b128 v[60:63], v23 offset:16
    v_cvt_pk_bf16_f32 v82, v16, v17
    v_mfma_f32_16x16x32_bf16 a[176:179], v[188:191], v[44:47], a[176:179]
    s_waitcnt lgkmcnt(3)
    v_exp_f32 v16, v84
    v_mfma_f32_16x16x32_bf16 a[36:39], v[160:163], v[24:27], a[36:39]
    s_waitcnt vmcnt(26)
    ds_read_b128 v[40:43], v22 offset:2304
    v_add_f32 v5, v5, v18
    v_mfma_f32_16x16x32_bf16 a[36:39], v[176:179], v[28:31], a[36:39]
    buffer_store_dwordx4 v[232:235], v11, s[4:7], s80 offen offset:0 sc1
    v_mfma_f32_16x16x32_bf16 a[84:87], v[164:167], v[24:27], a[84:87]
    v_add_f32 v5, v5, v19
    v_cvt_f32_i32 v144, v144
    v_mfma_f32_16x16x32_bf16 a[84:87], v[180:183], v[28:31], a[84:87]
    v_exp_f32 v17, v85
    v_mfma_f32_16x16x32_bf16 a[132:135], v[168:171], v[24:27], a[132:135]
    ds_read_b128 v[44:47], v22 offset:14592
    v_cvt_pk_bf16_f32 v83, v18, v19
    v_mfma_f32_16x16x32_bf16 a[132:135], v[184:187], v[28:31], a[132:135]
    s_waitcnt lgkmcnt(3)
    v_exp_f32 v18, v86
    v_mfma_f32_16x16x32_bf16 a[180:183], v[172:175], v[24:27], a[180:183]
    s_waitcnt vmcnt(19)
    v_cvt_f32_i32 v148, v148
    v_cvt_f32_i32 v145, v145
    v_mfma_f32_16x16x32_bf16 a[180:183], v[188:191], v[28:31], a[180:183]
    s_barrier
    v_add_f32 v6, v6, v16
    v_mfma_f32_16x16x32_bf16 a[40:43], v[160:163], v[32:35], a[40:43]
    ds_read_b128 v[24:27], v2 offset:0
    v_add_f32 v6, v6, v17
    v_mfma_f32_16x16x32_bf16 a[40:43], v[176:179], v[36:39], a[40:43]
    v_exp_f32 v19, v87
    v_mfma_f32_16x16x32_bf16 a[88:91], v[164:167], v[32:35], a[88:91]
    ds_read_b128 v[48:51], v23 offset:32
    v_cvt_pk_bf16_f32 v84, v16, v17
    v_mfma_f32_16x16x32_bf16 a[88:91], v[180:183], v[36:39], a[88:91]
    v_exp_f32 v16, v116
    v_mfma_f32_16x16x32_bf16 a[136:139], v[168:171], v[32:35], a[136:139]
    ds_read_b128 v[28:31], v3 offset:0
    v_cvt_f32_i32 v149, v149
    v_mfma_f32_16x16x32_bf16 a[136:139], v[184:187], v[36:39], a[136:139]
    buffer_store_dwordx4 v[236:239], v54, s[4:7], s80 offen offset:768 sc1
    v_mfma_f32_16x16x32_bf16 a[184:187], v[172:175], v[32:35], a[184:187]
    v_add_f32 v6, v6, v18
    v_add_f32 v6, v6, v19
    v_mfma_f32_16x16x32_bf16 a[184:187], v[188:191], v[36:39], a[184:187]
    s_waitcnt lgkmcnt(3)
    v_exp_f32 v17, v117
    v_mfma_f32_16x16x32_bf16 a[44:47], v[160:163], v[40:43], a[44:47]
    ds_read_b128 v[32:35], v2 offset:6144
    v_fma_f32 v144, v144, v56, v58
    v_mfma_f32_16x16x32_bf16 a[44:47], v[176:179], v[44:47], a[44:47]
    v_cvt_pk_bf16_f32 v85, v18, v19
    v_fma_f32 v148, v148, v57, v59
    v_mfma_f32_16x16x32_bf16 a[92:95], v[164:167], v[40:43], a[92:95]
    v_exp_f32 v18, v118
    v_mfma_f32_16x16x32_bf16 a[92:95], v[180:183], v[44:47], a[92:95]
    v_add_f32 v6, v6, v16
    v_fma_f32 v145, v145, v56, v58
    v_mfma_f32_16x16x32_bf16 a[140:143], v[168:171], v[40:43], a[140:143]
    ds_read_b128 v[36:39], v3 offset:6144
    v_add_f32 v6, v6, v17
    v_mfma_f32_16x16x32_bf16 a[140:143], v[184:187], v[44:47], a[140:143]
    v_exp_f32 v19, v119
    v_mfma_f32_16x16x32_bf16 a[188:191], v[172:175], v[40:43], a[188:191]
    v_cvt_pk_bf16_f32 v86, v16, v17
    v_fma_f32 v149, v149, v57, v59
    v_mfma_f32_16x16x32_bf16 a[188:191], v[188:191], v[44:47], a[188:191]
    s_waitcnt lgkmcnt(2)
    v_add_f32 v6, v6, v18
    v_add_f32 v6, v6, v19
    v_cvt_f32_i32 v146, v146
    v_cvt_pk_bf16_f32 v87, v18, v19
    v_cvt_f32_i32 v150, v150
    v_mfma_f32_16x16x32_bf16 v[160:163], v[24:27], a[192:195], v[128:131]
    ds_read_b128 v[40:43], v2 offset:128
    v_cvt_f32_i32 v147, v147
    v_mfma_f32_16x16x32_bf16 v[160:163], v[28:31], a[196:199], v[160:163]
    buffer_load_dwordx4 v[248:251], v12, s[68:71], s36 offen offset:1536 nt
    v_mfma_f32_16x16x32_bf16 v[164:167], v[24:27], a[216:219], v[132:135]
    v_exp_f32 v16, v88
    v_mfma_f32_16x16x32_bf16 v[164:167], v[28:31], a[220:223], v[164:167]
    v_exp_f32 v17, v89
    v_mfma_f32_16x16x32_bf16 v[168:171], v[24:27], a[240:243], v[136:139]
    ds_read_b128 v[44:47], v3 offset:128
    v_cvt_f32_i32 v151, v151
    v_mfma_f32_16x16x32_bf16 v[168:171], v[28:31], a[244:247], v[168:171]
    buffer_load_dwordx4 v[252:255], v12, s[68:71], s36 offen offset:2304 nt
    v_mfma_f32_16x16x32_bf16 v[172:175], v[24:27], v[200:203], v[140:143]
    v_exp_f32 v18, v90
    v_mfma_f32_16x16x32_bf16 v[172:175], v[28:31], v[204:207], v[172:175]
    s_waitcnt lgkmcnt(2)
    v_add_f32 v7, v7, v16
    v_add_f32 v7, v7, v17
    v_mfma_f32_16x16x32_bf16 v[96:99], v[32:35], a[192:195], v[128:131]
    ds_read_b128 v[24:27], v2 offset:6272
    v_fma_f32 v146, v146, v56, v58
    v_mfma_f32_16x16x32_bf16 v[96:99], v[36:39], a[196:199], v[96:99]
    v_exp_f32 v19, v91
    v_mfma_f32_16x16x32_bf16 v[100:103], v[32:35], a[216:219], v[132:135]
    s_mov_b32 m0, s56
    v_cvt_pk_bf16_f32 v88, v16, v17
    v_fma_f32 v150, v150, v57, v59
    v_mfma_f32_16x16x32_bf16 v[100:103], v[36:39], a[220:223], v[100:103]
    buffer_load_dwordx4 v4, s[4:7], s27 offen offset:0 sc1 lds
    v_mfma_f32_16x16x32_bf16 v[104:107], v[32:35], a[240:243], v[136:139]
    ds_read_b128 v[28:31], v3 offset:6272
    v_fma_f32 v147, v147, v56, v58
    v_mfma_f32_16x16x32_bf16 v[104:107], v[36:39], a[244:247], v[104:107]
    v_exp_f32 v16, v120
    v_mfma_f32_16x16x32_bf16 v[108:111], v[32:35], v[200:203], v[140:143]
    v_add_f32 v7, v7, v18
    v_add_f32 v7, v7, v19
    v_mfma_f32_16x16x32_bf16 v[108:111], v[36:39], v[204:207], v[108:111]
    s_waitcnt lgkmcnt(2)
    buffer_load_dwordx4 v4, s[4:7], s27 offen offset:1024 sc1 lds
    v_mfma_f32_16x16x32_bf16 v[160:163], v[40:43], a[200:203], v[160:163]
    ds_read_b128 v[32:35], v2 offset:256
    v_fma_f32 v151, v151, v57, v59
    v_mfma_f32_16x16x32_bf16 v[160:163], v[44:47], a[204:207], v[160:163]
    v_exp_f32 v17, v121
    v_mfma_f32_16x16x32_bf16 v[164:167], v[40:43], a[224:227], v[164:167]
    ds_read_b128 v[56:59], v23 offset:48
    v_cvt_pk_bf16_f32 v89, v18, v19
    v_mfma_f32_16x16x32_bf16 v[164:167], v[44:47], a[228:231], v[164:167]
    buffer_load_dwordx4 v4, s[4:7], s27 offen offset:2048 sc1 lds
    v_mfma_f32_16x16x32_bf16 v[168:171], v[40:43], a[248:251], v[168:171]
    s_waitcnt vmcnt(31)
    ds_read_b128 v[36:39], v3 offset:256
    v_mfma_f32_16x16x32_bf16 v[168:171], v[44:47], a[252:255], v[168:171]
    s_add_u32 s27, s27, 24576
    v_exp_f32 v18, v122
    v_mfma_f32_16x16x32_bf16 v[172:175], v[40:43], v[208:211], v[172:175]
    v_add_f32 v7, v7, v16
    v_add_f32 v7, v7, v17
    v_mfma_f32_16x16x32_bf16 v[172:175], v[44:47], v[212:215], v[172:175]
    s_waitcnt lgkmcnt(3)
    v_exp_f32 v19, v123
    v_mfma_f32_16x16x32_bf16 v[96:99], v[24:27], a[200:203], v[96:99]
    s_add_u32 s56, s56, 12288
    ds_read_b128 v[40:43], v2 offset:6400
    v_cvt_pk_bf16_f32 v90, v16, v17
    v_mfma_f32_16x16x32_bf16 v[96:99], v[28:31], a[204:207], v[96:99]
    s_mov_b32 m0, s56
    v_exp_f32 v16, v92
    v_mfma_f32_16x16x32_bf16 v[100:103], v[24:27], a[224:227], v[100:103]
    v_add_f32 v7, v7, v18
    v_add_f32 v7, v7, v19
    v_mfma_f32_16x16x32_bf16 v[100:103], v[28:31], a[228:231], v[100:103]
    v_exp_f32 v17, v93
    v_mfma_f32_16x16x32_bf16 v[104:107], v[24:27], a[248:251], v[104:107]
    ds_read_b128 v[44:47], v3 offset:6400
    v_cvt_pk_bf16_f32 v91, v18, v19
    v_mfma_f32_16x16x32_bf16 v[104:107], v[28:31], a[252:255], v[104:107]
    buffer_load_dwordx4 v4, s[4:7], s27 offen offset:0 sc1 lds
    v_mfma_f32_16x16x32_bf16 v[108:111], v[24:27], v[208:211], v[108:111]
    s_add_u32 s29, s30, 49152
    v_exp_f32 v18, v94
    v_mfma_f32_16x16x32_bf16 v[108:111], v[28:31], v[212:215], v[108:111]
    s_waitcnt lgkmcnt(2)
    v_add_f32 v8, v8, v16
    v_cvt_f32_i32 v152, v152
    v_mfma_f32_16x16x32_bf16 v[160:163], v[32:35], a[208:211], v[160:163]
    s_sub_u32 s3, s29, 147456
    ds_read_b128 v[24:27], v2 offset:12288
    v_add_f32 v8, v8, v17
    v_mfma_f32_16x16x32_bf16 v[160:163], v[36:39], a[212:215], v[160:163]
    buffer_load_dwordx4 v4, s[4:7], s27 offen offset:1024 sc1 lds
    v_mfma_f32_16x16x32_bf16 v[164:167], v[32:35], a[232:235], v[164:167]
    v_exp_f32 v19, v95
    v_mfma_f32_16x16x32_bf16 v[164:167], v[36:39], a[236:239], v[164:167]
    v_cvt_pk_bf16_f32 v92, v16, v17
    v_cvt_f32_i32 v156, v156
    v_mfma_f32_16x16x32_bf16 v[168:171], v[32:35], v[192:195], v[168:171]
    ds_read_b128 v[28:31], v3 offset:12288
    v_cvt_f32_i32 v153, v153
    v_mfma_f32_16x16x32_bf16 v[168:171], v[36:39], v[196:199], v[168:171]
    buffer_load_dwordx4 v4, s[4:7], s27 offen offset:2048 sc1 lds
    v_mfma_f32_16x16x32_bf16 v[172:175], v[32:35], v[216:219], v[172:175]
    s_add_u32 s27, s27, 24576
    v_exp_f32 v16, v124
    v_mfma_f32_16x16x32_bf16 v[172:175], v[36:39], v[220:223], v[172:175]
    s_waitcnt lgkmcnt(2)
    v_add_f32 v8, v8, v18
    v_add_f32 v8, v8, v19
    v_mfma_f32_16x16x32_bf16 v[96:99], v[40:43], a[208:211], v[96:99]
    s_add_u32 s56, s56, 36864
    ds_read_b128 v[32:35], v2 offset:18432
    v_add_u32 v23, 1792, v23
    v_mfma_f32_16x16x32_bf16 v[96:99], v[44:47], a[212:215], v[96:99]
    s_min_u32 s29, s29, s3
    v_exp_f32 v17, v125
    v_mfma_f32_16x16x32_bf16 v[100:103], v[40:43], a[232:235], v[100:103]
    s_sub_u32 s58, s56, 147456
    v_cvt_pk_bf16_f32 v93, v18, v19
    v_cvt_f32_i32 v157, v157
    v_mfma_f32_16x16x32_bf16 v[100:103], v[44:47], a[236:239], v[100:103]
    s_min_u32 s56, s56, s58
    v_exp_f32 v18, v126
    v_mfma_f32_16x16x32_bf16 v[104:107], v[40:43], v[192:195], v[104:107]
    s_sub_u32 s3, s29, s30
    ds_read_b128 v[36:39], v3 offset:18432
    v_add_f32 v8, v8, v16
    v_mfma_f32_16x16x32_bf16 v[104:107], v[44:47], v[196:199], v[104:107]
    s_mov_b32 m0, s26
    v_add_f32 v8, v8, v17
    v_fma_f32 v152, v152, v60, v62
    v_mfma_f32_16x16x32_bf16 v[108:111], v[40:43], v[216:219], v[108:111]
    v_exp_f32 v19, v127
    v_mfma_f32_16x16x32_bf16 v[108:111], v[44:47], v[220:223], v[108:111]
    s_waitcnt lgkmcnt(2)
    buffer_load_dwordx4 v4, s[4:7], s32 offen offset:0 sc1 lds
    v_mfma_f32_16x16x32_bf16 v[176:179], v[24:27], a[192:195], v[128:131]
    ds_read_b128 v[40:43], v2 offset:12416
    v_cvt_pk_bf16_f32 v94, v16, v17
    v_mfma_f32_16x16x32_bf16 v[176:179], v[28:31], a[196:199], v[176:179]
    v_add_f32 v8, v8, v18
    v_add_f32 v8, v8, v19
    v_mfma_f32_16x16x32_bf16 v[180:183], v[24:27], a[216:219], v[132:135]
    s_mov_b32 s30, s29
    v_cvt_pk_bf16_f32 v95, v18, v19
    v_fma_f32 v156, v156, v61, v63
    v_mfma_f32_16x16x32_bf16 v[180:183], v[28:31], a[220:223], v[180:183]
    buffer_load_dwordx4 v4, s[4:7], s32 offen offset:1024 sc1 lds
    v_mfma_f32_16x16x32_bf16 v[184:187], v[24:27], a[240:243], v[136:139]
    ds_read_b128 v[44:47], v3 offset:12416
    v_fma_f32 v153, v153, v60, v62
    v_mfma_f32_16x16x32_bf16 v[184:187], v[28:31], a[244:247], v[184:187]
    v_exp_f32 v16, v160
    v_mfma_f32_16x16x32_bf16 v[188:191], v[24:27], v[200:203], v[140:143]
    v_exp_f32 v17, v161
    v_mfma_f32_16x16x32_bf16 v[188:191], v[28:31], v[204:207], v[188:191]
    s_waitcnt lgkmcnt(2)
    buffer_load_dwordx4 v4, s[4:7], s32 offen offset:2048 sc1 lds
    v_mfma_f32_16x16x32_bf16 v[112:115], v[32:35], a[192:195], v[128:131]
    ds_read_b128 v[24:27], v2 offset:18560
    v_fma_f32 v157, v157, v61, v63
    v_mfma_f32_16x16x32_bf16 v[112:115], v[36:39], a[196:199], v[112:115]
    s_add_u32 s32, s32, 24576
    v_exp_f32 v18, v162
    v_mfma_f32_16x16x32_bf16 v[116:119], v[32:35], a[216:219], v[132:135]
    v_add_f32 v5, v5, v16
    v_add_f32 v5, v5, v17
    v_mfma_f32_16x16x32_bf16 v[116:119], v[36:39], a[220:223], v[116:119]
    s_add_u32 s26, s26, 12288
    v_exp_f32 v19, v163
    v_mfma_f32_16x16x32_bf16 v[120:123], v[32:35], a[240:243], v[136:139]
    ds_read_b128 v[28:31], v3 offset:18560
    v_cvt_f32_i32 v154, v154
    v_mfma_f32_16x16x32_bf16 v[120:123], v[36:39], a[244:247], v[120:123]
    s_mov_b32 m0, s26
    v_cvt_pk_bf16_f32 v160, v16, v17
    v_cvt_f32_i32 v158, v158
    v_mfma_f32_16x16x32_bf16 v[124:127], v[32:35], v[200:203], v[140:143]
    v_exp_f32 v16, v96
    v_mfma_f32_16x16x32_bf16 v[124:127], v[36:39], v[204:207], v[124:127]
    s_waitcnt lgkmcnt(2)
    v_add_f32 v5, v5, v18
    v_add_f32 v5, v5, v19
    v_mfma_f32_16x16x32_bf16 v[176:179], v[40:43], a[200:203], v[176:179]
    ds_read_b128 v[32:35], v2 offset:12544
    v_add_u32 v1, s3, v1
    v_mfma_f32_16x16x32_bf16 v[176:179], v[44:47], a[204:207], v[176:179]
    buffer_load_dwordx4 v4, s[4:7], s32 offen offset:0 sc1 lds
    v_mfma_f32_16x16x32_bf16 v[180:183], v[40:43], a[224:227], v[180:183]
    v_exp_f32 v17, v97
    v_mfma_f32_16x16x32_bf16 v[180:183], v[44:47], a[228:231], v[180:183]
    v_cvt_pk_bf16_f32 v161, v18, v19
    v_cvt_f32_i32 v155, v155
    v_mfma_f32_16x16x32_bf16 v[184:187], v[40:43], a[248:251], v[184:187]
    ds_read_b128 v[36:39], v3 offset:12544
    v_cvt_f32_i32 v159, v159
    v_mfma_f32_16x16x32_bf16 v[184:187], v[44:47], a[252:255], v[184:187]
    buffer_load_dwordx4 v4, s[4:7], s32 offen offset:1024 sc1 lds
    v_mfma_f32_16x16x32_bf16 v[188:191], v[40:43], v[208:211], v[188:191]
    v_exp_f32 v18, v98
    v_mfma_f32_16x16x32_bf16 v[188:191], v[44:47], v[212:215], v[188:191]
    s_waitcnt lgkmcnt(2)
    v_add_f32 v5, v5, v16
    v_add_f32 v5, v5, v17
    v_mfma_f32_16x16x32_bf16 v[112:115], v[24:27], a[200:203], v[112:115]
    ds_read_b128 v[40:43], v2 offset:18688
    v_add_u32 v21, s3, v21
    v_mfma_f32_16x16x32_bf16 v[112:115], v[28:31], a[204:207], v[112:115]
    buffer_load_dwordx4 v4, s[4:7], s32 offen offset:2048 sc1 lds
    v_mfma_f32_16x16x32_bf16 v[116:119], v[24:27], a[224:227], v[116:119]
    v_exp_f32 v19, v99
    v_mfma_f32_16x16x32_bf16 v[116:119], v[28:31], a[228:231], v[116:119]
    s_add_u32 s32, s32, 24576
    v_cvt_pk_bf16_f32 v162, v16, v17
    v_fma_f32 v154, v154, v60, v62
    v_mfma_f32_16x16x32_bf16 v[120:123], v[24:27], a[248:251], v[120:123]
    ds_read_b128 v[44:47], v3 offset:18688
    v_add_u32 v22, s3, v22
    v_mfma_f32_16x16x32_bf16 v[120:123], v[28:31], a[252:255], v[120:123]
    s_waitcnt lgkmcnt(2)
    v_exp_f32 v16, v164
    v_add_f32 v5, v5, v18
    v_mfma_f32_16x16x32_bf16 v[124:127], v[24:27], v[208:211], v[124:127]
    s_waitcnt vmcnt(14)
    v_add_f32 v5, v5, v19
    v_fma_f32 v158, v158, v61, v63
    v_mfma_f32_16x16x32_bf16 v[124:127], v[28:31], v[212:215], v[124:127]
    s_barrier
    v_exp_f32 v17, v165
    v_mfma_f32_16x16x32_bf16 v[176:179], v[32:35], a[208:211], v[176:179]
    s_add_u32 s33, s33, 196608
    ds_read_b128 v[24:27], v1 offset:0
    v_cvt_pk_bf16_f32 v163, v18, v19
    v_mfma_f32_16x16x32_bf16 v[176:179], v[36:39], a[212:215], v[176:179]
    s_sub_u32 s34, s33, 1572864
    v_exp_f32 v18, v166
    v_mfma_f32_16x16x32_bf16 v[180:183], v[32:35], a[232:235], v[180:183]
    s_min_u32 s33, s33, s34
    v_add_f32 v6, v6, v16
    v_add_f32 v6, v6, v17
    v_mfma_f32_16x16x32_bf16 v[180:183], v[36:39], a[236:239], v[180:183]
    s_add_u32 s26, s26, 36864
    v_exp_f32 v19, v167
    v_mfma_f32_16x16x32_bf16 v[184:187], v[32:35], v[192:195], v[184:187]
    s_add_u32 s34, s33, 3072
    ds_read_b128 v[28:31], v1 offset:12288
    v_cvt_pk_bf16_f32 v164, v16, v17
    v_mfma_f32_16x16x32_bf16 v[184:187], v[36:39], v[196:199], v[184:187]
    s_sub_u32 s57, s26, 147456
    v_exp_f32 v16, v100
    v_mfma_f32_16x16x32_bf16 v[188:191], v[32:35], v[216:219], v[188:191]
    s_min_u32 s26, s26, s57
    s_add_u32 s37, s37, 196608
    v_fma_f32 v155, v155, v60, v62
    v_mfma_f32_16x16x32_bf16 v[188:191], v[36:39], v[220:223], v[188:191]
    s_waitcnt lgkmcnt(2)
    v_add_f32 v6, v6, v18
    s_add_u32 s80, s80, 196608
    v_mfma_f32_16x16x32_bf16 v[112:115], v[40:43], a[208:211], v[112:115]
    ds_read_b128 v[32:35], v1 offset:768
    v_add_f32 v6, v6, v19
    v_mfma_f32_16x16x32_bf16 v[112:115], v[44:47], a[212:215], v[112:115]
    buffer_load_dwordx4 v[224:227], v9, s[64:67], s33 offen offset:0 nt
    v_mfma_f32_16x16x32_bf16 v[116:119], v[40:43], a[232:235], v[116:119]
    v_exp_f32 v17, v101
    v_mfma_f32_16x16x32_bf16 v[116:119], v[44:47], a[236:239], v[116:119]
    v_cvt_pk_bf16_f32 v165, v18, v19
    v_fma_f32 v159, v159, v61, v63
    v_mfma_f32_16x16x32_bf16 v[120:123], v[40:43], v[192:195], v[120:123]
    ds_read_b128 v[36:39], v1 offset:13056
    v_cvt_pk_bf16_f32 v144, v144, v148
    v_mfma_f32_16x16x32_bf16 v[120:123], v[44:47], v[196:199], v[120:123]
    v_add_u32 v55, 1, v55
    buffer_store_dword v55, v13, s[20:23], 0 offen sc1
    v_mfma_f32_16x16x32_bf16 v[124:127], v[40:43], v[216:219], v[124:127]
    buffer_load_dwordx4 v[228:231], v9, s[64:67], s33 offen offset:1536 nt
    buffer_load_dwordx4 v[232:235], v9, s[64:67], s34 offen offset:0 nt
    buffer_load_dwordx4 v[236:239], v9, s[64:67], s34 offen offset:1536 nt
    v_mfma_f32_16x16x32_bf16 v[124:127], v[44:47], v[220:223], v[124:127]
    s_waitcnt lgkmcnt(2)
    v_exp_f32 v18, v102
    v_add_f32 v6, v6, v16
    v_add_f32 v6, v6, v17
    v_exp_f32 v19, v103
    v_cvt_pk_bf16_f32 v166, v16, v17
    v_cvt_pk_bf16_f32 v148, v145, v149
    v_add_f32 v6, v6, v18
    v_cvt_pk_bf16_f32 v145, v152, v156
    v_add_f32 v6, v6, v19
    v_cvt_pk_bf16_f32 v149, v153, v157
    v_cvt_pk_bf16_f32 v167, v18, v19
    v_cvt_pk_bf16_f32 v152, v146, v150
    v_mfma_f32_16x16x32_bf16 a[0:3], v[64:67], v[24:27], a[0:3]
    s_mov_b32 m0, s56
    ds_read_b128 v[40:43], v1 offset:1536
    v_cvt_pk_bf16_f32 v153, v154, v158
    v_mfma_f32_16x16x32_bf16 a[0:3], v[80:83], v[28:31], a[0:3]
    v_exp_f32 v16, v168
    v_mfma_f32_16x16x32_bf16 a[48:51], v[68:71], v[24:27], a[48:51]
    v_exp_f32 v17, v169
    v_mfma_f32_16x16x32_bf16 a[48:51], v[84:87], v[28:31], a[48:51]
    v_exp_f32 v18, v170
    v_mfma_f32_16x16x32_bf16 a[96:99], v[72:75], v[24:27], a[96:99]
    ds_read_b128 v[44:47], v1 offset:13824
    v_cvt_pk_bf16_f32 v156, v147, v151
    v_mfma_f32_16x16x32_bf16 a[96:99], v[88:91], v[28:31], a[96:99]
    buffer_load_dwordx4 v4, s[4:7], s27 offen offset:0 sc1 lds
    v_mfma_f32_16x16x32_bf16 a[144:147], v[76:79], v[24:27], a[144:147]
    v_add_f32 v7, v7, v16
    v_add_f32 v7, v7, v17
    v_mfma_f32_16x16x32_bf16 a[144:147], v[92:95], v[28:31], a[144:147]
    s_waitcnt lgkmcnt(2)
    v_exp_f32 v19, v171
    v_mfma_f32_16x16x32_bf16 a[4:7], v[64:67], v[32:35], a[4:7]
    ds_read_b128 v[24:27], v1 offset:2304
    v_cvt_pk_bf16_f32 v157, v155, v159
    v_mfma_f32_16x16x32_bf16 a[4:7], v[80:83], v[36:39], a[4:7]
    s_waitcnt vmcnt(24)
    v_cvt_pk_bf16_f32 v168, v16, v17
    v_mfma_f32_16x16x32_bf16 a[52:55], v[68:71], v[32:35], a[52:55]
    v_exp_f32 v16, v104
    v_mfma_f32_16x16x32_bf16 a[52:55], v[84:87], v[36:39], a[52:55]
    v_add_f32 v7, v7, v18
    v_add_f32 v7, v7, v19
    v_mfma_f32_16x16x32_bf16 a[100:103], v[72:75], v[32:35], a[100:103]
    ds_read_b128 v[28:31], v1 offset:14592
    v_cvt_f32_i32 v240, v240
    v_mfma_f32_16x16x32_bf16 a[100:103], v[88:91], v[36:39], a[100:103]
    buffer_load_dwordx4 v4, s[4:7], s27 offen offset:1024 sc1 lds
    v_mfma_f32_16x16x32_bf16 a[148:151], v[76:79], v[32:35], a[148:151]
    v_exp_f32 v17, v105
    v_mfma_f32_16x16x32_bf16 a[148:151], v[92:95], v[36:39], a[148:151]
    s_waitcnt lgkmcnt(2)
    v_cvt_pk_bf16_f32 v169, v18, v19
    v_cvt_f32_i32 v244, v244
    v_mfma_f32_16x16x32_bf16 a[8:11], v[64:67], v[40:43], a[8:11]
    ds_read_b128 v[32:35], v21 offset:0
    v_mfma_f32_16x16x32_bf16 a[8:11], v[80:83], v[44:47], a[8:11]
    v_exp_f32 v18, v106
    v_mfma_f32_16x16x32_bf16 a[56:59], v[68:71], v[40:43], a[56:59]
    v_add_f32 v7, v7, v16
    v_add_f32 v7, v7, v17
    v_mfma_f32_16x16x32_bf16 a[56:59], v[84:87], v[44:47], a[56:59]
    v_exp_f32 v19, v107
    v_mfma_f32_16x16x32_bf16 a[104:107], v[72:75], v[40:43], a[104:107]
    ds_read_b128 v[36:39], v21 offset:12288
    v_cvt_f32_i32 v241, v241
    v_mfma_f32_16x16x32_bf16 a[104:107], v[88:91], v[44:47], a[104:107]
    buffer_load_dwordx4 v4, s[4:7], s27 offen offset:2048 sc1 lds
    v_mfma_f32_16x16x32_bf16 a[152:155], v[76:79], v[40:43], a[152:155]
    v_cvt_pk_bf16_f32 v170, v16, v17
    v_cvt_f32_i32 v245, v245
    v_mfma_f32_16x16x32_bf16 a[152:155], v[92:95], v[44:47], a[152:155]
    s_waitcnt lgkmcnt(2)
    v_exp_f32 v16, v172
    v_mfma_f32_16x16x32_bf16 a[12:15], v[64:67], v[24:27], a[12:15]
    ds_read_b128 v[40:43], v21 offset:768
    v_add_f32 v7, v7, v18
    v_mfma_f32_16x16x32_bf16 a[12:15], v[80:83], v[28:31], a[12:15]
    v_add_f32 v7, v7, v19
    v_fma_f32 v240, v240, v48, v50
    v_mfma_f32_16x16x32_bf16 a[60:63], v[68:71], v[24:27], a[60:63]
    v_exp_f32 v17, v173
    v_mfma_f32_16x16x32_bf16 a[60:63], v[84:87], v[28:31], a[60:63]
    s_add_u32 s27, s27, 24576
    v_cvt_pk_bf16_f32 v171, v18, v19
    v_fma_f32 v244, v244, v49, v51
    v_mfma_f32_16x16x32_bf16 a[108:111], v[72:75], v[24:27], a[108:111]
    ds_read_b128 v[44:47], v21 offset:13056
    v_mfma_f32_16x16x32_bf16 a[108:111], v[88:91], v[28:31], a[108:111]
    v_exp_f32 v18, v174
    v_mfma_f32_16x16x32_bf16 a[156:159], v[76:79], v[24:27], a[156:159]
    s_add_u32 s29, s28, 49152
    v_add_f32 v8, v8, v16
    v_add_f32 v8, v8, v17
    v_mfma_f32_16x16x32_bf16 a[156:159], v[92:95], v[28:31], a[156:159]
    s_waitcnt lgkmcnt(2)
    v_exp_f32 v19, v175
    v_mfma_f32_16x16x32_bf16 a[16:19], v[64:67], v[32:35], a[16:19]
    s_add_u32 s56, s56, 12288
    ds_read_b128 v[24:27], v21 offset:1536
    v_fma_f32 v241, v241, v48, v50
    v_mfma_f32_16x16x32_bf16 a[16:19], v[80:83], v[36:39], a[16:19]
    s_sub_u32 s3, s29, 147456
    v_cvt_pk_bf16_f32 v172, v16, v17
    v_fma_f32 v245, v245, v49, v51
    v_mfma_f32_16x16x32_bf16 a[64:67], v[68:71], v[32:35], a[64:67]
    v_exp_f32 v16, v108
    v_mfma_f32_16x16x32_bf16 a[64:67], v[84:87], v[36:39], a[64:67]
    s_mov_b32 m0, s56
    v_add_f32 v8, v8, v18
    v_add_f32 v8, v8, v19
    v_mfma_f32_16x16x32_bf16 a[112:115], v[72:75], v[32:35], a[112:115]
    ds_read_b128 v[28:31], v21 offset:13824
    v_cvt_f32_i32 v242, v242
    v_mfma_f32_16x16x32_bf16 a[112:115], v[88:91], v[36:39], a[112:115]
    v_exp_f32 v17, v109
    v_mfma_f32_16x16x32_bf16 a[160:163], v[76:79], v[32:35], a[160:163]
    v_cvt_pk_bf16_f32 v173, v18, v19
    v_cvt_f32_i32 v246, v246
    v_mfma_f32_16x16x32_bf16 a[160:163], v[92:95], v[36:39], a[160:163]
    s_waitcnt lgkmcnt(2)
    v_exp_f32 v18, v110
    v_mfma_f32_16x16x32_bf16 a[20:23], v[64:67], v[40:43], a[20:23]
    s_min_u32 s29, s29, s3
    ds_read_b128 v[32:35], v21 offset:2304
    v_add_f32 v8, v8, v16
    v_mfma_f32_16x16x32_bf16 a[20:23], v[80:83], v[44:47], a[20:23]
    buffer_load_dwordx4 v4, s[4:7], s27 offen offset:0 sc1 lds
    v_mfma_f32_16x16x32_bf16 a[68:71], v[68:71], v[40:43], a[68:71]
    v_add_f32 v8, v8, v17
    v_cvt_f32_i32 v243, v243
    v_mfma_f32_16x16x32_bf16 a[68:71], v[84:87], v[44:47], a[68:71]
    v_exp_f32 v19, v111
    v_mfma_f32_16x16x32_bf16 a[116:119], v[72:75], v[40:43], a[116:119]
    ds_read_b128 v[36:39], v21 offset:14592
    v_cvt_pk_bf16_f32 v174, v16, v17
    v_mfma_f32_16x16x32_bf16 a[116:119], v[88:91], v[44:47], a[116:119]
    v_add_f32 v8, v8, v18
    v_cvt_f32_i32 v247, v247
    v_mfma_f32_16x16x32_bf16 a[164:167], v[76:79], v[40:43], a[164:167]
    s_sub_u32 s3, s29, s28
    v_add_f32 v8, v8, v19
    v_cvt_pk_bf16_f32 v175, v18, v19
    v_mfma_f32_16x16x32_bf16 a[164:167], v[92:95], v[44:47], a[164:167]
    s_waitcnt lgkmcnt(2)
    v_exp_f32 v16, v176
    v_mfma_f32_16x16x32_bf16 a[24:27], v[64:67], v[24:27], a[24:27]
    ds_read_b128 v[40:43], v22 offset:0
    v_fma_f32 v242, v242, v48, v50
    v_mfma_f32_16x16x32_bf16 a[24:27], v[80:83], v[28:31], a[24:27]
    v_exp_f32 v17, v177
    v_mfma_f32_16x16x32_bf16 a[72:75], v[68:71], v[24:27], a[72:75]
    v_mfma_f32_16x16x32_bf16 a[72:75], v[84:87], v[28:31], a[72:75]
    buffer_load_dwordx4 v4, s[4:7], s27 offen offset:1024 sc1 lds
    v_mfma_f32_16x16x32_bf16 a[120:123], v[72:75], v[24:27], a[120:123]
    ds_read_b128 v[44:47], v22 offset:12288
    v_fma_f32 v246, v246, v49, v51
    v_mfma_f32_16x16x32_bf16 a[120:123], v[88:91], v[28:31], a[120:123]
    s_mov_b32 s28, s29
    v_exp_f32 v18, v178
    v_mfma_f32_16x16x32_bf16 a[168:171], v[76:79], v[24:27], a[168:171]
    v_add_f32 v5, v5, v16
    v_add_f32 v5, v5, v17
    v_mfma_f32_16x16x32_bf16 a[168:171], v[92:95], v[28:31], a[168:171]
    s_waitcnt lgkmcnt(2)
    v_exp_f32 v19, v179
    v_mfma_f32_16x16x32_bf16 a[28:31], v[64:67], v[32:35], a[28:31]
    ds_read_b128 v[24:27], v22 offset:768
    v_cvt_pk_bf16_f32 v176, v16, v17
    v_mfma_f32_16x16x32_bf16 a[28:31], v[80:83], v[36:39], a[28:31]
    v_fma_f32 v243, v243, v48, v50
    v_fma_f32 v247, v247, v49, v51
    v_mfma_f32_16x16x32_bf16 a[76:79], v[68:71], v[32:35], a[76:79]
    v_exp_f32 v16, v112
    v_mfma_f32_16x16x32_bf16 a[76:79], v[84:87], v[36:39], a[76:79]
    buffer_load_dwordx4 v4, s[4:7], s27 offen offset:2048 sc1 lds
    v_mfma_f32_16x16x32_bf16 a[124:127], v[72:75], v[32:35], a[124:127]
    ds_read_b128 v[28:31], v22 offset:13056
    v_add_f32 v5, v5, v18
    v_mfma_f32_16x16x32_bf16 a[124:127], v[88:91], v[36:39], a[124:127]
    ds_read_b128 v[48:51], v10 offset:0
    v_add_f32 v5, v5, v19
    v_mfma_f32_16x16x32_bf16 a[172:175], v[76:79], v[32:35], a[172:175]
    v_exp_f32 v17, v113
    v_mfma_f32_16x16x32_bf16 a[172:175], v[92:95], v[36:39], a[172:175]
    s_waitcnt lgkmcnt(3)
    v_cvt_pk_bf16_f32 v177, v18, v19
    v_add_u32 v2, s3, v2
    v_mfma_f32_16x16x32_bf16 a[32:35], v[64:67], v[40:43], a[32:35]
    ds_read_b128 v[32:35], v22 offset:1536
    v_cvt_pk_bf16_f32 v146, v240, v244
    v_mfma_f32_16x16x32_bf16 a[32:35], v[80:83], v[44:47], a[32:35]
    v_exp_f32 v18, v114
    v_mfma_f32_16x16x32_bf16 a[80:83], v[68:71], v[40:43], a[80:83]
    v_add_f32 v5, v5, v16
    v_add_f32 v5, v5, v17
    v_mfma_f32_16x16x32_bf16 a[80:83], v[84:87], v[44:47], a[80:83]
    s_add_u32 s27, s27, 24576
    v_exp_f32 v19, v115
    v_mfma_f32_16x16x32_bf16 a[128:131], v[72:75], v[40:43], a[128:131]
    s_add_u32 s56, s56, 36864
    ds_read_b128 v[36:39], v22 offset:13824
    v_cvt_pk_bf16_f32 v178, v16, v17
    v_mfma_f32_16x16x32_bf16 a[128:131], v[88:91], v[44:47], a[128:131]
    v_exp_f32 v16, v180
    v_mfma_f32_16x16x32_bf16 a[176:179], v[76:79], v[40:43], a[176:179]
    v_cvt_pk_bf16_f32 v150, v241, v245
    v_bfe_u32 v53, v4, 4, 6
    v_mfma_f32_16x16x32_bf16 a[176:179], v[92:95], v[44:47], a[176:179]
    s_waitcnt lgkmcnt(3)
    v_add_f32 v5, v5, v18
    v_add_u32 v3, s3, v3
    v_mfma_f32_16x16x32_bf16 a[36:39], v[64:67], v[24:27], a[36:39]
    s_sub_u32 s58, s56, 147456
    ds_read_b128 v[40:43], v22 offset:2304
    v_add_f32 v5, v5, v19
    v_mfma_f32_16x16x32_bf16 a[36:39], v[80:83], v[28:31], a[36:39]
    v_exp_f32 v17, v181
    v_mfma_f32_16x16x32_bf16 a[84:87], v[68:71], v[24:27], a[84:87]
    s_min_u32 s56, s56, s58
    v_cvt_pk_bf16_f32 v154, v242, v246
    v_cvt_pk_bf16_f32 v179, v18, v19
    v_mfma_f32_16x16x32_bf16 a[84:87], v[84:87], v[28:31], a[84:87]
    v_exp_f32 v18, v182
    v_mfma_f32_16x16x32_bf16 a[132:135], v[72:75], v[24:27], a[132:135]
    ds_read_b128 v[44:47], v22 offset:14592
    v_cvt_pk_bf16_f32 v158, v243, v247
    v_mfma_f32_16x16x32_bf16 a[132:135], v[88:91], v[28:31], a[132:135]
    s_waitcnt lgkmcnt(2)
    v_add_f32 v6, v6, v16
    v_lshlrev_b32 v53, 2, v53
    v_mfma_f32_16x16x32_bf16 a[180:183], v[76:79], v[24:27], a[180:183]
    s_waitcnt vmcnt(38)
    v_add_f32 v6, v6, v17
    s_waitcnt vmcnt(23)
    v_mfma_f32_16x16x32_bf16 a[180:183], v[92:95], v[28:31], a[180:183]
    s_barrier
    v_cvt_f32_i32 v248, v248
    v_mfma_f32_16x16x32_bf16 a[40:43], v[64:67], v[32:35], a[40:43]
    ds_read_b128 v[24:27], v2 offset:0
    v_mfma_f32_16x16x32_bf16 a[40:43], v[80:83], v[36:39], a[40:43]
    buffer_load_dword v52, v53, s[20:23], 0 offen sc1
    v_mfma_f32_16x16x32_bf16 a[88:91], v[68:71], v[32:35], a[88:91]
    v_exp_f32 v19, v183
    v_mfma_f32_16x16x32_bf16 a[88:91], v[84:87], v[36:39], a[88:91]
    v_cvt_pk_bf16_f32 v180, v16, v17
    v_cvt_f32_i32 v252, v252
    v_mfma_f32_16x16x32_bf16 a[136:139], v[72:75], v[32:35], a[136:139]
    ds_read_b128 v[28:31], v3 offset:0
    v_mfma_f32_16x16x32_bf16 a[136:139], v[88:91], v[36:39], a[136:139]
    v_exp_f32 v16, v116
    v_mfma_f32_16x16x32_bf16 a[184:187], v[76:79], v[32:35], a[184:187]
    v_add_f32 v6, v6, v18
    v_add_f32 v6, v6, v19
    v_mfma_f32_16x16x32_bf16 a[184:187], v[92:95], v[36:39], a[184:187]
    s_waitcnt lgkmcnt(2)
    v_exp_f32 v17, v117
    v_mfma_f32_16x16x32_bf16 a[44:47], v[64:67], v[40:43], a[44:47]
    ds_read_b128 v[32:35], v2 offset:6144
    v_cvt_pk_bf16_f32 v181, v18, v19
    v_mfma_f32_16x16x32_bf16 a[44:47], v[80:83], v[44:47], a[44:47]
    v_exp_f32 v18, v118
    v_mfma_f32_16x16x32_bf16 a[92:95], v[68:71], v[40:43], a[92:95]
    v_add_f32 v6, v6, v16
    v_cvt_f32_i32 v249, v249
    v_mfma_f32_16x16x32_bf16 a[92:95], v[84:87], v[44:47], a[92:95]
    v_add_f32 v6, v6, v17
    v_cvt_f32_i32 v253, v253
    v_mfma_f32_16x16x32_bf16 a[140:143], v[72:75], v[40:43], a[140:143]
    ds_read_b128 v[36:39], v3 offset:6144
    v_fma_f32 v248, v248, v56, v58
    v_mfma_f32_16x16x32_bf16 a[140:143], v[88:91], v[44:47], a[140:143]
    v_exp_f32 v19, v119
    v_mfma_f32_16x16x32_bf16 a[188:191], v[76:79], v[40:43], a[188:191]
    v_cvt_pk_bf16_f32 v182, v16, v17
    v_add_f32 v6, v6, v18
    v_mfma_f32_16x16x32_bf16 a[188:191], v[92:95], v[44:47], a[188:191]
    s_waitcnt lgkmcnt(2)
    v_add_f32 v6, v6, v19
    v_cvt_pk_bf16_f32 v183, v18, v19
    v_mfma_f32_16x16x32_bf16 v[64:67], v[24:27], a[192:195], v[128:131]
    ds_read_b128 v[40:43], v2 offset:128
    v_fma_f32 v252, v252, v57, v59
    v_mfma_f32_16x16x32_bf16 v[64:67], v[28:31], a[196:199], v[64:67]
    s_waitcnt vmcnt(0)
    v_subrev_u32 v52, s92, v52
    v_cmp_lt_u32 vcc, 15, v52
    v_mfma_f32_16x16x32_bf16 v[68:71], v[24:27], a[216:219], v[132:135]
    v_exp_f32 v16, v184
    v_mfma_f32_16x16x32_bf16 v[68:71], v[28:31], a[220:223], v[68:71]
    v_exp_f32 v17, v185
    v_mfma_f32_16x16x32_bf16 v[72:75], v[24:27], a[240:243], v[136:139]
    s_and_b32 s59, vcc_lo, 0xff
    ds_read_b128 v[44:47], v3 offset:128
    v_fma_f32 v249, v249, v56, v58
    v_mfma_f32_16x16x32_bf16 v[72:75], v[28:31], a[244:247], v[72:75]
    s_cbranch_scc1 L_pollslow2
L_pollok2:
    v_mfma_f32_16x16x32_bf16 v[76:79], v[24:27], v[200:203], v[140:143]
    s_add_u32 s92, s92, 1
    v_exp_f32 v18, v186
    v_mfma_f32_16x16x32_bf16 v[76:79], v[28:31], v[204:207], v[76:79]
    s_waitcnt lgkmcnt(2)
    v_add_f32 v7, v7, v16
    v_add_f32 v7, v7, v17
    v_mfma_f32_16x16x32_bf16 v[96:99], v[32:35], a[192:195], v[128:131]
    s_mov_b32 m0, s26
    ds_read_b128 v[24:27], v2 offset:6272
    v_fma_f32 v253, v253, v57, v59
    v_mfma_f32_16x16x32_bf16 v[96:99], v[36:39], a[196:199], v[96:99]
    buffer_load_dwordx4 v4, s[4:7], s32 offen offset:0 sc1 lds
    v_mfma_f32_16x16x32_bf16 v[100:103], v[32:35], a[216:219], v[132:135]
    v_exp_f32 v19, v187
    v_mfma_f32_16x16x32_bf16 v[100:103], v[36:39], a[220:223], v[100:103]
    v_cvt_pk_bf16_f32 v184, v16, v17
    v_cvt_f32_i32 v250, v250
    v_mfma_f32_16x16x32_bf16 v[104:107], v[32:35], a[240:243], v[136:139]
    ds_read_b128 v[28:31], v3 offset:6272
    v_cvt_f32_i32 v254, v254
    v_mfma_f32_16x16x32_bf16 v[104:107], v[36:39], a[244:247], v[104:107]
    buffer_load_dwordx4 v4, s[4:7], s32 offen offset:1024 sc1 lds
    v_mfma_f32_16x16x32_bf16 v[108:111], v[32:35], v[200:203], v[140:143]
    v_exp_f32 v16, v120
    v_mfma_f32_16x16x32_bf16 v[108:111], v[36:39], v[204:207], v[108:111]
    s_waitcnt lgkmcnt(2)
    v_add_f32 v7, v7, v18
    v_add_f32 v7, v7, v19
    v_mfma_f32_16x16x32_bf16 v[64:67], v[40:43], a[200:203], v[64:67]
    ds_read_b128 v[32:35], v2 offset:256
    v_cvt_f32_i32 v251, v251
    v_mfma_f32_16x16x32_bf16 v[64:67], v[44:47], a[204:207], v[64:67]
    buffer_load_dwordx4 v4, s[4:7], s32 offen offset:2048 sc1 lds
    v_mfma_f32_16x16x32_bf16 v[68:71], v[40:43], a[224:227], v[68:71]
    s_add_u32 s32, s32, 24576
    v_exp_f32 v17, v121
    v_mfma_f32_16x16x32_bf16 v[68:71], v[44:47], a[228:231], v[68:71]
    v_cvt_pk_bf16_f32 v185, v18, v19
    v_mfma_f32_16x16x32_bf16 v[72:75], v[40:43], a[248:251], v[72:75]
    s_add_u32 s26, s26, 12288
    ds_read_b128 v[36:39], v3 offset:256
    v_cvt_f32_i32 v255, v255
    v_mfma_f32_16x16x32_bf16 v[72:75], v[44:47], a[252:255], v[72:75]
    s_mov_b32 m0, s26
    v_exp_f32 v18, v122
    v_mfma_f32_16x16x32_bf16 v[76:79], v[40:43], v[208:211], v[76:79]
    v_add_f32 v7, v7, v16
    v_add_f32 v7, v7, v17
    v_mfma_f32_16x16x32_bf16 v[76:79], v[44:47], v[212:215], v[76:79]
    s_waitcnt lgkmcnt(2)
    v_exp_f32 v19, v123
    v_mfma_f32_16x16x32_bf16 v[96:99], v[24:27], a[200:203], v[96:99]
    ds_read_b128 v[40:43], v2 offset:6400
    v_cvt_pk_bf16_f32 v186, v16, v17
    v_mfma_f32_16x16x32_bf16 v[96:99], v[28:31], a[204:207], v[96:99]
    buffer_load_dwordx4 v4, s[4:7], s32 offen offset:0 sc1 lds
    v_mfma_f32_16x16x32_bf16 v[100:103], v[24:27], a[224:227], v[100:103]
    v_exp_f32 v16, v188
    v_mfma_f32_16x16x32_bf16 v[100:103], v[28:31], a[228:231], v[100:103]
    v_add_f32 v7, v7, v18
    v_add_f32 v7, v7, v19
    v_mfma_f32_16x16x32_bf16 v[104:107], v[24:27], a[248:251], v[104:107]
    ds_read_b128 v[44:47], v3 offset:6400
    v_fma_f32 v250, v250, v56, v58
    v_mfma_f32_16x16x32_bf16 v[104:107], v[28:31], a[252:255], v[104:107]
    buffer_load_dwordx4 v4, s[4:7], s32 offen offset:1024 sc1 lds
    v_mfma_f32_16x16x32_bf16 v[108:111], v[24:27], v[208:211], v[108:111]
    s_add_u32 s29, s30, 49152
    v_exp_f32 v17, v189
    v_mfma_f32_16x16x32_bf16 v[108:111], v[28:31], v[212:215], v[108:111]
    s_waitcnt lgkmcnt(2)
    v_cvt_pk_bf16_f32 v187, v18, v19
    v_fma_f32 v254, v254, v57, v59
    v_mfma_f32_16x16x32_bf16 v[64:67], v[32:35], a[208:211], v[64:67]
    s_sub_u32 s3, s29, 147456
    ds_read_b128 v[24:27], v2 offset:12288
    v_fma_f32 v251, v251, v56, v58
    v_mfma_f32_16x16x32_bf16 v[64:67], v[36:39], a[212:215], v[64:67]
    buffer_load_dwordx4 v4, s[4:7], s32 offen offset:2048 sc1 lds
    v_mfma_f32_16x16x32_bf16 v[68:71], v[32:35], a[232:235], v[68:71]
    v_exp_f32 v18, v190
    v_mfma_f32_16x16x32_bf16 v[68:71], v[36:39], a[236:239], v[68:71]
    s_add_u32 s32, s32, 24576
    v_add_f32 v8, v8, v16
    v_add_f32 v8, v8, v17
    v_mfma_f32_16x16x32_bf16 v[72:75], v[32:35], v[192:195], v[72:75]
    ds_read_b128 v[28:31], v3 offset:12288
    v_fma_f32 v255, v255, v57, v59
    v_mfma_f32_16x16x32_bf16 v[72:75], v[36:39], v[196:199], v[72:75]
    s_add_u32 s26, s26, 36864
    buffer_load_dwordx4 v[240:243], v9, s[64:67], s33 offen offset:384 nt
    v_mfma_f32_16x16x32_bf16 v[76:79], v[32:35], v[216:219], v[76:79]
    s_min_u32 s29, s29, s3
    v_exp_f32 v19, v191
    v_mfma_f32_16x16x32_bf16 v[76:79], v[36:39], v[220:223], v[76:79]
    s_waitcnt lgkmcnt(2)
    v_cvt_pk_bf16_f32 v188, v16, v17
    v_cvt_pk_bf16_f32 v147, v248, v252
    v_mfma_f32_16x16x32_bf16 v[96:99], v[40:43], a[208:211], v[96:99]
    s_sub_u32 s57, s26, 147456
    ds_read_b128 v[32:35], v2 offset:18432
    v_mfma_f32_16x16x32_bf16 v[96:99], v[44:47], a[212:215], v[96:99]
    v_exp_f32 v16, v124
    v_mfma_f32_16x16x32_bf16 v[100:103], v[40:43], a[232:235], v[100:103]
    s_min_u32 s26, s26, s57
    v_add_f32 v8, v8, v18
    v_add_f32 v8, v8, v19
    v_mfma_f32_16x16x32_bf16 v[100:103], v[44:47], a[236:239], v[100:103]
    buffer_load_dwordx4 v[244:247], v9, s[64:67], s33 offen offset:1920 nt
    v_mfma_f32_16x16x32_bf16 v[104:107], v[40:43], v[192:195], v[104:107]
    s_sub_u32 s3, s29, s30
    ds_read_b128 v[36:39], v3 offset:18432
    v_cvt_pk_bf16_f32 v151, v249, v253
    v_mfma_f32_16x16x32_bf16 v[104:107], v[44:47], v[196:199], v[104:107]
    v_exp_f32 v17, v125
    v_mfma_f32_16x16x32_bf16 v[108:111], v[40:43], v[216:219], v[108:111]
    v_cvt_pk_bf16_f32 v189, v18, v19
    v_cvt_pk_bf16_f32 v155, v250, v254
    v_mfma_f32_16x16x32_bf16 v[108:111], v[44:47], v[220:223], v[108:111]
    s_waitcnt lgkmcnt(2)
    v_exp_f32 v18, v126
    v_mfma_f32_16x16x32_bf16 v[80:83], v[24:27], a[192:195], v[128:131]
    ds_read_b128 v[40:43], v2 offset:12416
    v_add_f32 v8, v8, v16
    v_mfma_f32_16x16x32_bf16 v[80:83], v[28:31], a[196:199], v[80:83]
    v_add_f32 v8, v8, v17
    v_cvt_pk_bf16_f32 v159, v251, v255
    v_mfma_f32_16x16x32_bf16 v[84:87], v[24:27], a[216:219], v[132:135]
    v_exp_f32 v19, v127
    v_cvt_pk_bf16_f32 v190, v16, v17
    v_add_f32 v8, v8, v18
    v_add_f32 v8, v8, v19
    v_cvt_pk_bf16_f32 v191, v18, v19
    v_mfma_f32_16x16x32_bf16 v[84:87], v[28:31], a[220:223], v[84:87]
    s_mov_b32 s30, s29
    v_mfma_f32_16x16x32_bf16 v[88:91], v[24:27], a[240:243], v[136:139]
    ds_read_b128 v[44:47], v3 offset:12416
    v_mfma_f32_16x16x32_bf16 v[88:91], v[28:31], a[244:247], v[88:91]
    v_exp_f32 v16, v64
    v_mfma_f32_16x16x32_bf16 v[92:95], v[24:27], v[200:203], v[140:143]
    v_exp_f32 v17, v65
    v_mfma_f32_16x16x32_bf16 v[92:95], v[28:31], v[204:207], v[92:95]
    s_waitcnt lgkmcnt(2)
    v_exp_f32 v18, v66
    v_mfma_f32_16x16x32_bf16 v[112:115], v[32:35], a[192:195], v[128:131]
    ds_read_b128 v[24:27], v2 offset:18560
    v_add_f32 v5, v5, v16
    v_mfma_f32_16x16x32_bf16 v[112:115], v[36:39], a[196:199], v[112:115]
    buffer_store_dwordx4 v[144:147], v20, s[4:7], s81 offen offset:0 sc1
    v_mfma_f32_16x16x32_bf16 v[116:119], v[32:35], a[216:219], v[132:135]
    v_add_f32 v5, v5, v17
    v_add_u32 v1, s3, v1
    v_mfma_f32_16x16x32_bf16 v[116:119], v[36:39], a[220:223], v[116:119]
    v_exp_f32 v19, v67
    v_mfma_f32_16x16x32_bf16 v[120:123], v[32:35], a[240:243], v[136:139]
    ds_read_b128 v[28:31], v3 offset:18560
    v_cvt_pk_bf16_f32 v64, v16, v17
    v_mfma_f32_16x16x32_bf16 v[120:123], v[36:39], a[244:247], v[120:123]
    v_exp_f32 v16, v96
    v_mfma_f32_16x16x32_bf16 v[124:127], v[32:35], v[200:203], v[140:143]
    v_add_f32 v5, v5, v18
    v_add_f32 v5, v5, v19
    v_mfma_f32_16x16x32_bf16 v[124:127], v[36:39], v[204:207], v[124:127]
    s_waitcnt lgkmcnt(2)
    ds_read_b128 v[56:59], v10 offset:384
    v_add_u32 v21, s3, v21
    v_mfma_f32_16x16x32_bf16 v[80:83], v[40:43], a[200:203], v[80:83]
    s_waitcnt vmcnt(18)
    ds_read_b128 v[32:35], v2 offset:12544
    v_mfma_f32_16x16x32_bf16 v[80:83], v[44:47], a[204:207], v[80:83]
    buffer_store_dwordx4 v[148:151], v20, s[4:7], s81 offen offset:768 sc1
    v_mfma_f32_16x16x32_bf16 v[84:87], v[40:43], a[224:227], v[84:87]
    v_exp_f32 v17, v97
    v_mfma_f32_16x16x32_bf16 v[84:87], v[44:47], a[228:231], v[84:87]
    v_cvt_pk_bf16_f32 v65, v18, v19
    v_cvt_f32_i32 v224, v224
    v_mfma_f32_16x16x32_bf16 v[88:91], v[40:43], a[248:251], v[88:91]
    ds_read_b128 v[36:39], v3 offset:12544
    v_add_u32 v22, s3, v22
    v_mfma_f32_16x16x32_bf16 v[88:91], v[44:47], a[252:255], v[88:91]
    v_exp_f32 v18, v98
    v_mfma_f32_16x16x32_bf16 v[92:95], v[40:43], v[208:211], v[92:95]
    v_add_f32 v5, v5, v16
    v_add_f32 v5, v5, v17
    v_mfma_f32_16x16x32_bf16 v[92:95], v[44:47], v[212:215], v[92:95]
    s_waitcnt lgkmcnt(3)
    v_exp_f32 v19, v99
    v_mfma_f32_16x16x32_bf16 v[112:115], v[24:27], a[200:203], v[112:115]
    ds_read_b128 v[40:43], v2 offset:18688
    v_cvt_pk_bf16_f32 v66, v16, v17
    v_mfma_f32_16x16x32_bf16 v[112:115], v[28:31], a[204:207], v[112:115]
    buffer_store_dwordx4 v[152:155], v20, s[4:7], s81 offen offset:1536 sc1
    v_mfma_f32_16x16x32_bf16 v[116:119], v[24:27], a[224:227], v[116:119]
    v_exp_f32 v16, v68
    v_mfma_f32_16x16x32_bf16 v[116:119], v[28:31], a[228:231], v[116:119]
    v_add_f32 v5, v5, v18
    v_add_f32 v5, v5, v19
    v_mfma_f32_16x16x32_bf16 v[120:123], v[24:27], a[248:251], v[120:123]
    ds_read_b128 v[44:47], v3 offset:18688
    v_cvt_f32_i32 v225, v225
    v_mfma_f32_16x16x32_bf16 v[120:123], v[28:31], a[252:255], v[120:123]
    s_waitcnt lgkmcnt(2)
    v_exp_f32 v17, v69
    v_mfma_f32_16x16x32_bf16 v[124:127], v[24:27], v[208:211], v[124:127]
    s_waitcnt vmcnt(29)
    v_cvt_pk_bf16_f32 v67, v18, v19
    v_cvt_f32_i32 v228, v228
    v_mfma_f32_16x16x32_bf16 v[124:127], v[28:31], v[212:215], v[124:127]
    s_barrier
    ds_read_b128 v[60:63], v10 offset:768
    v_mfma_f32_16x16x32_bf16 v[80:83], v[32:35], a[208:211], v[80:83]
    ds_read_b128 v[24:27], v1 offset:0
    v_cvt_f32_i32 v229, v229
    v_mfma_f32_16x16x32_bf16 v[80:83], v[36:39], a[212:215], v[80:83]
    v_exp_f32 v18, v70
    v_mfma_f32_16x16x32_bf16 v[84:87], v[32:35], a[232:235], v[84:87]
    v_add_f32 v6, v6, v16
    v_add_f32 v6, v6, v17
    v_mfma_f32_16x16x32_bf16 v[84:87], v[36:39], a[236:239], v[84:87]
    v_exp_f32 v19, v71
    v_mfma_f32_16x16x32_bf16 v[88:91], v[32:35], v[192:195], v[88:91]
    ds_read_b128 v[28:31], v1 offset:12288
    v_cvt_pk_bf16_f32 v68, v16, v17
    v_mfma_f32_16x16x32_bf16 v[88:91], v[36:39], v[196:199], v[88:91]
    buffer_store_dwordx4 v[156:159], v20, s[4:7], s81 offen offset:2304 sc1
    v_mfma_f32_16x16x32_bf16 v[92:95], v[32:35], v[216:219], v[92:95]
    v_exp_f32 v16, v100
    v_mfma_f32_16x16x32_bf16 v[92:95], v[36:39], v[220:223], v[92:95]
    s_waitcnt lgkmcnt(3)
    v_add_f32 v6, v6, v18
    v_add_f32 v6, v6, v19
    v_mfma_f32_16x16x32_bf16 v[112:115], v[40:43], a[208:211], v[112:115]
    ds_read_b128 v[32:35], v1 offset:768
    v_fma_f32 v224, v224, v48, v50
    v_mfma_f32_16x16x32_bf16 v[112:115], v[44:47], a[212:215], v[112:115]
    v_exp_f32 v17, v101
    v_mfma_f32_16x16x32_bf16 v[116:119], v[40:43], a[232:235], v[116:119]
    v_cvt_pk_bf16_f32 v69, v18, v19
    v_fma_f32 v225, v225, v49, v51
    v_mfma_f32_16x16x32_bf16 v[116:119], v[44:47], a[236:239], v[116:119]
    v_exp_f32 v18, v102
    v_mfma_f32_16x16x32_bf16 v[120:123], v[40:43], v[192:195], v[120:123]
    ds_read_b128 v[36:39], v1 offset:13056
    v_add_f32 v6, v6, v16
    v_mfma_f32_16x16x32_bf16 v[120:123], v[44:47], v[196:199], v[120:123]
    v_add_f32 v6, v6, v17
    v_fma_f32 v228, v228, v48, v50
    v_mfma_f32_16x16x32_bf16 v[124:127], v[40:43], v[216:219], v[124:127]
    v_exp_f32 v19, v103
    v_mfma_f32_16x16x32_bf16 v[124:127], v[44:47], v[220:223], v[124:127]
    s_waitcnt lgkmcnt(2)
    v_cvt_pk_bf16_f32 v70, v16, v17
    v_add_f32 v6, v6, v18
    v_fma_f32 v229, v229, v49, v51
    v_add_f32 v6, v6, v19
    v_cvt_pk_bf16_f32 v224, v224, v225
    v_cvt_pk_bf16_f32 v71, v18, v19
    v_cvt_pk_bf16_f32 v228, v228, v229
    v_mfma_f32_16x16x32_bf16 a[0:3], v[160:163], v[24:27], a[0:3]
    ds_read_b128 v[40:43], v1 offset:1536
    v_cvt_f32_i32 v226, v226
    v_mfma_f32_16x16x32_bf16 a[0:3], v[176:179], v[28:31], a[0:3]
    buffer_load_dwordx4 v[248:251], v9, s[64:67], s34 offen offset:384 nt
    v_mfma_f32_16x16x32_bf16 a[48:51], v[164:167], v[24:27], a[48:51]
    v_exp_f32 v16, v72
    v_mfma_f32_16x16x32_bf16 a[48:51], v[180:183], v[28:31], a[48:51]
    v_exp_f32 v17, v73
    v_mfma_f32_16x16x32_bf16 a[96:99], v[168:171], v[24:27], a[96:99]
    ds_read_b128 v[44:47], v1 offset:13824
    v_cvt_f32_i32 v227, v227
    v_mfma_f32_16x16x32_bf16 a[96:99], v[184:187], v[28:31], a[96:99]
    v_exp_f32 v18, v74
    v_mfma_f32_16x16x32_bf16 a[144:147], v[172:175], v[24:27], a[144:147]
    v_add_f32 v7, v7, v16
    v_add_f32 v7, v7, v17
    v_mfma_f32_16x16x32_bf16 a[144:147], v[188:191], v[28:31], a[144:147]
    s_waitcnt lgkmcnt(2)
    buffer_load_dwordx4 v[252:255], v9, s[64:67], s34 offen offset:1920 nt
    v_mfma_f32_16x16x32_bf16 a[4:7], v[160:163], v[32:35], a[4:7]
    ds_read_b128 v[24:27], v1 offset:2304
    v_cvt_f32_i32 v230, v230
    v_mfma_f32_16x16x32_bf16 a[4:7], v[176:179], v[36:39], a[4:7]
    v_exp_f32 v19, v75
    v_mfma_f32_16x16x32_bf16 a[52:55], v[164:167], v[32:35], a[52:55]
    v_cvt_pk_bf16_f32 v72, v16, v17
    v_cvt_f32_i32 v231, v231
    v_mfma_f32_16x16x32_bf16 a[52:55], v[180:183], v[36:39], a[52:55]
    v_exp_f32 v16, v104
    v_mfma_f32_16x16x32_bf16 a[100:103], v[168:171], v[32:35], a[100:103]
    ds_read_b128 v[28:31], v1 offset:14592
    v_add_f32 v7, v7, v18
    v_mfma_f32_16x16x32_bf16 a[100:103], v[184:187], v[36:39], a[100:103]
    v_add_f32 v7, v7, v19
    v_fma_f32 v226, v226, v56, v58
    v_mfma_f32_16x16x32_bf16 a[148:151], v[172:175], v[32:35], a[148:151]
    v_exp_f32 v17, v105
    v_mfma_f32_16x16x32_bf16 a[148:151], v[188:191], v[36:39], a[148:151]
    s_waitcnt lgkmcnt(2)
    s_add_u32 s35, s35, 196608
    v_cvt_pk_bf16_f32 v73, v18, v19
    v_mfma_f32_16x16x32_bf16 a[8:11], v[160:163], v[40:43], a[8:11]
    s_sub_u32 s36, s35, 1572864
    ds_read_b128 v[32:35], v21 offset:0
    v_mfma_f32_16x16x32_bf16 a[8:11], v[176:179], v[44:47], a[8:11]
    s_min_u32 s35, s35, s36
    v_exp_f32 v18, v106
    v_mfma_f32_16x16x32_bf16 a[56:59], v[164:167], v[40:43], a[56:59]
    v_add_f32 v7, v7, v16
    v_add_f32 v7, v7, v17
    v_mfma_f32_16x16x32_bf16 a[56:59], v[180:183], v[44:47], a[56:59]
    s_add_u32 s36, s35, 3072
    v_exp_f32 v19, v107
    v_mfma_f32_16x16x32_bf16 a[104:107], v[168:171], v[40:43], a[104:107]
    ds_read_b128 v[36:39], v21 offset:12288
    v_cvt_pk_bf16_f32 v74, v16, v17
    v_mfma_f32_16x16x32_bf16 a[104:107], v[184:187], v[44:47], a[104:107]
    s_add_u32 s81, s81, 196608
    v_fma_f32 v227, v227, v57, v59
    v_fma_f32 v230, v230, v56, v58
    v_mfma_f32_16x16x32_bf16 a[152:155], v[172:175], v[40:43], a[152:155]
    v_exp_f32 v16, v76
    v_mfma_f32_16x16x32_bf16 a[152:155], v[188:191], v[44:47], a[152:155]
    s_waitcnt lgkmcnt(2)
    v_add_f32 v7, v7, v18
    v_add_f32 v7, v7, v19
    v_mfma_f32_16x16x32_bf16 a[12:15], v[160:163], v[24:27], a[12:15]
    ds_read_b128 v[40:43], v21 offset:768
    v_fma_f32 v231, v231, v57, v59
    v_mfma_f32_16x16x32_bf16 a[12:15], v[176:179], v[28:31], a[12:15]
    buffer_load_dwordx4 v[144:147], v12, s[68:71], s35 offen offset:0 nt
    v_mfma_f32_16x16x32_bf16 a[60:63], v[164:167], v[24:27], a[60:63]
    v_exp_f32 v17, v77
    v_mfma_f32_16x16x32_bf16 a[60:63], v[180:183], v[28:31], a[60:63]
    v_cvt_pk_bf16_f32 v75, v18, v19
    v_mfma_f32_16x16x32_bf16 a[108:111], v[168:171], v[24:27], a[108:111]
    ds_read_b128 v[44:47], v21 offset:13056
    v_cvt_pk_bf16_f32 v225, v226, v227
    v_mfma_f32_16x16x32_bf16 a[108:111], v[184:187], v[28:31], a[108:111]
    buffer_load_dwordx4 v[148:151], v12, s[68:71], s35 offen offset:768 nt
    v_mfma_f32_16x16x32_bf16 a[156:159], v[172:175], v[24:27], a[156:159]
    s_add_u32 s29, s28, 49152
    v_exp_f32 v18, v78
    v_mfma_f32_16x16x32_bf16 a[156:159], v[188:191], v[28:31], a[156:159]
    s_waitcnt lgkmcnt(2)
    v_add_f32 v8, v8, v16
    v_add_f32 v8, v8, v17
    v_mfma_f32_16x16x32_bf16 a[16:19], v[160:163], v[32:35], a[16:19]
    ds_read_b128 v[24:27], v21 offset:1536
    v_cvt_pk_bf16_f32 v229, v230, v231
    v_mfma_f32_16x16x32_bf16 a[16:19], v[176:179], v[36:39], a[16:19]
    s_sub_u32 s3, s29, 147456
    buffer_load_dwordx4 v[152:155], v12, s[68:71], s35 offen offset:1536 nt
    v_mfma_f32_16x16x32_bf16 a[64:67], v[164:167], v[32:35], a[64:67]
    v_exp_f32 v19, v79
    v_mfma_f32_16x16x32_bf16 a[64:67], v[180:183], v[36:39], a[64:67]
    v_cvt_pk_bf16_f32 v76, v16, v17
    v_mfma_f32_16x16x32_bf16 a[112:115], v[168:171], v[32:35], a[112:115]
    s_waitcnt vmcnt(24)
    ds_read_b128 v[28:31], v21 offset:13824
    v_mfma_f32_16x16x32_bf16 a[112:115], v[184:187], v[36:39], a[112:115]
    buffer_load_dwordx4 v[156:159], v12, s[68:71], s35 offen offset:2304 nt
    v_mfma_f32_16x16x32_bf16 a[160:163], v[172:175], v[32:35], a[160:163]
    v_exp_f32 v16, v108
    v_mfma_f32_16x16x32_bf16 a[160:163], v[188:191], v[36:39], a[160:163]
    s_waitcnt lgkmcnt(2)
    v_add_f32 v8, v8, v18
    v_add_f32 v8, v8, v19
    v_mfma_f32_16x16x32_bf16 a[20:23], v[160:163], v[40:43], a[20:23]
    s_mov_b32 m0, s56
    ds_read_b128 v[32:35], v21 offset:2304
    v_cvt_f32_i32 v232, v232
    v_mfma_f32_16x16x32_bf16 a[20:23], v[176:179], v[44:47], a[20:23]
    s_min_u32 s29, s29, s3
    v_exp_f32 v17, v109
    v_mfma_f32_16x16x32_bf16 a[68:71], v[164:167], v[40:43], a[68:71]
    v_cvt_pk_bf16_f32 v77, v18, v19
    v_mfma_f32_16x16x32_bf16 a[68:71], v[180:183], v[44:47], a[68:71]
    buffer_load_dwordx4 v4, s[4:7], s27 offen offset:0 sc1 lds
    v_mfma_f32_16x16x32_bf16 a[116:119], v[168:171], v[40:43], a[116:119]
    ds_read_b128 v[36:39], v21 offset:14592
    v_cvt_f32_i32 v233, v233
    v_mfma_f32_16x16x32_bf16 a[116:119], v[184:187], v[44:47], a[116:119]
    v_exp_f32 v18, v110
    v_mfma_f32_16x16x32_bf16 a[164:167], v[172:175], v[40:43], a[164:167]
    s_sub_u32 s3, s29, s28
    v_add_f32 v8, v8, v16
    v_add_f32 v8, v8, v17
    v_mfma_f32_16x16x32_bf16 a[164:167], v[188:191], v[44:47], a[164:167]
    s_waitcnt lgkmcnt(2)
    buffer_load_dwordx4 v4, s[4:7], s27 offen offset:1024 sc1 lds
    v_mfma_f32_16x16x32_bf16 a[24:27], v[160:163], v[24:27], a[24:27]
    ds_read_b128 v[40:43], v22 offset:0
    v_cvt_f32_i32 v236, v236
    v_mfma_f32_16x16x32_bf16 a[24:27], v[176:179], v[28:31], a[24:27]
    v_exp_f32 v19, v111
    v_cvt_pk_bf16_f32 v78, v16, v17
    v_mfma_f32_16x16x32_bf16 a[72:75], v[164:167], v[24:27], a[72:75]
    v_add_f32 v8, v8, v18
    v_add_f32 v8, v8, v19
    v_mfma_f32_16x16x32_bf16 a[72:75], v[180:183], v[28:31], a[72:75]
    buffer_load_dwordx4 v4, s[4:7], s27 offen offset:2048 sc1 lds
    v_mfma_f32_16x16x32_bf16 a[120:123], v[168:171], v[24:27], a[120:123]
    ds_read_b128 v[44:47], v22 offset:12288
    v_cvt_pk_bf16_f32 v79, v18, v19
    v_mfma_f32_16x16x32_bf16 a[120:123], v[184:187], v[28:31], a[120:123]
    s_mov_b32 s28, s29
    v_exp_f32 v16, v80
    v_mfma_f32_16x16x32_bf16 a[168:171], v[172:175], v[24:27], a[168:171]
    s_add_u32 s27, s27, 24576
    v_exp_f32 v17, v81
    v_mfma_f32_16x16x32_bf16 a[168:171], v[188:191], v[28:31], a[168:171]
    s_waitcnt lgkmcnt(2)
    v_exp_f32 v18, v82
    v_mfma_f32_16x16x32_bf16 a[28:31], v[160:163], v[32:35], a[28:31]
    s_add_u32 s56, s56, 12288
    ds_read_b128 v[24:27], v22 offset:768
    v_add_f32 v5, v5, v16
    v_mfma_f32_16x16x32_bf16 a[28:31], v[176:179], v[36:39], a[28:31]
    v_add_f32 v5, v5, v17
    v_cvt_f32_i32 v237, v237
    v_mfma_f32_16x16x32_bf16 a[76:79], v[164:167], v[32:35], a[76:79]
    s_mov_b32 m0, s56
    v_exp_f32 v19, v83
    v_mfma_f32_16x16x32_bf16 a[76:79], v[180:183], v[36:39], a[76:79]
    v_cvt_pk_bf16_f32 v80, v16, v17
    v_fma_f32 v232, v232, v48, v50
    v_mfma_f32_16x16x32_bf16 a[124:127], v[168:171], v[32:35], a[124:127]
    ds_read_b128 v[28:31], v22 offset:13056
    v_fma_f32 v233, v233, v49, v51
    v_mfma_f32_16x16x32_bf16 a[124:127], v[184:187], v[36:39], a[124:127]
    buffer_load_dwordx4 v4, s[4:7], s27 offen offset:0 sc1 lds
    v_mfma_f32_16x16x32_bf16 a[172:175], v[172:175], v[32:35], a[172:175]
    v_exp_f32 v16, v112
    v_mfma_f32_16x16x32_bf16 a[172:175], v[188:191], v[36:39], a[172:175]
    s_waitcnt lgkmcnt(2)
    v_add_f32 v5, v5, v18
    v_add_f32 v5, v5, v19
    v_mfma_f32_16x16x32_bf16 a[32:35], v[160:163], v[40:43], a[32:35]
    ds_read_b128 v[32:35], v22 offset:1536
    v_add_u32 v2, s3, v2
    v_mfma_f32_16x16x32_bf16 a[32:35], v[176:179], v[44:47], a[32:35]
    v_exp_f32 v17, v113
    v_mfma_f32_16x16x32_bf16 a[80:83], v[164:167], v[40:43], a[80:83]
    v_cvt_pk_bf16_f32 v81, v18, v19
    v_fma_f32 v236, v236, v48, v50
    v_mfma_f32_16x16x32_bf16 a[80:83], v[180:183], v[44:47], a[80:83]
    buffer_load_dwordx4 v4, s[4:7], s27 offen offset:1024 sc1 lds
    v_mfma_f32_16x16x32_bf16 a[128:131], v[168:171], v[40:43], a[128:131]
    ds_read_b128 v[36:39], v22 offset:13824
    v_fma_f32 v237, v237, v49, v51
    v_mfma_f32_16x16x32_bf16 a[128:131], v[184:187], v[44:47], a[128:131]
    v_exp_f32 v18, v114
    v_mfma_f32_16x16x32_bf16 a[176:179], v[172:175], v[40:43], a[176:179]
    v_add_f32 v5, v5, v16
    v_add_f32 v5, v5, v17
    v_mfma_f32_16x16x32_bf16 a[176:179], v[188:191], v[44:47], a[176:179]
    s_waitcnt lgkmcnt(2)
    buffer_load_dwordx4 v4, s[4:7], s27 offen offset:2048 sc1 lds
    v_mfma_f32_16x16x32_bf16 a[36:39], v[160:163], v[24:27], a[36:39]
    ds_read_b128 v[40:43], v22 offset:2304
    v_add_u32 v3, s3, v3
    v_mfma_f32_16x16x32_bf16 a[36:39], v[176:179], v[28:31], a[36:39]
    v_exp_f32 v19, v115
    v_cvt_pk_bf16_f32 v82, v16, v17
    v_mfma_f32_16x16x32_bf16 a[84:87], v[164:167], v[24:27], a[84:87]
    v_exp_f32 v16, v84
    v_mfma_f32_16x16x32_bf16 a[84:87], v[180:183], v[28:31], a[84:87]
    s_add_u32 s27, s27, 24576
    v_add_f32 v5, v5, v18
    v_add_f32 v5, v5, v19
    v_mfma_f32_16x16x32_bf16 a[132:135], v[168:171], v[24:27], a[132:135]
    s_add_u32 s56, s56, 36864
    ds_read_b128 v[44:47], v22 offset:14592
    v_cvt_pk_bf16_f32 v232, v232, v233
    v_mfma_f32_16x16x32_bf16 a[132:135], v[184:187], v[28:31], a[132:135]
    s_waitcnt lgkmcnt(2)
    v_exp_f32 v17, v85
    v_mfma_f32_16x16x32_bf16 a[180:183], v[172:175], v[24:27], a[180:183]
    s_waitcnt vmcnt(12)
    v_cvt_pk_bf16_f32 v83, v18, v19
    v_cvt_pk_bf16_f32 v236, v236, v237
    v_mfma_f32_16x16x32_bf16 a[180:183], v[188:191], v[28:31], a[180:183]
    s_barrier
    v_cvt_f32_i32 v234, v234
    v_mfma_f32_16x16x32_bf16 a[40:43], v[160:163], v[32:35], a[40:43]
    s_sub_u32 s58, s56, 147456
    ds_read_b128 v[24:27], v2 offset:0
    v_add_u32 v55, 1, v55
    v_mfma_f32_16x16x32_bf16 a[40:43], v[176:179], v[36:39], a[40:43]
    v_exp_f32 v18, v86
    v_mfma_f32_16x16x32_bf16 a[88:91], v[164:167], v[32:35], a[88:91]
    s_min_u32 s56, s56, s58
    v_add_f32 v6, v6, v16
    v_add_f32 v6, v6, v17
    v_mfma_f32_16x16x32_bf16 a[88:91], v[180:183], v[36:39], a[88:91]
    v_exp_f32 v19, v87
    v_mfma_f32_16x16x32_bf16 a[136:139], v[168:171], v[32:35], a[136:139]
    ds_read_b128 v[28:31], v3 offset:0
    v_cvt_pk_bf16_f32 v84, v16, v17
    v_mfma_f32_16x16x32_bf16 a[136:139], v[184:187], v[36:39], a[136:139]
    buffer_store_dword v55, v13, s[20:23], 0 offen sc1
    v_mfma_f32_16x16x32_bf16 a[184:187], v[172:175], v[32:35], a[184:187]
    v_exp_f32 v16, v116
    v_mfma_f32_16x16x32_bf16 a[184:187], v[188:191], v[36:39], a[184:187]
    s_waitcnt lgkmcnt(2)
    v_add_f32 v6, v6, v18
    v_add_f32 v6, v6, v19
    v_mfma_f32_16x16x32_bf16 a[44:47], v[160:163], v[40:43], a[44:47]
    ds_read_b128 v[32:35], v2 offset:6144
    v_cvt_f32_i32 v235, v235
    v_mfma_f32_16x16x32_bf16 a[44:47], v[176:179], v[44:47], a[44:47]
    v_exp_f32 v17, v117
    v_mfma_f32_16x16x32_bf16 a[92:95], v[164:167], v[40:43], a[92:95]
    v_cvt_pk_bf16_f32 v85, v18, v19
    v_cvt_f32_i32 v238, v238
    v_mfma_f32_16x16x32_bf16 a[92:95], v[180:183], v[44:47], a[92:95]
    v_exp_f32 v18, v118
    v_mfma_f32_16x16x32_bf16 a[140:143], v[168:171], v[40:43], a[140:143]
    ds_read_b128 v[36:39], v3 offset:6144
    v_add_f32 v6, v6, v16
    v_mfma_f32_16x16x32_bf16 a[140:143], v[184:187], v[44:47], a[140:143]
    v_add_f32 v6, v6, v17
    v_cvt_f32_i32 v239, v239
    v_mfma_f32_16x16x32_bf16 a[188:191], v[172:175], v[40:43], a[188:191]
    v_exp_f32 v19, v119
    v_mfma_f32_16x16x32_bf16 a[188:191], v[188:191], v[44:47], a[188:191]
    s_waitcnt lgkmcnt(2)
    v_cvt_pk_bf16_f32 v86, v16, v17
    v_add_f32 v6, v6, v18
    v_add_f32 v6, v6, v19
    v_cvt_pk_bf16_f32 v87, v18, v19
    v_mfma_f32_16x16x32_bf16 v[160:163], v[24:27], a[192:195], v[128:131]
    s_mov_b32 m0, s26
    ds_read_b128 v[40:43], v2 offset:128
    v_fma_f32 v234, v234, v56, v58
    v_mfma_f32_16x16x32_bf16 v[160:163], v[28:31], a[196:199], v[160:163]
    v_exp_f32 v16, v88
    v_mfma_f32_16x16x32_bf16 v[164:167], v[24:27], a[216:219], v[132:135]
    v_exp_f32 v17, v89
    v_mfma_f32_16x16x32_bf16 v[164:167], v[28:31], a[220:223], v[164:167]
    v_exp_f32 v18, v90
    v_mfma_f32_16x16x32_bf16 v[168:171], v[24:27], a[240:243], v[136:139]
    ds_read_b128 v[44:47], v3 offset:128
    v_fma_f32 v235, v235, v57, v59
    v_mfma_f32_16x16x32_bf16 v[168:171], v[28:31], a[244:247], v[168:171]
    buffer_load_dwordx4 v4, s[4:7], s32 offen offset:0 sc1 lds
    v_mfma_f32_16x16x32_bf16 v[172:175], v[24:27], v[200:203], v[140:143]
    v_add_f32 v7, v7, v16
    v_add_f32 v7, v7, v17
    v_mfma_f32_16x16x32_bf16 v[172:175], v[28:31], v[204:207], v[172:175]
    s_waitcnt lgkmcnt(2)
    v_exp_f32 v19, v91
    v_mfma_f32_16x16x32_bf16 v[96:99], v[32:35], a[192:195], v[128:131]
    ds_read_b128 v[24:27], v2 offset:6272
    v_fma_f32 v238, v238, v56, v58
    v_mfma_f32_16x16x32_bf16 v[96:99], v[36:39], a[196:199], v[96:99]
    v_cvt_pk_bf16_f32 v88, v16, v17
    v_fma_f32 v239, v239, v57, v59
    v_mfma_f32_16x16x32_bf16 v[100:103], v[32:35], a[216:219], v[132:135]
    v_exp_f32 v16, v120
    v_mfma_f32_16x16x32_bf16 v[100:103], v[36:39], a[220:223], v[100:103]
    v_add_f32 v7, v7, v18
    v_mfma_f32_16x16x32_bf16 v[104:107], v[32:35], a[240:243], v[136:139]
    ds_read_b128 v[28:31], v3 offset:6272
    v_add_f32 v7, v7, v19
    v_mfma_f32_16x16x32_bf16 v[104:107], v[36:39], a[244:247], v[104:107]
    buffer_load_dwordx4 v4, s[4:7], s32 offen offset:1024 sc1 lds
    v_mfma_f32_16x16x32_bf16 v[108:111], v[32:35], v[200:203], v[140:143]
    v_exp_f32 v17, v121
    v_mfma_f32_16x16x32_bf16 v[108:111], v[36:39], v[204:207], v[108:111]
    s_waitcnt lgkmcnt(2)
    v_cvt_pk_bf16_f32 v89, v18, v19
    v_cvt_pk_bf16_f32 v233, v234, v235
    v_mfma_f32_16x16x32_bf16 v[160:163], v[40:43], a[200:203], v[160:163]
    ds_read_b128 v[32:35], v2 offset:256
    v_cvt_pk_bf16_f32 v237, v238, v239
    v_mfma_f32_16x16x32_bf16 v[160:163], v[44:47], a[204:207], v[160:163]
    v_exp_f32 v18, v122
    v_mfma_f32_16x16x32_bf16 v[164:167], v[40:43], a[224:227], v[164:167]
    v_add_f32 v7, v7, v16
    v_add_f32 v7, v7, v17
    v_mfma_f32_16x16x32_bf16 v[164:167], v[44:47], a[228:231], v[164:167]
    v_mfma_f32_16x16x32_bf16 v[168:171], v[40:43], a[248:251], v[168:171]
    ds_read_b128 v[36:39], v3 offset:256
    v_mfma_f32_16x16x32_bf16 v[168:171], v[44:47], a[252:255], v[168:171]
    buffer_load_dwordx4 v4, s[4:7], s32 offen offset:2048 sc1 lds
    v_mfma_f32_16x16x32_bf16 v[172:175], v[40:43], v[208:211], v[172:175]
    v_exp_f32 v19, v123
    v_mfma_f32_16x16x32_bf16 v[172:175], v[44:47], v[212:215], v[172:175]
    s_waitcnt lgkmcnt(2)
    ds_read_b128 v[48:51], v10 offset:1152
    v_cvt_pk_bf16_f32 v90, v16, v17
    v_mfma_f32_16x16x32_bf16 v[96:99], v[24:27], a[200:203], v[96:99]
    s_waitcnt vmcnt(20)
    ds_read_b128 v[40:43], v2 offset:6400
    v_mfma_f32_16x16x32_bf16 v[96:99], v[28:31], a[204:207], v[96:99]
    v_exp_f32 v16, v92
    v_mfma_f32_16x16x32_bf16 v[100:103], v[24:27], a[224:227], v[100:103]
    v_add_f32 v7, v7, v18
    v_add_f32 v7, v7, v19
    v_mfma_f32_16x16x32_bf16 v[100:103], v[28:31], a[228:231], v[100:103]
    s_add_u32 s32, s32, 24576
    v_exp_f32 v17, v93
    v_mfma_f32_16x16x32_bf16 v[104:107], v[24:27], a[248:251], v[104:107]
    ds_read_b128 v[44:47], v3 offset:6400
    v_cvt_pk_bf16_f32 v91, v18, v19
    v_mfma_f32_16x16x32_bf16 v[104:107], v[28:31], a[252:255], v[104:107]
    v_exp_f32 v18, v94
    v_mfma_f32_16x16x32_bf16 v[108:111], v[24:27], v[208:211], v[108:111]
    s_add_u32 s29, s30, 49152
    v_cvt_f32_i32 v240, v240
    v_add_f32 v8, v8, v16
    v_mfma_f32_16x16x32_bf16 v[108:111], v[28:31], v[212:215], v[108:111]
    s_waitcnt lgkmcnt(3)
    v_add_f32 v8, v8, v17
    v_cvt_f32_i32 v241, v241
    v_mfma_f32_16x16x32_bf16 v[160:163], v[32:35], a[208:211], v[160:163]
    s_add_u32 s26, s26, 12288
    ds_read_b128 v[24:27], v2 offset:12288
    s_sub_u32 s3, s29, 147456
    v_mfma_f32_16x16x32_bf16 v[160:163], v[36:39], a[212:215], v[160:163]
    v_exp_f32 v19, v95
    v_mfma_f32_16x16x32_bf16 v[164:167], v[32:35], a[232:235], v[164:167]
    v_cvt_pk_bf16_f32 v92, v16, v17
    v_cvt_f32_i32 v244, v244
    v_mfma_f32_16x16x32_bf16 v[164:167], v[36:39], a[236:239], v[164:167]
    s_mov_b32 m0, s26
    v_exp_f32 v16, v124
    v_mfma_f32_16x16x32_bf16 v[168:171], v[32:35], v[192:195], v[168:171]
    ds_read_b128 v[28:31], v3 offset:12288
    v_add_f32 v8, v8, v18
    v_mfma_f32_16x16x32_bf16 v[168:171], v[36:39], v[196:199], v[168:171]
    v_add_f32 v8, v8, v19
    v_mfma_f32_16x16x32_bf16 v[172:175], v[32:35], v[216:219], v[172:175]
    s_min_u32 s29, s29, s3
    ds_read_b128 v[56:59], v23 offset:0
    v_mfma_f32_16x16x32_bf16 v[172:175], v[36:39], v[220:223], v[172:175]
    s_waitcnt lgkmcnt(3)
    v_exp_f32 v17, v125
    v_mfma_f32_16x16x32_bf16 v[96:99], v[40:43], a[208:211], v[96:99]
    ds_read_b128 v[32:35], v2 offset:18432
    v_cvt_pk_bf16_f32 v93, v18, v19
    v_mfma_f32_16x16x32_bf16 v[96:99], v[44:47], a[212:215], v[96:99]
    buffer_load_dwordx4 v4, s[4:7], s32 offen offset:0 sc1 lds
    v_mfma_f32_16x16x32_bf16 v[100:103], v[40:43], a[232:235], v[100:103]
    v_exp_f32 v18, v126
    v_mfma_f32_16x16x32_bf16 v[100:103], v[44:47], a[236:239], v[100:103]
    v_add_f32 v8, v8, v16
    v_add_u32 v10, 1792, v10
    v_mfma_f32_16x16x32_bf16 v[104:107], v[40:43], v[192:195], v[104:107]
    s_sub_u32 s3, s29, s30
    ds_read_b128 v[36:39], v3 offset:18432
    v_add_f32 v8, v8, v17
    v_mfma_f32_16x16x32_bf16 v[104:107], v[44:47], v[196:199], v[104:107]
    v_exp_f32 v19, v127
    v_mfma_f32_16x16x32_bf16 v[108:111], v[40:43], v[216:219], v[108:111]
    v_cvt_f32_i32 v245, v245
    v_cvt_pk_bf16_f32 v94, v16, v17
    v_mfma_f32_16x16x32_bf16 v[108:111], v[44:47], v[220:223], v[108:111]
    s_waitcnt lgkmcnt(3)
    v_add_f32 v8, v8, v18
    v_mfma_f32_16x16x32_bf16 v[176:179], v[24:27], a[192:195], v[128:131]
    ds_read_b128 v[40:43], v2 offset:12416
    v_add_f32 v8, v8, v19
    v_mfma_f32_16x16x32_bf16 v[176:179], v[28:31], a[196:199], v[176:179]
    v_fma_f32 v240, v240, v60, v62
    v_cvt_pk_bf16_f32 v95, v18, v19
    v_mfma_f32_16x16x32_bf16 v[180:183], v[24:27], a[216:219], v[132:135]
    s_mov_b32 s30, s29
    v_mfma_f32_16x16x32_bf16 v[180:183], v[28:31], a[220:223], v[180:183]
    buffer_load_dwordx4 v4, s[4:7], s32 offen offset:1024 sc1 lds
    v_mfma_f32_16x16x32_bf16 v[184:187], v[24:27], a[240:243], v[136:139]
    ds_read_b128 v[44:47], v3 offset:12416
    v_fma_f32 v241, v241, v61, v63
    v_mfma_f32_16x16x32_bf16 v[184:187], v[28:31], a[244:247], v[184:187]
    v_exp_f32 v16, v160
    v_mfma_f32_16x16x32_bf16 v[188:191], v[24:27], v[200:203], v[140:143]
    v_exp_f32 v17, v161
    v_mfma_f32_16x16x32_bf16 v[188:191], v[28:31], v[204:207], v[188:191]
    s_waitcnt lgkmcnt(2)
    v_exp_f32 v18, v162
    v_mfma_f32_16x16x32_bf16 v[112:115], v[32:35], a[192:195], v[128:131]
    ds_read_b128 v[24:27], v2 offset:18560
    v_add_f32 v5, v5, v16
    v_mfma_f32_16x16x32_bf16 v[112:115], v[36:39], a[196:199], v[112:115]
    v_add_f32 v5, v5, v17
    v_fma_f32 v244, v244, v60, v62
    v_mfma_f32_16x16x32_bf16 v[116:119], v[32:35], a[216:219], v[132:135]
    v_exp_f32 v19, v163
    v_mfma_f32_16x16x32_bf16 v[116:119], v[36:39], a[220:223], v[116:119]
    buffer_load_dwordx4 v4, s[4:7], s32 offen offset:2048 sc1 lds
    v_mfma_f32_16x16x32_bf16 v[120:123], v[32:35], a[240:243], v[136:139]
    ds_read_b128 v[28:31], v3 offset:18560
    v_cvt_pk_bf16_f32 v160, v16, v17
    v_mfma_f32_16x16x32_bf16 v[120:123], v[36:39], a[244:247], v[120:123]
    v_exp_f32 v16, v96
    v_mfma_f32_16x16x32_bf16 v[124:127], v[32:35], v[200:203], v[140:143]
    v_add_f32 v5, v5, v18
    v_add_u32 v1, s3, v1
    v_mfma_f32_16x16x32_bf16 v[124:127], v[36:39], v[204:207], v[124:127]
    s_waitcnt lgkmcnt(2)
    v_add_f32 v5, v5, v19
    v_fma_f32 v245, v245, v61, v63
    v_mfma_f32_16x16x32_bf16 v[176:179], v[40:43], a[200:203], v[176:179]
    ds_read_b128 v[32:35], v2 offset:12544
    v_add_u32 v21, s3, v21
    v_mfma_f32_16x16x32_bf16 v[176:179], v[44:47], a[204:207], v[176:179]
    v_exp_f32 v17, v97
    v_mfma_f32_16x16x32_bf16 v[180:183], v[40:43], a[224:227], v[180:183]
    v_cvt_pk_bf16_f32 v161, v18, v19
    v_cvt_pk_bf16_f32 v226, v240, v241
    v_mfma_f32_16x16x32_bf16 v[180:183], v[44:47], a[228:231], v[180:183]
    s_add_u32 s32, s32, 24576
    v_exp_f32 v18, v98
    v_mfma_f32_16x16x32_bf16 v[184:187], v[40:43], a[248:251], v[184:187]
    s_add_u32 s26, s26, 36864
    ds_read_b128 v[36:39], v3 offset:12544
    v_add_f32 v5, v5, v16
    v_mfma_f32_16x16x32_bf16 v[184:187], v[44:47], a[252:255], v[184:187]
    v_add_f32 v5, v5, v17
    v_cvt_pk_bf16_f32 v230, v244, v245
    v_mfma_f32_16x16x32_bf16 v[188:191], v[40:43], v[208:211], v[188:191]
    v_exp_f32 v19, v99
    v_mfma_f32_16x16x32_bf16 v[188:191], v[44:47], v[212:215], v[188:191]
    s_waitcnt lgkmcnt(2)
    v_cvt_pk_bf16_f32 v162, v16, v17
    v_bfe_u32 v53, v4, 4, 6
    v_mfma_f32_16x16x32_bf16 v[112:115], v[24:27], a[200:203], v[112:115]
    s_sub_u32 s57, s26, 147456
    ds_read_b128 v[40:43], v2 offset:18688
    v_add_u32 v22, s3, v22
    v_mfma_f32_16x16x32_bf16 v[112:115], v[28:31], a[204:207], v[112:115]
    v_exp_f32 v16, v164
    v_mfma_f32_16x16x32_bf16 v[116:119], v[24:27], a[224:227], v[116:119]
    s_min_u32 s26, s26, s57
    v_add_f32 v5, v5, v18
    v_add_f32 v5, v5, v19
    v_mfma_f32_16x16x32_bf16 v[116:119], v[28:31], a[228:231], v[116:119]
    v_exp_f32 v17, v165
    v_mfma_f32_16x16x32_bf16 v[120:123], v[24:27], a[248:251], v[120:123]
    ds_read_b128 v[44:47], v3 offset:18688
    v_cvt_pk_bf16_f32 v163, v18, v19
    v_mfma_f32_16x16x32_bf16 v[120:123], v[28:31], a[252:255], v[120:123]
    s_waitcnt lgkmcnt(2)
    v_exp_f32 v18, v166
    v_mfma_f32_16x16x32_bf16 v[124:127], v[24:27], v[208:211], v[124:127]
    s_waitcnt vmcnt(32)
    v_cvt_f32_i32 v242, v242
    v_add_f32 v6, v6, v16
    v_mfma_f32_16x16x32_bf16 v[124:127], v[28:31], v[212:215], v[124:127]
    s_barrier
    v_add_f32 v6, v6, v17
    v_mfma_f32_16x16x32_bf16 v[176:179], v[32:35], a[208:211], v[176:179]
    ds_read_b128 v[24:27], v1 offset:0
    v_lshlrev_b32 v53, 2, v53
    v_mfma_f32_16x16x32_bf16 v[176:179], v[36:39], a[212:215], v[176:179]
    buffer_load_dword v52, v53, s[20:23], 0 offen sc1
    v_mfma_f32_16x16x32_bf16 v[180:183], v[32:35], a[232:235], v[180:183]
    v_exp_f32 v19, v167
    v_mfma_f32_16x16x32_bf16 v[180:183], v[36:39], a[236:239], v[180:183]
    v_cvt_pk_bf16_f32 v164, v16, v17
    v_cvt_f32_i32 v243, v243
    v_mfma_f32_16x16x32_bf16 v[184:187], v[32:35], v[192:195], v[184:187]
    ds_read_b128 v[28:31], v1 offset:12288
    v_cvt_f32_i32 v246, v246
    v_mfma_f32_16x16x32_bf16 v[184:187], v[36:39], v[196:199], v[184:187]
    v_exp_f32 v16, v100
    v_mfma_f32_16x16x32_bf16 v[188:191], v[32:35], v[216:219], v[188:191]
    v_add_f32 v6, v6, v18
    v_add_f32 v6, v6, v19
    v_mfma_f32_16x16x32_bf16 v[188:191], v[36:39], v[220:223], v[188:191]
    s_waitcnt lgkmcnt(2)
    v_exp_f32 v17, v101
    v_mfma_f32_16x16x32_bf16 v[112:115], v[40:43], a[208:211], v[112:115]
    ds_read_b128 v[32:35], v1 offset:768
    v_cvt_pk_bf16_f32 v165, v18, v19
    v_mfma_f32_16x16x32_bf16 v[112:115], v[44:47], a[212:215], v[112:115]
    v_exp_f32 v18, v102
    v_mfma_f32_16x16x32_bf16 v[116:119], v[40:43], a[232:235], v[116:119]
    v_add_f32 v6, v6, v16
    v_cvt_f32_i32 v247, v247
    v_mfma_f32_16x16x32_bf16 v[116:119], v[44:47], a[236:239], v[116:119]
    v_add_f32 v6, v6, v17
    v_fma_f32 v242, v242, v48, v50
    v_mfma_f32_16x16x32_bf16 v[120:123], v[40:43], v[192:195], v[120:123]
    s_nop 0
    ds_read_b128 v[36:39], v1 offset:13056
    v_fma_f32 v243, v243, v49, v51
    v_mfma_f32_16x16x32_bf16 v[120:123], v[44:47], v[196:199], v[120:123]
    v_exp_f32 v19, v103
    v_mfma_f32_16x16x32_bf16 v[124:127], v[40:43], v[216:219], v[124:127]
    s_waitcnt lgkmcnt(2)
    v_cvt_pk_bf16_f32 v166, v16, v17
    v_add_f32 v6, v6, v18
    v_add_f32 v6, v6, v19
    v_cvt_pk_bf16_f32 v167, v18, v19
    v_mfma_f32_16x16x32_bf16 v[124:127], v[44:47], v[220:223], v[124:127]
    s_branch L_join
.p2align 6
L_loop:
    v_mfma_f32_16x16x32_bf16 a[0:3], v[160:163], v[24:27], a[0:3]
    ds_read_b128 v[40:43], v1 offset:1536
    v_fma_f32 v146, v146, v56, v58
    v_mfma_f32_16x16x32_bf16 a[0:3], v[176:179], v[28:31], a[0:3]
    buffer_load_dwordx4 v[248:251], v12, s[68:71], s36 offen offset:1536 nt
    v_mfma_f32_16x16x32_bf16 a[48:51], v[164:167], v[24:27], a[48:51]
    v_exp_f32 v16, v72
    v_mfma_f32_16x16x32_bf16 a[48:51], v[180:183], v[28:31], a[48:51]
    v_exp_f32 v17, v73
    v_mfma_f32_16x16x32_bf16 a[96:99], v[168:171], v[24:27], a[96:99]
    ds_read_b128 v[44:47], v1 offset:13824
    v_fma_f32 v150, v150, v57, v59
    v_mfma_f32_16x16x32_bf16 a[96:99], v[184:187], v[28:31], a[96:99]
    v_exp_f32 v18, v74
    v_mfma_f32_16x16x32_bf16 a[144:147], v[172:175], v[24:27], a[144:147]
    v_add_f32 v7, v7, v16
    v_add_f32 v7, v7, v17
    v_mfma_f32_16x16x32_bf16 a[144:147], v[188:191], v[28:31], a[144:147]
    s_waitcnt lgkmcnt(2)
    buffer_load_dwordx4 v[252:255], v12, s[68:71], s36 offen offset:2304 nt
    v_mfma_f32_16x16x32_bf16 a[4:7], v[160:163], v[32:35], a[4:7]
    ds_read_b128 v[24:27], v1 offset:2304
    v_fma_f32 v147, v147, v56, v58
    v_mfma_f32_16x16x32_bf16 a[4:7], v[176:179], v[36:39], a[4:7]
    v_exp_f32 v19, v75
    v_mfma_f32_16x16x32_bf16 a[52:55], v[164:167], v[32:35], a[52:55]
    v_cvt_pk_bf16_f32 v72, v16, v17
    v_fma_f32 v151, v151, v57, v59
    v_mfma_f32_16x16x32_bf16 a[52:55], v[180:183], v[36:39], a[52:55]
    v_exp_f32 v16, v104
    v_mfma_f32_16x16x32_bf16 a[100:103], v[168:171], v[32:35], a[100:103]
    ds_read_b128 v[28:31], v1 offset:14592
    v_add_f32 v7, v7, v18
    v_mfma_f32_16x16x32_bf16 a[100:103], v[184:187], v[36:39], a[100:103]
    ds_read_b128 v[56:59], v23 offset:48
    v_add_f32 v7, v7, v19
    v_mfma_f32_16x16x32_bf16 a[148:151], v[172:175], v[32:35], a[148:151]
    s_waitcnt vmcnt(31)
    v_exp_f32 v17, v105
    v_mfma_f32_16x16x32_bf16 a[148:151], v[188:191], v[36:39], a[148:151]
    s_waitcnt lgkmcnt(3)
    v_cvt_pk_bf16_f32 v73, v18, v19
    v_mfma_f32_16x16x32_bf16 a[8:11], v[160:163], v[40:43], a[8:11]
    ds_read_b128 v[32:35], v21 offset:0
    s_add_u32 s33, s33, 196608
    v_mfma_f32_16x16x32_bf16 a[8:11], v[176:179], v[44:47], a[8:11]
    s_sub_u32 s34, s33, 1572864
    v_exp_f32 v18, v106
    v_mfma_f32_16x16x32_bf16 a[56:59], v[164:167], v[40:43], a[56:59]
    v_add_f32 v7, v7, v16
    v_add_f32 v7, v7, v17
    v_mfma_f32_16x16x32_bf16 a[56:59], v[180:183], v[44:47], a[56:59]
    s_min_u32 s33, s33, s34
    v_exp_f32 v19, v107
    v_mfma_f32_16x16x32_bf16 a[104:107], v[168:171], v[40:43], a[104:107]
    s_mov_b32 m0, s56
    ds_read_b128 v[36:39], v21 offset:12288
    v_cvt_f32_i32 v152, v152
    v_mfma_f32_16x16x32_bf16 a[104:107], v[184:187], v[44:47], a[104:107]
    v_cvt_pk_bf16_f32 v74, v16, v17
    v_cvt_f32_i32 v156, v156
    v_mfma_f32_16x16x32_bf16 a[152:155], v[172:175], v[40:43], a[152:155]
    s_add_u32 s34, s33, 3072
    v_exp_f32 v16, v76
    v_mfma_f32_16x16x32_bf16 a[152:155], v[188:191], v[44:47], a[152:155]
    s_waitcnt lgkmcnt(3)
    buffer_load_dwordx4 v4, s[4:7], s27 offen offset:0 sc1 lds
    v_mfma_f32_16x16x32_bf16 a[12:15], v[160:163], v[24:27], a[12:15]
    s_add_u32 s37, s37, 196608
    ds_read_b128 v[40:43], v21 offset:768
    v_add_f32 v7, v7, v18
    v_mfma_f32_16x16x32_bf16 a[12:15], v[176:179], v[28:31], a[12:15]
    v_add_f32 v7, v7, v19
    v_cvt_f32_i32 v153, v153
    v_mfma_f32_16x16x32_bf16 a[60:63], v[164:167], v[24:27], a[60:63]
    v_exp_f32 v17, v77
    v_mfma_f32_16x16x32_bf16 a[60:63], v[180:183], v[28:31], a[60:63]
    s_add_u32 s80, s80, 196608
    v_cvt_pk_bf16_f32 v75, v18, v19
    v_add_u32 v23, 1792, v23
    v_mfma_f32_16x16x32_bf16 a[108:111], v[168:171], v[24:27], a[108:111]
    ds_read_b128 v[44:47], v21 offset:13056
    v_mfma_f32_16x16x32_bf16 a[108:111], v[184:187], v[28:31], a[108:111]
    v_exp_f32 v18, v78
    v_mfma_f32_16x16x32_bf16 a[156:159], v[172:175], v[24:27], a[156:159]
    s_add_u32 s29, s28, 49152
    v_add_f32 v8, v8, v16
    v_add_f32 v8, v8, v17
    v_mfma_f32_16x16x32_bf16 a[156:159], v[188:191], v[28:31], a[156:159]
    s_waitcnt lgkmcnt(2)
    buffer_load_dwordx4 v[224:227], v9, s[64:67], s33 offen offset:0 nt
    v_mfma_f32_16x16x32_bf16 a[16:19], v[160:163], v[32:35], a[16:19]
    ds_read_b128 v[24:27], v21 offset:1536
    v_cvt_f32_i32 v157, v157
    v_mfma_f32_16x16x32_bf16 a[16:19], v[176:179], v[36:39], a[16:19]
    s_sub_u32 s3, s29, 147456
    v_exp_f32 v19, v79
    v_mfma_f32_16x16x32_bf16 a[64:67], v[164:167], v[32:35], a[64:67]
    v_cvt_pk_bf16_f32 v76, v16, v17
    v_fma_f32 v152, v152, v60, v62
    v_mfma_f32_16x16x32_bf16 a[64:67], v[180:183], v[36:39], a[64:67]
    buffer_load_dwordx4 v4, s[4:7], s27 offen offset:1024 sc1 lds
    v_mfma_f32_16x16x32_bf16 a[112:115], v[168:171], v[32:35], a[112:115]
    ds_read_b128 v[28:31], v21 offset:13824
    v_fma_f32 v156, v156, v61, v63
    v_mfma_f32_16x16x32_bf16 a[112:115], v[184:187], v[36:39], a[112:115]
    v_exp_f32 v16, v108
    v_mfma_f32_16x16x32_bf16 a[160:163], v[172:175], v[32:35], a[160:163]
    v_add_f32 v8, v8, v18
    v_add_f32 v8, v8, v19
    v_mfma_f32_16x16x32_bf16 a[160:163], v[188:191], v[36:39], a[160:163]
    s_waitcnt lgkmcnt(2)
    buffer_load_dwordx4 v[228:231], v9, s[64:67], s33 offen offset:1536 nt
    v_mfma_f32_16x16x32_bf16 a[20:23], v[160:163], v[40:43], a[20:23]
    s_min_u32 s29, s29, s3
    ds_read_b128 v[32:35], v21 offset:2304
    v_fma_f32 v153, v153, v60, v62
    v_mfma_f32_16x16x32_bf16 a[20:23], v[176:179], v[44:47], a[20:23]
    v_exp_f32 v17, v109
    v_mfma_f32_16x16x32_bf16 a[68:71], v[164:167], v[40:43], a[68:71]
    v_cvt_pk_bf16_f32 v77, v18, v19
    v_mfma_f32_16x16x32_bf16 a[68:71], v[180:183], v[44:47], a[68:71]
    buffer_load_dwordx4 v[232:235], v9, s[64:67], s34 offen offset:0 nt
    v_mfma_f32_16x16x32_bf16 a[116:119], v[168:171], v[40:43], a[116:119]
    ds_read_b128 v[36:39], v21 offset:14592
    v_fma_f32 v157, v157, v61, v63
    v_mfma_f32_16x16x32_bf16 a[116:119], v[184:187], v[44:47], a[116:119]
    v_exp_f32 v18, v110
    v_mfma_f32_16x16x32_bf16 a[164:167], v[172:175], v[40:43], a[164:167]
    s_sub_u32 s3, s29, s28
    v_add_f32 v8, v8, v16
    v_add_f32 v8, v8, v17
    v_mfma_f32_16x16x32_bf16 a[164:167], v[188:191], v[44:47], a[164:167]
    s_waitcnt lgkmcnt(2)
    buffer_load_dwordx4 v4, s[4:7], s27 offen offset:2048 sc1 lds
    v_mfma_f32_16x16x32_bf16 a[24:27], v[160:163], v[24:27], a[24:27]
    s_add_u32 s27, s27, 24576
    ds_read_b128 v[40:43], v22 offset:0
    s_add_u32 s56, s56, 12288
    v_mfma_f32_16x16x32_bf16 a[24:27], v[176:179], v[28:31], a[24:27]
    v_exp_f32 v19, v111
    v_cvt_pk_bf16_f32 v78, v16, v17
    v_mfma_f32_16x16x32_bf16 a[72:75], v[164:167], v[24:27], a[72:75]
    s_mov_b32 m0, s56
    s_nop 0
    buffer_load_dwordx4 v[236:239], v9, s[64:67], s34 offen offset:1536 nt
    v_mfma_f32_16x16x32_bf16 a[72:75], v[180:183], v[28:31], a[72:75]
    v_add_f32 v8, v8, v18
    v_add_f32 v8, v8, v19
    v_mfma_f32_16x16x32_bf16 a[120:123], v[168:171], v[24:27], a[120:123]
    ds_read_b128 v[44:47], v22 offset:12288
    v_cvt_pk_bf16_f32 v79, v18, v19
    v_mfma_f32_16x16x32_bf16 a[120:123], v[184:187], v[28:31], a[120:123]
    s_mov_b32 s28, s29
    v_exp_f32 v16, v80
    v_mfma_f32_16x16x32_bf16 a[168:171], v[172:175], v[24:27], a[168:171]
    v_exp_f32 v17, v81
    v_mfma_f32_16x16x32_bf16 a[168:171], v[188:191], v[28:31], a[168:171]
    s_waitcnt lgkmcnt(2)
    buffer_load_dwordx4 v4, s[4:7], s27 offen offset:0 sc1 lds
    v_mfma_f32_16x16x32_bf16 a[28:31], v[160:163], v[32:35], a[28:31]
    ds_read_b128 v[24:27], v22 offset:768
    v_cvt_f32_i32 v154, v154
    v_mfma_f32_16x16x32_bf16 a[28:31], v[176:179], v[36:39], a[28:31]
    v_exp_f32 v18, v82
    v_mfma_f32_16x16x32_bf16 a[76:79], v[164:167], v[32:35], a[76:79]
    v_add_f32 v5, v5, v16
    v_add_f32 v5, v5, v17
    v_mfma_f32_16x16x32_bf16 a[76:79], v[180:183], v[36:39], a[76:79]
    v_exp_f32 v19, v83
    v_mfma_f32_16x16x32_bf16 a[124:127], v[168:171], v[32:35], a[124:127]
    ds_read_b128 v[28:31], v22 offset:13056
    v_cvt_pk_bf16_f32 v80, v16, v17
    v_mfma_f32_16x16x32_bf16 a[124:127], v[184:187], v[36:39], a[124:127]
    buffer_load_dwordx4 v4, s[4:7], s27 offen offset:1024 sc1 lds
    v_mfma_f32_16x16x32_bf16 a[172:175], v[172:175], v[32:35], a[172:175]
    v_exp_f32 v16, v112
    v_mfma_f32_16x16x32_bf16 a[172:175], v[188:191], v[36:39], a[172:175]
    s_waitcnt lgkmcnt(2)
    v_add_f32 v5, v5, v18
    v_add_f32 v5, v5, v19
    v_mfma_f32_16x16x32_bf16 a[32:35], v[160:163], v[40:43], a[32:35]
    ds_read_b128 v[32:35], v22 offset:1536
    v_cvt_f32_i32 v158, v158
    v_mfma_f32_16x16x32_bf16 a[32:35], v[176:179], v[44:47], a[32:35]
    v_exp_f32 v17, v113
    v_mfma_f32_16x16x32_bf16 a[80:83], v[164:167], v[40:43], a[80:83]
    v_cvt_pk_bf16_f32 v81, v18, v19
    v_cvt_f32_i32 v155, v155
    v_mfma_f32_16x16x32_bf16 a[80:83], v[180:183], v[44:47], a[80:83]
    v_exp_f32 v18, v114
    v_mfma_f32_16x16x32_bf16 a[128:131], v[168:171], v[40:43], a[128:131]
    ds_read_b128 v[36:39], v22 offset:13824
    v_add_f32 v5, v5, v16
    v_mfma_f32_16x16x32_bf16 a[128:131], v[184:187], v[44:47], a[128:131]
    buffer_load_dwordx4 v4, s[4:7], s27 offen offset:2048 sc1 lds
    v_mfma_f32_16x16x32_bf16 a[176:179], v[172:175], v[40:43], a[176:179]
    v_add_f32 v5, v5, v17
    v_cvt_f32_i32 v159, v159
    v_mfma_f32_16x16x32_bf16 a[176:179], v[188:191], v[44:47], a[176:179]
    s_waitcnt lgkmcnt(2)
    v_exp_f32 v19, v115
    v_mfma_f32_16x16x32_bf16 a[36:39], v[160:163], v[24:27], a[36:39]
    ds_read_b128 v[40:43], v22 offset:2304
    v_cvt_pk_bf16_f32 v82, v16, v17
    v_mfma_f32_16x16x32_bf16 a[36:39], v[176:179], v[28:31], a[36:39]
    v_exp_f32 v16, v84
    v_mfma_f32_16x16x32_bf16 a[84:87], v[164:167], v[24:27], a[84:87]
    v_add_u32 v2, s3, v2
    v_add_f32 v5, v5, v18
    v_mfma_f32_16x16x32_bf16 a[84:87], v[180:183], v[28:31], a[84:87]
    s_add_u32 s27, s27, 24576
    v_fma_f32 v154, v154, v60, v62
    v_add_f32 v5, v5, v19
    v_mfma_f32_16x16x32_bf16 a[132:135], v[168:171], v[24:27], a[132:135]
    s_add_u32 s56, s56, 36864
    ds_read_b128 v[44:47], v22 offset:14592
    v_add_u32 v3, s3, v3
    v_mfma_f32_16x16x32_bf16 a[132:135], v[184:187], v[28:31], a[132:135]
    s_waitcnt lgkmcnt(2)
    v_exp_f32 v17, v85
    v_mfma_f32_16x16x32_bf16 a[180:183], v[172:175], v[24:27], a[180:183]
    s_waitcnt vmcnt(12)
    v_cvt_pk_bf16_f32 v83, v18, v19
    v_fma_f32 v158, v158, v61, v63
    v_mfma_f32_16x16x32_bf16 a[180:183], v[188:191], v[28:31], a[180:183]
    s_barrier
    v_fma_f32 v155, v155, v60, v62
    v_mfma_f32_16x16x32_bf16 a[40:43], v[160:163], v[32:35], a[40:43]
    s_sub_u32 s58, s56, 147456
    ds_read_b128 v[24:27], v2 offset:0
    v_fma_f32 v159, v159, v61, v63
    v_mfma_f32_16x16x32_bf16 a[40:43], v[176:179], v[36:39], a[40:43]
    v_exp_f32 v18, v86
    v_mfma_f32_16x16x32_bf16 a[88:91], v[164:167], v[32:35], a[88:91]
    s_min_u32 s56, s56, s58
    v_add_f32 v6, v6, v16
    v_add_f32 v6, v6, v17
    v_mfma_f32_16x16x32_bf16 a[88:91], v[180:183], v[36:39], a[88:91]
    v_exp_f32 v19, v87
    v_mfma_f32_16x16x32_bf16 a[136:139], v[168:171], v[32:35], a[136:139]
    ds_read_b128 v[28:31], v3 offset:0
    v_cvt_pk_bf16_f32 v84, v16, v17
    v_mfma_f32_16x16x32_bf16 a[136:139], v[184:187], v[36:39], a[136:139]
    v_exp_f32 v16, v116
    v_mfma_f32_16x16x32_bf16 a[184:187], v[172:175], v[32:35], a[184:187]
    v_add_f32 v6, v6, v18
    v_cvt_pk_bf16_f32 v144, v144, v148
    v_mfma_f32_16x16x32_bf16 a[184:187], v[188:191], v[36:39], a[184:187]
    s_waitcnt lgkmcnt(2)
    v_add_f32 v6, v6, v19
    v_cvt_pk_bf16_f32 v148, v145, v149
    v_mfma_f32_16x16x32_bf16 a[44:47], v[160:163], v[40:43], a[44:47]
    ds_read_b128 v[32:35], v2 offset:6144
    v_cvt_pk_bf16_f32 v145, v152, v156
    v_mfma_f32_16x16x32_bf16 a[44:47], v[176:179], v[44:47], a[44:47]
    v_exp_f32 v17, v117
    v_mfma_f32_16x16x32_bf16 a[92:95], v[164:167], v[40:43], a[92:95]
    v_cvt_pk_bf16_f32 v85, v18, v19
    v_add_u32 v55, 1, v55
    v_mfma_f32_16x16x32_bf16 a[92:95], v[180:183], v[44:47], a[92:95]
    buffer_store_dword v55, v13, s[20:23], 0 offen sc1
    v_mfma_f32_16x16x32_bf16 a[140:143], v[168:171], v[40:43], a[140:143]
    ds_read_b128 v[36:39], v3 offset:6144
    v_cvt_pk_bf16_f32 v149, v153, v157
    v_mfma_f32_16x16x32_bf16 a[140:143], v[184:187], v[44:47], a[140:143]
    v_exp_f32 v18, v118
    v_mfma_f32_16x16x32_bf16 a[188:191], v[172:175], v[40:43], a[188:191]
    v_add_f32 v6, v6, v16
    v_add_f32 v6, v6, v17
    v_mfma_f32_16x16x32_bf16 a[188:191], v[188:191], v[44:47], a[188:191]
    s_waitcnt lgkmcnt(2)
    v_exp_f32 v19, v119
    v_cvt_pk_bf16_f32 v86, v16, v17
    v_add_f32 v6, v6, v18
    v_cvt_pk_bf16_f32 v152, v146, v150
    v_add_f32 v6, v6, v19
    v_cvt_pk_bf16_f32 v153, v154, v158
    v_cvt_pk_bf16_f32 v87, v18, v19
    v_cvt_pk_bf16_f32 v156, v147, v151
    v_mfma_f32_16x16x32_bf16 v[160:163], v[24:27], a[192:195], v[128:131]
    s_mov_b32 m0, s26
    ds_read_b128 v[40:43], v2 offset:128
    v_cvt_pk_bf16_f32 v157, v155, v159
    v_mfma_f32_16x16x32_bf16 v[160:163], v[28:31], a[196:199], v[160:163]
    s_waitcnt vmcnt(23)
    v_exp_f32 v16, v88
    v_mfma_f32_16x16x32_bf16 v[164:167], v[24:27], a[216:219], v[132:135]
    v_exp_f32 v17, v89
    v_mfma_f32_16x16x32_bf16 v[164:167], v[28:31], a[220:223], v[164:167]
    v_exp_f32 v18, v90
    v_mfma_f32_16x16x32_bf16 v[168:171], v[24:27], a[240:243], v[136:139]
    ds_read_b128 v[44:47], v3 offset:128
    v_cvt_f32_i32 v240, v240
    v_mfma_f32_16x16x32_bf16 v[168:171], v[28:31], a[244:247], v[168:171]
    buffer_load_dwordx4 v4, s[4:7], s32 offen offset:0 sc1 lds
    v_mfma_f32_16x16x32_bf16 v[172:175], v[24:27], v[200:203], v[140:143]
    v_add_f32 v7, v7, v16
    v_add_f32 v7, v7, v17
    v_mfma_f32_16x16x32_bf16 v[172:175], v[28:31], v[204:207], v[172:175]
    s_waitcnt lgkmcnt(2)
    v_exp_f32 v19, v91
    v_mfma_f32_16x16x32_bf16 v[96:99], v[32:35], a[192:195], v[128:131]
    ds_read_b128 v[24:27], v2 offset:6272
    v_cvt_pk_bf16_f32 v88, v16, v17
    v_mfma_f32_16x16x32_bf16 v[96:99], v[36:39], a[196:199], v[96:99]
    v_cvt_f32_i32 v244, v244
    v_mfma_f32_16x16x32_bf16 v[100:103], v[32:35], a[216:219], v[132:135]
    v_exp_f32 v16, v120
    v_mfma_f32_16x16x32_bf16 v[100:103], v[36:39], a[220:223], v[100:103]
    v_add_f32 v7, v7, v18
    v_cvt_f32_i32 v241, v241
    v_mfma_f32_16x16x32_bf16 v[104:107], v[32:35], a[240:243], v[136:139]
    ds_read_b128 v[28:31], v3 offset:6272
    v_add_f32 v7, v7, v19
    v_mfma_f32_16x16x32_bf16 v[104:107], v[36:39], a[244:247], v[104:107]
    v_exp_f32 v17, v121
    v_mfma_f32_16x16x32_bf16 v[108:111], v[32:35], v[200:203], v[140:143]
    v_cvt_f32_i32 v245, v245
    v_mfma_f32_16x16x32_bf16 v[108:111], v[36:39], v[204:207], v[108:111]
    s_waitcnt lgkmcnt(2)
    buffer_load_dwordx4 v4, s[4:7], s32 offen offset:1024 sc1 lds
    v_mfma_f32_16x16x32_bf16 v[160:163], v[40:43], a[200:203], v[160:163]
    ds_read_b128 v[32:35], v2 offset:256
    v_cvt_pk_bf16_f32 v89, v18, v19
    v_mfma_f32_16x16x32_bf16 v[160:163], v[44:47], a[204:207], v[160:163]
    v_exp_f32 v18, v122
    v_mfma_f32_16x16x32_bf16 v[164:167], v[40:43], a[224:227], v[164:167]
    v_add_f32 v7, v7, v16
    v_add_f32 v7, v7, v17
    v_mfma_f32_16x16x32_bf16 v[164:167], v[44:47], a[228:231], v[164:167]
    v_fma_f32 v240, v240, v48, v50
    v_mfma_f32_16x16x32_bf16 v[168:171], v[40:43], a[248:251], v[168:171]
    ds_read_b128 v[36:39], v3 offset:256
    v_mfma_f32_16x16x32_bf16 v[168:171], v[44:47], a[252:255], v[168:171]
    v_exp_f32 v19, v123
    v_mfma_f32_16x16x32_bf16 v[172:175], v[40:43], v[208:211], v[172:175]
    v_cvt_pk_bf16_f32 v90, v16, v17
    v_fma_f32 v244, v244, v49, v51
    v_mfma_f32_16x16x32_bf16 v[172:175], v[44:47], v[212:215], v[172:175]
    s_waitcnt lgkmcnt(2)
    buffer_load_dwordx4 v4, s[4:7], s32 offen offset:2048 sc1 lds
    v_mfma_f32_16x16x32_bf16 v[96:99], v[24:27], a[200:203], v[96:99]
    ds_read_b128 v[40:43], v2 offset:6400
    v_fma_f32 v241, v241, v48, v50
    v_mfma_f32_16x16x32_bf16 v[96:99], v[28:31], a[204:207], v[96:99]
    v_exp_f32 v16, v92
    v_mfma_f32_16x16x32_bf16 v[100:103], v[24:27], a[224:227], v[100:103]
    v_add_f32 v7, v7, v18
    v_add_f32 v7, v7, v19
    v_mfma_f32_16x16x32_bf16 v[100:103], v[28:31], a[228:231], v[100:103]
    v_exp_f32 v17, v93
    v_mfma_f32_16x16x32_bf16 v[104:107], v[24:27], a[248:251], v[104:107]
    ds_read_b128 v[44:47], v3 offset:6400
    v_cvt_pk_bf16_f32 v91, v18, v19
    v_mfma_f32_16x16x32_bf16 v[104:107], v[28:31], a[252:255], v[104:107]
    v_exp_f32 v18, v94
    v_mfma_f32_16x16x32_bf16 v[108:111], v[24:27], v[208:211], v[108:111]
    s_add_u32 s29, s30, 49152
    v_fma_f32 v245, v245, v49, v51
    v_add_f32 v8, v8, v16
    v_mfma_f32_16x16x32_bf16 v[108:111], v[28:31], v[212:215], v[108:111]
    s_waitcnt lgkmcnt(2)
    v_add_f32 v8, v8, v17
    s_add_u32 s32, s32, 24576
    v_mfma_f32_16x16x32_bf16 v[160:163], v[32:35], a[208:211], v[160:163]
    s_sub_u32 s3, s29, 147456
    ds_read_b128 v[24:27], v2 offset:12288
    v_cvt_f32_i32 v242, v242
    v_mfma_f32_16x16x32_bf16 v[160:163], v[36:39], a[212:215], v[160:163]
    v_exp_f32 v19, v95
    v_mfma_f32_16x16x32_bf16 v[164:167], v[32:35], a[232:235], v[164:167]
    v_cvt_pk_bf16_f32 v92, v16, v17
    v_cvt_f32_i32 v246, v246
    v_mfma_f32_16x16x32_bf16 v[164:167], v[36:39], a[236:239], v[164:167]
    s_add_u32 s26, s26, 12288
    v_exp_f32 v16, v124
    v_mfma_f32_16x16x32_bf16 v[168:171], v[32:35], v[192:195], v[168:171]
    ds_read_b128 v[28:31], v3 offset:12288
    v_add_f32 v8, v8, v18
    v_mfma_f32_16x16x32_bf16 v[168:171], v[36:39], v[196:199], v[168:171]
    v_add_f32 v8, v8, v19
    v_mfma_f32_16x16x32_bf16 v[172:175], v[32:35], v[216:219], v[172:175]
    s_min_u32 s29, s29, s3
    v_cvt_f32_i32 v243, v243
    v_mfma_f32_16x16x32_bf16 v[172:175], v[36:39], v[220:223], v[172:175]
    s_waitcnt lgkmcnt(2)
    v_exp_f32 v17, v125
    v_mfma_f32_16x16x32_bf16 v[96:99], v[40:43], a[208:211], v[96:99]
    s_mov_b32 m0, s26
    ds_read_b128 v[32:35], v2 offset:18432
    v_cvt_pk_bf16_f32 v93, v18, v19
    v_mfma_f32_16x16x32_bf16 v[96:99], v[44:47], a[212:215], v[96:99]
    v_exp_f32 v18, v126
    v_mfma_f32_16x16x32_bf16 v[100:103], v[40:43], a[232:235], v[100:103]
    v_cvt_f32_i32 v247, v247
    v_mfma_f32_16x16x32_bf16 v[100:103], v[44:47], a[236:239], v[100:103]
    v_add_f32 v8, v8, v16
    v_mfma_f32_16x16x32_bf16 v[104:107], v[40:43], v[192:195], v[104:107]
    s_sub_u32 s3, s29, s30
    ds_read_b128 v[36:39], v3 offset:18432
    v_add_f32 v8, v8, v17
    v_mfma_f32_16x16x32_bf16 v[104:107], v[44:47], v[196:199], v[104:107]
    v_exp_f32 v19, v127
    v_mfma_f32_16x16x32_bf16 v[108:111], v[40:43], v[216:219], v[108:111]
    v_fma_f32 v242, v242, v48, v50
    v_cvt_pk_bf16_f32 v94, v16, v17
    v_mfma_f32_16x16x32_bf16 v[108:111], v[44:47], v[220:223], v[108:111]
    s_waitcnt lgkmcnt(2)
    buffer_load_dwordx4 v4, s[4:7], s32 offen offset:0 sc1 lds
    v_mfma_f32_16x16x32_bf16 v[176:179], v[24:27], a[192:195], v[128:131]
    ds_read_b128 v[40:43], v2 offset:12416
    v_add_f32 v8, v8, v18
    v_mfma_f32_16x16x32_bf16 v[176:179], v[28:31], a[196:199], v[176:179]
    v_add_f32 v8, v8, v19
    v_fma_f32 v246, v246, v49, v51
    v_mfma_f32_16x16x32_bf16 v[180:183], v[24:27], a[216:219], v[132:135]
    s_mov_b32 s30, s29
    v_cvt_pk_bf16_f32 v95, v18, v19
    v_mfma_f32_16x16x32_bf16 v[180:183], v[28:31], a[220:223], v[180:183]
    v_fma_f32 v243, v243, v48, v50
    v_mfma_f32_16x16x32_bf16 v[184:187], v[24:27], a[240:243], v[136:139]
    ds_read_b128 v[44:47], v3 offset:12416
    v_mfma_f32_16x16x32_bf16 v[184:187], v[28:31], a[244:247], v[184:187]
    v_exp_f32 v16, v160
    v_mfma_f32_16x16x32_bf16 v[188:191], v[24:27], v[200:203], v[140:143]
    v_exp_f32 v17, v161
    v_mfma_f32_16x16x32_bf16 v[188:191], v[28:31], v[204:207], v[188:191]
    s_waitcnt lgkmcnt(2)
    v_exp_f32 v18, v162
    v_mfma_f32_16x16x32_bf16 v[112:115], v[32:35], a[192:195], v[128:131]
    ds_read_b128 v[24:27], v2 offset:18560
    v_add_f32 v5, v5, v16
    v_mfma_f32_16x16x32_bf16 v[112:115], v[36:39], a[196:199], v[112:115]
    buffer_load_dwordx4 v4, s[4:7], s32 offen offset:1024 sc1 lds
    v_mfma_f32_16x16x32_bf16 v[116:119], v[32:35], a[216:219], v[132:135]
    v_add_f32 v5, v5, v17
    v_fma_f32 v247, v247, v49, v51
    v_mfma_f32_16x16x32_bf16 v[116:119], v[36:39], a[220:223], v[116:119]
    v_exp_f32 v19, v163
    v_mfma_f32_16x16x32_bf16 v[120:123], v[32:35], a[240:243], v[136:139]
    ds_read_b128 v[28:31], v3 offset:18560
    v_cvt_pk_bf16_f32 v160, v16, v17
    v_mfma_f32_16x16x32_bf16 v[120:123], v[36:39], a[244:247], v[120:123]
    v_exp_f32 v16, v96
    v_mfma_f32_16x16x32_bf16 v[124:127], v[32:35], v[200:203], v[140:143]
    ds_read_b128 v[48:51], v10 offset:0
    v_add_f32 v5, v5, v18
    v_mfma_f32_16x16x32_bf16 v[124:127], v[36:39], v[204:207], v[124:127]
    s_waitcnt lgkmcnt(3)
    v_add_f32 v5, v5, v19
    v_add_u32 v1, s3, v1
    v_mfma_f32_16x16x32_bf16 v[176:179], v[40:43], a[200:203], v[176:179]
    ds_read_b128 v[32:35], v2 offset:12544
    v_cvt_pk_bf16_f32 v146, v240, v244
    v_mfma_f32_16x16x32_bf16 v[176:179], v[44:47], a[204:207], v[176:179]
    buffer_load_dwordx4 v4, s[4:7], s32 offen offset:2048 sc1 lds
    v_mfma_f32_16x16x32_bf16 v[180:183], v[40:43], a[224:227], v[180:183]
    v_exp_f32 v17, v97
    v_mfma_f32_16x16x32_bf16 v[180:183], v[44:47], a[228:231], v[180:183]
    v_cvt_pk_bf16_f32 v161, v18, v19
    v_add_u32 v21, s3, v21
    v_mfma_f32_16x16x32_bf16 v[184:187], v[40:43], a[248:251], v[184:187]
    ds_read_b128 v[36:39], v3 offset:12544
    v_cvt_pk_bf16_f32 v150, v241, v245
    v_mfma_f32_16x16x32_bf16 v[184:187], v[44:47], a[252:255], v[184:187]
    v_exp_f32 v18, v98
    v_mfma_f32_16x16x32_bf16 v[188:191], v[40:43], v[208:211], v[188:191]
    v_add_f32 v5, v5, v16
    v_add_f32 v5, v5, v17
    v_mfma_f32_16x16x32_bf16 v[188:191], v[44:47], v[212:215], v[188:191]
    s_waitcnt lgkmcnt(3)
    v_exp_f32 v19, v99
    v_mfma_f32_16x16x32_bf16 v[112:115], v[24:27], a[200:203], v[112:115]
    ds_read_b128 v[40:43], v2 offset:18688
    v_cvt_pk_bf16_f32 v162, v16, v17
    v_mfma_f32_16x16x32_bf16 v[112:115], v[28:31], a[204:207], v[112:115]
    v_exp_f32 v16, v164
    v_mfma_f32_16x16x32_bf16 v[116:119], v[24:27], a[224:227], v[116:119]
    v_add_f32 v5, v5, v18
    v_add_u32 v22, s3, v22
    v_mfma_f32_16x16x32_bf16 v[116:119], v[28:31], a[228:231], v[116:119]
    s_add_u32 s32, s32, 24576
    v_add_f32 v5, v5, v19
    v_cvt_pk_bf16_f32 v154, v242, v246
    v_mfma_f32_16x16x32_bf16 v[120:123], v[24:27], a[248:251], v[120:123]
    s_add_u32 s26, s26, 36864
    ds_read_b128 v[44:47], v3 offset:18688
    v_cvt_pk_bf16_f32 v158, v243, v247
    v_mfma_f32_16x16x32_bf16 v[120:123], v[28:31], a[252:255], v[120:123]
    s_waitcnt lgkmcnt(2)
    v_exp_f32 v17, v165
    v_mfma_f32_16x16x32_bf16 v[124:127], v[24:27], v[208:211], v[124:127]
    s_waitcnt vmcnt(31)
    v_cvt_pk_bf16_f32 v163, v18, v19
    s_waitcnt vmcnt(17)
    v_mfma_f32_16x16x32_bf16 v[124:127], v[28:31], v[212:215], v[124:127]
    s_barrier
    v_cvt_f32_i32 v248, v248
    v_mfma_f32_16x16x32_bf16 v[176:179], v[32:35], a[208:211], v[176:179]
    s_sub_u32 s57, s26, 147456
    ds_read_b128 v[24:27], v1 offset:0
    v_mfma_f32_16x16x32_bf16 v[176:179], v[36:39], a[212:215], v[176:179]
    v_exp_f32 v18, v166
    v_mfma_f32_16x16x32_bf16 v[180:183], v[32:35], a[232:235], v[180:183]
    s_min_u32 s26, s26, s57
    v_add_f32 v6, v6, v16
    v_add_f32 v6, v6, v17
    v_mfma_f32_16x16x32_bf16 v[180:183], v[36:39], a[236:239], v[180:183]
    v_exp_f32 v19, v167
    v_mfma_f32_16x16x32_bf16 v[184:187], v[32:35], v[192:195], v[184:187]
    ds_read_b128 v[28:31], v1 offset:12288
    v_cvt_pk_bf16_f32 v164, v16, v17
    v_mfma_f32_16x16x32_bf16 v[184:187], v[36:39], v[196:199], v[184:187]
    v_exp_f32 v16, v100
    v_mfma_f32_16x16x32_bf16 v[188:191], v[32:35], v[216:219], v[188:191]
    v_add_f32 v6, v6, v18
    v_add_f32 v6, v6, v19
    v_mfma_f32_16x16x32_bf16 v[188:191], v[36:39], v[220:223], v[188:191]
    s_waitcnt lgkmcnt(2)
    v_exp_f32 v17, v101
    v_mfma_f32_16x16x32_bf16 v[112:115], v[40:43], a[208:211], v[112:115]
    ds_read_b128 v[32:35], v1 offset:768
    v_cvt_pk_bf16_f32 v165, v18, v19
    v_mfma_f32_16x16x32_bf16 v[112:115], v[44:47], a[212:215], v[112:115]
    v_exp_f32 v18, v102
    v_mfma_f32_16x16x32_bf16 v[116:119], v[40:43], a[232:235], v[116:119]
    v_cvt_f32_i32 v252, v252
    v_add_f32 v6, v6, v16
    v_mfma_f32_16x16x32_bf16 v[116:119], v[44:47], a[236:239], v[116:119]
    v_add_f32 v6, v6, v17
    v_cvt_f32_i32 v249, v249
    v_mfma_f32_16x16x32_bf16 v[120:123], v[40:43], v[192:195], v[120:123]
    ds_read_b128 v[36:39], v1 offset:13056
    v_cvt_f32_i32 v253, v253
    v_mfma_f32_16x16x32_bf16 v[120:123], v[44:47], v[196:199], v[120:123]
    v_exp_f32 v19, v103
    v_mfma_f32_16x16x32_bf16 v[124:127], v[40:43], v[216:219], v[124:127]
    v_cvt_pk_bf16_f32 v166, v16, v17
    v_add_f32 v6, v6, v18
    v_mfma_f32_16x16x32_bf16 v[124:127], v[44:47], v[220:223], v[124:127]
    s_waitcnt lgkmcnt(2)
    v_add_f32 v6, v6, v19
    v_cvt_pk_bf16_f32 v167, v18, v19
    v_fma_f32 v248, v248, v56, v58
    v_mfma_f32_16x16x32_bf16 a[0:3], v[64:67], v[24:27], a[0:3]
    s_mov_b32 m0, s56
    ds_read_b128 v[40:43], v1 offset:1536
    v_bfe_u32 v53, v4, 4, 6
    v_mfma_f32_16x16x32_bf16 a[0:3], v[80:83], v[28:31], a[0:3]
    v_exp_f32 v16, v168
    v_mfma_f32_16x16x32_bf16 a[48:51], v[68:71], v[24:27], a[48:51]
    v_exp_f32 v17, v169
    v_mfma_f32_16x16x32_bf16 a[48:51], v[84:87], v[28:31], a[48:51]
    buffer_load_dwordx4 v4, s[4:7], s27 offen offset:0 sc1 lds
    v_mfma_f32_16x16x32_bf16 a[96:99], v[72:75], v[24:27], a[96:99]
    ds_read_b128 v[44:47], v1 offset:13824
    v_lshlrev_b32 v53, 2, v53
    v_mfma_f32_16x16x32_bf16 a[96:99], v[88:91], v[28:31], a[96:99]
    v_exp_f32 v18, v170
    v_mfma_f32_16x16x32_bf16 a[144:147], v[76:79], v[24:27], a[144:147]
    v_fma_f32 v252, v252, v57, v59
    v_add_f32 v7, v7, v16
    v_mfma_f32_16x16x32_bf16 a[144:147], v[92:95], v[28:31], a[144:147]
    s_waitcnt lgkmcnt(2)
    buffer_load_dword v52, v53, s[20:23], 0 offen sc1
    v_mfma_f32_16x16x32_bf16 a[4:7], v[64:67], v[32:35], a[4:7]
    ds_read_b128 v[24:27], v1 offset:2304
    v_add_f32 v7, v7, v17
    v_mfma_f32_16x16x32_bf16 a[4:7], v[80:83], v[36:39], a[4:7]
    v_exp_f32 v19, v171
    v_mfma_f32_16x16x32_bf16 a[52:55], v[68:71], v[32:35], a[52:55]
    v_cvt_pk_bf16_f32 v168, v16, v17
    v_fma_f32 v249, v249, v56, v58
    v_mfma_f32_16x16x32_bf16 a[52:55], v[84:87], v[36:39], a[52:55]
    buffer_load_dwordx4 v4, s[4:7], s27 offen offset:1024 sc1 lds
    v_mfma_f32_16x16x32_bf16 a[100:103], v[72:75], v[32:35], a[100:103]
    ds_read_b128 v[28:31], v1 offset:14592
    v_fma_f32 v253, v253, v57, v59
    v_mfma_f32_16x16x32_bf16 a[100:103], v[88:91], v[36:39], a[100:103]
    v_exp_f32 v16, v104
    v_mfma_f32_16x16x32_bf16 a[148:151], v[76:79], v[32:35], a[148:151]
    v_add_f32 v7, v7, v18
    v_add_f32 v7, v7, v19
    v_mfma_f32_16x16x32_bf16 a[148:151], v[92:95], v[36:39], a[148:151]
    s_waitcnt lgkmcnt(2)
    buffer_load_dwordx4 v[240:243], v9, s[64:67], s33 offen offset:384 nt
    v_mfma_f32_16x16x32_bf16 a[8:11], v[64:67], v[40:43], a[8:11]
    ds_read_b128 v[32:35], v21 offset:0
    v_cvt_f32_i32 v250, v250
    v_mfma_f32_16x16x32_bf16 a[8:11], v[80:83], v[44:47], a[8:11]
    v_exp_f32 v17, v105
    v_mfma_f32_16x16x32_bf16 a[56:59], v[68:71], v[40:43], a[56:59]
    v_cvt_pk_bf16_f32 v169, v18, v19
    v_cvt_f32_i32 v254, v254
    v_mfma_f32_16x16x32_bf16 a[56:59], v[84:87], v[44:47], a[56:59]
    buffer_load_dwordx4 v4, s[4:7], s27 offen offset:2048 sc1 lds
    v_mfma_f32_16x16x32_bf16 a[104:107], v[72:75], v[40:43], a[104:107]
    s_add_u32 s27, s27, 24576
    ds_read_b128 v[36:39], v21 offset:12288
    v_cvt_f32_i32 v251, v251
    v_mfma_f32_16x16x32_bf16 a[104:107], v[88:91], v[44:47], a[104:107]
    v_exp_f32 v18, v106
    v_mfma_f32_16x16x32_bf16 a[152:155], v[76:79], v[40:43], a[152:155]
    v_add_f32 v7, v7, v16
    v_add_f32 v7, v7, v17
    v_mfma_f32_16x16x32_bf16 a[152:155], v[92:95], v[44:47], a[152:155]
    s_waitcnt lgkmcnt(2)
    buffer_load_dwordx4 v[244:247], v9, s[64:67], s33 offen offset:1920 nt
    v_mfma_f32_16x16x32_bf16 a[12:15], v[64:67], v[24:27], a[12:15]
    s_add_u32 s56, s56, 12288
    ds_read_b128 v[40:43], v21 offset:768
    v_cvt_f32_i32 v255, v255
    v_mfma_f32_16x16x32_bf16 a[12:15], v[80:83], v[28:31], a[12:15]
    v_exp_f32 v19, v107
    v_cvt_pk_bf16_f32 v170, v16, v17
    v_mfma_f32_16x16x32_bf16 a[60:63], v[68:71], v[24:27], a[60:63]
    v_exp_f32 v16, v172
    v_mfma_f32_16x16x32_bf16 a[60:63], v[84:87], v[28:31], a[60:63]
    s_mov_b32 m0, s56
    v_add_f32 v7, v7, v18
    v_add_f32 v7, v7, v19
    v_mfma_f32_16x16x32_bf16 a[108:111], v[72:75], v[24:27], a[108:111]
    ds_read_b128 v[44:47], v21 offset:13056
    v_fma_f32 v250, v250, v56, v58
    v_mfma_f32_16x16x32_bf16 a[108:111], v[88:91], v[28:31], a[108:111]
    v_exp_f32 v17, v173
    v_mfma_f32_16x16x32_bf16 a[156:159], v[76:79], v[24:27], a[156:159]
    s_add_u32 s29, s28, 49152
    v_cvt_pk_bf16_f32 v171, v18, v19
    v_fma_f32 v254, v254, v57, v59
    v_mfma_f32_16x16x32_bf16 a[156:159], v[92:95], v[28:31], a[156:159]
    s_waitcnt lgkmcnt(2)
    buffer_load_dwordx4 v4, s[4:7], s27 offen offset:0 sc1 lds
    v_mfma_f32_16x16x32_bf16 a[16:19], v[64:67], v[32:35], a[16:19]
    ds_read_b128 v[24:27], v21 offset:1536
    v_fma_f32 v251, v251, v56, v58
    v_mfma_f32_16x16x32_bf16 a[16:19], v[80:83], v[36:39], a[16:19]
    s_sub_u32 s3, s29, 147456
    v_exp_f32 v18, v174
    v_mfma_f32_16x16x32_bf16 a[64:67], v[68:71], v[32:35], a[64:67]
    v_add_f32 v8, v8, v16
    v_add_f32 v8, v8, v17
    v_mfma_f32_16x16x32_bf16 a[64:67], v[84:87], v[36:39], a[64:67]
    v_exp_f32 v19, v175
    v_mfma_f32_16x16x32_bf16 a[112:115], v[72:75], v[32:35], a[112:115]
    ds_read_b128 v[28:31], v21 offset:13824
    v_cvt_pk_bf16_f32 v172, v16, v17
    v_mfma_f32_16x16x32_bf16 a[112:115], v[88:91], v[36:39], a[112:115]
    v_exp_f32 v16, v108
    v_mfma_f32_16x16x32_bf16 a[160:163], v[76:79], v[32:35], a[160:163]
    v_add_f32 v8, v8, v18
    v_add_f32 v8, v8, v19
    v_mfma_f32_16x16x32_bf16 a[160:163], v[92:95], v[36:39], a[160:163]
    s_waitcnt lgkmcnt(2)
    buffer_load_dwordx4 v4, s[4:7], s27 offen offset:1024 sc1 lds
    v_mfma_f32_16x16x32_bf16 a[20:23], v[64:67], v[40:43], a[20:23]
    s_min_u32 s29, s29, s3
    ds_read_b128 v[32:35], v21 offset:2304
    v_fma_f32 v255, v255, v57, v59
    v_mfma_f32_16x16x32_bf16 a[20:23], v[80:83], v[44:47], a[20:23]
    v_exp_f32 v17, v109
    v_mfma_f32_16x16x32_bf16 a[68:71], v[68:71], v[40:43], a[68:71]
    v_cvt_pk_bf16_f32 v173, v18, v19
    v_cvt_pk_bf16_f32 v147, v248, v252
    v_mfma_f32_16x16x32_bf16 a[68:71], v[84:87], v[44:47], a[68:71]
    v_exp_f32 v18, v110
    v_mfma_f32_16x16x32_bf16 a[116:119], v[72:75], v[40:43], a[116:119]
    ds_read_b128 v[36:39], v21 offset:14592
    v_add_f32 v8, v8, v16
    v_mfma_f32_16x16x32_bf16 a[116:119], v[88:91], v[44:47], a[116:119]
    buffer_load_dwordx4 v4, s[4:7], s27 offen offset:2048 sc1 lds
    v_mfma_f32_16x16x32_bf16 a[164:167], v[76:79], v[40:43], a[164:167]
    s_sub_u32 s3, s29, s28
    v_add_f32 v8, v8, v17
    v_cvt_pk_bf16_f32 v151, v249, v253
    v_mfma_f32_16x16x32_bf16 a[164:167], v[92:95], v[44:47], a[164:167]
    s_waitcnt lgkmcnt(2)
    v_exp_f32 v19, v111
    v_mfma_f32_16x16x32_bf16 a[24:27], v[64:67], v[24:27], a[24:27]
    ds_read_b128 v[40:43], v22 offset:0
    v_cvt_pk_bf16_f32 v174, v16, v17
    v_mfma_f32_16x16x32_bf16 a[24:27], v[80:83], v[28:31], a[24:27]
    v_add_f32 v8, v8, v18
    v_add_f32 v8, v8, v19
    v_mfma_f32_16x16x32_bf16 a[72:75], v[68:71], v[24:27], a[72:75]
    v_cvt_pk_bf16_f32 v175, v18, v19
    v_cvt_pk_bf16_f32 v155, v250, v254
    v_mfma_f32_16x16x32_bf16 a[72:75], v[84:87], v[28:31], a[72:75]
    s_add_u32 s27, s27, 24576
    v_exp_f32 v16, v176
    v_mfma_f32_16x16x32_bf16 a[120:123], v[72:75], v[24:27], a[120:123]
    s_add_u32 s56, s56, 36864
    ds_read_b128 v[44:47], v22 offset:12288
    v_cvt_pk_bf16_f32 v159, v251, v255
    v_mfma_f32_16x16x32_bf16 a[120:123], v[88:91], v[28:31], a[120:123]
    s_mov_b32 s28, s29
    v_exp_f32 v17, v177
    v_mfma_f32_16x16x32_bf16 a[168:171], v[76:79], v[24:27], a[168:171]
    v_exp_f32 v18, v178
    v_mfma_f32_16x16x32_bf16 a[168:171], v[92:95], v[28:31], a[168:171]
    s_waitcnt lgkmcnt(2)
    v_add_f32 v5, v5, v16
    v_add_f32 v5, v5, v17
    v_mfma_f32_16x16x32_bf16 a[28:31], v[64:67], v[32:35], a[28:31]
    s_sub_u32 s58, s56, 147456
    ds_read_b128 v[24:27], v22 offset:768
    v_mfma_f32_16x16x32_bf16 a[28:31], v[80:83], v[36:39], a[28:31]
    buffer_store_dwordx4 v[144:147], v20, s[4:7], s81 offen offset:0 sc1
    v_mfma_f32_16x16x32_bf16 a[76:79], v[68:71], v[32:35], a[76:79]
    s_min_u32 s56, s56, s58
    v_exp_f32 v19, v179
    v_mfma_f32_16x16x32_bf16 a[76:79], v[84:87], v[36:39], a[76:79]
    v_cvt_pk_bf16_f32 v176, v16, v17
    v_mfma_f32_16x16x32_bf16 a[124:127], v[72:75], v[32:35], a[124:127]
    ds_read_b128 v[28:31], v22 offset:13056
    v_add_u32 v2, s3, v2
    v_mfma_f32_16x16x32_bf16 a[124:127], v[88:91], v[36:39], a[124:127]
    v_exp_f32 v16, v112
    v_mfma_f32_16x16x32_bf16 a[172:175], v[76:79], v[32:35], a[172:175]
    v_add_f32 v5, v5, v18
    v_add_f32 v5, v5, v19
    v_mfma_f32_16x16x32_bf16 a[172:175], v[92:95], v[36:39], a[172:175]
    s_waitcnt lgkmcnt(2)
    v_exp_f32 v17, v113
    v_mfma_f32_16x16x32_bf16 a[32:35], v[64:67], v[40:43], a[32:35]
    ds_read_b128 v[32:35], v22 offset:1536
    v_cvt_pk_bf16_f32 v177, v18, v19
    v_mfma_f32_16x16x32_bf16 a[32:35], v[80:83], v[44:47], a[32:35]
    buffer_store_dwordx4 v[148:151], v20, s[4:7], s81 offen offset:768 sc1
    v_mfma_f32_16x16x32_bf16 a[80:83], v[68:71], v[40:43], a[80:83]
    v_exp_f32 v18, v114
    v_mfma_f32_16x16x32_bf16 a[80:83], v[84:87], v[44:47], a[80:83]
    v_add_f32 v5, v5, v16
    v_add_f32 v5, v5, v17
    v_mfma_f32_16x16x32_bf16 a[128:131], v[72:75], v[40:43], a[128:131]
    ds_read_b128 v[36:39], v22 offset:13824
    v_add_u32 v3, s3, v3
    v_mfma_f32_16x16x32_bf16 a[128:131], v[88:91], v[44:47], a[128:131]
    v_exp_f32 v19, v115
    v_mfma_f32_16x16x32_bf16 a[176:179], v[76:79], v[40:43], a[176:179]
    ds_read_b128 v[56:59], v10 offset:384
    v_cvt_pk_bf16_f32 v178, v16, v17
    v_mfma_f32_16x16x32_bf16 a[176:179], v[92:95], v[44:47], a[176:179]
    s_waitcnt lgkmcnt(3)
    v_exp_f32 v16, v180
    v_mfma_f32_16x16x32_bf16 a[36:39], v[64:67], v[24:27], a[36:39]
    s_waitcnt vmcnt(24)
    ds_read_b128 v[40:43], v22 offset:2304
    v_add_f32 v5, v5, v18
    v_mfma_f32_16x16x32_bf16 a[36:39], v[80:83], v[28:31], a[36:39]
    buffer_store_dwordx4 v[152:155], v20, s[4:7], s81 offen offset:1536 sc1
    v_mfma_f32_16x16x32_bf16 a[84:87], v[68:71], v[24:27], a[84:87]
    v_add_f32 v5, v5, v19
    v_cvt_f32_i32 v224, v224
    v_mfma_f32_16x16x32_bf16 a[84:87], v[84:87], v[28:31], a[84:87]
    v_exp_f32 v17, v181
    v_mfma_f32_16x16x32_bf16 a[132:135], v[72:75], v[24:27], a[132:135]
    ds_read_b128 v[44:47], v22 offset:14592
    v_cvt_pk_bf16_f32 v179, v18, v19
    v_mfma_f32_16x16x32_bf16 a[132:135], v[88:91], v[28:31], a[132:135]
    s_waitcnt lgkmcnt(3)
    v_exp_f32 v18, v182
    v_mfma_f32_16x16x32_bf16 a[180:183], v[76:79], v[24:27], a[180:183]
    s_waitcnt vmcnt(35)
    v_add_f32 v6, v6, v16
    v_cvt_f32_i32 v225, v225
    v_mfma_f32_16x16x32_bf16 a[180:183], v[92:95], v[28:31], a[180:183]
    s_barrier
    v_add_f32 v6, v6, v17
    v_mfma_f32_16x16x32_bf16 a[40:43], v[64:67], v[32:35], a[40:43]
    ds_read_b128 v[24:27], v2 offset:0
    v_cvt_f32_i32 v228, v228
    v_mfma_f32_16x16x32_bf16 a[40:43], v[80:83], v[36:39], a[40:43]
    v_exp_f32 v19, v183
    v_mfma_f32_16x16x32_bf16 a[88:91], v[68:71], v[32:35], a[88:91]
    ds_read_b128 v[60:63], v10 offset:768
    v_cvt_pk_bf16_f32 v180, v16, v17
    v_mfma_f32_16x16x32_bf16 a[88:91], v[84:87], v[36:39], a[88:91]
    v_exp_f32 v16, v116
    v_mfma_f32_16x16x32_bf16 a[136:139], v[72:75], v[32:35], a[136:139]
    ds_read_b128 v[28:31], v3 offset:0
    v_add_f32 v6, v6, v18
    v_mfma_f32_16x16x32_bf16 a[136:139], v[88:91], v[36:39], a[136:139]
    buffer_store_dwordx4 v[156:159], v20, s[4:7], s81 offen offset:2304 sc1
    v_mfma_f32_16x16x32_bf16 a[184:187], v[76:79], v[32:35], a[184:187]
    v_add_f32 v6, v6, v19
    v_cvt_f32_i32 v229, v229
    v_mfma_f32_16x16x32_bf16 a[184:187], v[92:95], v[36:39], a[184:187]
    s_waitcnt lgkmcnt(3)
    v_exp_f32 v17, v117
    v_mfma_f32_16x16x32_bf16 a[44:47], v[64:67], v[40:43], a[44:47]
    ds_read_b128 v[32:35], v2 offset:6144
    v_cvt_pk_bf16_f32 v181, v18, v19
    v_mfma_f32_16x16x32_bf16 a[44:47], v[80:83], v[44:47], a[44:47]
    v_exp_f32 v18, v118
    v_mfma_f32_16x16x32_bf16 a[92:95], v[68:71], v[40:43], a[92:95]
    v_add_f32 v6, v6, v16
    v_add_f32 v6, v6, v17
    v_mfma_f32_16x16x32_bf16 a[92:95], v[84:87], v[44:47], a[92:95]
    v_exp_f32 v19, v119
    v_mfma_f32_16x16x32_bf16 a[140:143], v[72:75], v[40:43], a[140:143]
    ds_read_b128 v[36:39], v3 offset:6144
    v_fma_f32 v224, v224, v48, v50
    v_mfma_f32_16x16x32_bf16 a[140:143], v[88:91], v[44:47], a[140:143]
    v_cvt_pk_bf16_f32 v182, v16, v17
    v_add_f32 v6, v6, v18
    v_mfma_f32_16x16x32_bf16 a[188:191], v[76:79], v[40:43], a[188:191]
    v_add_f32 v6, v6, v19
    v_fma_f32 v225, v225, v49, v51
    v_mfma_f32_16x16x32_bf16 a[188:191], v[92:95], v[44:47], a[188:191]
    s_waitcnt lgkmcnt(2)
    v_cvt_pk_bf16_f32 v183, v18, v19
    v_mfma_f32_16x16x32_bf16 v[64:67], v[24:27], a[192:195], v[128:131]
    ds_read_b128 v[40:43], v2 offset:128
    v_fma_f32 v228, v228, v48, v50
    v_mfma_f32_16x16x32_bf16 v[64:67], v[28:31], a[196:199], v[64:67]
    s_waitcnt vmcnt(11)
    v_subrev_u32 v52, s92, v52
    v_cmp_lt_u32 vcc, 15, v52
    v_mfma_f32_16x16x32_bf16 v[68:71], v[24:27], a[216:219], v[132:135]
    v_exp_f32 v16, v184
    v_mfma_f32_16x16x32_bf16 v[68:71], v[28:31], a[220:223], v[68:71]
    buffer_load_dwordx4 v[248:251], v9, s[64:67], s34 offen offset:384 nt
    v_mfma_f32_16x16x32_bf16 v[72:75], v[24:27], a[240:243], v[136:139]
    s_and_b32 s59, vcc_lo, 0xff
    ds_read_b128 v[44:47], v3 offset:128
    v_fma_f32 v229, v229, v49, v51
    v_mfma_f32_16x16x32_bf16 v[72:75], v[28:31], a[244:247], v[72:75]
    s_cbranch_scc1 L_pollslow3
L_pollok3:
    v_mfma_f32_16x16x32_bf16 v[76:79], v[24:27], v[200:203], v[140:143]
    s_add_u32 s92, s92, 1
    v_exp_f32 v17, v185
    v_mfma_f32_16x16x32_bf16 v[76:79], v[28:31], v[204:207], v[76:79]
    s_waitcnt lgkmcnt(2)
    v_exp_f32 v18, v186
    v_mfma_f32_16x16x32_bf16 v[96:99], v[32:35], a[192:195], v[128:131]
    s_mov_b32 m0, s26
    ds_read_b128 v[24:27], v2 offset:6272
    v_add_f32 v7, v7, v16
    v_mfma_f32_16x16x32_bf16 v[96:99], v[36:39], a[196:199], v[96:99]
    v_add_f32 v7, v7, v17
    v_cvt_pk_bf16_f32 v224, v224, v225
    v_mfma_f32_16x16x32_bf16 v[100:103], v[32:35], a[216:219], v[132:135]
    v_exp_f32 v19, v187
    v_mfma_f32_16x16x32_bf16 v[100:103], v[36:39], a[220:223], v[100:103]
    buffer_load_dwordx4 v[252:255], v9, s[64:67], s34 offen offset:1920 nt
    v_mfma_f32_16x16x32_bf16 v[104:107], v[32:35], a[240:243], v[136:139]
    ds_read_b128 v[28:31], v3 offset:6272
    v_cvt_pk_bf16_f32 v184, v16, v17
    v_mfma_f32_16x16x32_bf16 v[104:107], v[36:39], a[244:247], v[104:107]
    v_exp_f32 v16, v120
    v_mfma_f32_16x16x32_bf16 v[108:111], v[32:35], v[200:203], v[140:143]
    v_add_f32 v7, v7, v18
    v_add_f32 v7, v7, v19
    v_mfma_f32_16x16x32_bf16 v[108:111], v[36:39], v[204:207], v[108:111]
    s_waitcnt lgkmcnt(2)
    buffer_load_dwordx4 v4, s[4:7], s32 offen offset:0 sc1 lds
    v_mfma_f32_16x16x32_bf16 v[64:67], v[40:43], a[200:203], v[64:67]
    ds_read_b128 v[32:35], v2 offset:256
    v_cvt_pk_bf16_f32 v228, v228, v229
    v_mfma_f32_16x16x32_bf16 v[64:67], v[44:47], a[204:207], v[64:67]
    v_exp_f32 v17, v121
    v_mfma_f32_16x16x32_bf16 v[68:71], v[40:43], a[224:227], v[68:71]
    v_cvt_pk_bf16_f32 v185, v18, v19
    v_cvt_f32_i32 v226, v226
    v_mfma_f32_16x16x32_bf16 v[68:71], v[44:47], a[228:231], v[68:71]
    v_exp_f32 v18, v122
    v_mfma_f32_16x16x32_bf16 v[72:75], v[40:43], a[248:251], v[72:75]
    ds_read_b128 v[36:39], v3 offset:256
    v_add_f32 v7, v7, v16
    v_mfma_f32_16x16x32_bf16 v[72:75], v[44:47], a[252:255], v[72:75]
    buffer_load_dwordx4 v4, s[4:7], s32 offen offset:1024 sc1 lds
    v_mfma_f32_16x16x32_bf16 v[76:79], v[40:43], v[208:211], v[76:79]
    v_add_f32 v7, v7, v17
    v_mfma_f32_16x16x32_bf16 v[76:79], v[44:47], v[212:215], v[76:79]
    s_waitcnt lgkmcnt(2)
    v_exp_f32 v19, v123
    v_mfma_f32_16x16x32_bf16 v[96:99], v[24:27], a[200:203], v[96:99]
    ds_read_b128 v[40:43], v2 offset:6400
    v_cvt_pk_bf16_f32 v186, v16, v17
    v_mfma_f32_16x16x32_bf16 v[96:99], v[28:31], a[204:207], v[96:99]
    v_exp_f32 v16, v188
    v_mfma_f32_16x16x32_bf16 v[100:103], v[24:27], a[224:227], v[100:103]
    v_add_f32 v7, v7, v18
    v_add_f32 v7, v7, v19
    v_mfma_f32_16x16x32_bf16 v[100:103], v[28:31], a[228:231], v[100:103]
    v_exp_f32 v17, v189
    v_mfma_f32_16x16x32_bf16 v[104:107], v[24:27], a[248:251], v[104:107]
    ds_read_b128 v[44:47], v3 offset:6400
    v_cvt_pk_bf16_f32 v187, v18, v19
    v_mfma_f32_16x16x32_bf16 v[104:107], v[28:31], a[252:255], v[104:107]
    buffer_load_dwordx4 v4, s[4:7], s32 offen offset:2048 sc1 lds
    v_mfma_f32_16x16x32_bf16 v[108:111], v[24:27], v[208:211], v[108:111]
    s_add_u32 s29, s30, 49152
    v_exp_f32 v18, v190
    v_mfma_f32_16x16x32_bf16 v[108:111], v[28:31], v[212:215], v[108:111]
    s_waitcnt lgkmcnt(2)
    v_add_f32 v8, v8, v16
    v_cvt_f32_i32 v227, v227
    v_mfma_f32_16x16x32_bf16 v[64:67], v[32:35], a[208:211], v[64:67]
    s_sub_u32 s3, s29, 147456
    ds_read_b128 v[24:27], v2 offset:12288
    v_add_f32 v8, v8, v17
    v_mfma_f32_16x16x32_bf16 v[64:67], v[36:39], a[212:215], v[64:67]
    v_exp_f32 v19, v191
    v_mfma_f32_16x16x32_bf16 v[68:71], v[32:35], a[232:235], v[68:71]
    v_cvt_pk_bf16_f32 v188, v16, v17
    v_cvt_f32_i32 v230, v230
    v_mfma_f32_16x16x32_bf16 v[68:71], v[36:39], a[236:239], v[68:71]
    s_add_u32 s32, s32, 24576
    v_exp_f32 v16, v124
    v_mfma_f32_16x16x32_bf16 v[72:75], v[32:35], v[192:195], v[72:75]
    ds_read_b128 v[28:31], v3 offset:12288
    v_cvt_f32_i32 v231, v231
    v_mfma_f32_16x16x32_bf16 v[72:75], v[36:39], v[196:199], v[72:75]
    v_add_f32 v8, v8, v18
    v_add_f32 v8, v8, v19
    v_mfma_f32_16x16x32_bf16 v[76:79], v[32:35], v[216:219], v[76:79]
    s_min_u32 s29, s29, s3
    v_mfma_f32_16x16x32_bf16 v[76:79], v[36:39], v[220:223], v[76:79]
    s_waitcnt lgkmcnt(2)
    v_exp_f32 v17, v125
    v_mfma_f32_16x16x32_bf16 v[96:99], v[40:43], a[208:211], v[96:99]
    s_add_u32 s26, s26, 12288
    ds_read_b128 v[32:35], v2 offset:18432
    v_cvt_pk_bf16_f32 v189, v18, v19
    v_mfma_f32_16x16x32_bf16 v[96:99], v[44:47], a[212:215], v[96:99]
    v_exp_f32 v18, v126
    v_mfma_f32_16x16x32_bf16 v[100:103], v[40:43], a[232:235], v[100:103]
    v_fma_f32 v226, v226, v56, v58
    v_mfma_f32_16x16x32_bf16 v[100:103], v[44:47], a[236:239], v[100:103]
    s_mov_b32 m0, s26
    v_add_f32 v8, v8, v16
    v_mfma_f32_16x16x32_bf16 v[104:107], v[40:43], v[192:195], v[104:107]
    s_sub_u32 s3, s29, s30
    ds_read_b128 v[36:39], v3 offset:18432
    v_add_f32 v8, v8, v17
    v_mfma_f32_16x16x32_bf16 v[104:107], v[44:47], v[196:199], v[104:107]
    v_exp_f32 v19, v127
    v_mfma_f32_16x16x32_bf16 v[108:111], v[40:43], v[216:219], v[108:111]
    v_fma_f32 v227, v227, v57, v59
    v_cvt_pk_bf16_f32 v190, v16, v17
    v_mfma_f32_16x16x32_bf16 v[108:111], v[44:47], v[220:223], v[108:111]
    s_waitcnt lgkmcnt(2)
    v_add_f32 v8, v8, v18
    v_mfma_f32_16x16x32_bf16 v[80:83], v[24:27], a[192:195], v[128:131]
    ds_read_b128 v[40:43], v2 offset:12416
    v_add_f32 v8, v8, v19
    v_mfma_f32_16x16x32_bf16 v[80:83], v[28:31], a[196:199], v[80:83]
    buffer_load_dwordx4 v4, s[4:7], s32 offen offset:0 sc1 lds
    v_mfma_f32_16x16x32_bf16 v[84:87], v[24:27], a[216:219], v[132:135]
    s_mov_b32 s30, s29
    v_cvt_pk_bf16_f32 v191, v18, v19
    v_fma_f32 v230, v230, v56, v58
    v_mfma_f32_16x16x32_bf16 v[84:87], v[28:31], a[220:223], v[84:87]
    v_mfma_f32_16x16x32_bf16 v[88:91], v[24:27], a[240:243], v[136:139]
    ds_read_b128 v[44:47], v3 offset:12416
    v_mfma_f32_16x16x32_bf16 v[88:91], v[28:31], a[244:247], v[88:91]
    v_exp_f32 v16, v64
    v_mfma_f32_16x16x32_bf16 v[92:95], v[24:27], v[200:203], v[140:143]
    v_exp_f32 v17, v65
    v_mfma_f32_16x16x32_bf16 v[92:95], v[28:31], v[204:207], v[92:95]
    s_waitcnt lgkmcnt(2)
    v_exp_f32 v18, v66
    v_mfma_f32_16x16x32_bf16 v[112:115], v[32:35], a[192:195], v[128:131]
    ds_read_b128 v[24:27], v2 offset:18560
    v_add_f32 v5, v5, v16
    v_mfma_f32_16x16x32_bf16 v[112:115], v[36:39], a[196:199], v[112:115]
    v_add_f32 v5, v5, v17
    v_fma_f32 v231, v231, v57, v59
    v_mfma_f32_16x16x32_bf16 v[116:119], v[32:35], a[216:219], v[132:135]
    v_exp_f32 v19, v67
    v_mfma_f32_16x16x32_bf16 v[116:119], v[36:39], a[220:223], v[116:119]
    buffer_load_dwordx4 v4, s[4:7], s32 offen offset:1024 sc1 lds
    v_mfma_f32_16x16x32_bf16 v[120:123], v[32:35], a[240:243], v[136:139]
    ds_read_b128 v[28:31], v3 offset:18560
    v_cvt_pk_bf16_f32 v64, v16, v17
    v_mfma_f32_16x16x32_bf16 v[120:123], v[36:39], a[244:247], v[120:123]
    v_exp_f32 v16, v96
    v_mfma_f32_16x16x32_bf16 v[124:127], v[32:35], v[200:203], v[140:143]
    v_add_f32 v5, v5, v18
    v_add_u32 v1, s3, v1
    v_mfma_f32_16x16x32_bf16 v[124:127], v[36:39], v[204:207], v[124:127]
    s_waitcnt lgkmcnt(2)
    v_add_f32 v5, v5, v19
    v_cvt_pk_bf16_f32 v225, v226, v227
    v_mfma_f32_16x16x32_bf16 v[80:83], v[40:43], a[200:203], v[80:83]
    ds_read_b128 v[32:35], v2 offset:12544
    v_add_u32 v21, s3, v21
    v_mfma_f32_16x16x32_bf16 v[80:83], v[44:47], a[204:207], v[80:83]
    v_exp_f32 v17, v97
    v_mfma_f32_16x16x32_bf16 v[84:87], v[40:43], a[224:227], v[84:87]
    v_cvt_pk_bf16_f32 v65, v18, v19
    v_cvt_pk_bf16_f32 v229, v230, v231
    v_mfma_f32_16x16x32_bf16 v[84:87], v[44:47], a[228:231], v[84:87]
    buffer_load_dwordx4 v4, s[4:7], s32 offen offset:2048 sc1 lds
    v_mfma_f32_16x16x32_bf16 v[88:91], v[40:43], a[248:251], v[88:91]
    ds_read_b128 v[36:39], v3 offset:12544
    v_add_u32 v22, s3, v22
    v_mfma_f32_16x16x32_bf16 v[88:91], v[44:47], a[252:255], v[88:91]
    v_exp_f32 v18, v98
    v_mfma_f32_16x16x32_bf16 v[92:95], v[40:43], v[208:211], v[92:95]
    v_add_f32 v5, v5, v16
    v_add_f32 v5, v5, v17
    v_mfma_f32_16x16x32_bf16 v[92:95], v[44:47], v[212:215], v[92:95]
    s_waitcnt lgkmcnt(2)
    v_exp_f32 v19, v99
    v_mfma_f32_16x16x32_bf16 v[112:115], v[24:27], a[200:203], v[112:115]
    s_waitcnt vmcnt(31)
    ds_read_b128 v[40:43], v2 offset:18688
    v_cvt_pk_bf16_f32 v66, v16, v17
    v_mfma_f32_16x16x32_bf16 v[112:115], v[28:31], a[204:207], v[112:115]
    v_exp_f32 v16, v68
    v_mfma_f32_16x16x32_bf16 v[116:119], v[24:27], a[224:227], v[116:119]
    v_add_f32 v5, v5, v18
    v_add_f32 v5, v5, v19
    v_mfma_f32_16x16x32_bf16 v[116:119], v[28:31], a[228:231], v[116:119]
    s_add_u32 s32, s32, 24576
    v_exp_f32 v17, v69
    v_mfma_f32_16x16x32_bf16 v[120:123], v[24:27], a[248:251], v[120:123]
    s_add_u32 s26, s26, 36864
    ds_read_b128 v[44:47], v3 offset:18688
    v_cvt_pk_bf16_f32 v67, v18, v19
    v_mfma_f32_16x16x32_bf16 v[120:123], v[28:31], a[252:255], v[120:123]
    s_waitcnt lgkmcnt(2)
    v_exp_f32 v18, v70
    v_mfma_f32_16x16x32_bf16 v[124:127], v[24:27], v[208:211], v[124:127]
    s_waitcnt vmcnt(8)
    v_add_f32 v6, v6, v16
    v_cvt_f32_i32 v232, v232
    v_mfma_f32_16x16x32_bf16 v[124:127], v[28:31], v[212:215], v[124:127]
    s_barrier
    v_add_f32 v6, v6, v17
    v_mfma_f32_16x16x32_bf16 v[80:83], v[32:35], a[208:211], v[80:83]
    s_sub_u32 s57, s26, 147456
    ds_read_b128 v[24:27], v1 offset:0
    v_add_u32 v55, 1, v55
    v_mfma_f32_16x16x32_bf16 v[80:83], v[36:39], a[212:215], v[80:83]
    v_exp_f32 v19, v71
    v_mfma_f32_16x16x32_bf16 v[84:87], v[32:35], a[232:235], v[84:87]
    s_min_u32 s26, s26, s57
    v_cvt_pk_bf16_f32 v68, v16, v17
    v_cvt_f32_i32 v233, v233
    v_mfma_f32_16x16x32_bf16 v[84:87], v[36:39], a[236:239], v[84:87]
    v_exp_f32 v16, v100
    v_mfma_f32_16x16x32_bf16 v[88:91], v[32:35], v[192:195], v[88:91]
    ds_read_b128 v[28:31], v1 offset:12288
    v_add_f32 v6, v6, v18
    v_mfma_f32_16x16x32_bf16 v[88:91], v[36:39], v[196:199], v[88:91]
    buffer_store_dword v55, v13, s[20:23], 0 offen sc1
    v_mfma_f32_16x16x32_bf16 v[92:95], v[32:35], v[216:219], v[92:95]
    v_add_f32 v6, v6, v19
    v_mfma_f32_16x16x32_bf16 v[92:95], v[36:39], v[220:223], v[92:95]
    s_waitcnt lgkmcnt(2)
    v_exp_f32 v17, v101
    v_mfma_f32_16x16x32_bf16 v[112:115], v[40:43], a[208:211], v[112:115]
    ds_read_b128 v[32:35], v1 offset:768
    v_cvt_pk_bf16_f32 v69, v18, v19
    v_mfma_f32_16x16x32_bf16 v[112:115], v[44:47], a[212:215], v[112:115]
    v_exp_f32 v18, v102
    v_mfma_f32_16x16x32_bf16 v[116:119], v[40:43], a[232:235], v[116:119]
    v_add_f32 v6, v6, v16
    v_add_f32 v6, v6, v17
    v_mfma_f32_16x16x32_bf16 v[116:119], v[44:47], a[236:239], v[116:119]
    v_exp_f32 v19, v103
    v_mfma_f32_16x16x32_bf16 v[120:123], v[40:43], v[192:195], v[120:123]
    ds_read_b128 v[36:39], v1 offset:13056
    v_cvt_f32_i32 v236, v236
    v_mfma_f32_16x16x32_bf16 v[120:123], v[44:47], v[196:199], v[120:123]
    v_cvt_pk_bf16_f32 v70, v16, v17
    v_add_f32 v6, v6, v18
    v_mfma_f32_16x16x32_bf16 v[124:127], v[40:43], v[216:219], v[124:127]
    v_add_f32 v6, v6, v19
    v_cvt_pk_bf16_f32 v71, v18, v19
    v_mfma_f32_16x16x32_bf16 v[124:127], v[44:47], v[220:223], v[124:127]
    s_waitcnt lgkmcnt(2)
    v_mfma_f32_16x16x32_bf16 a[0:3], v[160:163], v[24:27], a[0:3]
    ds_read_b128 v[40:43], v1 offset:1536
    s_add_u32 s35, s35, 196608
    v_mfma_f32_16x16x32_bf16 a[0:3], v[176:179], v[28:31], a[0:3]
    s_mov_b32 m0, s56
    v_exp_f32 v16, v72
    v_mfma_f32_16x16x32_bf16 a[48:51], v[164:167], v[24:27], a[48:51]
    s_sub_u32 s36, s35, 1572864
    v_exp_f32 v17, v73
    v_mfma_f32_16x16x32_bf16 a[48:51], v[180:183], v[28:31], a[48:51]
    v_cvt_f32_i32 v237, v237
    v_fma_f32 v232, v232, v48, v50
    v_mfma_f32_16x16x32_bf16 a[96:99], v[168:171], v[24:27], a[96:99]
    ds_read_b128 v[44:47], v1 offset:13824
    v_mfma_f32_16x16x32_bf16 a[96:99], v[184:187], v[28:31], a[96:99]
    s_min_u32 s35, s35, s36
    buffer_load_dwordx4 v4, s[4:7], s27 offen offset:0 sc1 lds
    v_mfma_f32_16x16x32_bf16 a[144:147], v[172:175], v[24:27], a[144:147]
    v_exp_f32 v18, v74
    v_mfma_f32_16x16x32_bf16 a[144:147], v[188:191], v[28:31], a[144:147]
    s_waitcnt lgkmcnt(2)
    v_add_f32 v7, v7, v16
    v_add_f32 v7, v7, v17
    v_mfma_f32_16x16x32_bf16 a[4:7], v[160:163], v[32:35], a[4:7]
    s_add_u32 s36, s35, 3072
    ds_read_b128 v[24:27], v1 offset:2304
    v_fma_f32 v233, v233, v49, v51
    v_mfma_f32_16x16x32_bf16 a[4:7], v[176:179], v[36:39], a[4:7]
    v_exp_f32 v19, v75
    v_mfma_f32_16x16x32_bf16 a[52:55], v[164:167], v[32:35], a[52:55]
    v_cvt_pk_bf16_f32 v72, v16, v17
    v_mfma_f32_16x16x32_bf16 a[52:55], v[180:183], v[36:39], a[52:55]
    v_exp_f32 v16, v104
    v_mfma_f32_16x16x32_bf16 a[100:103], v[168:171], v[32:35], a[100:103]
    s_add_u32 s81, s81, 196608
    ds_read_b128 v[28:31], v1 offset:14592
    v_add_f32 v7, v7, v18
    v_mfma_f32_16x16x32_bf16 a[100:103], v[184:187], v[36:39], a[100:103]
    v_add_f32 v7, v7, v19
    v_mfma_f32_16x16x32_bf16 a[148:151], v[172:175], v[32:35], a[148:151]
    v_exp_f32 v17, v105
    v_mfma_f32_16x16x32_bf16 a[148:151], v[188:191], v[36:39], a[148:151]
    s_waitcnt lgkmcnt(2)
    buffer_load_dwordx4 v4, s[4:7], s27 offen offset:1024 sc1 lds
    v_mfma_f32_16x16x32_bf16 a[8:11], v[160:163], v[40:43], a[8:11]
    ds_read_b128 v[32:35], v21 offset:0
    v_cvt_pk_bf16_f32 v73, v18, v19
    v_mfma_f32_16x16x32_bf16 a[8:11], v[176:179], v[44:47], a[8:11]
    v_exp_f32 v18, v106
    v_mfma_f32_16x16x32_bf16 a[56:59], v[164:167], v[40:43], a[56:59]
    v_add_f32 v7, v7, v16
    v_add_f32 v7, v7, v17
    v_mfma_f32_16x16x32_bf16 a[56:59], v[180:183], v[44:47], a[56:59]
    buffer_load_dwordx4 v[144:147], v12, s[68:71], s35 offen offset:0 nt
    v_mfma_f32_16x16x32_bf16 a[104:107], v[168:171], v[40:43], a[104:107]
    ds_read_b128 v[36:39], v21 offset:12288
    v_fma_f32 v236, v236, v48, v50
    v_mfma_f32_16x16x32_bf16 a[104:107], v[184:187], v[44:47], a[104:107]
    v_exp_f32 v19, v107
    v_mfma_f32_16x16x32_bf16 a[152:155], v[172:175], v[40:43], a[152:155]
    v_cvt_pk_bf16_f32 v74, v16, v17
    v_fma_f32 v237, v237, v49, v51
    v_mfma_f32_16x16x32_bf16 a[152:155], v[188:191], v[44:47], a[152:155]
    s_waitcnt lgkmcnt(2)
    buffer_load_dwordx4 v4, s[4:7], s27 offen offset:2048 sc1 lds
    v_mfma_f32_16x16x32_bf16 a[12:15], v[160:163], v[24:27], a[12:15]
    ds_read_b128 v[40:43], v21 offset:768
    v_mfma_f32_16x16x32_bf16 a[12:15], v[176:179], v[28:31], a[12:15]
    v_exp_f32 v16, v76
    v_mfma_f32_16x16x32_bf16 a[60:63], v[164:167], v[24:27], a[60:63]
    v_add_f32 v7, v7, v18
    v_add_f32 v7, v7, v19
    v_mfma_f32_16x16x32_bf16 a[60:63], v[180:183], v[28:31], a[60:63]
    buffer_load_dwordx4 v[148:151], v12, s[68:71], s35 offen offset:768 nt
    v_mfma_f32_16x16x32_bf16 a[108:111], v[168:171], v[24:27], a[108:111]
    ds_read_b128 v[44:47], v21 offset:13056
    v_cvt_pk_bf16_f32 v232, v232, v233
    v_mfma_f32_16x16x32_bf16 a[108:111], v[184:187], v[28:31], a[108:111]
    v_exp_f32 v17, v77
    v_mfma_f32_16x16x32_bf16 a[156:159], v[172:175], v[24:27], a[156:159]
    s_add_u32 s29, s28, 49152
    v_cvt_pk_bf16_f32 v75, v18, v19
    s_add_u32 s27, s27, 24576
    v_mfma_f32_16x16x32_bf16 a[156:159], v[188:191], v[28:31], a[156:159]
    s_waitcnt lgkmcnt(2)
    buffer_load_dwordx4 v[152:155], v12, s[68:71], s35 offen offset:1536 nt
    v_mfma_f32_16x16x32_bf16 a[16:19], v[160:163], v[32:35], a[16:19]
    ds_read_b128 v[24:27], v21 offset:1536
    v_cvt_pk_bf16_f32 v236, v236, v237
    v_mfma_f32_16x16x32_bf16 a[16:19], v[176:179], v[36:39], a[16:19]
    s_sub_u32 s3, s29, 147456
    v_exp_f32 v18, v78
    v_mfma_f32_16x16x32_bf16 a[64:67], v[164:167], v[32:35], a[64:67]
    v_add_f32 v8, v8, v16
    v_add_f32 v8, v8, v17
    v_mfma_f32_16x16x32_bf16 a[64:67], v[180:183], v[36:39], a[64:67]
    s_add_u32 s56, s56, 12288
    v_exp_f32 v19, v79
    v_mfma_f32_16x16x32_bf16 a[112:115], v[168:171], v[32:35], a[112:115]
    ds_read_b128 v[28:31], v21 offset:13824
    v_cvt_pk_bf16_f32 v76, v16, v17
    v_mfma_f32_16x16x32_bf16 a[112:115], v[184:187], v[36:39], a[112:115]
    v_exp_f32 v16, v108
    v_mfma_f32_16x16x32_bf16 a[160:163], v[172:175], v[32:35], a[160:163]
    v_add_f32 v8, v8, v18
    v_add_f32 v8, v8, v19
    v_mfma_f32_16x16x32_bf16 a[160:163], v[188:191], v[36:39], a[160:163]
    s_waitcnt lgkmcnt(2)
    buffer_load_dwordx4 v[156:159], v12, s[68:71], s35 offen offset:2304 nt
    v_mfma_f32_16x16x32_bf16 a[20:23], v[160:163], v[40:43], a[20:23]
    s_mov_b32 m0, s56
    ds_read_b128 v[32:35], v21 offset:2304
    v_cvt_f32_i32 v234, v234
    v_mfma_f32_16x16x32_bf16 a[20:23], v[176:179], v[44:47], a[20:23]
    s_min_u32 s29, s29, s3
    v_exp_f32 v17, v109
    v_mfma_f32_16x16x32_bf16 a[68:71], v[164:167], v[40:43], a[68:71]
    v_cvt_pk_bf16_f32 v77, v18, v19
    v_cvt_f32_i32 v235, v235
    v_mfma_f32_16x16x32_bf16 a[68:71], v[180:183], v[44:47], a[68:71]
    v_exp_f32 v18, v110
    v_mfma_f32_16x16x32_bf16 a[116:119], v[168:171], v[40:43], a[116:119]
    ds_read_b128 v[36:39], v21 offset:14592
    v_add_f32 v8, v8, v16
    v_mfma_f32_16x16x32_bf16 a[116:119], v[184:187], v[44:47], a[116:119]
    v_add_f32 v8, v8, v17
    v_mfma_f32_16x16x32_bf16 a[164:167], v[172:175], v[40:43], a[164:167]
    s_sub_u32 s3, s29, s28
    v_exp_f32 v19, v111
    v_mfma_f32_16x16x32_bf16 a[164:167], v[188:191], v[44:47], a[164:167]
    s_waitcnt lgkmcnt(2)
    buffer_load_dwordx4 v4, s[4:7], s27 offen offset:0 sc1 lds
    v_mfma_f32_16x16x32_bf16 a[24:27], v[160:163], v[24:27], a[24:27]
    ds_read_b128 v[40:43], v22 offset:0
    v_cvt_pk_bf16_f32 v78, v16, v17
    v_mfma_f32_16x16x32_bf16 a[24:27], v[176:179], v[28:31], a[24:27]
    v_add_f32 v8, v8, v18
    v_add_f32 v8, v8, v19
    v_mfma_f32_16x16x32_bf16 a[72:75], v[164:167], v[24:27], a[72:75]
    v_cvt_pk_bf16_f32 v79, v18, v19
    v_cvt_f32_i32 v238, v238
    v_mfma_f32_16x16x32_bf16 a[72:75], v[180:183], v[28:31], a[72:75]
    v_exp_f32 v16, v80
    v_mfma_f32_16x16x32_bf16 a[120:123], v[168:171], v[24:27], a[120:123]
    ds_read_b128 v[44:47], v22 offset:12288
    v_mfma_f32_16x16x32_bf16 a[120:123], v[184:187], v[28:31], a[120:123]
    s_mov_b32 s28, s29
    v_exp_f32 v17, v81
    v_mfma_f32_16x16x32_bf16 a[168:171], v[172:175], v[24:27], a[168:171]
    v_exp_f32 v18, v82
    v_mfma_f32_16x16x32_bf16 a[168:171], v[188:191], v[28:31], a[168:171]
    s_waitcnt lgkmcnt(2)
    v_add_f32 v5, v5, v16
    v_add_f32 v5, v5, v17
    v_mfma_f32_16x16x32_bf16 a[28:31], v[160:163], v[32:35], a[28:31]
    ds_read_b128 v[24:27], v22 offset:768
    v_cvt_f32_i32 v239, v239
    v_mfma_f32_16x16x32_bf16 a[28:31], v[176:179], v[36:39], a[28:31]
    buffer_load_dwordx4 v4, s[4:7], s27 offen offset:1024 sc1 lds
    v_mfma_f32_16x16x32_bf16 a[76:79], v[164:167], v[32:35], a[76:79]
    v_exp_f32 v19, v83
    v_mfma_f32_16x16x32_bf16 a[76:79], v[180:183], v[36:39], a[76:79]
    v_cvt_pk_bf16_f32 v80, v16, v17
    v_fma_f32 v234, v234, v56, v58
    v_mfma_f32_16x16x32_bf16 a[124:127], v[168:171], v[32:35], a[124:127]
    ds_read_b128 v[28:31], v22 offset:13056
    v_add_u32 v2, s3, v2
    v_mfma_f32_16x16x32_bf16 a[124:127], v[184:187], v[36:39], a[124:127]
    v_exp_f32 v16, v112
    v_mfma_f32_16x16x32_bf16 a[172:175], v[172:175], v[32:35], a[172:175]
    v_add_f32 v5, v5, v18
    v_add_f32 v5, v5, v19
    v_mfma_f32_16x16x32_bf16 a[172:175], v[188:191], v[36:39], a[172:175]
    s_waitcnt lgkmcnt(2)
    v_exp_f32 v17, v113
    v_mfma_f32_16x16x32_bf16 a[32:35], v[160:163], v[40:43], a[32:35]
    ds_read_b128 v[32:35], v22 offset:1536
    v_cvt_pk_bf16_f32 v81, v18, v19
    v_mfma_f32_16x16x32_bf16 a[32:35], v[176:179], v[44:47], a[32:35]
    buffer_load_dwordx4 v4, s[4:7], s27 offen offset:2048 sc1 lds
    v_mfma_f32_16x16x32_bf16 a[80:83], v[164:167], v[40:43], a[80:83]
    v_exp_f32 v18, v114
    v_mfma_f32_16x16x32_bf16 a[80:83], v[180:183], v[44:47], a[80:83]
    v_add_f32 v5, v5, v16
    v_add_f32 v5, v5, v17
    v_mfma_f32_16x16x32_bf16 a[128:131], v[168:171], v[40:43], a[128:131]
    ds_read_b128 v[36:39], v22 offset:13824
    v_fma_f32 v235, v235, v57, v59
    v_mfma_f32_16x16x32_bf16 a[128:131], v[184:187], v[44:47], a[128:131]
    v_exp_f32 v19, v115
    v_mfma_f32_16x16x32_bf16 a[176:179], v[172:175], v[40:43], a[176:179]
    v_cvt_pk_bf16_f32 v82, v16, v17
    v_add_u32 v3, s3, v3
    v_mfma_f32_16x16x32_bf16 a[176:179], v[188:191], v[44:47], a[176:179]
    s_waitcnt lgkmcnt(2)
    v_exp_f32 v16, v84
    v_mfma_f32_16x16x32_bf16 a[36:39], v[160:163], v[24:27], a[36:39]
    ds_read_b128 v[40:43], v22 offset:2304
    v_add_f32 v5, v5, v18
    v_mfma_f32_16x16x32_bf16 a[36:39], v[176:179], v[28:31], a[36:39]
    v_add_f32 v5, v5, v19
    v_fma_f32 v238, v238, v56, v58
    v_mfma_f32_16x16x32_bf16 a[84:87], v[164:167], v[24:27], a[84:87]
    v_exp_f32 v17, v85
    v_mfma_f32_16x16x32_bf16 a[84:87], v[180:183], v[28:31], a[84:87]
    s_add_u32 s27, s27, 24576
    v_cvt_pk_bf16_f32 v83, v18, v19
    v_mfma_f32_16x16x32_bf16 a[132:135], v[168:171], v[24:27], a[132:135]
    s_add_u32 s56, s56, 36864
    ds_read_b128 v[44:47], v22 offset:14592
    v_fma_f32 v239, v239, v57, v59
    v_mfma_f32_16x16x32_bf16 a[132:135], v[184:187], v[28:31], a[132:135]
    s_waitcnt lgkmcnt(2)
    v_exp_f32 v18, v86
    v_mfma_f32_16x16x32_bf16 a[180:183], v[172:175], v[24:27], a[180:183]
    s_waitcnt vmcnt(32)
    v_add_f32 v6, v6, v16
    v_add_f32 v6, v6, v17
    v_mfma_f32_16x16x32_bf16 a[180:183], v[188:191], v[28:31], a[180:183]
    s_barrier
    s_sub_u32 s58, s56, 147456
    v_mfma_f32_16x16x32_bf16 a[40:43], v[160:163], v[32:35], a[40:43]
    ds_read_b128 v[24:27], v2 offset:0
    v_mfma_f32_16x16x32_bf16 a[40:43], v[176:179], v[36:39], a[40:43]
    v_exp_f32 v19, v87
    v_mfma_f32_16x16x32_bf16 a[88:91], v[164:167], v[32:35], a[88:91]
    s_min_u32 s56, s56, s58
    v_cvt_pk_bf16_f32 v84, v16, v17
    v_cvt_pk_bf16_f32 v233, v234, v235
    v_mfma_f32_16x16x32_bf16 a[88:91], v[180:183], v[36:39], a[88:91]
    v_exp_f32 v16, v116
    v_mfma_f32_16x16x32_bf16 a[136:139], v[168:171], v[32:35], a[136:139]
    ds_read_b128 v[28:31], v3 offset:0
    v_add_f32 v6, v6, v18
    v_mfma_f32_16x16x32_bf16 a[136:139], v[184:187], v[36:39], a[136:139]
    v_add_f32 v6, v6, v19
    v_mfma_f32_16x16x32_bf16 a[184:187], v[172:175], v[32:35], a[184:187]
    v_exp_f32 v17, v117
    v_mfma_f32_16x16x32_bf16 a[184:187], v[188:191], v[36:39], a[184:187]
    s_waitcnt lgkmcnt(2)
    v_cvt_pk_bf16_f32 v85, v18, v19
    v_cvt_pk_bf16_f32 v237, v238, v239
    v_mfma_f32_16x16x32_bf16 a[44:47], v[160:163], v[40:43], a[44:47]
    ds_read_b128 v[32:35], v2 offset:6144
    v_mfma_f32_16x16x32_bf16 a[44:47], v[176:179], v[44:47], a[44:47]
    v_exp_f32 v18, v118
    v_mfma_f32_16x16x32_bf16 a[92:95], v[164:167], v[40:43], a[92:95]
    v_add_f32 v6, v6, v16
    v_add_f32 v6, v6, v17
    v_mfma_f32_16x16x32_bf16 a[92:95], v[180:183], v[44:47], a[92:95]
    v_exp_f32 v19, v119
    v_mfma_f32_16x16x32_bf16 a[140:143], v[168:171], v[40:43], a[140:143]
    ds_read_b128 v[36:39], v3 offset:6144
    v_cvt_pk_bf16_f32 v86, v16, v17
    v_mfma_f32_16x16x32_bf16 a[140:143], v[184:187], v[44:47], a[140:143]
    v_add_f32 v6, v6, v18
    v_add_f32 v6, v6, v19
    v_mfma_f32_16x16x32_bf16 a[188:191], v[172:175], v[40:43], a[188:191]
    v_cvt_pk_bf16_f32 v87, v18, v19
    v_mfma_f32_16x16x32_bf16 a[188:191], v[188:191], v[44:47], a[188:191]
    s_waitcnt lgkmcnt(2)
    v_mfma_f32_16x16x32_bf16 v[160:163], v[24:27], a[192:195], v[128:131]
    s_mov_b32 m0, s26
    ds_read_b128 v[40:43], v2 offset:128
    v_mfma_f32_16x16x32_bf16 v[160:163], v[28:31], a[196:199], v[160:163]
    v_exp_f32 v16, v88
    v_mfma_f32_16x16x32_bf16 v[164:167], v[24:27], a[216:219], v[132:135]
    v_exp_f32 v17, v89
    v_mfma_f32_16x16x32_bf16 v[164:167], v[28:31], a[220:223], v[164:167]
    ds_read_b128 v[48:51], v10 offset:1152
    v_bfe_u32 v53, v4, 4, 6
    v_mfma_f32_16x16x32_bf16 v[168:171], v[24:27], a[240:243], v[136:139]
    s_waitcnt vmcnt(26)
    ds_read_b128 v[44:47], v3 offset:128
    v_lshlrev_b32 v53, 2, v53
    v_mfma_f32_16x16x32_bf16 v[168:171], v[28:31], a[244:247], v[168:171]
    buffer_load_dwordx4 v4, s[4:7], s32 offen offset:0 sc1 lds
    v_mfma_f32_16x16x32_bf16 v[172:175], v[24:27], v[200:203], v[140:143]
    v_exp_f32 v18, v90
    v_mfma_f32_16x16x32_bf16 v[172:175], v[28:31], v[204:207], v[172:175]
    s_waitcnt lgkmcnt(3)
    v_add_f32 v7, v7, v16
    v_add_f32 v7, v7, v17
    v_mfma_f32_16x16x32_bf16 v[96:99], v[32:35], a[192:195], v[128:131]
    ds_read_b128 v[24:27], v2 offset:6272
    v_cvt_f32_i32 v240, v240
    v_mfma_f32_16x16x32_bf16 v[96:99], v[36:39], a[196:199], v[96:99]
    buffer_load_dword v52, v53, s[20:23], 0 offen sc1
    v_mfma_f32_16x16x32_bf16 v[100:103], v[32:35], a[216:219], v[132:135]
    v_exp_f32 v19, v91
    v_mfma_f32_16x16x32_bf16 v[100:103], v[36:39], a[220:223], v[100:103]
    v_cvt_pk_bf16_f32 v88, v16, v17
    v_cvt_f32_i32 v241, v241
    v_mfma_f32_16x16x32_bf16 v[104:107], v[32:35], a[240:243], v[136:139]
    ds_read_b128 v[28:31], v3 offset:6272
    v_mfma_f32_16x16x32_bf16 v[104:107], v[36:39], a[244:247], v[104:107]
    v_exp_f32 v16, v120
    v_mfma_f32_16x16x32_bf16 v[108:111], v[32:35], v[200:203], v[140:143]
    v_add_f32 v7, v7, v18
    v_add_f32 v7, v7, v19
    v_mfma_f32_16x16x32_bf16 v[108:111], v[36:39], v[204:207], v[108:111]
    s_waitcnt lgkmcnt(2)
    buffer_load_dwordx4 v4, s[4:7], s32 offen offset:1024 sc1 lds
    v_mfma_f32_16x16x32_bf16 v[160:163], v[40:43], a[200:203], v[160:163]
    ds_read_b128 v[32:35], v2 offset:256
    v_cvt_f32_i32 v244, v244
    v_mfma_f32_16x16x32_bf16 v[160:163], v[44:47], a[204:207], v[160:163]
    v_exp_f32 v17, v121
    v_mfma_f32_16x16x32_bf16 v[164:167], v[40:43], a[224:227], v[164:167]
    v_cvt_pk_bf16_f32 v89, v18, v19
    v_mfma_f32_16x16x32_bf16 v[164:167], v[44:47], a[228:231], v[164:167]
    v_exp_f32 v18, v122
    v_mfma_f32_16x16x32_bf16 v[168:171], v[40:43], a[248:251], v[168:171]
    ds_read_b128 v[36:39], v3 offset:256
    v_add_f32 v7, v7, v16
    v_mfma_f32_16x16x32_bf16 v[168:171], v[44:47], a[252:255], v[168:171]
    ds_read_b128 v[56:59], v23 offset:0
    v_add_f32 v7, v7, v17
    v_mfma_f32_16x16x32_bf16 v[172:175], v[40:43], v[208:211], v[172:175]
    v_exp_f32 v19, v123
    v_mfma_f32_16x16x32_bf16 v[172:175], v[44:47], v[212:215], v[172:175]
    s_waitcnt lgkmcnt(3)
    buffer_load_dwordx4 v4, s[4:7], s32 offen offset:2048 sc1 lds
    v_mfma_f32_16x16x32_bf16 v[96:99], v[24:27], a[200:203], v[96:99]
    ds_read_b128 v[40:43], v2 offset:6400
    v_cvt_pk_bf16_f32 v90, v16, v17
    v_mfma_f32_16x16x32_bf16 v[96:99], v[28:31], a[204:207], v[96:99]
    v_exp_f32 v16, v92
    v_mfma_f32_16x16x32_bf16 v[100:103], v[24:27], a[224:227], v[100:103]
    v_add_f32 v7, v7, v18
    v_add_f32 v7, v7, v19
    v_mfma_f32_16x16x32_bf16 v[100:103], v[28:31], a[228:231], v[100:103]
    v_exp_f32 v17, v93
    v_mfma_f32_16x16x32_bf16 v[104:107], v[24:27], a[248:251], v[104:107]
    ds_read_b128 v[44:47], v3 offset:6400
    v_cvt_pk_bf16_f32 v91, v18, v19
    v_mfma_f32_16x16x32_bf16 v[104:107], v[28:31], a[252:255], v[104:107]
    v_exp_f32 v18, v94
    v_mfma_f32_16x16x32_bf16 v[108:111], v[24:27], v[208:211], v[108:111]
    s_add_u32 s29, s30, 49152
    v_add_u32 v10, 1792, v10
    v_add_f32 v8, v8, v16
    v_mfma_f32_16x16x32_bf16 v[108:111], v[28:31], v[212:215], v[108:111]
    s_waitcnt lgkmcnt(3)
    v_add_f32 v8, v8, v17
    s_add_u32 s32, s32, 24576
    v_mfma_f32_16x16x32_bf16 v[160:163], v[32:35], a[208:211], v[160:163]
    s_sub_u32 s3, s29, 147456
    ds_read_b128 v[24:27], v2 offset:12288
    v_cvt_f32_i32 v245, v245
    v_mfma_f32_16x16x32_bf16 v[160:163], v[36:39], a[212:215], v[160:163]
    v_exp_f32 v19, v95
    v_mfma_f32_16x16x32_bf16 v[164:167], v[32:35], a[232:235], v[164:167]
    v_cvt_pk_bf16_f32 v92, v16, v17
    v_mfma_f32_16x16x32_bf16 v[164:167], v[36:39], a[236:239], v[164:167]
    s_add_u32 s26, s26, 12288
    v_exp_f32 v16, v124
    v_mfma_f32_16x16x32_bf16 v[168:171], v[32:35], v[192:195], v[168:171]
    ds_read_b128 v[28:31], v3 offset:12288
    v_fma_f32 v240, v240, v60, v62
    v_mfma_f32_16x16x32_bf16 v[168:171], v[36:39], v[196:199], v[168:171]
    v_add_f32 v8, v8, v18
    v_add_f32 v8, v8, v19
    v_mfma_f32_16x16x32_bf16 v[172:175], v[32:35], v[216:219], v[172:175]
    s_min_u32 s29, s29, s3
    v_mfma_f32_16x16x32_bf16 v[172:175], v[36:39], v[220:223], v[172:175]
    s_waitcnt lgkmcnt(2)
    v_exp_f32 v17, v125
    v_mfma_f32_16x16x32_bf16 v[96:99], v[40:43], a[208:211], v[96:99]
    s_mov_b32 m0, s26
    ds_read_b128 v[32:35], v2 offset:18432
    v_cvt_pk_bf16_f32 v93, v18, v19
    v_mfma_f32_16x16x32_bf16 v[96:99], v[44:47], a[212:215], v[96:99]
    v_exp_f32 v18, v126
    v_mfma_f32_16x16x32_bf16 v[100:103], v[40:43], a[232:235], v[100:103]
    v_fma_f32 v241, v241, v61, v63
    v_mfma_f32_16x16x32_bf16 v[100:103], v[44:47], a[236:239], v[100:103]
    v_add_f32 v8, v8, v16
    v_mfma_f32_16x16x32_bf16 v[104:107], v[40:43], v[192:195], v[104:107]
    s_sub_u32 s3, s29, s30
    ds_read_b128 v[36:39], v3 offset:18432
    v_add_f32 v8, v8, v17
    v_mfma_f32_16x16x32_bf16 v[104:107], v[44:47], v[196:199], v[104:107]
    v_exp_f32 v19, v127
    v_mfma_f32_16x16x32_bf16 v[108:111], v[40:43], v[216:219], v[108:111]
    v_fma_f32 v244, v244, v60, v62
    v_cvt_pk_bf16_f32 v94, v16, v17
    v_mfma_f32_16x16x32_bf16 v[108:111], v[44:47], v[220:223], v[108:111]
    s_waitcnt lgkmcnt(2)
    buffer_load_dwordx4 v4, s[4:7], s32 offen offset:0 sc1 lds
    v_mfma_f32_16x16x32_bf16 v[176:179], v[24:27], a[192:195], v[128:131]
    ds_read_b128 v[40:43], v2 offset:12416
    v_add_f32 v8, v8, v18
    v_mfma_f32_16x16x32_bf16 v[176:179], v[28:31], a[196:199], v[176:179]
    v_add_f32 v8, v8, v19
    v_cvt_pk_bf16_f32 v95, v18, v19
    v_mfma_f32_16x16x32_bf16 v[180:183], v[24:27], a[216:219], v[132:135]
    s_mov_b32 s30, s29
    v_fma_f32 v245, v245, v61, v63
    v_mfma_f32_16x16x32_bf16 v[180:183], v[28:31], a[220:223], v[180:183]
    v_mfma_f32_16x16x32_bf16 v[184:187], v[24:27], a[240:243], v[136:139]
    ds_read_b128 v[44:47], v3 offset:12416
    v_mfma_f32_16x16x32_bf16 v[184:187], v[28:31], a[244:247], v[184:187]
    v_exp_f32 v16, v160
    v_mfma_f32_16x16x32_bf16 v[188:191], v[24:27], v[200:203], v[140:143]
    v_exp_f32 v17, v161
    v_mfma_f32_16x16x32_bf16 v[188:191], v[28:31], v[204:207], v[188:191]
    s_waitcnt lgkmcnt(2)
    v_exp_f32 v18, v162
    v_mfma_f32_16x16x32_bf16 v[112:115], v[32:35], a[192:195], v[128:131]
    ds_read_b128 v[24:27], v2 offset:18560
    v_add_f32 v5, v5, v16
    v_mfma_f32_16x16x32_bf16 v[112:115], v[36:39], a[196:199], v[112:115]
    buffer_load_dwordx4 v4, s[4:7], s32 offen offset:1024 sc1 lds
    v_mfma_f32_16x16x32_bf16 v[116:119], v[32:35], a[216:219], v[132:135]
    v_add_f32 v5, v5, v17
    v_cvt_pk_bf16_f32 v226, v240, v241
    v_mfma_f32_16x16x32_bf16 v[116:119], v[36:39], a[220:223], v[116:119]
    v_exp_f32 v19, v163
    v_mfma_f32_16x16x32_bf16 v[120:123], v[32:35], a[240:243], v[136:139]
    ds_read_b128 v[28:31], v3 offset:18560
    v_cvt_pk_bf16_f32 v160, v16, v17
    v_mfma_f32_16x16x32_bf16 v[120:123], v[36:39], a[244:247], v[120:123]
    v_exp_f32 v16, v96
    v_mfma_f32_16x16x32_bf16 v[124:127], v[32:35], v[200:203], v[140:143]
    v_add_f32 v5, v5, v18
    v_add_u32 v1, s3, v1
    v_mfma_f32_16x16x32_bf16 v[124:127], v[36:39], v[204:207], v[124:127]
    s_waitcnt lgkmcnt(2)
    v_add_f32 v5, v5, v19
    v_cvt_pk_bf16_f32 v230, v244, v245
    v_mfma_f32_16x16x32_bf16 v[176:179], v[40:43], a[200:203], v[176:179]
    ds_read_b128 v[32:35], v2 offset:12544
    v_add_u32 v21, s3, v21
    v_mfma_f32_16x16x32_bf16 v[176:179], v[44:47], a[204:207], v[176:179]
    buffer_load_dwordx4 v4, s[4:7], s32 offen offset:2048 sc1 lds
    v_mfma_f32_16x16x32_bf16 v[180:183], v[40:43], a[224:227], v[180:183]
    v_exp_f32 v17, v97
    v_mfma_f32_16x16x32_bf16 v[180:183], v[44:47], a[228:231], v[180:183]
    v_cvt_pk_bf16_f32 v161, v18, v19
    v_cvt_f32_i32 v242, v242
    v_mfma_f32_16x16x32_bf16 v[184:187], v[40:43], a[248:251], v[184:187]
    ds_read_b128 v[36:39], v3 offset:12544
    v_add_u32 v22, s3, v22
    v_mfma_f32_16x16x32_bf16 v[184:187], v[44:47], a[252:255], v[184:187]
    v_exp_f32 v18, v98
    v_mfma_f32_16x16x32_bf16 v[188:191], v[40:43], v[208:211], v[188:191]
    v_add_f32 v5, v5, v16
    v_add_f32 v5, v5, v17
    v_mfma_f32_16x16x32_bf16 v[188:191], v[44:47], v[212:215], v[188:191]
    s_waitcnt lgkmcnt(2)
    v_exp_f32 v19, v99
    v_mfma_f32_16x16x32_bf16 v[112:115], v[24:27], a[200:203], v[112:115]
    ds_read_b128 v[40:43], v2 offset:18688
    v_cvt_pk_bf16_f32 v162, v16, v17
    v_mfma_f32_16x16x32_bf16 v[112:115], v[28:31], a[204:207], v[112:115]
    v_exp_f32 v16, v164
    v_mfma_f32_16x16x32_bf16 v[116:119], v[24:27], a[224:227], v[116:119]
    v_add_f32 v5, v5, v18
    v_add_f32 v5, v5, v19
    v_mfma_f32_16x16x32_bf16 v[116:119], v[28:31], a[228:231], v[116:119]
    s_add_u32 s32, s32, 24576
    v_exp_f32 v17, v165
    v_mfma_f32_16x16x32_bf16 v[120:123], v[24:27], a[248:251], v[120:123]
    s_add_u32 s26, s26, 36864
    ds_read_b128 v[44:47], v3 offset:18688
    v_cvt_f32_i32 v243, v243
    v_mfma_f32_16x16x32_bf16 v[120:123], v[28:31], a[252:255], v[120:123]
    s_waitcnt lgkmcnt(2)
    v_cvt_pk_bf16_f32 v163, v18, v19
    v_cvt_f32_i32 v246, v246
    v_mfma_f32_16x16x32_bf16 v[124:127], v[24:27], v[208:211], v[124:127]
    s_waitcnt vmcnt(30)
    v_exp_f32 v18, v166
    v_mfma_f32_16x16x32_bf16 v[124:127], v[28:31], v[212:215], v[124:127]
    s_barrier
    v_add_f32 v6, v6, v16
    v_mfma_f32_16x16x32_bf16 v[176:179], v[32:35], a[208:211], v[176:179]
    s_sub_u32 s57, s26, 147456
    ds_read_b128 v[24:27], v1 offset:0
    v_add_f32 v6, v6, v17
    v_mfma_f32_16x16x32_bf16 v[176:179], v[36:39], a[212:215], v[176:179]
    buffer_load_dword v15, v4, s[88:91], s93 offen
    v_mfma_f32_16x16x32_bf16 v[180:183], v[32:35], a[232:235], v[180:183]
    s_min_u32 s26, s26, s57
    v_exp_f32 v19, v167
    v_mfma_f32_16x16x32_bf16 v[180:183], v[36:39], a[236:239], v[180:183]
    v_cvt_pk_bf16_f32 v164, v16, v17
    v_cvt_f32_i32 v247, v247
    v_mfma_f32_16x16x32_bf16 v[184:187], v[32:35], v[192:195], v[184:187]
    ds_read_b128 v[28:31], v1 offset:12288
    v_fma_f32 v242, v242, v48, v50
    v_mfma_f32_16x16x32_bf16 v[184:187], v[36:39], v[196:199], v[184:187]
    v_exp_f32 v16, v100
    v_mfma_f32_16x16x32_bf16 v[188:191], v[32:35], v[216:219], v[188:191]
    v_add_f32 v6, v6, v18
    v_add_f32 v6, v6, v19
    v_mfma_f32_16x16x32_bf16 v[188:191], v[36:39], v[220:223], v[188:191]
    s_waitcnt lgkmcnt(2)
    v_exp_f32 v17, v101
    v_mfma_f32_16x16x32_bf16 v[112:115], v[40:43], a[208:211], v[112:115]
    ds_read_b128 v[32:35], v1 offset:768
    v_cvt_pk_bf16_f32 v165, v18, v19
    v_mfma_f32_16x16x32_bf16 v[112:115], v[44:47], a[212:215], v[112:115]
    v_exp_f32 v18, v102
    v_mfma_f32_16x16x32_bf16 v[116:119], v[40:43], a[232:235], v[116:119]
    v_add_f32 v6, v6, v16
    v_add_f32 v6, v6, v17
    v_mfma_f32_16x16x32_bf16 v[116:119], v[44:47], a[236:239], v[116:119]
    v_exp_f32 v19, v103
    v_mfma_f32_16x16x32_bf16 v[120:123], v[40:43], v[192:195], v[120:123]
    ds_read_b128 v[36:39], v1 offset:13056
    v_fma_f32 v243, v243, v49, v51
    v_mfma_f32_16x16x32_bf16 v[120:123], v[44:47], v[196:199], v[120:123]
    v_cvt_pk_bf16_f32 v166, v16, v17
    v_add_f32 v6, v6, v18
    v_mfma_f32_16x16x32_bf16 v[124:127], v[40:43], v[216:219], v[124:127]
    v_add_f32 v6, v6, v19
    v_cvt_pk_bf16_f32 v167, v18, v19
    v_mfma_f32_16x16x32_bf16 v[124:127], v[44:47], v[220:223], v[124:127]
    s_waitcnt lgkmcnt(2)
L_join:
    v_mfma_f32_16x16x32_bf16 a[0:3], v[64:67], v[24:27], a[0:3]
    ds_read_b128 v[40:43], v1 offset:1536
    v_fma_f32 v246, v246, v48, v50
    v_mfma_f32_16x16x32_bf16 a[0:3], v[80:83], v[28:31], a[0:3]
    s_waitcnt vmcnt(0)
    v_subrev_u32 v52, s92, v52
    v_cmp_lt_u32 vcc, 15, v52
    v_mfma_f32_16x16x32_bf16 a[48:51], v[68:71], v[24:27], a[48:51]
    v_exp_f32 v16, v168
    v_mfma_f32_16x16x32_bf16 a[48:51], v[84:87], v[28:31], a[48:51]
    v_exp_f32 v17, v169
    v_mfma_f32_16x16x32_bf16 a[96:99], v[72:75], v[24:27], a[96:99]
    s_and_b32 s59, vcc_lo, 0xff
    ds_read_b128 v[44:47], v1 offset:13824
    v_fma_f32 v247, v247, v49, v51
    v_mfma_f32_16x16x32_bf16 a[96:99], v[88:91], v[28:31], a[96:99]
    s_cbranch_scc1 L_pollslow4
L_pollok4:
    v_mfma_f32_16x16x32_bf16 a[144:147], v[76:79], v[24:27], a[144:147]
    s_add_u32 s92, s92, 1
    v_exp_f32 v18, v170
    v_mfma_f32_16x16x32_bf16 a[144:147], v[92:95], v[28:31], a[144:147]
    s_waitcnt lgkmcnt(2)
    v_add_f32 v7, v7, v16
    v_add_f32 v7, v7, v17
    v_mfma_f32_16x16x32_bf16 a[4:7], v[64:67], v[32:35], a[4:7]
    s_mov_b32 m0, s56
    ds_read_b128 v[24:27], v1 offset:2304
    v_cvt_pk_bf16_f32 v227, v242, v243
    v_mfma_f32_16x16x32_bf16 a[4:7], v[80:83], v[36:39], a[4:7]
    v_exp_f32 v19, v171
    v_mfma_f32_16x16x32_bf16 a[52:55], v[68:71], v[32:35], a[52:55]
    v_cvt_pk_bf16_f32 v168, v16, v17
    v_mfma_f32_16x16x32_bf16 a[52:55], v[84:87], v[36:39], a[52:55]
    buffer_load_dwordx4 v4, s[4:7], s27 offen offset:0 sc1 lds
    v_mfma_f32_16x16x32_bf16 a[100:103], v[72:75], v[32:35], a[100:103]
    ds_read_b128 v[28:31], v1 offset:14592
    v_mfma_f32_16x16x32_bf16 a[100:103], v[88:91], v[36:39], a[100:103]
    v_exp_f32 v16, v104
    v_mfma_f32_16x16x32_bf16 a[148:151], v[76:79], v[32:35], a[148:151]
    v_add_f32 v7, v7, v18
    v_add_f32 v7, v7, v19
    v_mfma_f32_16x16x32_bf16 a[148:151], v[92:95], v[36:39], a[148:151]
    s_waitcnt lgkmcnt(2)
    v_exp_f32 v17, v105
    v_mfma_f32_16x16x32_bf16 a[8:11], v[64:67], v[40:43], a[8:11]
    ds_read_b128 v[32:35], v21 offset:0
    v_cvt_pk_bf16_f32 v169, v18, v19
    v_mfma_f32_16x16x32_bf16 a[8:11], v[80:83], v[44:47], a[8:11]
    buffer_load_dwordx4 v4, s[4:7], s27 offen offset:1024 sc1 lds
    v_mfma_f32_16x16x32_bf16 a[56:59], v[68:71], v[40:43], a[56:59]
    v_exp_f32 v18, v106
    v_mfma_f32_16x16x32_bf16 a[56:59], v[84:87], v[44:47], a[56:59]
    v_add_f32 v7, v7, v16
    v_add_f32 v7, v7, v17
    v_mfma_f32_16x16x32_bf16 a[104:107], v[72:75], v[40:43], a[104:107]
    ds_read_b128 v[36:39], v21 offset:12288
    v_cvt_pk_bf16_f32 v231, v246, v247
    v_mfma_f32_16x16x32_bf16 a[104:107], v[88:91], v[44:47], a[104:107]
    s_waitcnt vmcnt(20)
    v_exp_f32 v19, v107
    v_mfma_f32_16x16x32_bf16 a[152:155], v[76:79], v[40:43], a[152:155]
    v_cvt_pk_bf16_f32 v170, v16, v17
    v_mfma_f32_16x16x32_bf16 a[152:155], v[92:95], v[44:47], a[152:155]
    s_waitcnt lgkmcnt(2)
    buffer_load_dwordx4 v4, s[4:7], s27 offen offset:2048 sc1 lds
    v_mfma_f32_16x16x32_bf16 a[12:15], v[64:67], v[24:27], a[12:15]
    ds_read_b128 v[40:43], v21 offset:768
    v_mfma_f32_16x16x32_bf16 a[12:15], v[80:83], v[28:31], a[12:15]
    v_exp_f32 v16, v172
    v_mfma_f32_16x16x32_bf16 a[60:63], v[68:71], v[24:27], a[60:63]
    v_add_f32 v7, v7, v18
    v_add_f32 v7, v7, v19
    v_mfma_f32_16x16x32_bf16 a[60:63], v[84:87], v[28:31], a[60:63]
    v_exp_f32 v17, v173
    v_mfma_f32_16x16x32_bf16 a[108:111], v[72:75], v[24:27], a[108:111]
    s_add_u32 s27, s27, 24576
    ds_read_b128 v[44:47], v21 offset:13056
    v_cvt_pk_bf16_f32 v171, v18, v19
    v_mfma_f32_16x16x32_bf16 a[108:111], v[88:91], v[28:31], a[108:111]
    v_exp_f32 v18, v174
    v_mfma_f32_16x16x32_bf16 a[156:159], v[76:79], v[24:27], a[156:159]
    s_add_u32 s29, s28, 49152
    v_add_f32 v8, v8, v16
    v_add_f32 v8, v8, v17
    v_mfma_f32_16x16x32_bf16 a[156:159], v[92:95], v[28:31], a[156:159]
    s_waitcnt lgkmcnt(2)
    v_exp_f32 v19, v175
    v_mfma_f32_16x16x32_bf16 a[16:19], v[64:67], v[32:35], a[16:19]
    s_add_u32 s56, s56, 12288
    ds_read_b128 v[24:27], v21 offset:1536
    v_cvt_pk_bf16_f32 v172, v16, v17
    v_mfma_f32_16x16x32_bf16 a[16:19], v[80:83], v[36:39], a[16:19]
    s_sub_u32 s3, s29, 147456
    v_cvt_f32_i32 v248, v248
    v_cvt_f32_i32 v249, v249
    v_mfma_f32_16x16x32_bf16 a[64:67], v[68:71], v[32:35], a[64:67]
    v_exp_f32 v16, v108
    v_mfma_f32_16x16x32_bf16 a[64:67], v[84:87], v[36:39], a[64:67]
    s_mov_b32 m0, s56
    v_add_f32 v8, v8, v18
    v_add_f32 v8, v8, v19
    v_mfma_f32_16x16x32_bf16 a[112:115], v[72:75], v[32:35], a[112:115]
    ds_read_b128 v[28:31], v21 offset:13824
    v_mfma_f32_16x16x32_bf16 a[112:115], v[88:91], v[36:39], a[112:115]
    v_exp_f32 v17, v109
    v_mfma_f32_16x16x32_bf16 a[160:163], v[76:79], v[32:35], a[160:163]
    v_cvt_pk_bf16_f32 v173, v18, v19
    v_cvt_f32_i32 v252, v252
    v_mfma_f32_16x16x32_bf16 a[160:163], v[92:95], v[36:39], a[160:163]
    s_waitcnt lgkmcnt(2)
    buffer_load_dwordx4 v4, s[4:7], s27 offen offset:0 sc1 lds
    v_mfma_f32_16x16x32_bf16 a[20:23], v[64:67], v[40:43], a[20:23]
    s_min_u32 s29, s29, s3
    ds_read_b128 v[32:35], v21 offset:2304
    v_mfma_f32_16x16x32_bf16 a[20:23], v[80:83], v[44:47], a[20:23]
    v_exp_f32 v18, v110
    v_mfma_f32_16x16x32_bf16 a[68:71], v[68:71], v[40:43], a[68:71]
    v_add_f32 v8, v8, v16
    v_add_f32 v8, v8, v17
    v_mfma_f32_16x16x32_bf16 a[68:71], v[84:87], v[44:47], a[68:71]
    v_exp_f32 v19, v111
    v_mfma_f32_16x16x32_bf16 a[116:119], v[72:75], v[40:43], a[116:119]
    ds_read_b128 v[36:39], v21 offset:14592
    v_cvt_pk_bf16_f32 v174, v16, v17
    v_mfma_f32_16x16x32_bf16 a[116:119], v[88:91], v[44:47], a[116:119]
    v_add_f32 v8, v8, v18
    v_cvt_f32_i32 v253, v253
    v_mfma_f32_16x16x32_bf16 a[164:167], v[76:79], v[40:43], a[164:167]
    s_sub_u32 s3, s29, s28
    v_add_f32 v8, v8, v19
    v_cvt_pk_bf16_f32 v175, v18, v19
    v_mfma_f32_16x16x32_bf16 a[164:167], v[92:95], v[44:47], a[164:167]
    s_waitcnt lgkmcnt(2)
    buffer_load_dwordx4 v4, s[4:7], s27 offen offset:1024 sc1 lds
    v_mfma_f32_16x16x32_bf16 a[24:27], v[64:67], v[24:27], a[24:27]
    ds_read_b128 v[40:43], v22 offset:0
    v_mfma_f32_16x16x32_bf16 a[24:27], v[80:83], v[28:31], a[24:27]
    v_exp_f32 v16, v176
    v_mfma_f32_16x16x32_bf16 a[72:75], v[68:71], v[24:27], a[72:75]
    v_exp_f32 v17, v177
    v_mfma_f32_16x16x32_bf16 a[72:75], v[84:87], v[28:31], a[72:75]
    v_exp_f32 v18, v178
    v_mfma_f32_16x16x32_bf16 a[120:123], v[72:75], v[24:27], a[120:123]
    ds_read_b128 v[44:47], v22 offset:12288
    v_add_f32 v5, v5, v16
    v_mfma_f32_16x16x32_bf16 a[120:123], v[88:91], v[28:31], a[120:123]
    s_mov_b32 s28, s29
    buffer_load_dwordx4 v4, s[4:7], s27 offen offset:2048 sc1 lds
    v_mfma_f32_16x16x32_bf16 a[168:171], v[76:79], v[24:27], a[168:171]
    v_add_f32 v5, v5, v17
    v_fma_f32 v248, v248, v60, v62
    v_mfma_f32_16x16x32_bf16 a[168:171], v[92:95], v[28:31], a[168:171]
    s_waitcnt lgkmcnt(2)
    v_exp_f32 v19, v179
    v_mfma_f32_16x16x32_bf16 a[28:31], v[64:67], v[32:35], a[28:31]
    ds_read_b128 v[24:27], v22 offset:768
    v_cvt_pk_bf16_f32 v176, v16, v17
    v_mfma_f32_16x16x32_bf16 a[28:31], v[80:83], v[36:39], a[28:31]
    v_exp_f32 v16, v112
    v_mfma_f32_16x16x32_bf16 a[76:79], v[68:71], v[32:35], a[76:79]
    v_fma_f32 v249, v249, v61, v63
    v_add_f32 v5, v5, v18
    v_mfma_f32_16x16x32_bf16 a[76:79], v[84:87], v[36:39], a[76:79]
    s_add_u32 s27, s27, 24576
    v_add_f32 v5, v5, v19
    v_mfma_f32_16x16x32_bf16 a[124:127], v[72:75], v[32:35], a[124:127]
    ds_read_b128 v[28:31], v22 offset:13056
    v_add_u32 v2, s3, v2
    v_mfma_f32_16x16x32_bf16 a[124:127], v[88:91], v[36:39], a[124:127]
    s_add_u32 s56, s56, 36864
    buffer_load_dwordx4 v[240:243], v12, s[68:71], s36 offen offset:0 nt
    v_mfma_f32_16x16x32_bf16 a[172:175], v[76:79], v[32:35], a[172:175]
    v_exp_f32 v17, v113
    v_mfma_f32_16x16x32_bf16 a[172:175], v[92:95], v[36:39], a[172:175]
    s_waitcnt lgkmcnt(2)
    v_cvt_pk_bf16_f32 v177, v18, v19
    v_fma_f32 v252, v252, v60, v62
    v_mfma_f32_16x16x32_bf16 a[32:35], v[64:67], v[40:43], a[32:35]
    s_sub_u32 s58, s56, 147456
    ds_read_b128 v[32:35], v22 offset:1536
    v_mfma_f32_16x16x32_bf16 a[32:35], v[80:83], v[44:47], a[32:35]
    v_exp_f32 v18, v114
    v_mfma_f32_16x16x32_bf16 a[80:83], v[68:71], v[40:43], a[80:83]
    s_min_u32 s56, s56, s58
    v_add_f32 v5, v5, v16
    v_add_f32 v5, v5, v17
    v_mfma_f32_16x16x32_bf16 a[80:83], v[84:87], v[44:47], a[80:83]
    v_exp_f32 v19, v115
    v_mfma_f32_16x16x32_bf16 a[128:131], v[72:75], v[40:43], a[128:131]
    ds_read_b128 v[36:39], v22 offset:13824
    v_cvt_pk_bf16_f32 v178, v16, v17
    v_mfma_f32_16x16x32_bf16 a[128:131], v[88:91], v[44:47], a[128:131]
    v_exp_f32 v16, v180
    v_mfma_f32_16x16x32_bf16 a[176:179], v[76:79], v[40:43], a[176:179]
    v_add_u32 v3, s3, v3
    v_fma_f32 v253, v253, v61, v63
    v_mfma_f32_16x16x32_bf16 a[176:179], v[92:95], v[44:47], a[176:179]
    s_waitcnt lgkmcnt(2)
    v_add_f32 v5, v5, v18
    v_add_f32 v5, v5, v19
    v_mfma_f32_16x16x32_bf16 a[36:39], v[64:67], v[24:27], a[36:39]
    ds_read_b128 v[40:43], v22 offset:2304
    v_mfma_f32_16x16x32_bf16 a[36:39], v[80:83], v[28:31], a[36:39]
    v_exp_f32 v17, v181
    v_mfma_f32_16x16x32_bf16 a[84:87], v[68:71], v[24:27], a[84:87]
    v_cvt_pk_bf16_f32 v179, v18, v19
    v_cvt_pk_bf16_f32 v234, v248, v249
    v_mfma_f32_16x16x32_bf16 a[84:87], v[84:87], v[28:31], a[84:87]
    buffer_load_dwordx4 v[244:247], v12, s[68:71], s36 offen offset:768 nt
    v_mfma_f32_16x16x32_bf16 a[132:135], v[72:75], v[24:27], a[132:135]
    ds_read_b128 v[44:47], v22 offset:14592
    v_mfma_f32_16x16x32_bf16 a[132:135], v[88:91], v[28:31], a[132:135]
    s_waitcnt lgkmcnt(2)
    v_exp_f32 v18, v182
    v_mfma_f32_16x16x32_bf16 a[180:183], v[76:79], v[24:27], a[180:183]
    s_waitcnt vmcnt(27)
    v_add_f32 v6, v6, v16
    v_add_f32 v6, v6, v17
    v_mfma_f32_16x16x32_bf16 a[180:183], v[92:95], v[28:31], a[180:183]
    s_barrier
    v_mfma_f32_16x16x32_bf16 a[40:43], v[64:67], v[32:35], a[40:43]
    ds_read_b128 v[24:27], v2 offset:0
    v_cvt_pk_bf16_f32 v238, v252, v253
    v_mfma_f32_16x16x32_bf16 a[40:43], v[80:83], v[36:39], a[40:43]
    v_exp_f32 v19, v183
    v_mfma_f32_16x16x32_bf16 a[88:91], v[68:71], v[32:35], a[88:91]
    v_cvt_pk_bf16_f32 v180, v16, v17
    v_mfma_f32_16x16x32_bf16 a[88:91], v[84:87], v[36:39], a[88:91]
    v_exp_f32 v16, v116
    v_mfma_f32_16x16x32_bf16 a[136:139], v[72:75], v[32:35], a[136:139]
    ds_read_b128 v[28:31], v3 offset:0
    v_add_f32 v6, v6, v18
    v_mfma_f32_16x16x32_bf16 a[136:139], v[88:91], v[36:39], a[136:139]
    v_add_f32 v6, v6, v19
    v_mfma_f32_16x16x32_bf16 a[184:187], v[76:79], v[32:35], a[184:187]
    v_exp_f32 v17, v117
    v_mfma_f32_16x16x32_bf16 a[184:187], v[92:95], v[36:39], a[184:187]
    s_waitcnt lgkmcnt(2)
    v_cvt_pk_bf16_f32 v181, v18, v19
    v_cvt_f32_i32 v250, v250
    v_mfma_f32_16x16x32_bf16 a[44:47], v[64:67], v[40:43], a[44:47]
    ds_read_b128 v[32:35], v2 offset:6144
    v_mfma_f32_16x16x32_bf16 a[44:47], v[80:83], v[44:47], a[44:47]
    v_exp_f32 v18, v118
    v_mfma_f32_16x16x32_bf16 a[92:95], v[68:71], v[40:43], a[92:95]
    v_add_f32 v6, v6, v16
    v_add_f32 v6, v6, v17
    v_mfma_f32_16x16x32_bf16 a[92:95], v[84:87], v[44:47], a[92:95]
    v_exp_f32 v19, v119
    v_mfma_f32_16x16x32_bf16 a[140:143], v[72:75], v[40:43], a[140:143]
    ds_read_b128 v[36:39], v3 offset:6144
    v_cvt_pk_bf16_f32 v182, v16, v17
    v_mfma_f32_16x16x32_bf16 a[140:143], v[88:91], v[44:47], a[140:143]
    v_add_f32 v6, v6, v18
    v_add_f32 v6, v6, v19
    v_mfma_f32_16x16x32_bf16 a[188:191], v[76:79], v[40:43], a[188:191]
    v_cvt_pk_bf16_f32 v183, v18, v19
    v_mfma_f32_16x16x32_bf16 a[188:191], v[92:95], v[44:47], a[188:191]
    s_waitcnt lgkmcnt(2)
    v_mfma_f32_16x16x32_bf16 v[64:67], v[24:27], a[192:195], v[128:131]
    s_mov_b32 m0, s26
    ds_read_b128 v[40:43], v2 offset:128
    v_cvt_f32_i32 v251, v251
    v_mfma_f32_16x16x32_bf16 v[64:67], v[28:31], a[196:199], v[64:67]
    v_exp_f32 v16, v184
    v_mfma_f32_16x16x32_bf16 v[68:71], v[24:27], a[216:219], v[132:135]
    v_exp_f32 v17, v185
    v_mfma_f32_16x16x32_bf16 v[68:71], v[28:31], a[220:223], v[68:71]
    buffer_load_dwordx4 v4, s[4:7], s32 offen offset:0 sc1 lds
    v_mfma_f32_16x16x32_bf16 v[72:75], v[24:27], a[240:243], v[136:139]
    ds_read_b128 v[44:47], v3 offset:128
    v_cvt_f32_i32 v254, v254
    v_mfma_f32_16x16x32_bf16 v[72:75], v[28:31], a[244:247], v[72:75]
    v_exp_f32 v18, v186
    v_mfma_f32_16x16x32_bf16 v[76:79], v[24:27], v[200:203], v[140:143]
    v_add_f32 v7, v7, v16
    v_add_f32 v7, v7, v17
    v_mfma_f32_16x16x32_bf16 v[76:79], v[28:31], v[204:207], v[76:79]
    s_waitcnt lgkmcnt(2)
    v_exp_f32 v19, v187
    v_mfma_f32_16x16x32_bf16 v[96:99], v[32:35], a[192:195], v[128:131]
    ds_read_b128 v[24:27], v2 offset:6272
    v_cvt_pk_bf16_f32 v184, v16, v17
    v_mfma_f32_16x16x32_bf16 v[96:99], v[36:39], a[196:199], v[96:99]
    buffer_load_dwordx4 v4, s[4:7], s32 offen offset:1024 sc1 lds
    v_mfma_f32_16x16x32_bf16 v[100:103], v[32:35], a[216:219], v[132:135]
    v_exp_f32 v16, v120
    v_mfma_f32_16x16x32_bf16 v[100:103], v[36:39], a[220:223], v[100:103]
    v_add_f32 v7, v7, v18
    v_cvt_f32_i32 v255, v255
    v_mfma_f32_16x16x32_bf16 v[104:107], v[32:35], a[240:243], v[136:139]
    ds_read_b128 v[28:31], v3 offset:6272
    v_add_f32 v7, v7, v19
    v_mfma_f32_16x16x32_bf16 v[104:107], v[36:39], a[244:247], v[104:107]
    v_exp_f32 v17, v121
    v_mfma_f32_16x16x32_bf16 v[108:111], v[32:35], v[200:203], v[140:143]
    v_mfma_f32_16x16x32_bf16 v[108:111], v[36:39], v[204:207], v[108:111]
    s_waitcnt lgkmcnt(2)
    buffer_load_dwordx4 v4, s[4:7], s32 offen offset:2048 sc1 lds
    v_mfma_f32_16x16x32_bf16 v[64:67], v[40:43], a[200:203], v[64:67]
    ds_read_b128 v[32:35], v2 offset:256
    v_cvt_pk_bf16_f32 v185, v18, v19
    v_mfma_f32_16x16x32_bf16 v[64:67], v[44:47], a[204:207], v[64:67]
    v_exp_f32 v18, v122
    v_mfma_f32_16x16x32_bf16 v[68:71], v[40:43], a[224:227], v[68:71]
    v_add_f32 v7, v7, v16
    v_fma_f32 v250, v250, v48, v50
    v_mfma_f32_16x16x32_bf16 v[68:71], v[44:47], a[228:231], v[68:71]
    v_add_f32 v7, v7, v17
    v_mfma_f32_16x16x32_bf16 v[72:75], v[40:43], a[248:251], v[72:75]
    s_add_u32 s32, s32, 24576
    ds_read_b128 v[36:39], v3 offset:256
    v_mfma_f32_16x16x32_bf16 v[72:75], v[44:47], a[252:255], v[72:75]
    v_exp_f32 v19, v123
    v_mfma_f32_16x16x32_bf16 v[76:79], v[40:43], v[208:211], v[76:79]
    v_cvt_pk_bf16_f32 v186, v16, v17
    v_fma_f32 v251, v251, v49, v51
    v_mfma_f32_16x16x32_bf16 v[76:79], v[44:47], v[212:215], v[76:79]
    s_waitcnt lgkmcnt(2)
    v_exp_f32 v16, v188
    v_mfma_f32_16x16x32_bf16 v[96:99], v[24:27], a[200:203], v[96:99]
    s_add_u32 s26, s26, 12288
    ds_read_b128 v[40:43], v2 offset:6400
    v_add_f32 v7, v7, v18
    v_mfma_f32_16x16x32_bf16 v[96:99], v[28:31], a[204:207], v[96:99]
    v_add_f32 v7, v7, v19
    v_mfma_f32_16x16x32_bf16 v[100:103], v[24:27], a[224:227], v[100:103]
    v_exp_f32 v17, v189
    v_mfma_f32_16x16x32_bf16 v[100:103], v[28:31], a[228:231], v[100:103]
    s_mov_b32 m0, s26
    v_cvt_pk_bf16_f32 v187, v18, v19
    v_fma_f32 v254, v254, v48, v50
    v_mfma_f32_16x16x32_bf16 v[104:107], v[24:27], a[248:251], v[104:107]
    ds_read_b128 v[44:47], v3 offset:6400
    v_mfma_f32_16x16x32_bf16 v[104:107], v[28:31], a[252:255], v[104:107]
    v_exp_f32 v18, v190
    v_mfma_f32_16x16x32_bf16 v[108:111], v[24:27], v[208:211], v[108:111]
    s_add_u32 s29, s30, 49152
    v_add_f32 v8, v8, v16
    v_mfma_f32_16x16x32_bf16 v[108:111], v[28:31], v[212:215], v[108:111]
    s_waitcnt lgkmcnt(2)
    buffer_load_dwordx4 v4, s[4:7], s32 offen offset:0 sc1 lds
    v_mfma_f32_16x16x32_bf16 v[64:67], v[32:35], a[208:211], v[64:67]
    s_sub_u32 s3, s29, 147456
    ds_read_b128 v[24:27], v2 offset:12288
    v_add_f32 v8, v8, v17
    v_mfma_f32_16x16x32_bf16 v[64:67], v[36:39], a[212:215], v[64:67]
    v_exp_f32 v19, v191
    v_mfma_f32_16x16x32_bf16 v[68:71], v[32:35], a[232:235], v[68:71]
    v_cvt_pk_bf16_f32 v188, v16, v17
    v_fma_f32 v255, v255, v49, v51
    v_mfma_f32_16x16x32_bf16 v[68:71], v[36:39], a[236:239], v[68:71]
    v_exp_f32 v16, v124
    v_mfma_f32_16x16x32_bf16 v[72:75], v[32:35], v[192:195], v[72:75]
    ds_read_b128 v[28:31], v3 offset:12288
    v_add_f32 v8, v8, v18
    v_mfma_f32_16x16x32_bf16 v[72:75], v[36:39], v[196:199], v[72:75]
    v_add_f32 v8, v8, v19
    v_mfma_f32_16x16x32_bf16 v[76:79], v[32:35], v[216:219], v[76:79]
    s_min_u32 s29, s29, s3
    v_mfma_f32_16x16x32_bf16 v[76:79], v[36:39], v[220:223], v[76:79]
    s_waitcnt lgkmcnt(2)
    buffer_load_dwordx4 v4, s[4:7], s32 offen offset:1024 sc1 lds
    v_mfma_f32_16x16x32_bf16 v[96:99], v[40:43], a[208:211], v[96:99]
    ds_read_b128 v[32:35], v2 offset:18432
    v_cvt_pk_bf16_f32 v235, v250, v251
    v_mfma_f32_16x16x32_bf16 v[96:99], v[44:47], a[212:215], v[96:99]
    v_exp_f32 v17, v125
    v_mfma_f32_16x16x32_bf16 v[100:103], v[40:43], a[232:235], v[100:103]
    v_cvt_pk_bf16_f32 v189, v18, v19
    v_mfma_f32_16x16x32_bf16 v[100:103], v[44:47], a[236:239], v[100:103]
    v_exp_f32 v18, v126
    v_mfma_f32_16x16x32_bf16 v[104:107], v[40:43], v[192:195], v[104:107]
    s_sub_u32 s3, s29, s30
    ds_read_b128 v[36:39], v3 offset:18432
    v_add_f32 v8, v8, v16
    v_mfma_f32_16x16x32_bf16 v[104:107], v[44:47], v[196:199], v[104:107]
    buffer_load_dwordx4 v4, s[4:7], s32 offen offset:2048 sc1 lds
    v_mfma_f32_16x16x32_bf16 v[108:111], v[40:43], v[216:219], v[108:111]
    v_add_f32 v8, v8, v17
    v_cvt_pk_bf16_f32 v239, v254, v255
    v_mfma_f32_16x16x32_bf16 v[108:111], v[44:47], v[220:223], v[108:111]
    s_waitcnt lgkmcnt(2)
    v_exp_f32 v19, v127
    v_mfma_f32_16x16x32_bf16 v[80:83], v[24:27], a[192:195], v[128:131]
    ds_read_b128 v[40:43], v2 offset:12416
    v_cvt_pk_bf16_f32 v190, v16, v17
    v_mfma_f32_16x16x32_bf16 v[80:83], v[28:31], a[196:199], v[80:83]
    v_add_f32 v8, v8, v18
    v_add_f32 v8, v8, v19
    v_mfma_f32_16x16x32_bf16 v[84:87], v[24:27], a[216:219], v[132:135]
    s_mov_b32 s30, s29
    v_cvt_pk_bf16_f32 v191, v18, v19
    v_mfma_f32_16x16x32_bf16 v[84:87], v[28:31], a[220:223], v[84:87]
    s_add_u32 s32, s32, 24576
    v_mfma_f32_16x16x32_bf16 v[88:91], v[24:27], a[240:243], v[136:139]
    s_add_u32 s26, s26, 36864
    ds_read_b128 v[44:47], v3 offset:12416
    v_mfma_f32_16x16x32_bf16 v[88:91], v[28:31], a[244:247], v[88:91]
    v_exp_f32 v16, v64
    v_mfma_f32_16x16x32_bf16 v[92:95], v[24:27], v[200:203], v[140:143]
    v_exp_f32 v17, v65
    v_mfma_f32_16x16x32_bf16 v[92:95], v[28:31], v[204:207], v[92:95]
    s_waitcnt lgkmcnt(2)
    v_exp_f32 v18, v66
    v_mfma_f32_16x16x32_bf16 v[112:115], v[32:35], a[192:195], v[128:131]
    s_sub_u32 s57, s26, 147456
    ds_read_b128 v[24:27], v2 offset:18560
    v_add_f32 v5, v5, v16
    v_mfma_f32_16x16x32_bf16 v[112:115], v[36:39], a[196:199], v[112:115]
    buffer_store_dwordx4 v[224:227], v11, s[4:7], s37 offen offset:0 sc1
    v_mfma_f32_16x16x32_bf16 v[116:119], v[32:35], a[216:219], v[132:135]
    s_min_u32 s26, s26, s57
    v_add_f32 v5, v5, v17
    v_add_u32 v1, s3, v1
    v_mfma_f32_16x16x32_bf16 v[116:119], v[36:39], a[220:223], v[116:119]
    v_exp_f32 v19, v67
    v_mfma_f32_16x16x32_bf16 v[120:123], v[32:35], a[240:243], v[136:139]
    ds_read_b128 v[28:31], v3 offset:18560
    v_cvt_pk_bf16_f32 v64, v16, v17
    v_mfma_f32_16x16x32_bf16 v[120:123], v[36:39], a[244:247], v[120:123]
    v_exp_f32 v16, v96
    v_mfma_f32_16x16x32_bf16 v[124:127], v[32:35], v[200:203], v[140:143]
    v_add_f32 v5, v5, v18
    v_add_f32 v5, v5, v19
    v_mfma_f32_16x16x32_bf16 v[124:127], v[36:39], v[204:207], v[124:127]
    s_waitcnt lgkmcnt(2)
    v_exp_f32 v17, v97
    v_mfma_f32_16x16x32_bf16 v[80:83], v[40:43], a[200:203], v[80:83]
    ds_read_b128 v[32:35], v2 offset:12544
    v_add_u32 v21, s3, v21
    v_mfma_f32_16x16x32_bf16 v[80:83], v[44:47], a[204:207], v[80:83]
    buffer_store_dwordx4 v[228:231], v54, s[4:7], s37 offen offset:768 sc1
    v_mfma_f32_16x16x32_bf16 v[84:87], v[40:43], a[224:227], v[84:87]
    ds_read_b128 v[60:63], v23 offset:16
    v_cvt_pk_bf16_f32 v65, v18, v19
    v_mfma_f32_16x16x32_bf16 v[84:87], v[44:47], a[228:231], v[84:87]
    s_waitcnt vmcnt(29)
    v_exp_f32 v18, v98
    v_mfma_f32_16x16x32_bf16 v[88:91], v[40:43], a[248:251], v[88:91]
    ds_read_b128 v[36:39], v3 offset:12544
    v_add_f32 v5, v5, v16
    v_mfma_f32_16x16x32_bf16 v[88:91], v[44:47], a[252:255], v[88:91]
    v_add_f32 v5, v5, v17
    v_cvt_f32_i32 v144, v144
    v_mfma_f32_16x16x32_bf16 v[92:95], v[40:43], v[208:211], v[92:95]
    v_exp_f32 v19, v99
    v_mfma_f32_16x16x32_bf16 v[92:95], v[44:47], v[212:215], v[92:95]
    s_waitcnt lgkmcnt(3)
    v_cvt_pk_bf16_f32 v66, v16, v17
    v_cvt_f32_i32 v148, v148
    v_mfma_f32_16x16x32_bf16 v[112:115], v[24:27], a[200:203], v[112:115]
    ds_read_b128 v[40:43], v2 offset:18688
    v_cvt_f32_i32 v145, v145
    v_mfma_f32_16x16x32_bf16 v[112:115], v[28:31], a[204:207], v[112:115]
    buffer_store_dwordx4 v[232:235], v11, s[4:7], s80 offen offset:0 sc1
    v_mfma_f32_16x16x32_bf16 v[116:119], v[24:27], a[224:227], v[116:119]
    v_exp_f32 v16, v68
    v_mfma_f32_16x16x32_bf16 v[116:119], v[28:31], a[228:231], v[116:119]
    v_add_f32 v5, v5, v18
    v_add_f32 v5, v5, v19
    v_mfma_f32_16x16x32_bf16 v[120:123], v[24:27], a[248:251], v[120:123]
    ds_read_b128 v[44:47], v3 offset:18688
    v_add_u32 v22, s3, v22
    v_mfma_f32_16x16x32_bf16 v[120:123], v[28:31], a[252:255], v[120:123]
    s_waitcnt lgkmcnt(2)
    v_exp_f32 v17, v69
    v_mfma_f32_16x16x32_bf16 v[124:127], v[24:27], v[208:211], v[124:127]
    s_waitcnt vmcnt(25)
    ds_read_b128 v[48:51], v23 offset:32
    v_cvt_pk_bf16_f32 v67, v18, v19
    v_mfma_f32_16x16x32_bf16 v[124:127], v[28:31], v[212:215], v[124:127]
    s_barrier
    v_cvt_f32_i32 v149, v149
    v_mfma_f32_16x16x32_bf16 v[80:83], v[32:35], a[208:211], v[80:83]
    ds_read_b128 v[24:27], v1 offset:0
    v_fma_f32 v144, v144, v56, v58
    v_mfma_f32_16x16x32_bf16 v[80:83], v[36:39], a[212:215], v[80:83]
    v_exp_f32 v18, v70
    v_mfma_f32_16x16x32_bf16 v[84:87], v[32:35], a[232:235], v[84:87]
    v_add_f32 v6, v6, v16
    v_add_f32 v6, v6, v17
    v_mfma_f32_16x16x32_bf16 v[84:87], v[36:39], a[236:239], v[84:87]
    v_exp_f32 v19, v71
    v_mfma_f32_16x16x32_bf16 v[88:91], v[32:35], v[192:195], v[88:91]
    ds_read_b128 v[28:31], v1 offset:12288
    v_cvt_pk_bf16_f32 v68, v16, v17
    v_mfma_f32_16x16x32_bf16 v[88:91], v[36:39], v[196:199], v[88:91]
    buffer_store_dwordx4 v[236:239], v54, s[4:7], s80 offen offset:768 sc1
    v_mfma_f32_16x16x32_bf16 v[92:95], v[32:35], v[216:219], v[92:95]
    v_exp_f32 v16, v100
    v_mfma_f32_16x16x32_bf16 v[92:95], v[36:39], v[220:223], v[92:95]
    s_waitcnt lgkmcnt(3)
    v_add_f32 v6, v6, v18
    v_add_f32 v6, v6, v19
    v_mfma_f32_16x16x32_bf16 v[112:115], v[40:43], a[208:211], v[112:115]
    ds_read_b128 v[32:35], v1 offset:768
    v_fma_f32 v148, v148, v57, v59
    v_mfma_f32_16x16x32_bf16 v[112:115], v[44:47], a[212:215], v[112:115]
    v_exp_f32 v17, v101
    v_mfma_f32_16x16x32_bf16 v[116:119], v[40:43], a[232:235], v[116:119]
    v_cvt_pk_bf16_f32 v69, v18, v19
    v_fma_f32 v145, v145, v56, v58
    v_mfma_f32_16x16x32_bf16 v[116:119], v[44:47], a[236:239], v[116:119]
    v_exp_f32 v18, v102
    v_mfma_f32_16x16x32_bf16 v[120:123], v[40:43], v[192:195], v[120:123]
    s_sub_u32 s31, s31, 1
    ds_read_b128 v[36:39], v1 offset:13056
    v_add_f32 v6, v6, v16
    v_mfma_f32_16x16x32_bf16 v[120:123], v[44:47], v[196:199], v[120:123]
    v_add_f32 v6, v6, v17
    v_fma_f32 v149, v149, v57, v59
    v_mfma_f32_16x16x32_bf16 v[124:127], v[40:43], v[216:219], v[124:127]
    s_waitcnt lgkmcnt(2)
    s_cmp_lg_u32 s31, 0
    v_exp_f32 v19, v103
    v_cvt_pk_bf16_f32 v70, v16, v17
    v_cvt_f32_i32 v146, v146
    v_add_f32 v6, v6, v18
    v_cvt_f32_i32 v150, v150
    v_add_f32 v6, v6, v19
    v_cvt_f32_i32 v147, v147
    v_cvt_pk_bf16_f32 v71, v18, v19
    v_cvt_f32_i32 v151, v151
    v_mfma_f32_16x16x32_bf16 v[124:127], v[44:47], v[220:223], v[124:127]
    s_cbranch_scc1 L_loop
    v_mfma_f32_16x16x32_bf16 a[0:3], v[160:163], v[24:27], a[0:3]
    ds_read_b128 v[40:43], v1 offset:1536
    v_fma_f32 v146, v146, v56, v58
    v_mfma_f32_16x16x32_bf16 a[0:3], v[176:179], v[28:31], a[0:3]
    buffer_load_dwordx4 v[248:251], v12, s[68:71], s36 offen offset:1536 nt
    v_mfma_f32_16x16x32_bf16 a[48:51], v[164:167], v[24:27], a[48:51]
    v_exp_f32 v16, v72
    v_mfma_f32_16x16x32_bf16 a[48:51], v[180:183], v[28:31], a[48:51]
    v_exp_f32 v17, v73
    v_mfma_f32_16x16x32_bf16 a[96:99], v[168:171], v[24:27], a[96:99]
    ds_read_b128 v[44:47], v1 offset:13824
    v_fma_f32 v150, v150, v57, v59
    v_mfma_f32_16x16x32_bf16 a[96:99], v[184:187], v[28:31], a[96:99]
    v_exp_f32 v18, v74
    v_mfma_f32_16x16x32_bf16 a[144:147], v[172:175], v[24:27], a[144:147]
    v_add_f32 v7, v7, v16
    v_add_f32 v7, v7, v17
    v_mfma_f32_16x16x32_bf16 a[144:147], v[188:191], v[28:31], a[144:147]
    s_waitcnt lgkmcnt(2)
    buffer_load_dwordx4 v[252:255], v12, s[68:71], s36 offen offset:2304 nt
    v_mfma_f32_16x16x32_bf16 a[4:7], v[160:163], v[32:35], a[4:7]
    ds_read_b128 v[24:27], v1 offset:2304
    v_fma_f32 v147, v147, v56, v58
    v_mfma_f32_16x16x32_bf16 a[4:7], v[176:179], v[36:39], a[4:7]
    v_exp_f32 v19, v75
    v_mfma_f32_16x16x32_bf16 a[52:55], v[164:167], v[32:35], a[52:55]
    v_cvt_pk_bf16_f32 v72, v16, v17
    v_fma_f32 v151, v151, v57, v59
    v_mfma_f32_16x16x32_bf16 a[52:55], v[180:183], v[36:39], a[52:55]
    v_exp_f32 v16, v104
    v_mfma_f32_16x16x32_bf16 a[100:103], v[168:171], v[32:35], a[100:103]
    ds_read_b128 v[28:31], v1 offset:14592
    v_add_f32 v7, v7, v18
    v_mfma_f32_16x16x32_bf16 a[100:103], v[184:187], v[36:39], a[100:103]
    ds_read_b128 v[56:59], v23 offset:48
    v_add_f32 v7, v7, v19
    v_mfma_f32_16x16x32_bf16 a[148:151], v[172:175], v[32:35], a[148:151]
    s_waitcnt vmcnt(31)
    v_exp_f32 v17, v105
    v_mfma_f32_16x16x32_bf16 a[148:151], v[188:191], v[36:39], a[148:151]
    s_waitcnt lgkmcnt(3)
    v_cvt_pk_bf16_f32 v73, v18, v19
    v_mfma_f32_16x16x32_bf16 a[8:11], v[160:163], v[40:43], a[8:11]
    ds_read_b128 v[32:35], v21 offset:0
    v_mfma_f32_16x16x32_bf16 a[8:11], v[176:179], v[44:47], a[8:11]
    v_exp_f32 v18, v106
    v_mfma_f32_16x16x32_bf16 a[56:59], v[164:167], v[40:43], a[56:59]
    v_add_f32 v7, v7, v16
    v_add_f32 v7, v7, v17
    v_mfma_f32_16x16x32_bf16 a[56:59], v[180:183], v[44:47], a[56:59]
    v_exp_f32 v19, v107
    v_mfma_f32_16x16x32_bf16 a[104:107], v[168:171], v[40:43], a[104:107]
    s_mov_b32 m0, s56
    ds_read_b128 v[36:39], v21 offset:12288
    v_cvt_f32_i32 v152, v152
    v_mfma_f32_16x16x32_bf16 a[104:107], v[184:187], v[44:47], a[104:107]
    v_cvt_pk_bf16_f32 v74, v16, v17
    v_cvt_f32_i32 v156, v156
    v_mfma_f32_16x16x32_bf16 a[152:155], v[172:175], v[40:43], a[152:155]
    v_exp_f32 v16, v76
    v_mfma_f32_16x16x32_bf16 a[152:155], v[188:191], v[44:47], a[152:155]
    s_waitcnt lgkmcnt(3)
    buffer_load_dwordx4 v4, s[4:7], s27 offen offset:0 sc1 lds
    v_mfma_f32_16x16x32_bf16 a[12:15], v[160:163], v[24:27], a[12:15]
    ds_read_b128 v[40:43], v21 offset:768
    v_add_f32 v7, v7, v18
    v_mfma_f32_16x16x32_bf16 a[12:15], v[176:179], v[28:31], a[12:15]
    v_add_f32 v7, v7, v19
    v_cvt_f32_i32 v153, v153
    v_mfma_f32_16x16x32_bf16 a[60:63], v[164:167], v[24:27], a[60:63]
    v_exp_f32 v17, v77
    v_mfma_f32_16x16x32_bf16 a[60:63], v[180:183], v[28:31], a[60:63]
    v_cvt_pk_bf16_f32 v75, v18, v19
    v_add_u32 v23, 1792, v23
    v_mfma_f32_16x16x32_bf16 a[108:111], v[168:171], v[24:27], a[108:111]
    ds_read_b128 v[44:47], v21 offset:13056
    v_mfma_f32_16x16x32_bf16 a[108:111], v[184:187], v[28:31], a[108:111]
    v_exp_f32 v18, v78
    v_mfma_f32_16x16x32_bf16 a[156:159], v[172:175], v[24:27], a[156:159]
    s_add_u32 s29, s28, 49152
    v_add_f32 v8, v8, v16
    v_add_f32 v8, v8, v17
    v_mfma_f32_16x16x32_bf16 a[156:159], v[188:191], v[28:31], a[156:159]
    s_waitcnt lgkmcnt(2)
    buffer_load_dwordx4 v4, s[4:7], s27 offen offset:1024 sc1 lds
    v_mfma_f32_16x16x32_bf16 a[16:19], v[160:163], v[32:35], a[16:19]
    ds_read_b128 v[24:27], v21 offset:1536
    v_cvt_f32_i32 v157, v157
    v_mfma_f32_16x16x32_bf16 a[16:19], v[176:179], v[36:39], a[16:19]
    s_sub_u32 s3, s29, 147456
    v_exp_f32 v19, v79
    v_mfma_f32_16x16x32_bf16 a[64:67], v[164:167], v[32:35], a[64:67]
    v_cvt_pk_bf16_f32 v76, v16, v17
    v_fma_f32 v152, v152, v60, v62
    v_mfma_f32_16x16x32_bf16 a[64:67], v[180:183], v[36:39], a[64:67]
    v_exp_f32 v16, v108
    v_mfma_f32_16x16x32_bf16 a[112:115], v[168:171], v[32:35], a[112:115]
    ds_read_b128 v[28:31], v21 offset:13824
    v_add_f32 v8, v8, v18
    v_mfma_f32_16x16x32_bf16 a[112:115], v[184:187], v[36:39], a[112:115]
    buffer_load_dwordx4 v4, s[4:7], s27 offen offset:2048 sc1 lds
    v_mfma_f32_16x16x32_bf16 a[160:163], v[172:175], v[32:35], a[160:163]
    v_add_f32 v8, v8, v19
    v_fma_f32 v156, v156, v61, v63
    v_mfma_f32_16x16x32_bf16 a[160:163], v[188:191], v[36:39], a[160:163]
    s_waitcnt lgkmcnt(2)
    v_exp_f32 v17, v109
    v_mfma_f32_16x16x32_bf16 a[20:23], v[160:163], v[40:43], a[20:23]
    s_min_u32 s29, s29, s3
    ds_read_b128 v[32:35], v21 offset:2304
    v_cvt_pk_bf16_f32 v77, v18, v19
    v_mfma_f32_16x16x32_bf16 a[20:23], v[176:179], v[44:47], a[20:23]
    v_exp_f32 v18, v110
    v_mfma_f32_16x16x32_bf16 a[68:71], v[164:167], v[40:43], a[68:71]
    s_add_u32 s27, s27, 24576
    v_add_f32 v8, v8, v16
    v_add_f32 v8, v8, v17
    v_mfma_f32_16x16x32_bf16 a[68:71], v[180:183], v[44:47], a[68:71]
    v_exp_f32 v19, v111
    v_mfma_f32_16x16x32_bf16 a[116:119], v[168:171], v[40:43], a[116:119]
    ds_read_b128 v[36:39], v21 offset:14592
    v_fma_f32 v153, v153, v60, v62
    v_mfma_f32_16x16x32_bf16 a[116:119], v[184:187], v[44:47], a[116:119]
    s_add_u32 s56, s56, 12288
    v_cvt_pk_bf16_f32 v78, v16, v17
    v_add_f32 v8, v8, v18
    v_mfma_f32_16x16x32_bf16 a[164:167], v[172:175], v[40:43], a[164:167]
    s_sub_u32 s3, s29, s28
    v_add_f32 v8, v8, v19
    v_fma_f32 v157, v157, v61, v63
    v_mfma_f32_16x16x32_bf16 a[164:167], v[188:191], v[44:47], a[164:167]
    s_waitcnt lgkmcnt(2)
    v_cvt_pk_bf16_f32 v79, v18, v19
    v_cvt_f32_i32 v154, v154
    v_mfma_f32_16x16x32_bf16 a[24:27], v[160:163], v[24:27], a[24:27]
    ds_read_b128 v[40:43], v22 offset:0
    v_mfma_f32_16x16x32_bf16 a[24:27], v[176:179], v[28:31], a[24:27]
    s_mov_b32 m0, s56
    v_exp_f32 v16, v80
    v_mfma_f32_16x16x32_bf16 a[72:75], v[164:167], v[24:27], a[72:75]
    v_exp_f32 v17, v81
    v_mfma_f32_16x16x32_bf16 a[72:75], v[180:183], v[28:31], a[72:75]
    v_exp_f32 v18, v82
    v_mfma_f32_16x16x32_bf16 a[120:123], v[168:171], v[24:27], a[120:123]
    ds_read_b128 v[44:47], v22 offset:12288
    v_cvt_f32_i32 v158, v158
    v_mfma_f32_16x16x32_bf16 a[120:123], v[184:187], v[28:31], a[120:123]
    s_mov_b32 s28, s29
    v_add_f32 v5, v5, v16
    v_add_f32 v5, v5, v17
    v_mfma_f32_16x16x32_bf16 a[168:171], v[172:175], v[24:27], a[168:171]
    v_cvt_f32_i32 v155, v155
    v_mfma_f32_16x16x32_bf16 a[168:171], v[188:191], v[28:31], a[168:171]
    s_waitcnt lgkmcnt(2)
    buffer_load_dwordx4 v4, s[4:7], s27 offen offset:0 sc1 lds
    v_mfma_f32_16x16x32_bf16 a[28:31], v[160:163], v[32:35], a[28:31]
    ds_read_b128 v[24:27], v22 offset:768
    v_cvt_f32_i32 v159, v159
    v_mfma_f32_16x16x32_bf16 a[28:31], v[176:179], v[36:39], a[28:31]
    v_exp_f32 v19, v83
    v_mfma_f32_16x16x32_bf16 a[76:79], v[164:167], v[32:35], a[76:79]
    v_cvt_pk_bf16_f32 v80, v16, v17
    v_mfma_f32_16x16x32_bf16 a[76:79], v[180:183], v[36:39], a[76:79]
    v_exp_f32 v16, v112
    v_mfma_f32_16x16x32_bf16 a[124:127], v[168:171], v[32:35], a[124:127]
    ds_read_b128 v[28:31], v22 offset:13056
    v_add_f32 v5, v5, v18
    v_mfma_f32_16x16x32_bf16 a[124:127], v[184:187], v[36:39], a[124:127]
    buffer_load_dwordx4 v4, s[4:7], s27 offen offset:1024 sc1 lds
    v_mfma_f32_16x16x32_bf16 a[172:175], v[172:175], v[32:35], a[172:175]
    v_add_f32 v5, v5, v19
    v_fma_f32 v154, v154, v60, v62
    v_mfma_f32_16x16x32_bf16 a[172:175], v[188:191], v[36:39], a[172:175]
    s_waitcnt lgkmcnt(2)
    v_exp_f32 v17, v113
    v_mfma_f32_16x16x32_bf16 a[32:35], v[160:163], v[40:43], a[32:35]
    ds_read_b128 v[32:35], v22 offset:1536
    v_cvt_pk_bf16_f32 v81, v18, v19
    v_mfma_f32_16x16x32_bf16 a[32:35], v[176:179], v[44:47], a[32:35]
    v_exp_f32 v18, v114
    v_mfma_f32_16x16x32_bf16 a[80:83], v[164:167], v[40:43], a[80:83]
    v_add_f32 v5, v5, v16
    v_add_f32 v5, v5, v17
    v_mfma_f32_16x16x32_bf16 a[80:83], v[180:183], v[44:47], a[80:83]
    v_exp_f32 v19, v115
    v_mfma_f32_16x16x32_bf16 a[128:131], v[168:171], v[40:43], a[128:131]
    ds_read_b128 v[36:39], v22 offset:13824
    v_fma_f32 v158, v158, v61, v63
    v_mfma_f32_16x16x32_bf16 a[128:131], v[184:187], v[44:47], a[128:131]
    buffer_load_dwordx4 v4, s[4:7], s27 offen offset:2048 sc1 lds
    v_mfma_f32_16x16x32_bf16 a[176:179], v[172:175], v[40:43], a[176:179]
    v_cvt_pk_bf16_f32 v82, v16, v17
    v_add_u32 v2, s3, v2
    v_mfma_f32_16x16x32_bf16 a[176:179], v[188:191], v[44:47], a[176:179]
    s_waitcnt lgkmcnt(2)
    v_exp_f32 v16, v84
    v_mfma_f32_16x16x32_bf16 a[36:39], v[160:163], v[24:27], a[36:39]
    ds_read_b128 v[40:43], v22 offset:2304
    v_add_f32 v5, v5, v18
    v_mfma_f32_16x16x32_bf16 a[36:39], v[176:179], v[28:31], a[36:39]
    v_add_f32 v5, v5, v19
    v_fma_f32 v155, v155, v60, v62
    v_mfma_f32_16x16x32_bf16 a[84:87], v[164:167], v[24:27], a[84:87]
    v_exp_f32 v17, v85
    v_mfma_f32_16x16x32_bf16 a[84:87], v[180:183], v[28:31], a[84:87]
    s_add_u32 s27, s27, 24576
    v_add_u32 v3, s3, v3
    v_fma_f32 v159, v159, v61, v63
    v_mfma_f32_16x16x32_bf16 a[132:135], v[168:171], v[24:27], a[132:135]
    s_add_u32 s56, s56, 36864
    ds_read_b128 v[44:47], v22 offset:14592
    v_cvt_pk_bf16_f32 v83, v18, v19
    v_mfma_f32_16x16x32_bf16 a[132:135], v[184:187], v[28:31], a[132:135]
    s_waitcnt lgkmcnt(2)
    v_exp_f32 v18, v86
    v_mfma_f32_16x16x32_bf16 a[180:183], v[172:175], v[24:27], a[180:183]
    s_waitcnt vmcnt(8)
    v_add_f32 v6, v6, v16
    v_cvt_pk_bf16_f32 v144, v144, v148
    v_mfma_f32_16x16x32_bf16 a[180:183], v[188:191], v[28:31], a[180:183]
    s_barrier
    v_add_f32 v6, v6, v17
    v_mfma_f32_16x16x32_bf16 a[40:43], v[160:163], v[32:35], a[40:43]
    s_sub_u32 s58, s56, 147456
    ds_read_b128 v[24:27], v2 offset:0
    v_cvt_pk_bf16_f32 v148, v145, v149
    v_mfma_f32_16x16x32_bf16 a[40:43], v[176:179], v[36:39], a[40:43]
    v_exp_f32 v19, v87
    v_mfma_f32_16x16x32_bf16 a[88:91], v[164:167], v[32:35], a[88:91]
    s_min_u32 s56, s56, s58
    v_cvt_pk_bf16_f32 v84, v16, v17
    v_cvt_pk_bf16_f32 v145, v152, v156
    v_mfma_f32_16x16x32_bf16 a[88:91], v[180:183], v[36:39], a[88:91]
    v_exp_f32 v16, v116
    v_mfma_f32_16x16x32_bf16 a[136:139], v[168:171], v[32:35], a[136:139]
    ds_read_b128 v[28:31], v3 offset:0
    v_add_f32 v6, v6, v18
    v_mfma_f32_16x16x32_bf16 a[136:139], v[184:187], v[36:39], a[136:139]
    v_add_f32 v6, v6, v19
    v_add_u32 v55, 1, v55
    v_mfma_f32_16x16x32_bf16 a[184:187], v[172:175], v[32:35], a[184:187]
    v_exp_f32 v17, v117
    v_mfma_f32_16x16x32_bf16 a[184:187], v[188:191], v[36:39], a[184:187]
    s_waitcnt lgkmcnt(2)
    buffer_store_dword v55, v13, s[20:23], 0 offen sc1
    v_mfma_f32_16x16x32_bf16 a[44:47], v[160:163], v[40:43], a[44:47]
    ds_read_b128 v[32:35], v2 offset:6144
    v_cvt_pk_bf16_f32 v85, v18, v19
    v_mfma_f32_16x16x32_bf16 a[44:47], v[176:179], v[44:47], a[44:47]
    v_exp_f32 v18, v118
    v_mfma_f32_16x16x32_bf16 a[92:95], v[164:167], v[40:43], a[92:95]
    v_cvt_pk_bf16_f32 v149, v153, v157
    v_add_f32 v6, v6, v16
    v_mfma_f32_16x16x32_bf16 a[92:95], v[180:183], v[44:47], a[92:95]
    v_add_f32 v6, v6, v17
    v_cvt_pk_bf16_f32 v152, v146, v150
    v_mfma_f32_16x16x32_bf16 a[140:143], v[168:171], v[40:43], a[140:143]
    ds_read_b128 v[36:39], v3 offset:6144
    v_cvt_pk_bf16_f32 v153, v154, v158
    v_mfma_f32_16x16x32_bf16 a[140:143], v[184:187], v[44:47], a[140:143]
    v_exp_f32 v19, v119
    v_mfma_f32_16x16x32_bf16 a[188:191], v[172:175], v[40:43], a[188:191]
    v_cvt_pk_bf16_f32 v86, v16, v17
    v_add_f32 v6, v6, v18
    v_mfma_f32_16x16x32_bf16 a[188:191], v[188:191], v[44:47], a[188:191]
    s_waitcnt lgkmcnt(2)
    v_add_f32 v6, v6, v19
    v_cvt_pk_bf16_f32 v87, v18, v19
    v_cvt_pk_bf16_f32 v156, v147, v151
    v_mfma_f32_16x16x32_bf16 v[160:163], v[24:27], a[192:195], v[128:131]
    s_mov_b32 m0, s26
    ds_read_b128 v[40:43], v2 offset:128
    v_cvt_pk_bf16_f32 v157, v155, v159
    v_mfma_f32_16x16x32_bf16 v[160:163], v[28:31], a[196:199], v[160:163]
    s_waitcnt vmcnt(19)
    v_exp_f32 v16, v88
    v_mfma_f32_16x16x32_bf16 v[164:167], v[24:27], a[216:219], v[132:135]
    v_exp_f32 v17, v89
    v_mfma_f32_16x16x32_bf16 v[164:167], v[28:31], a[220:223], v[164:167]
    v_exp_f32 v18, v90
    v_mfma_f32_16x16x32_bf16 v[168:171], v[24:27], a[240:243], v[136:139]
    ds_read_b128 v[44:47], v3 offset:128
    v_mfma_f32_16x16x32_bf16 v[168:171], v[28:31], a[244:247], v[168:171]
    buffer_load_dwordx4 v4, s[4:7], s32 offen offset:0 sc1 lds
    v_mfma_f32_16x16x32_bf16 v[172:175], v[24:27], v[200:203], v[140:143]
    v_add_f32 v7, v7, v16
    v_add_f32 v7, v7, v17
    v_mfma_f32_16x16x32_bf16 v[172:175], v[28:31], v[204:207], v[172:175]
    s_waitcnt lgkmcnt(2)
    v_exp_f32 v19, v91
    v_mfma_f32_16x16x32_bf16 v[96:99], v[32:35], a[192:195], v[128:131]
    ds_read_b128 v[24:27], v2 offset:6272
    v_cvt_f32_i32 v240, v240
    v_mfma_f32_16x16x32_bf16 v[96:99], v[36:39], a[196:199], v[96:99]
    v_cvt_pk_bf16_f32 v88, v16, v17
    v_cvt_f32_i32 v244, v244
    v_mfma_f32_16x16x32_bf16 v[100:103], v[32:35], a[216:219], v[132:135]
    v_exp_f32 v16, v120
    v_mfma_f32_16x16x32_bf16 v[100:103], v[36:39], a[220:223], v[100:103]
    v_add_f32 v7, v7, v18
    v_cvt_f32_i32 v241, v241
    v_mfma_f32_16x16x32_bf16 v[104:107], v[32:35], a[240:243], v[136:139]
    ds_read_b128 v[28:31], v3 offset:6272
    v_add_f32 v7, v7, v19
    v_mfma_f32_16x16x32_bf16 v[104:107], v[36:39], a[244:247], v[104:107]
    v_exp_f32 v17, v121
    v_mfma_f32_16x16x32_bf16 v[108:111], v[32:35], v[200:203], v[140:143]
    v_mfma_f32_16x16x32_bf16 v[108:111], v[36:39], v[204:207], v[108:111]
    s_waitcnt lgkmcnt(2)
    buffer_load_dwordx4 v4, s[4:7], s32 offen offset:1024 sc1 lds
    v_mfma_f32_16x16x32_bf16 v[160:163], v[40:43], a[200:203], v[160:163]
    ds_read_b128 v[32:35], v2 offset:256
    v_cvt_pk_bf16_f32 v89, v18, v19
    v_mfma_f32_16x16x32_bf16 v[160:163], v[44:47], a[204:207], v[160:163]
    v_exp_f32 v18, v122
    v_mfma_f32_16x16x32_bf16 v[164:167], v[40:43], a[224:227], v[164:167]
    v_add_f32 v7, v7, v16
    v_cvt_f32_i32 v245, v245
    v_mfma_f32_16x16x32_bf16 v[164:167], v[44:47], a[228:231], v[164:167]
    v_add_f32 v7, v7, v17
    v_fma_f32 v240, v240, v48, v50
    v_mfma_f32_16x16x32_bf16 v[168:171], v[40:43], a[248:251], v[168:171]
    ds_read_b128 v[36:39], v3 offset:256
    v_mfma_f32_16x16x32_bf16 v[168:171], v[44:47], a[252:255], v[168:171]
    v_exp_f32 v19, v123
    v_mfma_f32_16x16x32_bf16 v[172:175], v[40:43], v[208:211], v[172:175]
    v_cvt_pk_bf16_f32 v90, v16, v17
    v_fma_f32 v244, v244, v49, v51
    v_mfma_f32_16x16x32_bf16 v[172:175], v[44:47], v[212:215], v[172:175]
    s_waitcnt lgkmcnt(2)
    buffer_load_dwordx4 v4, s[4:7], s32 offen offset:2048 sc1 lds
    v_mfma_f32_16x16x32_bf16 v[96:99], v[24:27], a[200:203], v[96:99]
    ds_read_b128 v[40:43], v2 offset:6400
    v_mfma_f32_16x16x32_bf16 v[96:99], v[28:31], a[204:207], v[96:99]
    v_exp_f32 v16, v92
    v_mfma_f32_16x16x32_bf16 v[100:103], v[24:27], a[224:227], v[100:103]
    v_add_f32 v7, v7, v18
    v_add_f32 v7, v7, v19
    v_mfma_f32_16x16x32_bf16 v[100:103], v[28:31], a[228:231], v[100:103]
    v_exp_f32 v17, v93
    v_mfma_f32_16x16x32_bf16 v[104:107], v[24:27], a[248:251], v[104:107]
    ds_read_b128 v[44:47], v3 offset:6400
    v_cvt_pk_bf16_f32 v91, v18, v19
    v_mfma_f32_16x16x32_bf16 v[104:107], v[28:31], a[252:255], v[104:107]
    v_exp_f32 v18, v94
    v_mfma_f32_16x16x32_bf16 v[108:111], v[24:27], v[208:211], v[108:111]
    s_add_u32 s29, s30, 49152
    v_fma_f32 v241, v241, v48, v50
    v_add_f32 v8, v8, v16
    v_mfma_f32_16x16x32_bf16 v[108:111], v[28:31], v[212:215], v[108:111]
    s_waitcnt lgkmcnt(2)
    v_fma_f32 v245, v245, v49, v51
    v_add_f32 v8, v8, v17
    v_mfma_f32_16x16x32_bf16 v[160:163], v[32:35], a[208:211], v[160:163]
    s_add_u32 s32, s32, 24576
    ds_read_b128 v[24:27], v2 offset:12288
    v_cvt_f32_i32 v242, v242
    v_mfma_f32_16x16x32_bf16 v[160:163], v[36:39], a[212:215], v[160:163]
    s_sub_u32 s3, s29, 147456
    v_exp_f32 v19, v95
    v_mfma_f32_16x16x32_bf16 v[164:167], v[32:35], a[232:235], v[164:167]
    v_cvt_pk_bf16_f32 v92, v16, v17
    v_mfma_f32_16x16x32_bf16 v[164:167], v[36:39], a[236:239], v[164:167]
    s_add_u32 s26, s26, 12288
    v_exp_f32 v16, v124
    v_mfma_f32_16x16x32_bf16 v[168:171], v[32:35], v[192:195], v[168:171]
    ds_read_b128 v[28:31], v3 offset:12288
    v_cvt_f32_i32 v246, v246
    v_mfma_f32_16x16x32_bf16 v[168:171], v[36:39], v[196:199], v[168:171]
    v_add_f32 v8, v8, v18
    v_add_f32 v8, v8, v19
    v_mfma_f32_16x16x32_bf16 v[172:175], v[32:35], v[216:219], v[172:175]
    s_min_u32 s29, s29, s3
    v_mfma_f32_16x16x32_bf16 v[172:175], v[36:39], v[220:223], v[172:175]
    s_waitcnt lgkmcnt(2)
    v_exp_f32 v17, v125
    v_mfma_f32_16x16x32_bf16 v[96:99], v[40:43], a[208:211], v[96:99]
    s_mov_b32 m0, s26
    ds_read_b128 v[32:35], v2 offset:18432
    v_cvt_pk_bf16_f32 v93, v18, v19
    v_mfma_f32_16x16x32_bf16 v[96:99], v[44:47], a[212:215], v[96:99]
    v_exp_f32 v18, v126
    v_mfma_f32_16x16x32_bf16 v[100:103], v[40:43], a[232:235], v[100:103]
    v_cvt_f32_i32 v243, v243
    v_cvt_f32_i32 v247, v247
    v_mfma_f32_16x16x32_bf16 v[100:103], v[44:47], a[236:239], v[100:103]
    v_add_f32 v8, v8, v16
    v_mfma_f32_16x16x32_bf16 v[104:107], v[40:43], v[192:195], v[104:107]
    s_sub_u32 s3, s29, s30
    ds_read_b128 v[36:39], v3 offset:18432
    v_add_f32 v8, v8, v17
    v_mfma_f32_16x16x32_bf16 v[104:107], v[44:47], v[196:199], v[104:107]
    v_exp_f32 v19, v127
    v_mfma_f32_16x16x32_bf16 v[108:111], v[40:43], v[216:219], v[108:111]
    v_fma_f32 v242, v242, v48, v50
    v_cvt_pk_bf16_f32 v94, v16, v17
    v_mfma_f32_16x16x32_bf16 v[108:111], v[44:47], v[220:223], v[108:111]
    s_waitcnt lgkmcnt(2)
    buffer_load_dwordx4 v4, s[4:7], s32 offen offset:0 sc1 lds
    v_mfma_f32_16x16x32_bf16 v[176:179], v[24:27], a[192:195], v[128:131]
    ds_read_b128 v[40:43], v2 offset:12416
    v_add_f32 v8, v8, v18
    v_mfma_f32_16x16x32_bf16 v[176:179], v[28:31], a[196:199], v[176:179]
    v_add_f32 v8, v8, v19
    v_fma_f32 v246, v246, v49, v51
    v_mfma_f32_16x16x32_bf16 v[180:183], v[24:27], a[216:219], v[132:135]
    s_mov_b32 s30, s29
    v_cvt_pk_bf16_f32 v95, v18, v19
    v_mfma_f32_16x16x32_bf16 v[180:183], v[28:31], a[220:223], v[180:183]
    v_mfma_f32_16x16x32_bf16 v[184:187], v[24:27], a[240:243], v[136:139]
    ds_read_b128 v[44:47], v3 offset:12416
    v_mfma_f32_16x16x32_bf16 v[184:187], v[28:31], a[244:247], v[184:187]
    v_exp_f32 v16, v160
    v_mfma_f32_16x16x32_bf16 v[188:191], v[24:27], v[200:203], v[140:143]
    v_exp_f32 v17, v161
    v_mfma_f32_16x16x32_bf16 v[188:191], v[28:31], v[204:207], v[188:191]
    s_waitcnt lgkmcnt(2)
    v_exp_f32 v18, v162
    v_mfma_f32_16x16x32_bf16 v[112:115], v[32:35], a[192:195], v[128:131]
    ds_read_b128 v[24:27], v2 offset:18560
    v_fma_f32 v243, v243, v48, v50
    v_mfma_f32_16x16x32_bf16 v[112:115], v[36:39], a[196:199], v[112:115]
    buffer_load_dwordx4 v4, s[4:7], s32 offen offset:1024 sc1 lds
    v_mfma_f32_16x16x32_bf16 v[116:119], v[32:35], a[216:219], v[132:135]
    v_add_f32 v5, v5, v16
    v_add_f32 v5, v5, v17
    v_mfma_f32_16x16x32_bf16 v[116:119], v[36:39], a[220:223], v[116:119]
    v_exp_f32 v19, v163
    v_mfma_f32_16x16x32_bf16 v[120:123], v[32:35], a[240:243], v[136:139]
    ds_read_b128 v[28:31], v3 offset:18560
    v_cvt_pk_bf16_f32 v160, v16, v17
    v_mfma_f32_16x16x32_bf16 v[120:123], v[36:39], a[244:247], v[120:123]
    v_exp_f32 v16, v96
    v_mfma_f32_16x16x32_bf16 v[124:127], v[32:35], v[200:203], v[140:143]
    v_fma_f32 v247, v247, v49, v51
    v_add_f32 v5, v5, v18
    v_mfma_f32_16x16x32_bf16 v[124:127], v[36:39], v[204:207], v[124:127]
    s_waitcnt lgkmcnt(2)
    v_add_f32 v5, v5, v19
    v_add_u32 v1, s3, v1
    v_mfma_f32_16x16x32_bf16 v[176:179], v[40:43], a[200:203], v[176:179]
    ds_read_b128 v[32:35], v2 offset:12544
    v_cvt_pk_bf16_f32 v146, v240, v244
    v_mfma_f32_16x16x32_bf16 v[176:179], v[44:47], a[204:207], v[176:179]
    buffer_load_dwordx4 v4, s[4:7], s32 offen offset:2048 sc1 lds
    v_mfma_f32_16x16x32_bf16 v[180:183], v[40:43], a[224:227], v[180:183]
    v_exp_f32 v17, v97
    v_mfma_f32_16x16x32_bf16 v[180:183], v[44:47], a[228:231], v[180:183]
    v_cvt_pk_bf16_f32 v161, v18, v19
    v_cvt_pk_bf16_f32 v150, v241, v245
    v_mfma_f32_16x16x32_bf16 v[184:187], v[40:43], a[248:251], v[184:187]
    ds_read_b128 v[36:39], v3 offset:12544
    v_add_u32 v21, s3, v21
    v_mfma_f32_16x16x32_bf16 v[184:187], v[44:47], a[252:255], v[184:187]
    v_exp_f32 v18, v98
    v_mfma_f32_16x16x32_bf16 v[188:191], v[40:43], v[208:211], v[188:191]
    v_add_f32 v5, v5, v16
    v_add_f32 v5, v5, v17
    v_mfma_f32_16x16x32_bf16 v[188:191], v[44:47], v[212:215], v[188:191]
    s_waitcnt lgkmcnt(2)
    v_exp_f32 v19, v99
    v_mfma_f32_16x16x32_bf16 v[112:115], v[24:27], a[200:203], v[112:115]
    ds_read_b128 v[40:43], v2 offset:18688
    v_cvt_pk_bf16_f32 v162, v16, v17
    v_mfma_f32_16x16x32_bf16 v[112:115], v[28:31], a[204:207], v[112:115]
    v_exp_f32 v16, v164
    v_mfma_f32_16x16x32_bf16 v[116:119], v[24:27], a[224:227], v[116:119]
    v_add_f32 v5, v5, v18
    v_cvt_pk_bf16_f32 v154, v242, v246
    v_mfma_f32_16x16x32_bf16 v[116:119], v[28:31], a[228:231], v[116:119]
    s_add_u32 s32, s32, 24576
    v_add_u32 v22, s3, v22
    v_add_f32 v5, v5, v19
    v_mfma_f32_16x16x32_bf16 v[120:123], v[24:27], a[248:251], v[120:123]
    s_add_u32 s26, s26, 36864
    ds_read_b128 v[44:47], v3 offset:18688
    v_cvt_pk_bf16_f32 v158, v243, v247
    v_mfma_f32_16x16x32_bf16 v[120:123], v[28:31], a[252:255], v[120:123]
    s_waitcnt lgkmcnt(2)
    v_exp_f32 v17, v165
    v_mfma_f32_16x16x32_bf16 v[124:127], v[24:27], v[208:211], v[124:127]
    s_waitcnt vmcnt(27)
    v_cvt_pk_bf16_f32 v163, v18, v19
    s_waitcnt vmcnt(13)
    v_mfma_f32_16x16x32_bf16 v[124:127], v[28:31], v[212:215], v[124:127]
    s_barrier
    v_cvt_f32_i32 v248, v248
    v_mfma_f32_16x16x32_bf16 v[176:179], v[32:35], a[208:211], v[176:179]
    s_sub_u32 s57, s26, 147456
    ds_read_b128 v[24:27], v1 offset:0
    v_cvt_f32_i32 v252, v252
    v_mfma_f32_16x16x32_bf16 v[176:179], v[36:39], a[212:215], v[176:179]
    v_exp_f32 v18, v166
    v_mfma_f32_16x16x32_bf16 v[180:183], v[32:35], a[232:235], v[180:183]
    s_min_u32 s26, s26, s57
    v_add_f32 v6, v6, v16
    v_add_f32 v6, v6, v17
    v_mfma_f32_16x16x32_bf16 v[180:183], v[36:39], a[236:239], v[180:183]
    v_exp_f32 v19, v167
    v_mfma_f32_16x16x32_bf16 v[184:187], v[32:35], v[192:195], v[184:187]
    ds_read_b128 v[28:31], v1 offset:12288
    v_cvt_pk_bf16_f32 v164, v16, v17
    v_mfma_f32_16x16x32_bf16 v[184:187], v[36:39], v[196:199], v[184:187]
    v_exp_f32 v16, v100
    v_mfma_f32_16x16x32_bf16 v[188:191], v[32:35], v[216:219], v[188:191]
    v_add_f32 v6, v6, v18
    v_add_f32 v6, v6, v19
    v_mfma_f32_16x16x32_bf16 v[188:191], v[36:39], v[220:223], v[188:191]
    s_waitcnt lgkmcnt(2)
    v_exp_f32 v17, v101
    v_mfma_f32_16x16x32_bf16 v[112:115], v[40:43], a[208:211], v[112:115]
    ds_read_b128 v[32:35], v1 offset:768
    v_cvt_pk_bf16_f32 v165, v18, v19
    v_mfma_f32_16x16x32_bf16 v[112:115], v[44:47], a[212:215], v[112:115]
    v_exp_f32 v18, v102
    v_mfma_f32_16x16x32_bf16 v[116:119], v[40:43], a[232:235], v[116:119]
    v_add_f32 v6, v6, v16
    v_cvt_f32_i32 v249, v249
    v_mfma_f32_16x16x32_bf16 v[116:119], v[44:47], a[236:239], v[116:119]
    v_add_f32 v6, v6, v17
    v_cvt_f32_i32 v253, v253
    v_mfma_f32_16x16x32_bf16 v[120:123], v[40:43], v[192:195], v[120:123]
    ds_read_b128 v[36:39], v1 offset:13056
    v_fma_f32 v248, v248, v56, v58
    v_mfma_f32_16x16x32_bf16 v[120:123], v[44:47], v[196:199], v[120:123]
    v_exp_f32 v19, v103
    v_mfma_f32_16x16x32_bf16 v[124:127], v[40:43], v[216:219], v[124:127]
    v_cvt_pk_bf16_f32 v166, v16, v17
    v_add_f32 v6, v6, v18
    v_mfma_f32_16x16x32_bf16 v[124:127], v[44:47], v[220:223], v[124:127]
    s_waitcnt lgkmcnt(2)
    v_add_f32 v6, v6, v19
    v_cvt_pk_bf16_f32 v167, v18, v19
    v_mfma_f32_16x16x32_bf16 a[0:3], v[64:67], v[24:27], a[0:3]
    s_mov_b32 m0, s56
    ds_read_b128 v[40:43], v1 offset:1536
    v_bfe_u32 v53, v4, 4, 6
    v_mfma_f32_16x16x32_bf16 a[0:3], v[80:83], v[28:31], a[0:3]
    v_exp_f32 v16, v168
    v_mfma_f32_16x16x32_bf16 a[48:51], v[68:71], v[24:27], a[48:51]
    v_exp_f32 v17, v169
    v_mfma_f32_16x16x32_bf16 a[48:51], v[84:87], v[28:31], a[48:51]
    buffer_load_dwordx4 v4, s[4:7], s27 offen offset:0 sc1 lds
    v_mfma_f32_16x16x32_bf16 a[96:99], v[72:75], v[24:27], a[96:99]
    ds_read_b128 v[44:47], v1 offset:13824
    v_lshlrev_b32 v53, 2, v53
    v_mfma_f32_16x16x32_bf16 a[96:99], v[88:91], v[28:31], a[96:99]
    v_exp_f32 v18, v170
    v_mfma_f32_16x16x32_bf16 a[144:147], v[76:79], v[24:27], a[144:147]
    v_fma_f32 v252, v252, v57, v59
    v_add_f32 v7, v7, v16
    v_mfma_f32_16x16x32_bf16 a[144:147], v[92:95], v[28:31], a[144:147]
    s_waitcnt lgkmcnt(2)
    buffer_load_dword v52, v53, s[20:23], 0 offen sc1
    v_mfma_f32_16x16x32_bf16 a[4:7], v[64:67], v[32:35], a[4:7]
    ds_read_b128 v[24:27], v1 offset:2304
    v_add_f32 v7, v7, v17
    v_mfma_f32_16x16x32_bf16 a[4:7], v[80:83], v[36:39], a[4:7]
    v_exp_f32 v19, v171
    v_mfma_f32_16x16x32_bf16 a[52:55], v[68:71], v[32:35], a[52:55]
    v_cvt_pk_bf16_f32 v168, v16, v17
    v_fma_f32 v249, v249, v56, v58
    v_mfma_f32_16x16x32_bf16 a[52:55], v[84:87], v[36:39], a[52:55]
    buffer_load_dwordx4 v4, s[4:7], s27 offen offset:1024 sc1 lds
    v_mfma_f32_16x16x32_bf16 a[100:103], v[72:75], v[32:35], a[100:103]
    ds_read_b128 v[28:31], v1 offset:14592
    v_fma_f32 v253, v253, v57, v59
    v_mfma_f32_16x16x32_bf16 a[100:103], v[88:91], v[36:39], a[100:103]
    v_exp_f32 v16, v104
    v_mfma_f32_16x16x32_bf16 a[148:151], v[76:79], v[32:35], a[148:151]
    v_add_f32 v7, v7, v18
    v_add_f32 v7, v7, v19
    v_mfma_f32_16x16x32_bf16 a[148:151], v[92:95], v[36:39], a[148:151]
    s_waitcnt lgkmcnt(2)
    buffer_load_dwordx4 v4, s[4:7], s27 offen offset:2048 sc1 lds
    v_mfma_f32_16x16x32_bf16 a[8:11], v[64:67], v[40:43], a[8:11]
    ds_read_b128 v[32:35], v21 offset:0
    v_cvt_f32_i32 v250, v250
    v_mfma_f32_16x16x32_bf16 a[8:11], v[80:83], v[44:47], a[8:11]
    v_exp_f32 v17, v105
    v_mfma_f32_16x16x32_bf16 a[56:59], v[68:71], v[40:43], a[56:59]
    v_cvt_pk_bf16_f32 v169, v18, v19
    v_cvt_f32_i32 v254, v254
    v_mfma_f32_16x16x32_bf16 a[56:59], v[84:87], v[44:47], a[56:59]
    v_exp_f32 v18, v106
    v_mfma_f32_16x16x32_bf16 a[104:107], v[72:75], v[40:43], a[104:107]
    s_add_u32 s27, s27, 24576
    ds_read_b128 v[36:39], v21 offset:12288
    v_add_f32 v7, v7, v16
    v_mfma_f32_16x16x32_bf16 a[104:107], v[88:91], v[44:47], a[104:107]
    v_add_f32 v7, v7, v17
    v_cvt_f32_i32 v251, v251
    v_mfma_f32_16x16x32_bf16 a[152:155], v[76:79], v[40:43], a[152:155]
    v_exp_f32 v19, v107
    v_mfma_f32_16x16x32_bf16 a[152:155], v[92:95], v[44:47], a[152:155]
    s_waitcnt lgkmcnt(2)
    v_cvt_pk_bf16_f32 v170, v16, v17
    v_cvt_f32_i32 v255, v255
    v_mfma_f32_16x16x32_bf16 a[12:15], v[64:67], v[24:27], a[12:15]
    s_add_u32 s56, s56, 12288
    ds_read_b128 v[40:43], v21 offset:768
    v_fma_f32 v250, v250, v56, v58
    v_mfma_f32_16x16x32_bf16 a[12:15], v[80:83], v[28:31], a[12:15]
    v_exp_f32 v16, v172
    v_mfma_f32_16x16x32_bf16 a[60:63], v[68:71], v[24:27], a[60:63]
    v_add_f32 v7, v7, v18
    v_add_f32 v7, v7, v19
    v_mfma_f32_16x16x32_bf16 a[60:63], v[84:87], v[28:31], a[60:63]
    s_mov_b32 m0, s56
    v_exp_f32 v17, v173
    v_mfma_f32_16x16x32_bf16 a[108:111], v[72:75], v[24:27], a[108:111]
    ds_read_b128 v[44:47], v21 offset:13056
    v_cvt_pk_bf16_f32 v171, v18, v19
    v_mfma_f32_16x16x32_bf16 a[108:111], v[88:91], v[28:31], a[108:111]
    v_exp_f32 v18, v174
    v_mfma_f32_16x16x32_bf16 a[156:159], v[76:79], v[24:27], a[156:159]
    s_add_u32 s29, s28, 49152
    v_add_f32 v8, v8, v16
    v_add_f32 v8, v8, v17
    v_mfma_f32_16x16x32_bf16 a[156:159], v[92:95], v[28:31], a[156:159]
    s_waitcnt lgkmcnt(2)
    buffer_load_dwordx4 v4, s[4:7], s27 offen offset:0 sc1 lds
    v_mfma_f32_16x16x32_bf16 a[16:19], v[64:67], v[32:35], a[16:19]
    ds_read_b128 v[24:27], v21 offset:1536
    v_fma_f32 v254, v254, v57, v59
    v_mfma_f32_16x16x32_bf16 a[16:19], v[80:83], v[36:39], a[16:19]
    s_sub_u32 s3, s29, 147456
    v_exp_f32 v19, v175
    v_mfma_f32_16x16x32_bf16 a[64:67], v[68:71], v[32:35], a[64:67]
    v_cvt_pk_bf16_f32 v172, v16, v17
    v_fma_f32 v251, v251, v56, v58
    v_mfma_f32_16x16x32_bf16 a[64:67], v[84:87], v[36:39], a[64:67]
    v_exp_f32 v16, v108
    v_mfma_f32_16x16x32_bf16 a[112:115], v[72:75], v[32:35], a[112:115]
    ds_read_b128 v[28:31], v21 offset:13824
    v_add_f32 v8, v8, v18
    v_mfma_f32_16x16x32_bf16 a[112:115], v[88:91], v[36:39], a[112:115]
    v_add_f32 v8, v8, v19
    v_fma_f32 v255, v255, v57, v59
    v_mfma_f32_16x16x32_bf16 a[160:163], v[76:79], v[32:35], a[160:163]
    v_exp_f32 v17, v109
    v_mfma_f32_16x16x32_bf16 a[160:163], v[92:95], v[36:39], a[160:163]
    s_waitcnt lgkmcnt(2)
    buffer_load_dwordx4 v4, s[4:7], s27 offen offset:1024 sc1 lds
    v_mfma_f32_16x16x32_bf16 a[20:23], v[64:67], v[40:43], a[20:23]
    s_min_u32 s29, s29, s3
    ds_read_b128 v[32:35], v21 offset:2304
    v_cvt_pk_bf16_f32 v173, v18, v19
    v_mfma_f32_16x16x32_bf16 a[20:23], v[80:83], v[44:47], a[20:23]
    v_exp_f32 v18, v110
    v_mfma_f32_16x16x32_bf16 a[68:71], v[68:71], v[40:43], a[68:71]
    v_add_f32 v8, v8, v16
    v_cvt_pk_bf16_f32 v147, v248, v252
    v_mfma_f32_16x16x32_bf16 a[68:71], v[84:87], v[44:47], a[68:71]
    v_add_f32 v8, v8, v17
    v_cvt_pk_bf16_f32 v151, v249, v253
    v_mfma_f32_16x16x32_bf16 a[116:119], v[72:75], v[40:43], a[116:119]
    ds_read_b128 v[36:39], v21 offset:14592
    v_mfma_f32_16x16x32_bf16 a[116:119], v[88:91], v[44:47], a[116:119]
    buffer_load_dwordx4 v4, s[4:7], s27 offen offset:2048 sc1 lds
    v_mfma_f32_16x16x32_bf16 a[164:167], v[76:79], v[40:43], a[164:167]
    s_sub_u32 s3, s29, s28
    v_exp_f32 v19, v111
    v_mfma_f32_16x16x32_bf16 a[164:167], v[92:95], v[44:47], a[164:167]
    s_waitcnt lgkmcnt(2)
    v_cvt_pk_bf16_f32 v174, v16, v17
    v_add_f32 v8, v8, v18
    v_mfma_f32_16x16x32_bf16 a[24:27], v[64:67], v[24:27], a[24:27]
    ds_read_b128 v[40:43], v22 offset:0
    v_add_f32 v8, v8, v19
    v_mfma_f32_16x16x32_bf16 a[24:27], v[80:83], v[28:31], a[24:27]
    v_cvt_pk_bf16_f32 v175, v18, v19
    v_cvt_pk_bf16_f32 v155, v250, v254
    v_mfma_f32_16x16x32_bf16 a[72:75], v[68:71], v[24:27], a[72:75]
    v_exp_f32 v16, v176
    v_mfma_f32_16x16x32_bf16 a[72:75], v[84:87], v[28:31], a[72:75]
    s_add_u32 s27, s27, 24576
    v_exp_f32 v17, v177
    v_mfma_f32_16x16x32_bf16 a[120:123], v[72:75], v[24:27], a[120:123]
    s_add_u32 s56, s56, 36864
    ds_read_b128 v[44:47], v22 offset:12288
    v_cvt_pk_bf16_f32 v159, v251, v255
    v_mfma_f32_16x16x32_bf16 a[120:123], v[88:91], v[28:31], a[120:123]
    s_mov_b32 s28, s29
    v_exp_f32 v18, v178
    v_mfma_f32_16x16x32_bf16 a[168:171], v[76:79], v[24:27], a[168:171]
    v_add_f32 v5, v5, v16
    v_add_f32 v5, v5, v17
    v_mfma_f32_16x16x32_bf16 a[168:171], v[92:95], v[28:31], a[168:171]
    s_waitcnt lgkmcnt(2)
    v_exp_f32 v19, v179
    v_mfma_f32_16x16x32_bf16 a[28:31], v[64:67], v[32:35], a[28:31]
    s_sub_u32 s58, s56, 147456
    ds_read_b128 v[24:27], v22 offset:768
    v_cvt_pk_bf16_f32 v176, v16, v17
    v_mfma_f32_16x16x32_bf16 a[28:31], v[80:83], v[36:39], a[28:31]
    buffer_store_dwordx4 v[144:147], v20, s[4:7], s81 offen offset:0 sc1
    v_mfma_f32_16x16x32_bf16 a[76:79], v[68:71], v[32:35], a[76:79]
    s_min_u32 s56, s56, s58
    v_exp_f32 v16, v112
    v_mfma_f32_16x16x32_bf16 a[76:79], v[84:87], v[36:39], a[76:79]
    v_add_f32 v5, v5, v18
    v_add_f32 v5, v5, v19
    v_mfma_f32_16x16x32_bf16 a[124:127], v[72:75], v[32:35], a[124:127]
    ds_read_b128 v[28:31], v22 offset:13056
    v_add_u32 v2, s3, v2
    v_mfma_f32_16x16x32_bf16 a[124:127], v[88:91], v[36:39], a[124:127]
    v_exp_f32 v17, v113
    v_mfma_f32_16x16x32_bf16 a[172:175], v[76:79], v[32:35], a[172:175]
    v_cvt_pk_bf16_f32 v177, v18, v19
    v_mfma_f32_16x16x32_bf16 a[172:175], v[92:95], v[36:39], a[172:175]
    s_waitcnt lgkmcnt(2)
    v_exp_f32 v18, v114
    v_mfma_f32_16x16x32_bf16 a[32:35], v[64:67], v[40:43], a[32:35]
    ds_read_b128 v[32:35], v22 offset:1536
    v_add_f32 v5, v5, v16
    v_mfma_f32_16x16x32_bf16 a[32:35], v[80:83], v[44:47], a[32:35]
    buffer_store_dwordx4 v[148:151], v20, s[4:7], s81 offen offset:768 sc1
    v_mfma_f32_16x16x32_bf16 a[80:83], v[68:71], v[40:43], a[80:83]
    v_add_f32 v5, v5, v17
    v_add_u32 v3, s3, v3
    v_mfma_f32_16x16x32_bf16 a[80:83], v[84:87], v[44:47], a[80:83]
    v_exp_f32 v19, v115
    v_mfma_f32_16x16x32_bf16 a[128:131], v[72:75], v[40:43], a[128:131]
    ds_read_b128 v[36:39], v22 offset:13824
    v_cvt_pk_bf16_f32 v178, v16, v17
    v_mfma_f32_16x16x32_bf16 a[128:131], v[88:91], v[44:47], a[128:131]
    v_exp_f32 v16, v180
    v_mfma_f32_16x16x32_bf16 a[176:179], v[76:79], v[40:43], a[176:179]
    v_add_f32 v5, v5, v18
    v_mfma_f32_16x16x32_bf16 a[176:179], v[92:95], v[44:47], a[176:179]
    s_waitcnt lgkmcnt(2)
    v_add_f32 v5, v5, v19
    v_mfma_f32_16x16x32_bf16 a[36:39], v[64:67], v[24:27], a[36:39]
    ds_read_b128 v[40:43], v22 offset:2304
    v_mfma_f32_16x16x32_bf16 a[36:39], v[80:83], v[28:31], a[36:39]
    buffer_store_dwordx4 v[152:155], v20, s[4:7], s81 offen offset:1536 sc1
    v_mfma_f32_16x16x32_bf16 a[84:87], v[68:71], v[24:27], a[84:87]
    v_exp_f32 v17, v181
    v_mfma_f32_16x16x32_bf16 a[84:87], v[84:87], v[28:31], a[84:87]
    v_cvt_pk_bf16_f32 v179, v18, v19
    v_mfma_f32_16x16x32_bf16 a[132:135], v[72:75], v[24:27], a[132:135]
    ds_read_b128 v[44:47], v22 offset:14592
    v_mfma_f32_16x16x32_bf16 a[132:135], v[88:91], v[28:31], a[132:135]
    s_waitcnt lgkmcnt(2)
    v_exp_f32 v18, v182
    v_mfma_f32_16x16x32_bf16 a[180:183], v[76:79], v[24:27], a[180:183]
    s_waitcnt vmcnt(29)
    v_add_f32 v6, v6, v16
    v_add_f32 v6, v6, v17
    v_mfma_f32_16x16x32_bf16 a[180:183], v[92:95], v[28:31], a[180:183]
    s_barrier
    v_mfma_f32_16x16x32_bf16 a[40:43], v[64:67], v[32:35], a[40:43]
    ds_read_b128 v[24:27], v2 offset:0
    v_mfma_f32_16x16x32_bf16 a[40:43], v[80:83], v[36:39], a[40:43]
    v_exp_f32 v19, v183
    v_mfma_f32_16x16x32_bf16 a[88:91], v[68:71], v[32:35], a[88:91]
    v_cvt_pk_bf16_f32 v180, v16, v17
    v_mfma_f32_16x16x32_bf16 a[88:91], v[84:87], v[36:39], a[88:91]
    v_exp_f32 v16, v116
    v_mfma_f32_16x16x32_bf16 a[136:139], v[72:75], v[32:35], a[136:139]
    ds_read_b128 v[28:31], v3 offset:0
    v_add_f32 v6, v6, v18
    v_mfma_f32_16x16x32_bf16 a[136:139], v[88:91], v[36:39], a[136:139]
    buffer_store_dwordx4 v[156:159], v20, s[4:7], s81 offen offset:2304 sc1
    v_mfma_f32_16x16x32_bf16 a[184:187], v[76:79], v[32:35], a[184:187]
    v_add_f32 v6, v6, v19
    v_mfma_f32_16x16x32_bf16 a[184:187], v[92:95], v[36:39], a[184:187]
    s_waitcnt lgkmcnt(2)
    v_exp_f32 v17, v117
    v_mfma_f32_16x16x32_bf16 a[44:47], v[64:67], v[40:43], a[44:47]
    ds_read_b128 v[32:35], v2 offset:6144
    v_cvt_pk_bf16_f32 v181, v18, v19
    v_mfma_f32_16x16x32_bf16 a[44:47], v[80:83], v[44:47], a[44:47]
    v_exp_f32 v18, v118
    v_mfma_f32_16x16x32_bf16 a[92:95], v[68:71], v[40:43], a[92:95]
    v_add_f32 v6, v6, v16
    v_add_f32 v6, v6, v17
    v_mfma_f32_16x16x32_bf16 a[92:95], v[84:87], v[44:47], a[92:95]
    v_exp_f32 v19, v119
    v_mfma_f32_16x16x32_bf16 a[140:143], v[72:75], v[40:43], a[140:143]
    ds_read_b128 v[36:39], v3 offset:6144
    v_cvt_pk_bf16_f32 v182, v16, v17
    v_mfma_f32_16x16x32_bf16 a[140:143], v[88:91], v[44:47], a[140:143]
    v_add_f32 v6, v6, v18
    v_add_f32 v6, v6, v19
    v_mfma_f32_16x16x32_bf16 a[188:191], v[76:79], v[40:43], a[188:191]
    v_cvt_pk_bf16_f32 v183, v18, v19
    v_mfma_f32_16x16x32_bf16 a[188:191], v[92:95], v[44:47], a[188:191]
    s_waitcnt lgkmcnt(2)
    v_mfma_f32_16x16x32_bf16 v[64:67], v[24:27], a[192:195], v[128:131]
    ds_read_b128 v[40:43], v2 offset:128
    v_mfma_f32_16x16x32_bf16 v[64:67], v[28:31], a[196:199], v[64:67]
    s_waitcnt vmcnt(9)
    v_subrev_u32 v52, s92, v52
    v_cmp_lt_u32 vcc, 15, v52
    v_mfma_f32_16x16x32_bf16 v[68:71], v[24:27], a[216:219], v[132:135]
    v_exp_f32 v16, v184
    v_mfma_f32_16x16x32_bf16 v[68:71], v[28:31], a[220:223], v[68:71]
    v_exp_f32 v17, v185
    v_mfma_f32_16x16x32_bf16 v[72:75], v[24:27], a[240:243], v[136:139]
    s_and_b32 s59, vcc_lo, 0xff
    ds_read_b128 v[44:47], v3 offset:128
    v_mfma_f32_16x16x32_bf16 v[72:75], v[28:31], a[244:247], v[72:75]
    s_cbranch_scc1 L_pollslow5
L_pollok5:
    v_mfma_f32_16x16x32_bf16 v[76:79], v[24:27], v[200:203], v[140:143]
    s_add_u32 s92, s92, 1
    v_exp_f32 v18, v186
    v_mfma_f32_16x16x32_bf16 v[76:79], v[28:31], v[204:207], v[76:79]
    s_waitcnt lgkmcnt(2)
    v_add_f32 v7, v7, v16
    v_add_f32 v7, v7, v17
    v_mfma_f32_16x16x32_bf16 v[96:99], v[32:35], a[192:195], v[128:131]
    s_mov_b32 m0, s26
    ds_read_b128 v[24:27], v2 offset:6272
    v_mfma_f32_16x16x32_bf16 v[96:99], v[36:39], a[196:199], v[96:99]
    v_exp_f32 v19, v187
    v_mfma_f32_16x16x32_bf16 v[100:103], v[32:35], a[216:219], v[132:135]
    v_cvt_pk_bf16_f32 v184, v16, v17
    v_mfma_f32_16x16x32_bf16 v[100:103], v[36:39], a[220:223], v[100:103]
    v_exp_f32 v16, v120
    v_mfma_f32_16x16x32_bf16 v[104:107], v[32:35], a[240:243], v[136:139]
    ds_read_b128 v[28:31], v3 offset:6272
    v_add_f32 v7, v7, v18
    v_mfma_f32_16x16x32_bf16 v[104:107], v[36:39], a[244:247], v[104:107]
    buffer_load_dwordx4 v4, s[4:7], s32 offen offset:0 sc1 lds
    v_mfma_f32_16x16x32_bf16 v[108:111], v[32:35], v[200:203], v[140:143]
    v_add_f32 v7, v7, v19
    v_mfma_f32_16x16x32_bf16 v[108:111], v[36:39], v[204:207], v[108:111]
    s_waitcnt lgkmcnt(2)
    v_exp_f32 v17, v121
    v_mfma_f32_16x16x32_bf16 v[64:67], v[40:43], a[200:203], v[64:67]
    ds_read_b128 v[32:35], v2 offset:256
    v_cvt_pk_bf16_f32 v185, v18, v19
    v_mfma_f32_16x16x32_bf16 v[64:67], v[44:47], a[204:207], v[64:67]
    v_exp_f32 v18, v122
    v_mfma_f32_16x16x32_bf16 v[68:71], v[40:43], a[224:227], v[68:71]
    v_add_f32 v7, v7, v16
    v_add_f32 v7, v7, v17
    v_mfma_f32_16x16x32_bf16 v[68:71], v[44:47], a[228:231], v[68:71]
    v_mfma_f32_16x16x32_bf16 v[72:75], v[40:43], a[248:251], v[72:75]
    ds_read_b128 v[36:39], v3 offset:256
    v_mfma_f32_16x16x32_bf16 v[72:75], v[44:47], a[252:255], v[72:75]
    buffer_load_dwordx4 v4, s[4:7], s32 offen offset:1024 sc1 lds
    v_mfma_f32_16x16x32_bf16 v[76:79], v[40:43], v[208:211], v[76:79]
    v_exp_f32 v19, v123
    v_mfma_f32_16x16x32_bf16 v[76:79], v[44:47], v[212:215], v[76:79]
    s_waitcnt lgkmcnt(2)
    v_cvt_pk_bf16_f32 v186, v16, v17
    v_mfma_f32_16x16x32_bf16 v[96:99], v[24:27], a[200:203], v[96:99]
    ds_read_b128 v[40:43], v2 offset:6400
    v_mfma_f32_16x16x32_bf16 v[96:99], v[28:31], a[204:207], v[96:99]
    v_exp_f32 v16, v188
    v_mfma_f32_16x16x32_bf16 v[100:103], v[24:27], a[224:227], v[100:103]
    v_add_f32 v7, v7, v18
    v_add_f32 v7, v7, v19
    v_mfma_f32_16x16x32_bf16 v[100:103], v[28:31], a[228:231], v[100:103]
    v_exp_f32 v17, v189
    v_mfma_f32_16x16x32_bf16 v[104:107], v[24:27], a[248:251], v[104:107]
    ds_read_b128 v[44:47], v3 offset:6400
    v_cvt_pk_bf16_f32 v187, v18, v19
    v_mfma_f32_16x16x32_bf16 v[104:107], v[28:31], a[252:255], v[104:107]
    buffer_load_dwordx4 v4, s[4:7], s32 offen offset:2048 sc1 lds
    v_mfma_f32_16x16x32_bf16 v[108:111], v[24:27], v[208:211], v[108:111]
    s_add_u32 s29, s30, 49152
    v_exp_f32 v18, v190
    v_mfma_f32_16x16x32_bf16 v[108:111], v[28:31], v[212:215], v[108:111]
    s_waitcnt lgkmcnt(2)
    v_add_f32 v8, v8, v16
    v_add_f32 v8, v8, v17
    v_mfma_f32_16x16x32_bf16 v[64:67], v[32:35], a[208:211], v[64:67]
    s_sub_u32 s3, s29, 147456
    ds_read_b128 v[24:27], v2 offset:12288
    v_mfma_f32_16x16x32_bf16 v[64:67], v[36:39], a[212:215], v[64:67]
    v_exp_f32 v19, v191
    v_mfma_f32_16x16x32_bf16 v[68:71], v[32:35], a[232:235], v[68:71]
    v_cvt_pk_bf16_f32 v188, v16, v17
    v_mfma_f32_16x16x32_bf16 v[68:71], v[36:39], a[236:239], v[68:71]
    s_add_u32 s32, s32, 24576
    v_exp_f32 v16, v124
    v_mfma_f32_16x16x32_bf16 v[72:75], v[32:35], v[192:195], v[72:75]
    ds_read_b128 v[28:31], v3 offset:12288
    v_add_f32 v8, v8, v18
    v_mfma_f32_16x16x32_bf16 v[72:75], v[36:39], v[196:199], v[72:75]
    v_add_f32 v8, v8, v19
    v_mfma_f32_16x16x32_bf16 v[76:79], v[32:35], v[216:219], v[76:79]
    s_min_u32 s29, s29, s3
    v_mfma_f32_16x16x32_bf16 v[76:79], v[36:39], v[220:223], v[76:79]
    s_waitcnt lgkmcnt(2)
    v_exp_f32 v17, v125
    v_mfma_f32_16x16x32_bf16 v[96:99], v[40:43], a[208:211], v[96:99]
    s_add_u32 s26, s26, 12288
    ds_read_b128 v[32:35], v2 offset:18432
    v_cvt_pk_bf16_f32 v189, v18, v19
    v_mfma_f32_16x16x32_bf16 v[96:99], v[44:47], a[212:215], v[96:99]
    v_exp_f32 v18, v126
    v_mfma_f32_16x16x32_bf16 v[100:103], v[40:43], a[232:235], v[100:103]
    v_mfma_f32_16x16x32_bf16 v[100:103], v[44:47], a[236:239], v[100:103]
    s_mov_b32 m0, s26
    v_add_f32 v8, v8, v16
    v_mfma_f32_16x16x32_bf16 v[104:107], v[40:43], v[192:195], v[104:107]
    s_sub_u32 s3, s29, s30
    ds_read_b128 v[36:39], v3 offset:18432
    v_add_f32 v8, v8, v17
    v_mfma_f32_16x16x32_bf16 v[104:107], v[44:47], v[196:199], v[104:107]
    v_exp_f32 v19, v127
    v_mfma_f32_16x16x32_bf16 v[108:111], v[40:43], v[216:219], v[108:111]
    v_cvt_pk_bf16_f32 v190, v16, v17
    v_mfma_f32_16x16x32_bf16 v[108:111], v[44:47], v[220:223], v[108:111]
    s_waitcnt lgkmcnt(2)
    v_add_f32 v8, v8, v18
    v_mfma_f32_16x16x32_bf16 v[80:83], v[24:27], a[192:195], v[128:131]
    ds_read_b128 v[40:43], v2 offset:12416
    v_add_f32 v8, v8, v19
    v_mfma_f32_16x16x32_bf16 v[80:83], v[28:31], a[196:199], v[80:83]
    buffer_load_dwordx4 v4, s[4:7], s32 offen offset:0 sc1 lds
    v_mfma_f32_16x16x32_bf16 v[84:87], v[24:27], a[216:219], v[132:135]
    s_mov_b32 s30, s29
    v_cvt_pk_bf16_f32 v191, v18, v19
    v_mfma_f32_16x16x32_bf16 v[84:87], v[28:31], a[220:223], v[84:87]
    v_mfma_f32_16x16x32_bf16 v[88:91], v[24:27], a[240:243], v[136:139]
    ds_read_b128 v[44:47], v3 offset:12416
    v_mfma_f32_16x16x32_bf16 v[88:91], v[28:31], a[244:247], v[88:91]
    v_exp_f32 v16, v64
    v_mfma_f32_16x16x32_bf16 v[92:95], v[24:27], v[200:203], v[140:143]
    v_exp_f32 v17, v65
    v_mfma_f32_16x16x32_bf16 v[92:95], v[28:31], v[204:207], v[92:95]
    s_waitcnt lgkmcnt(2)
    v_exp_f32 v18, v66
    v_mfma_f32_16x16x32_bf16 v[112:115], v[32:35], a[192:195], v[128:131]
    ds_read_b128 v[24:27], v2 offset:18560
    v_add_f32 v5, v5, v16
    v_mfma_f32_16x16x32_bf16 v[112:115], v[36:39], a[196:199], v[112:115]
    v_add_f32 v5, v5, v17
    v_add_u32 v1, s3, v1
    v_mfma_f32_16x16x32_bf16 v[116:119], v[32:35], a[216:219], v[132:135]
    v_exp_f32 v19, v67
    v_mfma_f32_16x16x32_bf16 v[116:119], v[36:39], a[220:223], v[116:119]
    buffer_load_dwordx4 v4, s[4:7], s32 offen offset:1024 sc1 lds
    v_mfma_f32_16x16x32_bf16 v[120:123], v[32:35], a[240:243], v[136:139]
    ds_read_b128 v[28:31], v3 offset:18560
    v_cvt_pk_bf16_f32 v64, v16, v17
    v_mfma_f32_16x16x32_bf16 v[120:123], v[36:39], a[244:247], v[120:123]
    v_exp_f32 v16, v96
    v_mfma_f32_16x16x32_bf16 v[124:127], v[32:35], v[200:203], v[140:143]
    v_add_f32 v5, v5, v18
    v_add_f32 v5, v5, v19
    v_mfma_f32_16x16x32_bf16 v[124:127], v[36:39], v[204:207], v[124:127]
    s_waitcnt lgkmcnt(2)
    v_exp_f32 v17, v97
    v_mfma_f32_16x16x32_bf16 v[80:83], v[40:43], a[200:203], v[80:83]
    ds_read_b128 v[32:35], v2 offset:12544
    v_add_u32 v21, s3, v21
    v_mfma_f32_16x16x32_bf16 v[80:83], v[44:47], a[204:207], v[80:83]
    v_cvt_pk_bf16_f32 v65, v18, v19
    v_mfma_f32_16x16x32_bf16 v[84:87], v[40:43], a[224:227], v[84:87]
    v_exp_f32 v18, v98
    v_mfma_f32_16x16x32_bf16 v[84:87], v[44:47], a[228:231], v[84:87]
    buffer_load_dwordx4 v4, s[4:7], s32 offen offset:2048 sc1 lds
    v_mfma_f32_16x16x32_bf16 v[88:91], v[40:43], a[248:251], v[88:91]
    ds_read_b128 v[36:39], v3 offset:12544
    v_add_f32 v5, v5, v16
    v_mfma_f32_16x16x32_bf16 v[88:91], v[44:47], a[252:255], v[88:91]
    v_add_f32 v5, v5, v17
    v_add_u32 v22, s3, v22
    v_mfma_f32_16x16x32_bf16 v[92:95], v[40:43], v[208:211], v[92:95]
    v_exp_f32 v19, v99
    v_mfma_f32_16x16x32_bf16 v[92:95], v[44:47], v[212:215], v[92:95]
    s_waitcnt lgkmcnt(2)
    v_cvt_pk_bf16_f32 v66, v16, v17
    v_mfma_f32_16x16x32_bf16 v[112:115], v[24:27], a[200:203], v[112:115]
    ds_read_b128 v[40:43], v2 offset:18688
    v_mfma_f32_16x16x32_bf16 v[112:115], v[28:31], a[204:207], v[112:115]
    v_exp_f32 v16, v68
    v_mfma_f32_16x16x32_bf16 v[116:119], v[24:27], a[224:227], v[116:119]
    v_add_f32 v5, v5, v18
    v_add_f32 v5, v5, v19
    v_mfma_f32_16x16x32_bf16 v[116:119], v[28:31], a[228:231], v[116:119]
    s_add_u32 s32, s32, 24576
    v_exp_f32 v17, v69
    v_mfma_f32_16x16x32_bf16 v[120:123], v[24:27], a[248:251], v[120:123]
    s_add_u32 s26, s26, 36864
    ds_read_b128 v[44:47], v3 offset:18688
    v_cvt_pk_bf16_f32 v67, v18, v19
    v_mfma_f32_16x16x32_bf16 v[120:123], v[28:31], a[252:255], v[120:123]
    s_waitcnt lgkmcnt(2)
    v_exp_f32 v18, v70
    v_mfma_f32_16x16x32_bf16 v[124:127], v[24:27], v[208:211], v[124:127]
    s_waitcnt vmcnt(6)
    v_add_f32 v6, v6, v16
    v_mfma_f32_16x16x32_bf16 v[124:127], v[28:31], v[212:215], v[124:127]
    s_barrier
    v_add_f32 v6, v6, v17
    v_mfma_f32_16x16x32_bf16 v[80:83], v[32:35], a[208:211], v[80:83]
    s_sub_u32 s57, s26, 147456
    ds_read_b128 v[24:27], v1 offset:0
    v_add_u32 v55, 1, v55
    v_mfma_f32_16x16x32_bf16 v[80:83], v[36:39], a[212:215], v[80:83]
    v_exp_f32 v19, v71
    v_mfma_f32_16x16x32_bf16 v[84:87], v[32:35], a[232:235], v[84:87]
    s_min_u32 s26, s26, s57
    v_cvt_pk_bf16_f32 v68, v16, v17
    v_mfma_f32_16x16x32_bf16 v[84:87], v[36:39], a[236:239], v[84:87]
    v_exp_f32 v16, v100
    v_mfma_f32_16x16x32_bf16 v[88:91], v[32:35], v[192:195], v[88:91]
    ds_read_b128 v[28:31], v1 offset:12288
    v_add_f32 v6, v6, v18
    v_mfma_f32_16x16x32_bf16 v[88:91], v[36:39], v[196:199], v[88:91]
    buffer_store_dword v55, v13, s[20:23], 0 offen sc1
    v_mfma_f32_16x16x32_bf16 v[92:95], v[32:35], v[216:219], v[92:95]
    v_add_f32 v6, v6, v19
    v_mfma_f32_16x16x32_bf16 v[92:95], v[36:39], v[220:223], v[92:95]
    s_waitcnt lgkmcnt(2)
    v_exp_f32 v17, v101
    v_mfma_f32_16x16x32_bf16 v[112:115], v[40:43], a[208:211], v[112:115]
    ds_read_b128 v[32:35], v1 offset:768
    v_cvt_pk_bf16_f32 v69, v18, v19
    v_mfma_f32_16x16x32_bf16 v[112:115], v[44:47], a[212:215], v[112:115]
    v_exp_f32 v18, v102
    v_mfma_f32_16x16x32_bf16 v[116:119], v[40:43], a[232:235], v[116:119]
    v_add_f32 v6, v6, v16
    v_add_f32 v6, v6, v17
    v_mfma_f32_16x16x32_bf16 v[116:119], v[44:47], a[236:239], v[116:119]
    v_exp_f32 v19, v103
    v_mfma_f32_16x16x32_bf16 v[120:123], v[40:43], v[192:195], v[120:123]
    ds_read_b128 v[36:39], v1 offset:13056
    v_cvt_pk_bf16_f32 v70, v16, v17
    v_mfma_f32_16x16x32_bf16 v[120:123], v[44:47], v[196:199], v[120:123]
    v_add_f32 v6, v6, v18
    v_mfma_f32_16x16x32_bf16 v[124:127], v[40:43], v[216:219], v[124:127]
    v_add_f32 v6, v6, v19
    v_cvt_pk_bf16_f32 v71, v18, v19
    v_mfma_f32_16x16x32_bf16 v[124:127], v[44:47], v[220:223], v[124:127]
    s_waitcnt lgkmcnt(2)
    s_mov_b32 s31, 2
.p2align 6
L_loop2:
    v_mfma_f32_16x16x32_bf16 a[0:3], v[160:163], v[24:27], a[0:3]
    s_mov_b32 m0, s56
    ds_read_b128 v[40:43], v1 offset:1536
    v_mfma_f32_16x16x32_bf16 a[0:3], v[176:179], v[28:31], a[0:3]
    v_exp_f32 v16, v72
    v_mfma_f32_16x16x32_bf16 a[48:51], v[164:167], v[24:27], a[48:51]
    v_exp_f32 v17, v73
    v_mfma_f32_16x16x32_bf16 a[48:51], v[180:183], v[28:31], a[48:51]
    v_exp_f32 v18, v74
    v_mfma_f32_16x16x32_bf16 a[96:99], v[168:171], v[24:27], a[96:99]
    ds_read_b128 v[44:47], v1 offset:13824
    v_add_f32 v7, v7, v16
    v_mfma_f32_16x16x32_bf16 a[96:99], v[184:187], v[28:31], a[96:99]
    buffer_load_dwordx4 v4, s[4:7], s27 offen offset:0 sc1 lds
    v_mfma_f32_16x16x32_bf16 a[144:147], v[172:175], v[24:27], a[144:147]
    v_add_f32 v7, v7, v17
    v_mfma_f32_16x16x32_bf16 a[144:147], v[188:191], v[28:31], a[144:147]
    s_waitcnt lgkmcnt(2)
    v_exp_f32 v19, v75
    v_mfma_f32_16x16x32_bf16 a[4:7], v[160:163], v[32:35], a[4:7]
    ds_read_b128 v[24:27], v1 offset:2304
    v_cvt_pk_bf16_f32 v72, v16, v17
    v_mfma_f32_16x16x32_bf16 a[4:7], v[176:179], v[36:39], a[4:7]
    v_exp_f32 v16, v104
    v_mfma_f32_16x16x32_bf16 a[52:55], v[164:167], v[32:35], a[52:55]
    v_add_f32 v7, v7, v18
    v_mfma_f32_16x16x32_bf16 a[52:55], v[180:183], v[36:39], a[52:55]
    v_add_f32 v7, v7, v19
    v_mfma_f32_16x16x32_bf16 a[100:103], v[168:171], v[32:35], a[100:103]
    ds_read_b128 v[28:31], v1 offset:14592
    v_mfma_f32_16x16x32_bf16 a[100:103], v[184:187], v[36:39], a[100:103]
    v_exp_f32 v17, v105
    v_mfma_f32_16x16x32_bf16 a[148:151], v[172:175], v[32:35], a[148:151]
    v_cvt_pk_bf16_f32 v73, v18, v19
    v_mfma_f32_16x16x32_bf16 a[148:151], v[188:191], v[36:39], a[148:151]
    s_waitcnt lgkmcnt(2)
    buffer_load_dwordx4 v4, s[4:7], s27 offen offset:1024 sc1 lds
    v_mfma_f32_16x16x32_bf16 a[8:11], v[160:163], v[40:43], a[8:11]
    ds_read_b128 v[32:35], v21 offset:0
    v_mfma_f32_16x16x32_bf16 a[8:11], v[176:179], v[44:47], a[8:11]
    v_exp_f32 v18, v106
    v_mfma_f32_16x16x32_bf16 a[56:59], v[164:167], v[40:43], a[56:59]
    v_add_f32 v7, v7, v16
    v_add_f32 v7, v7, v17
    v_mfma_f32_16x16x32_bf16 a[56:59], v[180:183], v[44:47], a[56:59]
    v_exp_f32 v19, v107
    v_mfma_f32_16x16x32_bf16 a[104:107], v[168:171], v[40:43], a[104:107]
    ds_read_b128 v[36:39], v21 offset:12288
    v_cvt_pk_bf16_f32 v74, v16, v17
    v_mfma_f32_16x16x32_bf16 a[104:107], v[184:187], v[44:47], a[104:107]
    v_exp_f32 v16, v76
    v_mfma_f32_16x16x32_bf16 a[152:155], v[172:175], v[40:43], a[152:155]
    v_add_f32 v7, v7, v18
    v_mfma_f32_16x16x32_bf16 a[152:155], v[188:191], v[44:47], a[152:155]
    s_waitcnt lgkmcnt(2)
    buffer_load_dwordx4 v4, s[4:7], s27 offen offset:2048 sc1 lds
    v_mfma_f32_16x16x32_bf16 a[12:15], v[160:163], v[24:27], a[12:15]
    ds_read_b128 v[40:43], v21 offset:768
    v_add_f32 v7, v7, v19
    v_mfma_f32_16x16x32_bf16 a[12:15], v[176:179], v[28:31], a[12:15]
    v_exp_f32 v17, v77
    v_mfma_f32_16x16x32_bf16 a[60:63], v[164:167], v[24:27], a[60:63]
    v_cvt_pk_bf16_f32 v75, v18, v19
    v_mfma_f32_16x16x32_bf16 a[60:63], v[180:183], v[28:31], a[60:63]
    v_exp_f32 v18, v78
    v_mfma_f32_16x16x32_bf16 a[108:111], v[168:171], v[24:27], a[108:111]
    ds_read_b128 v[44:47], v21 offset:13056
    v_add_f32 v8, v8, v16
    v_mfma_f32_16x16x32_bf16 a[108:111], v[184:187], v[28:31], a[108:111]
    v_add_f32 v8, v8, v17
    v_mfma_f32_16x16x32_bf16 a[156:159], v[172:175], v[24:27], a[156:159]
    s_add_u32 s29, s28, 49152
    v_exp_f32 v19, v79
    v_mfma_f32_16x16x32_bf16 a[156:159], v[188:191], v[28:31], a[156:159]
    s_waitcnt lgkmcnt(2)
    s_add_u32 s27, s27, 24576
    v_mfma_f32_16x16x32_bf16 a[16:19], v[160:163], v[32:35], a[16:19]
    ds_read_b128 v[24:27], v21 offset:1536
    v_cvt_pk_bf16_f32 v76, v16, v17
    v_mfma_f32_16x16x32_bf16 a[16:19], v[176:179], v[36:39], a[16:19]
    s_sub_u32 s3, s29, 147456
    v_exp_f32 v16, v108
    v_mfma_f32_16x16x32_bf16 a[64:67], v[164:167], v[32:35], a[64:67]
    v_add_f32 v8, v8, v18
    v_mfma_f32_16x16x32_bf16 a[64:67], v[180:183], v[36:39], a[64:67]
    s_add_u32 s56, s56, 12288
    v_add_f32 v8, v8, v19
    v_mfma_f32_16x16x32_bf16 a[112:115], v[168:171], v[32:35], a[112:115]
    ds_read_b128 v[28:31], v21 offset:13824
    v_mfma_f32_16x16x32_bf16 a[112:115], v[184:187], v[36:39], a[112:115]
    v_exp_f32 v17, v109
    v_mfma_f32_16x16x32_bf16 a[160:163], v[172:175], v[32:35], a[160:163]
    v_cvt_pk_bf16_f32 v77, v18, v19
    v_mfma_f32_16x16x32_bf16 a[160:163], v[188:191], v[36:39], a[160:163]
    s_waitcnt lgkmcnt(2)
    v_exp_f32 v18, v110
    v_mfma_f32_16x16x32_bf16 a[20:23], v[160:163], v[40:43], a[20:23]
    s_mov_b32 m0, s56
    ds_read_b128 v[32:35], v21 offset:2304
    v_add_f32 v8, v8, v16
    v_mfma_f32_16x16x32_bf16 a[20:23], v[176:179], v[44:47], a[20:23]
    s_min_u32 s29, s29, s3
    v_add_f32 v8, v8, v17
    v_mfma_f32_16x16x32_bf16 a[68:71], v[164:167], v[40:43], a[68:71]
    v_exp_f32 v19, v111
    v_mfma_f32_16x16x32_bf16 a[68:71], v[180:183], v[44:47], a[68:71]
    v_mfma_f32_16x16x32_bf16 a[116:119], v[168:171], v[40:43], a[116:119]
    ds_read_b128 v[36:39], v21 offset:14592
    v_cvt_pk_bf16_f32 v78, v16, v17
    v_mfma_f32_16x16x32_bf16 a[116:119], v[184:187], v[44:47], a[116:119]
    v_add_f32 v8, v8, v18
    v_add_f32 v8, v8, v19
    v_mfma_f32_16x16x32_bf16 a[164:167], v[172:175], v[40:43], a[164:167]
    s_sub_u32 s3, s29, s28
    v_cvt_pk_bf16_f32 v79, v18, v19
    v_mfma_f32_16x16x32_bf16 a[164:167], v[188:191], v[44:47], a[164:167]
    s_waitcnt lgkmcnt(2)
    buffer_load_dwordx4 v4, s[4:7], s27 offen offset:0 sc1 lds
    v_mfma_f32_16x16x32_bf16 a[24:27], v[160:163], v[24:27], a[24:27]
    ds_read_b128 v[40:43], v22 offset:0
    v_mfma_f32_16x16x32_bf16 a[24:27], v[176:179], v[28:31], a[24:27]
    v_exp_f32 v16, v80
    v_mfma_f32_16x16x32_bf16 a[72:75], v[164:167], v[24:27], a[72:75]
    v_exp_f32 v17, v81
    v_mfma_f32_16x16x32_bf16 a[72:75], v[180:183], v[28:31], a[72:75]
    v_exp_f32 v18, v82
    v_mfma_f32_16x16x32_bf16 a[120:123], v[168:171], v[24:27], a[120:123]
    ds_read_b128 v[44:47], v22 offset:12288
    v_add_f32 v5, v5, v16
    v_mfma_f32_16x16x32_bf16 a[120:123], v[184:187], v[28:31], a[120:123]
    s_mov_b32 s28, s29
    v_add_f32 v5, v5, v17
    v_mfma_f32_16x16x32_bf16 a[168:171], v[172:175], v[24:27], a[168:171]
    v_exp_f32 v19, v83
    v_mfma_f32_16x16x32_bf16 a[168:171], v[188:191], v[28:31], a[168:171]
    s_waitcnt lgkmcnt(2)
    v_mfma_f32_16x16x32_bf16 a[28:31], v[160:163], v[32:35], a[28:31]
    ds_read_b128 v[24:27], v22 offset:768
    v_cvt_pk_bf16_f32 v80, v16, v17
    v_mfma_f32_16x16x32_bf16 a[28:31], v[176:179], v[36:39], a[28:31]
    buffer_load_dwordx4 v4, s[4:7], s27 offen offset:1024 sc1 lds
    v_mfma_f32_16x16x32_bf16 a[76:79], v[164:167], v[32:35], a[76:79]
    v_exp_f32 v16, v112
    v_mfma_f32_16x16x32_bf16 a[76:79], v[180:183], v[36:39], a[76:79]
    v_add_f32 v5, v5, v18
    v_add_f32 v5, v5, v19
    v_mfma_f32_16x16x32_bf16 a[124:127], v[168:171], v[32:35], a[124:127]
    ds_read_b128 v[28:31], v22 offset:13056
    v_add_u32 v2, s3, v2
    v_mfma_f32_16x16x32_bf16 a[124:127], v[184:187], v[36:39], a[124:127]
    v_exp_f32 v17, v113
    v_mfma_f32_16x16x32_bf16 a[172:175], v[172:175], v[32:35], a[172:175]
    v_cvt_pk_bf16_f32 v81, v18, v19
    v_mfma_f32_16x16x32_bf16 a[172:175], v[188:191], v[36:39], a[172:175]
    s_waitcnt lgkmcnt(2)
    v_exp_f32 v18, v114
    v_mfma_f32_16x16x32_bf16 a[32:35], v[160:163], v[40:43], a[32:35]
    ds_read_b128 v[32:35], v22 offset:1536
    v_add_f32 v5, v5, v16
    v_mfma_f32_16x16x32_bf16 a[32:35], v[176:179], v[44:47], a[32:35]
    buffer_load_dwordx4 v4, s[4:7], s27 offen offset:2048 sc1 lds
    v_mfma_f32_16x16x32_bf16 a[80:83], v[164:167], v[40:43], a[80:83]
    v_add_f32 v5, v5, v17
    v_add_u32 v3, s3, v3
    v_mfma_f32_16x16x32_bf16 a[80:83], v[180:183], v[44:47], a[80:83]
    v_exp_f32 v19, v115
    v_mfma_f32_16x16x32_bf16 a[128:131], v[168:171], v[40:43], a[128:131]
    ds_read_b128 v[36:39], v22 offset:13824
    v_cvt_pk_bf16_f32 v82, v16, v17
    v_mfma_f32_16x16x32_bf16 a[128:131], v[184:187], v[44:47], a[128:131]
    v_exp_f32 v16, v84
    v_mfma_f32_16x16x32_bf16 a[176:179], v[172:175], v[40:43], a[176:179]
    v_add_f32 v5, v5, v18
    v_mfma_f32_16x16x32_bf16 a[176:179], v[188:191], v[44:47], a[176:179]
    s_waitcnt lgkmcnt(2)
    v_add_f32 v5, v5, v19
    v_mfma_f32_16x16x32_bf16 a[36:39], v[160:163], v[24:27], a[36:39]
    ds_read_b128 v[40:43], v22 offset:2304
    v_mfma_f32_16x16x32_bf16 a[36:39], v[176:179], v[28:31], a[36:39]
    v_exp_f32 v17, v85
    v_mfma_f32_16x16x32_bf16 a[84:87], v[164:167], v[24:27], a[84:87]
    v_cvt_pk_bf16_f32 v83, v18, v19
    v_mfma_f32_16x16x32_bf16 a[84:87], v[180:183], v[28:31], a[84:87]
    s_add_u32 s27, s27, 24576
    v_exp_f32 v18, v86
    v_mfma_f32_16x16x32_bf16 a[132:135], v[168:171], v[24:27], a[132:135]
    s_add_u32 s56, s56, 36864
    ds_read_b128 v[44:47], v22 offset:14592
    v_add_f32 v6, v6, v16
    v_mfma_f32_16x16x32_bf16 a[132:135], v[184:187], v[28:31], a[132:135]
    s_waitcnt lgkmcnt(2)
    v_add_f32 v6, v6, v17
    v_mfma_f32_16x16x32_bf16 a[180:183], v[172:175], v[24:27], a[180:183]
    s_waitcnt vmcnt(24)
    v_exp_f32 v19, v87
    v_mfma_f32_16x16x32_bf16 a[180:183], v[188:191], v[28:31], a[180:183]
    s_barrier
    s_sub_u32 s58, s56, 147456
    v_mfma_f32_16x16x32_bf16 a[40:43], v[160:163], v[32:35], a[40:43]
    ds_read_b128 v[24:27], v2 offset:0
    v_cvt_pk_bf16_f32 v84, v16, v17
    v_mfma_f32_16x16x32_bf16 a[40:43], v[176:179], v[36:39], a[40:43]
    v_exp_f32 v16, v116
    v_mfma_f32_16x16x32_bf16 a[88:91], v[164:167], v[32:35], a[88:91]
    s_min_u32 s56, s56, s58
    v_add_f32 v6, v6, v18
    v_mfma_f32_16x16x32_bf16 a[88:91], v[180:183], v[36:39], a[88:91]
    v_add_f32 v6, v6, v19
    v_mfma_f32_16x16x32_bf16 a[136:139], v[168:171], v[32:35], a[136:139]
    ds_read_b128 v[28:31], v3 offset:0
    v_mfma_f32_16x16x32_bf16 a[136:139], v[184:187], v[36:39], a[136:139]
    v_exp_f32 v17, v117
    v_mfma_f32_16x16x32_bf16 a[184:187], v[172:175], v[32:35], a[184:187]
    v_cvt_pk_bf16_f32 v85, v18, v19
    v_mfma_f32_16x16x32_bf16 a[184:187], v[188:191], v[36:39], a[184:187]
    s_waitcnt lgkmcnt(2)
    v_exp_f32 v18, v118
    v_mfma_f32_16x16x32_bf16 a[44:47], v[160:163], v[40:43], a[44:47]
    ds_read_b128 v[32:35], v2 offset:6144
    v_add_f32 v6, v6, v16
    v_mfma_f32_16x16x32_bf16 a[44:47], v[176:179], v[44:47], a[44:47]
    v_add_f32 v6, v6, v17
    v_mfma_f32_16x16x32_bf16 a[92:95], v[164:167], v[40:43], a[92:95]
    v_exp_f32 v19, v119
    v_mfma_f32_16x16x32_bf16 a[92:95], v[180:183], v[44:47], a[92:95]
    v_mfma_f32_16x16x32_bf16 a[140:143], v[168:171], v[40:43], a[140:143]
    ds_read_b128 v[36:39], v3 offset:6144
    v_cvt_pk_bf16_f32 v86, v16, v17
    v_mfma_f32_16x16x32_bf16 a[140:143], v[184:187], v[44:47], a[140:143]
    v_add_f32 v6, v6, v18
    v_add_f32 v6, v6, v19
    v_mfma_f32_16x16x32_bf16 a[188:191], v[172:175], v[40:43], a[188:191]
    v_cvt_pk_bf16_f32 v87, v18, v19
    v_mfma_f32_16x16x32_bf16 a[188:191], v[188:191], v[44:47], a[188:191]
    s_waitcnt lgkmcnt(2)
    v_mfma_f32_16x16x32_bf16 v[160:163], v[24:27], a[192:195], v[128:131]
    s_mov_b32 m0, s26
    ds_read_b128 v[40:43], v2 offset:128
    v_mfma_f32_16x16x32_bf16 v[160:163], v[28:31], a[196:199], v[160:163]
    v_exp_f32 v16, v88
    v_mfma_f32_16x16x32_bf16 v[164:167], v[24:27], a[216:219], v[132:135]
    v_exp_f32 v17, v89
    v_mfma_f32_16x16x32_bf16 v[164:167], v[28:31], a[220:223], v[164:167]
    v_bfe_u32 v53, v4, 4, 6
    v_mfma_f32_16x16x32_bf16 v[168:171], v[24:27], a[240:243], v[136:139]
    ds_read_b128 v[44:47], v3 offset:128
    v_lshlrev_b32 v53, 2, v53
    v_mfma_f32_16x16x32_bf16 v[168:171], v[28:31], a[244:247], v[168:171]
    buffer_load_dwordx4 v4, s[4:7], s32 offen offset:0 sc1 lds
    v_mfma_f32_16x16x32_bf16 v[172:175], v[24:27], v[200:203], v[140:143]
    v_exp_f32 v18, v90
    v_mfma_f32_16x16x32_bf16 v[172:175], v[28:31], v[204:207], v[172:175]
    s_waitcnt lgkmcnt(2)
    v_add_f32 v7, v7, v16
    v_add_f32 v7, v7, v17
    v_mfma_f32_16x16x32_bf16 v[96:99], v[32:35], a[192:195], v[128:131]
    ds_read_b128 v[24:27], v2 offset:6272
    v_mfma_f32_16x16x32_bf16 v[96:99], v[36:39], a[196:199], v[96:99]
    buffer_load_dword v52, v53, s[20:23], 0 offen sc1
    v_mfma_f32_16x16x32_bf16 v[100:103], v[32:35], a[216:219], v[132:135]
    v_exp_f32 v19, v91
    v_mfma_f32_16x16x32_bf16 v[100:103], v[36:39], a[220:223], v[100:103]
    v_cvt_pk_bf16_f32 v88, v16, v17
    v_mfma_f32_16x16x32_bf16 v[104:107], v[32:35], a[240:243], v[136:139]
    ds_read_b128 v[28:31], v3 offset:6272
    v_mfma_f32_16x16x32_bf16 v[104:107], v[36:39], a[244:247], v[104:107]
    v_exp_f32 v16, v120
    v_mfma_f32_16x16x32_bf16 v[108:111], v[32:35], v[200:203], v[140:143]
    v_add_f32 v7, v7, v18
    v_add_f32 v7, v7, v19
    v_mfma_f32_16x16x32_bf16 v[108:111], v[36:39], v[204:207], v[108:111]
    s_waitcnt lgkmcnt(2)
    buffer_load_dwordx4 v4, s[4:7], s32 offen offset:1024 sc1 lds
    v_mfma_f32_16x16x32_bf16 v[160:163], v[40:43], a[200:203], v[160:163]
    ds_read_b128 v[32:35], v2 offset:256
    v_mfma_f32_16x16x32_bf16 v[160:163], v[44:47], a[204:207], v[160:163]
    v_exp_f32 v17, v121
    v_mfma_f32_16x16x32_bf16 v[164:167], v[40:43], a[224:227], v[164:167]
    v_cvt_pk_bf16_f32 v89, v18, v19
    v_mfma_f32_16x16x32_bf16 v[164:167], v[44:47], a[228:231], v[164:167]
    v_exp_f32 v18, v122
    v_mfma_f32_16x16x32_bf16 v[168:171], v[40:43], a[248:251], v[168:171]
    ds_read_b128 v[36:39], v3 offset:256
    v_add_f32 v7, v7, v16
    v_mfma_f32_16x16x32_bf16 v[168:171], v[44:47], a[252:255], v[168:171]
    v_add_f32 v7, v7, v17
    v_mfma_f32_16x16x32_bf16 v[172:175], v[40:43], v[208:211], v[172:175]
    v_exp_f32 v19, v123
    v_mfma_f32_16x16x32_bf16 v[172:175], v[44:47], v[212:215], v[172:175]
    s_waitcnt lgkmcnt(2)
    buffer_load_dwordx4 v4, s[4:7], s32 offen offset:2048 sc1 lds
    v_mfma_f32_16x16x32_bf16 v[96:99], v[24:27], a[200:203], v[96:99]
    ds_read_b128 v[40:43], v2 offset:6400
    v_cvt_pk_bf16_f32 v90, v16, v17
    v_mfma_f32_16x16x32_bf16 v[96:99], v[28:31], a[204:207], v[96:99]
    v_exp_f32 v16, v92
    v_mfma_f32_16x16x32_bf16 v[100:103], v[24:27], a[224:227], v[100:103]
    v_add_f32 v7, v7, v18
    v_add_f32 v7, v7, v19
    v_mfma_f32_16x16x32_bf16 v[100:103], v[28:31], a[228:231], v[100:103]
    v_exp_f32 v17, v93
    v_mfma_f32_16x16x32_bf16 v[104:107], v[24:27], a[248:251], v[104:107]
    ds_read_b128 v[44:47], v3 offset:6400
    v_cvt_pk_bf16_f32 v91, v18, v19
    v_mfma_f32_16x16x32_bf16 v[104:107], v[28:31], a[252:255], v[104:107]
    v_exp_f32 v18, v94
    v_mfma_f32_16x16x32_bf16 v[108:111], v[24:27], v[208:211], v[108:111]
    s_add_u32 s29, s30, 49152
    v_add_f32 v8, v8, v16
    s_add_u32 s32, s32, 24576
    v_mfma_f32_16x16x32_bf16 v[108:111], v[28:31], v[212:215], v[108:111]
    s_waitcnt lgkmcnt(2)
    v_add_f32 v8, v8, v17
    v_mfma_f32_16x16x32_bf16 v[160:163], v[32:35], a[208:211], v[160:163]
    s_sub_u32 s3, s29, 147456
    ds_read_b128 v[24:27], v2 offset:12288
    v_mfma_f32_16x16x32_bf16 v[160:163], v[36:39], a[212:215], v[160:163]
    v_exp_f32 v19, v95
    v_mfma_f32_16x16x32_bf16 v[164:167], v[32:35], a[232:235], v[164:167]
    v_cvt_pk_bf16_f32 v92, v16, v17
    v_mfma_f32_16x16x32_bf16 v[164:167], v[36:39], a[236:239], v[164:167]
    s_add_u32 s26, s26, 12288
    v_exp_f32 v16, v124
    v_mfma_f32_16x16x32_bf16 v[168:171], v[32:35], v[192:195], v[168:171]
    ds_read_b128 v[28:31], v3 offset:12288
    v_add_f32 v8, v8, v18
    v_mfma_f32_16x16x32_bf16 v[168:171], v[36:39], v[196:199], v[168:171]
    v_add_f32 v8, v8, v19
    v_mfma_f32_16x16x32_bf16 v[172:175], v[32:35], v[216:219], v[172:175]
    s_min_u32 s29, s29, s3
    v_mfma_f32_16x16x32_bf16 v[172:175], v[36:39], v[220:223], v[172:175]
    s_waitcnt lgkmcnt(2)
    v_exp_f32 v17, v125
    v_mfma_f32_16x16x32_bf16 v[96:99], v[40:43], a[208:211], v[96:99]
    s_mov_b32 m0, s26
    ds_read_b128 v[32:35], v2 offset:18432
    v_cvt_pk_bf16_f32 v93, v18, v19
    v_mfma_f32_16x16x32_bf16 v[96:99], v[44:47], a[212:215], v[96:99]
    v_exp_f32 v18, v126
    v_mfma_f32_16x16x32_bf16 v[100:103], v[40:43], a[232:235], v[100:103]
    v_mfma_f32_16x16x32_bf16 v[100:103], v[44:47], a[236:239], v[100:103]
    v_add_f32 v8, v8, v16
    v_mfma_f32_16x16x32_bf16 v[104:107], v[40:43], v[192:195], v[104:107]
    s_sub_u32 s3, s29, s30
    ds_read_b128 v[36:39], v3 offset:18432
    v_add_f32 v8, v8, v17
    v_mfma_f32_16x16x32_bf16 v[104:107], v[44:47], v[196:199], v[104:107]
    v_exp_f32 v19, v127
    v_mfma_f32_16x16x32_bf16 v[108:111], v[40:43], v[216:219], v[108:111]
    v_cvt_pk_bf16_f32 v94, v16, v17
    v_mfma_f32_16x16x32_bf16 v[108:111], v[44:47], v[220:223], v[108:111]
    s_waitcnt lgkmcnt(2)
    buffer_load_dwordx4 v4, s[4:7], s32 offen offset:0 sc1 lds
    v_mfma_f32_16x16x32_bf16 v[176:179], v[24:27], a[192:195], v[128:131]
    ds_read_b128 v[40:43], v2 offset:12416
    v_add_f32 v8, v8, v18
    v_mfma_f32_16x16x32_bf16 v[176:179], v[28:31], a[196:199], v[176:179]
    v_add_f32 v8, v8, v19
    v_cvt_pk_bf16_f32 v95, v18, v19
    v_mfma_f32_16x16x32_bf16 v[180:183], v[24:27], a[216:219], v[132:135]
    s_mov_b32 s30, s29
    v_mfma_f32_16x16x32_bf16 v[180:183], v[28:31], a[220:223], v[180:183]
    v_mfma_f32_16x16x32_bf16 v[184:187], v[24:27], a[240:243], v[136:139]
    ds_read_b128 v[44:47], v3 offset:12416
    v_mfma_f32_16x16x32_bf16 v[184:187], v[28:31], a[244:247], v[184:187]
    v_exp_f32 v16, v160
    v_mfma_f32_16x16x32_bf16 v[188:191], v[24:27], v[200:203], v[140:143]
    v_exp_f32 v17, v161
    v_mfma_f32_16x16x32_bf16 v[188:191], v[28:31], v[204:207], v[188:191]
    s_waitcnt lgkmcnt(2)
    v_exp_f32 v18, v162
    v_mfma_f32_16x16x32_bf16 v[112:115], v[32:35], a[192:195], v[128:131]
    ds_read_b128 v[24:27], v2 offset:18560
    v_add_f32 v5, v5, v16
    v_mfma_f32_16x16x32_bf16 v[112:115], v[36:39], a[196:199], v[112:115]
    buffer_load_dwordx4 v4, s[4:7], s32 offen offset:1024 sc1 lds
    v_mfma_f32_16x16x32_bf16 v[116:119], v[32:35], a[216:219], v[132:135]
    v_add_f32 v5, v5, v17
    v_add_u32 v1, s3, v1
    v_mfma_f32_16x16x32_bf16 v[116:119], v[36:39], a[220:223], v[116:119]
    v_exp_f32 v19, v163
    v_mfma_f32_16x16x32_bf16 v[120:123], v[32:35], a[240:243], v[136:139]
    ds_read_b128 v[28:31], v3 offset:18560
    v_cvt_pk_bf16_f32 v160, v16, v17
    v_mfma_f32_16x16x32_bf16 v[120:123], v[36:39], a[244:247], v[120:123]
    v_exp_f32 v16, v96
    v_mfma_f32_16x16x32_bf16 v[124:127], v[32:35], v[200:203], v[140:143]
    v_add_f32 v5, v5, v18
    v_add_f32 v5, v5, v19
    v_mfma_f32_16x16x32_bf16 v[124:127], v[36:39], v[204:207], v[124:127]
    s_waitcnt lgkmcnt(2)
    v_exp_f32 v17, v97
    v_mfma_f32_16x16x32_bf16 v[176:179], v[40:43], a[200:203], v[176:179]
    ds_read_b128 v[32:35], v2 offset:12544
    v_add_u32 v21, s3, v21
    v_mfma_f32_16x16x32_bf16 v[176:179], v[44:47], a[204:207], v[176:179]
    buffer_load_dwordx4 v4, s[4:7], s32 offen offset:2048 sc1 lds
    v_mfma_f32_16x16x32_bf16 v[180:183], v[40:43], a[224:227], v[180:183]
    v_cvt_pk_bf16_f32 v161, v18, v19
    v_mfma_f32_16x16x32_bf16 v[180:183], v[44:47], a[228:231], v[180:183]
    v_exp_f32 v18, v98
    v_mfma_f32_16x16x32_bf16 v[184:187], v[40:43], a[248:251], v[184:187]
    ds_read_b128 v[36:39], v3 offset:12544
    v_add_f32 v5, v5, v16
    v_mfma_f32_16x16x32_bf16 v[184:187], v[44:47], a[252:255], v[184:187]
    v_add_f32 v5, v5, v17
    v_add_u32 v22, s3, v22
    v_mfma_f32_16x16x32_bf16 v[188:191], v[40:43], v[208:211], v[188:191]
    v_exp_f32 v19, v99
    v_mfma_f32_16x16x32_bf16 v[188:191], v[44:47], v[212:215], v[188:191]
    s_waitcnt lgkmcnt(2)
    v_cvt_pk_bf16_f32 v162, v16, v17
    v_mfma_f32_16x16x32_bf16 v[112:115], v[24:27], a[200:203], v[112:115]
    ds_read_b128 v[40:43], v2 offset:18688
    v_mfma_f32_16x16x32_bf16 v[112:115], v[28:31], a[204:207], v[112:115]
    v_exp_f32 v16, v164
    v_mfma_f32_16x16x32_bf16 v[116:119], v[24:27], a[224:227], v[116:119]
    v_add_f32 v5, v5, v18
    v_add_f32 v5, v5, v19
    v_mfma_f32_16x16x32_bf16 v[116:119], v[28:31], a[228:231], v[116:119]
    s_add_u32 s32, s32, 24576
    v_exp_f32 v17, v165
    v_mfma_f32_16x16x32_bf16 v[120:123], v[24:27], a[248:251], v[120:123]
    s_add_u32 s26, s26, 36864
    ds_read_b128 v[44:47], v3 offset:18688
    v_cvt_pk_bf16_f32 v163, v18, v19
    v_mfma_f32_16x16x32_bf16 v[120:123], v[28:31], a[252:255], v[120:123]
    s_waitcnt lgkmcnt(2)
    v_exp_f32 v18, v166
    v_mfma_f32_16x16x32_bf16 v[124:127], v[24:27], v[208:211], v[124:127]
    s_waitcnt vmcnt(24)
    v_add_f32 v6, v6, v16
    v_mfma_f32_16x16x32_bf16 v[124:127], v[28:31], v[212:215], v[124:127]
    s_barrier
    v_add_f32 v6, v6, v17
    v_mfma_f32_16x16x32_bf16 v[176:179], v[32:35], a[208:211], v[176:179]
    s_sub_u32 s57, s26, 147456
    ds_read_b128 v[24:27], v1 offset:0
    v_mfma_f32_16x16x32_bf16 v[176:179], v[36:39], a[212:215], v[176:179]
    buffer_load_dword v15, v4, s[88:91], s93 offen
    v_mfma_f32_16x16x32_bf16 v[180:183], v[32:35], a[232:235], v[180:183]
    s_min_u32 s26, s26, s57
    v_exp_f32 v19, v167
    v_mfma_f32_16x16x32_bf16 v[180:183], v[36:39], a[236:239], v[180:183]
    v_cvt_pk_bf16_f32 v164, v16, v17
    v_mfma_f32_16x16x32_bf16 v[184:187], v[32:35], v[192:195], v[184:187]
    ds_read_b128 v[28:31], v1 offset:12288
    v_mfma_f32_16x16x32_bf16 v[184:187], v[36:39], v[196:199], v[184:187]
    v_exp_f32 v16, v100
    v_mfma_f32_16x16x32_bf16 v[188:191], v[32:35], v[216:219], v[188:191]
    v_add_f32 v6, v6, v18
    v_add_f32 v6, v6, v19
    v_mfma_f32_16x16x32_bf16 v[188:191], v[36:39], v[220:223], v[188:191]
    s_waitcnt lgkmcnt(2)
    v_exp_f32 v17, v101
    v_mfma_f32_16x16x32_bf16 v[112:115], v[40:43], a[208:211], v[112:115]
    ds_read_b128 v[32:35], v1 offset:768
    v_cvt_pk_bf16_f32 v165, v18, v19
    v_mfma_f32_16x16x32_bf16 v[112:115], v[44:47], a[212:215], v[112:115]
    v_exp_f32 v18, v102
    v_mfma_f32_16x16x32_bf16 v[116:119], v[40:43], a[232:235], v[116:119]
    v_add_f32 v6, v6, v16
    v_add_f32 v6, v6, v17
    v_mfma_f32_16x16x32_bf16 v[116:119], v[44:47], a[236:239], v[116:119]
    v_exp_f32 v19, v103
    v_mfma_f32_16x16x32_bf16 v[120:123], v[40:43], v[192:195], v[120:123]
    ds_read_b128 v[36:39], v1 offset:13056
    v_cvt_pk_bf16_f32 v166, v16, v17
    v_mfma_f32_16x16x32_bf16 v[120:123], v[44:47], v[196:199], v[120:123]
    v_add_f32 v6, v6, v18
    v_mfma_f32_16x16x32_bf16 v[124:127], v[40:43], v[216:219], v[124:127]
    v_add_f32 v6, v6, v19
    v_cvt_pk_bf16_f32 v167, v18, v19
    v_mfma_f32_16x16x32_bf16 v[124:127], v[44:47], v[220:223], v[124:127]
    s_waitcnt lgkmcnt(2)
    v_mfma_f32_16x16x32_bf16 a[0:3], v[64:67], v[24:27], a[0:3]
    ds_read_b128 v[40:43], v1 offset:1536
    v_mfma_f32_16x16x32_bf16 a[0:3], v[80:83], v[28:31], a[0:3]
    s_waitcnt vmcnt(6)
    v_subrev_u32 v52, s92, v52
    v_cmp_lt_u32 vcc, 15, v52
    v_mfma_f32_16x16x32_bf16 a[48:51], v[68:71], v[24:27], a[48:51]
    v_exp_f32 v16, v168
    v_mfma_f32_16x16x32_bf16 a[48:51], v[84:87], v[28:31], a[48:51]
    v_exp_f32 v17, v169
    v_mfma_f32_16x16x32_bf16 a[96:99], v[72:75], v[24:27], a[96:99]
    s_and_b32 s59, vcc_lo, 0xff
    ds_read_b128 v[44:47], v1 offset:13824
    v_mfma_f32_16x16x32_bf16 a[96:99], v[88:91], v[28:31], a[96:99]
    s_cbranch_scc1 L_pollslow6
L_pollok6:
    v_mfma_f32_16x16x32_bf16 a[144:147], v[76:79], v[24:27], a[144:147]
    v_exp_f32 v18, v170
    v_mfma_f32_16x16x32_bf16 a[144:147], v[92:95], v[28:31], a[144:147]
    s_waitcnt lgkmcnt(2)
    v_add_f32 v7, v7, v16
    v_add_f32 v7, v7, v17
    v_mfma_f32_16x16x32_bf16 a[4:7], v[64:67], v[32:35], a[4:7]
    s_mov_b32 m0, s56
    ds_read_b128 v[24:27], v1 offset:2304
    v_mfma_f32_16x16x32_bf16 a[4:7], v[80:83], v[36:39], a[4:7]
    v_exp_f32 v19, v171
    v_mfma_f32_16x16x32_bf16 a[52:55], v[68:71], v[32:35], a[52:55]
    v_cvt_pk_bf16_f32 v168, v16, v17
    v_mfma_f32_16x16x32_bf16 a[52:55], v[84:87], v[36:39], a[52:55]
    v_exp_f32 v16, v104
    v_mfma_f32_16x16x32_bf16 a[100:103], v[72:75], v[32:35], a[100:103]
    ds_read_b128 v[28:31], v1 offset:14592
    v_add_f32 v7, v7, v18
    v_mfma_f32_16x16x32_bf16 a[100:103], v[88:91], v[36:39], a[100:103]
    buffer_load_dwordx4 v4, s[4:7], s27 offen offset:0 sc1 lds
    v_mfma_f32_16x16x32_bf16 a[148:151], v[76:79], v[32:35], a[148:151]
    v_add_f32 v7, v7, v19
    v_mfma_f32_16x16x32_bf16 a[148:151], v[92:95], v[36:39], a[148:151]
    s_waitcnt lgkmcnt(2)
    v_exp_f32 v17, v105
    v_mfma_f32_16x16x32_bf16 a[8:11], v[64:67], v[40:43], a[8:11]
    ds_read_b128 v[32:35], v21 offset:0
    v_cvt_pk_bf16_f32 v169, v18, v19
    v_mfma_f32_16x16x32_bf16 a[8:11], v[80:83], v[44:47], a[8:11]
    v_exp_f32 v18, v106
    v_mfma_f32_16x16x32_bf16 a[56:59], v[68:71], v[40:43], a[56:59]
    v_add_f32 v7, v7, v16
    v_add_f32 v7, v7, v17
    v_mfma_f32_16x16x32_bf16 a[56:59], v[84:87], v[44:47], a[56:59]
    v_exp_f32 v19, v107
    v_mfma_f32_16x16x32_bf16 a[104:107], v[72:75], v[40:43], a[104:107]
    ds_read_b128 v[36:39], v21 offset:12288
    v_cvt_pk_bf16_f32 v170, v16, v17
    v_mfma_f32_16x16x32_bf16 a[104:107], v[88:91], v[44:47], a[104:107]
    buffer_load_dwordx4 v4, s[4:7], s27 offen offset:1024 sc1 lds
    v_mfma_f32_16x16x32_bf16 a[152:155], v[76:79], v[40:43], a[152:155]
    v_exp_f32 v16, v172
    v_mfma_f32_16x16x32_bf16 a[152:155], v[92:95], v[44:47], a[152:155]
    s_waitcnt lgkmcnt(2)
    v_add_f32 v7, v7, v18
    v_add_f32 v7, v7, v19
    v_mfma_f32_16x16x32_bf16 a[12:15], v[64:67], v[24:27], a[12:15]
    ds_read_b128 v[40:43], v21 offset:768
    v_mfma_f32_16x16x32_bf16 a[12:15], v[80:83], v[28:31], a[12:15]
    v_exp_f32 v17, v173
    v_mfma_f32_16x16x32_bf16 a[60:63], v[68:71], v[24:27], a[60:63]
    v_cvt_pk_bf16_f32 v171, v18, v19
    v_mfma_f32_16x16x32_bf16 a[60:63], v[84:87], v[28:31], a[60:63]
    v_exp_f32 v18, v174
    v_mfma_f32_16x16x32_bf16 a[108:111], v[72:75], v[24:27], a[108:111]
    ds_read_b128 v[44:47], v21 offset:13056
    v_add_f32 v8, v8, v16
    v_mfma_f32_16x16x32_bf16 a[108:111], v[88:91], v[28:31], a[108:111]
    buffer_load_dwordx4 v4, s[4:7], s27 offen offset:2048 sc1 lds
    v_mfma_f32_16x16x32_bf16 a[156:159], v[76:79], v[24:27], a[156:159]
    s_add_u32 s29, s28, 49152
    v_add_f32 v8, v8, v17
    v_mfma_f32_16x16x32_bf16 a[156:159], v[92:95], v[28:31], a[156:159]
    s_waitcnt lgkmcnt(2)
    v_exp_f32 v19, v175
    v_mfma_f32_16x16x32_bf16 a[16:19], v[64:67], v[32:35], a[16:19]
    ds_read_b128 v[24:27], v21 offset:1536
    v_cvt_pk_bf16_f32 v172, v16, v17
    v_mfma_f32_16x16x32_bf16 a[16:19], v[80:83], v[36:39], a[16:19]
    s_sub_u32 s3, s29, 147456
    v_exp_f32 v16, v108
    v_mfma_f32_16x16x32_bf16 a[64:67], v[68:71], v[32:35], a[64:67]
    v_add_f32 v8, v8, v18
    v_mfma_f32_16x16x32_bf16 a[64:67], v[84:87], v[36:39], a[64:67]
    s_add_u32 s27, s27, 24576
    v_add_f32 v8, v8, v19
    v_mfma_f32_16x16x32_bf16 a[112:115], v[72:75], v[32:35], a[112:115]
    ds_read_b128 v[28:31], v21 offset:13824
    v_mfma_f32_16x16x32_bf16 a[112:115], v[88:91], v[36:39], a[112:115]
    v_exp_f32 v17, v109
    v_mfma_f32_16x16x32_bf16 a[160:163], v[76:79], v[32:35], a[160:163]
    v_cvt_pk_bf16_f32 v173, v18, v19
    v_mfma_f32_16x16x32_bf16 a[160:163], v[92:95], v[36:39], a[160:163]
    s_waitcnt lgkmcnt(2)
    v_exp_f32 v18, v110
    v_mfma_f32_16x16x32_bf16 a[20:23], v[64:67], v[40:43], a[20:23]
    s_add_u32 s56, s56, 12288
    ds_read_b128 v[32:35], v21 offset:2304
    v_add_f32 v8, v8, v16
    v_mfma_f32_16x16x32_bf16 a[20:23], v[80:83], v[44:47], a[20:23]
    s_min_u32 s29, s29, s3
    v_add_f32 v8, v8, v17
    v_mfma_f32_16x16x32_bf16 a[68:71], v[68:71], v[40:43], a[68:71]
    v_exp_f32 v19, v111
    v_mfma_f32_16x16x32_bf16 a[68:71], v[84:87], v[44:47], a[68:71]
    s_mov_b32 m0, s56
    v_mfma_f32_16x16x32_bf16 a[116:119], v[72:75], v[40:43], a[116:119]
    ds_read_b128 v[36:39], v21 offset:14592
    v_cvt_pk_bf16_f32 v174, v16, v17
    v_mfma_f32_16x16x32_bf16 a[116:119], v[88:91], v[44:47], a[116:119]
    v_add_f32 v8, v8, v18
    v_add_f32 v8, v8, v19
    v_mfma_f32_16x16x32_bf16 a[164:167], v[76:79], v[40:43], a[164:167]
    s_sub_u32 s3, s29, s28
    v_cvt_pk_bf16_f32 v175, v18, v19
    v_mfma_f32_16x16x32_bf16 a[164:167], v[92:95], v[44:47], a[164:167]
    s_waitcnt lgkmcnt(2)
    v_exp_f32 v16, v176
    v_mfma_f32_16x16x32_bf16 a[24:27], v[64:67], v[24:27], a[24:27]
    ds_read_b128 v[40:43], v22 offset:0
    v_mfma_f32_16x16x32_bf16 a[24:27], v[80:83], v[28:31], a[24:27]
    buffer_load_dwordx4 v4, s[4:7], s27 offen offset:0 sc1 lds
    v_mfma_f32_16x16x32_bf16 a[72:75], v[68:71], v[24:27], a[72:75]
    v_exp_f32 v17, v177
    v_mfma_f32_16x16x32_bf16 a[72:75], v[84:87], v[28:31], a[72:75]
    v_exp_f32 v18, v178
    v_mfma_f32_16x16x32_bf16 a[120:123], v[72:75], v[24:27], a[120:123]
    ds_read_b128 v[44:47], v22 offset:12288
    v_add_f32 v5, v5, v16
    v_mfma_f32_16x16x32_bf16 a[120:123], v[88:91], v[28:31], a[120:123]
    s_mov_b32 s28, s29
    v_add_f32 v5, v5, v17
    v_mfma_f32_16x16x32_bf16 a[168:171], v[76:79], v[24:27], a[168:171]
    v_exp_f32 v19, v179
    v_mfma_f32_16x16x32_bf16 a[168:171], v[92:95], v[28:31], a[168:171]
    s_waitcnt lgkmcnt(2)
    v_mfma_f32_16x16x32_bf16 a[28:31], v[64:67], v[32:35], a[28:31]
    ds_read_b128 v[24:27], v22 offset:768
    v_cvt_pk_bf16_f32 v176, v16, v17
    v_mfma_f32_16x16x32_bf16 a[28:31], v[80:83], v[36:39], a[28:31]
    v_exp_f32 v16, v112
    v_mfma_f32_16x16x32_bf16 a[76:79], v[68:71], v[32:35], a[76:79]
    v_add_f32 v5, v5, v18
    v_mfma_f32_16x16x32_bf16 a[76:79], v[84:87], v[36:39], a[76:79]
    buffer_load_dwordx4 v4, s[4:7], s27 offen offset:1024 sc1 lds
    v_mfma_f32_16x16x32_bf16 a[124:127], v[72:75], v[32:35], a[124:127]
    ds_read_b128 v[28:31], v22 offset:13056
    v_add_f32 v5, v5, v19
    v_mfma_f32_16x16x32_bf16 a[124:127], v[88:91], v[36:39], a[124:127]
    v_exp_f32 v17, v113
    v_mfma_f32_16x16x32_bf16 a[172:175], v[76:79], v[32:35], a[172:175]
    v_cvt_pk_bf16_f32 v177, v18, v19
    v_add_u32 v2, s3, v2
    v_mfma_f32_16x16x32_bf16 a[172:175], v[92:95], v[36:39], a[172:175]
    s_waitcnt lgkmcnt(2)
    v_exp_f32 v18, v114
    v_mfma_f32_16x16x32_bf16 a[32:35], v[64:67], v[40:43], a[32:35]
    ds_read_b128 v[32:35], v22 offset:1536
    v_add_f32 v5, v5, v16
    v_mfma_f32_16x16x32_bf16 a[32:35], v[80:83], v[44:47], a[32:35]
    v_add_f32 v5, v5, v17
    v_mfma_f32_16x16x32_bf16 a[80:83], v[68:71], v[40:43], a[80:83]
    v_exp_f32 v19, v115
    v_mfma_f32_16x16x32_bf16 a[80:83], v[84:87], v[44:47], a[80:83]
    buffer_load_dwordx4 v4, s[4:7], s27 offen offset:2048 sc1 lds
    v_mfma_f32_16x16x32_bf16 a[128:131], v[72:75], v[40:43], a[128:131]
    ds_read_b128 v[36:39], v22 offset:13824
    v_cvt_pk_bf16_f32 v178, v16, v17
    v_mfma_f32_16x16x32_bf16 a[128:131], v[88:91], v[44:47], a[128:131]
    v_exp_f32 v16, v180
    v_mfma_f32_16x16x32_bf16 a[176:179], v[76:79], v[40:43], a[176:179]
    v_add_u32 v3, s3, v3
    v_add_f32 v5, v5, v18
    v_mfma_f32_16x16x32_bf16 a[176:179], v[92:95], v[44:47], a[176:179]
    s_waitcnt lgkmcnt(2)
    v_add_f32 v5, v5, v19
    v_mfma_f32_16x16x32_bf16 a[36:39], v[64:67], v[24:27], a[36:39]
    ds_read_b128 v[40:43], v22 offset:2304
    v_mfma_f32_16x16x32_bf16 a[36:39], v[80:83], v[28:31], a[36:39]
    v_exp_f32 v17, v181
    v_mfma_f32_16x16x32_bf16 a[84:87], v[68:71], v[24:27], a[84:87]
    v_cvt_pk_bf16_f32 v179, v18, v19
    v_mfma_f32_16x16x32_bf16 a[84:87], v[84:87], v[28:31], a[84:87]
    s_add_u32 s27, s27, 24576
    v_exp_f32 v18, v182
    v_mfma_f32_16x16x32_bf16 a[132:135], v[72:75], v[24:27], a[132:135]
    s_add_u32 s56, s56, 36864
    ds_read_b128 v[44:47], v22 offset:14592
    v_add_f32 v6, v6, v16
    v_mfma_f32_16x16x32_bf16 a[132:135], v[88:91], v[28:31], a[132:135]
    s_waitcnt lgkmcnt(2)
    v_add_f32 v6, v6, v17
    v_mfma_f32_16x16x32_bf16 a[180:183], v[76:79], v[24:27], a[180:183]
    s_waitcnt vmcnt(21)
    v_exp_f32 v19, v183
    v_mfma_f32_16x16x32_bf16 a[180:183], v[92:95], v[28:31], a[180:183]
    s_barrier
    s_sub_u32 s58, s56, 147456
    v_mfma_f32_16x16x32_bf16 a[40:43], v[64:67], v[32:35], a[40:43]
    ds_read_b128 v[24:27], v2 offset:0
    v_cvt_pk_bf16_f32 v180, v16, v17
    v_mfma_f32_16x16x32_bf16 a[40:43], v[80:83], v[36:39], a[40:43]
    v_exp_f32 v16, v116
    v_mfma_f32_16x16x32_bf16 a[88:91], v[68:71], v[32:35], a[88:91]
    s_min_u32 s56, s56, s58
    v_add_f32 v6, v6, v18
    v_mfma_f32_16x16x32_bf16 a[88:91], v[84:87], v[36:39], a[88:91]
    v_add_f32 v6, v6, v19
    v_mfma_f32_16x16x32_bf16 a[136:139], v[72:75], v[32:35], a[136:139]
    ds_read_b128 v[28:31], v3 offset:0
    v_mfma_f32_16x16x32_bf16 a[136:139], v[88:91], v[36:39], a[136:139]
    v_exp_f32 v17, v117
    v_mfma_f32_16x16x32_bf16 a[184:187], v[76:79], v[32:35], a[184:187]
    v_cvt_pk_bf16_f32 v181, v18, v19
    v_mfma_f32_16x16x32_bf16 a[184:187], v[92:95], v[36:39], a[184:187]
    s_waitcnt lgkmcnt(2)
    v_exp_f32 v18, v118
    v_mfma_f32_16x16x32_bf16 a[44:47], v[64:67], v[40:43], a[44:47]
    ds_read_b128 v[32:35], v2 offset:6144
    v_add_f32 v6, v6, v16
    v_mfma_f32_16x16x32_bf16 a[44:47], v[80:83], v[44:47], a[44:47]
    v_add_f32 v6, v6, v17
    v_mfma_f32_16x16x32_bf16 a[92:95], v[68:71], v[40:43], a[92:95]
    v_exp_f32 v19, v119
    v_mfma_f32_16x16x32_bf16 a[92:95], v[84:87], v[44:47], a[92:95]
    v_mfma_f32_16x16x32_bf16 a[140:143], v[72:75], v[40:43], a[140:143]
    ds_read_b128 v[36:39], v3 offset:6144
    v_cvt_pk_bf16_f32 v182, v16, v17
    v_mfma_f32_16x16x32_bf16 a[140:143], v[88:91], v[44:47], a[140:143]
    v_add_f32 v6, v6, v18
    v_add_f32 v6, v6, v19
    v_mfma_f32_16x16x32_bf16 a[188:191], v[76:79], v[40:43], a[188:191]
    v_cvt_pk_bf16_f32 v183, v18, v19
    v_mfma_f32_16x16x32_bf16 a[188:191], v[92:95], v[44:47], a[188:191]
    s_waitcnt lgkmcnt(2)
    v_mfma_f32_16x16x32_bf16 v[64:67], v[24:27], a[192:195], v[128:131]
    s_mov_b32 m0, s26
    ds_read_b128 v[40:43], v2 offset:128
    v_mfma_f32_16x16x32_bf16 v[64:67], v[28:31], a[196:199], v[64:67]
    v_exp_f32 v16, v184
    v_mfma_f32_16x16x32_bf16 v[68:71], v[24:27], a[216:219], v[132:135]
    v_exp_f32 v17, v185
    v_mfma_f32_16x16x32_bf16 v[68:71], v[28:31], a[220:223], v[68:71]
    v_exp_f32 v18, v186
    v_mfma_f32_16x16x32_bf16 v[72:75], v[24:27], a[240:243], v[136:139]
    ds_read_b128 v[44:47], v3 offset:128
    v_mfma_f32_16x16x32_bf16 v[72:75], v[28:31], a[244:247], v[72:75]
    buffer_load_dwordx4 v4, s[4:7], s32 offen offset:0 sc1 lds
    v_mfma_f32_16x16x32_bf16 v[76:79], v[24:27], v[200:203], v[140:143]
    v_add_f32 v7, v7, v16
    v_add_f32 v7, v7, v17
    v_mfma_f32_16x16x32_bf16 v[76:79], v[28:31], v[204:207], v[76:79]
    s_waitcnt lgkmcnt(2)
    v_exp_f32 v19, v187
    v_mfma_f32_16x16x32_bf16 v[96:99], v[32:35], a[192:195], v[128:131]
    ds_read_b128 v[24:27], v2 offset:6272
    v_cvt_pk_bf16_f32 v184, v16, v17
    v_mfma_f32_16x16x32_bf16 v[96:99], v[36:39], a[196:199], v[96:99]
    v_mfma_f32_16x16x32_bf16 v[100:103], v[32:35], a[216:219], v[132:135]
    v_exp_f32 v16, v120
    v_mfma_f32_16x16x32_bf16 v[100:103], v[36:39], a[220:223], v[100:103]
    v_add_f32 v7, v7, v18
    v_mfma_f32_16x16x32_bf16 v[104:107], v[32:35], a[240:243], v[136:139]
    ds_read_b128 v[28:31], v3 offset:6272
    v_add_f32 v7, v7, v19
    v_mfma_f32_16x16x32_bf16 v[104:107], v[36:39], a[244:247], v[104:107]
    v_exp_f32 v17, v121
    v_mfma_f32_16x16x32_bf16 v[108:111], v[32:35], v[200:203], v[140:143]
    v_mfma_f32_16x16x32_bf16 v[108:111], v[36:39], v[204:207], v[108:111]
    s_waitcnt lgkmcnt(2)
    buffer_load_dwordx4 v4, s[4:7], s32 offen offset:1024 sc1 lds
    v_mfma_f32_16x16x32_bf16 v[64:67], v[40:43], a[200:203], v[64:67]
    ds_read_b128 v[32:35], v2 offset:256
    v_cvt_pk_bf16_f32 v185, v18, v19
    v_mfma_f32_16x16x32_bf16 v[64:67], v[44:47], a[204:207], v[64:67]
    v_exp_f32 v18, v122
    v_mfma_f32_16x16x32_bf16 v[68:71], v[40:43], a[224:227], v[68:71]
    v_add_f32 v7, v7, v16
    v_add_f32 v7, v7, v17
    v_mfma_f32_16x16x32_bf16 v[68:71], v[44:47], a[228:231], v[68:71]
    v_mfma_f32_16x16x32_bf16 v[72:75], v[40:43], a[248:251], v[72:75]
    ds_read_b128 v[36:39], v3 offset:256
    v_mfma_f32_16x16x32_bf16 v[72:75], v[44:47], a[252:255], v[72:75]
    v_exp_f32 v19, v123
    v_mfma_f32_16x16x32_bf16 v[76:79], v[40:43], v[208:211], v[76:79]
    v_cvt_pk_bf16_f32 v186, v16, v17
    v_mfma_f32_16x16x32_bf16 v[76:79], v[44:47], v[212:215], v[76:79]
    s_waitcnt lgkmcnt(2)
    buffer_load_dwordx4 v4, s[4:7], s32 offen offset:2048 sc1 lds
    v_mfma_f32_16x16x32_bf16 v[96:99], v[24:27], a[200:203], v[96:99]
    ds_read_b128 v[40:43], v2 offset:6400
    v_mfma_f32_16x16x32_bf16 v[96:99], v[28:31], a[204:207], v[96:99]
    v_exp_f32 v16, v188
    v_mfma_f32_16x16x32_bf16 v[100:103], v[24:27], a[224:227], v[100:103]
    v_add_f32 v7, v7, v18
    v_add_f32 v7, v7, v19
    v_mfma_f32_16x16x32_bf16 v[100:103], v[28:31], a[228:231], v[100:103]
    v_exp_f32 v17, v189
    v_mfma_f32_16x16x32_bf16 v[104:107], v[24:27], a[248:251], v[104:107]
    ds_read_b128 v[44:47], v3 offset:6400
    v_cvt_pk_bf16_f32 v187, v18, v19
    v_mfma_f32_16x16x32_bf16 v[104:107], v[28:31], a[252:255], v[104:107]
    v_exp_f32 v18, v190
    v_mfma_f32_16x16x32_bf16 v[108:111], v[24:27], v[208:211], v[108:111]
    s_add_u32 s29, s30, 49152
    v_add_f32 v8, v8, v16
    s_add_u32 s32, s32, 24576
    v_mfma_f32_16x16x32_bf16 v[108:111], v[28:31], v[212:215], v[108:111]
    s_waitcnt lgkmcnt(2)
    v_add_f32 v8, v8, v17
    v_mfma_f32_16x16x32_bf16 v[64:67], v[32:35], a[208:211], v[64:67]
    s_sub_u32 s3, s29, 147456
    ds_read_b128 v[24:27], v2 offset:12288
    v_mfma_f32_16x16x32_bf16 v[64:67], v[36:39], a[212:215], v[64:67]
    v_exp_f32 v19, v191
    v_mfma_f32_16x16x32_bf16 v[68:71], v[32:35], a[232:235], v[68:71]
    v_cvt_pk_bf16_f32 v188, v16, v17
    v_mfma_f32_16x16x32_bf16 v[68:71], v[36:39], a[236:239], v[68:71]
    s_add_u32 s26, s26, 12288
    v_exp_f32 v16, v124
    v_mfma_f32_16x16x32_bf16 v[72:75], v[32:35], v[192:195], v[72:75]
    ds_read_b128 v[28:31], v3 offset:12288
    v_add_f32 v8, v8, v18
    v_mfma_f32_16x16x32_bf16 v[72:75], v[36:39], v[196:199], v[72:75]
    v_add_f32 v8, v8, v19
    v_mfma_f32_16x16x32_bf16 v[76:79], v[32:35], v[216:219], v[76:79]
    s_min_u32 s29, s29, s3
    v_mfma_f32_16x16x32_bf16 v[76:79], v[36:39], v[220:223], v[76:79]
    s_waitcnt lgkmcnt(2)
    v_exp_f32 v17, v125
    v_mfma_f32_16x16x32_bf16 v[96:99], v[40:43], a[208:211], v[96:99]
    s_mov_b32 m0, s26
    ds_read_b128 v[32:35], v2 offset:18432
    v_cvt_pk_bf16_f32 v189, v18, v19
    v_mfma_f32_16x16x32_bf16 v[96:99], v[44:47], a[212:215], v[96:99]
    v_exp_f32 v18, v126
    v_mfma_f32_16x16x32_bf16 v[100:103], v[40:43], a[232:235], v[100:103]
    v_mfma_f32_16x16x32_bf16 v[100:103], v[44:47], a[236:239], v[100:103]
    v_add_f32 v8, v8, v16
    v_mfma_f32_16x16x32_bf16 v[104:107], v[40:43], v[192:195], v[104:107]
    s_sub_u32 s3, s29, s30
    ds_read_b128 v[36:39], v3 offset:18432
    v_add_f32 v8, v8, v17
    v_mfma_f32_16x16x32_bf16 v[104:107], v[44:47], v[196:199], v[104:107]
    v_exp_f32 v19, v127
    v_mfma_f32_16x16x32_bf16 v[108:111], v[40:43], v[216:219], v[108:111]
    v_cvt_pk_bf16_f32 v190, v16, v17
    v_mfma_f32_16x16x32_bf16 v[108:111], v[44:47], v[220:223], v[108:111]
    s_waitcnt lgkmcnt(2)
    buffer_load_dwordx4 v4, s[4:7], s32 offen offset:0 sc1 lds
    v_mfma_f32_16x16x32_bf16 v[80:83], v[24:27], a[192:195], v[128:131]
    ds_read_b128 v[40:43], v2 offset:12416
    v_add_f32 v8, v8, v18
    v_mfma_f32_16x16x32_bf16 v[80:83], v[28:31], a[196:199], v[80:83]
    v_add_f32 v8, v8, v19
    v_cvt_pk_bf16_f32 v191, v18, v19
    v_mfma_f32_16x16x32_bf16 v[84:87], v[24:27], a[216:219], v[132:135]
    s_mov_b32 s30, s29
    v_mfma_f32_16x16x32_bf16 v[84:87], v[28:31], a[220:223], v[84:87]
    v_mfma_f32_16x16x32_bf16 v[88:91], v[24:27], a[240:243], v[136:139]
    ds_read_b128 v[44:47], v3 offset:12416
    v_mfma_f32_16x16x32_bf16 v[88:91], v[28:31], a[244:247], v[88:91]
    v_exp_f32 v16, v64
    v_mfma_f32_16x16x32_bf16 v[92:95], v[24:27], v[200:203], v[140:143]
    v_exp_f32 v17, v65
    v_mfma_f32_16x16x32_bf16 v[92:95], v[28:31], v[204:207], v[92:95]
    s_waitcnt lgkmcnt(2)
    v_exp_f32 v18, v66
    v_mfma_f32_16x16x32_bf16 v[112:115], v[32:35], a[192:195], v[128:131]
    ds_read_b128 v[24:27], v2 offset:18560
    v_add_f32 v5, v5, v16
    v_mfma_f32_16x16x32_bf16 v[112:115], v[36:39], a[196:199], v[112:115]
    buffer_load_dwordx4 v4, s[4:7], s32 offen offset:1024 sc1 lds
    v_mfma_f32_16x16x32_bf16 v[116:119], v[32:35], a[216:219], v[132:135]
    v_add_f32 v5, v5, v17
    v_add_u32 v1, s3, v1
    v_mfma_f32_16x16x32_bf16 v[116:119], v[36:39], a[220:223], v[116:119]
    v_exp_f32 v19, v67
    v_mfma_f32_16x16x32_bf16 v[120:123], v[32:35], a[240:243], v[136:139]
    ds_read_b128 v[28:31], v3 offset:18560
    v_cvt_pk_bf16_f32 v64, v16, v17
    v_mfma_f32_16x16x32_bf16 v[120:123], v[36:39], a[244:247], v[120:123]
    v_exp_f32 v16, v96
    v_mfma_f32_16x16x32_bf16 v[124:127], v[32:35], v[200:203], v[140:143]
    v_add_f32 v5, v5, v18
    v_add_f32 v5, v5, v19
    v_mfma_f32_16x16x32_bf16 v[124:127], v[36:39], v[204:207], v[124:127]
    s_waitcnt lgkmcnt(2)
    v_exp_f32 v17, v97
    v_mfma_f32_16x16x32_bf16 v[80:83], v[40:43], a[200:203], v[80:83]
    ds_read_b128 v[32:35], v2 offset:12544
    v_add_u32 v21, s3, v21
    v_mfma_f32_16x16x32_bf16 v[80:83], v[44:47], a[204:207], v[80:83]
    buffer_load_dwordx4 v4, s[4:7], s32 offen offset:2048 sc1 lds
    v_mfma_f32_16x16x32_bf16 v[84:87], v[40:43], a[224:227], v[84:87]
    v_cvt_pk_bf16_f32 v65, v18, v19
    v_mfma_f32_16x16x32_bf16 v[84:87], v[44:47], a[228:231], v[84:87]
    v_exp_f32 v18, v98
    v_mfma_f32_16x16x32_bf16 v[88:91], v[40:43], a[248:251], v[88:91]
    ds_read_b128 v[36:39], v3 offset:12544
    v_add_f32 v5, v5, v16
    v_mfma_f32_16x16x32_bf16 v[88:91], v[44:47], a[252:255], v[88:91]
    v_add_f32 v5, v5, v17
    v_add_u32 v22, s3, v22
    v_mfma_f32_16x16x32_bf16 v[92:95], v[40:43], v[208:211], v[92:95]
    v_exp_f32 v19, v99
    v_mfma_f32_16x16x32_bf16 v[92:95], v[44:47], v[212:215], v[92:95]
    s_waitcnt lgkmcnt(2)
    v_cvt_pk_bf16_f32 v66, v16, v17
    v_mfma_f32_16x16x32_bf16 v[112:115], v[24:27], a[200:203], v[112:115]
    ds_read_b128 v[40:43], v2 offset:18688
    v_mfma_f32_16x16x32_bf16 v[112:115], v[28:31], a[204:207], v[112:115]
    v_exp_f32 v16, v68
    v_mfma_f32_16x16x32_bf16 v[116:119], v[24:27], a[224:227], v[116:119]
    v_add_f32 v5, v5, v18
    v_add_f32 v5, v5, v19
    v_mfma_f32_16x16x32_bf16 v[116:119], v[28:31], a[228:231], v[116:119]
    s_add_u32 s32, s32, 24576
    v_exp_f32 v17, v69
    v_mfma_f32_16x16x32_bf16 v[120:123], v[24:27], a[248:251], v[120:123]
    s_add_u32 s26, s26, 36864
    ds_read_b128 v[44:47], v3 offset:18688
    v_cvt_pk_bf16_f32 v67, v18, v19
    v_mfma_f32_16x16x32_bf16 v[120:123], v[28:31], a[252:255], v[120:123]
    s_waitcnt lgkmcnt(2)
    v_exp_f32 v18, v70
    v_mfma_f32_16x16x32_bf16 v[124:127], v[24:27], v[208:211], v[124:127]
    s_waitcnt vmcnt(20)
    v_add_f32 v6, v6, v16
    v_add_f32 v6, v6, v17
    v_mfma_f32_16x16x32_bf16 v[124:127], v[28:31], v[212:215], v[124:127]
    s_barrier
    s_sub_u32 s57, s26, 147456
    v_mfma_f32_16x16x32_bf16 v[80:83], v[32:35], a[208:211], v[80:83]
    ds_read_b128 v[24:27], v1 offset:0
    v_mfma_f32_16x16x32_bf16 v[80:83], v[36:39], a[212:215], v[80:83]
    v_exp_f32 v19, v71
    v_mfma_f32_16x16x32_bf16 v[84:87], v[32:35], a[232:235], v[84:87]
    s_min_u32 s26, s26, s57
    v_cvt_pk_bf16_f32 v68, v16, v17
    v_mfma_f32_16x16x32_bf16 v[84:87], v[36:39], a[236:239], v[84:87]
    v_exp_f32 v16, v100
    v_mfma_f32_16x16x32_bf16 v[88:91], v[32:35], v[192:195], v[88:91]
    ds_read_b128 v[28:31], v1 offset:12288
    v_add_f32 v6, v6, v18
    v_mfma_f32_16x16x32_bf16 v[88:91], v[36:39], v[196:199], v[88:91]
    v_add_f32 v6, v6, v19
    v_mfma_f32_16x16x32_bf16 v[92:95], v[32:35], v[216:219], v[92:95]
    v_exp_f32 v17, v101
    v_mfma_f32_16x16x32_bf16 v[92:95], v[36:39], v[220:223], v[92:95]
    s_waitcnt lgkmcnt(2)
    v_cvt_pk_bf16_f32 v69, v18, v19
    v_mfma_f32_16x16x32_bf16 v[112:115], v[40:43], a[208:211], v[112:115]
    ds_read_b128 v[32:35], v1 offset:768
    v_mfma_f32_16x16x32_bf16 v[112:115], v[44:47], a[212:215], v[112:115]
    v_exp_f32 v18, v102
    v_mfma_f32_16x16x32_bf16 v[116:119], v[40:43], a[232:235], v[116:119]
    v_add_f32 v6, v6, v16
    v_add_f32 v6, v6, v17
    v_mfma_f32_16x16x32_bf16 v[116:119], v[44:47], a[236:239], v[116:119]
    v_exp_f32 v19, v103
    v_mfma_f32_16x16x32_bf16 v[120:123], v[40:43], v[192:195], v[120:123]
    s_sub_u32 s31, s31, 1
    ds_read_b128 v[36:39], v1 offset:13056
    v_cvt_pk_bf16_f32 v70, v16, v17
    v_mfma_f32_16x16x32_bf16 v[120:123], v[44:47], v[196:199], v[120:123]
    v_add_f32 v6, v6, v18
    v_add_f32 v6, v6, v19
    v_mfma_f32_16x16x32_bf16 v[124:127], v[40:43], v[216:219], v[124:127]
    s_waitcnt lgkmcnt(2)
    s_cmp_lg_u32 s31, 0
    v_cvt_pk_bf16_f32 v71, v18, v19
    v_mfma_f32_16x16x32_bf16 v[124:127], v[44:47], v[220:223], v[124:127]
    s_cbranch_scc1 L_loop2
    v_mfma_f32_16x16x32_bf16 a[0:3], v[160:163], v[24:27], a[0:3]
    s_mov_b32 m0, s56
    ds_read_b128 v[40:43], v1 offset:1536
    v_bfe_u32 v63, v4, 4, 6
    v_mfma_f32_16x16x32_bf16 a[0:3], v[176:179], v[28:31], a[0:3]
    v_exp_f32 v16, v72
    v_mfma_f32_16x16x32_bf16 a[48:51], v[164:167], v[24:27], a[48:51]
    v_exp_f32 v17, v73
    v_mfma_f32_16x16x32_bf16 a[48:51], v[180:183], v[28:31], a[48:51]
    v_exp_f32 v18, v74
    v_mfma_f32_16x16x32_bf16 a[96:99], v[168:171], v[24:27], a[96:99]
    ds_read_b128 v[44:47], v1 offset:13824
    v_add_f32 v7, v7, v16
    v_mfma_f32_16x16x32_bf16 a[96:99], v[184:187], v[28:31], a[96:99]
    buffer_load_dwordx4 v4, s[4:7], s27 offen offset:0 sc1 lds
    v_mfma_f32_16x16x32_bf16 a[144:147], v[172:175], v[24:27], a[144:147]
    v_add_f32 v7, v7, v17
    v_and_b32 v62, 48, v63
    v_mfma_f32_16x16x32_bf16 a[144:147], v[188:191], v[28:31], a[144:147]
    s_waitcnt lgkmcnt(2)
    v_exp_f32 v19, v75
    v_mfma_f32_16x16x32_bf16 a[4:7], v[160:163], v[32:35], a[4:7]
    ds_read_b128 v[24:27], v1 offset:2304
    v_cvt_pk_bf16_f32 v72, v16, v17
    v_mfma_f32_16x16x32_bf16 a[4:7], v[176:179], v[36:39], a[4:7]
    v_exp_f32 v16, v104
    v_mfma_f32_16x16x32_bf16 a[52:55], v[164:167], v[32:35], a[52:55]
    v_add_f32 v7, v7, v18
    v_and_b32 v63, 15, v63
    v_mfma_f32_16x16x32_bf16 a[52:55], v[180:183], v[36:39], a[52:55]
    v_add_f32 v7, v7, v19
    v_mfma_f32_16x16x32_bf16 a[100:103], v[168:171], v[32:35], a[100:103]
    ds_read_b128 v[28:31], v1 offset:14592
    v_mfma_f32_16x16x32_bf16 a[100:103], v[184:187], v[36:39], a[100:103]
    v_exp_f32 v17, v105
    v_mfma_f32_16x16x32_bf16 a[148:151], v[172:175], v[32:35], a[148:151]
    v_cvt_pk_bf16_f32 v73, v18, v19
    v_mfma_f32_16x16x32_bf16 a[148:151], v[188:191], v[36:39], a[148:151]
    s_waitcnt lgkmcnt(2)
    buffer_load_dwordx4 v4, s[4:7], s27 offen offset:1024 sc1 lds
    v_mfma_f32_16x16x32_bf16 a[8:11], v[160:163], v[40:43], a[8:11]
    ds_read_b128 v[32:35], v21 offset:0
    v_mfma_f32_16x16x32_bf16 a[8:11], v[176:179], v[44:47], a[8:11]
    v_exp_f32 v18, v106
    v_mfma_f32_16x16x32_bf16 a[56:59], v[164:167], v[40:43], a[56:59]
    v_add_f32 v7, v7, v16
    v_add_f32 v7, v7, v17
    v_mfma_f32_16x16x32_bf16 a[56:59], v[180:183], v[44:47], a[56:59]
    v_exp_f32 v19, v107
    v_mfma_f32_16x16x32_bf16 a[104:107], v[168:171], v[40:43], a[104:107]
    ds_read_b128 v[36:39], v21 offset:12288
    v_cvt_pk_bf16_f32 v74, v16, v17
    v_mfma_f32_16x16x32_bf16 a[104:107], v[184:187], v[44:47], a[104:107]
    v_exp_f32 v16, v76
    v_mfma_f32_16x16x32_bf16 a[152:155], v[172:175], v[40:43], a[152:155]
    v_mul_u32_u24 v61, 96, v62
    v_add_f32 v7, v7, v18
    v_mfma_f32_16x16x32_bf16 a[152:155], v[188:191], v[44:47], a[152:155]
    s_waitcnt lgkmcnt(2)
    buffer_load_dwordx4 v4, s[4:7], s27 offen offset:2048 sc1 lds
    v_mfma_f32_16x16x32_bf16 a[12:15], v[160:163], v[24:27], a[12:15]
    ds_read_b128 v[40:43], v21 offset:768
    v_add_f32 v7, v7, v19
    v_mfma_f32_16x16x32_bf16 a[12:15], v[176:179], v[28:31], a[12:15]
    v_exp_f32 v17, v77
    v_mfma_f32_16x16x32_bf16 a[60:63], v[164:167], v[24:27], a[60:63]
    v_cvt_pk_bf16_f32 v75, v18, v19
    v_lshl_add_u32 v60, v63, 4, v61
    v_mfma_f32_16x16x32_bf16 a[60:63], v[180:183], v[28:31], a[60:63]
    v_exp_f32 v18, v78
    v_mfma_f32_16x16x32_bf16 a[108:111], v[168:171], v[24:27], a[108:111]
    ds_read_b128 v[44:47], v21 offset:13056
    v_add_f32 v8, v8, v16
    v_mfma_f32_16x16x32_bf16 a[108:111], v[184:187], v[28:31], a[108:111]
    v_add_f32 v8, v8, v17
    v_mfma_f32_16x16x32_bf16 a[156:159], v[172:175], v[24:27], a[156:159]
    s_add_u32 s29, s28, 49152
    v_exp_f32 v19, v79
    v_mfma_f32_16x16x32_bf16 a[156:159], v[188:191], v[28:31], a[156:159]
    s_waitcnt lgkmcnt(2)
    s_add_u32 s27, s27, 24576
    v_lshl_add_u32 v61, v63, 3, v61
    v_mfma_f32_16x16x32_bf16 a[16:19], v[160:163], v[32:35], a[16:19]
    ds_read_b128 v[24:27], v21 offset:1536
    v_cvt_pk_bf16_f32 v76, v16, v17
    v_mfma_f32_16x16x32_bf16 a[16:19], v[176:179], v[36:39], a[16:19]
    s_sub_u32 s3, s29, 147456
    v_exp_f32 v16, v108
    v_mfma_f32_16x16x32_bf16 a[64:67], v[164:167], v[32:35], a[64:67]
    v_add_f32 v8, v8, v18
    v_mfma_f32_16x16x32_bf16 a[64:67], v[180:183], v[36:39], a[64:67]
    s_add_u32 s56, s56, 12288
    v_add_f32 v8, v8, v19
    v_mfma_f32_16x16x32_bf16 a[112:115], v[168:171], v[32:35], a[112:115]
    ds_read_b128 v[28:31], v21 offset:13824
    v_mfma_f32_16x16x32_bf16 a[112:115], v[184:187], v[36:39], a[112:115]
    v_exp_f32 v17, v109
    v_mfma_f32_16x16x32_bf16 a[160:163], v[172:175], v[32:35], a[160:163]
    s_lshl_b32 s24, s95, 2
    v_cvt_pk_bf16_f32 v77, v18, v19
    v_mfma_f32_16x16x32_bf16 a[160:163], v[188:191], v[36:39], a[160:163]
    s_waitcnt lgkmcnt(2)
    v_exp_f32 v18, v110
    v_mfma_f32_16x16x32_bf16 a[20:23], v[160:163], v[40:43], a[20:23]
    s_mov_b32 m0, s56
    ds_read_b128 v[32:35], v21 offset:2304
    v_add_f32 v8, v8, v16
    v_mfma_f32_16x16x32_bf16 a[20:23], v[176:179], v[44:47], a[20:23]
    s_min_u32 s29, s29, s3
    v_add_f32 v8, v8, v17
    v_mfma_f32_16x16x32_bf16 a[68:71], v[164:167], v[40:43], a[68:71]
    v_exp_f32 v19, v111
    v_mfma_f32_16x16x32_bf16 a[68:71], v[180:183], v[44:47], a[68:71]
    v_mfma_f32_16x16x32_bf16 a[116:119], v[168:171], v[40:43], a[116:119]
    ds_read_b128 v[36:39], v21 offset:14592
    v_cvt_pk_bf16_f32 v78, v16, v17
    v_mfma_f32_16x16x32_bf16 a[116:119], v[184:187], v[44:47], a[116:119]
    s_add_u32 s24, s24, s25
    v_add_f32 v8, v8, v18
    v_add_f32 v8, v8, v19
    v_mfma_f32_16x16x32_bf16 a[164:167], v[172:175], v[40:43], a[164:167]
    s_sub_u32 s3, s29, s28
    v_cvt_pk_bf16_f32 v79, v18, v19
    v_mfma_f32_16x16x32_bf16 a[164:167], v[188:191], v[44:47], a[164:167]
    s_waitcnt lgkmcnt(2)
    buffer_load_dwordx4 v4, s[4:7], s27 offen offset:0 sc1 lds
    v_mfma_f32_16x16x32_bf16 a[24:27], v[160:163], v[24:27], a[24:27]
    ds_read_b128 v[40:43], v22 offset:0
    v_mfma_f32_16x16x32_bf16 a[24:27], v[176:179], v[28:31], a[24:27]
    v_exp_f32 v16, v80
    v_mfma_f32_16x16x32_bf16 a[72:75], v[164:167], v[24:27], a[72:75]
    v_exp_f32 v17, v81
    v_mfma_f32_16x16x32_bf16 a[72:75], v[180:183], v[28:31], a[72:75]
    v_exp_f32 v18, v82
    v_mfma_f32_16x16x32_bf16 a[120:123], v[168:171], v[24:27], a[120:123]
    s_mul_i32 s24, s24, 24576
    ds_read_b128 v[44:47], v22 offset:12288
    v_add_f32 v5, v5, v16
    v_mfma_f32_16x16x32_bf16 a[120:123], v[184:187], v[28:31], a[120:123]
    s_mov_b32 s28, s29
    v_add_f32 v5, v5, v17
    v_mfma_f32_16x16x32_bf16 a[168:171], v[172:175], v[24:27], a[168:171]
    v_exp_f32 v19, v83
    v_mfma_f32_16x16x32_bf16 a[168:171], v[188:191], v[28:31], a[168:171]
    s_waitcnt lgkmcnt(2)
    v_mfma_f32_16x16x32_bf16 a[28:31], v[160:163], v[32:35], a[28:31]
    ds_read_b128 v[24:27], v22 offset:768
    v_cvt_pk_bf16_f32 v80, v16, v17
    v_mfma_f32_16x16x32_bf16 a[28:31], v[176:179], v[36:39], a[28:31]
    buffer_load_dwordx4 v4, s[4:7], s27 offen offset:1024 sc1 lds
    v_mfma_f32_16x16x32_bf16 a[76:79], v[164:167], v[32:35], a[76:79]
    v_exp_f32 v16, v112
    v_mfma_f32_16x16x32_bf16 a[76:79], v[180:183], v[36:39], a[76:79]
    s_add_u32 s33, s24, 0
    v_add_f32 v5, v5, v18
    v_add_f32 v5, v5, v19
    v_mfma_f32_16x16x32_bf16 a[124:127], v[168:171], v[32:35], a[124:127]
    ds_read_b128 v[28:31], v22 offset:13056
    v_add_u32 v2, s3, v2
    v_mfma_f32_16x16x32_bf16 a[124:127], v[184:187], v[36:39], a[124:127]
    v_exp_f32 v17, v113
    v_mfma_f32_16x16x32_bf16 a[172:175], v[172:175], v[32:35], a[172:175]
    v_cvt_pk_bf16_f32 v81, v18, v19
    v_mfma_f32_16x16x32_bf16 a[172:175], v[188:191], v[36:39], a[172:175]
    s_waitcnt lgkmcnt(2)
    v_exp_f32 v18, v114
    v_mfma_f32_16x16x32_bf16 a[32:35], v[160:163], v[40:43], a[32:35]
    ds_read_b128 v[32:35], v22 offset:1536
    v_add_f32 v5, v5, v16
    v_mfma_f32_16x16x32_bf16 a[32:35], v[176:179], v[44:47], a[32:35]
    buffer_load_dwordx4 v4, s[4:7], s27 offen offset:2048 sc1 lds
    v_mfma_f32_16x16x32_bf16 a[80:83], v[164:167], v[40:43], a[80:83]
    s_add_u32 s34, s24, 6144
    v_add_f32 v5, v5, v17
    v_add_u32 v3, s3, v3
    v_mfma_f32_16x16x32_bf16 a[80:83], v[180:183], v[44:47], a[80:83]
    v_exp_f32 v19, v115
    v_mfma_f32_16x16x32_bf16 a[128:131], v[168:171], v[40:43], a[128:131]
    ds_read_b128 v[36:39], v22 offset:13824
    v_cvt_pk_bf16_f32 v82, v16, v17
    v_mfma_f32_16x16x32_bf16 a[128:131], v[184:187], v[44:47], a[128:131]
    v_exp_f32 v16, v84
    v_mfma_f32_16x16x32_bf16 a[176:179], v[172:175], v[40:43], a[176:179]
    v_add_f32 v5, v5, v18
    v_mfma_f32_16x16x32_bf16 a[176:179], v[188:191], v[44:47], a[176:179]
    s_waitcnt lgkmcnt(2)
    v_add_f32 v5, v5, v19
    v_mfma_f32_16x16x32_bf16 a[36:39], v[160:163], v[24:27], a[36:39]
    ds_read_b128 v[40:43], v22 offset:2304
    v_mfma_f32_16x16x32_bf16 a[36:39], v[176:179], v[28:31], a[36:39]
    s_add_u32 s35, s24, 12288
    v_exp_f32 v17, v85
    v_mfma_f32_16x16x32_bf16 a[84:87], v[164:167], v[24:27], a[84:87]
    v_cvt_pk_bf16_f32 v83, v18, v19
    v_mfma_f32_16x16x32_bf16 a[84:87], v[180:183], v[28:31], a[84:87]
    s_add_u32 s27, s27, 24576
    v_exp_f32 v18, v86
    v_mfma_f32_16x16x32_bf16 a[132:135], v[168:171], v[24:27], a[132:135]
    s_add_u32 s56, s56, 36864
    ds_read_b128 v[44:47], v22 offset:14592
    v_add_f32 v6, v6, v16
    v_mfma_f32_16x16x32_bf16 a[132:135], v[184:187], v[28:31], a[132:135]
    s_waitcnt lgkmcnt(2)
    v_add_f32 v6, v6, v17
    v_mfma_f32_16x16x32_bf16 a[180:183], v[172:175], v[24:27], a[180:183]
    s_waitcnt vmcnt(63)
    v_exp_f32 v19, v87
    v_mfma_f32_16x16x32_bf16 a[180:183], v[188:191], v[28:31], a[180:183]
    s_barrier
    s_sub_u32 s58, s56, 147456
    v_mfma_f32_16x16x32_bf16 a[40:43], v[160:163], v[32:35], a[40:43]
    s_add_u32 s36, s24, 18432
    ds_read_b128 v[24:27], v2 offset:0
    v_cvt_pk_bf16_f32 v84, v16, v17
    v_mfma_f32_16x16x32_bf16 a[40:43], v[176:179], v[36:39], a[40:43]
    v_exp_f32 v16, v116
    v_mfma_f32_16x16x32_bf16 a[88:91], v[164:167], v[32:35], a[88:91]
    s_min_u32 s56, s56, s58
    v_add_f32 v6, v6, v18
    v_mfma_f32_16x16x32_bf16 a[88:91], v[180:183], v[36:39], a[88:91]
    v_add_f32 v6, v6, v19
    v_mfma_f32_16x16x32_bf16 a[136:139], v[168:171], v[32:35], a[136:139]
    ds_read_b128 v[28:31], v3 offset:0
    v_mfma_f32_16x16x32_bf16 a[136:139], v[184:187], v[36:39], a[136:139]
    v_exp_f32 v17, v117
    v_mfma_f32_16x16x32_bf16 a[184:187], v[172:175], v[32:35], a[184:187]
    v_cvt_pk_bf16_f32 v85, v18, v19
    v_mfma_f32_16x16x32_bf16 a[184:187], v[188:191], v[36:39], a[184:187]
    s_waitcnt lgkmcnt(2)
    v_exp_f32 v18, v118
    v_mfma_f32_16x16x32_bf16 a[44:47], v[160:163], v[40:43], a[44:47]
    ds_read_b128 v[32:35], v2 offset:6144
    v_add_f32 v6, v6, v16
    v_mfma_f32_16x16x32_bf16 a[44:47], v[176:179], v[44:47], a[44:47]
    v_add_f32 v6, v6, v17
    v_mfma_f32_16x16x32_bf16 a[92:95], v[164:167], v[40:43], a[92:95]
    v_exp_f32 v19, v119
    v_mfma_f32_16x16x32_bf16 a[92:95], v[180:183], v[44:47], a[92:95]
    v_mfma_f32_16x16x32_bf16 a[140:143], v[168:171], v[40:43], a[140:143]
    ds_read_b128 v[36:39], v3 offset:6144
    v_cvt_pk_bf16_f32 v86, v16, v17
    v_mfma_f32_16x16x32_bf16 a[140:143], v[184:187], v[44:47], a[140:143]
    v_add_f32 v6, v6, v18
    v_add_f32 v6, v6, v19
    v_mfma_f32_16x16x32_bf16 a[188:191], v[172:175], v[40:43], a[188:191]
    v_cvt_pk_bf16_f32 v87, v18, v19
    v_mfma_f32_16x16x32_bf16 a[188:191], v[188:191], v[44:47], a[188:191]
    s_waitcnt lgkmcnt(2)
    v_mfma_f32_16x16x32_bf16 v[160:163], v[24:27], a[192:195], v[128:131]
    ds_read_b128 v[40:43], v2 offset:128
    v_mfma_f32_16x16x32_bf16 v[160:163], v[28:31], a[196:199], v[160:163]
    v_exp_f32 v16, v88
    v_mfma_f32_16x16x32_bf16 v[164:167], v[24:27], a[216:219], v[132:135]
    v_exp_f32 v17, v89
    v_mfma_f32_16x16x32_bf16 v[164:167], v[28:31], a[220:223], v[164:167]
    v_exp_f32 v18, v90
    v_mfma_f32_16x16x32_bf16 v[168:171], v[24:27], a[240:243], v[136:139]
    ds_read_b128 v[44:47], v3 offset:128
    v_mfma_f32_16x16x32_bf16 v[168:171], v[28:31], a[244:247], v[168:171]
    v_add_f32 v7, v7, v16
    v_add_f32 v7, v7, v17
    v_mfma_f32_16x16x32_bf16 v[172:175], v[24:27], v[200:203], v[140:143]
    v_mfma_f32_16x16x32_bf16 v[172:175], v[28:31], v[204:207], v[172:175]
    s_waitcnt lgkmcnt(2)
    v_exp_f32 v19, v91
    v_mfma_f32_16x16x32_bf16 v[96:99], v[32:35], a[192:195], v[128:131]
    ds_read_b128 v[24:27], v2 offset:6272
    v_cvt_pk_bf16_f32 v88, v16, v17
    v_mfma_f32_16x16x32_bf16 v[96:99], v[36:39], a[196:199], v[96:99]
    v_mfma_f32_16x16x32_bf16 v[100:103], v[32:35], a[216:219], v[132:135]
    v_exp_f32 v16, v120
    v_mfma_f32_16x16x32_bf16 v[100:103], v[36:39], a[220:223], v[100:103]
    v_add_f32 v7, v7, v18
    v_mfma_f32_16x16x32_bf16 v[104:107], v[32:35], a[240:243], v[136:139]
    ds_read_b128 v[28:31], v3 offset:6272
    v_add_f32 v7, v7, v19
    v_mfma_f32_16x16x32_bf16 v[104:107], v[36:39], a[244:247], v[104:107]
    v_exp_f32 v17, v121
    v_mfma_f32_16x16x32_bf16 v[108:111], v[32:35], v[200:203], v[140:143]
    v_mfma_f32_16x16x32_bf16 v[108:111], v[36:39], v[204:207], v[108:111]
    s_waitcnt lgkmcnt(2)
    v_cvt_pk_bf16_f32 v89, v18, v19
    v_mfma_f32_16x16x32_bf16 v[160:163], v[40:43], a[200:203], v[160:163]
    ds_read_b128 v[32:35], v2 offset:256
    v_mfma_f32_16x16x32_bf16 v[160:163], v[44:47], a[204:207], v[160:163]
    v_exp_f32 v18, v122
    v_mfma_f32_16x16x32_bf16 v[164:167], v[40:43], a[224:227], v[164:167]
    v_add_f32 v7, v7, v16
    v_add_f32 v7, v7, v17
    v_mfma_f32_16x16x32_bf16 v[164:167], v[44:47], a[228:231], v[164:167]
    v_mfma_f32_16x16x32_bf16 v[168:171], v[40:43], a[248:251], v[168:171]
    ds_read_b128 v[36:39], v3 offset:256
    v_mfma_f32_16x16x32_bf16 v[168:171], v[44:47], a[252:255], v[168:171]
    v_exp_f32 v19, v123
    v_mfma_f32_16x16x32_bf16 v[172:175], v[40:43], v[208:211], v[172:175]
    v_cvt_pk_bf16_f32 v90, v16, v17
    v_mfma_f32_16x16x32_bf16 v[172:175], v[44:47], v[212:215], v[172:175]
    s_waitcnt lgkmcnt(2)
    v_exp_f32 v16, v92
    v_mfma_f32_16x16x32_bf16 v[96:99], v[24:27], a[200:203], v[96:99]
    ds_read_b128 v[40:43], v2 offset:6400
    v_add_f32 v7, v7, v18
    v_mfma_f32_16x16x32_bf16 v[96:99], v[28:31], a[204:207], v[96:99]
    v_add_f32 v7, v7, v19
    v_mfma_f32_16x16x32_bf16 v[100:103], v[24:27], a[224:227], v[100:103]
    v_exp_f32 v17, v93
    v_mfma_f32_16x16x32_bf16 v[100:103], v[28:31], a[228:231], v[100:103]
    v_cvt_pk_bf16_f32 v91, v18, v19
    v_mfma_f32_16x16x32_bf16 v[104:107], v[24:27], a[248:251], v[104:107]
    ds_read_b128 v[44:47], v3 offset:6400
    v_mfma_f32_16x16x32_bf16 v[104:107], v[28:31], a[252:255], v[104:107]
    v_exp_f32 v18, v94
    v_mfma_f32_16x16x32_bf16 v[108:111], v[24:27], v[208:211], v[108:111]
    s_add_u32 s29, s30, 49152
    v_add_f32 v8, v8, v16
    v_mfma_f32_16x16x32_bf16 v[108:111], v[28:31], v[212:215], v[108:111]
    s_waitcnt lgkmcnt(2)
    v_add_f32 v8, v8, v17
    v_mfma_f32_16x16x32_bf16 v[160:163], v[32:35], a[208:211], v[160:163]
    s_sub_u32 s3, s29, 147456
    ds_read_b128 v[24:27], v2 offset:12288
    v_mfma_f32_16x16x32_bf16 v[160:163], v[36:39], a[212:215], v[160:163]
    v_exp_f32 v19, v95
    v_mfma_f32_16x16x32_bf16 v[164:167], v[32:35], a[232:235], v[164:167]
    v_cvt_pk_bf16_f32 v92, v16, v17
    v_mfma_f32_16x16x32_bf16 v[164:167], v[36:39], a[236:239], v[164:167]
    v_exp_f32 v16, v124
    v_mfma_f32_16x16x32_bf16 v[168:171], v[32:35], v[192:195], v[168:171]
    ds_read_b128 v[28:31], v3 offset:12288
    v_add_f32 v8, v8, v18
    v_mfma_f32_16x16x32_bf16 v[168:171], v[36:39], v[196:199], v[168:171]
    v_add_f32 v8, v8, v19
    v_mfma_f32_16x16x32_bf16 v[172:175], v[32:35], v[216:219], v[172:175]
    s_min_u32 s29, s29, s3
    v_mfma_f32_16x16x32_bf16 v[172:175], v[36:39], v[220:223], v[172:175]
    s_waitcnt lgkmcnt(2)
    v_exp_f32 v17, v125
    v_mfma_f32_16x16x32_bf16 v[96:99], v[40:43], a[208:211], v[96:99]
    ds_read_b128 v[32:35], v2 offset:18432
    v_cvt_pk_bf16_f32 v93, v18, v19
    v_mfma_f32_16x16x32_bf16 v[96:99], v[44:47], a[212:215], v[96:99]
    v_exp_f32 v18, v126
    v_mfma_f32_16x16x32_bf16 v[100:103], v[40:43], a[232:235], v[100:103]
    v_mfma_f32_16x16x32_bf16 v[100:103], v[44:47], a[236:239], v[100:103]
    v_add_f32 v8, v8, v16
    v_mfma_f32_16x16x32_bf16 v[104:107], v[40:43], v[192:195], v[104:107]
    s_sub_u32 s3, s29, s30
    ds_read_b128 v[36:39], v3 offset:18432
    v_add_f32 v8, v8, v17
    v_mfma_f32_16x16x32_bf16 v[104:107], v[44:47], v[196:199], v[104:107]
    v_exp_f32 v19, v127
    v_mfma_f32_16x16x32_bf16 v[108:111], v[40:43], v[216:219], v[108:111]
    v_cvt_pk_bf16_f32 v94, v16, v17
    v_mfma_f32_16x16x32_bf16 v[108:111], v[44:47], v[220:223], v[108:111]
    s_waitcnt lgkmcnt(2)
    v_add_f32 v8, v8, v18
    v_mfma_f32_16x16x32_bf16 v[176:179], v[24:27], a[192:195], v[128:131]
    ds_read_b128 v[40:43], v2 offset:12416
    v_add_f32 v8, v8, v19
    v_mfma_f32_16x16x32_bf16 v[176:179], v[28:31], a[196:199], v[176:179]
    v_cvt_pk_bf16_f32 v95, v18, v19
    v_mfma_f32_16x16x32_bf16 v[180:183], v[24:27], a[216:219], v[132:135]
    s_mov_b32 s30, s29
    v_mfma_f32_16x16x32_bf16 v[180:183], v[28:31], a[220:223], v[180:183]
    v_mfma_f32_16x16x32_bf16 v[184:187], v[24:27], a[240:243], v[136:139]
    ds_read_b128 v[44:47], v3 offset:12416
    v_mfma_f32_16x16x32_bf16 v[184:187], v[28:31], a[244:247], v[184:187]
    v_exp_f32 v16, v160
    v_mfma_f32_16x16x32_bf16 v[188:191], v[24:27], v[200:203], v[140:143]
    v_exp_f32 v17, v161
    v_mfma_f32_16x16x32_bf16 v[188:191], v[28:31], v[204:207], v[188:191]
    s_waitcnt lgkmcnt(2)
    v_exp_f32 v18, v162
    v_mfma_f32_16x16x32_bf16 v[112:115], v[32:35], a[192:195], v[128:131]
    ds_read_b128 v[24:27], v2 offset:18560
    v_add_f32 v5, v5, v16
    v_mfma_f32_16x16x32_bf16 v[112:115], v[36:39], a[196:199], v[112:115]
    v_add_f32 v5, v5, v17
    v_add_u32 v1, s3, v1
    v_mfma_f32_16x16x32_bf16 v[116:119], v[32:35], a[216:219], v[132:135]
    v_exp_f32 v19, v163
    v_mfma_f32_16x16x32_bf16 v[116:119], v[36:39], a[220:223], v[116:119]
    v_cvt_pk_bf16_f32 v160, v16, v17
    v_mfma_f32_16x16x32_bf16 v[120:123], v[32:35], a[240:243], v[136:139]
    ds_read_b128 v[28:31], v3 offset:18560
    v_mfma_f32_16x16x32_bf16 v[120:123], v[36:39], a[244:247], v[120:123]
    v_exp_f32 v16, v96
    v_mfma_f32_16x16x32_bf16 v[124:127], v[32:35], v[200:203], v[140:143]
    v_add_f32 v5, v5, v18
    v_add_f32 v5, v5, v19
    v_mfma_f32_16x16x32_bf16 v[124:127], v[36:39], v[204:207], v[124:127]
    s_waitcnt lgkmcnt(2)
    v_exp_f32 v17, v97
    v_mfma_f32_16x16x32_bf16 v[176:179], v[40:43], a[200:203], v[176:179]
    ds_read_b128 v[32:35], v2 offset:12544
    v_add_u32 v21, s3, v21
    v_mfma_f32_16x16x32_bf16 v[176:179], v[44:47], a[204:207], v[176:179]
    v_cvt_pk_bf16_f32 v161, v18, v19
    v_mfma_f32_16x16x32_bf16 v[180:183], v[40:43], a[224:227], v[180:183]
    v_exp_f32 v18, v98
    v_mfma_f32_16x16x32_bf16 v[180:183], v[44:47], a[228:231], v[180:183]
    v_add_f32 v5, v5, v16
    v_mfma_f32_16x16x32_bf16 v[184:187], v[40:43], a[248:251], v[184:187]
    ds_read_b128 v[36:39], v3 offset:12544
    v_add_f32 v5, v5, v17
    v_mfma_f32_16x16x32_bf16 v[184:187], v[44:47], a[252:255], v[184:187]
    v_exp_f32 v19, v99
    v_mfma_f32_16x16x32_bf16 v[188:191], v[40:43], v[208:211], v[188:191]
    v_cvt_pk_bf16_f32 v162, v16, v17
    v_add_u32 v22, s3, v22
    v_mfma_f32_16x16x32_bf16 v[188:191], v[44:47], v[212:215], v[188:191]
    s_waitcnt lgkmcnt(2)
    v_exp_f32 v16, v164
    v_mfma_f32_16x16x32_bf16 v[112:115], v[24:27], a[200:203], v[112:115]
    ds_read_b128 v[40:43], v2 offset:18688
    v_add_f32 v5, v5, v18
    v_mfma_f32_16x16x32_bf16 v[112:115], v[28:31], a[204:207], v[112:115]
    v_add_f32 v5, v5, v19
    v_mfma_f32_16x16x32_bf16 v[116:119], v[24:27], a[224:227], v[116:119]
    v_exp_f32 v17, v165
    v_mfma_f32_16x16x32_bf16 v[116:119], v[28:31], a[228:231], v[116:119]
    v_cvt_pk_bf16_f32 v163, v18, v19
    v_mfma_f32_16x16x32_bf16 v[120:123], v[24:27], a[248:251], v[120:123]
    ds_read_b128 v[44:47], v3 offset:18688
    v_mfma_f32_16x16x32_bf16 v[120:123], v[28:31], a[252:255], v[120:123]
    s_waitcnt lgkmcnt(2)
    v_exp_f32 v18, v166
    v_mfma_f32_16x16x32_bf16 v[124:127], v[24:27], v[208:211], v[124:127]
    s_waitcnt vmcnt(0)
    v_add_f32 v6, v6, v16
    v_mfma_f32_16x16x32_bf16 v[124:127], v[28:31], v[212:215], v[124:127]
    s_barrier
    v_add_f32 v6, v6, v17
    v_mfma_f32_16x16x32_bf16 v[176:179], v[32:35], a[208:211], v[176:179]
    ds_read_b128 v[24:27], v1 offset:0
    v_add_u32 v9, 49152, v1
    v_mfma_f32_16x16x32_bf16 v[176:179], v[36:39], a[212:215], v[176:179]
    v_exp_f32 v19, v167
    v_mfma_f32_16x16x32_bf16 v[180:183], v[32:35], a[232:235], v[180:183]
    v_cvt_pk_bf16_f32 v164, v16, v17
    v_add_u32 v10, 49152, v21
    v_mfma_f32_16x16x32_bf16 v[180:183], v[36:39], a[236:239], v[180:183]
    v_exp_f32 v16, v100
    v_mfma_f32_16x16x32_bf16 v[184:187], v[32:35], v[192:195], v[184:187]
    ds_read_b128 v[28:31], v1 offset:12288
    v_add_f32 v6, v6, v18
    v_mfma_f32_16x16x32_bf16 v[184:187], v[36:39], v[196:199], v[184:187]
    v_add_f32 v6, v6, v19
    v_mfma_f32_16x16x32_bf16 v[188:191], v[32:35], v[216:219], v[188:191]
    v_exp_f32 v17, v101
    v_mfma_f32_16x16x32_bf16 v[188:191], v[36:39], v[220:223], v[188:191]
    s_waitcnt lgkmcnt(2)
    v_cvt_pk_bf16_f32 v165, v18, v19
    v_add_u32 v11, 49152, v22
    v_mfma_f32_16x16x32_bf16 v[112:115], v[40:43], a[208:211], v[112:115]
    ds_read_b128 v[32:35], v1 offset:768
    v_mfma_f32_16x16x32_bf16 v[112:115], v[44:47], a[212:215], v[112:115]
    v_exp_f32 v18, v102
    v_mfma_f32_16x16x32_bf16 v[116:119], v[40:43], a[232:235], v[116:119]
    v_add_f32 v6, v6, v16
    v_add_f32 v6, v6, v17
    v_mfma_f32_16x16x32_bf16 v[116:119], v[44:47], a[236:239], v[116:119]
    v_exp_f32 v19, v103
    v_mfma_f32_16x16x32_bf16 v[120:123], v[40:43], v[192:195], v[120:123]
    ds_read_b128 v[36:39], v1 offset:13056
    v_cvt_pk_bf16_f32 v166, v16, v17
    v_mfma_f32_16x16x32_bf16 v[120:123], v[44:47], v[196:199], v[120:123]
    v_add_f32 v6, v6, v18
    v_mfma_f32_16x16x32_bf16 v[124:127], v[40:43], v[216:219], v[124:127]
    v_add_f32 v6, v6, v19
    v_cvt_pk_bf16_f32 v167, v18, v19
    v_mfma_f32_16x16x32_bf16 v[124:127], v[44:47], v[220:223], v[124:127]
    s_waitcnt lgkmcnt(2)
    v_mfma_f32_16x16x32_bf16 a[0:3], v[64:67], v[24:27], a[0:3]
    ds_read_b128 v[40:43], v1 offset:1536
    v_mfma_f32_16x16x32_bf16 a[0:3], v[80:83], v[28:31], a[0:3]
    v_exp_f32 v16, v176
    v_mfma_f32_16x16x32_bf16 a[48:51], v[68:71], v[24:27], a[48:51]
    ds_read_b128 v[44:47], v1 offset:13824
    v_mfma_f32_16x16x32_bf16 a[48:51], v[84:87], v[28:31], a[48:51]
    s_waitcnt lgkmcnt(2)
    v_exp_f32 v17, v177
    v_mfma_f32_16x16x32_bf16 a[4:7], v[64:67], v[32:35], a[4:7]
    ds_read_b128 v[24:27], v1 offset:2304
    v_mfma_f32_16x16x32_bf16 a[4:7], v[80:83], v[36:39], a[4:7]
    v_exp_f32 v18, v178
    v_mfma_f32_16x16x32_bf16 a[52:55], v[68:71], v[32:35], a[52:55]
    ds_read_b128 v[28:31], v1 offset:14592
    v_add_f32 v5, v5, v16
    v_mfma_f32_16x16x32_bf16 a[52:55], v[84:87], v[36:39], a[52:55]
    s_waitcnt lgkmcnt(2)
    v_add_f32 v5, v5, v17
    v_mfma_f32_16x16x32_bf16 a[8:11], v[64:67], v[40:43], a[8:11]
    ds_read_b128 v[32:35], v21 offset:0
    v_mfma_f32_16x16x32_bf16 a[8:11], v[80:83], v[44:47], a[8:11]
    v_exp_f32 v19, v179
    v_mfma_f32_16x16x32_bf16 a[56:59], v[68:71], v[40:43], a[56:59]
    ds_read_b128 v[36:39], v21 offset:12288
    v_cvt_pk_bf16_f32 v176, v16, v17
    v_mfma_f32_16x16x32_bf16 a[56:59], v[84:87], v[44:47], a[56:59]
    s_waitcnt lgkmcnt(2)
    v_exp_f32 v16, v112
    v_mfma_f32_16x16x32_bf16 a[12:15], v[64:67], v[24:27], a[12:15]
    ds_read_b128 v[40:43], v21 offset:768
    v_add_f32 v5, v5, v18
    v_mfma_f32_16x16x32_bf16 a[12:15], v[80:83], v[28:31], a[12:15]
    v_add_f32 v5, v5, v19
    v_mfma_f32_16x16x32_bf16 a[60:63], v[68:71], v[24:27], a[60:63]
    ds_read_b128 v[44:47], v21 offset:13056
    v_mfma_f32_16x16x32_bf16 a[60:63], v[84:87], v[28:31], a[60:63]
    s_waitcnt lgkmcnt(2)
    v_exp_f32 v17, v113
    v_mfma_f32_16x16x32_bf16 a[16:19], v[64:67], v[32:35], a[16:19]
    ds_read_b128 v[24:27], v21 offset:1536
    v_cvt_pk_bf16_f32 v177, v18, v19
    v_mfma_f32_16x16x32_bf16 a[16:19], v[80:83], v[36:39], a[16:19]
    v_exp_f32 v18, v114
    v_mfma_f32_16x16x32_bf16 a[64:67], v[68:71], v[32:35], a[64:67]
    ds_read_b128 v[28:31], v21 offset:13824
    v_add_f32 v5, v5, v16
    v_mfma_f32_16x16x32_bf16 a[64:67], v[84:87], v[36:39], a[64:67]
    s_waitcnt lgkmcnt(2)
    v_add_f32 v5, v5, v17
    v_mfma_f32_16x16x32_bf16 a[20:23], v[64:67], v[40:43], a[20:23]
    ds_read_b128 v[32:35], v21 offset:2304
    v_mfma_f32_16x16x32_bf16 a[20:23], v[80:83], v[44:47], a[20:23]
    v_exp_f32 v19, v115
    v_mfma_f32_16x16x32_bf16 a[68:71], v[68:71], v[40:43], a[68:71]
    ds_read_b128 v[36:39], v21 offset:14592
    v_cvt_pk_bf16_f32 v178, v16, v17
    v_mfma_f32_16x16x32_bf16 a[68:71], v[84:87], v[44:47], a[68:71]
    s_waitcnt lgkmcnt(2)
    v_exp_f32 v16, v180
    v_mfma_f32_16x16x32_bf16 a[24:27], v[64:67], v[24:27], a[24:27]
    ds_read_b128 v[40:43], v22 offset:0
    v_add_f32 v5, v5, v18
    v_mfma_f32_16x16x32_bf16 a[24:27], v[80:83], v[28:31], a[24:27]
    v_add_f32 v5, v5, v19
    v_mfma_f32_16x16x32_bf16 a[72:75], v[68:71], v[24:27], a[72:75]
    ds_read_b128 v[44:47], v22 offset:12288
    v_mfma_f32_16x16x32_bf16 a[72:75], v[84:87], v[28:31], a[72:75]
    s_waitcnt lgkmcnt(2)
    v_exp_f32 v17, v181
    v_mfma_f32_16x16x32_bf16 a[28:31], v[64:67], v[32:35], a[28:31]
    ds_read_b128 v[24:27], v22 offset:768
    v_cvt_pk_bf16_f32 v179, v18, v19
    v_mfma_f32_16x16x32_bf16 a[28:31], v[80:83], v[36:39], a[28:31]
    v_exp_f32 v18, v182
    v_mfma_f32_16x16x32_bf16 a[76:79], v[68:71], v[32:35], a[76:79]
    ds_read_b128 v[28:31], v22 offset:13056
    v_add_f32 v6, v6, v16
    v_mfma_f32_16x16x32_bf16 a[76:79], v[84:87], v[36:39], a[76:79]
    s_waitcnt lgkmcnt(2)
    v_add_f32 v6, v6, v17
    v_mfma_f32_16x16x32_bf16 a[32:35], v[64:67], v[40:43], a[32:35]
    ds_read_b128 v[32:35], v22 offset:1536
    v_mfma_f32_16x16x32_bf16 a[32:35], v[80:83], v[44:47], a[32:35]
    v_exp_f32 v19, v183
    v_mfma_f32_16x16x32_bf16 a[80:83], v[68:71], v[40:43], a[80:83]
    ds_read_b128 v[36:39], v22 offset:13824
    v_cvt_pk_bf16_f32 v180, v16, v17
    v_mfma_f32_16x16x32_bf16 a[80:83], v[84:87], v[44:47], a[80:83]
    s_waitcnt lgkmcnt(2)
    v_exp_f32 v16, v116
    v_mfma_f32_16x16x32_bf16 a[36:39], v[64:67], v[24:27], a[36:39]
    ds_read_b128 v[40:43], v22 offset:2304
    v_add_f32 v6, v6, v18
    v_mfma_f32_16x16x32_bf16 a[36:39], v[80:83], v[28:31], a[36:39]
    v_add_f32 v6, v6, v19
    v_mfma_f32_16x16x32_bf16 a[84:87], v[68:71], v[24:27], a[84:87]
    ds_read_b128 v[44:47], v22 offset:14592
    v_mfma_f32_16x16x32_bf16 a[84:87], v[84:87], v[28:31], a[84:87]
    s_waitcnt lgkmcnt(2)
    v_exp_f32 v17, v117
    v_mfma_f32_16x16x32_bf16 a[40:43], v[64:67], v[32:35], a[40:43]
    ds_read_b128 v[24:27], v9 offset:0
    v_cvt_pk_bf16_f32 v181, v18, v19
    v_mfma_f32_16x16x32_bf16 a[40:43], v[80:83], v[36:39], a[40:43]
    v_exp_f32 v18, v118
    v_mfma_f32_16x16x32_bf16 a[88:91], v[68:71], v[32:35], a[88:91]
    ds_read_b128 v[28:31], v9 offset:12288
    v_add_f32 v6, v6, v16
    v_mfma_f32_16x16x32_bf16 a[88:91], v[84:87], v[36:39], a[88:91]
    s_waitcnt lgkmcnt(2)
    v_add_f32 v6, v6, v17
    v_mfma_f32_16x16x32_bf16 a[44:47], v[64:67], v[40:43], a[44:47]
    ds_read_b128 v[32:35], v9 offset:768
    v_mfma_f32_16x16x32_bf16 a[44:47], v[80:83], v[44:47], a[44:47]
    v_exp_f32 v19, v119
    v_mfma_f32_16x16x32_bf16 a[92:95], v[68:71], v[40:43], a[92:95]
    ds_read_b128 v[36:39], v9 offset:13056
    v_cvt_pk_bf16_f32 v182, v16, v17
    v_mfma_f32_16x16x32_bf16 a[92:95], v[84:87], v[44:47], a[92:95]
    s_waitcnt lgkmcnt(2)
    v_add_f32 v6, v6, v18
    v_add_f32 v6, v6, v19
    v_cvt_pk_bf16_f32 v183, v18, v19
    s_nop 1
    v_mfma_f32_16x16x32_bf16 a[0:3], v[160:163], v[24:27], a[0:3]
    ds_read_b128 v[40:43], v9 offset:1536
    v_max_f32 v20, v5, v6
    v_mfma_f32_16x16x32_bf16 a[0:3], v[176:179], v[28:31], a[0:3]
    s_mov_b32 s29, 0x5f800000
    v_cmp_lt_f32 vcc, s29, v20
    v_mfma_f32_16x16x32_bf16 a[48:51], v[164:167], v[24:27], a[48:51]
    ds_read_b128 v[44:47], v9 offset:13824
    v_mfma_f32_16x16x32_bf16 a[48:51], v[180:183], v[28:31], a[48:51]
    s_waitcnt lgkmcnt(2)
    v_exp_f32 v16, v168
    v_mfma_f32_16x16x32_bf16 a[4:7], v[160:163], v[32:35], a[4:7]
    ds_read_b128 v[24:27], v9 offset:2304
    v_mfma_f32_16x16x32_bf16 a[4:7], v[176:179], v[36:39], a[4:7]
    v_exp_f32 v17, v169
    v_mfma_f32_16x16x32_bf16 a[52:55], v[164:167], v[32:35], a[52:55]
    ds_read_b128 v[28:31], v9 offset:14592
    v_mfma_f32_16x16x32_bf16 a[52:55], v[180:183], v[36:39], a[52:55]
    s_waitcnt lgkmcnt(2)
    v_exp_f32 v18, v170
    v_mfma_f32_16x16x32_bf16 a[8:11], v[160:163], v[40:43], a[8:11]
    ds_read_b128 v[32:35], v10 offset:0
    v_add_f32 v7, v7, v16
    v_mfma_f32_16x16x32_bf16 a[8:11], v[176:179], v[44:47], a[8:11]
    v_add_f32 v7, v7, v17
    v_mfma_f32_16x16x32_bf16 a[56:59], v[164:167], v[40:43], a[56:59]
    ds_read_b128 v[36:39], v10 offset:12288
    v_mfma_f32_16x16x32_bf16 a[56:59], v[180:183], v[44:47], a[56:59]
    s_waitcnt lgkmcnt(2)
    v_exp_f32 v19, v171
    v_mfma_f32_16x16x32_bf16 a[12:15], v[160:163], v[24:27], a[12:15]
    ds_read_b128 v[40:43], v10 offset:768
    v_cvt_pk_bf16_f32 v168, v16, v17
    v_mfma_f32_16x16x32_bf16 a[12:15], v[176:179], v[28:31], a[12:15]
    v_exp_f32 v16, v104
    v_mfma_f32_16x16x32_bf16 a[60:63], v[164:167], v[24:27], a[60:63]
    ds_read_b128 v[44:47], v10 offset:13056
    v_add_f32 v7, v7, v18
    v_mfma_f32_16x16x32_bf16 a[60:63], v[180:183], v[28:31], a[60:63]
    s_waitcnt lgkmcnt(2)
    v_add_f32 v7, v7, v19
    v_mfma_f32_16x16x32_bf16 a[16:19], v[160:163], v[32:35], a[16:19]
    ds_read_b128 v[24:27], v10 offset:1536
    v_mfma_f32_16x16x32_bf16 a[16:19], v[176:179], v[36:39], a[16:19]
    v_exp_f32 v17, v105
    v_mfma_f32_16x16x32_bf16 a[64:67], v[164:167], v[32:35], a[64:67]
    ds_read_b128 v[28:31], v10 offset:13824
    v_cvt_pk_bf16_f32 v169, v18, v19
    v_mfma_f32_16x16x32_bf16 a[64:67], v[180:183], v[36:39], a[64:67]
    s_waitcnt lgkmcnt(2)
    v_exp_f32 v18, v106
    v_mfma_f32_16x16x32_bf16 a[20:23], v[160:163], v[40:43], a[20:23]
    ds_read_b128 v[32:35], v10 offset:2304
    v_add_f32 v7, v7, v16
    v_mfma_f32_16x16x32_bf16 a[20:23], v[176:179], v[44:47], a[20:23]
    v_add_f32 v7, v7, v17
    v_mfma_f32_16x16x32_bf16 a[68:71], v[164:167], v[40:43], a[68:71]
    ds_read_b128 v[36:39], v10 offset:14592
    v_mfma_f32_16x16x32_bf16 a[68:71], v[180:183], v[44:47], a[68:71]
    s_waitcnt lgkmcnt(2)
    v_exp_f32 v19, v107
    v_mfma_f32_16x16x32_bf16 a[24:27], v[160:163], v[24:27], a[24:27]
    ds_read_b128 v[40:43], v11 offset:0
    v_cvt_pk_bf16_f32 v170, v16, v17
    v_mfma_f32_16x16x32_bf16 a[24:27], v[176:179], v[28:31], a[24:27]
    v_exp_f32 v16, v172
    v_mfma_f32_16x16x32_bf16 a[72:75], v[164:167], v[24:27], a[72:75]
    ds_read_b128 v[44:47], v11 offset:12288
    v_add_f32 v7, v7, v18
    v_mfma_f32_16x16x32_bf16 a[72:75], v[180:183], v[28:31], a[72:75]
    s_waitcnt lgkmcnt(2)
    v_add_f32 v7, v7, v19
    v_mfma_f32_16x16x32_bf16 a[28:31], v[160:163], v[32:35], a[28:31]
    ds_read_b128 v[24:27], v11 offset:768
    v_mfma_f32_16x16x32_bf16 a[28:31], v[176:179], v[36:39], a[28:31]
    v_exp_f32 v17, v173
    v_mfma_f32_16x16x32_bf16 a[76:79], v[164:167], v[32:35], a[76:79]
    ds_read_b128 v[28:31], v11 offset:13056
    v_cvt_pk_bf16_f32 v171, v18, v19
    v_mfma_f32_16x16x32_bf16 a[76:79], v[180:183], v[36:39], a[76:79]
    s_waitcnt lgkmcnt(2)
    v_exp_f32 v18, v174
    v_mfma_f32_16x16x32_bf16 a[32:35], v[160:163], v[40:43], a[32:35]
    ds_read_b128 v[32:35], v11 offset:1536
    v_add_f32 v8, v8, v16
    v_mfma_f32_16x16x32_bf16 a[32:35], v[176:179], v[44:47], a[32:35]
    v_add_f32 v8, v8, v17
    v_mfma_f32_16x16x32_bf16 a[80:83], v[164:167], v[40:43], a[80:83]
    ds_read_b128 v[36:39], v11 offset:13824
    v_mfma_f32_16x16x32_bf16 a[80:83], v[180:183], v[44:47], a[80:83]
    s_waitcnt lgkmcnt(2)
    v_exp_f32 v19, v175
    v_mfma_f32_16x16x32_bf16 a[36:39], v[160:163], v[24:27], a[36:39]
    ds_read_b128 v[40:43], v11 offset:2304
    v_cvt_pk_bf16_f32 v172, v16, v17
    v_mfma_f32_16x16x32_bf16 a[36:39], v[176:179], v[28:31], a[36:39]
    v_exp_f32 v16, v108
    v_mfma_f32_16x16x32_bf16 a[84:87], v[164:167], v[24:27], a[84:87]
    ds_read_b128 v[44:47], v11 offset:14592
    v_add_f32 v8, v8, v18
    v_mfma_f32_16x16x32_bf16 a[84:87], v[180:183], v[28:31], a[84:87]
    s_waitcnt lgkmcnt(2)
    v_add_f32 v8, v8, v19
    v_mfma_f32_16x16x32_bf16 a[40:43], v[160:163], v[32:35], a[40:43]
    ds_read_b128 v[24:27], v1 offset:0
    v_mfma_f32_16x16x32_bf16 a[40:43], v[176:179], v[36:39], a[40:43]
    v_exp_f32 v17, v109
    v_mfma_f32_16x16x32_bf16 a[88:91], v[164:167], v[32:35], a[88:91]
    ds_read_b128 v[28:31], v1 offset:12288
    v_cvt_pk_bf16_f32 v173, v18, v19
    v_mfma_f32_16x16x32_bf16 a[88:91], v[180:183], v[36:39], a[88:91]
    s_waitcnt lgkmcnt(2)
    v_exp_f32 v18, v110
    v_mfma_f32_16x16x32_bf16 a[44:47], v[160:163], v[40:43], a[44:47]
    ds_read_b128 v[32:35], v1 offset:768
    v_add_f32 v8, v8, v16
    v_mfma_f32_16x16x32_bf16 a[44:47], v[176:179], v[44:47], a[44:47]
    v_add_f32 v8, v8, v17
    v_mfma_f32_16x16x32_bf16 a[92:95], v[164:167], v[40:43], a[92:95]
    ds_read_b128 v[36:39], v1 offset:13056
    v_mfma_f32_16x16x32_bf16 a[92:95], v[180:183], v[44:47], a[92:95]
    s_waitcnt lgkmcnt(2)
    v_exp_f32 v19, v111
    v_cvt_pk_bf16_f32 v174, v16, v17
    v_add_f32 v8, v8, v18
    v_add_f32 v8, v8, v19
    v_cvt_pk_bf16_f32 v175, v18, v19
    s_cbranch_vccnz L_slow
    v_mfma_f32_16x16x32_bf16 a[96:99], v[72:75], v[24:27], a[96:99]
    ds_read_b128 v[40:43], v1 offset:1536
    v_mfma_f32_16x16x32_bf16 a[96:99], v[88:91], v[28:31], a[96:99]
    v_exp_f32 v16, v184
    v_exp_f32 v17, v185
    v_exp_f32 v18, v186
    v_add_f32 v7, v7, v16
    v_add_f32 v7, v7, v17
    v_mfma_f32_16x16x32_bf16 a[144:147], v[76:79], v[24:27], a[144:147]
    ds_read_b128 v[44:47], v1 offset:13824
    v_mfma_f32_16x16x32_bf16 a[144:147], v[92:95], v[28:31], a[144:147]
    s_waitcnt lgkmcnt(2)
    v_exp_f32 v19, v187
    v_cvt_pk_bf16_f32 v184, v16, v17
    v_exp_f32 v16, v120
    v_add_f32 v7, v7, v18
    v_add_f32 v7, v7, v19
    v_exp_f32 v17, v121
    v_mfma_f32_16x16x32_bf16 a[100:103], v[72:75], v[32:35], a[100:103]
    ds_read_b128 v[24:27], v1 offset:2304
    v_cvt_pk_bf16_f32 v185, v18, v19
    v_mfma_f32_16x16x32_bf16 a[100:103], v[88:91], v[36:39], a[100:103]
    v_exp_f32 v18, v122
    v_add_f32 v7, v7, v16
    v_add_f32 v7, v7, v17
    v_exp_f32 v19, v123
    v_cvt_pk_bf16_f32 v186, v16, v17
    v_exp_f32 v16, v188
    v_mfma_f32_16x16x32_bf16 a[148:151], v[76:79], v[32:35], a[148:151]
    ds_read_b128 v[28:31], v1 offset:14592
    v_add_f32 v7, v7, v18
    v_mfma_f32_16x16x32_bf16 a[148:151], v[92:95], v[36:39], a[148:151]
    s_waitcnt lgkmcnt(2)
    v_add_f32 v7, v7, v19
    v_exp_f32 v17, v189
    v_cvt_pk_bf16_f32 v187, v18, v19
    v_exp_f32 v18, v190
    v_add_f32 v8, v8, v16
    v_add_f32 v8, v8, v17
    v_mfma_f32_16x16x32_bf16 a[104:107], v[72:75], v[40:43], a[104:107]
    ds_read_b128 v[32:35], v21 offset:0
    v_mfma_f32_16x16x32_bf16 a[104:107], v[88:91], v[44:47], a[104:107]
    v_exp_f32 v19, v191
    v_cvt_pk_bf16_f32 v188, v16, v17
    v_exp_f32 v16, v124
    v_add_f32 v8, v8, v18
    v_add_f32 v8, v8, v19
    v_exp_f32 v17, v125
    v_mfma_f32_16x16x32_bf16 a[152:155], v[76:79], v[40:43], a[152:155]
    ds_read_b128 v[36:39], v21 offset:12288
    v_cvt_pk_bf16_f32 v189, v18, v19
    v_mfma_f32_16x16x32_bf16 a[152:155], v[92:95], v[44:47], a[152:155]
    s_waitcnt lgkmcnt(2)
    v_exp_f32 v18, v126
    v_add_f32 v8, v8, v16
    v_add_f32 v8, v8, v17
    v_exp_f32 v19, v127
    v_cvt_pk_bf16_f32 v190, v16, v17
    v_add_f32 v8, v8, v18
    v_add_f32 v8, v8, v19
    v_mfma_f32_16x16x32_bf16 a[108:111], v[72:75], v[24:27], a[108:111]
    ds_read_b128 v[40:43], v21 offset:768
    v_cvt_pk_bf16_f32 v191, v18, v19
    v_mfma_f32_16x16x32_bf16 a[108:111], v[88:91], v[28:31], a[108:111]
    v_max_f32 v20, v7, v8
    v_cmp_lt_f32 vcc, s29, v20
    v_mov_b32 v20, v5
    v_mov_b32 v23, v6
    s_nop 0
    v_permlane16_swap_b32 v5, v20
    v_permlane16_swap_b32 v6, v23
    s_nop 0
    v_add_f32 v5, v5, v20
    v_mfma_f32_16x16x32_bf16 a[156:159], v[76:79], v[24:27], a[156:159]
    ds_read_b128 v[44:47], v21 offset:13056
    v_add_f32 v6, v6, v23
    v_mfma_f32_16x16x32_bf16 a[156:159], v[92:95], v[28:31], a[156:159]
    s_waitcnt lgkmcnt(2)
    v_mov_b32 v20, v5
    v_mov_b32 v23, v6
    s_nop 0
    v_permlane32_swap_b32 v5, v20
    v_permlane32_swap_b32 v6, v23
    s_nop 0
    v_add_f32 v5, v5, v20
    v_add_f32 v6, v6, v23
    v_rcp_f32 v20, v5
    v_mfma_f32_16x16x32_bf16 a[112:115], v[72:75], v[32:35], a[112:115]
    ds_read_b128 v[24:27], v21 offset:1536
    v_rcp_f32 v23, v6
    v_mfma_f32_16x16x32_bf16 a[112:115], v[88:91], v[36:39], a[112:115]
    s_nop 0
    ds_bpermute_b32 v48, v62, v20 offset:0
    ds_bpermute_b32 v49, v62, v20 offset:4
    ds_bpermute_b32 v50, v62, v20 offset:8
    ds_bpermute_b32 v51, v62, v20 offset:12
    ds_bpermute_b32 v52, v62, v23 offset:0
    ds_bpermute_b32 v53, v62, v23 offset:4
    ds_bpermute_b32 v54, v62, v23 offset:8
    ds_bpermute_b32 v55, v62, v23 offset:12
    s_waitcnt lgkmcnt(4)
    v_mfma_f32_16x16x32_bf16 a[160:163], v[76:79], v[32:35], a[160:163]
    ds_read_b128 v[28:31], v21 offset:13824
    v_accvgpr_read_b32 v224, a0
    v_mfma_f32_16x16x32_bf16 a[160:163], v[92:95], v[36:39], a[160:163]
    s_nop 0
    v_accvgpr_read_b32 v225, a4
    v_accvgpr_read_b32 v226, a8
    v_accvgpr_read_b32 v227, a12
    v_accvgpr_read_b32 v228, a16
    v_accvgpr_read_b32 v229, a20
    v_accvgpr_read_b32 v230, a24
    v_accvgpr_read_b32 v231, a28
    v_accvgpr_read_b32 v232, a32
    v_accvgpr_read_b32 v233, a36
    v_mfma_f32_16x16x32_bf16 a[116:119], v[72:75], v[40:43], a[116:119]
    ds_read_b128 v[32:35], v21 offset:2304
    v_accvgpr_read_b32 v234, a40
    v_mfma_f32_16x16x32_bf16 a[116:119], v[88:91], v[44:47], a[116:119]
    v_accvgpr_read_b32 v235, a44
    v_mul_f32 v224, v224, v48
    v_mul_f32 v225, v225, v48
    v_mul_f32 v226, v226, v48
    v_mul_f32 v227, v227, v48
    v_mul_f32 v228, v228, v48
    v_mul_f32 v229, v229, v48
    v_mul_f32 v230, v230, v48
    v_mul_f32 v231, v231, v48
    v_mfma_f32_16x16x32_bf16 a[164:167], v[76:79], v[40:43], a[164:167]
    ds_read_b128 v[36:39], v21 offset:14592
    v_mul_f32 v232, v232, v48
    v_mfma_f32_16x16x32_bf16 a[164:167], v[92:95], v[44:47], a[164:167]
    s_waitcnt lgkmcnt(2)
    v_mul_f32 v233, v233, v48
    v_mul_f32 v234, v234, v48
    v_mul_f32 v235, v235, v48
    v_cvt_pk_bf16_f32 v224, v224, v225
    v_cvt_pk_bf16_f32 v225, v226, v227
    v_cvt_pk_bf16_f32 v226, v228, v229
    v_cvt_pk_bf16_f32 v227, v230, v231
    v_cvt_pk_bf16_f32 v228, v232, v233
    v_cvt_pk_bf16_f32 v229, v234, v235
    v_mfma_f32_16x16x32_bf16 a[120:123], v[72:75], v[24:27], a[120:123]
    ds_read_b128 v[40:43], v22 offset:0
    v_mfma_f32_16x16x32_bf16 a[120:123], v[88:91], v[28:31], a[120:123]
    buffer_store_dwordx4 v[224:227], v60, s[12:15], s33 offen offset:0 sc0 sc1
    buffer_store_dwordx2 v[228:229], v61, s[12:15], s33 offen offset:256 sc0 sc1
    v_accvgpr_read_b32 v236, a1
    v_mfma_f32_16x16x32_bf16 a[168:171], v[76:79], v[24:27], a[168:171]
    ds_read_b128 v[44:47], v22 offset:12288
    v_accvgpr_read_b32 v237, a5
    v_mfma_f32_16x16x32_bf16 a[168:171], v[92:95], v[28:31], a[168:171]
    s_waitcnt lgkmcnt(2)
    v_accvgpr_read_b32 v238, a9
    v_accvgpr_read_b32 v239, a13
    v_accvgpr_read_b32 v240, a17
    v_accvgpr_read_b32 v241, a21
    v_accvgpr_read_b32 v242, a25
    v_accvgpr_read_b32 v243, a29
    v_accvgpr_read_b32 v244, a33
    v_accvgpr_read_b32 v245, a37
    v_accvgpr_read_b32 v246, a41
    v_mfma_f32_16x16x32_bf16 a[124:127], v[72:75], v[32:35], a[124:127]
    ds_read_b128 v[24:27], v22 offset:768
    v_accvgpr_read_b32 v247, a45
    v_mfma_f32_16x16x32_bf16 a[124:127], v[88:91], v[36:39], a[124:127]
    v_mul_f32 v236, v236, v49
    v_mul_f32 v237, v237, v49
    v_mul_f32 v238, v238, v49
    v_mul_f32 v239, v239, v49
    v_mul_f32 v240, v240, v49
    v_mul_f32 v241, v241, v49
    v_mul_f32 v242, v242, v49
    v_mul_f32 v243, v243, v49
    v_mul_f32 v244, v244, v49
    v_mfma_f32_16x16x32_bf16 a[172:175], v[76:79], v[32:35], a[172:175]
    ds_read_b128 v[28:31], v22 offset:13056
    v_mul_f32 v245, v245, v49
    v_mfma_f32_16x16x32_bf16 a[172:175], v[92:95], v[36:39], a[172:175]
    s_waitcnt lgkmcnt(2)
    v_mul_f32 v246, v246, v49
    v_mul_f32 v247, v247, v49
    v_cvt_pk_bf16_f32 v236, v236, v237
    v_cvt_pk_bf16_f32 v237, v238, v239
    v_cvt_pk_bf16_f32 v238, v240, v241
    v_cvt_pk_bf16_f32 v239, v242, v243
    v_cvt_pk_bf16_f32 v240, v244, v245
    v_cvt_pk_bf16_f32 v241, v246, v247
    v_mfma_f32_16x16x32_bf16 a[128:131], v[72:75], v[40:43], a[128:131]
    ds_read_b128 v[32:35], v22 offset:1536
    v_mfma_f32_16x16x32_bf16 a[128:131], v[88:91], v[44:47], a[128:131]
    buffer_store_dwordx4 v[236:239], v60, s[12:15], s33 offen offset:384 sc0 sc1
    buffer_store_dwordx2 v[240:241], v61, s[12:15], s33 offen offset:640 sc0 sc1
    v_accvgpr_read_b32 v144, a2
    v_mfma_f32_16x16x32_bf16 a[176:179], v[76:79], v[40:43], a[176:179]
    ds_read_b128 v[36:39], v22 offset:13824
    v_accvgpr_read_b32 v145, a6
    v_mfma_f32_16x16x32_bf16 a[176:179], v[92:95], v[44:47], a[176:179]
    s_waitcnt lgkmcnt(2)
    v_accvgpr_read_b32 v146, a10
    v_accvgpr_read_b32 v147, a14
    v_accvgpr_read_b32 v148, a18
    v_accvgpr_read_b32 v149, a22
    v_accvgpr_read_b32 v150, a26
    v_accvgpr_read_b32 v151, a30
    v_accvgpr_read_b32 v152, a34
    v_accvgpr_read_b32 v153, a38
    v_accvgpr_read_b32 v154, a42
    v_mfma_f32_16x16x32_bf16 a[132:135], v[72:75], v[24:27], a[132:135]
    ds_read_b128 v[40:43], v22 offset:2304
    v_accvgpr_read_b32 v155, a46
    v_mfma_f32_16x16x32_bf16 a[132:135], v[88:91], v[28:31], a[132:135]
    v_mul_f32 v144, v144, v50
    v_mul_f32 v145, v145, v50
    v_mul_f32 v146, v146, v50
    v_mul_f32 v147, v147, v50
    v_mul_f32 v148, v148, v50
    v_mul_f32 v149, v149, v50
    v_mul_f32 v150, v150, v50
    v_mul_f32 v151, v151, v50
    v_mul_f32 v152, v152, v50
    v_mfma_f32_16x16x32_bf16 a[180:183], v[76:79], v[24:27], a[180:183]
    ds_read_b128 v[44:47], v22 offset:14592
    v_mul_f32 v153, v153, v50
    v_mfma_f32_16x16x32_bf16 a[180:183], v[92:95], v[28:31], a[180:183]
    s_waitcnt lgkmcnt(2)
    v_mul_f32 v154, v154, v50
    v_mul_f32 v155, v155, v50
    v_cvt_pk_bf16_f32 v144, v144, v145
    v_cvt_pk_bf16_f32 v145, v146, v147
    v_cvt_pk_bf16_f32 v146, v148, v149
    v_cvt_pk_bf16_f32 v147, v150, v151
    v_cvt_pk_bf16_f32 v148, v152, v153
    v_cvt_pk_bf16_f32 v149, v154, v155
    v_mfma_f32_16x16x32_bf16 a[136:139], v[72:75], v[32:35], a[136:139]
    ds_read_b128 v[24:27], v9 offset:0
    v_mfma_f32_16x16x32_bf16 a[136:139], v[88:91], v[36:39], a[136:139]
    buffer_store_dwordx4 v[144:147], v60, s[12:15], s33 offen offset:768 sc0 sc1
    buffer_store_dwordx2 v[148:149], v61, s[12:15], s33 offen offset:1024 sc0 sc1
    v_accvgpr_read_b32 v132, a3
    v_mfma_f32_16x16x32_bf16 a[184:187], v[76:79], v[32:35], a[184:187]
    ds_read_b128 v[28:31], v9 offset:12288
    v_accvgpr_read_b32 v133, a7
    v_mfma_f32_16x16x32_bf16 a[184:187], v[92:95], v[36:39], a[184:187]
    s_waitcnt lgkmcnt(2)
    v_accvgpr_read_b32 v134, a11
    v_accvgpr_read_b32 v135, a15
    v_accvgpr_read_b32 v136, a19
    v_accvgpr_read_b32 v137, a23
    v_accvgpr_read_b32 v138, a27
    v_accvgpr_read_b32 v139, a31
    v_accvgpr_read_b32 v140, a35
    v_accvgpr_read_b32 v141, a39
    v_accvgpr_read_b32 v142, a43
    v_mfma_f32_16x16x32_bf16 a[140:143], v[72:75], v[40:43], a[140:143]
    ds_read_b128 v[32:35], v9 offset:768
    v_accvgpr_read_b32 v143, a47
    v_mfma_f32_16x16x32_bf16 a[140:143], v[88:91], v[44:47], a[140:143]
    v_mul_f32 v132, v132, v51
    v_mul_f32 v133, v133, v51
    v_mul_f32 v134, v134, v51
    v_mul_f32 v135, v135, v51
    v_mul_f32 v136, v136, v51
    v_mul_f32 v137, v137, v51
    v_mul_f32 v138, v138, v51
    v_mul_f32 v139, v139, v51
    v_mul_f32 v140, v140, v51
    v_mfma_f32_16x16x32_bf16 a[188:191], v[76:79], v[40:43], a[188:191]
    ds_read_b128 v[36:39], v9 offset:13056
    v_mul_f32 v141, v141, v51
    v_mfma_f32_16x16x32_bf16 a[188:191], v[92:95], v[44:47], a[188:191]
    s_waitcnt lgkmcnt(2)
    v_mul_f32 v142, v142, v51
    v_mul_f32 v143, v143, v51
    v_cvt_pk_bf16_f32 v132, v132, v133
    v_cvt_pk_bf16_f32 v133, v134, v135
    v_cvt_pk_bf16_f32 v134, v136, v137
    v_cvt_pk_bf16_f32 v135, v138, v139
    v_cvt_pk_bf16_f32 v136, v140, v141
    v_cvt_pk_bf16_f32 v137, v142, v143
    s_nop 1
    s_cbranch_vccnz L_slow
    v_mfma_f32_16x16x32_bf16 a[96:99], v[168:171], v[24:27], a[96:99]
    ds_read_b128 v[40:43], v9 offset:1536
    v_mfma_f32_16x16x32_bf16 a[96:99], v[184:187], v[28:31], a[96:99]
    buffer_store_dwordx4 v[132:135], v60, s[12:15], s33 offen offset:1152 sc0 sc1
    buffer_store_dwordx2 v[136:137], v61, s[12:15], s33 offen offset:1408 sc0 sc1
    s_nop 0
    v_mfma_f32_16x16x32_bf16 a[144:147], v[172:175], v[24:27], a[144:147]
    ds_read_b128 v[44:47], v9 offset:13824
    v_accvgpr_read_b32 v224, a48
    v_mfma_f32_16x16x32_bf16 a[144:147], v[188:191], v[28:31], a[144:147]
    s_waitcnt lgkmcnt(2)
    v_accvgpr_read_b32 v225, a52
    v_accvgpr_read_b32 v226, a56
    v_accvgpr_read_b32 v227, a60
    v_accvgpr_read_b32 v228, a64
    v_accvgpr_read_b32 v229, a68
    v_accvgpr_read_b32 v230, a72
    v_accvgpr_read_b32 v231, a76
    v_accvgpr_read_b32 v232, a80
    v_accvgpr_read_b32 v233, a84
    v_mfma_f32_16x16x32_bf16 a[100:103], v[168:171], v[32:35], a[100:103]
    ds_read_b128 v[24:27], v9 offset:2304
    v_accvgpr_read_b32 v234, a88
    v_mfma_f32_16x16x32_bf16 a[100:103], v[184:187], v[36:39], a[100:103]
    v_accvgpr_read_b32 v235, a92
    v_mul_f32 v224, v224, v52
    v_mul_f32 v225, v225, v52
    v_mul_f32 v226, v226, v52
    v_mul_f32 v227, v227, v52
    v_mul_f32 v228, v228, v52
    v_mul_f32 v229, v229, v52
    v_mul_f32 v230, v230, v52
    v_mul_f32 v231, v231, v52
    v_mfma_f32_16x16x32_bf16 a[148:151], v[172:175], v[32:35], a[148:151]
    ds_read_b128 v[28:31], v9 offset:14592
    v_mul_f32 v232, v232, v52
    v_mfma_f32_16x16x32_bf16 a[148:151], v[188:191], v[36:39], a[148:151]
    s_waitcnt lgkmcnt(2)
    v_mul_f32 v233, v233, v52
    v_mul_f32 v234, v234, v52
    v_mul_f32 v235, v235, v52
    v_cvt_pk_bf16_f32 v224, v224, v225
    v_cvt_pk_bf16_f32 v225, v226, v227
    v_cvt_pk_bf16_f32 v226, v228, v229
    v_cvt_pk_bf16_f32 v227, v230, v231
    v_cvt_pk_bf16_f32 v228, v232, v233
    v_cvt_pk_bf16_f32 v229, v234, v235
    v_mfma_f32_16x16x32_bf16 a[104:107], v[168:171], v[40:43], a[104:107]
    ds_read_b128 v[32:35], v10 offset:0
    v_mfma_f32_16x16x32_bf16 a[104:107], v[184:187], v[44:47], a[104:107]
    buffer_store_dwordx4 v[224:227], v60, s[12:15], s34 offen offset:0 sc0 sc1
    buffer_store_dwordx2 v[228:229], v61, s[12:15], s34 offen offset:256 sc0 sc1
    v_accvgpr_read_b32 v236, a49
    v_mfma_f32_16x16x32_bf16 a[152:155], v[172:175], v[40:43], a[152:155]
    ds_read_b128 v[36:39], v10 offset:12288
    v_accvgpr_read_b32 v237, a53
    v_mfma_f32_16x16x32_bf16 a[152:155], v[188:191], v[44:47], a[152:155]
    s_waitcnt lgkmcnt(2)
    v_accvgpr_read_b32 v238, a57
    v_accvgpr_read_b32 v239, a61
    v_accvgpr_read_b32 v240, a65
    v_accvgpr_read_b32 v241, a69
    v_accvgpr_read_b32 v242, a73
    v_accvgpr_read_b32 v243, a77
    v_accvgpr_read_b32 v244, a81
    v_accvgpr_read_b32 v245, a85
    v_accvgpr_read_b32 v246, a89
    v_mfma_f32_16x16x32_bf16 a[108:111], v[168:171], v[24:27], a[108:111]
    ds_read_b128 v[40:43], v10 offset:768
    v_accvgpr_read_b32 v247, a93
    v_mfma_f32_16x16x32_bf16 a[108:111], v[184:187], v[28:31], a[108:111]
    v_mul_f32 v236, v236, v53
    v_mul_f32 v237, v237, v53
    v_mul_f32 v238, v238, v53
    v_mul_f32 v239, v239, v53
    v_mul_f32 v240, v240, v53
    v_mul_f32 v241, v241, v53
    v_mul_f32 v242, v242, v53
    v_mul_f32 v243, v243, v53
    v_mul_f32 v244, v244, v53
    v_mfma_f32_16x16x32_bf16 a[156:159], v[172:175], v[24:27], a[156:159]
    ds_read_b128 v[44:47], v10 offset:13056
    v_mul_f32 v245, v245, v53
    v_mfma_f32_16x16x32_bf16 a[156:159], v[188:191], v[28:31], a[156:159]
    s_waitcnt lgkmcnt(2)
    v_mul_f32 v246, v246, v53
    v_mul_f32 v247, v247, v53
    v_cvt_pk_bf16_f32 v236, v236, v237
    v_cvt_pk_bf16_f32 v237, v238, v239
    v_cvt_pk_bf16_f32 v238, v240, v241
    v_cvt_pk_bf16_f32 v239, v242, v243
    v_cvt_pk_bf16_f32 v240, v244, v245
    v_cvt_pk_bf16_f32 v241, v246, v247
    v_mfma_f32_16x16x32_bf16 a[112:115], v[168:171], v[32:35], a[112:115]
    ds_read_b128 v[24:27], v10 offset:1536
    v_mfma_f32_16x16x32_bf16 a[112:115], v[184:187], v[36:39], a[112:115]
    buffer_store_dwordx4 v[236:239], v60, s[12:15], s34 offen offset:384 sc0 sc1
    buffer_store_dwordx2 v[240:241], v61, s[12:15], s34 offen offset:640 sc0 sc1
    v_accvgpr_read_b32 v144, a50
    v_mfma_f32_16x16x32_bf16 a[160:163], v[172:175], v[32:35], a[160:163]
    ds_read_b128 v[28:31], v10 offset:13824
    v_accvgpr_read_b32 v145, a54
    v_mfma_f32_16x16x32_bf16 a[160:163], v[188:191], v[36:39], a[160:163]
    s_waitcnt lgkmcnt(2)
    v_accvgpr_read_b32 v146, a58
    v_accvgpr_read_b32 v147, a62
    v_accvgpr_read_b32 v148, a66
    v_accvgpr_read_b32 v149, a70
    v_accvgpr_read_b32 v150, a74
    v_accvgpr_read_b32 v151, a78
    v_accvgpr_read_b32 v152, a82
    v_accvgpr_read_b32 v153, a86
    v_accvgpr_read_b32 v154, a90
    v_mfma_f32_16x16x32_bf16 a[116:119], v[168:171], v[40:43], a[116:119]
    ds_read_b128 v[32:35], v10 offset:2304
    v_accvgpr_read_b32 v155, a94
    v_mfma_f32_16x16x32_bf16 a[116:119], v[184:187], v[44:47], a[116:119]
    v_mul_f32 v144, v144, v54
    v_mul_f32 v145, v145, v54
    v_mul_f32 v146, v146, v54
    v_mul_f32 v147, v147, v54
    v_mul_f32 v148, v148, v54
    v_mul_f32 v149, v149, v54
    v_mul_f32 v150, v150, v54
    v_mul_f32 v151, v151, v54
    v_mul_f32 v152, v152, v54
    v_mfma_f32_16x16x32_bf16 a[164:167], v[172:175], v[40:43], a[164:167]
    ds_read_b128 v[36:39], v10 offset:14592
    v_mul_f32 v153, v153, v54
    v_mfma_f32_16x16x32_bf16 a[164:167], v[188:191], v[44:47], a[164:167]
    s_waitcnt lgkmcnt(2)
    v_mul_f32 v154, v154, v54
    v_mul_f32 v155, v155, v54
    v_cvt_pk_bf16_f32 v144, v144, v145
    v_cvt_pk_bf16_f32 v145, v146, v147
    v_cvt_pk_bf16_f32 v146, v148, v149
    v_cvt_pk_bf16_f32 v147, v150, v151
    v_cvt_pk_bf16_f32 v148, v152, v153
    v_cvt_pk_bf16_f32 v149, v154, v155
    v_mfma_f32_16x16x32_bf16 a[120:123], v[168:171], v[24:27], a[120:123]
    ds_read_b128 v[40:43], v11 offset:0
    v_mfma_f32_16x16x32_bf16 a[120:123], v[184:187], v[28:31], a[120:123]
    buffer_store_dwordx4 v[144:147], v60, s[12:15], s34 offen offset:768 sc0 sc1
    buffer_store_dwordx2 v[148:149], v61, s[12:15], s34 offen offset:1024 sc0 sc1
    v_accvgpr_read_b32 v132, a51
    v_mfma_f32_16x16x32_bf16 a[168:171], v[172:175], v[24:27], a[168:171]
    ds_read_b128 v[44:47], v11 offset:12288
    v_accvgpr_read_b32 v133, a55
    v_mfma_f32_16x16x32_bf16 a[168:171], v[188:191], v[28:31], a[168:171]
    s_waitcnt lgkmcnt(2)
    v_accvgpr_read_b32 v134, a59
    v_accvgpr_read_b32 v135, a63
    v_accvgpr_read_b32 v136, a67
    v_accvgpr_read_b32 v137, a71
    v_accvgpr_read_b32 v138, a75
    v_accvgpr_read_b32 v139, a79
    v_accvgpr_read_b32 v140, a83
    v_accvgpr_read_b32 v141, a87
    v_accvgpr_read_b32 v142, a91
    v_mfma_f32_16x16x32_bf16 a[124:127], v[168:171], v[32:35], a[124:127]
    ds_read_b128 v[24:27], v11 offset:768
    v_accvgpr_read_b32 v143, a95
    v_mfma_f32_16x16x32_bf16 a[124:127], v[184:187], v[36:39], a[124:127]
    v_mul_f32 v132, v132, v55
    v_mul_f32 v133, v133, v55
    v_mul_f32 v134, v134, v55
    v_mul_f32 v135, v135, v55
    v_mul_f32 v136, v136, v55
    v_mul_f32 v137, v137, v55
    v_mul_f32 v138, v138, v55
    v_mul_f32 v139, v139, v55
    v_mul_f32 v140, v140, v55
    v_mfma_f32_16x16x32_bf16 a[172:175], v[172:175], v[32:35], a[172:175]
    ds_read_b128 v[28:31], v11 offset:13056
    v_mul_f32 v141, v141, v55
    v_mfma_f32_16x16x32_bf16 a[172:175], v[188:191], v[36:39], a[172:175]
    s_waitcnt lgkmcnt(2)
    v_mul_f32 v142, v142, v55
    v_mul_f32 v143, v143, v55
    v_cvt_pk_bf16_f32 v132, v132, v133
    v_cvt_pk_bf16_f32 v133, v134, v135
    v_cvt_pk_bf16_f32 v134, v136, v137
    v_cvt_pk_bf16_f32 v135, v138, v139
    v_cvt_pk_bf16_f32 v136, v140, v141
    v_cvt_pk_bf16_f32 v137, v142, v143
    v_mfma_f32_16x16x32_bf16 a[128:131], v[168:171], v[40:43], a[128:131]
    ds_read_b128 v[32:35], v11 offset:1536
    v_mfma_f32_16x16x32_bf16 a[128:131], v[184:187], v[44:47], a[128:131]
    buffer_store_dwordx4 v[132:135], v60, s[12:15], s34 offen offset:1152 sc0 sc1
    buffer_store_dwordx2 v[136:137], v61, s[12:15], s34 offen offset:1408 sc0 sc1
    v_mov_b32 v20, v7
    v_mfma_f32_16x16x32_bf16 a[176:179], v[172:175], v[40:43], a[176:179]
    ds_read_b128 v[36:39], v11 offset:13824
    v_mov_b32 v23, v8
    v_mfma_f32_16x16x32_bf16 a[176:179], v[188:191], v[44:47], a[176:179]
    s_waitcnt lgkmcnt(2)
    s_nop 0
    v_permlane16_swap_b32 v7, v20
    v_permlane16_swap_b32 v8, v23
    s_nop 0
    v_add_f32 v7, v7, v20
    v_add_f32 v8, v8, v23
    v_mov_b32 v20, v7
    v_mov_b32 v23, v8
    s_nop 0
    v_mfma_f32_16x16x32_bf16 a[132:135], v[168:171], v[24:27], a[132:135]
    ds_read_b128 v[40:43], v11 offset:2304
    v_permlane32_swap_b32 v7, v20
    v_mfma_f32_16x16x32_bf16 a[132:135], v[184:187], v[28:31], a[132:135]
    v_permlane32_swap_b32 v8, v23
    s_nop 0
    v_add_f32 v7, v7, v20
    v_add_f32 v8, v8, v23
    v_rcp_f32 v20, v7
    v_rcp_f32 v23, v8
    s_nop 0
    ds_bpermute_b32 v56, v62, v20 offset:0
    ds_bpermute_b32 v57, v62, v20 offset:4
    ds_bpermute_b32 v58, v62, v20 offset:8
    ds_bpermute_b32 v59, v62, v20 offset:12
    ds_bpermute_b32 v128, v62, v23 offset:0
    v_mfma_f32_16x16x32_bf16 a[180:183], v[172:175], v[24:27], a[180:183]
    ds_read_b128 v[44:47], v11 offset:14592
    ds_bpermute_b32 v129, v62, v23 offset:4
    v_mfma_f32_16x16x32_bf16 a[180:183], v[188:191], v[28:31], a[180:183]
    s_waitcnt lgkmcnt(8)
    ds_bpermute_b32 v130, v62, v23 offset:8
    ds_bpermute_b32 v131, v62, v23 offset:12
    v_mfma_f32_16x16x32_bf16 a[136:139], v[168:171], v[32:35], a[136:139]
    v_mfma_f32_16x16x32_bf16 a[136:139], v[184:187], v[36:39], a[136:139]
    v_mfma_f32_16x16x32_bf16 a[184:187], v[172:175], v[32:35], a[184:187]
    v_mfma_f32_16x16x32_bf16 a[184:187], v[188:191], v[36:39], a[184:187]
    s_waitcnt lgkmcnt(3)
    v_mfma_f32_16x16x32_bf16 a[140:143], v[168:171], v[40:43], a[140:143]
    v_mfma_f32_16x16x32_bf16 a[140:143], v[184:187], v[44:47], a[140:143]
    v_mfma_f32_16x16x32_bf16 a[188:191], v[172:175], v[40:43], a[188:191]
    v_mfma_f32_16x16x32_bf16 a[188:191], v[188:191], v[44:47], a[188:191]
    s_nop 4
    s_nop 0
    v_accvgpr_read_b32 v100, a96
    v_accvgpr_read_b32 v101, a100
    v_accvgpr_read_b32 v102, a104
    v_accvgpr_read_b32 v103, a108
    v_accvgpr_read_b32 v104, a112
    v_accvgpr_read_b32 v105, a116
    v_accvgpr_read_b32 v106, a120
    v_accvgpr_read_b32 v107, a124
    v_accvgpr_read_b32 v108, a128
    v_accvgpr_read_b32 v109, a132
    v_accvgpr_read_b32 v110, a136
    v_accvgpr_read_b32 v111, a140
    v_pk_mul_f32 v[100:101], v[100:101], v[56:57] op_sel:[0,0] op_sel_hi:[1,0]
    v_pk_mul_f32 v[102:103], v[102:103], v[56:57] op_sel:[0,0] op_sel_hi:[1,0]
    v_pk_mul_f32 v[104:105], v[104:105], v[56:57] op_sel:[0,0] op_sel_hi:[1,0]
    v_pk_mul_f32 v[106:107], v[106:107], v[56:57] op_sel:[0,0] op_sel_hi:[1,0]
    v_pk_mul_f32 v[108:109], v[108:109], v[56:57] op_sel:[0,0] op_sel_hi:[1,0]
    v_pk_mul_f32 v[110:111], v[110:111], v[56:57] op_sel:[0,0] op_sel_hi:[1,0]
    v_cvt_pk_bf16_f32 v100, v100, v101
    v_cvt_pk_bf16_f32 v101, v102, v103
    v_cvt_pk_bf16_f32 v102, v104, v105
    v_cvt_pk_bf16_f32 v103, v106, v107
    v_cvt_pk_bf16_f32 v104, v108, v109
    v_cvt_pk_bf16_f32 v105, v110, v111
    buffer_store_dwordx4 v[100:103], v60, s[12:15], s35 offen offset:0 sc0 sc1
    buffer_store_dwordx2 v[104:105], v61, s[12:15], s35 offen offset:256 sc0 sc1
    v_accvgpr_read_b32 v112, a97
    v_accvgpr_read_b32 v113, a101
    v_accvgpr_read_b32 v114, a105
    v_accvgpr_read_b32 v115, a109
    v_accvgpr_read_b32 v116, a113
    v_accvgpr_read_b32 v117, a117
    v_accvgpr_read_b32 v118, a121
    v_accvgpr_read_b32 v119, a125
    v_accvgpr_read_b32 v120, a129
    v_accvgpr_read_b32 v121, a133
    v_accvgpr_read_b32 v122, a137
    v_accvgpr_read_b32 v123, a141
    v_pk_mul_f32 v[112:113], v[112:113], v[56:57] op_sel:[0,1] op_sel_hi:[1,1]
    v_pk_mul_f32 v[114:115], v[114:115], v[56:57] op_sel:[0,1] op_sel_hi:[1,1]
    v_pk_mul_f32 v[116:117], v[116:117], v[56:57] op_sel:[0,1] op_sel_hi:[1,1]
    v_pk_mul_f32 v[118:119], v[118:119], v[56:57] op_sel:[0,1] op_sel_hi:[1,1]
    v_pk_mul_f32 v[120:121], v[120:121], v[56:57] op_sel:[0,1] op_sel_hi:[1,1]
    v_pk_mul_f32 v[122:123], v[122:123], v[56:57] op_sel:[0,1] op_sel_hi:[1,1]
    v_cvt_pk_bf16_f32 v112, v112, v113
    v_cvt_pk_bf16_f32 v113, v114, v115
    v_cvt_pk_bf16_f32 v114, v116, v117
    v_cvt_pk_bf16_f32 v115, v118, v119
    v_cvt_pk_bf16_f32 v116, v120, v121
    v_cvt_pk_bf16_f32 v117, v122, v123
    buffer_store_dwordx4 v[112:115], v60, s[12:15], s35 offen offset:384 sc0 sc1
    buffer_store_dwordx2 v[116:117], v61, s[12:15], s35 offen offset:640 sc0 sc1
    v_accvgpr_read_b32 v64, a98
    v_accvgpr_read_b32 v65, a102
    v_accvgpr_read_b32 v66, a106
    v_accvgpr_read_b32 v67, a110
    v_accvgpr_read_b32 v68, a114
    v_accvgpr_read_b32 v69, a118
    v_accvgpr_read_b32 v70, a122
    v_accvgpr_read_b32 v71, a126
    v_accvgpr_read_b32 v72, a130
    v_accvgpr_read_b32 v73, a134
    v_accvgpr_read_b32 v74, a138
    v_accvgpr_read_b32 v75, a142
    v_pk_mul_f32 v[64:65], v[64:65], v[58:59] op_sel:[0,0] op_sel_hi:[1,0]
    v_pk_mul_f32 v[66:67], v[66:67], v[58:59] op_sel:[0,0] op_sel_hi:[1,0]
    v_pk_mul_f32 v[68:69], v[68:69], v[58:59] op_sel:[0,0] op_sel_hi:[1,0]
    v_pk_mul_f32 v[70:71], v[70:71], v[58:59] op_sel:[0,0] op_sel_hi:[1,0]
    v_pk_mul_f32 v[72:73], v[72:73], v[58:59] op_sel:[0,0] op_sel_hi:[1,0]
    v_pk_mul_f32 v[74:75], v[74:75], v[58:59] op_sel:[0,0] op_sel_hi:[1,0]
    v_cvt_pk_bf16_f32 v64, v64, v65
    v_cvt_pk_bf16_f32 v65, v66, v67
    v_cvt_pk_bf16_f32 v66, v68, v69
    v_cvt_pk_bf16_f32 v67, v70, v71
    v_cvt_pk_bf16_f32 v68, v72, v73
    v_cvt_pk_bf16_f32 v69, v74, v75
    buffer_store_dwordx4 v[64:67], v60, s[12:15], s35 offen offset:768 sc0 sc1
    buffer_store_dwordx2 v[68:69], v61, s[12:15], s35 offen offset:1024 sc0 sc1
    v_accvgpr_read_b32 v76, a99
    v_accvgpr_read_b32 v77, a103
    v_accvgpr_read_b32 v78, a107
    v_accvgpr_read_b32 v79, a111
    v_accvgpr_read_b32 v80, a115
    v_accvgpr_read_b32 v81, a119
    v_accvgpr_read_b32 v82, a123
    v_accvgpr_read_b32 v83, a127
    v_accvgpr_read_b32 v84, a131
    v_accvgpr_read_b32 v85, a135
    v_accvgpr_read_b32 v86, a139
    v_accvgpr_read_b32 v87, a143
    v_pk_mul_f32 v[76:77], v[76:77], v[58:59] op_sel:[0,1] op_sel_hi:[1,1]
    v_pk_mul_f32 v[78:79], v[78:79], v[58:59] op_sel:[0,1] op_sel_hi:[1,1]
    v_pk_mul_f32 v[80:81], v[80:81], v[58:59] op_sel:[0,1] op_sel_hi:[1,1]
    v_pk_mul_f32 v[82:83], v[82:83], v[58:59] op_sel:[0,1] op_sel_hi:[1,1]
    v_pk_mul_f32 v[84:85], v[84:85], v[58:59] op_sel:[0,1] op_sel_hi:[1,1]
    v_pk_mul_f32 v[86:87], v[86:87], v[58:59] op_sel:[0,1] op_sel_hi:[1,1]
    v_cvt_pk_bf16_f32 v76, v76, v77
    v_cvt_pk_bf16_f32 v77, v78, v79
    v_cvt_pk_bf16_f32 v78, v80, v81
    v_cvt_pk_bf16_f32 v79, v82, v83
    v_cvt_pk_bf16_f32 v80, v84, v85
    v_cvt_pk_bf16_f32 v81, v86, v87
    buffer_store_dwordx4 v[76:79], v60, s[12:15], s35 offen offset:1152 sc0 sc1
    buffer_store_dwordx2 v[80:81], v61, s[12:15], s35 offen offset:1408 sc0 sc1
    s_waitcnt lgkmcnt(0)
    v_accvgpr_read_b32 v88, a144
    v_accvgpr_read_b32 v89, a148
    v_accvgpr_read_b32 v90, a152
    v_accvgpr_read_b32 v91, a156
    v_accvgpr_read_b32 v92, a160
    v_accvgpr_read_b32 v93, a164
    v_accvgpr_read_b32 v94, a168
    v_accvgpr_read_b32 v95, a172
    v_accvgpr_read_b32 v96, a176
    v_accvgpr_read_b32 v97, a180
    v_accvgpr_read_b32 v98, a184
    v_accvgpr_read_b32 v99, a188
    v_pk_mul_f32 v[88:89], v[88:89], v[128:129] op_sel:[0,0] op_sel_hi:[1,0]
    v_pk_mul_f32 v[90:91], v[90:91], v[128:129] op_sel:[0,0] op_sel_hi:[1,0]
    v_pk_mul_f32 v[92:93], v[92:93], v[128:129] op_sel:[0,0] op_sel_hi:[1,0]
    v_pk_mul_f32 v[94:95], v[94:95], v[128:129] op_sel:[0,0] op_sel_hi:[1,0]
    v_pk_mul_f32 v[96:97], v[96:97], v[128:129] op_sel:[0,0] op_sel_hi:[1,0]
    v_pk_mul_f32 v[98:99], v[98:99], v[128:129] op_sel:[0,0] op_sel_hi:[1,0]
    v_cvt_pk_bf16_f32 v88, v88, v89
    v_cvt_pk_bf16_f32 v89, v90, v91
    v_cvt_pk_bf16_f32 v90, v92, v93
    v_cvt_pk_bf16_f32 v91, v94, v95
    v_cvt_pk_bf16_f32 v92, v96, v97
    v_cvt_pk_bf16_f32 v93, v98, v99
    buffer_store_dwordx4 v[88:91], v60, s[12:15], s36 offen offset:0 sc0 sc1
    buffer_store_dwordx2 v[92:93], v61, s[12:15], s36 offen offset:256 sc0 sc1
    v_accvgpr_read_b32 v100, a145
    v_accvgpr_read_b32 v101, a149
    v_accvgpr_read_b32 v102, a153
    v_accvgpr_read_b32 v103, a157
    v_accvgpr_read_b32 v104, a161
    v_accvgpr_read_b32 v105, a165
    v_accvgpr_read_b32 v106, a169
    v_accvgpr_read_b32 v107, a173
    v_accvgpr_read_b32 v108, a177
    v_accvgpr_read_b32 v109, a181
    v_accvgpr_read_b32 v110, a185
    v_accvgpr_read_b32 v111, a189
    v_pk_mul_f32 v[100:101], v[100:101], v[128:129] op_sel:[0,1] op_sel_hi:[1,1]
    v_pk_mul_f32 v[102:103], v[102:103], v[128:129] op_sel:[0,1] op_sel_hi:[1,1]
    v_pk_mul_f32 v[104:105], v[104:105], v[128:129] op_sel:[0,1] op_sel_hi:[1,1]
    v_pk_mul_f32 v[106:107], v[106:107], v[128:129] op_sel:[0,1] op_sel_hi:[1,1]
    v_pk_mul_f32 v[108:109], v[108:109], v[128:129] op_sel:[0,1] op_sel_hi:[1,1]
    v_pk_mul_f32 v[110:111], v[110:111], v[128:129] op_sel:[0,1] op_sel_hi:[1,1]
    v_cvt_pk_bf16_f32 v100, v100, v101
    v_cvt_pk_bf16_f32 v101, v102, v103
    v_cvt_pk_bf16_f32 v102, v104, v105
    v_cvt_pk_bf16_f32 v103, v106, v107
    v_cvt_pk_bf16_f32 v104, v108, v109
    v_cvt_pk_bf16_f32 v105, v110, v111
    buffer_store_dwordx4 v[100:103], v60, s[12:15], s36 offen offset:384 sc0 sc1
    buffer_store_dwordx2 v[104:105], v61, s[12:15], s36 offen offset:640 sc0 sc1
    v_accvgpr_read_b32 v112, a146
    v_accvgpr_read_b32 v113, a150
    v_accvgpr_read_b32 v114, a154
    v_accvgpr_read_b32 v115, a158
    v_accvgpr_read_b32 v116, a162
    v_accvgpr_read_b32 v117, a166
    v_accvgpr_read_b32 v118, a170
    v_accvgpr_read_b32 v119, a174
    v_accvgpr_read_b32 v120, a178
    v_accvgpr_read_b32 v121, a182
    v_accvgpr_read_b32 v122, a186
    v_accvgpr_read_b32 v123, a190
    v_pk_mul_f32 v[112:113], v[112:113], v[130:131] op_sel:[0,0] op_sel_hi:[1,0]
    v_pk_mul_f32 v[114:115], v[114:115], v[130:131] op_sel:[0,0] op_sel_hi:[1,0]
    v_pk_mul_f32 v[116:117], v[116:117], v[130:131] op_sel:[0,0] op_sel_hi:[1,0]
    v_pk_mul_f32 v[118:119], v[118:119], v[130:131] op_sel:[0,0] op_sel_hi:[1,0]
    v_pk_mul_f32 v[120:121], v[120:121], v[130:131] op_sel:[0,0] op_sel_hi:[1,0]
    v_pk_mul_f32 v[122:123], v[122:123], v[130:131] op_sel:[0,0] op_sel_hi:[1,0]
    v_cvt_pk_bf16_f32 v112, v112, v113
    v_cvt_pk_bf16_f32 v113, v114, v115
    v_cvt_pk_bf16_f32 v114, v116, v117
    v_cvt_pk_bf16_f32 v115, v118, v119
    v_cvt_pk_bf16_f32 v116, v120, v121
    v_cvt_pk_bf16_f32 v117, v122, v123
    buffer_store_dwordx4 v[112:115], v60, s[12:15], s36 offen offset:768 sc0 sc1
    buffer_store_dwordx2 v[116:117], v61, s[12:15], s36 offen offset:1024 sc0 sc1
    v_accvgpr_read_b32 v64, a147
    v_accvgpr_read_b32 v65, a151
    v_accvgpr_read_b32 v66, a155
    v_accvgpr_read_b32 v67, a159
    v_accvgpr_read_b32 v68, a163
    v_accvgpr_read_b32 v69, a167
    v_accvgpr_read_b32 v70, a171
    v_accvgpr_read_b32 v71, a175
    v_accvgpr_read_b32 v72, a179
    v_accvgpr_read_b32 v73, a183
    v_accvgpr_read_b32 v74, a187
    v_accvgpr_read_b32 v75, a191
    v_pk_mul_f32 v[64:65], v[64:65], v[130:131] op_sel:[0,1] op_sel_hi:[1,1]
    v_pk_mul_f32 v[66:67], v[66:67], v[130:131] op_sel:[0,1] op_sel_hi:[1,1]
    v_pk_mul_f32 v[68:69], v[68:69], v[130:131] op_sel:[0,1] op_sel_hi:[1,1]
    v_pk_mul_f32 v[70:71], v[70:71], v[130:131] op_sel:[0,1] op_sel_hi:[1,1]
    v_pk_mul_f32 v[72:73], v[72:73], v[130:131] op_sel:[0,1] op_sel_hi:[1,1]
    v_pk_mul_f32 v[74:75], v[74:75], v[130:131] op_sel:[0,1] op_sel_hi:[1,1]
    v_cvt_pk_bf16_f32 v64, v64, v65
    v_cvt_pk_bf16_f32 v65, v66, v67
    v_cvt_pk_bf16_f32 v66, v68, v69
    v_cvt_pk_bf16_f32 v67, v70, v71
    v_cvt_pk_bf16_f32 v68, v72, v73
    v_cvt_pk_bf16_f32 v69, v74, v75
    buffer_store_dwordx4 v[64:67], v60, s[12:15], s36 offen offset:1152 sc0 sc1
    buffer_store_dwordx2 v[68:69], v61, s[12:15], s36 offen offset:1408 sc0 sc1
L_fin:
L_done:
    s_endpgm
L_pollslow0:
    s_mov_b32 s59, 200
L_pollsm0:
    s_buffer_load_dwordx8 s[48:55], s[20:23], 0 glc
    s_waitcnt lgkmcnt(0)
    s_sub_u32 s48, s48, s92
    s_sub_u32 s49, s49, s92
    s_sub_u32 s50, s50, s92
    s_sub_u32 s51, s51, s92
    s_sub_u32 s52, s52, s92
    s_sub_u32 s53, s53, s92
    s_sub_u32 s54, s54, s92
    s_sub_u32 s55, s55, s92
    s_max_u32 s48, s48, s49
    s_max_u32 s48, s48, s50
    s_max_u32 s48, s48, s51
    s_max_u32 s48, s48, s52
    s_max_u32 s48, s48, s53
    s_max_u32 s48, s48, s54
    s_max_u32 s48, s48, s55
    s_cmp_lt_u32 s48, 16
    s_cbranch_scc1 L_pollok0
    s_sub_u32 s59, s59, 1
    s_cbranch_scc1 L_pollvec0
    s_sleep 1
    s_branch L_pollsm0
L_pollvec0:
    s_sub_u32 s96, s96, 1
    s_cbranch_scc1 L_pollgiveup0
    s_sleep 2
    buffer_load_dword v52, v53, s[20:23], 0 offen sc1
    s_waitcnt vmcnt(0)
    v_subrev_u32 v52, s92, v52
    v_cmp_lt_u32 vcc, 15, v52
    s_nop 0
    s_and_b32 s59, vcc_lo, 0xff
    s_cbranch_scc1 L_pollvec0
    s_branch L_pollok0
L_pollgiveup0:
    s_mov_b32 s96, 0
    s_branch L_pollok0
L_pollslow1:
    s_mov_b32 s59, 200
L_pollsm1:
    s_buffer_load_dwordx8 s[48:55], s[20:23], 0 glc
    s_waitcnt lgkmcnt(0)
    s_sub_u32 s48, s48, s92
    s_sub_u32 s49, s49, s92
    s_sub_u32 s50, s50, s92
    s_sub_u32 s51, s51, s92
    s_sub_u32 s52, s52, s92
    s_sub_u32 s53, s53, s92
    s_sub_u32 s54, s54, s92
    s_sub_u32 s55, s55, s92
    s_max_u32 s48, s48, s49
    s_max_u32 s48, s48, s50
    s_max_u32 s48, s48, s51
    s_max_u32 s48, s48, s52
    s_max_u32 s48, s48, s53
    s_max_u32 s48, s48, s54
    s_max_u32 s48, s48, s55
    s_cmp_lt_u32 s48, 16
    s_cbranch_scc1 L_pollok1
    s_sub_u32 s59, s59, 1
    s_cbranch_scc1 L_pollvec1
    s_sleep 1
    s_branch L_pollsm1
L_pollvec1:
    s_sub_u32 s96, s96, 1
    s_cbranch_scc1 L_pollgiveup1
    s_sleep 2
    buffer_load_dword v52, v53, s[20:23], 0 offen sc1
    s_waitcnt vmcnt(0)
    v_subrev_u32 v52, s92, v52
    v_cmp_lt_u32 vcc, 15, v52
    s_nop 0
    s_and_b32 s59, vcc_lo, 0xff
    s_cbranch_scc1 L_pollvec1
    s_branch L_pollok1
L_pollgiveup1:
    s_mov_b32 s96, 0
    s_branch L_pollok1
L_pollslow2:
    s_mov_b32 s59, 200
L_pollsm2:
    s_buffer_load_dwordx8 s[48:55], s[20:23], 0 glc
    s_waitcnt lgkmcnt(0)
    s_sub_u32 s48, s48, s92
    s_sub_u32 s49, s49, s92
    s_sub_u32 s50, s50, s92
    s_sub_u32 s51, s51, s92
    s_sub_u32 s52, s52, s92
    s_sub_u32 s53, s53, s92
    s_sub_u32 s54, s54, s92
    s_sub_u32 s55, s55, s92
    s_max_u32 s48, s48, s49
    s_max_u32 s48, s48, s50
    s_max_u32 s48, s48, s51
    s_max_u32 s48, s48, s52
    s_max_u32 s48, s48, s53
    s_max_u32 s48, s48, s54
    s_max_u32 s48, s48, s55
    s_cmp_lt_u32 s48, 16
    s_cbranch_scc1 L_pollok2
    s_sub_u32 s59, s59, 1
    s_cbranch_scc1 L_pollvec2
    s_sleep 1
    s_branch L_pollsm2
L_pollvec2:
    s_sub_u32 s96, s96, 1
    s_cbranch_scc1 L_pollgiveup2
    s_sleep 2
    buffer_load_dword v52, v53, s[20:23], 0 offen sc1
    s_waitcnt vmcnt(0)
    v_subrev_u32 v52, s92, v52
    v_cmp_lt_u32 vcc, 15, v52
    s_nop 0
    s_and_b32 s59, vcc_lo, 0xff
    s_cbranch_scc1 L_pollvec2
    s_branch L_pollok2
L_pollgiveup2:
    s_mov_b32 s96, 0
    s_branch L_pollok2
L_pollslow3:
    s_mov_b32 s59, 200
L_pollsm3:
    s_buffer_load_dwordx8 s[48:55], s[20:23], 0 glc
    s_waitcnt lgkmcnt(0)
    s_sub_u32 s48, s48, s92
    s_sub_u32 s49, s49, s92
    s_sub_u32 s50, s50, s92
    s_sub_u32 s51, s51, s92
    s_sub_u32 s52, s52, s92
    s_sub_u32 s53, s53, s92
    s_sub_u32 s54, s54, s92
    s_sub_u32 s55, s55, s92
    s_max_u32 s48, s48, s49
    s_max_u32 s48, s48, s50
    s_max_u32 s48, s48, s51
    s_max_u32 s48, s48, s52
    s_max_u32 s48, s48, s53
    s_max_u32 s48, s48, s54
    s_max_u32 s48, s48, s55
    s_cmp_lt_u32 s48, 16
    s_cbranch_scc1 L_pollok3
    s_sub_u32 s59, s59, 1
    s_cbranch_scc1 L_pollvec3
    s_sleep 1
    s_branch L_pollsm3
L_pollvec3:
    s_sub_u32 s96, s96, 1
    s_cbranch_scc1 L_pollgiveup3
    s_sleep 2
    buffer_load_dword v52, v53, s[20:23], 0 offen sc1
    s_waitcnt vmcnt(0)
    v_subrev_u32 v52, s92, v52
    v_cmp_lt_u32 vcc, 15, v52
    s_nop 0
    s_and_b32 s59, vcc_lo, 0xff
    s_cbranch_scc1 L_pollvec3
    s_branch L_pollok3
L_pollgiveup3:
    s_mov_b32 s96, 0
    s_branch L_pollok3
L_pollslow4:
    s_mov_b32 s59, 200
L_pollsm4:
    s_buffer_load_dwordx8 s[48:55], s[20:23], 0 glc
    s_waitcnt lgkmcnt(0)
    s_sub_u32 s48, s48, s92
    s_sub_u32 s49, s49, s92
    s_sub_u32 s50, s50, s92
    s_sub_u32 s51, s51, s92
    s_sub_u32 s52, s52, s92
    s_sub_u32 s53, s53, s92
    s_sub_u32 s54, s54, s92
    s_sub_u32 s55, s55, s92
    s_max_u32 s48, s48, s49
    s_max_u32 s48, s48, s50
    s_max_u32 s48, s48, s51
    s_max_u32 s48, s48, s52
    s_max_u32 s48, s48, s53
    s_max_u32 s48, s48, s54
    s_max_u32 s48, s48, s55
    s_cmp_lt_u32 s48, 16
    s_cbranch_scc1 L_pollok4
    s_sub_u32 s59, s59, 1
    s_cbranch_scc1 L_pollvec4
    s_sleep 1
    s_branch L_pollsm4
L_pollvec4:
    s_sub_u32 s96, s96, 1
    s_cbranch_scc1 L_pollgiveup4
    s_sleep 2
    buffer_load_dword v52, v53, s[20:23], 0 offen sc1
    s_waitcnt vmcnt(0)
    v_subrev_u32 v52, s92, v52
    v_cmp_lt_u32 vcc, 15, v52
    s_nop 0
    s_and_b32 s59, vcc_lo, 0xff
    s_cbranch_scc1 L_pollvec4
    s_branch L_pollok4
L_pollgiveup4:
    s_mov_b32 s96, 0
    s_branch L_pollok4
L_pollslow5:
    s_mov_b32 s59, 200
L_pollsm5:
    s_buffer_load_dwordx8 s[48:55], s[20:23], 0 glc
    s_waitcnt lgkmcnt(0)
    s_sub_u32 s48, s48, s92
    s_sub_u32 s49, s49, s92
    s_sub_u32 s50, s50, s92
    s_sub_u32 s51, s51, s92
    s_sub_u32 s52, s52, s92
    s_sub_u32 s53, s53, s92
    s_sub_u32 s54, s54, s92
    s_sub_u32 s55, s55, s92
    s_max_u32 s48, s48, s49
    s_max_u32 s48, s48, s50
    s_max_u32 s48, s48, s51
    s_max_u32 s48, s48, s52
    s_max_u32 s48, s48, s53
    s_max_u32 s48, s48, s54
    s_max_u32 s48, s48, s55
    s_cmp_lt_u32 s48, 16
    s_cbranch_scc1 L_pollok5
    s_sub_u32 s59, s59, 1
    s_cbranch_scc1 L_pollvec5
    s_sleep 1
    s_branch L_pollsm5
L_pollvec5:
    s_sub_u32 s96, s96, 1
    s_cbranch_scc1 L_pollgiveup5
    s_sleep 2
    buffer_load_dword v52, v53, s[20:23], 0 offen sc1
    s_waitcnt vmcnt(0)
    v_subrev_u32 v52, s92, v52
    v_cmp_lt_u32 vcc, 15, v52
    s_nop 0
    s_and_b32 s59, vcc_lo, 0xff
    s_cbranch_scc1 L_pollvec5
    s_branch L_pollok5
L_pollgiveup5:
    s_mov_b32 s96, 0
    s_branch L_pollok5
L_pollslow6:
    s_mov_b32 s59, 200
L_pollsm6:
    s_buffer_load_dwordx8 s[48:55], s[20:23], 0 glc
    s_waitcnt lgkmcnt(0)
    s_sub_u32 s48, s48, s92
    s_sub_u32 s49, s49, s92
    s_sub_u32 s50, s50, s92
    s_sub_u32 s51, s51, s92
    s_sub_u32 s52, s52, s92
    s_sub_u32 s53, s53, s92
    s_sub_u32 s54, s54, s92
    s_sub_u32 s55, s55, s92
    s_max_u32 s48, s48, s49
    s_max_u32 s48, s48, s50
    s_max_u32 s48, s48, s51
    s_max_u32 s48, s48, s52
    s_max_u32 s48, s48, s53
    s_max_u32 s48, s48, s54
    s_max_u32 s48, s48, s55
    s_cmp_lt_u32 s48, 16
    s_cbranch_scc1 L_pollok6
    s_sub_u32 s59, s59, 1
    s_cbranch_scc1 L_pollvec6
    s_sleep 1
    s_branch L_pollsm6
L_pollvec6:
    s_sub_u32 s96, s96, 1
    s_cbranch_scc1 L_pollgiveup6
    s_sleep 2
    buffer_load_dword v52, v53, s[20:23], 0 offen sc1
    s_waitcnt vmcnt(0)
    v_subrev_u32 v52, s92, v52
    v_cmp_lt_u32 vcc, 15, v52
    s_nop 0
    s_and_b32 s59, vcc_lo, 0xff
    s_cbranch_scc1 L_pollvec6
    s_branch L_pollok6
L_pollgiveup6:
    s_mov_b32 s96, 0
    s_branch L_pollok6
L_pollslowP:
L_pollvecP:
    s_sub_u32 s96, s96, 1
    s_cbranch_scc1 L_pollgiveupP
    s_sleep 2
    buffer_load_dword v52, v53, s[20:23], 0 offen sc1
    s_waitcnt vmcnt(0)
    v_subrev_u32 v52, s92, v52
    v_cmp_lt_u32 vcc, 15, v52
    s_nop 0
    s_and_b32 s59, vcc_lo, 0xff
    s_cbranch_scc1 L_pollvecP
    s_branch L_pollokP
L_pollgiveupP:
    s_mov_b32 s96, 0
    s_branch L_pollokP
L_tagslow:
    s_sub_u32 s96, s96, 1
    s_cbranch_scc1 L_taggiveup
    s_sleep 2
    buffer_load_dword v52, off, s[88:91], s93 sc1
    s_waitcnt vmcnt(0)
    v_readfirstlane_b32 s92, v52
    s_nop 0
    s_cmp_eq_u32 s92, 0
    s_cbranch_scc1 L_tagslow
    s_branch L_tagok
L_taggiveup:
    s_mov_b32 s96, 0
    s_branch L_tagok
L_slow:
    s_waitcnt vmcnt(0) lgkmcnt(0)
    s_nop 15
    v_accvgpr_write_b32 a0, 0
    v_accvgpr_write_b32 a1, 0
    v_accvgpr_write_b32 a2, 0
    v_accvgpr_write_b32 a3, 0
    v_accvgpr_write_b32 a4, 0
    v_accvgpr_write_b32 a5, 0
    v_accvgpr_write_b32 a6, 0
    v_accvgpr_write_b32 a7, 0
    v_accvgpr_write_b32 a8, 0
    v_accvgpr_write_b32 a9, 0
    v_accvgpr_write_b32 a10, 0
    v_accvgpr_write_b32 a11, 0
    v_accvgpr_write_b32 a12, 0
    v_accvgpr_write_b32 a13, 0
    v_accvgpr_write_b32 a14, 0
    v_accvgpr_write_b32 a15, 0
    v_accvgpr_write_b32 a16, 0
    v_accvgpr_write_b32 a17, 0
    v_accvgpr_write_b32 a18, 0
    v_accvgpr_write_b32 a19, 0
    v_accvgpr_write_b32 a20, 0
    v_accvgpr_write_b32 a21, 0
    v_accvgpr_write_b32 a22, 0
    v_accvgpr_write_b32 a23, 0
    v_accvgpr_write_b32 a24, 0
    v_accvgpr_write_b32 a25, 0
    v_accvgpr_write_b32 a26, 0
    v_accvgpr_write_b32 a27, 0
    v_accvgpr_write_b32 a28, 0
    v_accvgpr_write_b32 a29, 0
    v_accvgpr_write_b32 a30, 0
    v_accvgpr_write_b32 a31, 0
    v_accvgpr_write_b32 a32, 0
    v_accvgpr_write_b32 a33, 0
    v_accvgpr_write_b32 a34, 0
    v_accvgpr_write_b32 a35, 0
    v_accvgpr_write_b32 a36, 0
    v_accvgpr_write_b32 a37, 0
    v_accvgpr_write_b32 a38, 0
    v_accvgpr_write_b32 a39, 0
    v_accvgpr_write_b32 a40, 0
    v_accvgpr_write_b32 a41, 0
    v_accvgpr_write_b32 a42, 0
    v_accvgpr_write_b32 a43, 0
    v_accvgpr_write_b32 a44, 0
    v_accvgpr_write_b32 a45, 0
    v_accvgpr_write_b32 a46, 0
    v_accvgpr_write_b32 a47, 0
    v_accvgpr_write_b32 a48, 0
    v_accvgpr_write_b32 a49, 0
    v_accvgpr_write_b32 a50, 0
    v_accvgpr_write_b32 a51, 0
    v_accvgpr_write_b32 a52, 0
    v_accvgpr_write_b32 a53, 0
    v_accvgpr_write_b32 a54, 0
    v_accvgpr_write_b32 a55, 0
    v_accvgpr_write_b32 a56, 0
    v_accvgpr_write_b32 a57, 0
    v_accvgpr_write_b32 a58, 0
    v_accvgpr_write_b32 a59, 0
    v_accvgpr_write_b32 a60, 0
    v_accvgpr_write_b32 a61, 0
    v_accvgpr_write_b32 a62, 0
    v_accvgpr_write_b32 a63, 0
    v_accvgpr_write_b32 a64, 0
    v_accvgpr_write_b32 a65, 0
    v_accvgpr_write_b32 a66, 0
    v_accvgpr_write_b32 a67, 0
    v_accvgpr_write_b32 a68, 0
    v_accvgpr_write_b32 a69, 0
    v_accvgpr_write_b32 a70, 0
    v_accvgpr_write_b32 a71, 0
    v_accvgpr_write_b32 a72, 0
    v_accvgpr_write_b32 a73, 0
    v_accvgpr_write_b32 a74, 0
    v_accvgpr_write_b32 a75, 0
    v_accvgpr_write_b32 a76, 0
    v_accvgpr_write_b32 a77, 0
    v_accvgpr_write_b32 a78, 0
    v_accvgpr_write_b32 a79, 0
    v_accvgpr_write_b32 a80, 0
    v_accvgpr_write_b32 a81, 0
    v_accvgpr_write_b32 a82, 0
    v_accvgpr_write_b32 a83, 0
    v_accvgpr_write_b32 a84, 0
    v_accvgpr_write_b32 a85, 0
    v_accvgpr_write_b32 a86, 0
    v_accvgpr_write_b32 a87, 0
    v_accvgpr_write_b32 a88, 0
    v_accvgpr_write_b32 a89, 0
    v_accvgpr_write_b32 a90, 0
    v_accvgpr_write_b32 a91, 0
    v_accvgpr_write_b32 a92, 0
    v_accvgpr_write_b32 a93, 0
    v_accvgpr_write_b32 a94, 0
    v_accvgpr_write_b32 a95, 0
    v_accvgpr_write_b32 a96, 0
    v_accvgpr_write_b32 a97, 0
    v_accvgpr_write_b32 a98, 0
    v_accvgpr_write_b32 a99, 0
    v_accvgpr_write_b32 a100, 0
    v_accvgpr_write_b32 a101, 0
    v_accvgpr_write_b32 a102, 0
    v_accvgpr_write_b32 a103, 0
    v_accvgpr_write_b32 a104, 0
    v_accvgpr_write_b32 a105, 0
    v_accvgpr_write_b32 a106, 0
    v_accvgpr_write_b32 a107, 0
    v_accvgpr_write_b32 a108, 0
    v_accvgpr_write_b32 a109, 0
    v_accvgpr_write_b32 a110, 0
    v_accvgpr_write_b32 a111, 0
    v_accvgpr_write_b32 a112, 0
    v_accvgpr_write_b32 a113, 0
    v_accvgpr_write_b32 a114, 0
    v_accvgpr_write_b32 a115, 0
    v_accvgpr_write_b32 a116, 0
    v_accvgpr_write_b32 a117, 0
    v_accvgpr_write_b32 a118, 0
    v_accvgpr_write_b32 a119, 0
    v_accvgpr_write_b32 a120, 0
    v_accvgpr_write_b32 a121, 0
    v_accvgpr_write_b32 a122, 0
    v_accvgpr_write_b32 a123, 0
    v_accvgpr_write_b32 a124, 0
    v_accvgpr_write_b32 a125, 0
    v_accvgpr_write_b32 a126, 0
    v_accvgpr_write_b32 a127, 0
    v_accvgpr_write_b32 a128, 0
    v_accvgpr_write_b32 a129, 0
    v_accvgpr_write_b32 a130, 0
    v_accvgpr_write_b32 a131, 0
    v_accvgpr_write_b32 a132, 0
    v_accvgpr_write_b32 a133, 0
    v_accvgpr_write_b32 a134, 0
    v_accvgpr_write_b32 a135, 0
    v_accvgpr_write_b32 a136, 0
    v_accvgpr_write_b32 a137, 0
    v_accvgpr_write_b32 a138, 0
    v_accvgpr_write_b32 a139, 0
    v_accvgpr_write_b32 a140, 0
    v_accvgpr_write_b32 a141, 0
    v_accvgpr_write_b32 a142, 0
    v_accvgpr_write_b32 a143, 0
    v_accvgpr_write_b32 a144, 0
    v_accvgpr_write_b32 a145, 0
    v_accvgpr_write_b32 a146, 0
    v_accvgpr_write_b32 a147, 0
    v_accvgpr_write_b32 a148, 0
    v_accvgpr_write_b32 a149, 0
    v_accvgpr_write_b32 a150, 0
    v_accvgpr_write_b32 a151, 0
    v_accvgpr_write_b32 a152, 0
    v_accvgpr_write_b32 a153, 0
    v_accvgpr_write_b32 a154, 0
    v_accvgpr_write_b32 a155, 0
    v_accvgpr_write_b32 a156, 0
    v_accvgpr_write_b32 a157, 0
    v_accvgpr_write_b32 a158, 0
    v_accvgpr_write_b32 a159, 0
    v_accvgpr_write_b32 a160, 0
    v_accvgpr_write_b32 a161, 0
    v_accvgpr_write_b32 a162, 0
    v_accvgpr_write_b32 a163, 0
    v_accvgpr_write_b32 a164, 0
    v_accvgpr_write_b32 a165, 0
    v_accvgpr_write_b32 a166, 0
    v_accvgpr_write_b32 a167, 0
    v_accvgpr_write_b32 a168, 0
    v_accvgpr_write_b32 a169, 0
    v_accvgpr_write_b32 a170, 0
    v_accvgpr_write_b32 a171, 0
    v_accvgpr_write_b32 a172, 0
    v_accvgpr_write_b32 a173, 0
    v_accvgpr_write_b32 a174, 0
    v_accvgpr_write_b32 a175, 0
    v_accvgpr_write_b32 a176, 0
    v_accvgpr_write_b32 a177, 0
    v_accvgpr_write_b32 a178, 0
    v_accvgpr_write_b32 a179, 0
    v_accvgpr_write_b32 a180, 0
    v_accvgpr_write_b32 a181, 0
    v_accvgpr_write_b32 a182, 0
    v_accvgpr_write_b32 a183, 0
    v_accvgpr_write_b32 a184, 0
    v_accvgpr_write_b32 a185, 0
    v_accvgpr_write_b32 a186, 0
    v_accvgpr_write_b32 a187, 0
    v_accvgpr_write_b32 a188, 0
    v_accvgpr_write_b32 a189, 0
    v_accvgpr_write_b32 a190, 0
    v_accvgpr_write_b32 a191, 0
    v_mov_b32 v5, 0
    v_mov_b32 v240, 0xff7fffff
    v_mov_b32 v6, 0
    v_mov_b32 v241, 0xff7fffff
    v_mov_b32 v7, 0
    v_mov_b32 v242, 0xff7fffff
    v_mov_b32 v8, 0
    v_mov_b32 v243, 0xff7fffff
    v_subrev_u32 v244, s28, v2
    v_subrev_u32 v245, s28, v3
    v_subrev_u32 v246, s30, v1
    v_subrev_u32 v247, s30, v21
    v_subrev_u32 v248, s30, v22
    s_mov_b32 s48, 0
L_slowloop:
    s_add_u32 s49, s48, 6144
    s_add_u32 s50, s48, 12288
    buffer_load_dwordx4 v[64:67], v244, s[4:7], s48 offen offset:0 sc1
    buffer_load_dwordx4 v[68:71], v245, s[4:7], s48 offen offset:0 sc1
    buffer_load_dwordx4 v[72:75], v244, s[4:7], s49 offen offset:0 sc1
    buffer_load_dwordx4 v[76:79], v245, s[4:7], s49 offen offset:0 sc1
    buffer_load_dwordx4 v[80:83], v244, s[4:7], s48 offen offset:128 sc1
    buffer_load_dwordx4 v[84:87], v245, s[4:7], s48 offen offset:128 sc1
    buffer_load_dwordx4 v[88:91], v244, s[4:7], s49 offen offset:128 sc1
    buffer_load_dwordx4 v[92:95], v245, s[4:7], s49 offen offset:128 sc1
    buffer_load_dwordx4 v[96:99], v244, s[4:7], s48 offen offset:256 sc1
    buffer_load_dwordx4 v[100:103], v245, s[4:7], s48 offen offset:256 sc1
    buffer_load_dwordx4 v[104:107], v244, s[4:7], s49 offen offset:256 sc1
    buffer_load_dwordx4 v[108:111], v245, s[4:7], s49 offen offset:256 sc1
    buffer_load_dwordx4 v[112:115], v246, s[4:7], s50 offen offset:0 sc1
    buffer_load_dwordx4 v[116:119], v246, s[4:7], s50 offen offset:768 sc1
    buffer_load_dwordx4 v[120:123], v246, s[4:7], s50 offen offset:1536 sc1
    buffer_load_dwordx4 v[124:127], v246, s[4:7], s50 offen offset:2304 sc1
    buffer_load_dwordx4 v[128:131], v247, s[4:7], s50 offen offset:0 sc1
    buffer_load_dwordx4 v[132:135], v247, s[4:7], s50 offen offset:768 sc1
    buffer_load_dwordx4 v[136:139], v247, s[4:7], s50 offen offset:1536 sc1
    buffer_load_dwordx4 v[140:143], v247, s[4:7], s50 offen offset:2304 sc1
    buffer_load_dwordx4 v[144:147], v248, s[4:7], s50 offen offset:0 sc1
    buffer_load_dwordx4 v[148:151], v248, s[4:7], s50 offen offset:768 sc1
    buffer_load_dwordx4 v[152:155], v248, s[4:7], s50 offen offset:1536 sc1
    buffer_load_dwordx4 v[156:159], v248, s[4:7], s50 offen offset:2304 sc1
    s_waitcnt vmcnt(12)
    v_mfma_f32_16x16x32_bf16 v[160:163], v[64:67], a[192:195], 0
    v_mfma_f32_16x16x32_bf16 v[168:171], v[64:67], a[216:219], 0
    v_mfma_f32_16x16x32_bf16 v[176:179], v[64:67], a[240:243], 0
    v_mfma_f32_16x16x32_bf16 v[184:187], v[64:67], v[200:203], 0
    v_mfma_f32_16x16x32_bf16 v[160:163], v[68:71], a[196:199], v[160:163]
    v_mfma_f32_16x16x32_bf16 v[168:171], v[68:71], a[220:223], v[168:171]
    v_mfma_f32_16x16x32_bf16 v[176:179], v[68:71], a[244:247], v[176:179]
    v_mfma_f32_16x16x32_bf16 v[184:187], v[68:71], v[204:207], v[184:187]
    v_mfma_f32_16x16x32_bf16 v[164:167], v[72:75], a[192:195], 0
    v_mfma_f32_16x16x32_bf16 v[172:175], v[72:75], a[216:219], 0
    v_mfma_f32_16x16x32_bf16 v[180:183], v[72:75], a[240:243], 0
    v_mfma_f32_16x16x32_bf16 v[188:191], v[72:75], v[200:203], 0
    v_mfma_f32_16x16x32_bf16 v[164:167], v[76:79], a[196:199], v[164:167]
    v_mfma_f32_16x16x32_bf16 v[172:175], v[76:79], a[220:223], v[172:175]
    v_mfma_f32_16x16x32_bf16 v[180:183], v[76:79], a[244:247], v[180:183]
    v_mfma_f32_16x16x32_bf16 v[188:191], v[76:79], v[204:207], v[188:191]
    v_mfma_f32_16x16x32_bf16 v[160:163], v[80:83], a[200:203], v[160:163]
    v_mfma_f32_16x16x32_bf16 v[168:171], v[80:83], a[224:227], v[168:171]
    v_mfma_f32_16x16x32_bf16 v[176:179], v[80:83], a[248:251], v[176:179]
    v_mfma_f32_16x16x32_bf16 v[184:187], v[80:83], v[208:211], v[184:187]
    v_mfma_f32_16x16x32_bf16 v[160:163], v[84:87], a[204:207], v[160:163]
    v_mfma_f32_16x16x32_bf16 v[168:171], v[84:87], a[228:231], v[168:171]
    v_mfma_f32_16x16x32_bf16 v[176:179], v[84:87], a[252:255], v[176:179]
    v_mfma_f32_16x16x32_bf16 v[184:187], v[84:87], v[212:215], v[184:187]
    v_mfma_f32_16x16x32_bf16 v[164:167], v[88:91], a[200:203], v[164:167]
    v_mfma_f32_16x16x32_bf16 v[172:175], v[88:91], a[224:227], v[172:175]
    v_mfma_f32_16x16x32_bf16 v[180:183], v[88:91], a[248:251], v[180:183]
    v_mfma_f32_16x16x32_bf16 v[188:191], v[88:91], v[208:211], v[188:191]
    v_mfma_f32_16x16x32_bf16 v[164:167], v[92:95], a[204:207], v[164:167]
    v_mfma_f32_16x16x32_bf16 v[172:175], v[92:95], a[228:231], v[172:175]
    v_mfma_f32_16x16x32_bf16 v[180:183], v[92:95], a[252:255], v[180:183]
    v_mfma_f32_16x16x32_bf16 v[188:191], v[92:95], v[212:215], v[188:191]
    v_mfma_f32_16x16x32_bf16 v[160:163], v[96:99], a[208:211], v[160:163]
    v_mfma_f32_16x16x32_bf16 v[168:171], v[96:99], a[232:235], v[168:171]
    v_mfma_f32_16x16x32_bf16 v[176:179], v[96:99], v[192:195], v[176:179]
    v_mfma_f32_16x16x32_bf16 v[184:187], v[96:99], v[216:219], v[184:187]
    v_mfma_f32_16x16x32_bf16 v[160:163], v[100:103], a[212:215], v[160:163]
    v_mfma_f32_16x16x32_bf16 v[168:171], v[100:103], a[236:239], v[168:171]
    v_mfma_f32_16x16x32_bf16 v[176:179], v[100:103], v[196:199], v[176:179]
    v_mfma_f32_16x16x32_bf16 v[184:187], v[100:103], v[220:223], v[184:187]
    v_mfma_f32_16x16x32_bf16 v[164:167], v[104:107], a[208:211], v[164:167]
    v_mfma_f32_16x16x32_bf16 v[172:175], v[104:107], a[232:235], v[172:175]
    v_mfma_f32_16x16x32_bf16 v[180:183], v[104:107], v[192:195], v[180:183]
    v_mfma_f32_16x16x32_bf16 v[188:191], v[104:107], v[216:219], v[188:191]
    v_mfma_f32_16x16x32_bf16 v[164:167], v[108:111], a[212:215], v[164:167]
    v_mfma_f32_16x16x32_bf16 v[172:175], v[108:111], a[236:239], v[172:175]
    v_mfma_f32_16x16x32_bf16 v[180:183], v[108:111], v[196:199], v[180:183]
    v_mfma_f32_16x16x32_bf16 v[188:191], v[108:111], v[220:223], v[188:191]
    s_nop 9
    v_max3_f32 v16, v160, v161, v162
    v_max3_f32 v16, v16, v163, v164
    v_max3_f32 v16, v16, v165, v166
    v_max3_f32 v16, v16, v167, v240
    v_mov_b32 v17, v16
    s_nop 1
    v_permlane16_swap_b32 v16, v17
    s_nop 1
    v_max_f32 v16, v16, v17
    v_mov_b32 v17, v16
    s_nop 1
    v_permlane32_swap_b32 v16, v17
    s_nop 1
    v_max_f32 v16, v16, v17
    v_sub_f32 v17, v240, v16
    v_exp_f32 v17, v17
    v_mov_b32 v240, v16
    ds_bpermute_b32 v250, v62, v17 offset:0
    ds_bpermute_b32 v251, v62, v17 offset:4
    ds_bpermute_b32 v252, v62, v17 offset:8
    ds_bpermute_b32 v253, v62, v17 offset:12
    v_sub_f32 v160, v160, v16
    v_sub_f32 v161, v161, v16
    v_sub_f32 v162, v162, v16
    v_sub_f32 v163, v163, v16
    v_sub_f32 v164, v164, v16
    v_sub_f32 v165, v165, v16
    v_sub_f32 v166, v166, v16
    v_sub_f32 v167, v167, v16
    v_exp_f32 v160, v160
    v_exp_f32 v161, v161
    v_exp_f32 v162, v162
    v_exp_f32 v163, v163
    v_exp_f32 v164, v164
    v_exp_f32 v165, v165
    v_exp_f32 v166, v166
    v_exp_f32 v167, v167
    v_mul_f32 v5, v5, v17
    v_add_f32 v5, v5, v160
    v_add_f32 v5, v5, v161
    v_add_f32 v5, v5, v162
    v_add_f32 v5, v5, v163
    v_add_f32 v5, v5, v164
    v_add_f32 v5, v5, v165
    v_add_f32 v5, v5, v166
    v_add_f32 v5, v5, v167
    v_cvt_pk_bf16_f32 v224, v160, v161
    v_cvt_pk_bf16_f32 v225, v162, v163
    v_cvt_pk_bf16_f32 v226, v164, v165
    v_cvt_pk_bf16_f32 v227, v166, v167
    s_waitcnt lgkmcnt(0)
    v_accvgpr_read_b32 v18, a0
    v_mul_f32 v18, v18, v250
    v_accvgpr_write_b32 a0, v18
    v_accvgpr_read_b32 v19, a1
    v_mul_f32 v19, v19, v251
    v_accvgpr_write_b32 a1, v19
    v_accvgpr_read_b32 v18, a2
    v_mul_f32 v18, v18, v252
    v_accvgpr_write_b32 a2, v18
    v_accvgpr_read_b32 v19, a3
    v_mul_f32 v19, v19, v253
    v_accvgpr_write_b32 a3, v19
    v_accvgpr_read_b32 v18, a4
    v_mul_f32 v18, v18, v250
    v_accvgpr_write_b32 a4, v18
    v_accvgpr_read_b32 v19, a5
    v_mul_f32 v19, v19, v251
    v_accvgpr_write_b32 a5, v19
    v_accvgpr_read_b32 v18, a6
    v_mul_f32 v18, v18, v252
    v_accvgpr_write_b32 a6, v18
    v_accvgpr_read_b32 v19, a7
    v_mul_f32 v19, v19, v253
    v_accvgpr_write_b32 a7, v19
    v_accvgpr_read_b32 v18, a8
    v_mul_f32 v18, v18, v250
    v_accvgpr_write_b32 a8, v18
    v_accvgpr_read_b32 v19, a9
    v_mul_f32 v19, v19, v251
    v_accvgpr_write_b32 a9, v19
    v_accvgpr_read_b32 v18, a10
    v_mul_f32 v18, v18, v252
    v_accvgpr_write_b32 a10, v18
    v_accvgpr_read_b32 v19, a11
    v_mul_f32 v19, v19, v253
    v_accvgpr_write_b32 a11, v19
    v_accvgpr_read_b32 v18, a12
    v_mul_f32 v18, v18, v250
    v_accvgpr_write_b32 a12, v18
    v_accvgpr_read_b32 v19, a13
    v_mul_f32 v19, v19, v251
    v_accvgpr_write_b32 a13, v19
    v_accvgpr_read_b32 v18, a14
    v_mul_f32 v18, v18, v252
    v_accvgpr_write_b32 a14, v18
    v_accvgpr_read_b32 v19, a15
    v_mul_f32 v19, v19, v253
    v_accvgpr_write_b32 a15, v19
    v_accvgpr_read_b32 v18, a16
    v_mul_f32 v18, v18, v250
    v_accvgpr_write_b32 a16, v18
    v_accvgpr_read_b32 v19, a17
    v_mul_f32 v19, v19, v251
    v_accvgpr_write_b32 a17, v19
    v_accvgpr_read_b32 v18, a18
    v_mul_f32 v18, v18, v252
    v_accvgpr_write_b32 a18, v18
    v_accvgpr_read_b32 v19, a19
    v_mul_f32 v19, v19, v253
    v_accvgpr_write_b32 a19, v19
    v_accvgpr_read_b32 v18, a20
    v_mul_f32 v18, v18, v250
    v_accvgpr_write_b32 a20, v18
    v_accvgpr_read_b32 v19, a21
    v_mul_f32 v19, v19, v251
    v_accvgpr_write_b32 a21, v19
    v_accvgpr_read_b32 v18, a22
    v_mul_f32 v18, v18, v252
    v_accvgpr_write_b32 a22, v18
    v_accvgpr_read_b32 v19, a23
    v_mul_f32 v19, v19, v253
    v_accvgpr_write_b32 a23, v19
    v_accvgpr_read_b32 v18, a24
    v_mul_f32 v18, v18, v250
    v_accvgpr_write_b32 a24, v18
    v_accvgpr_read_b32 v19, a25
    v_mul_f32 v19, v19, v251
    v_accvgpr_write_b32 a25, v19
    v_accvgpr_read_b32 v18, a26
    v_mul_f32 v18, v18, v252
    v_accvgpr_write_b32 a26, v18
    v_accvgpr_read_b32 v19, a27
    v_mul_f32 v19, v19, v253
    v_accvgpr_write_b32 a27, v19
    v_accvgpr_read_b32 v18, a28
    v_mul_f32 v18, v18, v250
    v_accvgpr_write_b32 a28, v18
    v_accvgpr_read_b32 v19, a29
    v_mul_f32 v19, v19, v251
    v_accvgpr_write_b32 a29, v19
    v_accvgpr_read_b32 v18, a30
    v_mul_f32 v18, v18, v252
    v_accvgpr_write_b32 a30, v18
    v_accvgpr_read_b32 v19, a31
    v_mul_f32 v19, v19, v253
    v_accvgpr_write_b32 a31, v19
    v_accvgpr_read_b32 v18, a32
    v_mul_f32 v18, v18, v250
    v_accvgpr_write_b32 a32, v18
    v_accvgpr_read_b32 v19, a33
    v_mul_f32 v19, v19, v251
    v_accvgpr_write_b32 a33, v19
    v_accvgpr_read_b32 v18, a34
    v_mul_f32 v18, v18, v252
    v_accvgpr_write_b32 a34, v18
    v_accvgpr_read_b32 v19, a35
    v_mul_f32 v19, v19, v253
    v_accvgpr_write_b32 a35, v19
    v_accvgpr_read_b32 v18, a36
    v_mul_f32 v18, v18, v250
    v_accvgpr_write_b32 a36, v18
    v_accvgpr_read_b32 v19, a37
    v_mul_f32 v19, v19, v251
    v_accvgpr_write_b32 a37, v19
    v_accvgpr_read_b32 v18, a38
    v_mul_f32 v18, v18, v252
    v_accvgpr_write_b32 a38, v18
    v_accvgpr_read_b32 v19, a39
    v_mul_f32 v19, v19, v253
    v_accvgpr_write_b32 a39, v19
    v_accvgpr_read_b32 v18, a40
    v_mul_f32 v18, v18, v250
    v_accvgpr_write_b32 a40, v18
    v_accvgpr_read_b32 v19, a41
    v_mul_f32 v19, v19, v251
    v_accvgpr_write_b32 a41, v19
    v_accvgpr_read_b32 v18, a42
    v_mul_f32 v18, v18, v252
    v_accvgpr_write_b32 a42, v18
    v_accvgpr_read_b32 v19, a43
    v_mul_f32 v19, v19, v253
    v_accvgpr_write_b32 a43, v19
    v_accvgpr_read_b32 v18, a44
    v_mul_f32 v18, v18, v250
    v_accvgpr_write_b32 a44, v18
    v_accvgpr_read_b32 v19, a45
    v_mul_f32 v19, v19, v251
    v_accvgpr_write_b32 a45, v19
    v_accvgpr_read_b32 v18, a46
    v_mul_f32 v18, v18, v252
    v_accvgpr_write_b32 a46, v18
    v_accvgpr_read_b32 v19, a47
    v_mul_f32 v19, v19, v253
    v_accvgpr_write_b32 a47, v19
    v_max3_f32 v16, v168, v169, v170
    v_max3_f32 v16, v16, v171, v172
    v_max3_f32 v16, v16, v173, v174
    v_max3_f32 v16, v16, v175, v241
    v_mov_b32 v17, v16
    s_nop 1
    v_permlane16_swap_b32 v16, v17
    s_nop 1
    v_max_f32 v16, v16, v17
    v_mov_b32 v17, v16
    s_nop 1
    v_permlane32_swap_b32 v16, v17
    s_nop 1
    v_max_f32 v16, v16, v17
    v_sub_f32 v17, v241, v16
    v_exp_f32 v17, v17
    v_mov_b32 v241, v16
    ds_bpermute_b32 v250, v62, v17 offset:0
    ds_bpermute_b32 v251, v62, v17 offset:4
    ds_bpermute_b32 v252, v62, v17 offset:8
    ds_bpermute_b32 v253, v62, v17 offset:12
    v_sub_f32 v168, v168, v16
    v_sub_f32 v169, v169, v16
    v_sub_f32 v170, v170, v16
    v_sub_f32 v171, v171, v16
    v_sub_f32 v172, v172, v16
    v_sub_f32 v173, v173, v16
    v_sub_f32 v174, v174, v16
    v_sub_f32 v175, v175, v16
    v_exp_f32 v168, v168
    v_exp_f32 v169, v169
    v_exp_f32 v170, v170
    v_exp_f32 v171, v171
    v_exp_f32 v172, v172
    v_exp_f32 v173, v173
    v_exp_f32 v174, v174
    v_exp_f32 v175, v175
    v_mul_f32 v6, v6, v17
    v_add_f32 v6, v6, v168
    v_add_f32 v6, v6, v169
    v_add_f32 v6, v6, v170
    v_add_f32 v6, v6, v171
    v_add_f32 v6, v6, v172
    v_add_f32 v6, v6, v173
    v_add_f32 v6, v6, v174
    v_add_f32 v6, v6, v175
    v_cvt_pk_bf16_f32 v228, v168, v169
    v_cvt_pk_bf16_f32 v229, v170, v171
    v_cvt_pk_bf16_f32 v230, v172, v173
    v_cvt_pk_bf16_f32 v231, v174, v175
    s_waitcnt lgkmcnt(0)
    v_accvgpr_read_b32 v18, a48
    v_mul_f32 v18, v18, v250
    v_accvgpr_write_b32 a48, v18
    v_accvgpr_read_b32 v19, a49
    v_mul_f32 v19, v19, v251
    v_accvgpr_write_b32 a49, v19
    v_accvgpr_read_b32 v18, a50
    v_mul_f32 v18, v18, v252
    v_accvgpr_write_b32 a50, v18
    v_accvgpr_read_b32 v19, a51
    v_mul_f32 v19, v19, v253
    v_accvgpr_write_b32 a51, v19
    v_accvgpr_read_b32 v18, a52
    v_mul_f32 v18, v18, v250
    v_accvgpr_write_b32 a52, v18
    v_accvgpr_read_b32 v19, a53
    v_mul_f32 v19, v19, v251
    v_accvgpr_write_b32 a53, v19
    v_accvgpr_read_b32 v18, a54
    v_mul_f32 v18, v18, v252
    v_accvgpr_write_b32 a54, v18
    v_accvgpr_read_b32 v19, a55
    v_mul_f32 v19, v19, v253
    v_accvgpr_write_b32 a55, v19
    v_accvgpr_read_b32 v18, a56
    v_mul_f32 v18, v18, v250
    v_accvgpr_write_b32 a56, v18
    v_accvgpr_read_b32 v19, a57
    v_mul_f32 v19, v19, v251
    v_accvgpr_write_b32 a57, v19
    v_accvgpr_read_b32 v18, a58
    v_mul_f32 v18, v18, v252
    v_accvgpr_write_b32 a58, v18
    v_accvgpr_read_b32 v19, a59
    v_mul_f32 v19, v19, v253
    v_accvgpr_write_b32 a59, v19
    v_accvgpr_read_b32 v18, a60
    v_mul_f32 v18, v18, v250
    v_accvgpr_write_b32 a60, v18
    v_accvgpr_read_b32 v19, a61
    v_mul_f32 v19, v19, v251
    v_accvgpr_write_b32 a61, v19
    v_accvgpr_read_b32 v18, a62
    v_mul_f32 v18, v18, v252
    v_accvgpr_write_b32 a62, v18
    v_accvgpr_read_b32 v19, a63
    v_mul_f32 v19, v19, v253
    v_accvgpr_write_b32 a63, v19
    v_accvgpr_read_b32 v18, a64
    v_mul_f32 v18, v18, v250
    v_accvgpr_write_b32 a64, v18
    v_accvgpr_read_b32 v19, a65
    v_mul_f32 v19, v19, v251
    v_accvgpr_write_b32 a65, v19
    v_accvgpr_read_b32 v18, a66
    v_mul_f32 v18, v18, v252
    v_accvgpr_write_b32 a66, v18
    v_accvgpr_read_b32 v19, a67
    v_mul_f32 v19, v19, v253
    v_accvgpr_write_b32 a67, v19
    v_accvgpr_read_b32 v18, a68
    v_mul_f32 v18, v18, v250
    v_accvgpr_write_b32 a68, v18
    v_accvgpr_read_b32 v19, a69
    v_mul_f32 v19, v19, v251
    v_accvgpr_write_b32 a69, v19
    v_accvgpr_read_b32 v18, a70
    v_mul_f32 v18, v18, v252
    v_accvgpr_write_b32 a70, v18
    v_accvgpr_read_b32 v19, a71
    v_mul_f32 v19, v19, v253
    v_accvgpr_write_b32 a71, v19
    v_accvgpr_read_b32 v18, a72
    v_mul_f32 v18, v18, v250
    v_accvgpr_write_b32 a72, v18
    v_accvgpr_read_b32 v19, a73
    v_mul_f32 v19, v19, v251
    v_accvgpr_write_b32 a73, v19
    v_accvgpr_read_b32 v18, a74
    v_mul_f32 v18, v18, v252
    v_accvgpr_write_b32 a74, v18
    v_accvgpr_read_b32 v19, a75
    v_mul_f32 v19, v19, v253
    v_accvgpr_write_b32 a75, v19
    v_accvgpr_read_b32 v18, a76
    v_mul_f32 v18, v18, v250
    v_accvgpr_write_b32 a76, v18
    v_accvgpr_read_b32 v19, a77
    v_mul_f32 v19, v19, v251
    v_accvgpr_write_b32 a77, v19
    v_accvgpr_read_b32 v18, a78
    v_mul_f32 v18, v18, v252
    v_accvgpr_write_b32 a78, v18
    v_accvgpr_read_b32 v19, a79
    v_mul_f32 v19, v19, v253
    v_accvgpr_write_b32 a79, v19
    v_accvgpr_read_b32 v18, a80
    v_mul_f32 v18, v18, v250
    v_accvgpr_write_b32 a80, v18
    v_accvgpr_read_b32 v19, a81
    v_mul_f32 v19, v19, v251
    v_accvgpr_write_b32 a81, v19
    v_accvgpr_read_b32 v18, a82
    v_mul_f32 v18, v18, v252
    v_accvgpr_write_b32 a82, v18
    v_accvgpr_read_b32 v19, a83
    v_mul_f32 v19, v19, v253
    v_accvgpr_write_b32 a83, v19
    v_accvgpr_read_b32 v18, a84
    v_mul_f32 v18, v18, v250
    v_accvgpr_write_b32 a84, v18
    v_accvgpr_read_b32 v19, a85
    v_mul_f32 v19, v19, v251
    v_accvgpr_write_b32 a85, v19
    v_accvgpr_read_b32 v18, a86
    v_mul_f32 v18, v18, v252
    v_accvgpr_write_b32 a86, v18
    v_accvgpr_read_b32 v19, a87
    v_mul_f32 v19, v19, v253
    v_accvgpr_write_b32 a87, v19
    v_accvgpr_read_b32 v18, a88
    v_mul_f32 v18, v18, v250
    v_accvgpr_write_b32 a88, v18
    v_accvgpr_read_b32 v19, a89
    v_mul_f32 v19, v19, v251
    v_accvgpr_write_b32 a89, v19
    v_accvgpr_read_b32 v18, a90
    v_mul_f32 v18, v18, v252
    v_accvgpr_write_b32 a90, v18
    v_accvgpr_read_b32 v19, a91
    v_mul_f32 v19, v19, v253
    v_accvgpr_write_b32 a91, v19
    v_accvgpr_read_b32 v18, a92
    v_mul_f32 v18, v18, v250
    v_accvgpr_write_b32 a92, v18
    v_accvgpr_read_b32 v19, a93
    v_mul_f32 v19, v19, v251
    v_accvgpr_write_b32 a93, v19
    v_accvgpr_read_b32 v18, a94
    v_mul_f32 v18, v18, v252
    v_accvgpr_write_b32 a94, v18
    v_accvgpr_read_b32 v19, a95
    v_mul_f32 v19, v19, v253
    v_accvgpr_write_b32 a95, v19
    v_max3_f32 v16, v176, v177, v178
    v_max3_f32 v16, v16, v179, v180
    v_max3_f32 v16, v16, v181, v182
    v_max3_f32 v16, v16, v183, v242
    v_mov_b32 v17, v16
    s_nop 1
    v_permlane16_swap_b32 v16, v17
    s_nop 1
    v_max_f32 v16, v16, v17
    v_mov_b32 v17, v16
    s_nop 1
    v_permlane32_swap_b32 v16, v17
    s_nop 1
    v_max_f32 v16, v16, v17
    v_sub_f32 v17, v242, v16
    v_exp_f32 v17, v17
    v_mov_b32 v242, v16
    ds_bpermute_b32 v250, v62, v17 offset:0
    ds_bpermute_b32 v251, v62, v17 offset:4
    ds_bpermute_b32 v252, v62, v17 offset:8
    ds_bpermute_b32 v253, v62, v17 offset:12
    v_sub_f32 v176, v176, v16
    v_sub_f32 v177, v177, v16
    v_sub_f32 v178, v178, v16
    v_sub_f32 v179, v179, v16
    v_sub_f32 v180, v180, v16
    v_sub_f32 v181, v181, v16
    v_sub_f32 v182, v182, v16
    v_sub_f32 v183, v183, v16
    v_exp_f32 v176, v176
    v_exp_f32 v177, v177
    v_exp_f32 v178, v178
    v_exp_f32 v179, v179
    v_exp_f32 v180, v180
    v_exp_f32 v181, v181
    v_exp_f32 v182, v182
    v_exp_f32 v183, v183
    v_mul_f32 v7, v7, v17
    v_add_f32 v7, v7, v176
    v_add_f32 v7, v7, v177
    v_add_f32 v7, v7, v178
    v_add_f32 v7, v7, v179
    v_add_f32 v7, v7, v180
    v_add_f32 v7, v7, v181
    v_add_f32 v7, v7, v182
    v_add_f32 v7, v7, v183
    v_cvt_pk_bf16_f32 v232, v176, v177
    v_cvt_pk_bf16_f32 v233, v178, v179
    v_cvt_pk_bf16_f32 v234, v180, v181
    v_cvt_pk_bf16_f32 v235, v182, v183
    s_waitcnt lgkmcnt(0)
    v_accvgpr_read_b32 v18, a96
    v_mul_f32 v18, v18, v250
    v_accvgpr_write_b32 a96, v18
    v_accvgpr_read_b32 v19, a97
    v_mul_f32 v19, v19, v251
    v_accvgpr_write_b32 a97, v19
    v_accvgpr_read_b32 v18, a98
    v_mul_f32 v18, v18, v252
    v_accvgpr_write_b32 a98, v18
    v_accvgpr_read_b32 v19, a99
    v_mul_f32 v19, v19, v253
    v_accvgpr_write_b32 a99, v19
    v_accvgpr_read_b32 v18, a100
    v_mul_f32 v18, v18, v250
    v_accvgpr_write_b32 a100, v18
    v_accvgpr_read_b32 v19, a101
    v_mul_f32 v19, v19, v251
    v_accvgpr_write_b32 a101, v19
    v_accvgpr_read_b32 v18, a102
    v_mul_f32 v18, v18, v252
    v_accvgpr_write_b32 a102, v18
    v_accvgpr_read_b32 v19, a103
    v_mul_f32 v19, v19, v253
    v_accvgpr_write_b32 a103, v19
    v_accvgpr_read_b32 v18, a104
    v_mul_f32 v18, v18, v250
    v_accvgpr_write_b32 a104, v18
    v_accvgpr_read_b32 v19, a105
    v_mul_f32 v19, v19, v251
    v_accvgpr_write_b32 a105, v19
    v_accvgpr_read_b32 v18, a106
    v_mul_f32 v18, v18, v252
    v_accvgpr_write_b32 a106, v18
    v_accvgpr_read_b32 v19, a107
    v_mul_f32 v19, v19, v253
    v_accvgpr_write_b32 a107, v19
    v_accvgpr_read_b32 v18, a108
    v_mul_f32 v18, v18, v250
    v_accvgpr_write_b32 a108, v18
    v_accvgpr_read_b32 v19, a109
    v_mul_f32 v19, v19, v251
    v_accvgpr_write_b32 a109, v19
    v_accvgpr_read_b32 v18, a110
    v_mul_f32 v18, v18, v252
    v_accvgpr_write_b32 a110, v18
    v_accvgpr_read_b32 v19, a111
    v_mul_f32 v19, v19, v253
    v_accvgpr_write_b32 a111, v19
    v_accvgpr_read_b32 v18, a112
    v_mul_f32 v18, v18, v250
    v_accvgpr_write_b32 a112, v18
    v_accvgpr_read_b32 v19, a113
    v_mul_f32 v19, v19, v251
    v_accvgpr_write_b32 a113, v19
    v_accvgpr_read_b32 v18, a114
    v_mul_f32 v18, v18, v252
    v_accvgpr_write_b32 a114, v18
    v_accvgpr_read_b32 v19, a115
    v_mul_f32 v19, v19, v253
    v_accvgpr_write_b32 a115, v19
    v_accvgpr_read_b32 v18, a116
    v_mul_f32 v18, v18, v250
    v_accvgpr_write_b32 a116, v18
    v_accvgpr_read_b32 v19, a117
    v_mul_f32 v19, v19, v251
    v_accvgpr_write_b32 a117, v19
    v_accvgpr_read_b32 v18, a118
    v_mul_f32 v18, v18, v252
    v_accvgpr_write_b32 a118, v18
    v_accvgpr_read_b32 v19, a119
    v_mul_f32 v19, v19, v253
    v_accvgpr_write_b32 a119, v19
    v_accvgpr_read_b32 v18, a120
    v_mul_f32 v18, v18, v250
    v_accvgpr_write_b32 a120, v18
    v_accvgpr_read_b32 v19, a121
    v_mul_f32 v19, v19, v251
    v_accvgpr_write_b32 a121, v19
    v_accvgpr_read_b32 v18, a122
    v_mul_f32 v18, v18, v252
    v_accvgpr_write_b32 a122, v18
    v_accvgpr_read_b32 v19, a123
    v_mul_f32 v19, v19, v253
    v_accvgpr_write_b32 a123, v19
    v_accvgpr_read_b32 v18, a124
    v_mul_f32 v18, v18, v250
    v_accvgpr_write_b32 a124, v18
    v_accvgpr_read_b32 v19, a125
    v_mul_f32 v19, v19, v251
    v_accvgpr_write_b32 a125, v19
    v_accvgpr_read_b32 v18, a126
    v_mul_f32 v18, v18, v252
    v_accvgpr_write_b32 a126, v18
    v_accvgpr_read_b32 v19, a127
    v_mul_f32 v19, v19, v253
    v_accvgpr_write_b32 a127, v19
    v_accvgpr_read_b32 v18, a128
    v_mul_f32 v18, v18, v250
    v_accvgpr_write_b32 a128, v18
    v_accvgpr_read_b32 v19, a129
    v_mul_f32 v19, v19, v251
    v_accvgpr_write_b32 a129, v19
    v_accvgpr_read_b32 v18, a130
    v_mul_f32 v18, v18, v252
    v_accvgpr_write_b32 a130, v18
    v_accvgpr_read_b32 v19, a131
    v_mul_f32 v19, v19, v253
    v_accvgpr_write_b32 a131, v19
    v_accvgpr_read_b32 v18, a132
    v_mul_f32 v18, v18, v250
    v_accvgpr_write_b32 a132, v18
    v_accvgpr_read_b32 v19, a133
    v_mul_f32 v19, v19, v251
    v_accvgpr_write_b32 a133, v19
    v_accvgpr_read_b32 v18, a134
    v_mul_f32 v18, v18, v252
    v_accvgpr_write_b32 a134, v18
    v_accvgpr_read_b32 v19, a135
    v_mul_f32 v19, v19, v253
    v_accvgpr_write_b32 a135, v19
    v_accvgpr_read_b32 v18, a136
    v_mul_f32 v18, v18, v250
    v_accvgpr_write_b32 a136, v18
    v_accvgpr_read_b32 v19, a137
    v_mul_f32 v19, v19, v251
    v_accvgpr_write_b32 a137, v19
    v_accvgpr_read_b32 v18, a138
    v_mul_f32 v18, v18, v252
    v_accvgpr_write_b32 a138, v18
    v_accvgpr_read_b32 v19, a139
    v_mul_f32 v19, v19, v253
    v_accvgpr_write_b32 a139, v19
    v_accvgpr_read_b32 v18, a140
    v_mul_f32 v18, v18, v250
    v_accvgpr_write_b32 a140, v18
    v_accvgpr_read_b32 v19, a141
    v_mul_f32 v19, v19, v251
    v_accvgpr_write_b32 a141, v19
    v_accvgpr_read_b32 v18, a142
    v_mul_f32 v18, v18, v252
    v_accvgpr_write_b32 a142, v18
    v_accvgpr_read_b32 v19, a143
    v_mul_f32 v19, v19, v253
    v_accvgpr_write_b32 a143, v19
    v_max3_f32 v16, v184, v185, v186
    v_max3_f32 v16, v16, v187, v188
    v_max3_f32 v16, v16, v189, v190
    v_max3_f32 v16, v16, v191, v243
    v_mov_b32 v17, v16
    s_nop 1
    v_permlane16_swap_b32 v16, v17
    s_nop 1
    v_max_f32 v16, v16, v17
    v_mov_b32 v17, v16
    s_nop 1
    v_permlane32_swap_b32 v16, v17
    s_nop 1
    v_max_f32 v16, v16, v17
    v_sub_f32 v17, v243, v16
    v_exp_f32 v17, v17
    v_mov_b32 v243, v16
    ds_bpermute_b32 v250, v62, v17 offset:0
    ds_bpermute_b32 v251, v62, v17 offset:4
    ds_bpermute_b32 v252, v62, v17 offset:8
    ds_bpermute_b32 v253, v62, v17 offset:12
    v_sub_f32 v184, v184, v16
    v_sub_f32 v185, v185, v16
    v_sub_f32 v186, v186, v16
    v_sub_f32 v187, v187, v16
    v_sub_f32 v188, v188, v16
    v_sub_f32 v189, v189, v16
    v_sub_f32 v190, v190, v16
    v_sub_f32 v191, v191, v16
    v_exp_f32 v184, v184
    v_exp_f32 v185, v185
    v_exp_f32 v186, v186
    v_exp_f32 v187, v187
    v_exp_f32 v188, v188
    v_exp_f32 v189, v189
    v_exp_f32 v190, v190
    v_exp_f32 v191, v191
    v_mul_f32 v8, v8, v17
    v_add_f32 v8, v8, v184
    v_add_f32 v8, v8, v185
    v_add_f32 v8, v8, v186
    v_add_f32 v8, v8, v187
    v_add_f32 v8, v8, v188
    v_add_f32 v8, v8, v189
    v_add_f32 v8, v8, v190
    v_add_f32 v8, v8, v191
    v_cvt_pk_bf16_f32 v236, v184, v185
    v_cvt_pk_bf16_f32 v237, v186, v187
    v_cvt_pk_bf16_f32 v238, v188, v189
    v_cvt_pk_bf16_f32 v239, v190, v191
    s_waitcnt lgkmcnt(0)
    v_accvgpr_read_b32 v18, a144
    v_mul_f32 v18, v18, v250
    v_accvgpr_write_b32 a144, v18
    v_accvgpr_read_b32 v19, a145
    v_mul_f32 v19, v19, v251
    v_accvgpr_write_b32 a145, v19
    v_accvgpr_read_b32 v18, a146
    v_mul_f32 v18, v18, v252
    v_accvgpr_write_b32 a146, v18
    v_accvgpr_read_b32 v19, a147
    v_mul_f32 v19, v19, v253
    v_accvgpr_write_b32 a147, v19
    v_accvgpr_read_b32 v18, a148
    v_mul_f32 v18, v18, v250
    v_accvgpr_write_b32 a148, v18
    v_accvgpr_read_b32 v19, a149
    v_mul_f32 v19, v19, v251
    v_accvgpr_write_b32 a149, v19
    v_accvgpr_read_b32 v18, a150
    v_mul_f32 v18, v18, v252
    v_accvgpr_write_b32 a150, v18
    v_accvgpr_read_b32 v19, a151
    v_mul_f32 v19, v19, v253
    v_accvgpr_write_b32 a151, v19
    v_accvgpr_read_b32 v18, a152
    v_mul_f32 v18, v18, v250
    v_accvgpr_write_b32 a152, v18
    v_accvgpr_read_b32 v19, a153
    v_mul_f32 v19, v19, v251
    v_accvgpr_write_b32 a153, v19
    v_accvgpr_read_b32 v18, a154
    v_mul_f32 v18, v18, v252
    v_accvgpr_write_b32 a154, v18
    v_accvgpr_read_b32 v19, a155
    v_mul_f32 v19, v19, v253
    v_accvgpr_write_b32 a155, v19
    v_accvgpr_read_b32 v18, a156
    v_mul_f32 v18, v18, v250
    v_accvgpr_write_b32 a156, v18
    v_accvgpr_read_b32 v19, a157
    v_mul_f32 v19, v19, v251
    v_accvgpr_write_b32 a157, v19
    v_accvgpr_read_b32 v18, a158
    v_mul_f32 v18, v18, v252
    v_accvgpr_write_b32 a158, v18
    v_accvgpr_read_b32 v19, a159
    v_mul_f32 v19, v19, v253
    v_accvgpr_write_b32 a159, v19
    v_accvgpr_read_b32 v18, a160
    v_mul_f32 v18, v18, v250
    v_accvgpr_write_b32 a160, v18
    v_accvgpr_read_b32 v19, a161
    v_mul_f32 v19, v19, v251
    v_accvgpr_write_b32 a161, v19
    v_accvgpr_read_b32 v18, a162
    v_mul_f32 v18, v18, v252
    v_accvgpr_write_b32 a162, v18
    v_accvgpr_read_b32 v19, a163
    v_mul_f32 v19, v19, v253
    v_accvgpr_write_b32 a163, v19
    v_accvgpr_read_b32 v18, a164
    v_mul_f32 v18, v18, v250
    v_accvgpr_write_b32 a164, v18
    v_accvgpr_read_b32 v19, a165
    v_mul_f32 v19, v19, v251
    v_accvgpr_write_b32 a165, v19
    v_accvgpr_read_b32 v18, a166
    v_mul_f32 v18, v18, v252
    v_accvgpr_write_b32 a166, v18
    v_accvgpr_read_b32 v19, a167
    v_mul_f32 v19, v19, v253
    v_accvgpr_write_b32 a167, v19
    v_accvgpr_read_b32 v18, a168
    v_mul_f32 v18, v18, v250
    v_accvgpr_write_b32 a168, v18
    v_accvgpr_read_b32 v19, a169
    v_mul_f32 v19, v19, v251
    v_accvgpr_write_b32 a169, v19
    v_accvgpr_read_b32 v18, a170
    v_mul_f32 v18, v18, v252
    v_accvgpr_write_b32 a170, v18
    v_accvgpr_read_b32 v19, a171
    v_mul_f32 v19, v19, v253
    v_accvgpr_write_b32 a171, v19
    v_accvgpr_read_b32 v18, a172
    v_mul_f32 v18, v18, v250
    v_accvgpr_write_b32 a172, v18
    v_accvgpr_read_b32 v19, a173
    v_mul_f32 v19, v19, v251
    v_accvgpr_write_b32 a173, v19
    v_accvgpr_read_b32 v18, a174
    v_mul_f32 v18, v18, v252
    v_accvgpr_write_b32 a174, v18
    v_accvgpr_read_b32 v19, a175
    v_mul_f32 v19, v19, v253
    v_accvgpr_write_b32 a175, v19
    v_accvgpr_read_b32 v18, a176
    v_mul_f32 v18, v18, v250
    v_accvgpr_write_b32 a176, v18
    v_accvgpr_read_b32 v19, a177
    v_mul_f32 v19, v19, v251
    v_accvgpr_write_b32 a177, v19
    v_accvgpr_read_b32 v18, a178
    v_mul_f32 v18, v18, v252
    v_accvgpr_write_b32 a178, v18
    v_accvgpr_read_b32 v19, a179
    v_mul_f32 v19, v19, v253
    v_accvgpr_write_b32 a179, v19
    v_accvgpr_read_b32 v18, a180
    v_mul_f32 v18, v18, v250
    v_accvgpr_write_b32 a180, v18
    v_accvgpr_read_b32 v19, a181
    v_mul_f32 v19, v19, v251
    v_accvgpr_write_b32 a181, v19
    v_accvgpr_read_b32 v18, a182
    v_mul_f32 v18, v18, v252
    v_accvgpr_write_b32 a182, v18
    v_accvgpr_read_b32 v19, a183
    v_mul_f32 v19, v19, v253
    v_accvgpr_write_b32 a183, v19
    v_accvgpr_read_b32 v18, a184
    v_mul_f32 v18, v18, v250
    v_accvgpr_write_b32 a184, v18
    v_accvgpr_read_b32 v19, a185
    v_mul_f32 v19, v19, v251
    v_accvgpr_write_b32 a185, v19
    v_accvgpr_read_b32 v18, a186
    v_mul_f32 v18, v18, v252
    v_accvgpr_write_b32 a186, v18
    v_accvgpr_read_b32 v19, a187
    v_mul_f32 v19, v19, v253
    v_accvgpr_write_b32 a187, v19
    v_accvgpr_read_b32 v18, a188
    v_mul_f32 v18, v18, v250
    v_accvgpr_write_b32 a188, v18
    v_accvgpr_read_b32 v19, a189
    v_mul_f32 v19, v19, v251
    v_accvgpr_write_b32 a189, v19
    v_accvgpr_read_b32 v18, a190
    v_mul_f32 v18, v18, v252
    v_accvgpr_write_b32 a190, v18
    v_accvgpr_read_b32 v19, a191
    v_mul_f32 v19, v19, v253
    v_accvgpr_write_b32 a191, v19
    s_waitcnt vmcnt(0)
    s_nop 1
    v_mfma_f32_16x16x32_bf16 a[0:3], v[224:227], v[112:115], a[0:3]
    v_mfma_f32_16x16x32_bf16 a[48:51], v[228:231], v[112:115], a[48:51]
    v_mfma_f32_16x16x32_bf16 a[96:99], v[232:235], v[112:115], a[96:99]
    v_mfma_f32_16x16x32_bf16 a[144:147], v[236:239], v[112:115], a[144:147]
    v_mfma_f32_16x16x32_bf16 a[4:7], v[224:227], v[116:119], a[4:7]
    v_mfma_f32_16x16x32_bf16 a[52:55], v[228:231], v[116:119], a[52:55]
    v_mfma_f32_16x16x32_bf16 a[100:103], v[232:235], v[116:119], a[100:103]
    v_mfma_f32_16x16x32_bf16 a[148:151], v[236:239], v[116:119], a[148:151]
    v_mfma_f32_16x16x32_bf16 a[8:11], v[224:227], v[120:123], a[8:11]
    v_mfma_f32_16x16x32_bf16 a[56:59], v[228:231], v[120:123], a[56:59]
    v_mfma_f32_16x16x32_bf16 a[104:107], v[232:235], v[120:123], a[104:107]
    v_mfma_f32_16x16x32_bf16 a[152:155], v[236:239], v[120:123], a[152:155]
    v_mfma_f32_16x16x32_bf16 a[12:15], v[224:227], v[124:127], a[12:15]
    v_mfma_f32_16x16x32_bf16 a[60:63], v[228:231], v[124:127], a[60:63]
    v_mfma_f32_16x16x32_bf16 a[108:111], v[232:235], v[124:127], a[108:111]
    v_mfma_f32_16x16x32_bf16 a[156:159], v[236:239], v[124:127], a[156:159]
    v_mfma_f32_16x16x32_bf16 a[16:19], v[224:227], v[128:131], a[16:19]
    v_mfma_f32_16x16x32_bf16 a[64:67], v[228:231], v[128:131], a[64:67]
    v_mfma_f32_16x16x32_bf16 a[112:115], v[232:235], v[128:131], a[112:115]
    v_mfma_f32_16x16x32_bf16 a[160:163], v[236:239], v[128:131], a[160:163]
    v_mfma_f32_16x16x32_bf16 a[20:23], v[224:227], v[132:135], a[20:23]
    v_mfma_f32_16x16x32_bf16 a[68:71], v[228:231], v[132:135], a[68:71]
    v_mfma_f32_16x16x32_bf16 a[116:119], v[232:235], v[132:135], a[116:119]
    v_mfma_f32_16x16x32_bf16 a[164:167], v[236:239], v[132:135], a[164:167]
    v_mfma_f32_16x16x32_bf16 a[24:27], v[224:227], v[136:139], a[24:27]
    v_mfma_f32_16x16x32_bf16 a[72:75], v[228:231], v[136:139], a[72:75]
    v_mfma_f32_16x16x32_bf16 a[120:123], v[232:235], v[136:139], a[120:123]
    v_mfma_f32_16x16x32_bf16 a[168:171], v[236:239], v[136:139], a[168:171]
    v_mfma_f32_16x16x32_bf16 a[28:31], v[224:227], v[140:143], a[28:31]
    v_mfma_f32_16x16x32_bf16 a[76:79], v[228:231], v[140:143], a[76:79]
    v_mfma_f32_16x16x32_bf16 a[124:127], v[232:235], v[140:143], a[124:127]
    v_mfma_f32_16x16x32_bf16 a[172:175], v[236:239], v[140:143], a[172:175]
    v_mfma_f32_16x16x32_bf16 a[32:35], v[224:227], v[144:147], a[32:35]
    v_mfma_f32_16x16x32_bf16 a[80:83], v[228:231], v[144:147], a[80:83]
    v_mfma_f32_16x16x32_bf16 a[128:131], v[232:235], v[144:147], a[128:131]
    v_mfma_f32_16x16x32_bf16 a[176:179], v[236:239], v[144:147], a[176:179]
    v_mfma_f32_16x16x32_bf16 a[36:39], v[224:227], v[148:151], a[36:39]
    v_mfma_f32_16x16x32_bf16 a[84:87], v[228:231], v[148:151], a[84:87]
    v_mfma_f32_16x16x32_bf16 a[132:135], v[232:235], v[148:151], a[132:135]
    v_mfma_f32_16x16x32_bf16 a[180:183], v[236:239], v[148:151], a[180:183]
    v_mfma_f32_16x16x32_bf16 a[40:43], v[224:227], v[152:155], a[40:43]
    v_mfma_f32_16x16x32_bf16 a[88:91], v[228:231], v[152:155], a[88:91]
    v_mfma_f32_16x16x32_bf16 a[136:139], v[232:235], v[152:155], a[136:139]
    v_mfma_f32_16x16x32_bf16 a[184:187], v[236:239], v[152:155], a[184:187]
    v_mfma_f32_16x16x32_bf16 a[44:47], v[224:227], v[156:159], a[44:47]
    v_mfma_f32_16x16x32_bf16 a[92:95], v[228:231], v[156:159], a[92:95]
    v_mfma_f32_16x16x32_bf16 a[140:143], v[232:235], v[156:159], a[140:143]
    v_mfma_f32_16x16x32_bf16 a[188:191], v[236:239], v[156:159], a[188:191]
    s_add_u32 s48, s48, 24576
    s_cmp_lt_u32 s48, 1572864
    s_nop 7
    s_cbranch_scc1 L_slowloop
    v_mov_b32 v20, v5
    v_mov_b32 v23, v6
    s_nop 0
    v_permlane16_swap_b32 v5, v20
    v_permlane16_swap_b32 v6, v23
    s_nop 0
    v_add_f32 v5, v5, v20
    v_add_f32 v6, v6, v23
    v_mov_b32 v20, v5
    v_mov_b32 v23, v6
    s_nop 0
    v_permlane32_swap_b32 v5, v20
    v_permlane32_swap_b32 v6, v23
    s_nop 0
    v_add_f32 v5, v5, v20
    v_add_f32 v6, v6, v23
    v_rcp_f32 v20, v5
    v_rcp_f32 v23, v6
    s_nop 0
    ds_bpermute_b32 v48, v62, v20 offset:0
    ds_bpermute_b32 v49, v62, v20 offset:4
    ds_bpermute_b32 v50, v62, v20 offset:8
    ds_bpermute_b32 v51, v62, v20 offset:12
    ds_bpermute_b32 v52, v62, v23 offset:0
    ds_bpermute_b32 v53, v62, v23 offset:4
    ds_bpermute_b32 v54, v62, v23 offset:8
    ds_bpermute_b32 v55, v62, v23 offset:12
    v_mov_b32 v20, v7
    v_mov_b32 v23, v8
    s_nop 0
    v_permlane16_swap_b32 v7, v20
    v_permlane16_swap_b32 v8, v23
    s_nop 0
    v_add_f32 v7, v7, v20
    v_add_f32 v8, v8, v23
    v_mov_b32 v20, v7
    v_mov_b32 v23, v8
    s_nop 0
    v_permlane32_swap_b32 v7, v20
    v_permlane32_swap_b32 v8, v23
    s_nop 0
    v_add_f32 v7, v7, v20
    v_add_f32 v8, v8, v23
    v_rcp_f32 v20, v7
    v_rcp_f32 v23, v8
    s_nop 0
    ds_bpermute_b32 v56, v62, v20 offset:0
    ds_bpermute_b32 v57, v62, v20 offset:4
    ds_bpermute_b32 v58, v62, v20 offset:8
    ds_bpermute_b32 v59, v62, v20 offset:12
    ds_bpermute_b32 v128, v62, v23 offset:0
    ds_bpermute_b32 v129, v62, v23 offset:4
    ds_bpermute_b32 v130, v62, v23 offset:8
    ds_bpermute_b32 v131, v62, v23 offset:12
    s_waitcnt lgkmcnt(12)
    v_accvgpr_read_b32 v64, a0
    v_accvgpr_read_b32 v65, a4
    v_accvgpr_read_b32 v66, a8
    v_accvgpr_read_b32 v67, a12
    v_accvgpr_read_b32 v68, a16
    v_accvgpr_read_b32 v69, a20
    v_accvgpr_read_b32 v70, a24
    v_accvgpr_read_b32 v71, a28
    v_accvgpr_read_b32 v72, a32
    v_accvgpr_read_b32 v73, a36
    v_accvgpr_read_b32 v74, a40
    v_accvgpr_read_b32 v75, a44
    v_pk_mul_f32 v[64:65], v[64:65], v[48:49] op_sel:[0,0] op_sel_hi:[1,0]
    v_pk_mul_f32 v[66:67], v[66:67], v[48:49] op_sel:[0,0] op_sel_hi:[1,0]
    v_pk_mul_f32 v[68:69], v[68:69], v[48:49] op_sel:[0,0] op_sel_hi:[1,0]
    v_pk_mul_f32 v[70:71], v[70:71], v[48:49] op_sel:[0,0] op_sel_hi:[1,0]
    v_pk_mul_f32 v[72:73], v[72:73], v[48:49] op_sel:[0,0] op_sel_hi:[1,0]
    v_pk_mul_f32 v[74:75], v[74:75], v[48:49] op_sel:[0,0] op_sel_hi:[1,0]
    v_cvt_pk_bf16_f32 v64, v64, v65
    v_cvt_pk_bf16_f32 v65, v66, v67
    v_cvt_pk_bf16_f32 v66, v68, v69
    v_cvt_pk_bf16_f32 v67, v70, v71
    v_cvt_pk_bf16_f32 v68, v72, v73
    v_cvt_pk_bf16_f32 v69, v74, v75
    buffer_store_dwordx4 v[64:67], v60, s[12:15], s33 offen offset:0 sc0 sc1
    buffer_store_dwordx2 v[68:69], v61, s[12:15], s33 offen offset:256 sc0 sc1
    v_accvgpr_read_b32 v76, a1
    v_accvgpr_read_b32 v77, a5
    v_accvgpr_read_b32 v78, a9
    v_accvgpr_read_b32 v79, a13
    v_accvgpr_read_b32 v80, a17
    v_accvgpr_read_b32 v81, a21
    v_accvgpr_read_b32 v82, a25
    v_accvgpr_read_b32 v83, a29
    v_accvgpr_read_b32 v84, a33
    v_accvgpr_read_b32 v85, a37
    v_accvgpr_read_b32 v86, a41
    v_accvgpr_read_b32 v87, a45
    v_pk_mul_f32 v[76:77], v[76:77], v[48:49] op_sel:[0,1] op_sel_hi:[1,1]
    v_pk_mul_f32 v[78:79], v[78:79], v[48:49] op_sel:[0,1] op_sel_hi:[1,1]
    v_pk_mul_f32 v[80:81], v[80:81], v[48:49] op_sel:[0,1] op_sel_hi:[1,1]
    v_pk_mul_f32 v[82:83], v[82:83], v[48:49] op_sel:[0,1] op_sel_hi:[1,1]
    v_pk_mul_f32 v[84:85], v[84:85], v[48:49] op_sel:[0,1] op_sel_hi:[1,1]
    v_pk_mul_f32 v[86:87], v[86:87], v[48:49] op_sel:[0,1] op_sel_hi:[1,1]
    v_cvt_pk_bf16_f32 v76, v76, v77
    v_cvt_pk_bf16_f32 v77, v78, v79
    v_cvt_pk_bf16_f32 v78, v80, v81
    v_cvt_pk_bf16_f32 v79, v82, v83
    v_cvt_pk_bf16_f32 v80, v84, v85
    v_cvt_pk_bf16_f32 v81, v86, v87
    buffer_store_dwordx4 v[76:79], v60, s[12:15], s33 offen offset:384 sc0 sc1
    buffer_store_dwordx2 v[80:81], v61, s[12:15], s33 offen offset:640 sc0 sc1
    v_accvgpr_read_b32 v88, a2
    v_accvgpr_read_b32 v89, a6
    v_accvgpr_read_b32 v90, a10
    v_accvgpr_read_b32 v91, a14
    v_accvgpr_read_b32 v92, a18
    v_accvgpr_read_b32 v93, a22
    v_accvgpr_read_b32 v94, a26
    v_accvgpr_read_b32 v95, a30
    v_accvgpr_read_b32 v96, a34
    v_accvgpr_read_b32 v97, a38
    v_accvgpr_read_b32 v98, a42
    v_accvgpr_read_b32 v99, a46
    v_pk_mul_f32 v[88:89], v[88:89], v[50:51] op_sel:[0,0] op_sel_hi:[1,0]
    v_pk_mul_f32 v[90:91], v[90:91], v[50:51] op_sel:[0,0] op_sel_hi:[1,0]
    v_pk_mul_f32 v[92:93], v[92:93], v[50:51] op_sel:[0,0] op_sel_hi:[1,0]
    v_pk_mul_f32 v[94:95], v[94:95], v[50:51] op_sel:[0,0] op_sel_hi:[1,0]
    v_pk_mul_f32 v[96:97], v[96:97], v[50:51] op_sel:[0,0] op_sel_hi:[1,0]
    v_pk_mul_f32 v[98:99], v[98:99], v[50:51] op_sel:[0,0] op_sel_hi:[1,0]
    v_cvt_pk_bf16_f32 v88, v88, v89
    v_cvt_pk_bf16_f32 v89, v90, v91
    v_cvt_pk_bf16_f32 v90, v92, v93
    v_cvt_pk_bf16_f32 v91, v94, v95
    v_cvt_pk_bf16_f32 v92, v96, v97
    v_cvt_pk_bf16_f32 v93, v98, v99
    buffer_store_dwordx4 v[88:91], v60, s[12:15], s33 offen offset:768 sc0 sc1
    buffer_store_dwordx2 v[92:93], v61, s[12:15], s33 offen offset:1024 sc0 sc1
    v_accvgpr_read_b32 v100, a3
    v_accvgpr_read_b32 v101, a7
    v_accvgpr_read_b32 v102, a11
    v_accvgpr_read_b32 v103, a15
    v_accvgpr_read_b32 v104, a19
    v_accvgpr_read_b32 v105, a23
    v_accvgpr_read_b32 v106, a27
    v_accvgpr_read_b32 v107, a31
    v_accvgpr_read_b32 v108, a35
    v_accvgpr_read_b32 v109, a39
    v_accvgpr_read_b32 v110, a43
    v_accvgpr_read_b32 v111, a47
    v_pk_mul_f32 v[100:101], v[100:101], v[50:51] op_sel:[0,1] op_sel_hi:[1,1]
    v_pk_mul_f32 v[102:103], v[102:103], v[50:51] op_sel:[0,1] op_sel_hi:[1,1]
    v_pk_mul_f32 v[104:105], v[104:105], v[50:51] op_sel:[0,1] op_sel_hi:[1,1]
    v_pk_mul_f32 v[106:107], v[106:107], v[50:51] op_sel:[0,1] op_sel_hi:[1,1]
    v_pk_mul_f32 v[108:109], v[108:109], v[50:51] op_sel:[0,1] op_sel_hi:[1,1]
    v_pk_mul_f32 v[110:111], v[110:111], v[50:51] op_sel:[0,1] op_sel_hi:[1,1]
    v_cvt_pk_bf16_f32 v100, v100, v101
    v_cvt_pk_bf16_f32 v101, v102, v103
    v_cvt_pk_bf16_f32 v102, v104, v105
    v_cvt_pk_bf16_f32 v103, v106, v107
    v_cvt_pk_bf16_f32 v104, v108, v109
    v_cvt_pk_bf16_f32 v105, v110, v111
    buffer_store_dwordx4 v[100:103], v60, s[12:15], s33 offen offset:1152 sc0 sc1
    buffer_store_dwordx2 v[104:105], v61, s[12:15], s33 offen offset:1408 sc0 sc1
    s_waitcnt lgkmcnt(8)
    v_accvgpr_read_b32 v112, a48
    v_accvgpr_read_b32 v113, a52
    v_accvgpr_read_b32 v114, a56
    v_accvgpr_read_b32 v115, a60
    v_accvgpr_read_b32 v116, a64
    v_accvgpr_read_b32 v117, a68
    v_accvgpr_read_b32 v118, a72
    v_accvgpr_read_b32 v119, a76
    v_accvgpr_read_b32 v120, a80
    v_accvgpr_read_b32 v121, a84
    v_accvgpr_read_b32 v122, a88
    v_accvgpr_read_b32 v123, a92
    v_pk_mul_f32 v[112:113], v[112:113], v[52:53] op_sel:[0,0] op_sel_hi:[1,0]
    v_pk_mul_f32 v[114:115], v[114:115], v[52:53] op_sel:[0,0] op_sel_hi:[1,0]
    v_pk_mul_f32 v[116:117], v[116:117], v[52:53] op_sel:[0,0] op_sel_hi:[1,0]
    v_pk_mul_f32 v[118:119], v[118:119], v[52:53] op_sel:[0,0] op_sel_hi:[1,0]
    v_pk_mul_f32 v[120:121], v[120:121], v[52:53] op_sel:[0,0] op_sel_hi:[1,0]
    v_pk_mul_f32 v[122:123], v[122:123], v[52:53] op_sel:[0,0] op_sel_hi:[1,0]
    v_cvt_pk_bf16_f32 v112, v112, v113
    v_cvt_pk_bf16_f32 v113, v114, v115
    v_cvt_pk_bf16_f32 v114, v116, v117
    v_cvt_pk_bf16_f32 v115, v118, v119
    v_cvt_pk_bf16_f32 v116, v120, v121
    v_cvt_pk_bf16_f32 v117, v122, v123
    buffer_store_dwordx4 v[112:115], v60, s[12:15], s34 offen offset:0 sc0 sc1
    buffer_store_dwordx2 v[116:117], v61, s[12:15], s34 offen offset:256 sc0 sc1
    v_accvgpr_read_b32 v64, a49
    v_accvgpr_read_b32 v65, a53
    v_accvgpr_read_b32 v66, a57
    v_accvgpr_read_b32 v67, a61
    v_accvgpr_read_b32 v68, a65
    v_accvgpr_read_b32 v69, a69
    v_accvgpr_read_b32 v70, a73
    v_accvgpr_read_b32 v71, a77
    v_accvgpr_read_b32 v72, a81
    v_accvgpr_read_b32 v73, a85
    v_accvgpr_read_b32 v74, a89
    v_accvgpr_read_b32 v75, a93
    v_pk_mul_f32 v[64:65], v[64:65], v[52:53] op_sel:[0,1] op_sel_hi:[1,1]
    v_pk_mul_f32 v[66:67], v[66:67], v[52:53] op_sel:[0,1] op_sel_hi:[1,1]
    v_pk_mul_f32 v[68:69], v[68:69], v[52:53] op_sel:[0,1] op_sel_hi:[1,1]
    v_pk_mul_f32 v[70:71], v[70:71], v[52:53] op_sel:[0,1] op_sel_hi:[1,1]
    v_pk_mul_f32 v[72:73], v[72:73], v[52:53] op_sel:[0,1] op_sel_hi:[1,1]
    v_pk_mul_f32 v[74:75], v[74:75], v[52:53] op_sel:[0,1] op_sel_hi:[1,1]
    v_cvt_pk_bf16_f32 v64, v64, v65
    v_cvt_pk_bf16_f32 v65, v66, v67
    v_cvt_pk_bf16_f32 v66, v68, v69
    v_cvt_pk_bf16_f32 v67, v70, v71
    v_cvt_pk_bf16_f32 v68, v72, v73
    v_cvt_pk_bf16_f32 v69, v74, v75
    buffer_store_dwordx4 v[64:67], v60, s[12:15], s34 offen offset:384 sc0 sc1
    buffer_store_dwordx2 v[68:69], v61, s[12:15], s34 offen offset:640 sc0 sc1
    v_accvgpr_read_b32 v76, a50
    v_accvgpr_read_b32 v77, a54
    v_accvgpr_read_b32 v78, a58
    v_accvgpr_read_b32 v79, a62
    v_accvgpr_read_b32 v80, a66
    v_accvgpr_read_b32 v81, a70
    v_accvgpr_read_b32 v82, a74
    v_accvgpr_read_b32 v83, a78
    v_accvgpr_read_b32 v84, a82
    v_accvgpr_read_b32 v85, a86
    v_accvgpr_read_b32 v86, a90
    v_accvgpr_read_b32 v87, a94
    v_pk_mul_f32 v[76:77], v[76:77], v[54:55] op_sel:[0,0] op_sel_hi:[1,0]
    v_pk_mul_f32 v[78:79], v[78:79], v[54:55] op_sel:[0,0] op_sel_hi:[1,0]
    v_pk_mul_f32 v[80:81], v[80:81], v[54:55] op_sel:[0,0] op_sel_hi:[1,0]
    v_pk_mul_f32 v[82:83], v[82:83], v[54:55] op_sel:[0,0] op_sel_hi:[1,0]
    v_pk_mul_f32 v[84:85], v[84:85], v[54:55] op_sel:[0,0] op_sel_hi:[1,0]
    v_pk_mul_f32 v[86:87], v[86:87], v[54:55] op_sel:[0,0] op_sel_hi:[1,0]
    v_cvt_pk_bf16_f32 v76, v76, v77
    v_cvt_pk_bf16_f32 v77, v78, v79
    v_cvt_pk_bf16_f32 v78, v80, v81
    v_cvt_pk_bf16_f32 v79, v82, v83
    v_cvt_pk_bf16_f32 v80, v84, v85
    v_cvt_pk_bf16_f32 v81, v86, v87
    buffer_store_dwordx4 v[76:79], v60, s[12:15], s34 offen offset:768 sc0 sc1
    buffer_store_dwordx2 v[80:81], v61, s[12:15], s34 offen offset:1024 sc0 sc1
    v_accvgpr_read_b32 v88, a51
    v_accvgpr_read_b32 v89, a55
    v_accvgpr_read_b32 v90, a59
    v_accvgpr_read_b32 v91, a63
    v_accvgpr_read_b32 v92, a67
    v_accvgpr_read_b32 v93, a71
    v_accvgpr_read_b32 v94, a75
    v_accvgpr_read_b32 v95, a79
    v_accvgpr_read_b32 v96, a83
    v_accvgpr_read_b32 v97, a87
    v_accvgpr_read_b32 v98, a91
    v_accvgpr_read_b32 v99, a95
    v_pk_mul_f32 v[88:89], v[88:89], v[54:55] op_sel:[0,1] op_sel_hi:[1,1]
    v_pk_mul_f32 v[90:91], v[90:91], v[54:55] op_sel:[0,1] op_sel_hi:[1,1]
    v_pk_mul_f32 v[92:93], v[92:93], v[54:55] op_sel:[0,1] op_sel_hi:[1,1]
    v_pk_mul_f32 v[94:95], v[94:95], v[54:55] op_sel:[0,1] op_sel_hi:[1,1]
    v_pk_mul_f32 v[96:97], v[96:97], v[54:55] op_sel:[0,1] op_sel_hi:[1,1]
    v_pk_mul_f32 v[98:99], v[98:99], v[54:55] op_sel:[0,1] op_sel_hi:[1,1]
    v_cvt_pk_bf16_f32 v88, v88, v89
    v_cvt_pk_bf16_f32 v89, v90, v91
    v_cvt_pk_bf16_f32 v90, v92, v93
    v_cvt_pk_bf16_f32 v91, v94, v95
    v_cvt_pk_bf16_f32 v92, v96, v97
    v_cvt_pk_bf16_f32 v93, v98, v99
    buffer_store_dwordx4 v[88:91], v60, s[12:15], s34 offen offset:1152 sc0 sc1
    buffer_store_dwordx2 v[92:93], v61, s[12:15], s34 offen offset:1408 sc0 sc1
    s_waitcnt lgkmcnt(4)
    v_accvgpr_read_b32 v100, a96
    v_accvgpr_read_b32 v101, a100
    v_accvgpr_read_b32 v102, a104
    v_accvgpr_read_b32 v103, a108
    v_accvgpr_read_b32 v104, a112
    v_accvgpr_read_b32 v105, a116
    v_accvgpr_read_b32 v106, a120
    v_accvgpr_read_b32 v107, a124
    v_accvgpr_read_b32 v108, a128
    v_accvgpr_read_b32 v109, a132
    v_accvgpr_read_b32 v110, a136
    v_accvgpr_read_b32 v111, a140
    v_pk_mul_f32 v[100:101], v[100:101], v[56:57] op_sel:[0,0] op_sel_hi:[1,0]
    v_pk_mul_f32 v[102:103], v[102:103], v[56:57] op_sel:[0,0] op_sel_hi:[1,0]
    v_pk_mul_f32 v[104:105], v[104:105], v[56:57] op_sel:[0,0] op_sel_hi:[1,0]
    v_pk_mul_f32 v[106:107], v[106:107], v[56:57] op_sel:[0,0] op_sel_hi:[1,0]
    v_pk_mul_f32 v[108:109], v[108:109], v[56:57] op_sel:[0,0] op_sel_hi:[1,0]
    v_pk_mul_f32 v[110:111], v[110:111], v[56:57] op_sel:[0,0] op_sel_hi:[1,0]
    v_cvt_pk_bf16_f32 v100, v100, v101
    v_cvt_pk_bf16_f32 v101, v102, v103
    v_cvt_pk_bf16_f32 v102, v104, v105
    v_cvt_pk_bf16_f32 v103, v106, v107
    v_cvt_pk_bf16_f32 v104, v108, v109
    v_cvt_pk_bf16_f32 v105, v110, v111
    buffer_store_dwordx4 v[100:103], v60, s[12:15], s35 offen offset:0 sc0 sc1
    buffer_store_dwordx2 v[104:105], v61, s[12:15], s35 offen offset:256 sc0 sc1
    v_accvgpr_read_b32 v112, a97
    v_accvgpr_read_b32 v113, a101
    v_accvgpr_read_b32 v114, a105
    v_accvgpr_read_b32 v115, a109
    v_accvgpr_read_b32 v116, a113
    v_accvgpr_read_b32 v117, a117
    v_accvgpr_read_b32 v118, a121
    v_accvgpr_read_b32 v119, a125
    v_accvgpr_read_b32 v120, a129
    v_accvgpr_read_b32 v121, a133
    v_accvgpr_read_b32 v122, a137
    v_accvgpr_read_b32 v123, a141
    v_pk_mul_f32 v[112:113], v[112:113], v[56:57] op_sel:[0,1] op_sel_hi:[1,1]
    v_pk_mul_f32 v[114:115], v[114:115], v[56:57] op_sel:[0,1] op_sel_hi:[1,1]
    v_pk_mul_f32 v[116:117], v[116:117], v[56:57] op_sel:[0,1] op_sel_hi:[1,1]
    v_pk_mul_f32 v[118:119], v[118:119], v[56:57] op_sel:[0,1] op_sel_hi:[1,1]
    v_pk_mul_f32 v[120:121], v[120:121], v[56:57] op_sel:[0,1] op_sel_hi:[1,1]
    v_pk_mul_f32 v[122:123], v[122:123], v[56:57] op_sel:[0,1] op_sel_hi:[1,1]
    v_cvt_pk_bf16_f32 v112, v112, v113
    v_cvt_pk_bf16_f32 v113, v114, v115
    v_cvt_pk_bf16_f32 v114, v116, v117
    v_cvt_pk_bf16_f32 v115, v118, v119
    v_cvt_pk_bf16_f32 v116, v120, v121
    v_cvt_pk_bf16_f32 v117, v122, v123
    buffer_store_dwordx4 v[112:115], v60, s[12:15], s35 offen offset:384 sc0 sc1
    buffer_store_dwordx2 v[116:117], v61, s[12:15], s35 offen offset:640 sc0 sc1
    v_accvgpr_read_b32 v64, a98
    v_accvgpr_read_b32 v65, a102
    v_accvgpr_read_b32 v66, a106
    v_accvgpr_read_b32 v67, a110
    v_accvgpr_read_b32 v68, a114
    v_accvgpr_read_b32 v69, a118
    v_accvgpr_read_b32 v70, a122
    v_accvgpr_read_b32 v71, a126
    v_accvgpr_read_b32 v72, a130
    v_accvgpr_read_b32 v73, a134
    v_accvgpr_read_b32 v74, a138
    v_accvgpr_read_b32 v75, a142
    v_pk_mul_f32 v[64:65], v[64:65], v[58:59] op_sel:[0,0] op_sel_hi:[1,0]
    v_pk_mul_f32 v[66:67], v[66:67], v[58:59] op_sel:[0,0] op_sel_hi:[1,0]
    v_pk_mul_f32 v[68:69], v[68:69], v[58:59] op_sel:[0,0] op_sel_hi:[1,0]
    v_pk_mul_f32 v[70:71], v[70:71], v[58:59] op_sel:[0,0] op_sel_hi:[1,0]
    v_pk_mul_f32 v[72:73], v[72:73], v[58:59] op_sel:[0,0] op_sel_hi:[1,0]
    v_pk_mul_f32 v[74:75], v[74:75], v[58:59] op_sel:[0,0] op_sel_hi:[1,0]
    v_cvt_pk_bf16_f32 v64, v64, v65
    v_cvt_pk_bf16_f32 v65, v66, v67
    v_cvt_pk_bf16_f32 v66, v68, v69
    v_cvt_pk_bf16_f32 v67, v70, v71
    v_cvt_pk_bf16_f32 v68, v72, v73
    v_cvt_pk_bf16_f32 v69, v74, v75
    buffer_store_dwordx4 v[64:67], v60, s[12:15], s35 offen offset:768 sc0 sc1
    buffer_store_dwordx2 v[68:69], v61, s[12:15], s35 offen offset:1024 sc0 sc1
    v_accvgpr_read_b32 v76, a99
    v_accvgpr_read_b32 v77, a103
    v_accvgpr_read_b32 v78, a107
    v_accvgpr_read_b32 v79, a111
    v_accvgpr_read_b32 v80, a115
    v_accvgpr_read_b32 v81, a119
    v_accvgpr_read_b32 v82, a123
    v_accvgpr_read_b32 v83, a127
    v_accvgpr_read_b32 v84, a131
    v_accvgpr_read_b32 v85, a135
    v_accvgpr_read_b32 v86, a139
    v_accvgpr_read_b32 v87, a143
    v_pk_mul_f32 v[76:77], v[76:77], v[58:59] op_sel:[0,1] op_sel_hi:[1,1]
    v_pk_mul_f32 v[78:79], v[78:79], v[58:59] op_sel:[0,1] op_sel_hi:[1,1]
    v_pk_mul_f32 v[80:81], v[80:81], v[58:59] op_sel:[0,1] op_sel_hi:[1,1]
    v_pk_mul_f32 v[82:83], v[82:83], v[58:59] op_sel:[0,1] op_sel_hi:[1,1]
    v_pk_mul_f32 v[84:85], v[84:85], v[58:59] op_sel:[0,1] op_sel_hi:[1,1]
    v_pk_mul_f32 v[86:87], v[86:87], v[58:59] op_sel:[0,1] op_sel_hi:[1,1]
    v_cvt_pk_bf16_f32 v76, v76, v77
    v_cvt_pk_bf16_f32 v77, v78, v79
    v_cvt_pk_bf16_f32 v78, v80, v81
    v_cvt_pk_bf16_f32 v79, v82, v83
    v_cvt_pk_bf16_f32 v80, v84, v85
    v_cvt_pk_bf16_f32 v81, v86, v87
    buffer_store_dwordx4 v[76:79], v60, s[12:15], s35 offen offset:1152 sc0 sc1
    buffer_store_dwordx2 v[80:81], v61, s[12:15], s35 offen offset:1408 sc0 sc1
    s_waitcnt lgkmcnt(0)
    v_accvgpr_read_b32 v88, a144
    v_accvgpr_read_b32 v89, a148
    v_accvgpr_read_b32 v90, a152
    v_accvgpr_read_b32 v91, a156
    v_accvgpr_read_b32 v92, a160
    v_accvgpr_read_b32 v93, a164
    v_accvgpr_read_b32 v94, a168
    v_accvgpr_read_b32 v95, a172
    v_accvgpr_read_b32 v96, a176
    v_accvgpr_read_b32 v97, a180
    v_accvgpr_read_b32 v98, a184
    v_accvgpr_read_b32 v99, a188
    v_pk_mul_f32 v[88:89], v[88:89], v[128:129] op_sel:[0,0] op_sel_hi:[1,0]
    v_pk_mul_f32 v[90:91], v[90:91], v[128:129] op_sel:[0,0] op_sel_hi:[1,0]
    v_pk_mul_f32 v[92:93], v[92:93], v[128:129] op_sel:[0,0] op_sel_hi:[1,0]
    v_pk_mul_f32 v[94:95], v[94:95], v[128:129] op_sel:[0,0] op_sel_hi:[1,0]
    v_pk_mul_f32 v[96:97], v[96:97], v[128:129] op_sel:[0,0] op_sel_hi:[1,0]
    v_pk_mul_f32 v[98:99], v[98:99], v[128:129] op_sel:[0,0] op_sel_hi:[1,0]
    v_cvt_pk_bf16_f32 v88, v88, v89
    v_cvt_pk_bf16_f32 v89, v90, v91
    v_cvt_pk_bf16_f32 v90, v92, v93
    v_cvt_pk_bf16_f32 v91, v94, v95
    v_cvt_pk_bf16_f32 v92, v96, v97
    v_cvt_pk_bf16_f32 v93, v98, v99
    buffer_store_dwordx4 v[88:91], v60, s[12:15], s36 offen offset:0 sc0 sc1
    buffer_store_dwordx2 v[92:93], v61, s[12:15], s36 offen offset:256 sc0 sc1
    v_accvgpr_read_b32 v100, a145
    v_accvgpr_read_b32 v101, a149
    v_accvgpr_read_b32 v102, a153
    v_accvgpr_read_b32 v103, a157
    v_accvgpr_read_b32 v104, a161
    v_accvgpr_read_b32 v105, a165
    v_accvgpr_read_b32 v106, a169
    v_accvgpr_read_b32 v107, a173
    v_accvgpr_read_b32 v108, a177
    v_accvgpr_read_b32 v109, a181
    v_accvgpr_read_b32 v110, a185
    v_accvgpr_read_b32 v111, a189
    v_pk_mul_f32 v[100:101], v[100:101], v[128:129] op_sel:[0,1] op_sel_hi:[1,1]
    v_pk_mul_f32 v[102:103], v[102:103], v[128:129] op_sel:[0,1] op_sel_hi:[1,1]
    v_pk_mul_f32 v[104:105], v[104:105], v[128:129] op_sel:[0,1] op_sel_hi:[1,1]
    v_pk_mul_f32 v[106:107], v[106:107], v[128:129] op_sel:[0,1] op_sel_hi:[1,1]
    v_pk_mul_f32 v[108:109], v[108:109], v[128:129] op_sel:[0,1] op_sel_hi:[1,1]
    v_pk_mul_f32 v[110:111], v[110:111], v[128:129] op_sel:[0,1] op_sel_hi:[1,1]
    v_cvt_pk_bf16_f32 v100, v100, v101
    v_cvt_pk_bf16_f32 v101, v102, v103
    v_cvt_pk_bf16_f32 v102, v104, v105
    v_cvt_pk_bf16_f32 v103, v106, v107
    v_cvt_pk_bf16_f32 v104, v108, v109
    v_cvt_pk_bf16_f32 v105, v110, v111
    buffer_store_dwordx4 v[100:103], v60, s[12:15], s36 offen offset:384 sc0 sc1
    buffer_store_dwordx2 v[104:105], v61, s[12:15], s36 offen offset:640 sc0 sc1
    v_accvgpr_read_b32 v112, a146
    v_accvgpr_read_b32 v113, a150
    v_accvgpr_read_b32 v114, a154
    v_accvgpr_read_b32 v115, a158
    v_accvgpr_read_b32 v116, a162
    v_accvgpr_read_b32 v117, a166
    v_accvgpr_read_b32 v118, a170
    v_accvgpr_read_b32 v119, a174
    v_accvgpr_read_b32 v120, a178
    v_accvgpr_read_b32 v121, a182
    v_accvgpr_read_b32 v122, a186
    v_accvgpr_read_b32 v123, a190
    v_pk_mul_f32 v[112:113], v[112:113], v[130:131] op_sel:[0,0] op_sel_hi:[1,0]
    v_pk_mul_f32 v[114:115], v[114:115], v[130:131] op_sel:[0,0] op_sel_hi:[1,0]
    v_pk_mul_f32 v[116:117], v[116:117], v[130:131] op_sel:[0,0] op_sel_hi:[1,0]
    v_pk_mul_f32 v[118:119], v[118:119], v[130:131] op_sel:[0,0] op_sel_hi:[1,0]
    v_pk_mul_f32 v[120:121], v[120:121], v[130:131] op_sel:[0,0] op_sel_hi:[1,0]
    v_pk_mul_f32 v[122:123], v[122:123], v[130:131] op_sel:[0,0] op_sel_hi:[1,0]
    v_cvt_pk_bf16_f32 v112, v112, v113
    v_cvt_pk_bf16_f32 v113, v114, v115
    v_cvt_pk_bf16_f32 v114, v116, v117
    v_cvt_pk_bf16_f32 v115, v118, v119
    v_cvt_pk_bf16_f32 v116, v120, v121
    v_cvt_pk_bf16_f32 v117, v122, v123
    buffer_store_dwordx4 v[112:115], v60, s[12:15], s36 offen offset:768 sc0 sc1
    buffer_store_dwordx2 v[116:117], v61, s[12:15], s36 offen offset:1024 sc0 sc1
    v_accvgpr_read_b32 v64, a147
    v_accvgpr_read_b32 v65, a151
    v_accvgpr_read_b32 v66, a155
    v_accvgpr_read_b32 v67, a159
    v_accvgpr_read_b32 v68, a163
    v_accvgpr_read_b32 v69, a167
    v_accvgpr_read_b32 v70, a171
    v_accvgpr_read_b32 v71, a175
    v_accvgpr_read_b32 v72, a179
    v_accvgpr_read_b32 v73, a183
    v_accvgpr_read_b32 v74, a187
    v_accvgpr_read_b32 v75, a191
    v_pk_mul_f32 v[64:65], v[64:65], v[130:131] op_sel:[0,1] op_sel_hi:[1,1]
    v_pk_mul_f32 v[66:67], v[66:67], v[130:131] op_sel:[0,1] op_sel_hi:[1,1]
    v_pk_mul_f32 v[68:69], v[68:69], v[130:131] op_sel:[0,1] op_sel_hi:[1,1]
    v_pk_mul_f32 v[70:71], v[70:71], v[130:131] op_sel:[0,1] op_sel_hi:[1,1]
    v_pk_mul_f32 v[72:73], v[72:73], v[130:131] op_sel:[0,1] op_sel_hi:[1,1]
    v_pk_mul_f32 v[74:75], v[74:75], v[130:131] op_sel:[0,1] op_sel_hi:[1,1]
    v_cvt_pk_bf16_f32 v64, v64, v65
    v_cvt_pk_bf16_f32 v65, v66, v67
    v_cvt_pk_bf16_f32 v66, v68, v69
    v_cvt_pk_bf16_f32 v67, v70, v71
    v_cvt_pk_bf16_f32 v68, v72, v73
    v_cvt_pk_bf16_f32 v69, v74, v75
    buffer_store_dwordx4 v[64:67], v60, s[12:15], s36 offen offset:1152 sc0 sc1
    buffer_store_dwordx2 v[68:69], v61, s[12:15], s36 offen offset:1408 sc0 sc1
    s_branch L_fin
.section .rodata,"a"
.p2align 6
.amdhsa_kernel standalone__kv_cache_quant_int4_int2_kv_with_per_channel_or_per_token_scales__prompt_kernel
  .amdhsa_next_free_vgpr 512
  .amdhsa_next_free_sgpr 102
  .amdhsa_accum_offset 256
  .amdhsa_group_segment_fixed_size 0
  .amdhsa_kernarg_size 80
  .amdhsa_user_sgpr_count 2
  .amdhsa_user_sgpr_kernarg_segment_ptr 1
  .amdhsa_system_sgpr_workgroup_id_x 1
.end_amdhsa_kernel
```

```asm
; @launch grid=(256,1,1) block=(256,1,1) lds=161920
.amdgcn_target "amdgcn-amd-amdhsa--gfx950"
.text
.globl standalone__kv_cache_quant_int4_int2_kv_with_per_channel_or_per_token_scales__prompt_kernel
.p2align 8
.type standalone__kv_cache_quant_int4_int2_kv_with_per_channel_or_per_token_scales__prompt_kernel,@function
standalone__kv_cache_quant_int4_int2_kv_with_per_channel_or_per_token_scales__prompt_kernel:
    s_load_dwordx16 s[40:55], s[0:1], 0
    s_getpc_b64 s[60:61]
L_pc:
    s_movk_i32 s62, 0x4000
    s_lshl_b32 s63, 1, 17
    v_lshlrev_b32 v31, 6, v0
    buffer_load_dword v15, v31, s[60:63], 0 offen
    s_lshr_b32 s24, s2, 8
    s_cbranch_scc1 L_done
    s_load_dwordx4 s[16:19], s[0:1], 64
    v_lshlrev_b32 v30, 4, v0
    v_and_b32 v25, 63, v0
    v_lshrrev_b32 v24, 6, v0
    s_movk_i32 s24, 5120
    v_mul_u32_u24 v26, 43, v25
    v_mad_u32_u24 v12, v24, s24, v30
    s_movk_i32 s24, 384
    v_lshrrev_b32 v26, 10, v26
    s_and_b32 s22, s2, 7
    s_mul_i32 s29, s22, 264
    v_mad_u32_u24 v9, v26, s24, v12
    s_andn2_b32 s23, s2, 63
    s_bfe_u32 s95, s2, 0x30003
    s_add_u32 s29, s29, s23
    s_add_u32 s29, s29, s95
    s_lshr_b32 s23, s29, 1
    s_mulk_i32 s23, 384
    s_mul_i32 s24, s29, 24576
    v_lshl_add_u32 v27, v25, 3, s23
    s_addk_i32 s24, 2048
    s_mov_b32 exec_hi, 0xffff
    s_waitcnt lgkmcnt(0)
    global_load_dwordx2 v[32:33], v27, s[46:47]
    global_load_dwordx2 v[34:35], v27, s[48:49]
    s_add_u32 s56, s42, s24
    s_addc_u32 s57, s43, 0
    global_load_dwordx4 v[64:67], v9, s[56:57] offset:-2048 nt
    global_load_dwordx4 v[68:71], v9, s[56:57] offset:-512 nt
    global_load_dwordx4 v[72:75], v9, s[56:57] offset:1024 nt
    global_load_dwordx4 v[76:79], v9, s[56:57] offset:2560 nt
    global_load_dwordx4 v[80:83], v9, s[56:57] offset:-1664 nt
    global_load_dwordx4 v[84:87], v9, s[56:57] offset:-128 nt
    global_load_dwordx4 v[88:91], v9, s[56:57] offset:1408 nt
    global_load_dwordx4 v[92:95], v9, s[56:57] offset:2944 nt
    s_add_u32 s58, s44, s24
    s_addc_u32 s59, s45, 0
    global_load_dwordx4 v[96:99], v12, s[58:59] offset:-2048 nt
    global_load_dwordx4 v[100:103], v12, s[58:59] offset:-1280 nt
    global_load_dwordx4 v[104:107], v12, s[58:59] offset:-512 nt
    global_load_dwordx4 v[108:111], v12, s[58:59] offset:256 nt
    v_readfirstlane_b32 s25, v24
    s_lshl_b32 s23, s29, 6
    s_lshr_b32 s94, s29, 6
    s_lshl4_add_u32 s23, s25, s23
    s_load_dwordx4 s[64:67], s[50:51], s23
    s_load_dwordx4 s[68:71], s[52:53], s23
    s_lshl_b32 s22, s94, 10
    s_add_u32 s22, s22, 67108864
    s_or_b32 s83, s95, s25
    s_cbranch_scc1 L_notleader0
    s_load_dwordx8 s[72:79], s[18:19], s22 glc
L_notleader0:
    s_mov_b32 exec_hi, -1
    s_mov_b32 exec_hi, 0xffff
    global_load_dwordx4 v[112:115], v12, s[58:59] offset:1024 nt
    s_mov_b32 exec_hi, -1
    s_mul_i32 s24, s94, 786432
    s_add_u32 s8, s40, s24
    s_addc_u32 s9, s41, 0
    s_mov_b32 s10, 786432
    s_mov_b32 s11, 0x20000
    s_add_u32 s12, s54, s24
    s_addc_u32 s13, s55, 0
    s_mov_b32 s14, 786432
    s_mov_b32 s15, 0x20000
    s_lshl2_add_u32 s24, s95, s25
    s_mul_i32 s24, s24, 24576
    s_mul_i32 s82, s25, 6144
    s_add_u32 s82, s82, 73728
    v_add_u32 v208, 0, v25
    v_add_u32 v209, 64, v25
    v_add_u32 v210, 128, v25
    v_add_u32 v211, 192, v25
    v_add_u32 v212, 256, v25
    v_add_u32 v213, 320, v25
    v_mul_u32_u24 v216, 2731, v208
    v_mul_u32_u24 v217, 2731, v209
    v_mul_u32_u24 v218, 2731, v210
    v_mul_u32_u24 v219, 2731, v211
    v_mul_u32_u24 v220, 2731, v212
    s_mov_b32 exec_hi, 0xffff
    global_load_dwordx4 v[116:119], v12, s[58:59] offset:1792 nt
    s_mov_b32 exec_hi, -1
    v_mul_u32_u24 v221, 2731, v213
    v_bfe_u32 v216, v216, 17, 3
    v_bfe_u32 v217, v217, 17, 3
    v_bfe_u32 v218, v218, 17, 3
    v_bfe_u32 v219, v219, 17, 3
    v_bfe_u32 v220, v220, 17, 3
    v_bfe_u32 v221, v221, 17, 3
    v_xor_b32 v208, v208, v216
    v_xor_b32 v209, v209, v217
    v_xor_b32 v210, v210, v218
    v_xor_b32 v211, v211, v219
    v_xor_b32 v212, v212, v220
    v_xor_b32 v213, v213, v221
    v_lshl_add_u32 v208, v208, 4, s24
    v_lshl_add_u32 v209, v209, 4, s24
    v_lshl_add_u32 v210, v210, 4, s24
    v_lshl_add_u32 v211, v211, 4, s24
    v_lshl_add_u32 v212, v212, 4, s24
    v_lshl_add_u32 v213, v213, 4, s24
    v_mov_b32 v16, 0
    v_mov_b32 v17, 147456
    ds_write_b32 v17, v16
    s_mov_b32 s97, 0xffff0000
    s_mov_b32 s38, 0x3dd53b95
    v_mul_u32_u24 v27, 24, v26
    s_mov_b32 exec_hi, 0xffff
    global_load_dwordx4 v[120:123], v12, s[58:59] offset:2560 nt
    s_mov_b32 exec_hi, -1
    v_sub_u32 v27, v25, v27
    v_lshlrev_b32 v10, 4, v27
    v_add_u32 v10, 147584, v10
    v_mul_u32_u24 v36, 768, v26
    v_add_u32 v36, v36, v10
    s_waitcnt vmcnt(15)
    v_lshlrev_b32 v128, 16, v32
    v_and_b32 v129, s97, v32
    v_lshlrev_b32 v130, 16, v34
    v_and_b32 v131, s97, v34
    v_lshlrev_b32 v132, 16, v33
    v_and_b32 v133, s97, v33
    v_lshlrev_b32 v134, 16, v35
    v_and_b32 v135, s97, v35
    v_mul_f32 v128, s38, v128
    v_mul_f32 v129, s38, v129
    v_mul_f32 v132, s38, v132
    v_mul_f32 v133, s38, v133
    v_mul_f32_e64 v130, -v130, v128
    v_mul_f32_e64 v131, -v131, v129
    v_mul_f32_e64 v134, -v134, v132
    v_mul_f32_e64 v135, -v135, v133
    s_mov_b32 exec_hi, 0xffff
    ds_write_b128 v36, v[128:131] offset:0
    ds_write_b128 v36, v[132:135] offset:384
    s_mov_b32 exec_hi, -1
    ds_read_b128 v[128:131], v10 offset:0
    ds_read_b128 v[132:135], v10 offset:384
    s_mov_b32 exec_hi, 0xffff
    global_load_dwordx4 v[124:127], v12, s[58:59] offset:3328 nt
    s_mov_b32 exec_hi, -1
    ds_read_b128 v[136:139], v10 offset:768
    ds_read_b128 v[140:143], v10 offset:1152
    v_lshrrev_b32 v48, 1, v26
    v_lshlrev_b32 v48, 30, v48
    v_lshlrev_b32 v31, 4, v25
    v_mul_u32_u24 v30, 3072, v24
    v_add_u32 v4, v30, v31
    v_lshl_add_u32 v49, v24, 2, v26
    v_mul_u32_u24 v49, 384, v49
    v_lshlrev_b32 v50, 1, v24
    v_xor_b32 v50, v27, v50
    v_lshl_add_u32 v49, v50, 4, v49
    v_or_b32 v11, v49, v48
    v_xor_b32 v54, 16, v11
    v_lshrrev_b32 v49, 5, v25
    v_sub_u32 v49, 1, v49
    v_and_b32 v49, v49, v24
    v_lshlrev_b32 v49, 4, v49
    v_xor_b32 v49, v49, v4
    v_add_u32 v49, 12288, v49
    v_or_b32 v20, v49, v48
    s_mul_i32 s37, s95, 24576
    s_add_u32 s80, s37, 6144
    s_mov_b32 s81, s37
    s_mul_i32 s39, s94, 1769472
    v_or_b32 v9, v9, v48
    v_or_b32 v12, v12, v48
    s_waitcnt lgkmcnt(0)
    s_barrier
    s_add_u32 s4, s18, s39
    s_addc_u32 s5, s19, 0
    s_mov_b32 s6, 1572864
    s_mov_b32 s7, 0x20000
    s_add_u32 s20, s18, s22
    s_addc_u32 s21, s19, 0
    s_mov_b32 s22, 32
    s_mov_b32 s23, 0x20000
    s_mov_b32 s88, s16
    s_mov_b32 s89, s17
    s_movk_i32 s90, 256
    s_mov_b32 s91, s63
    s_lshl_b32 s93, s94, 3
    s_cmp_lg_u32 s83, 0
    s_cbranch_scc1 L_notleader
    s_mov_b32 s24, 1
    s_lshr_b32 s72, s72, 8
    s_min_u32 s72, s72, 31
    s_bitset1_b32 s24, s72
    s_lshr_b32 s73, s73, 8
    s_min_u32 s73, s73, 31
    s_bitset1_b32 s24, s73
    s_lshr_b32 s74, s74, 8
    s_min_u32 s74, s74, 31
    s_bitset1_b32 s24, s74
    s_lshr_b32 s75, s75, 8
    s_min_u32 s75, s75, 31
    s_bitset1_b32 s24, s75
    s_lshr_b32 s76, s76, 8
    s_min_u32 s76, s76, 31
    s_bitset1_b32 s24, s76
    s_lshr_b32 s77, s77, 8
    s_min_u32 s77, s77, 31
    s_bitset1_b32 s24, s77
    s_lshr_b32 s78, s78, 8
    s_min_u32 s78, s78, 31
    s_bitset1_b32 s24, s78
    s_lshr_b32 s79, s79, 8
    s_min_u32 s79, s79, 31
    s_bitset1_b32 s24, s79
    s_ff0_i32_b32 s24, s24
    s_lshl_b32 s24, s24, 8
    v_mov_b32 v52, s24
    s_mov_b64 exec, 1
    buffer_store_dword v52, off, s[88:91], s93 sc1
    s_mov_b64 exec, -1
L_notleader:
    s_add_u32 m0, s82, 0
    s_movk_i32 s24, 0
    buffer_load_dwordx4 v208, s[8:11], s24 offen nt lds
    s_waitcnt vmcnt(15)
    v_cvt_f32_i32 v64, v64
    v_cvt_f32_i32 v65, v65
    v_cvt_f32_i32 v68, v68
    v_cvt_f32_i32 v69, v69
    v_fma_f32 v64, v64, v128, v130
    v_fma_f32 v65, v65, v129, v131
    v_fma_f32 v68, v68, v128, v130
    v_fma_f32 v69, v69, v129, v131
    v_cvt_pk_bf16_f32 v64, v64, v65
    v_cvt_pk_bf16_f32 v68, v68, v69
    v_cvt_f32_i32 v66, v66
    v_cvt_f32_i32 v67, v67
    v_cvt_f32_i32 v70, v70
    v_cvt_f32_i32 v71, v71
    v_fma_f32 v66, v66, v132, v134
    v_fma_f32 v67, v67, v133, v135
    v_fma_f32 v70, v70, v132, v134
    v_fma_f32 v71, v71, v133, v135
    v_cvt_pk_bf16_f32 v65, v66, v67
    v_cvt_pk_bf16_f32 v69, v70, v71
    s_waitcnt vmcnt(13)
    v_cvt_f32_i32 v72, v72
    v_cvt_f32_i32 v73, v73
    v_cvt_f32_i32 v76, v76
    v_cvt_f32_i32 v77, v77
    v_fma_f32 v72, v72, v128, v130
    v_fma_f32 v73, v73, v129, v131
    s_add_u32 m0, s82, 1024
    s_movk_i32 s24, 0
    buffer_load_dwordx4 v209, s[8:11], s24 offen nt lds
    v_fma_f32 v76, v76, v128, v130
    v_fma_f32 v77, v77, v129, v131
    v_cvt_pk_bf16_f32 v72, v72, v73
    v_cvt_pk_bf16_f32 v76, v76, v77
    v_cvt_f32_i32 v74, v74
    v_cvt_f32_i32 v75, v75
    v_cvt_f32_i32 v78, v78
    v_cvt_f32_i32 v79, v79
    v_fma_f32 v74, v74, v132, v134
    v_fma_f32 v75, v75, v133, v135
    v_fma_f32 v78, v78, v132, v134
    v_fma_f32 v79, v79, v133, v135
    v_cvt_pk_bf16_f32 v73, v74, v75
    v_cvt_pk_bf16_f32 v77, v78, v79
    s_waitcnt vmcnt(12)
    v_cvt_f32_i32 v80, v80
    v_cvt_f32_i32 v81, v81
    v_cvt_f32_i32 v84, v84
    v_cvt_f32_i32 v85, v85
    v_fma_f32 v80, v80, v136, v138
    v_fma_f32 v81, v81, v137, v139
    v_fma_f32 v84, v84, v136, v138
    v_fma_f32 v85, v85, v137, v139
    v_cvt_pk_bf16_f32 v66, v80, v81
    v_cvt_pk_bf16_f32 v70, v84, v85
    v_cvt_f32_i32 v82, v82
    v_cvt_f32_i32 v83, v83
    v_cvt_f32_i32 v86, v86
    s_add_u32 m0, s82, 2048
    s_movk_i32 s24, 0
    buffer_load_dwordx4 v210, s[8:11], s24 offen nt lds
    v_cvt_f32_i32 v87, v87
    v_fma_f32 v82, v82, v140, v142
    v_fma_f32 v83, v83, v141, v143
    v_fma_f32 v86, v86, v140, v142
    v_fma_f32 v87, v87, v141, v143
    v_cvt_pk_bf16_f32 v67, v82, v83
    v_cvt_pk_bf16_f32 v71, v86, v87
    s_waitcnt vmcnt(11)
    v_cvt_f32_i32 v88, v88
    v_cvt_f32_i32 v89, v89
    v_cvt_f32_i32 v92, v92
    v_cvt_f32_i32 v93, v93
    v_fma_f32 v88, v88, v136, v138
    v_fma_f32 v89, v89, v137, v139
    v_fma_f32 v92, v92, v136, v138
    v_fma_f32 v93, v93, v137, v139
    v_cvt_pk_bf16_f32 v74, v88, v89
    v_cvt_pk_bf16_f32 v78, v92, v93
    v_cvt_f32_i32 v90, v90
    v_cvt_f32_i32 v91, v91
    v_cvt_f32_i32 v94, v94
    v_cvt_f32_i32 v95, v95
    v_fma_f32 v90, v90, v140, v142
    v_fma_f32 v91, v91, v141, v143
    v_fma_f32 v94, v94, v140, v142
    v_fma_f32 v95, v95, v141, v143
    v_cvt_pk_bf16_f32 v75, v90, v91
    v_cvt_pk_bf16_f32 v79, v94, v95
    buffer_store_dwordx4 v[64:67], v11, s[4:7], s37 offen offset:0 sc1
    buffer_store_dwordx4 v[68:71], v54, s[4:7], s37 offen offset:768 sc1
    buffer_store_dwordx4 v[72:75], v11, s[4:7], s80 offen offset:0 sc1
    buffer_store_dwordx4 v[76:79], v54, s[4:7], s80 offen offset:768 sc1
    s_mov_b32 exec_hi, 0xffff
    ds_write_b128 v11, v[64:67] offset:0
    ds_write_b128 v54, v[68:71] offset:768
    ds_write_b128 v11, v[72:75] offset:6144
    ds_write_b128 v54, v[76:79] offset:6912
    s_mov_b32 exec_hi, -1
    s_add_u32 m0, s82, 3072
    s_movk_i32 s24, 0
    buffer_load_dwordx4 v211, s[8:11], s24 offen nt lds
    s_lshl_b32 s57, s64, 16
    s_and_b32 s58, s64, s97
    v_mov_b32 v128, s57
    v_mov_b32 v129, s58
    s_lshl_b32 s57, s68, 16
    s_and_b32 s58, s68, s97
    v_mul_f32_e64 v130, -s57, v128
    v_mul_f32_e64 v131, -s58, v129
    s_lshl_b32 s57, s65, 16
    s_and_b32 s58, s65, s97
    v_mov_b32 v132, s57
    v_mov_b32 v133, s58
    s_lshl_b32 s57, s69, 16
    s_and_b32 s58, s69, s97
    v_mul_f32_e64 v134, -s57, v132
    v_mul_f32_e64 v135, -s58, v133
    s_lshl_b32 s57, s66, 16
    s_and_b32 s58, s66, s97
    v_mov_b32 v136, s57
    v_mov_b32 v137, s58
    s_lshl_b32 s57, s70, 16
    s_and_b32 s58, s70, s97
    v_mul_f32_e64 v138, -s57, v136
    v_mul_f32_e64 v139, -s58, v137
    s_lshl_b32 s57, s67, 16
    s_and_b32 s58, s67, s97
    v_mov_b32 v140, s57
    v_mov_b32 v141, s58
    s_lshl_b32 s57, s71, 16
    s_and_b32 s58, s71, s97
    v_mul_f32_e64 v142, -s57, v140
    v_mul_f32_e64 v143, -s58, v141
    s_waitcnt vmcnt(14)
    v_cvt_f32_i32 v96, v96
    v_cvt_f32_i32 v100, v100
    v_cvt_f32_i32 v97, v97
    v_cvt_f32_i32 v101, v101
    v_fma_f32 v96, v96, v128, v130
    s_add_u32 m0, s82, 4096
    s_movk_i32 s24, 0
    buffer_load_dwordx4 v212, s[8:11], s24 offen nt lds
    v_fma_f32 v100, v100, v129, v131
    v_fma_f32 v97, v97, v128, v130
    v_fma_f32 v101, v101, v129, v131
    v_cvt_f32_i32 v98, v98
    v_cvt_f32_i32 v102, v102
    v_cvt_f32_i32 v99, v99
    v_cvt_f32_i32 v103, v103
    v_fma_f32 v98, v98, v128, v130
    v_fma_f32 v102, v102, v129, v131
    v_fma_f32 v99, v99, v128, v130
    v_fma_f32 v103, v103, v129, v131
    s_waitcnt vmcnt(13)
    v_cvt_f32_i32 v104, v104
    v_cvt_f32_i32 v108, v108
    v_cvt_f32_i32 v105, v105
    v_cvt_f32_i32 v109, v109
    v_fma_f32 v104, v104, v132, v134
    v_fma_f32 v108, v108, v133, v135
    v_fma_f32 v105, v105, v132, v134
    v_fma_f32 v109, v109, v133, v135
    v_cvt_f32_i32 v106, v106
    v_cvt_f32_i32 v110, v110
    v_cvt_f32_i32 v107, v107
    v_cvt_f32_i32 v111, v111
    v_fma_f32 v106, v106, v132, v134
    v_fma_f32 v110, v110, v133, v135
    v_fma_f32 v107, v107, v132, v134
    v_fma_f32 v111, v111, v133, v135
    v_cvt_pk_bf16_f32 v96, v96, v100
    v_cvt_pk_bf16_f32 v100, v97, v101
    v_cvt_pk_bf16_f32 v97, v104, v108
    v_cvt_pk_bf16_f32 v101, v105, v109
    v_cvt_pk_bf16_f32 v104, v98, v102
    v_cvt_pk_bf16_f32 v105, v106, v110
    v_cvt_pk_bf16_f32 v108, v99, v103
    v_cvt_pk_bf16_f32 v109, v107, v111
    s_waitcnt vmcnt(11)
    v_cvt_f32_i32 v112, v112
    v_cvt_f32_i32 v116, v116
    s_add_u32 m0, s82, 5120
    s_movk_i32 s24, 0
    buffer_load_dwordx4 v213, s[8:11], s24 offen nt lds
    v_cvt_f32_i32 v113, v113
    v_cvt_f32_i32 v117, v117
    v_fma_f32 v112, v112, v136, v138
    v_fma_f32 v116, v116, v137, v139
    v_fma_f32 v113, v113, v136, v138
    v_fma_f32 v117, v117, v137, v139
    v_cvt_f32_i32 v114, v114
    v_cvt_f32_i32 v118, v118
    v_cvt_f32_i32 v115, v115
    v_cvt_f32_i32 v119, v119
    v_fma_f32 v114, v114, v136, v138
    v_fma_f32 v118, v118, v137, v139
    v_fma_f32 v115, v115, v136, v138
    v_fma_f32 v119, v119, v137, v139
    s_waitcnt vmcnt(10)
    v_cvt_f32_i32 v120, v120
    v_cvt_f32_i32 v124, v124
    v_cvt_f32_i32 v121, v121
    v_cvt_f32_i32 v125, v125
    v_fma_f32 v120, v120, v140, v142
    v_fma_f32 v124, v124, v141, v143
    v_fma_f32 v121, v121, v140, v142
    v_fma_f32 v125, v125, v141, v143
    v_cvt_f32_i32 v122, v122
    v_cvt_f32_i32 v126, v126
    v_cvt_f32_i32 v123, v123
    v_cvt_f32_i32 v127, v127
    v_fma_f32 v122, v122, v140, v142
    v_fma_f32 v126, v126, v141, v143
    v_fma_f32 v123, v123, v140, v142
    v_fma_f32 v127, v127, v141, v143
    v_cvt_pk_bf16_f32 v98, v112, v116
    v_cvt_pk_bf16_f32 v102, v113, v117
    v_cvt_pk_bf16_f32 v99, v120, v124
    v_cvt_pk_bf16_f32 v103, v121, v125
    v_cvt_pk_bf16_f32 v106, v114, v118
    v_cvt_pk_bf16_f32 v107, v122, v126
    v_cvt_pk_bf16_f32 v110, v115, v119
    v_cvt_pk_bf16_f32 v111, v123, v127
    buffer_store_dwordx4 v[96:99], v20, s[4:7], s81 offen offset:0 sc1
    buffer_store_dwordx4 v[100:103], v20, s[4:7], s81 offen offset:768 sc1
    buffer_store_dwordx4 v[104:107], v20, s[4:7], s81 offen offset:1536 sc1
    buffer_store_dwordx4 v[108:111], v20, s[4:7], s81 offen offset:2304 sc1
    s_mov_b32 exec_hi, 0xffff
    ds_write_b128 v20, v[96:99] offset:12288
    ds_write_b128 v20, v[100:103] offset:13056
    ds_write_b128 v20, v[104:107] offset:13824
    ds_write_b128 v20, v[108:111] offset:14592
    s_mov_b32 exec_hi, -1
    v_mov_b32 v52, 0
    buffer_load_dword v52, off, s[88:91], s93 sc1
    s_lshl_b32 s39, s95, 2
    v_lshl_add_u32 v13, v0, 2, s39
    v_cmp_lt_u32 vcc, 0, v0
    v_mov_b32 v30, 0x40000000
    s_mov_b32 s96, 100000
    v_cndmask_b32 v13, v13, v30, vcc
    s_mul_i32 s39, s94, 1572864
    s_add_u32 s64, s42, s39
    s_addc_u32 s65, s43, 0
    s_mov_b32 s66, 1572864
    s_mov_b32 s67, 0x20000
    s_add_u32 s68, s44, s39
    s_addc_u32 s69, s45, 0
    s_mov_b32 s70, 1572864
    s_mov_b32 s71, 0x20000
    s_waitcnt vmcnt(11)
    s_add_u32 m0, s82, 24576
    s_movk_i32 s24, 6144
    buffer_load_dwordx4 v208, s[8:11], s24 offen nt lds
    s_and_b32 s33, s29, 63
    s_mul_i32 s33, s33, 24576
    s_mov_b32 s35, s33
    s_mul_i32 s26, s25, 3072
    s_add_u32 s26, s26, 12288
    s_add_u32 s56, s26, 24576
    s_add_u32 s39, s95, 1
    s_and_b32 s39, s39, 7
    s_mul_i32 s32, s39, 24576
    s_waitcnt vmcnt(11)
    s_add_u32 m0, s82, 25600
    s_movk_i32 s24, 6144
    buffer_load_dwordx4 v209, s[8:11], s24 offen nt lds
    s_add_u32 s27, s32, 12288
    s_mov_b32 s28, 0
    s_mov_b32 s30, 24576
    v_and_b32 v26, 15, v25
    v_lshrrev_b32 v49, 4, v25
    v_bfe_u32 v28, v25, 1, 3
    v_xor_b32 v29, v49, v28
    v_mul_u32_u24 v30, 384, v26
    v_lshl_add_u32 v2, v29, 4, v30
    v_xor_b32 v3, 64, v2
    s_waitcnt vmcnt(11)
    s_add_u32 m0, s82, 26624
    s_movk_i32 s24, 6144
    buffer_load_dwordx4 v210, s[8:11], s24 offen nt lds
    v_mul_u32_u24 v50, 3072, v49
    v_add_u32 v50, 24576, v50
    v_and_b32 v51, 1, v49
    v_lshl_add_u32 v51, v26, 1, v51
    v_lshl_add_u32 v1, v51, 4, v50
    v_xor_b32 v21, 16, v1
    v_lshl_add_u32 v22, v26, 4, v50
    v_add_u32 v22, 512, v22
    v_lshrrev_b32 v29, 1, v49
    s_waitcnt vmcnt(11)
    s_add_u32 m0, s82, 27648
    s_movk_i32 s24, 6144
    buffer_load_dwordx4 v211, s[8:11], s24 offen nt lds
    v_xor_b32 v29, v29, v28
    v_lshl_add_u32 v31, v29, 4, v30
    v_and_b32 v29, 1, v49
    v_lshl_add_u32 v31, v29, 3, v31
    v_lshlrev_b32 v15, 6, v0
    v_add_u32 v0, s82, v31
    v_mov_b32 v5, 0
    v_mov_b32 v6, 0
    v_mov_b32 v7, 0
    v_mov_b32 v8, 0
    s_waitcnt vmcnt(4)
    v_readfirstlane_b32 s92, v52
    s_mov_b32 s39, 100
L_tagretry:
    s_cmp_lg_u32 s92, 0
    s_cbranch_scc1 L_tagok
    s_sub_u32 s39, s39, 1
    s_cbranch_scc1 L_tagslow
    s_sleep 8
    s_buffer_load_dword s92, s[88:91], s93 glc
    s_waitcnt lgkmcnt(0)
    s_branch L_tagretry
L_tagok:
    s_add_u32 s92, s92, 1
    v_mov_b32 v55, s92
    s_mov_b64 exec, 1
    v_mov_b32 v16, 1
    v_mov_b32 v17, 147456
    ds_add_rtn_u32 v16, v17, v16
    s_waitcnt lgkmcnt(0)
    v_readfirstlane_b32 s24, v16
    s_nop 0
    s_cmp_lg_u32 s24, 3
    s_cbranch_scc1 L_nopost
    s_lshl_b32 s39, s95, 2
    buffer_store_dword v55, off, s[20:23], s39 sc1
L_nopost:
    s_mov_b64 exec, -1
    s_waitcnt vmcnt(11)
    s_add_u32 m0, s82, 28672
    s_movk_i32 s24, 6144
    buffer_load_dwordx4 v212, s[8:11], s24 offen nt lds
    s_waitcnt vmcnt(11)
    s_add_u32 m0, s82, 29696
    s_movk_i32 s24, 6144
    buffer_load_dwordx4 v213, s[8:11], s24 offen nt lds
    s_lshl_b32 s24, s25, 4
    s_add_u32 s24, s24, s29
    s_and_b32 s58, s24, 63
    s_add_u32 s24, s24, 8
    s_and_b32 s57, s24, 63
    s_andn2_b32 s24, s29, 63
    s_or_b32 s58, s58, s24
    s_or_b32 s57, s57, s24
    v_mov_b32 v37, s58
    v_mov_b32 v38, s57
    v_cmp_lt_u32 vcc, 15, v25
    s_lshr_b32 s58, s58, 1
    s_lshr_b32 s57, s57, 1
    s_mulk_i32 s58, 384
    s_mulk_i32 s57, 384
    v_cndmask_b32 v37, v37, v38, vcc
    v_lshl_add_u32 v38, v25, 3, s58
    v_lshl_add_u32 v39, v25, 3, s57
    v_lshlrev_b32 v37, 6, v37
    v_lshl_add_u32 v37, v26, 2, v37
    s_mov_b32 exec_hi, 0xffff
    global_load_dwordx2 v[80:81], v38, s[46:47]
    global_load_dwordx2 v[82:83], v38, s[48:49]
    global_load_dwordx2 v[84:85], v39, s[46:47]
    global_load_dwordx2 v[86:87], v39, s[48:49]
    s_mov_b32 exec_hi, 0
    global_load_dword v88, v37, s[50:51]
    global_load_dword v89, v37, s[52:53]
    s_mov_b32 exec_hi, -1
    v_xor_b32 v17, 32, v0
    v_xor_b32 v18, 64, v0
    v_xor_b32 v19, 96, v0
    s_waitcnt vmcnt(17)
    ds_read_b64 a[192:193], v0 offset:0
    ds_read_b64 a[194:195], v18 offset:128
    ds_read_b64 a[196:197], v17 offset:0
    ds_read_b64 a[198:199], v19 offset:128
    ds_read_b64 a[200:201], v18 offset:0
    ds_read_b64 a[202:203], v0 offset:256
    ds_read_b64 a[204:205], v19 offset:0
    ds_read_b64 a[206:207], v17 offset:256
    ds_read_b64 a[208:209], v0 offset:128
    ds_read_b64 a[210:211], v18 offset:256
    ds_read_b64 a[212:213], v17 offset:128
    ds_read_b64 a[214:215], v19 offset:256
    s_waitcnt lgkmcnt(0)
    s_barrier
    ds_read_b128 v[144:147], v2 offset:0
    ds_read_b128 v[148:151], v3 offset:0
    ds_read_b128 v[152:155], v2 offset:6144
    ds_read_b128 v[156:159], v3 offset:6144
    ds_read_b128 v[160:163], v2 offset:128
    ds_read_b128 v[164:167], v3 offset:128
    ds_read_b128 v[168:171], v2 offset:6272
    ds_read_b128 v[172:175], v3 offset:6272
    ds_read_b128 v[176:179], v2 offset:256
    ds_read_b128 v[180:183], v3 offset:256
    ds_read_b128 v[184:187], v2 offset:6400
    ds_read_b128 v[188:191], v3 offset:6400
    s_waitcnt lgkmcnt(0)
    v_mfma_f32_16x16x32_bf16 v[64:67], v[144:147], a[192:195], 0
    v_mfma_f32_16x16x32_bf16 v[64:67], v[148:151], a[196:199], v[64:67]
    v_mfma_f32_16x16x32_bf16 v[64:67], v[160:163], a[200:203], v[64:67]
    v_mfma_f32_16x16x32_bf16 v[64:67], v[164:167], a[204:207], v[64:67]
    v_mfma_f32_16x16x32_bf16 v[64:67], v[176:179], a[208:211], v[64:67]
    v_mfma_f32_16x16x32_bf16 v[64:67], v[180:183], a[212:215], v[64:67]
    v_mfma_f32_16x16x32_bf16 v[96:99], v[152:155], a[192:195], 0
    v_mfma_f32_16x16x32_bf16 v[96:99], v[156:159], a[196:199], v[96:99]
    v_mfma_f32_16x16x32_bf16 v[96:99], v[168:171], a[200:203], v[96:99]
    v_mfma_f32_16x16x32_bf16 v[96:99], v[172:175], a[204:207], v[96:99]
    v_mfma_f32_16x16x32_bf16 v[96:99], v[184:187], a[208:211], v[96:99]
    v_mfma_f32_16x16x32_bf16 v[96:99], v[188:191], a[212:215], v[96:99]
    s_nop 7
    s_waitcnt vmcnt(11)
    s_add_u32 m0, s82, 49152
    s_movk_i32 s24, 12288
    buffer_load_dwordx4 v208, s[8:11], s24 offen nt lds
    v_max3_f32 v48, v64, v65, v66
    v_max3_f32 v48, v48, v67, v96
    v_max3_f32 v48, v48, v97, v98
    v_max_f32 v48, v48, v99
    v_mov_b32 v49, v48
    s_nop 1
    v_permlane16_swap_b32 v48, v49
    s_nop 1
    v_max_f32 v48, v48, v49
    v_mov_b32 v49, v48
    s_nop 1
    v_permlane32_swap_b32 v48, v49
    s_nop 1
    v_max_f32 v48, v48, v49
    v_sub_f32 v128, 0, v48
    v_sub_f32 v129, 0, v48
    v_sub_f32 v130, 0, v48
    v_sub_f32 v131, 0, v48
    v_sub_f32 v64, v64, v48
    v_sub_f32 v65, v65, v48
    v_sub_f32 v66, v66, v48
    v_sub_f32 v67, v67, v48
    v_sub_f32 v96, v96, v48
    s_waitcnt vmcnt(11)
    s_add_u32 m0, s82, 50176
    s_movk_i32 s24, 12288
    buffer_load_dwordx4 v209, s[8:11], s24 offen nt lds
    v_sub_f32 v97, v97, v48
    v_sub_f32 v98, v98, v48
    v_sub_f32 v99, v99, v48
    v_exp_f32 v64, v64
    v_exp_f32 v65, v65
    v_exp_f32 v66, v66
    v_exp_f32 v67, v67
    v_exp_f32 v96, v96
    v_exp_f32 v97, v97
    v_exp_f32 v98, v98
    v_exp_f32 v99, v99
    v_add_f32 v5, v5, v64
    v_add_f32 v5, v5, v65
    v_add_f32 v5, v5, v66
    v_add_f32 v5, v5, v67
    v_add_f32 v5, v5, v96
    v_add_f32 v5, v5, v97
    v_add_f32 v5, v5, v98
    v_add_f32 v5, v5, v99
    v_cvt_pk_bf16_f32 v64, v64, v65
    v_cvt_pk_bf16_f32 v65, v66, v67
    v_cvt_pk_bf16_f32 v66, v96, v97
    v_cvt_pk_bf16_f32 v67, v98, v99
    s_buffer_load_dwordx8 s[72:79], s[20:23], 0 glc
    s_waitcnt vmcnt(8)
    s_add_u32 m0, s82, 51200
    s_movk_i32 s24, 12288
    buffer_load_dwordx4 v210, s[8:11], s24 offen nt lds
    s_add_u32 s33, s33, 196608
    s_sub_u32 s34, s33, 1572864
    s_min_u32 s33, s33, s34
    s_add_u32 s34, s33, 3072
    s_add_u32 s37, s37, 196608
    s_add_u32 s80, s80, 196608
    s_add_u32 s35, s35, 196608
    s_sub_u32 s36, s35, 1572864
    s_min_u32 s35, s35, s36
    s_add_u32 s36, s35, 3072
    s_add_u32 s81, s81, 196608
    s_mov_b32 s88, s60
    s_mov_b32 s89, s61
    s_mov_b32 s90, L_slow-L_pc
    s_lshr_b32 s59, s2, 3
    s_mul_i32 s93, s59, 43
    s_lshr_b32 s93, s93, 7
    s_mul_i32 s39, s93, 3
    s_sub_u32 s59, s59, s39
    s_lshl_b32 s59, s59, 10
    s_mul_i32 s93, s93, 12288
    s_add_u32 s93, s93, s59
    s_waitcnt vmcnt(3)
    v_lshlrev_b32 v112, 16, v80
    v_and_b32 v113, s97, v80
    v_lshlrev_b32 v114, 16, v82
    v_and_b32 v115, s97, v82
    v_lshlrev_b32 v116, 16, v81
    v_and_b32 v117, s97, v81
    v_lshlrev_b32 v118, 16, v83
    v_and_b32 v119, s97, v83
    v_lshlrev_b32 v120, 16, v84
    v_and_b32 v121, s97, v84
    v_lshlrev_b32 v122, 16, v86
    v_and_b32 v123, s97, v86
    v_lshlrev_b32 v124, 16, v85
    v_and_b32 v125, s97, v85
    v_lshlrev_b32 v126, 16, v87
    v_and_b32 v127, s97, v87
    v_lshlrev_b32 v92, 16, v88
    v_and_b32 v93, s97, v88
    s_waitcnt vmcnt(8)
    s_add_u32 m0, s82, 52224
    s_movk_i32 s24, 12288
    buffer_load_dwordx4 v211, s[8:11], s24 offen nt lds
    v_lshlrev_b32 v94, 16, v89
    v_and_b32 v95, s97, v89
    v_mul_f32 v112, s38, v112
    v_mul_f32 v113, s38, v113
    v_mul_f32 v116, s38, v116
    v_mul_f32 v117, s38, v117
    v_mul_f32 v120, s38, v120
    v_mul_f32 v121, s38, v121
    v_mul_f32 v124, s38, v124
    v_mul_f32 v125, s38, v125
    v_mul_f32_e64 v114, -v114, v112
    v_mul_f32_e64 v115, -v115, v113
    v_mul_f32_e64 v118, -v118, v116
    v_mul_f32_e64 v119, -v119, v117
    v_mul_f32_e64 v122, -v122, v120
    v_mul_f32_e64 v123, -v123, v121
    v_mul_f32_e64 v126, -v126, v124
    v_mul_f32_e64 v127, -v127, v125
    v_mul_f32_e64 v94, -v94, v92
    v_mul_f32_e64 v95, -v95, v93
    s_mul_i32 s57, s25, 3584
    v_add_u32 v36, s57, v36
    s_add_u32 s57, s57, 147584
    v_lshrrev_b32 v37, 4, v25
    v_mul_u32_u24 v37, 1792, v37
    v_lshl_add_u32 v37, v26, 4, v37
    v_add_u32 v37, s57, v37
    s_mov_b32 exec_hi, 0xffff
    ds_write_b128 v36, v[112:115] offset:0
    ds_write_b128 v36, v[116:119] offset:384
    ds_write_b128 v36, v[120:123] offset:1792
    ds_write_b128 v36, v[124:127] offset:2176
    s_mov_b32 exec_hi, 0
    ds_write_b128 v37, v[92:95] offset:1536
    s_mov_b32 exec_hi, -1
    v_add_u32 v10, 1792, v10
    s_lshl_b32 s57, s25, 6
    s_add_u32 s57, s57, 150912
    v_mov_b32 v23, s57
    v_bfe_u32 v53, v4, 4, 6
    v_lshlrev_b32 v53, 2, v53
    s_mov_b32 s39, 200
    s_waitcnt lgkmcnt(0)
    s_sub_u32 s72, s72, s92
    s_sub_u32 s73, s73, s92
    s_sub_u32 s74, s74, s92
    s_sub_u32 s75, s75, s92
    s_sub_u32 s76, s76, s92
    s_sub_u32 s77, s77, s92
    s_sub_u32 s78, s78, s92
    s_sub_u32 s79, s79, s92
    s_max_u32 s72, s72, s73
    s_max_u32 s72, s72, s74
    s_max_u32 s72, s72, s75
    s_max_u32 s72, s72, s76
    s_max_u32 s72, s72, s77
    s_max_u32 s72, s72, s78
    s_max_u32 s72, s72, s79
    s_cmp_lt_u32 s72, 16
    s_cbranch_scc1 L_pollokP
L_pollretry:
    s_buffer_load_dwordx8 s[48:55], s[20:23], 0 glc
    s_waitcnt lgkmcnt(0)
    s_sub_u32 s48, s48, s92
    s_sub_u32 s49, s49, s92
    s_sub_u32 s50, s50, s92
    s_sub_u32 s51, s51, s92
    s_sub_u32 s52, s52, s92
    s_sub_u32 s53, s53, s92
    s_sub_u32 s54, s54, s92
    s_sub_u32 s55, s55, s92
    s_max_u32 s48, s48, s49
    s_max_u32 s48, s48, s50
    s_max_u32 s48, s48, s51
    s_max_u32 s48, s48, s52
    s_max_u32 s48, s48, s53
    s_max_u32 s48, s48, s54
    s_max_u32 s48, s48, s55
    s_cmp_lt_u32 s48, 16
    s_cbranch_scc1 L_pollokP
    s_sub_u32 s39, s39, 1
    s_cbranch_scc1 L_pollslowP
    s_sleep 1
    s_branch L_pollretry
L_pollokP:
    s_add_u32 s92, s92, 1
    s_mov_b32 m0, s26
    s_nop 0
    buffer_load_dwordx4 v4, s[4:7], s32 offen offset:0 sc1 lds
    buffer_load_dwordx4 v4, s[4:7], s32 offen offset:1024 sc1 lds
    buffer_load_dwordx4 v4, s[4:7], s32 offen offset:2048 sc1 lds
    s_add_u32 s32, s32, 24576
    s_sub_u32 s57, s32, 196608
    s_min_u32 s32, s32, s57
    s_add_u32 s26, s26, 36864
    s_sub_u32 s57, s26, 147456
    s_min_u32 s26, s26, s57
    v_xor_b32 v17, 32, v0
    v_xor_b32 v18, 64, v0
    v_xor_b32 v19, 96, v0
    s_waitcnt vmcnt(13)
    ds_read_b64 a[216:217], v0 offset:24576
    ds_read_b64 a[218:219], v18 offset:24704
    ds_read_b64 a[220:221], v17 offset:24576
    ds_read_b64 a[222:223], v19 offset:24704
    ds_read_b64 a[224:225], v18 offset:24576
    ds_read_b64 a[226:227], v0 offset:24832
    ds_read_b64 a[228:229], v19 offset:24576
    ds_read_b64 a[230:231], v17 offset:24832
    ds_read_b64 a[232:233], v0 offset:24704
    ds_read_b64 a[234:235], v18 offset:24832
    ds_read_b64 a[236:237], v17 offset:24704
    ds_read_b64 a[238:239], v19 offset:24832
    s_waitcnt lgkmcnt(0)
    v_mfma_f32_16x16x32_bf16 v[68:71], v[144:147], a[216:219], 0
    v_mfma_f32_16x16x32_bf16 v[68:71], v[148:151], a[220:223], v[68:71]
    v_mfma_f32_16x16x32_bf16 v[68:71], v[160:163], a[224:227], v[68:71]
    v_mfma_f32_16x16x32_bf16 v[68:71], v[164:167], a[228:231], v[68:71]
    v_mfma_f32_16x16x32_bf16 v[68:71], v[176:179], a[232:235], v[68:71]
    v_mfma_f32_16x16x32_bf16 v[68:71], v[180:183], a[236:239], v[68:71]
    v_mfma_f32_16x16x32_bf16 v[100:103], v[152:155], a[216:219], 0
    v_mfma_f32_16x16x32_bf16 v[100:103], v[156:159], a[220:223], v[100:103]
    v_mfma_f32_16x16x32_bf16 v[100:103], v[168:171], a[224:227], v[100:103]
    v_mfma_f32_16x16x32_bf16 v[100:103], v[172:175], a[228:231], v[100:103]
    v_mfma_f32_16x16x32_bf16 v[100:103], v[184:187], a[232:235], v[100:103]
    v_mfma_f32_16x16x32_bf16 v[100:103], v[188:191], a[236:239], v[100:103]
    s_nop 7
    s_mov_b32 m0, s26
    s_nop 0
    buffer_load_dwordx4 v4, s[4:7], s32 offen offset:0 sc1 lds
    buffer_load_dwordx4 v4, s[4:7], s32 offen offset:1024 sc1 lds
    buffer_load_dwordx4 v4, s[4:7], s32 offen offset:2048 sc1 lds
    s_add_u32 s32, s32, 24576
    s_sub_u32 s57, s32, 196608
    s_min_u32 s32, s32, s57
    s_add_u32 s26, s26, 12288
    v_max3_f32 v48, v68, v69, v70
    v_max3_f32 v48, v48, v71, v100
    v_max3_f32 v48, v48, v101, v102
    v_max_f32 v48, v48, v103
    v_mov_b32 v49, v48
    s_nop 1
    v_permlane16_swap_b32 v48, v49
    s_nop 1
    v_max_f32 v48, v48, v49
    v_mov_b32 v49, v48
    s_nop 1
    v_permlane32_swap_b32 v48, v49
    s_nop 1
    v_max_f32 v48, v48, v49
    v_sub_f32 v132, 0, v48
    s_mov_b32 m0, s26
    s_nop 0
    buffer_load_dwordx4 v4, s[4:7], s32 offen offset:0 sc1 lds
    buffer_load_dwordx4 v4, s[4:7], s32 offen offset:1024 sc1 lds
    buffer_load_dwordx4 v4, s[4:7], s32 offen offset:2048 sc1 lds
    s_add_u32 s32, s32, 24576
    s_sub_u32 s57, s32, 196608
    s_min_u32 s32, s32, s57
    s_add_u32 s26, s26, 36864
    s_sub_u32 s57, s26, 147456
    s_min_u32 s26, s26, s57
    v_sub_f32 v133, 0, v48
    v_sub_f32 v134, 0, v48
    v_sub_f32 v135, 0, v48
    v_sub_f32 v68, v68, v48
    v_sub_f32 v69, v69, v48
    v_sub_f32 v70, v70, v48
    v_sub_f32 v71, v71, v48
    v_sub_f32 v100, v100, v48
    v_sub_f32 v101, v101, v48
    v_sub_f32 v102, v102, v48
    v_sub_f32 v103, v103, v48
    v_exp_f32 v68, v68
    v_exp_f32 v69, v69
    v_exp_f32 v70, v70
    v_exp_f32 v71, v71
    s_mov_b32 m0, s56
    s_nop 0
    buffer_load_dwordx4 v4, s[4:7], s27 offen offset:0 sc1 lds
    buffer_load_dwordx4 v4, s[4:7], s27 offen offset:1024 sc1 lds
    buffer_load_dwordx4 v4, s[4:7], s27 offen offset:2048 sc1 lds
    s_add_u32 s27, s27, 24576
    s_sub_u32 s58, s27, 196608
    s_min_u32 s27, s27, s58
    s_add_u32 s56, s56, 36864
    s_sub_u32 s58, s56, 147456
    s_min_u32 s56, s56, s58
    v_exp_f32 v100, v100
    v_exp_f32 v101, v101
    v_exp_f32 v102, v102
    v_exp_f32 v103, v103
    v_add_f32 v6, v6, v68
    v_add_f32 v6, v6, v69
    v_add_f32 v6, v6, v70
    v_add_f32 v6, v6, v71
    v_add_f32 v6, v6, v100
    v_add_f32 v6, v6, v101
    v_add_f32 v6, v6, v102
    v_add_f32 v6, v6, v103
    v_cvt_pk_bf16_f32 v68, v68, v69
    v_cvt_pk_bf16_f32 v69, v70, v71
    v_cvt_pk_bf16_f32 v70, v100, v101
    v_cvt_pk_bf16_f32 v71, v102, v103
    s_waitcnt vmcnt(9)
    s_waitcnt lgkmcnt(0)
    s_barrier
    ds_read_b128 v[24:27], v2 offset:12288
    ds_read_b128 v[28:31], v3 offset:12288
    ds_read_b128 v[32:35], v2 offset:18432
    ds_read_b128 v[36:39], v3 offset:18432
    s_waitcnt lgkmcnt(2)
    v_mfma_f32_16x16x32_bf16 v[80:83], v[24:27], a[192:195], v[128:131]
    ds_read_b128 v[40:43], v2 offset:12416
    v_mfma_f32_16x16x32_bf16 v[80:83], v[28:31], a[196:199], v[80:83]
    s_add_u32 m0, s82, 53248
    s_movk_i32 s24, 12288
    buffer_load_dwordx4 v212, s[8:11], s24 offen nt lds
    v_mfma_f32_16x16x32_bf16 v[84:87], v[24:27], a[216:219], v[132:135]
    ds_read_b128 v[44:47], v3 offset:12416
    v_mfma_f32_16x16x32_bf16 v[84:87], v[28:31], a[220:223], v[84:87]
    s_waitcnt lgkmcnt(2)
    v_mfma_f32_16x16x32_bf16 v[112:115], v[32:35], a[192:195], v[128:131]
    ds_read_b128 v[24:27], v2 offset:18560
    v_mfma_f32_16x16x32_bf16 v[112:115], v[36:39], a[196:199], v[112:115]
    s_add_u32 m0, s82, 54272
    s_movk_i32 s24, 12288
    buffer_load_dwordx4 v213, s[8:11], s24 offen nt lds
    v_mfma_f32_16x16x32_bf16 v[116:119], v[32:35], a[216:219], v[132:135]
    ds_read_b128 v[28:31], v3 offset:18560
    v_mfma_f32_16x16x32_bf16 v[116:119], v[36:39], a[220:223], v[116:119]
    s_waitcnt lgkmcnt(2)
    v_mfma_f32_16x16x32_bf16 v[80:83], v[40:43], a[200:203], v[80:83]
    ds_read_b128 v[32:35], v2 offset:12544
    v_mfma_f32_16x16x32_bf16 v[80:83], v[44:47], a[204:207], v[80:83]
    s_add_u32 m0, s82, 24576
    s_movk_i32 s24, 18432
    buffer_load_dwordx4 v208, s[8:11], s24 offen nt lds
    v_mfma_f32_16x16x32_bf16 v[84:87], v[40:43], a[224:227], v[84:87]
    ds_read_b128 v[36:39], v3 offset:12544
    v_mfma_f32_16x16x32_bf16 v[84:87], v[44:47], a[228:231], v[84:87]
    s_waitcnt lgkmcnt(2)
    v_mfma_f32_16x16x32_bf16 v[112:115], v[24:27], a[200:203], v[112:115]
    ds_read_b128 v[40:43], v2 offset:18688
    v_mfma_f32_16x16x32_bf16 v[112:115], v[28:31], a[204:207], v[112:115]
    s_waitcnt vmcnt(6)
    s_barrier
    v_mfma_f32_16x16x32_bf16 v[116:119], v[24:27], a[224:227], v[116:119]
    ds_read_b128 v[44:47], v3 offset:18688
    v_mfma_f32_16x16x32_bf16 v[116:119], v[28:31], a[228:231], v[116:119]
    s_waitcnt lgkmcnt(2)
    v_mfma_f32_16x16x32_bf16 v[80:83], v[32:35], a[208:211], v[80:83]
    v_add_u32 v2, 49152, v2
    v_add_u32 v3, 49152, v3
    ds_read_b128 v[24:27], v2 offset:0
    v_mfma_f32_16x16x32_bf16 v[80:83], v[36:39], a[212:215], v[80:83]
    s_add_u32 m0, s82, 25600
    s_movk_i32 s24, 18432
    buffer_load_dwordx4 v209, s[8:11], s24 offen nt lds
    v_mfma_f32_16x16x32_bf16 v[84:87], v[32:35], a[232:235], v[84:87]
    ds_read_b128 v[28:31], v3 offset:0
    v_mfma_f32_16x16x32_bf16 v[84:87], v[36:39], a[236:239], v[84:87]
    s_waitcnt lgkmcnt(2)
    v_mfma_f32_16x16x32_bf16 v[112:115], v[40:43], a[208:211], v[112:115]
    ds_read_b128 v[32:35], v2 offset:6144
    v_mfma_f32_16x16x32_bf16 v[112:115], v[44:47], a[212:215], v[112:115]
    s_add_u32 m0, s82, 26624
    s_movk_i32 s24, 18432
    buffer_load_dwordx4 v210, s[8:11], s24 offen nt lds
    v_mfma_f32_16x16x32_bf16 v[116:119], v[40:43], a[232:235], v[116:119]
    ds_read_b128 v[36:39], v3 offset:6144
    v_mfma_f32_16x16x32_bf16 v[116:119], v[44:47], a[236:239], v[116:119]
    s_waitcnt lgkmcnt(2)
    v_mfma_f32_16x16x32_bf16 v[160:163], v[24:27], a[192:195], v[128:131]
    ds_read_b128 v[40:43], v2 offset:128
    v_mfma_f32_16x16x32_bf16 v[160:163], v[28:31], a[196:199], v[160:163]
    s_add_u32 m0, s82, 27648
    s_movk_i32 s24, 18432
    buffer_load_dwordx4 v211, s[8:11], s24 offen nt lds
    v_exp_f32 v16, v80
    v_mfma_f32_16x16x32_bf16 v[164:167], v[24:27], a[216:219], v[132:135]
    ds_read_b128 v[44:47], v3 offset:128
    v_mfma_f32_16x16x32_bf16 v[164:167], v[28:31], a[220:223], v[164:167]
    s_waitcnt lgkmcnt(2)
    v_exp_f32 v17, v81
    v_exp_f32 v18, v82
    v_add_f32 v5, v5, v16
    v_mfma_f32_16x16x32_bf16 v[96:99], v[32:35], a[192:195], v[128:131]
    ds_read_b128 v[24:27], v2 offset:6272
    v_add_f32 v5, v5, v17
    v_mfma_f32_16x16x32_bf16 v[96:99], v[36:39], a[196:199], v[96:99]
    s_add_u32 m0, s82, 28672
    s_movk_i32 s24, 18432
    buffer_load_dwordx4 v212, s[8:11], s24 offen nt lds
    v_exp_f32 v19, v83
    v_mfma_f32_16x16x32_bf16 v[100:103], v[32:35], a[216:219], v[132:135]
    ds_read_b128 v[28:31], v3 offset:6272
    v_cvt_pk_bf16_f32 v80, v16, v17
    v_mfma_f32_16x16x32_bf16 v[100:103], v[36:39], a[220:223], v[100:103]
    s_waitcnt lgkmcnt(2)
    v_exp_f32 v16, v112
    v_add_f32 v5, v5, v18
    v_add_f32 v5, v5, v19
    v_mfma_f32_16x16x32_bf16 v[160:163], v[40:43], a[200:203], v[160:163]
    ds_read_b128 v[32:35], v2 offset:256
    v_mfma_f32_16x16x32_bf16 v[160:163], v[44:47], a[204:207], v[160:163]
    s_add_u32 m0, s82, 29696
    s_movk_i32 s24, 18432
    buffer_load_dwordx4 v213, s[8:11], s24 offen nt lds
    v_exp_f32 v17, v113
    v_mfma_f32_16x16x32_bf16 v[164:167], v[40:43], a[224:227], v[164:167]
    ds_read_b128 v[36:39], v3 offset:256
    v_cvt_pk_bf16_f32 v81, v18, v19
    v_mfma_f32_16x16x32_bf16 v[164:167], v[44:47], a[228:231], v[164:167]
    s_waitcnt lgkmcnt(2)
    v_exp_f32 v18, v114
    v_add_f32 v5, v5, v16
    v_add_f32 v5, v5, v17
    v_mfma_f32_16x16x32_bf16 v[96:99], v[24:27], a[200:203], v[96:99]
    ds_read_b128 v[40:43], v2 offset:6400
    v_mfma_f32_16x16x32_bf16 v[96:99], v[28:31], a[204:207], v[96:99]
    s_mov_b32 m0, s56
    v_exp_f32 v19, v115
    v_cvt_pk_bf16_f32 v82, v16, v17
    v_exp_f32 v16, v84
    v_mfma_f32_16x16x32_bf16 v[100:103], v[24:27], a[224:227], v[100:103]
    ds_read_b128 v[44:47], v3 offset:6400
    v_add_f32 v5, v5, v18
    v_mfma_f32_16x16x32_bf16 v[100:103], v[28:31], a[228:231], v[100:103]
    s_waitcnt lgkmcnt(2)
    v_add_f32 v5, v5, v19
    v_exp_f32 v17, v85
    v_cvt_pk_bf16_f32 v83, v18, v19
    v_mfma_f32_16x16x32_bf16 v[160:163], v[32:35], a[208:211], v[160:163]
    ds_read_b128 v[24:27], v2 offset:12288
    v_mfma_f32_16x16x32_bf16 v[160:163], v[36:39], a[212:215], v[160:163]
    buffer_load_dwordx4 v4, s[4:7], s27 offen offset:0 sc1 lds
    v_exp_f32 v18, v86
    v_add_f32 v6, v6, v16
    v_mfma_f32_16x16x32_bf16 v[164:167], v[32:35], a[232:235], v[164:167]
    ds_read_b128 v[28:31], v3 offset:12288
    v_add_f32 v6, v6, v17
    v_mfma_f32_16x16x32_bf16 v[164:167], v[36:39], a[236:239], v[164:167]
    s_waitcnt lgkmcnt(2)
    v_exp_f32 v19, v87
    v_cvt_pk_bf16_f32 v84, v16, v17
    v_exp_f32 v16, v116
    v_mfma_f32_16x16x32_bf16 v[96:99], v[40:43], a[208:211], v[96:99]
    ds_read_b128 v[32:35], v2 offset:18432
    v_add_f32 v6, v6, v18
    v_mfma_f32_16x16x32_bf16 v[96:99], v[44:47], a[212:215], v[96:99]
    buffer_load_dwordx4 v4, s[4:7], s27 offen offset:1024 sc1 lds
    v_add_f32 v6, v6, v19
    v_exp_f32 v17, v117
    v_mfma_f32_16x16x32_bf16 v[100:103], v[40:43], a[232:235], v[100:103]
    ds_read_b128 v[36:39], v3 offset:18432
    v_cvt_pk_bf16_f32 v85, v18, v19
    v_mfma_f32_16x16x32_bf16 v[100:103], v[44:47], a[236:239], v[100:103]
    s_waitcnt lgkmcnt(2)
    v_exp_f32 v18, v118
    v_add_f32 v6, v6, v16
    v_add_f32 v6, v6, v17
    v_mfma_f32_16x16x32_bf16 v[176:179], v[24:27], a[192:195], v[128:131]
    ds_read_b128 v[40:43], v2 offset:12416
    v_mfma_f32_16x16x32_bf16 v[176:179], v[28:31], a[196:199], v[176:179]
    buffer_load_dwordx4 v4, s[4:7], s27 offen offset:2048 sc1 lds
    v_exp_f32 v19, v119
    v_cvt_pk_bf16_f32 v86, v16, v17
    v_mfma_f32_16x16x32_bf16 v[180:183], v[24:27], a[216:219], v[132:135]
    ds_read_b128 v[44:47], v3 offset:12416
    v_add_f32 v6, v6, v18
    v_mfma_f32_16x16x32_bf16 v[180:183], v[28:31], a[220:223], v[180:183]
    s_waitcnt lgkmcnt(2)
    v_add_f32 v6, v6, v19
    v_cvt_pk_bf16_f32 v87, v18, v19
    v_mfma_f32_16x16x32_bf16 v[120:123], v[32:35], a[192:195], v[128:131]
    ds_read_b128 v[24:27], v2 offset:18560
    v_mfma_f32_16x16x32_bf16 v[120:123], v[36:39], a[196:199], v[120:123]
    s_add_u32 s27, s27, 24576
    s_sub_u32 s58, s27, 196608
    s_min_u32 s27, s27, s58
    v_exp_f32 v16, v160
    v_mfma_f32_16x16x32_bf16 v[124:127], v[32:35], a[216:219], v[132:135]
    ds_read_b128 v[28:31], v3 offset:18560
    v_mfma_f32_16x16x32_bf16 v[124:127], v[36:39], a[220:223], v[124:127]
    s_waitcnt lgkmcnt(2)
    v_exp_f32 v17, v161
    v_exp_f32 v18, v162
    v_add_f32 v5, v5, v16
    v_mfma_f32_16x16x32_bf16 v[176:179], v[40:43], a[200:203], v[176:179]
    ds_read_b128 v[32:35], v2 offset:12544
    v_add_f32 v5, v5, v17
    v_mfma_f32_16x16x32_bf16 v[176:179], v[44:47], a[204:207], v[176:179]
    s_add_u32 s56, s56, 12288
    v_exp_f32 v19, v163
    v_cvt_pk_bf16_f32 v160, v16, v17
    v_exp_f32 v16, v96
    v_mfma_f32_16x16x32_bf16 v[180:183], v[40:43], a[224:227], v[180:183]
    ds_read_b128 v[36:39], v3 offset:12544
    v_add_f32 v5, v5, v18
    v_mfma_f32_16x16x32_bf16 v[180:183], v[44:47], a[228:231], v[180:183]
    s_waitcnt lgkmcnt(2)
    v_add_f32 v5, v5, v19
    v_exp_f32 v17, v97
    v_cvt_pk_bf16_f32 v161, v18, v19
    v_mfma_f32_16x16x32_bf16 v[120:123], v[24:27], a[200:203], v[120:123]
    ds_read_b128 v[40:43], v2 offset:18688
    v_mfma_f32_16x16x32_bf16 v[120:123], v[28:31], a[204:207], v[120:123]
    s_waitcnt vmcnt(11)
    s_barrier
    v_exp_f32 v18, v98
    v_add_f32 v5, v5, v16
    v_mfma_f32_16x16x32_bf16 v[124:127], v[24:27], a[224:227], v[124:127]
    ds_read_b128 v[44:47], v3 offset:18688
    v_add_f32 v5, v5, v17
    v_mfma_f32_16x16x32_bf16 v[124:127], v[28:31], a[228:231], v[124:127]
    s_waitcnt lgkmcnt(2)
    v_exp_f32 v19, v99
    v_cvt_pk_bf16_f32 v162, v16, v17
    v_exp_f32 v16, v164
    v_mfma_f32_16x16x32_bf16 v[176:179], v[32:35], a[208:211], v[176:179]
    ds_read_b128 v[24:27], v1 offset:0
    v_add_f32 v5, v5, v18
    v_mfma_f32_16x16x32_bf16 v[176:179], v[36:39], a[212:215], v[176:179]
    s_mov_b32 m0, s56
    v_add_f32 v5, v5, v19
    v_exp_f32 v17, v165
    v_cvt_pk_bf16_f32 v163, v18, v19
    v_mfma_f32_16x16x32_bf16 v[180:183], v[32:35], a[232:235], v[180:183]
    ds_read_b128 v[28:31], v1 offset:12288
    v_mfma_f32_16x16x32_bf16 v[180:183], v[36:39], a[236:239], v[180:183]
    s_waitcnt lgkmcnt(2)
    v_exp_f32 v18, v166
    v_add_f32 v6, v6, v16
    v_add_f32 v6, v6, v17
    v_mfma_f32_16x16x32_bf16 v[120:123], v[40:43], a[208:211], v[120:123]
    ds_read_b128 v[32:35], v1 offset:768
    v_mfma_f32_16x16x32_bf16 v[120:123], v[44:47], a[212:215], v[120:123]
    buffer_load_dwordx4 v4, s[4:7], s27 offen offset:0 sc1 lds
    v_exp_f32 v19, v167
    v_cvt_pk_bf16_f32 v164, v16, v17
    v_mfma_f32_16x16x32_bf16 v[124:127], v[40:43], a[232:235], v[124:127]
    ds_read_b128 v[36:39], v1 offset:13056
    v_mfma_f32_16x16x32_bf16 v[124:127], v[44:47], a[236:239], v[124:127]
    s_waitcnt lgkmcnt(2)
    v_exp_f32 v16, v100
    v_add_f32 v6, v6, v18
    v_add_f32 v6, v6, v19
    v_mfma_f32_16x16x32_bf16 a[0:3], v[64:67], v[24:27], 0
    ds_read_b128 v[40:43], v1 offset:1536
    v_mfma_f32_16x16x32_bf16 a[0:3], v[80:83], v[28:31], a[0:3]
    buffer_load_dwordx4 v4, s[4:7], s27 offen offset:1024 sc1 lds
    v_exp_f32 v17, v101
    v_cvt_pk_bf16_f32 v165, v18, v19
    v_mfma_f32_16x16x32_bf16 a[48:51], v[68:71], v[24:27], 0
    ds_read_b128 v[44:47], v1 offset:13824
    v_mfma_f32_16x16x32_bf16 a[48:51], v[84:87], v[28:31], a[48:51]
    s_waitcnt lgkmcnt(2)
    v_exp_f32 v18, v102
    v_add_f32 v6, v6, v16
    v_add_f32 v6, v6, v17
    v_mfma_f32_16x16x32_bf16 a[4:7], v[64:67], v[32:35], 0
    ds_read_b128 v[24:27], v1 offset:2304
    v_mfma_f32_16x16x32_bf16 a[4:7], v[80:83], v[36:39], a[4:7]
    buffer_load_dwordx4 v4, s[4:7], s27 offen offset:2048 sc1 lds
    v_exp_f32 v19, v103
    v_cvt_pk_bf16_f32 v166, v16, v17
    v_mfma_f32_16x16x32_bf16 a[52:55], v[68:71], v[32:35], 0
    ds_read_b128 v[28:31], v1 offset:14592
    v_add_f32 v6, v6, v18
    v_mfma_f32_16x16x32_bf16 a[52:55], v[84:87], v[36:39], a[52:55]
    s_waitcnt lgkmcnt(2)
    v_add_f32 v6, v6, v19
    v_cvt_pk_bf16_f32 v167, v18, v19
    v_exp_f32 v16, v176
    v_mfma_f32_16x16x32_bf16 a[8:11], v[64:67], v[40:43], 0
    ds_read_b128 v[32:35], v21 offset:0
    v_mfma_f32_16x16x32_bf16 a[8:11], v[80:83], v[44:47], a[8:11]
    s_add_u32 s27, s27, 24576
    s_sub_u32 s58, s27, 196608
    s_min_u32 s27, s27, s58
    v_exp_f32 v17, v177
    v_mfma_f32_16x16x32_bf16 a[56:59], v[68:71], v[40:43], 0
    ds_read_b128 v[36:39], v21 offset:12288
    v_mfma_f32_16x16x32_bf16 a[56:59], v[84:87], v[44:47], a[56:59]
    s_waitcnt lgkmcnt(2)
    v_exp_f32 v18, v178
    v_add_f32 v5, v5, v16
    v_add_f32 v5, v5, v17
    v_mfma_f32_16x16x32_bf16 a[12:15], v[64:67], v[24:27], 0
    ds_read_b128 v[40:43], v21 offset:768
    v_mfma_f32_16x16x32_bf16 a[12:15], v[80:83], v[28:31], a[12:15]
    s_add_u32 s56, s56, 36864
    s_sub_u32 s58, s56, 147456
    s_min_u32 s56, s56, s58
    v_exp_f32 v19, v179
    v_cvt_pk_bf16_f32 v176, v16, v17
    v_mfma_f32_16x16x32_bf16 a[60:63], v[68:71], v[24:27], 0
    ds_read_b128 v[44:47], v21 offset:13056
    v_mfma_f32_16x16x32_bf16 a[60:63], v[84:87], v[28:31], a[60:63]
    s_waitcnt lgkmcnt(2)
    v_exp_f32 v16, v120
    v_add_f32 v5, v5, v18
    v_add_f32 v5, v5, v19
    v_mfma_f32_16x16x32_bf16 a[16:19], v[64:67], v[32:35], 0
    ds_read_b128 v[24:27], v21 offset:1536
    v_mfma_f32_16x16x32_bf16 a[16:19], v[80:83], v[36:39], a[16:19]
    buffer_load_dwordx4 v[224:227], v9, s[64:67], s33 offen offset:0 nt
    v_exp_f32 v17, v121
    v_cvt_pk_bf16_f32 v177, v18, v19
    v_mfma_f32_16x16x32_bf16 a[64:67], v[68:71], v[32:35], 0
    ds_read_b128 v[28:31], v21 offset:13824
    v_mfma_f32_16x16x32_bf16 a[64:67], v[84:87], v[36:39], a[64:67]
    s_waitcnt lgkmcnt(2)
    v_exp_f32 v18, v122
    v_add_f32 v5, v5, v16
    v_add_f32 v5, v5, v17
    v_mfma_f32_16x16x32_bf16 a[20:23], v[64:67], v[40:43], 0
    ds_read_b128 v[32:35], v21 offset:2304
    v_mfma_f32_16x16x32_bf16 a[20:23], v[80:83], v[44:47], a[20:23]
    buffer_load_dwordx4 v[228:231], v9, s[64:67], s33 offen offset:1536 nt
    v_exp_f32 v19, v123
    v_cvt_pk_bf16_f32 v178, v16, v17
    v_mfma_f32_16x16x32_bf16 a[68:71], v[68:71], v[40:43], 0
    ds_read_b128 v[36:39], v21 offset:14592
    v_mfma_f32_16x16x32_bf16 a[68:71], v[84:87], v[44:47], a[68:71]
    s_waitcnt lgkmcnt(2)
    v_exp_f32 v16, v180
    v_add_f32 v5, v5, v18
    v_add_f32 v5, v5, v19
    v_mfma_f32_16x16x32_bf16 a[24:27], v[64:67], v[24:27], 0
    ds_read_b128 v[40:43], v22 offset:0
    v_mfma_f32_16x16x32_bf16 a[24:27], v[80:83], v[28:31], a[24:27]
    buffer_load_dwordx4 v[232:235], v9, s[64:67], s34 offen offset:0 nt
    v_exp_f32 v17, v181
    v_cvt_pk_bf16_f32 v179, v18, v19
    v_mfma_f32_16x16x32_bf16 a[72:75], v[68:71], v[24:27], 0
    ds_read_b128 v[44:47], v22 offset:12288
    v_mfma_f32_16x16x32_bf16 a[72:75], v[84:87], v[28:31], a[72:75]
    s_waitcnt lgkmcnt(2)
    v_exp_f32 v18, v182
    v_add_f32 v6, v6, v16
    v_add_f32 v6, v6, v17
    v_mfma_f32_16x16x32_bf16 a[28:31], v[64:67], v[32:35], 0
    ds_read_b128 v[24:27], v22 offset:768
    v_mfma_f32_16x16x32_bf16 a[28:31], v[80:83], v[36:39], a[28:31]
    buffer_load_dwordx4 v[236:239], v9, s[64:67], s34 offen offset:1536 nt
    v_exp_f32 v19, v183
    v_cvt_pk_bf16_f32 v180, v16, v17
    v_mfma_f32_16x16x32_bf16 a[76:79], v[68:71], v[32:35], 0
    ds_read_b128 v[28:31], v22 offset:13056
    v_mfma_f32_16x16x32_bf16 a[76:79], v[84:87], v[36:39], a[76:79]
    s_waitcnt lgkmcnt(2)
    v_exp_f32 v16, v124
    v_add_f32 v6, v6, v18
    v_add_f32 v6, v6, v19
    v_mfma_f32_16x16x32_bf16 a[32:35], v[64:67], v[40:43], 0
    ds_read_b128 v[32:35], v22 offset:1536
    v_mfma_f32_16x16x32_bf16 a[32:35], v[80:83], v[44:47], a[32:35]
    buffer_load_dwordx4 v[240:243], v9, s[64:67], s33 offen offset:384 nt
    v_exp_f32 v17, v125
    v_cvt_pk_bf16_f32 v181, v18, v19
    v_mfma_f32_16x16x32_bf16 a[80:83], v[68:71], v[40:43], 0
    ds_read_b128 v[36:39], v22 offset:13824
    v_mfma_f32_16x16x32_bf16 a[80:83], v[84:87], v[44:47], a[80:83]
    s_waitcnt lgkmcnt(2)
    v_exp_f32 v18, v126
    v_add_f32 v6, v6, v16
    v_add_f32 v6, v6, v17
    v_mfma_f32_16x16x32_bf16 a[36:39], v[64:67], v[24:27], 0
    ds_read_b128 v[40:43], v22 offset:2304
    v_mfma_f32_16x16x32_bf16 a[36:39], v[80:83], v[28:31], a[36:39]
    s_waitcnt vmcnt(5)
    s_barrier
    v_exp_f32 v19, v127
    v_cvt_pk_bf16_f32 v182, v16, v17
    v_mfma_f32_16x16x32_bf16 a[84:87], v[68:71], v[24:27], 0
    ds_read_b128 v[44:47], v22 offset:14592
    v_add_f32 v6, v6, v18
    v_mfma_f32_16x16x32_bf16 a[84:87], v[84:87], v[28:31], a[84:87]
    s_waitcnt lgkmcnt(2)
    v_add_f32 v6, v6, v19
    v_cvt_pk_bf16_f32 v183, v18, v19
    v_mfma_f32_16x16x32_bf16 a[40:43], v[64:67], v[32:35], 0
    v_add_u32 v1, 49152, v1
    v_add_u32 v21, 49152, v21
    v_add_u32 v22, 49152, v22
    ds_read_b128 v[24:27], v1 offset:0
    v_mfma_f32_16x16x32_bf16 a[40:43], v[80:83], v[36:39], a[40:43]
    buffer_load_dwordx4 v[244:247], v9, s[64:67], s33 offen offset:1920 nt
    v_mfma_f32_16x16x32_bf16 a[88:91], v[68:71], v[32:35], 0
    ds_read_b128 v[28:31], v1 offset:12288
    v_mfma_f32_16x16x32_bf16 a[88:91], v[84:87], v[36:39], a[88:91]
    s_waitcnt lgkmcnt(2)
    v_mfma_f32_16x16x32_bf16 a[44:47], v[64:67], v[40:43], 0
    ds_read_b128 v[32:35], v1 offset:768
    v_mfma_f32_16x16x32_bf16 a[44:47], v[80:83], v[44:47], a[44:47]
    buffer_load_dwordx4 v[248:251], v9, s[64:67], s34 offen offset:384 nt
    v_mfma_f32_16x16x32_bf16 a[92:95], v[68:71], v[40:43], 0
    ds_read_b128 v[36:39], v1 offset:13056
    v_mfma_f32_16x16x32_bf16 a[92:95], v[84:87], v[44:47], a[92:95]
    s_waitcnt lgkmcnt(2)
    v_xor_b32 v17, 32, v0
    v_xor_b32 v18, 64, v0
    v_xor_b32 v19, 96, v0
    s_waitcnt vmcnt(19)
    ds_read_b64 a[240:241], v0 offset:49152
    ds_read_b64 a[242:243], v18 offset:49280
    ds_read_b64 a[244:245], v17 offset:49152
    ds_read_b64 a[246:247], v19 offset:49280
    ds_read_b64 a[248:249], v18 offset:49152
    ds_read_b64 a[250:251], v0 offset:49408
    ds_read_b64 a[252:253], v19 offset:49152
    ds_read_b64 a[254:255], v17 offset:49408
    ds_read_b64 v[192:193], v0 offset:49280
    ds_read_b64 v[194:195], v18 offset:49408
    ds_read_b64 v[196:197], v17 offset:49280
    ds_read_b64 v[198:199], v19 offset:49408
    s_waitcnt lgkmcnt(0)
    v_mfma_f32_16x16x32_bf16 a[0:3], v[160:163], v[24:27], a[0:3]
    ds_read_b128 v[40:43], v1 offset:1536
    ds_read_b128 v[48:51], v10 offset:0
    v_mfma_f32_16x16x32_bf16 a[0:3], v[176:179], v[28:31], a[0:3]
    buffer_load_dwordx4 v[252:255], v9, s[64:67], s34 offen offset:1920 nt
    v_mfma_f32_16x16x32_bf16 a[48:51], v[164:167], v[24:27], a[48:51]
    ds_read_b128 v[44:47], v1 offset:13824
    v_mfma_f32_16x16x32_bf16 a[48:51], v[180:183], v[28:31], a[48:51]
    s_nop 0
    v_mfma_f32_16x16x32_bf16 a[4:7], v[160:163], v[32:35], a[4:7]
    ds_read_b128 v[24:27], v1 offset:2304
    v_mfma_f32_16x16x32_bf16 a[4:7], v[176:179], v[36:39], a[4:7]
    buffer_load_dwordx4 v[144:147], v12, s[68:71], s35 offen offset:0 nt
    v_mfma_f32_16x16x32_bf16 a[52:55], v[164:167], v[32:35], a[52:55]
    ds_read_b128 v[28:31], v1 offset:14592
    v_mfma_f32_16x16x32_bf16 a[52:55], v[180:183], v[36:39], a[52:55]
    s_waitcnt lgkmcnt(2)
    v_mfma_f32_16x16x32_bf16 a[8:11], v[160:163], v[40:43], a[8:11]
    ds_read_b128 v[32:35], v21 offset:0
    v_mfma_f32_16x16x32_bf16 a[8:11], v[176:179], v[44:47], a[8:11]
    buffer_load_dwordx4 v[148:151], v12, s[68:71], s35 offen offset:768 nt
    v_mfma_f32_16x16x32_bf16 a[56:59], v[164:167], v[40:43], a[56:59]
    ds_read_b128 v[36:39], v21 offset:12288
    v_mfma_f32_16x16x32_bf16 a[56:59], v[180:183], v[44:47], a[56:59]
    s_waitcnt lgkmcnt(2)
    v_mfma_f32_16x16x32_bf16 a[12:15], v[160:163], v[24:27], a[12:15]
    ds_read_b128 v[40:43], v21 offset:768
    v_mfma_f32_16x16x32_bf16 a[12:15], v[176:179], v[28:31], a[12:15]
    buffer_load_dwordx4 v[152:155], v12, s[68:71], s35 offen offset:1536 nt
    v_mfma_f32_16x16x32_bf16 a[60:63], v[164:167], v[24:27], a[60:63]
    ds_read_b128 v[44:47], v21 offset:13056
    v_mfma_f32_16x16x32_bf16 a[60:63], v[180:183], v[28:31], a[60:63]
    s_waitcnt lgkmcnt(2)
    v_mfma_f32_16x16x32_bf16 a[16:19], v[160:163], v[32:35], a[16:19]
    ds_read_b128 v[24:27], v21 offset:1536
    v_mfma_f32_16x16x32_bf16 a[16:19], v[176:179], v[36:39], a[16:19]
    buffer_load_dwordx4 v[156:159], v12, s[68:71], s35 offen offset:2304 nt
    v_mfma_f32_16x16x32_bf16 a[64:67], v[164:167], v[32:35], a[64:67]
    ds_read_b128 v[28:31], v21 offset:13824
    v_mfma_f32_16x16x32_bf16 a[64:67], v[180:183], v[36:39], a[64:67]
    s_waitcnt lgkmcnt(2)
    v_mfma_f32_16x16x32_bf16 a[20:23], v[160:163], v[40:43], a[20:23]
    ds_read_b128 v[32:35], v21 offset:2304
    v_mfma_f32_16x16x32_bf16 a[20:23], v[176:179], v[44:47], a[20:23]
    s_mov_b32 s62, L_slow-L_pc
    s_bfe_u32 s24, s2, 0x20003
    s_add_u32 s24, s24, 1
    s_lshl_b32 s24, s24, 14
    v_mfma_f32_16x16x32_bf16 a[68:71], v[164:167], v[40:43], a[68:71]
    ds_read_b128 v[36:39], v21 offset:14592
    v_mfma_f32_16x16x32_bf16 a[68:71], v[180:183], v[44:47], a[68:71]
    s_waitcnt lgkmcnt(2)
    v_mfma_f32_16x16x32_bf16 a[24:27], v[160:163], v[24:27], a[24:27]
    ds_read_b128 v[40:43], v22 offset:0
    v_mfma_f32_16x16x32_bf16 a[24:27], v[176:179], v[28:31], a[24:27]
    buffer_load_dword v15, v15, s[60:63], s24 offen
    v_mfma_f32_16x16x32_bf16 a[72:75], v[164:167], v[24:27], a[72:75]
    ds_read_b128 v[44:47], v22 offset:12288
    v_mfma_f32_16x16x32_bf16 a[72:75], v[180:183], v[28:31], a[72:75]
    s_waitcnt lgkmcnt(2)
    v_mfma_f32_16x16x32_bf16 a[28:31], v[160:163], v[32:35], a[28:31]
    ds_read_b128 v[24:27], v22 offset:768
    v_mfma_f32_16x16x32_bf16 a[28:31], v[176:179], v[36:39], a[28:31]
    v_mfma_f32_16x16x32_bf16 a[76:79], v[164:167], v[32:35], a[76:79]
    ds_read_b128 v[28:31], v22 offset:13056
    v_mfma_f32_16x16x32_bf16 a[76:79], v[180:183], v[36:39], a[76:79]
    s_waitcnt lgkmcnt(2)
    v_mfma_f32_16x16x32_bf16 a[32:35], v[160:163], v[40:43], a[32:35]
    ds_read_b128 v[32:35], v22 offset:1536
    v_mfma_f32_16x16x32_bf16 a[32:35], v[176:179], v[44:47], a[32:35]
    v_mfma_f32_16x16x32_bf16 a[80:83], v[164:167], v[40:43], a[80:83]
    ds_read_b128 v[36:39], v22 offset:13824
    v_mfma_f32_16x16x32_bf16 a[80:83], v[180:183], v[44:47], a[80:83]
    s_waitcnt lgkmcnt(2)
    v_mfma_f32_16x16x32_bf16 a[36:39], v[160:163], v[24:27], a[36:39]
    ds_read_b128 v[40:43], v22 offset:2304
    v_mfma_f32_16x16x32_bf16 a[36:39], v[176:179], v[28:31], a[36:39]
    v_mfma_f32_16x16x32_bf16 a[84:87], v[164:167], v[24:27], a[84:87]
    ds_read_b128 v[44:47], v22 offset:14592
    v_mfma_f32_16x16x32_bf16 a[84:87], v[180:183], v[28:31], a[84:87]
    s_waitcnt lgkmcnt(2)
    v_mfma_f32_16x16x32_bf16 a[40:43], v[160:163], v[32:35], a[40:43]
    v_add_u32 v2, 4294918144, v2
    v_add_u32 v3, 4294918144, v3
    ds_read_b128 v[24:27], v2 offset:0
    v_mfma_f32_16x16x32_bf16 a[40:43], v[176:179], v[36:39], a[40:43]
    v_mfma_f32_16x16x32_bf16 a[88:91], v[164:167], v[32:35], a[88:91]
    ds_read_b128 v[28:31], v3 offset:0
    v_mfma_f32_16x16x32_bf16 a[88:91], v[180:183], v[36:39], a[88:91]
    s_waitcnt lgkmcnt(2)
    v_mfma_f32_16x16x32_bf16 a[44:47], v[160:163], v[40:43], a[44:47]
    ds_read_b128 v[32:35], v2 offset:6144
    v_mfma_f32_16x16x32_bf16 a[44:47], v[176:179], v[44:47], a[44:47]
    v_mfma_f32_16x16x32_bf16 a[92:95], v[164:167], v[40:43], a[92:95]
    ds_read_b128 v[36:39], v3 offset:6144
    v_mfma_f32_16x16x32_bf16 a[92:95], v[180:183], v[44:47], a[92:95]
    s_waitcnt lgkmcnt(2)
    v_xor_b32 v17, 32, v0
    v_xor_b32 v18, 64, v0
    v_xor_b32 v19, 96, v0
    s_waitcnt vmcnt(19)
    ds_read_b64 v[200:201], v0 offset:24576
    ds_read_b64 v[202:203], v18 offset:24704
    ds_read_b64 v[204:205], v17 offset:24576
    ds_read_b64 v[206:207], v19 offset:24704
    ds_read_b64 v[208:209], v18 offset:24576
    ds_read_b64 v[210:211], v0 offset:24832
    ds_read_b64 v[212:213], v19 offset:24576
    ds_read_b64 v[214:215], v17 offset:24832
    ds_read_b64 v[216:217], v0 offset:24704
    ds_read_b64 v[218:219], v18 offset:24832
    ds_read_b64 v[220:221], v17 offset:24704
    ds_read_b64 v[222:223], v19 offset:24832
    s_waitcnt lgkmcnt(0)
    s_barrier
    v_mfma_f32_16x16x32_bf16 v[72:75], v[24:27], a[240:243], 0
    ds_read_b128 v[40:43], v2 offset:128
    ds_read_b128 v[56:59], v10 offset:384
    v_mfma_f32_16x16x32_bf16 v[72:75], v[28:31], a[244:247], v[72:75]
    s_mov_b32 m0, s26
    s_waitcnt vmcnt(11)
    v_cvt_f32_i32 v224, v224
    v_cvt_f32_i32 v225, v225
    v_cvt_f32_i32 v228, v228
    v_mfma_f32_16x16x32_bf16 v[76:79], v[24:27], v[200:203], 0
    ds_read_b128 v[44:47], v3 offset:128
    ds_read_b128 v[60:63], v10 offset:768
    v_mfma_f32_16x16x32_bf16 v[76:79], v[28:31], v[204:207], v[76:79]
    s_nop 0
    v_cvt_f32_i32 v229, v229
    v_fma_f32 v224, v224, v48, v50
    v_fma_f32 v225, v225, v49, v51
    v_fma_f32 v228, v228, v48, v50
    v_fma_f32 v229, v229, v49, v51
    v_cvt_pk_bf16_f32 v224, v224, v225
    v_cvt_pk_bf16_f32 v228, v228, v229
    s_waitcnt lgkmcnt(2)
    v_cvt_f32_i32 v226, v226
    v_mfma_f32_16x16x32_bf16 v[104:107], v[32:35], a[240:243], 0
    ds_read_b128 v[24:27], v2 offset:6272
    v_cvt_f32_i32 v227, v227
    v_mfma_f32_16x16x32_bf16 v[104:107], v[36:39], a[244:247], v[104:107]
    buffer_load_dwordx4 v4, s[4:7], s32 offen offset:0 sc1 lds
    v_cvt_f32_i32 v230, v230
    v_cvt_f32_i32 v231, v231
    v_fma_f32 v226, v226, v56, v58
    v_fma_f32 v227, v227, v57, v59
    v_fma_f32 v230, v230, v56, v58
    v_fma_f32 v231, v231, v57, v59
    v_mfma_f32_16x16x32_bf16 v[108:111], v[32:35], v[200:203], 0
    ds_read_b128 v[28:31], v3 offset:6272
    v_cvt_pk_bf16_f32 v225, v226, v227
    v_mfma_f32_16x16x32_bf16 v[108:111], v[36:39], v[204:207], v[108:111]
    s_waitcnt lgkmcnt(3)
    v_cvt_pk_bf16_f32 v229, v230, v231
    s_waitcnt vmcnt(10)
    v_cvt_f32_i32 v232, v232
    v_cvt_f32_i32 v233, v233
    v_cvt_f32_i32 v236, v236
    v_cvt_f32_i32 v237, v237
    v_fma_f32 v232, v232, v48, v50
    v_fma_f32 v233, v233, v49, v51
    v_mfma_f32_16x16x32_bf16 v[72:75], v[40:43], a[248:251], v[72:75]
    ds_read_b128 v[32:35], v2 offset:256
    v_fma_f32 v236, v236, v48, v50
    v_mfma_f32_16x16x32_bf16 v[72:75], v[44:47], a[252:255], v[72:75]
    buffer_load_dwordx4 v4, s[4:7], s32 offen offset:1024 sc1 lds
    v_fma_f32 v237, v237, v49, v51
    v_cvt_pk_bf16_f32 v232, v232, v233
    v_cvt_pk_bf16_f32 v236, v236, v237
    v_cvt_f32_i32 v234, v234
    v_cvt_f32_i32 v235, v235
    v_cvt_f32_i32 v238, v238
    v_mfma_f32_16x16x32_bf16 v[76:79], v[40:43], v[208:211], v[76:79]
    ds_read_b128 v[36:39], v3 offset:256
    v_cvt_f32_i32 v239, v239
    v_mfma_f32_16x16x32_bf16 v[76:79], v[44:47], v[212:215], v[76:79]
    s_waitcnt lgkmcnt(2)
    v_fma_f32 v234, v234, v56, v58
    v_fma_f32 v235, v235, v57, v59
    v_fma_f32 v238, v238, v56, v58
    v_fma_f32 v239, v239, v57, v59
    v_cvt_pk_bf16_f32 v233, v234, v235
    v_cvt_pk_bf16_f32 v237, v238, v239
    v_mfma_f32_16x16x32_bf16 v[104:107], v[24:27], a[248:251], v[104:107]
    ds_read_b128 v[40:43], v2 offset:6400
    ds_read_b128 v[48:51], v10 offset:1152
    v_mfma_f32_16x16x32_bf16 v[104:107], v[28:31], a[252:255], v[104:107]
    buffer_load_dwordx4 v4, s[4:7], s32 offen offset:2048 sc1 lds
    s_waitcnt vmcnt(10)
    v_cvt_f32_i32 v240, v240
    v_cvt_f32_i32 v241, v241
    v_cvt_f32_i32 v244, v244
    v_mfma_f32_16x16x32_bf16 v[108:111], v[24:27], v[208:211], v[108:111]
    ds_read_b128 v[44:47], v3 offset:6400
    ds_read_b128 v[56:59], v23 offset:0
    v_mfma_f32_16x16x32_bf16 v[108:111], v[28:31], v[212:215], v[108:111]
    s_waitcnt lgkmcnt(4)
    v_add_u32 v10, 1792, v10
    v_cvt_f32_i32 v245, v245
    v_fma_f32 v240, v240, v60, v62
    v_fma_f32 v241, v241, v61, v63
    v_fma_f32 v244, v244, v60, v62
    v_fma_f32 v245, v245, v61, v63
    v_cvt_pk_bf16_f32 v226, v240, v241
    v_cvt_pk_bf16_f32 v230, v244, v245
    s_waitcnt lgkmcnt(2)
    v_mfma_f32_16x16x32_bf16 v[72:75], v[32:35], v[192:195], v[72:75]
    ds_read_b128 v[24:27], v2 offset:12288
    v_cvt_f32_i32 v242, v242
    v_mfma_f32_16x16x32_bf16 v[72:75], v[36:39], v[196:199], v[72:75]
    s_add_u32 s32, s32, 24576
    s_sub_u32 s57, s32, 196608
    s_min_u32 s32, s32, s57
    v_cvt_f32_i32 v243, v243
    v_cvt_f32_i32 v246, v246
    v_cvt_f32_i32 v247, v247
    v_fma_f32 v242, v242, v48, v50
    v_fma_f32 v243, v243, v49, v51
    v_fma_f32 v246, v246, v48, v50
    v_mfma_f32_16x16x32_bf16 v[76:79], v[32:35], v[216:219], v[76:79]
    ds_read_b128 v[28:31], v3 offset:12288
    v_fma_f32 v247, v247, v49, v51
    v_mfma_f32_16x16x32_bf16 v[76:79], v[36:39], v[220:223], v[76:79]
    s_waitcnt lgkmcnt(3)
    v_cvt_pk_bf16_f32 v227, v242, v243
    v_cvt_pk_bf16_f32 v231, v246, v247
    s_waitcnt vmcnt(8)
    v_cvt_f32_i32 v248, v248
    v_cvt_f32_i32 v249, v249
    v_cvt_f32_i32 v252, v252
    v_cvt_f32_i32 v253, v253
    v_fma_f32 v248, v248, v60, v62
    v_mfma_f32_16x16x32_bf16 v[104:107], v[40:43], v[192:195], v[104:107]
    ds_read_b128 v[32:35], v2 offset:18432
    v_fma_f32 v249, v249, v61, v63
    v_mfma_f32_16x16x32_bf16 v[104:107], v[44:47], v[196:199], v[104:107]
    s_add_u32 s26, s26, 12288
    v_fma_f32 v252, v252, v60, v62
    v_fma_f32 v253, v253, v61, v63
    v_cvt_pk_bf16_f32 v234, v248, v249
    v_cvt_pk_bf16_f32 v238, v252, v253
    v_cvt_f32_i32 v250, v250
    v_cvt_f32_i32 v251, v251
    v_cvt_f32_i32 v254, v254
    v_cvt_f32_i32 v255, v255
    v_mfma_f32_16x16x32_bf16 v[108:111], v[40:43], v[216:219], v[108:111]
    ds_read_b128 v[36:39], v3 offset:18432
    v_fma_f32 v250, v250, v48, v50
    v_mfma_f32_16x16x32_bf16 v[108:111], v[44:47], v[220:223], v[108:111]
    s_waitcnt lgkmcnt(2)
    v_fma_f32 v251, v251, v49, v51
    v_fma_f32 v254, v254, v48, v50
    v_fma_f32 v255, v255, v49, v51
    v_cvt_pk_bf16_f32 v235, v250, v251
    v_cvt_pk_bf16_f32 v239, v254, v255
    v_mfma_f32_16x16x32_bf16 v[88:91], v[24:27], a[240:243], 0
    ds_read_b128 v[40:43], v2 offset:12416
    v_mfma_f32_16x16x32_bf16 v[88:91], v[28:31], a[244:247], v[88:91]
    s_mov_b32 m0, s26
    v_mfma_f32_16x16x32_bf16 v[92:95], v[24:27], v[200:203], 0
    ds_read_b128 v[44:47], v3 offset:12416
    v_mfma_f32_16x16x32_bf16 v[92:95], v[28:31], v[204:207], v[92:95]
    s_waitcnt lgkmcnt(2)
    v_mfma_f32_16x16x32_bf16 v[120:123], v[32:35], a[240:243], 0
    ds_read_b128 v[24:27], v2 offset:18560
    v_max3_f32 v16, v72, v73, v74
    v_mfma_f32_16x16x32_bf16 v[120:123], v[36:39], a[244:247], v[120:123]
    buffer_load_dwordx4 v4, s[4:7], s32 offen offset:0 sc1 lds
    v_max3_f32 v18, v76, v77, v78
    v_max3_f32 v16, v16, v75, v104
    v_max3_f32 v18, v18, v79, v108
    v_max3_f32 v16, v16, v105, v106
    v_max3_f32 v18, v18, v109, v110
    v_max_f32 v16, v16, v107
    v_mfma_f32_16x16x32_bf16 v[124:127], v[32:35], v[200:203], 0
    ds_read_b128 v[28:31], v3 offset:18560
    v_max_f32 v18, v18, v111
    v_mfma_f32_16x16x32_bf16 v[124:127], v[36:39], v[204:207], v[124:127]
    s_waitcnt lgkmcnt(2)
    v_mov_b32 v17, v16
    v_mov_b32 v19, v18
    s_nop 0
    v_permlane16_swap_b32 v16, v17
    v_permlane16_swap_b32 v18, v19
    s_nop 0
    v_max_f32 v16, v16, v17
    v_max_f32 v18, v18, v19
    v_mfma_f32_16x16x32_bf16 v[88:91], v[40:43], a[248:251], v[88:91]
    ds_read_b128 v[32:35], v2 offset:12544
    v_mov_b32 v17, v16
    v_mfma_f32_16x16x32_bf16 v[88:91], v[44:47], a[252:255], v[88:91]
    buffer_load_dwordx4 v4, s[4:7], s32 offen offset:1024 sc1 lds
    v_mov_b32 v19, v18
    s_nop 0
    v_permlane32_swap_b32 v16, v17
    v_permlane32_swap_b32 v18, v19
    s_nop 0
    v_max_f32 v16, v16, v17
    v_mfma_f32_16x16x32_bf16 v[92:95], v[40:43], v[208:211], v[92:95]
    ds_read_b128 v[36:39], v3 offset:12544
    v_max_f32 v18, v18, v19
    v_mfma_f32_16x16x32_bf16 v[92:95], v[44:47], v[212:215], v[92:95]
    s_waitcnt lgkmcnt(2)
    v_sub_f32 v136, 0, v16
    v_sub_f32 v137, 0, v16
    v_sub_f32 v138, 0, v16
    v_sub_f32 v139, 0, v16
    v_sub_f32 v140, 0, v18
    v_sub_f32 v141, 0, v18
    v_sub_f32 v142, 0, v18
    v_sub_f32 v143, 0, v18
    v_mfma_f32_16x16x32_bf16 v[120:123], v[24:27], a[248:251], v[120:123]
    ds_read_b128 v[40:43], v2 offset:18688
    v_add_f32 v72, v72, v136
    v_mfma_f32_16x16x32_bf16 v[120:123], v[28:31], a[252:255], v[120:123]
    buffer_load_dwordx4 v4, s[4:7], s32 offen offset:2048 sc1 lds
    v_add_f32 v73, v73, v136
    v_add_f32 v74, v74, v136
    v_add_f32 v75, v75, v136
    v_add_f32 v104, v104, v136
    v_add_f32 v105, v105, v136
    v_add_f32 v106, v106, v136
    v_mfma_f32_16x16x32_bf16 v[124:127], v[24:27], v[208:211], v[124:127]
    ds_read_b128 v[44:47], v3 offset:18688
    v_add_f32 v107, v107, v136
    v_mfma_f32_16x16x32_bf16 v[124:127], v[28:31], v[212:215], v[124:127]
    s_waitcnt lgkmcnt(2)
    v_add_f32 v76, v76, v140
    v_add_f32 v77, v77, v140
    v_add_f32 v78, v78, v140
    v_add_f32 v79, v79, v140
    v_add_f32 v108, v108, v140
    v_add_f32 v109, v109, v140
    v_add_f32 v110, v110, v140
    v_add_f32 v111, v111, v140
    v_mfma_f32_16x16x32_bf16 v[88:91], v[32:35], v[192:195], v[88:91]
    v_add_u32 v2, 49152, v2
    v_add_u32 v3, 49152, v3
    ds_read_b128 v[24:27], v2 offset:0
    v_mfma_f32_16x16x32_bf16 v[88:91], v[36:39], v[196:199], v[88:91]
    s_add_u32 s32, s32, 24576
    s_sub_u32 s57, s32, 196608
    s_min_u32 s32, s32, s57
    v_exp_f32 v16, v72
    v_exp_f32 v17, v73
    v_exp_f32 v18, v74
    v_mfma_f32_16x16x32_bf16 v[92:95], v[32:35], v[216:219], v[92:95]
    ds_read_b128 v[28:31], v3 offset:0
    v_add_f32 v7, v7, v16
    v_mfma_f32_16x16x32_bf16 v[92:95], v[36:39], v[220:223], v[92:95]
    s_waitcnt lgkmcnt(2)
    v_add_f32 v7, v7, v17
    v_exp_f32 v19, v75
    v_cvt_pk_bf16_f32 v72, v16, v17
    v_exp_f32 v16, v104
    v_add_f32 v7, v7, v18
    v_add_f32 v7, v7, v19
    v_mfma_f32_16x16x32_bf16 v[120:123], v[40:43], v[192:195], v[120:123]
    ds_read_b128 v[32:35], v2 offset:6144
    v_mfma_f32_16x16x32_bf16 v[120:123], v[44:47], v[196:199], v[120:123]
    s_add_u32 s26, s26, 36864
    s_sub_u32 s57, s26, 147456
    s_min_u32 s26, s26, s57
    v_exp_f32 v17, v105
    v_cvt_pk_bf16_f32 v73, v18, v19
    v_exp_f32 v18, v106
    v_add_f32 v7, v7, v16
    v_mfma_f32_16x16x32_bf16 v[124:127], v[40:43], v[216:219], v[124:127]
    ds_read_b128 v[36:39], v3 offset:6144
    v_add_f32 v7, v7, v17
    v_mfma_f32_16x16x32_bf16 v[124:127], v[44:47], v[220:223], v[124:127]
    s_waitcnt lgkmcnt(2)
    v_exp_f32 v19, v107
    v_cvt_pk_bf16_f32 v74, v16, v17
    v_exp_f32 v16, v76
    v_add_f32 v7, v7, v18
    v_add_f32 v7, v7, v19
    s_nop 1
    v_mfma_f32_16x16x32_bf16 v[168:171], v[24:27], a[240:243], v[136:139]
    ds_read_b128 v[40:43], v2 offset:128
    v_mfma_f32_16x16x32_bf16 v[168:171], v[28:31], a[244:247], v[168:171]
    buffer_store_dwordx4 v[224:227], v11, s[4:7], s37 offen offset:0 sc1
    v_mfma_f32_16x16x32_bf16 v[172:175], v[24:27], v[200:203], v[140:143]
    ds_read_b128 v[44:47], v3 offset:128
    v_mfma_f32_16x16x32_bf16 v[172:175], v[28:31], v[204:207], v[172:175]
    s_waitcnt lgkmcnt(2)
    v_exp_f32 v17, v77
    v_cvt_pk_bf16_f32 v75, v18, v19
    v_exp_f32 v18, v78
    v_add_f32 v8, v8, v16
    v_mfma_f32_16x16x32_bf16 v[96:99], v[32:35], a[240:243], v[136:139]
    ds_read_b128 v[24:27], v2 offset:6272
    v_add_f32 v8, v8, v17
    v_mfma_f32_16x16x32_bf16 v[96:99], v[36:39], a[244:247], v[96:99]
    v_exp_f32 v19, v79
    v_cvt_pk_bf16_f32 v76, v16, v17
    v_exp_f32 v16, v108
    v_add_f32 v8, v8, v18
    v_mfma_f32_16x16x32_bf16 v[100:103], v[32:35], v[200:203], v[140:143]
    ds_read_b128 v[28:31], v3 offset:6272
    v_add_f32 v8, v8, v19
    v_mfma_f32_16x16x32_bf16 v[100:103], v[36:39], v[204:207], v[100:103]
    s_waitcnt lgkmcnt(2)
    v_exp_f32 v17, v109
    v_cvt_pk_bf16_f32 v77, v18, v19
    v_exp_f32 v18, v110
    v_add_f32 v8, v8, v16
    v_mfma_f32_16x16x32_bf16 v[168:171], v[40:43], a[248:251], v[168:171]
    ds_read_b128 v[32:35], v2 offset:256
    v_add_f32 v8, v8, v17
    v_mfma_f32_16x16x32_bf16 v[168:171], v[44:47], a[252:255], v[168:171]
    buffer_store_dwordx4 v[228:231], v54, s[4:7], s37 offen offset:768 sc1
    v_mfma_f32_16x16x32_bf16 v[172:175], v[40:43], v[208:211], v[172:175]
    ds_read_b128 v[36:39], v3 offset:256
    v_mfma_f32_16x16x32_bf16 v[172:175], v[44:47], v[212:215], v[172:175]
    s_waitcnt lgkmcnt(2)
    v_exp_f32 v19, v111
    v_cvt_pk_bf16_f32 v78, v16, v17
    v_add_f32 v8, v8, v18
    v_add_f32 v8, v8, v19
    v_cvt_pk_bf16_f32 v79, v18, v19
    v_mfma_f32_16x16x32_bf16 v[96:99], v[24:27], a[248:251], v[96:99]
    ds_read_b128 v[40:43], v2 offset:6400
    v_add_f32 v88, v88, v136
    v_mfma_f32_16x16x32_bf16 v[96:99], v[28:31], a[252:255], v[96:99]
    v_add_f32 v89, v89, v136
    v_add_f32 v90, v90, v136
    v_add_f32 v91, v91, v136
    v_add_f32 v120, v120, v136
    v_add_f32 v121, v121, v136
    v_add_f32 v122, v122, v136
    v_mfma_f32_16x16x32_bf16 v[100:103], v[24:27], v[208:211], v[100:103]
    ds_read_b128 v[44:47], v3 offset:6400
    v_add_f32 v123, v123, v136
    v_mfma_f32_16x16x32_bf16 v[100:103], v[28:31], v[212:215], v[100:103]
    s_waitcnt lgkmcnt(2)
    v_add_f32 v92, v92, v140
    v_add_f32 v93, v93, v140
    v_add_f32 v94, v94, v140
    v_add_f32 v95, v95, v140
    v_add_f32 v124, v124, v140
    v_add_f32 v125, v125, v140
    v_mfma_f32_16x16x32_bf16 v[168:171], v[32:35], v[192:195], v[168:171]
    ds_read_b128 v[24:27], v2 offset:12288
    v_add_f32 v126, v126, v140
    v_mfma_f32_16x16x32_bf16 v[168:171], v[36:39], v[196:199], v[168:171]
    buffer_store_dwordx4 v[232:235], v11, s[4:7], s80 offen offset:0 sc1
    v_add_f32 v127, v127, v140
    v_mfma_f32_16x16x32_bf16 v[172:175], v[32:35], v[216:219], v[172:175]
    ds_read_b128 v[28:31], v3 offset:12288
    v_mfma_f32_16x16x32_bf16 v[172:175], v[36:39], v[220:223], v[172:175]
    s_waitcnt lgkmcnt(2)
    v_exp_f32 v16, v88
    v_exp_f32 v17, v89
    v_exp_f32 v18, v90
    v_mfma_f32_16x16x32_bf16 v[96:99], v[40:43], v[192:195], v[96:99]
    ds_read_b128 v[32:35], v2 offset:18432
    v_add_f32 v7, v7, v16
    v_mfma_f32_16x16x32_bf16 v[96:99], v[44:47], v[196:199], v[96:99]
    v_add_f32 v7, v7, v17
    v_exp_f32 v19, v91
    v_cvt_pk_bf16_f32 v88, v16, v17
    v_exp_f32 v16, v120
    v_mfma_f32_16x16x32_bf16 v[100:103], v[40:43], v[216:219], v[100:103]
    ds_read_b128 v[36:39], v3 offset:18432
    v_add_f32 v7, v7, v18
    v_mfma_f32_16x16x32_bf16 v[100:103], v[44:47], v[220:223], v[100:103]
    s_waitcnt lgkmcnt(2)
    v_add_f32 v7, v7, v19
    v_exp_f32 v17, v121
    v_cvt_pk_bf16_f32 v89, v18, v19
    v_exp_f32 v18, v122
    v_mfma_f32_16x16x32_bf16 v[184:187], v[24:27], a[240:243], v[136:139]
    ds_read_b128 v[40:43], v2 offset:12416
    v_add_f32 v7, v7, v16
    v_mfma_f32_16x16x32_bf16 v[184:187], v[28:31], a[244:247], v[184:187]
    buffer_store_dwordx4 v[236:239], v54, s[4:7], s80 offen offset:768 sc1
    v_add_f32 v7, v7, v17
    v_mfma_f32_16x16x32_bf16 v[188:191], v[24:27], v[200:203], v[140:143]
    ds_read_b128 v[44:47], v3 offset:12416
    v_mfma_f32_16x16x32_bf16 v[188:191], v[28:31], v[204:207], v[188:191]
    s_waitcnt lgkmcnt(2)
    v_exp_f32 v19, v123
    v_cvt_pk_bf16_f32 v90, v16, v17
    v_exp_f32 v16, v92
    v_add_f32 v7, v7, v18
    v_mfma_f32_16x16x32_bf16 v[112:115], v[32:35], a[240:243], v[136:139]
    ds_read_b128 v[24:27], v2 offset:18560
    v_add_f32 v7, v7, v19
    v_mfma_f32_16x16x32_bf16 v[112:115], v[36:39], a[244:247], v[112:115]
    v_exp_f32 v17, v93
    v_cvt_pk_bf16_f32 v91, v18, v19
    v_exp_f32 v18, v94
    v_add_f32 v8, v8, v16
    v_mfma_f32_16x16x32_bf16 v[116:119], v[32:35], v[200:203], v[140:143]
    ds_read_b128 v[28:31], v3 offset:18560
    v_add_f32 v8, v8, v17
    v_mfma_f32_16x16x32_bf16 v[116:119], v[36:39], v[204:207], v[116:119]
    s_waitcnt lgkmcnt(2)
    v_exp_f32 v19, v95
    v_cvt_pk_bf16_f32 v92, v16, v17
    v_exp_f32 v16, v124
    v_add_f32 v8, v8, v18
    v_mfma_f32_16x16x32_bf16 v[184:187], v[40:43], a[248:251], v[184:187]
    ds_read_b128 v[32:35], v2 offset:12544
    v_add_f32 v8, v8, v19
    v_mfma_f32_16x16x32_bf16 v[184:187], v[44:47], a[252:255], v[184:187]
    buffer_load_dwordx4 v[240:243], v12, s[68:71], s36 offen offset:0 nt
    v_exp_f32 v17, v125
    v_cvt_pk_bf16_f32 v93, v18, v19
    v_mfma_f32_16x16x32_bf16 v[188:191], v[40:43], v[208:211], v[188:191]
    ds_read_b128 v[36:39], v3 offset:12544
    v_mfma_f32_16x16x32_bf16 v[188:191], v[44:47], v[212:215], v[188:191]
    s_waitcnt lgkmcnt(2)
    v_exp_f32 v18, v126
    v_add_f32 v8, v8, v16
    v_add_f32 v8, v8, v17
    v_exp_f32 v19, v127
    v_mfma_f32_16x16x32_bf16 v[112:115], v[24:27], a[248:251], v[112:115]
    ds_read_b128 v[40:43], v2 offset:18688
    v_cvt_pk_bf16_f32 v94, v16, v17
    v_mfma_f32_16x16x32_bf16 v[112:115], v[28:31], a[252:255], v[112:115]
    buffer_load_dwordx4 v[244:247], v12, s[68:71], s36 offen offset:768 nt
    v_add_f32 v8, v8, v18
    v_add_f32 v8, v8, v19
    v_cvt_pk_bf16_f32 v95, v18, v19
    v_mfma_f32_16x16x32_bf16 v[116:119], v[24:27], v[208:211], v[116:119]
    ds_read_b128 v[44:47], v3 offset:18688
    v_mfma_f32_16x16x32_bf16 v[116:119], v[28:31], v[212:215], v[116:119]
    s_waitcnt lgkmcnt(2)
    v_mfma_f32_16x16x32_bf16 v[184:187], v[32:35], v[192:195], v[184:187]
    v_add_u32 v1, 4294918144, v1
    v_add_u32 v21, 4294918144, v21
    v_add_u32 v22, 4294918144, v22
    ds_read_b128 v[24:27], v1 offset:0
    v_mfma_f32_16x16x32_bf16 v[184:187], v[36:39], v[196:199], v[184:187]
    buffer_load_dwordx4 v[248:251], v12, s[68:71], s36 offen offset:1536 nt
    v_mfma_f32_16x16x32_bf16 v[188:191], v[32:35], v[216:219], v[188:191]
    ds_read_b128 v[28:31], v1 offset:12288
    v_mfma_f32_16x16x32_bf16 v[188:191], v[36:39], v[220:223], v[188:191]
    s_waitcnt lgkmcnt(2)
    v_mfma_f32_16x16x32_bf16 v[112:115], v[40:43], v[192:195], v[112:115]
    ds_read_b128 v[32:35], v1 offset:768
    v_mfma_f32_16x16x32_bf16 v[112:115], v[44:47], v[196:199], v[112:115]
    buffer_load_dwordx4 v[252:255], v12, s[68:71], s36 offen offset:2304 nt
    v_mfma_f32_16x16x32_bf16 v[116:119], v[40:43], v[216:219], v[116:119]
    ds_read_b128 v[36:39], v1 offset:13056
    v_mfma_f32_16x16x32_bf16 v[116:119], v[44:47], v[220:223], v[116:119]
    s_waitcnt lgkmcnt(2)
    v_mfma_f32_16x16x32_bf16 a[96:99], v[72:75], v[24:27], 0
    ds_read_b128 v[40:43], v1 offset:1536
    ds_read_b128 v[60:63], v23 offset:16
    v_mfma_f32_16x16x32_bf16 a[96:99], v[88:91], v[28:31], a[96:99]
    s_mov_b32 m0, s56
    v_exp_f32 v16, v168
    v_exp_f32 v17, v169
    v_exp_f32 v18, v170
    v_mfma_f32_16x16x32_bf16 a[144:147], v[76:79], v[24:27], 0
    ds_read_b128 v[44:47], v1 offset:13824
    v_add_f32 v7, v7, v16
    v_mfma_f32_16x16x32_bf16 a[144:147], v[92:95], v[28:31], a[144:147]
    s_waitcnt lgkmcnt(3)
    v_add_f32 v7, v7, v17
    v_exp_f32 v19, v171
    v_cvt_pk_bf16_f32 v168, v16, v17
    v_exp_f32 v16, v96
    v_mfma_f32_16x16x32_bf16 a[100:103], v[72:75], v[32:35], 0
    ds_read_b128 v[24:27], v1 offset:2304
    v_add_f32 v7, v7, v18
    v_mfma_f32_16x16x32_bf16 a[100:103], v[88:91], v[36:39], a[100:103]
    buffer_load_dwordx4 v4, s[4:7], s27 offen offset:0 sc1 lds
    v_add_f32 v7, v7, v19
    v_exp_f32 v17, v97
    v_cvt_pk_bf16_f32 v169, v18, v19
    v_mfma_f32_16x16x32_bf16 a[148:151], v[76:79], v[32:35], 0
    ds_read_b128 v[28:31], v1 offset:14592
    s_waitcnt vmcnt(18)
    v_mfma_f32_16x16x32_bf16 a[148:151], v[92:95], v[36:39], a[148:151]
    s_waitcnt lgkmcnt(2)
    v_exp_f32 v18, v98
    v_add_f32 v7, v7, v16
    v_add_f32 v7, v7, v17
    v_exp_f32 v19, v99
    v_mfma_f32_16x16x32_bf16 a[104:107], v[72:75], v[40:43], 0
    ds_read_b128 v[32:35], v21 offset:0
    v_cvt_pk_bf16_f32 v170, v16, v17
    v_mfma_f32_16x16x32_bf16 a[104:107], v[88:91], v[44:47], a[104:107]
    buffer_load_dwordx4 v4, s[4:7], s27 offen offset:1024 sc1 lds
    v_exp_f32 v16, v172
    v_add_f32 v7, v7, v18
    v_add_f32 v7, v7, v19
    v_mfma_f32_16x16x32_bf16 a[152:155], v[76:79], v[40:43], 0
    ds_read_b128 v[36:39], v21 offset:12288
    v_cvt_f32_i32 v144, v144
    v_mfma_f32_16x16x32_bf16 a[152:155], v[92:95], v[44:47], a[152:155]
    s_waitcnt lgkmcnt(2)
    v_exp_f32 v17, v173
    v_cvt_pk_bf16_f32 v171, v18, v19
    v_exp_f32 v18, v174
    v_add_f32 v8, v8, v16
    v_mfma_f32_16x16x32_bf16 a[108:111], v[72:75], v[24:27], 0
    ds_read_b128 v[40:43], v21 offset:768
    v_add_f32 v8, v8, v17
    v_mfma_f32_16x16x32_bf16 a[108:111], v[88:91], v[28:31], a[108:111]
    buffer_load_dwordx4 v4, s[4:7], s27 offen offset:2048 sc1 lds
    v_exp_f32 v19, v175
    v_cvt_pk_bf16_f32 v172, v16, v17
    v_cvt_f32_i32 v148, v148
    v_mfma_f32_16x16x32_bf16 a[156:159], v[76:79], v[24:27], 0
    ds_read_b128 v[44:47], v21 offset:13056
    v_cvt_f32_i32 v145, v145
    v_mfma_f32_16x16x32_bf16 a[156:159], v[92:95], v[28:31], a[156:159]
    s_waitcnt lgkmcnt(2)
    v_exp_f32 v16, v100
    v_add_f32 v8, v8, v18
    v_add_f32 v8, v8, v19
    v_exp_f32 v17, v101
    v_mfma_f32_16x16x32_bf16 a[112:115], v[72:75], v[32:35], 0
    ds_read_b128 v[24:27], v21 offset:1536
    v_cvt_pk_bf16_f32 v173, v18, v19
    v_mfma_f32_16x16x32_bf16 a[112:115], v[88:91], v[36:39], a[112:115]
    s_add_u32 s27, s27, 24576
    s_sub_u32 s58, s27, 196608
    s_min_u32 s27, s27, s58
    v_exp_f32 v18, v102
    v_add_f32 v8, v8, v16
    v_add_f32 v8, v8, v17
    v_mfma_f32_16x16x32_bf16 a[160:163], v[76:79], v[32:35], 0
    ds_read_b128 v[28:31], v21 offset:13824
    ds_read_b128 v[48:51], v23 offset:32
    v_mfma_f32_16x16x32_bf16 a[160:163], v[92:95], v[36:39], a[160:163]
    s_waitcnt lgkmcnt(3)
    v_exp_f32 v19, v103
    v_cvt_pk_bf16_f32 v174, v16, v17
    v_add_f32 v8, v8, v18
    v_add_f32 v8, v8, v19
    v_cvt_pk_bf16_f32 v175, v18, v19
    v_mfma_f32_16x16x32_bf16 a[116:119], v[72:75], v[40:43], 0
    ds_read_b128 v[32:35], v21 offset:2304
    v_cvt_f32_i32 v149, v149
    v_mfma_f32_16x16x32_bf16 a[116:119], v[88:91], v[44:47], a[116:119]
    s_add_u32 s56, s56, 12288
    v_mfma_f32_16x16x32_bf16 a[164:167], v[76:79], v[40:43], 0
    ds_read_b128 v[36:39], v21 offset:14592
    v_mfma_f32_16x16x32_bf16 a[164:167], v[92:95], v[44:47], a[164:167]
    s_waitcnt lgkmcnt(3)
    v_mfma_f32_16x16x32_bf16 a[120:123], v[72:75], v[24:27], 0
    ds_read_b128 v[40:43], v22 offset:0
    v_mfma_f32_16x16x32_bf16 a[120:123], v[88:91], v[28:31], a[120:123]
    v_mfma_f32_16x16x32_bf16 a[168:171], v[76:79], v[24:27], 0
    ds_read_b128 v[44:47], v22 offset:12288
    v_mfma_f32_16x16x32_bf16 a[168:171], v[92:95], v[28:31], a[168:171]
    s_waitcnt lgkmcnt(2)
    v_mfma_f32_16x16x32_bf16 a[124:127], v[72:75], v[32:35], 0
    ds_read_b128 v[24:27], v22 offset:768
    v_mfma_f32_16x16x32_bf16 a[124:127], v[88:91], v[36:39], a[124:127]
    v_mfma_f32_16x16x32_bf16 a[172:175], v[76:79], v[32:35], 0
    ds_read_b128 v[28:31], v22 offset:13056
    v_mfma_f32_16x16x32_bf16 a[172:175], v[92:95], v[36:39], a[172:175]
    s_waitcnt lgkmcnt(2)
    v_mfma_f32_16x16x32_bf16 a[128:131], v[72:75], v[40:43], 0
    ds_read_b128 v[32:35], v22 offset:1536
    v_mfma_f32_16x16x32_bf16 a[128:131], v[88:91], v[44:47], a[128:131]
    v_mfma_f32_16x16x32_bf16 a[176:179], v[76:79], v[40:43], 0
    ds_read_b128 v[36:39], v22 offset:13824
    v_mfma_f32_16x16x32_bf16 a[176:179], v[92:95], v[44:47], a[176:179]
    s_waitcnt lgkmcnt(2)
    v_mfma_f32_16x16x32_bf16 a[132:135], v[72:75], v[24:27], 0
    ds_read_b128 v[40:43], v22 offset:2304
    v_mfma_f32_16x16x32_bf16 a[132:135], v[88:91], v[28:31], a[132:135]
    s_waitcnt vmcnt(7)
    s_barrier
    v_mfma_f32_16x16x32_bf16 a[180:183], v[76:79], v[24:27], 0
    ds_read_b128 v[44:47], v22 offset:14592
    v_mfma_f32_16x16x32_bf16 a[180:183], v[92:95], v[28:31], a[180:183]
    s_waitcnt lgkmcnt(2)
    v_mfma_f32_16x16x32_bf16 a[136:139], v[72:75], v[32:35], 0
    v_add_u32 v2, 49152, v2
    v_add_u32 v3, 49152, v3
    s_mov_b32 s28, 98304
    ds_read_b128 v[24:27], v2 offset:0
    v_mfma_f32_16x16x32_bf16 a[136:139], v[88:91], v[36:39], a[136:139]
    v_add_u32 v55, 1, v55
    buffer_store_dword v55, v13, s[20:23], 0 offen sc1
    v_mfma_f32_16x16x32_bf16 a[184:187], v[76:79], v[32:35], 0
    ds_read_b128 v[28:31], v3 offset:0
    v_mfma_f32_16x16x32_bf16 a[184:187], v[92:95], v[36:39], a[184:187]
    s_waitcnt lgkmcnt(2)
    v_mfma_f32_16x16x32_bf16 a[140:143], v[72:75], v[40:43], 0
    ds_read_b128 v[32:35], v2 offset:6144
    v_mfma_f32_16x16x32_bf16 a[140:143], v[88:91], v[44:47], a[140:143]
    v_mfma_f32_16x16x32_bf16 a[188:191], v[76:79], v[40:43], 0
    ds_read_b128 v[36:39], v3 offset:6144
    v_mfma_f32_16x16x32_bf16 a[188:191], v[92:95], v[44:47], a[188:191]
    s_waitcnt lgkmcnt(2)
    s_mov_b32 s31, 5
    v_mfma_f32_16x16x32_bf16 v[64:67], v[24:27], a[192:195], v[128:131]
    s_mov_b32 m0, s56
    ds_read_b128 v[40:43], v2 offset:128
    v_fma_f32 v144, v144, v56, v58
    v_mfma_f32_16x16x32_bf16 v[64:67], v[28:31], a[196:199], v[64:67]
    v_exp_f32 v16, v184
    v_mfma_f32_16x16x32_bf16 v[68:71], v[24:27], a[216:219], v[132:135]
    v_exp_f32 v17, v185
    v_mfma_f32_16x16x32_bf16 v[68:71], v[28:31], a[220:223], v[68:71]
    buffer_load_dwordx4 v4, s[4:7], s27 offen offset:0 sc1 lds
    v_mfma_f32_16x16x32_bf16 v[72:75], v[24:27], a[240:243], v[136:139]
    ds_read_b128 v[44:47], v3 offset:128
    v_fma_f32 v148, v148, v57, v59
    v_mfma_f32_16x16x32_bf16 v[72:75], v[28:31], a[244:247], v[72:75]
    v_exp_f32 v18, v186
    v_mfma_f32_16x16x32_bf16 v[76:79], v[24:27], v[200:203], v[140:143]
    v_add_f32 v7, v7, v16
    v_add_f32 v7, v7, v17
    v_mfma_f32_16x16x32_bf16 v[76:79], v[28:31], v[204:207], v[76:79]
    s_waitcnt lgkmcnt(2)
    buffer_load_dwordx4 v4, s[4:7], s27 offen offset:1024 sc1 lds
    v_mfma_f32_16x16x32_bf16 v[96:99], v[32:35], a[192:195], v[128:131]
    ds_read_b128 v[24:27], v2 offset:6272
    v_fma_f32 v145, v145, v56, v58
    v_mfma_f32_16x16x32_bf16 v[96:99], v[36:39], a[196:199], v[96:99]
    v_exp_f32 v19, v187
    v_mfma_f32_16x16x32_bf16 v[100:103], v[32:35], a[216:219], v[132:135]
    v_cvt_pk_bf16_f32 v184, v16, v17
    v_fma_f32 v149, v149, v57, v59
    v_mfma_f32_16x16x32_bf16 v[100:103], v[36:39], a[220:223], v[100:103]
    v_exp_f32 v16, v112
    v_mfma_f32_16x16x32_bf16 v[104:107], v[32:35], a[240:243], v[136:139]
    ds_read_b128 v[28:31], v3 offset:6272
    v_add_f32 v7, v7, v18
    v_mfma_f32_16x16x32_bf16 v[104:107], v[36:39], a[244:247], v[104:107]
    buffer_load_dwordx4 v4, s[4:7], s27 offen offset:2048 sc1 lds
    v_mfma_f32_16x16x32_bf16 v[108:111], v[32:35], v[200:203], v[140:143]
    v_add_f32 v7, v7, v19
    v_cvt_f32_i32 v146, v146
    v_mfma_f32_16x16x32_bf16 v[108:111], v[36:39], v[204:207], v[108:111]
    s_waitcnt lgkmcnt(2)
    v_exp_f32 v17, v113
    v_mfma_f32_16x16x32_bf16 v[64:67], v[40:43], a[200:203], v[64:67]
    s_add_u32 s27, s27, 24576
    ds_read_b128 v[32:35], v2 offset:256
    v_cvt_pk_bf16_f32 v185, v18, v19
    v_mfma_f32_16x16x32_bf16 v[64:67], v[44:47], a[204:207], v[64:67]
    v_exp_f32 v18, v114
    v_mfma_f32_16x16x32_bf16 v[68:71], v[40:43], a[224:227], v[68:71]
    s_sub_u32 s58, s27, 196608
    v_add_f32 v7, v7, v16
    v_cvt_f32_i32 v150, v150
    v_mfma_f32_16x16x32_bf16 v[68:71], v[44:47], a[228:231], v[68:71]
    v_add_f32 v7, v7, v17
    v_cvt_f32_i32 v147, v147
    v_mfma_f32_16x16x32_bf16 v[72:75], v[40:43], a[248:251], v[72:75]
    ds_read_b128 v[36:39], v3 offset:256
    v_mfma_f32_16x16x32_bf16 v[72:75], v[44:47], a[252:255], v[72:75]
    s_min_u32 s27, s27, s58
    v_exp_f32 v19, v115
    v_mfma_f32_16x16x32_bf16 v[76:79], v[40:43], v[208:211], v[76:79]
    v_cvt_pk_bf16_f32 v186, v16, v17
    v_cvt_f32_i32 v151, v151
    v_mfma_f32_16x16x32_bf16 v[76:79], v[44:47], v[212:215], v[76:79]
    s_waitcnt lgkmcnt(2)
    v_exp_f32 v16, v188
    v_mfma_f32_16x16x32_bf16 v[96:99], v[24:27], a[200:203], v[96:99]
    s_add_u32 s56, s56, 36864
    ds_read_b128 v[40:43], v2 offset:6400
    v_add_f32 v7, v7, v18
    v_mfma_f32_16x16x32_bf16 v[96:99], v[28:31], a[204:207], v[96:99]
    v_add_f32 v7, v7, v19
    v_fma_f32 v146, v146, v56, v58
    v_mfma_f32_16x16x32_bf16 v[100:103], v[24:27], a[224:227], v[100:103]
    s_sub_u32 s58, s56, 147456
    v_exp_f32 v17, v189
    v_mfma_f32_16x16x32_bf16 v[100:103], v[28:31], a[228:231], v[100:103]
    v_cvt_pk_bf16_f32 v187, v18, v19
    v_mfma_f32_16x16x32_bf16 v[104:107], v[24:27], a[248:251], v[104:107]
    s_min_u32 s56, s56, s58
    ds_read_b128 v[44:47], v3 offset:6400
    v_mfma_f32_16x16x32_bf16 v[104:107], v[28:31], a[252:255], v[104:107]
    v_exp_f32 v18, v190
    v_mfma_f32_16x16x32_bf16 v[108:111], v[24:27], v[208:211], v[108:111]
    s_add_u32 s29, s30, 49152
    v_add_f32 v8, v8, v16
    v_fma_f32 v150, v150, v57, v59
    v_mfma_f32_16x16x32_bf16 v[108:111], v[28:31], v[212:215], v[108:111]
    s_waitcnt lgkmcnt(2)
    v_add_f32 v8, v8, v17
    s_mov_b32 m0, s26
    v_mfma_f32_16x16x32_bf16 v[64:67], v[32:35], a[208:211], v[64:67]
    s_sub_u32 s3, s29, 147456
    ds_read_b128 v[24:27], v2 offset:12288
    v_fma_f32 v147, v147, v56, v58
    v_mfma_f32_16x16x32_bf16 v[64:67], v[36:39], a[212:215], v[64:67]
    v_exp_f32 v19, v191
    v_mfma_f32_16x16x32_bf16 v[68:71], v[32:35], a[232:235], v[68:71]
    v_cvt_pk_bf16_f32 v188, v16, v17
    v_mfma_f32_16x16x32_bf16 v[68:71], v[36:39], a[236:239], v[68:71]
    buffer_load_dwordx4 v4, s[4:7], s32 offen offset:0 sc1 lds
    v_mfma_f32_16x16x32_bf16 v[72:75], v[32:35], v[192:195], v[72:75]
    ds_read_b128 v[28:31], v3 offset:12288
    v_fma_f32 v151, v151, v57, v59
    v_mfma_f32_16x16x32_bf16 v[72:75], v[36:39], v[196:199], v[72:75]
    v_exp_f32 v16, v116
    v_mfma_f32_16x16x32_bf16 v[76:79], v[32:35], v[216:219], v[76:79]
    s_min_u32 s29, s29, s3
    v_add_f32 v8, v8, v18
    v_add_f32 v8, v8, v19
    v_mfma_f32_16x16x32_bf16 v[76:79], v[36:39], v[220:223], v[76:79]
    s_waitcnt lgkmcnt(2)
    buffer_load_dwordx4 v4, s[4:7], s32 offen offset:1024 sc1 lds
    v_mfma_f32_16x16x32_bf16 v[96:99], v[40:43], a[208:211], v[96:99]
    ds_read_b128 v[32:35], v2 offset:18432
    v_mfma_f32_16x16x32_bf16 v[96:99], v[44:47], a[212:215], v[96:99]
    v_exp_f32 v17, v117
    v_mfma_f32_16x16x32_bf16 v[100:103], v[40:43], a[232:235], v[100:103]
    ds_read_b128 v[56:59], v23 offset:48
    v_cvt_pk_bf16_f32 v189, v18, v19
    v_mfma_f32_16x16x32_bf16 v[100:103], v[44:47], a[236:239], v[100:103]
    s_waitcnt vmcnt(24)
    v_exp_f32 v18, v118
    v_mfma_f32_16x16x32_bf16 v[104:107], v[40:43], v[192:195], v[104:107]
    s_sub_u32 s3, s29, s30
    ds_read_b128 v[36:39], v3 offset:18432
    v_add_f32 v8, v8, v16
    v_mfma_f32_16x16x32_bf16 v[104:107], v[44:47], v[196:199], v[104:107]
    buffer_load_dwordx4 v4, s[4:7], s32 offen offset:2048 sc1 lds
    v_mfma_f32_16x16x32_bf16 v[108:111], v[40:43], v[216:219], v[108:111]
    v_add_f32 v8, v8, v17
    v_cvt_f32_i32 v152, v152
    v_mfma_f32_16x16x32_bf16 v[108:111], v[44:47], v[220:223], v[108:111]
    s_waitcnt lgkmcnt(3)
    v_exp_f32 v19, v119
    v_mfma_f32_16x16x32_bf16 v[80:83], v[24:27], a[192:195], v[128:131]
    s_add_u32 s32, s32, 24576
    ds_read_b128 v[40:43], v2 offset:12416
    v_cvt_pk_bf16_f32 v190, v16, v17
    v_mfma_f32_16x16x32_bf16 v[80:83], v[28:31], a[196:199], v[80:83]
    v_add_f32 v8, v8, v18
    v_add_f32 v8, v8, v19
    v_mfma_f32_16x16x32_bf16 v[84:87], v[24:27], a[216:219], v[132:135]
    s_mov_b32 s30, s29
    v_cvt_pk_bf16_f32 v191, v18, v19
    v_cvt_f32_i32 v156, v156
    v_mfma_f32_16x16x32_bf16 v[84:87], v[28:31], a[220:223], v[84:87]
    s_sub_u32 s57, s32, 196608
    v_mfma_f32_16x16x32_bf16 v[88:91], v[24:27], a[240:243], v[136:139]
    ds_read_b128 v[44:47], v3 offset:12416
    v_mfma_f32_16x16x32_bf16 v[88:91], v[28:31], a[244:247], v[88:91]
    s_min_u32 s32, s32, s57
    v_exp_f32 v16, v64
    v_mfma_f32_16x16x32_bf16 v[92:95], v[24:27], v[200:203], v[140:143]
    v_exp_f32 v17, v65
    v_mfma_f32_16x16x32_bf16 v[92:95], v[28:31], v[204:207], v[92:95]
    s_waitcnt lgkmcnt(2)
    v_exp_f32 v18, v66
    v_mfma_f32_16x16x32_bf16 v[112:115], v[32:35], a[192:195], v[128:131]
    s_add_u32 s26, s26, 12288
    ds_read_b128 v[24:27], v2 offset:18560
    v_cvt_f32_i32 v153, v153
    v_mfma_f32_16x16x32_bf16 v[112:115], v[36:39], a[196:199], v[112:115]
    v_add_f32 v5, v5, v16
    v_add_f32 v5, v5, v17
    v_mfma_f32_16x16x32_bf16 v[116:119], v[32:35], a[216:219], v[132:135]
    s_mov_b32 m0, s26
    v_exp_f32 v19, v67
    v_mfma_f32_16x16x32_bf16 v[116:119], v[36:39], a[220:223], v[116:119]
    v_add_u32 v23, 1792, v23
    v_cvt_pk_bf16_f32 v64, v16, v17
    v_mfma_f32_16x16x32_bf16 v[120:123], v[32:35], a[240:243], v[136:139]
    ds_read_b128 v[28:31], v3 offset:18560
    v_add_u32 v1, s3, v1
    v_mfma_f32_16x16x32_bf16 v[120:123], v[36:39], a[244:247], v[120:123]
    v_exp_f32 v16, v96
    v_mfma_f32_16x16x32_bf16 v[124:127], v[32:35], v[200:203], v[140:143]
    v_add_f32 v5, v5, v18
    v_cvt_f32_i32 v157, v157
    v_mfma_f32_16x16x32_bf16 v[124:127], v[36:39], v[204:207], v[124:127]
    s_waitcnt lgkmcnt(2)
    buffer_load_dwordx4 v4, s[4:7], s32 offen offset:0 sc1 lds
    v_mfma_f32_16x16x32_bf16 v[80:83], v[40:43], a[200:203], v[80:83]
    ds_read_b128 v[32:35], v2 offset:12544
    v_add_f32 v5, v5, v19
    v_mfma_f32_16x16x32_bf16 v[80:83], v[44:47], a[204:207], v[80:83]
    v_exp_f32 v17, v97
    v_mfma_f32_16x16x32_bf16 v[84:87], v[40:43], a[224:227], v[84:87]
    v_cvt_pk_bf16_f32 v65, v18, v19
    v_fma_f32 v152, v152, v60, v62
    v_mfma_f32_16x16x32_bf16 v[84:87], v[44:47], a[228:231], v[84:87]
    buffer_load_dwordx4 v4, s[4:7], s32 offen offset:1024 sc1 lds
    v_mfma_f32_16x16x32_bf16 v[88:91], v[40:43], a[248:251], v[88:91]
    ds_read_b128 v[36:39], v3 offset:12544
    v_add_u32 v21, s3, v21
    v_mfma_f32_16x16x32_bf16 v[88:91], v[44:47], a[252:255], v[88:91]
    v_exp_f32 v18, v98
    v_mfma_f32_16x16x32_bf16 v[92:95], v[40:43], v[208:211], v[92:95]
    v_add_f32 v5, v5, v16
    v_add_f32 v5, v5, v17
    v_mfma_f32_16x16x32_bf16 v[92:95], v[44:47], v[212:215], v[92:95]
    s_waitcnt lgkmcnt(2)
    v_exp_f32 v19, v99
    v_mfma_f32_16x16x32_bf16 v[112:115], v[24:27], a[200:203], v[112:115]
    ds_read_b128 v[40:43], v2 offset:18688
    v_cvt_pk_bf16_f32 v66, v16, v17
    v_mfma_f32_16x16x32_bf16 v[112:115], v[28:31], a[204:207], v[112:115]
    buffer_load_dwordx4 v4, s[4:7], s32 offen offset:2048 sc1 lds
    v_mfma_f32_16x16x32_bf16 v[116:119], v[24:27], a[224:227], v[116:119]
    v_exp_f32 v16, v68
    v_mfma_f32_16x16x32_bf16 v[116:119], v[28:31], a[228:231], v[116:119]
    v_add_f32 v5, v5, v18
    v_add_u32 v22, s3, v22
    v_mfma_f32_16x16x32_bf16 v[120:123], v[24:27], a[248:251], v[120:123]
    ds_read_b128 v[44:47], v3 offset:18688
    v_add_f32 v5, v5, v19
    v_mfma_f32_16x16x32_bf16 v[120:123], v[28:31], a[252:255], v[120:123]
    s_waitcnt lgkmcnt(2)
    v_exp_f32 v17, v69
    v_mfma_f32_16x16x32_bf16 v[124:127], v[24:27], v[208:211], v[124:127]
    s_waitcnt vmcnt(40)
    v_cvt_pk_bf16_f32 v67, v18, v19
    v_fma_f32 v156, v156, v61, v63
    v_mfma_f32_16x16x32_bf16 v[124:127], v[28:31], v[212:215], v[124:127]
    s_barrier
    v_fma_f32 v153, v153, v60, v62
    v_mfma_f32_16x16x32_bf16 v[80:83], v[32:35], a[208:211], v[80:83]
    s_mov_b32 s32, 196608
    ds_read_b128 v[24:27], v1 offset:0
    v_fma_f32 v157, v157, v61, v63
    v_mfma_f32_16x16x32_bf16 v[80:83], v[36:39], a[212:215], v[80:83]
    s_add_u32 s26, s26, 36864
    v_exp_f32 v18, v70
    v_mfma_f32_16x16x32_bf16 v[84:87], v[32:35], a[232:235], v[84:87]
    s_sub_u32 s57, s26, 147456
    v_add_f32 v6, v6, v16
    v_add_f32 v6, v6, v17
    v_mfma_f32_16x16x32_bf16 v[84:87], v[36:39], a[236:239], v[84:87]
    v_exp_f32 v19, v71
    v_mfma_f32_16x16x32_bf16 v[88:91], v[32:35], v[192:195], v[88:91]
    s_min_u32 s26, s26, s57
    ds_read_b128 v[28:31], v1 offset:12288
    v_cvt_pk_bf16_f32 v68, v16, v17
    v_mfma_f32_16x16x32_bf16 v[88:91], v[36:39], v[196:199], v[88:91]
    v_exp_f32 v16, v100
    v_mfma_f32_16x16x32_bf16 v[92:95], v[32:35], v[216:219], v[92:95]
    v_add_f32 v6, v6, v18
    v_add_f32 v6, v6, v19
    v_mfma_f32_16x16x32_bf16 v[92:95], v[36:39], v[220:223], v[92:95]
    s_waitcnt lgkmcnt(2)
    v_exp_f32 v17, v101
    v_mfma_f32_16x16x32_bf16 v[112:115], v[40:43], a[208:211], v[112:115]
    ds_read_b128 v[32:35], v1 offset:768
    v_cvt_f32_i32 v154, v154
    v_mfma_f32_16x16x32_bf16 v[112:115], v[44:47], a[212:215], v[112:115]
    v_cvt_pk_bf16_f32 v69, v18, v19
    v_cvt_f32_i32 v158, v158
    v_mfma_f32_16x16x32_bf16 v[116:119], v[40:43], a[232:235], v[116:119]
    v_exp_f32 v18, v102
    v_mfma_f32_16x16x32_bf16 v[116:119], v[44:47], a[236:239], v[116:119]
    v_add_f32 v6, v6, v16
    v_add_f32 v6, v6, v17
    v_mfma_f32_16x16x32_bf16 v[120:123], v[40:43], v[192:195], v[120:123]
    ds_read_b128 v[36:39], v1 offset:13056
    v_cvt_f32_i32 v155, v155
    v_mfma_f32_16x16x32_bf16 v[120:123], v[44:47], v[196:199], v[120:123]
    v_exp_f32 v19, v103
    v_mfma_f32_16x16x32_bf16 v[124:127], v[40:43], v[216:219], v[124:127]
    v_cvt_pk_bf16_f32 v70, v16, v17
    v_add_f32 v6, v6, v18
    v_mfma_f32_16x16x32_bf16 v[124:127], v[44:47], v[220:223], v[124:127]
    s_waitcnt lgkmcnt(2)
    v_add_f32 v6, v6, v19
    v_cvt_f32_i32 v159, v159
    v_cvt_pk_bf16_f32 v71, v18, v19
    v_fma_f32 v154, v154, v60, v62
    v_mfma_f32_16x16x32_bf16 a[96:99], v[168:171], v[24:27], a[96:99]
    ds_read_b128 v[40:43], v1 offset:1536
    s_add_u32 s29, s28, 49152
    v_mfma_f32_16x16x32_bf16 a[96:99], v[184:187], v[28:31], a[96:99]
    s_mov_b32 m0, s56
    s_sub_u32 s3, s29, 147456
    s_min_u32 s29, s29, s3
    s_sub_u32 s3, s29, s28
    s_mov_b32 s28, s29
    v_add_u32 v2, s3, v2
    v_add_u32 v3, s3, v3
    v_mfma_f32_16x16x32_bf16 a[144:147], v[172:175], v[24:27], a[144:147]
    ds_read_b128 v[44:47], v1 offset:13824
    v_fma_f32 v158, v158, v61, v63
    v_mfma_f32_16x16x32_bf16 a[144:147], v[188:191], v[28:31], a[144:147]
    s_waitcnt lgkmcnt(2)
    v_exp_f32 v16, v72
    v_exp_f32 v17, v73
    v_exp_f32 v18, v74
    v_mfma_f32_16x16x32_bf16 a[100:103], v[168:171], v[32:35], a[100:103]
    ds_read_b128 v[24:27], v1 offset:2304
    v_add_f32 v7, v7, v16
    v_mfma_f32_16x16x32_bf16 a[100:103], v[184:187], v[36:39], a[100:103]
    buffer_load_dwordx4 v4, s[4:7], s27 offen offset:0 sc1 lds
    v_add_f32 v7, v7, v17
    v_exp_f32 v19, v75
    v_cvt_pk_bf16_f32 v72, v16, v17
    v_mfma_f32_16x16x32_bf16 a[148:151], v[172:175], v[32:35], a[148:151]
    ds_read_b128 v[28:31], v1 offset:14592
    v_fma_f32 v155, v155, v60, v62
    v_mfma_f32_16x16x32_bf16 a[148:151], v[188:191], v[36:39], a[148:151]
    s_waitcnt lgkmcnt(2)
    v_exp_f32 v16, v104
    v_add_f32 v7, v7, v18
    v_add_f32 v7, v7, v19
    v_exp_f32 v17, v105
    v_mfma_f32_16x16x32_bf16 a[104:107], v[168:171], v[40:43], a[104:107]
    ds_read_b128 v[32:35], v21 offset:0
    v_cvt_pk_bf16_f32 v73, v18, v19
    v_mfma_f32_16x16x32_bf16 a[104:107], v[184:187], v[44:47], a[104:107]
    buffer_load_dwordx4 v4, s[4:7], s27 offen offset:1024 sc1 lds
    v_exp_f32 v18, v106
    v_add_f32 v7, v7, v16
    v_add_f32 v7, v7, v17
    v_mfma_f32_16x16x32_bf16 a[152:155], v[172:175], v[40:43], a[152:155]
    ds_read_b128 v[36:39], v21 offset:12288
    v_fma_f32 v159, v159, v61, v63
    v_mfma_f32_16x16x32_bf16 a[152:155], v[188:191], v[44:47], a[152:155]
    s_waitcnt lgkmcnt(2)
    v_exp_f32 v19, v107
    v_cvt_pk_bf16_f32 v74, v16, v17
    v_exp_f32 v16, v76
    v_add_f32 v7, v7, v18
    v_mfma_f32_16x16x32_bf16 a[108:111], v[168:171], v[24:27], a[108:111]
    ds_read_b128 v[40:43], v21 offset:768
    v_add_f32 v7, v7, v19
    v_mfma_f32_16x16x32_bf16 a[108:111], v[184:187], v[28:31], a[108:111]
    buffer_load_dwordx4 v4, s[4:7], s27 offen offset:2048 sc1 lds
    v_exp_f32 v17, v77
    v_cvt_pk_bf16_f32 v75, v18, v19
    v_cvt_pk_bf16_f32 v144, v144, v148
    v_mfma_f32_16x16x32_bf16 a[156:159], v[172:175], v[24:27], a[156:159]
    ds_read_b128 v[44:47], v21 offset:13056
    v_cvt_pk_bf16_f32 v148, v145, v149
    v_mfma_f32_16x16x32_bf16 a[156:159], v[188:191], v[28:31], a[156:159]
    s_waitcnt lgkmcnt(2)
    v_exp_f32 v18, v78
    v_add_f32 v8, v8, v16
    v_add_f32 v8, v8, v17
    v_exp_f32 v19, v79
    v_mfma_f32_16x16x32_bf16 a[112:115], v[168:171], v[32:35], a[112:115]
    ds_read_b128 v[24:27], v21 offset:1536
    v_cvt_pk_bf16_f32 v76, v16, v17
    v_mfma_f32_16x16x32_bf16 a[112:115], v[184:187], v[36:39], a[112:115]
    s_add_u32 s27, s27, 24576
    s_sub_u32 s58, s27, 196608
    s_min_u32 s27, s27, s58
    s_add_u32 s56, s56, 12288
    v_exp_f32 v16, v108
    v_add_f32 v8, v8, v18
    v_mfma_f32_16x16x32_bf16 a[160:163], v[172:175], v[32:35], a[160:163]
    ds_read_b128 v[28:31], v21 offset:13824
    v_add_f32 v8, v8, v19
    v_mfma_f32_16x16x32_bf16 a[160:163], v[188:191], v[36:39], a[160:163]
    s_waitcnt lgkmcnt(2)
    v_exp_f32 v17, v109
    v_cvt_pk_bf16_f32 v77, v18, v19
    v_exp_f32 v18, v110
    v_add_f32 v8, v8, v16
    v_mfma_f32_16x16x32_bf16 a[116:119], v[168:171], v[40:43], a[116:119]
    ds_read_b128 v[32:35], v21 offset:2304
    v_add_f32 v8, v8, v17
    v_mfma_f32_16x16x32_bf16 a[116:119], v[184:187], v[44:47], a[116:119]
    s_mov_b32 m0, s56
    v_exp_f32 v19, v111
    v_cvt_pk_bf16_f32 v78, v16, v17
    v_add_f32 v8, v8, v18
    v_add_f32 v8, v8, v19
    v_cvt_pk_bf16_f32 v79, v18, v19
    v_mfma_f32_16x16x32_bf16 a[164:167], v[172:175], v[40:43], a[164:167]
    ds_read_b128 v[36:39], v21 offset:14592
    v_cvt_pk_bf16_f32 v145, v152, v156
    v_mfma_f32_16x16x32_bf16 a[164:167], v[188:191], v[44:47], a[164:167]
    s_waitcnt lgkmcnt(2)
    v_exp_f32 v16, v80
    v_exp_f32 v17, v81
    v_exp_f32 v18, v82
    v_mfma_f32_16x16x32_bf16 a[120:123], v[168:171], v[24:27], a[120:123]
    ds_read_b128 v[40:43], v22 offset:0
    v_add_f32 v5, v5, v16
    v_mfma_f32_16x16x32_bf16 a[120:123], v[184:187], v[28:31], a[120:123]
    buffer_load_dwordx4 v4, s[4:7], s27 offen offset:0 sc1 lds
    v_add_f32 v5, v5, v17
    v_exp_f32 v19, v83
    v_cvt_pk_bf16_f32 v80, v16, v17
    v_mfma_f32_16x16x32_bf16 a[168:171], v[172:175], v[24:27], a[168:171]
    ds_read_b128 v[44:47], v22 offset:12288
    v_cvt_pk_bf16_f32 v149, v153, v157
    v_mfma_f32_16x16x32_bf16 a[168:171], v[188:191], v[28:31], a[168:171]
    s_waitcnt lgkmcnt(2)
    v_exp_f32 v16, v112
    v_add_f32 v5, v5, v18
    v_add_f32 v5, v5, v19
    v_exp_f32 v17, v113
    v_mfma_f32_16x16x32_bf16 a[124:127], v[168:171], v[32:35], a[124:127]
    ds_read_b128 v[24:27], v22 offset:768
    v_cvt_pk_bf16_f32 v81, v18, v19
    v_mfma_f32_16x16x32_bf16 a[124:127], v[184:187], v[36:39], a[124:127]
    buffer_load_dwordx4 v4, s[4:7], s27 offen offset:1024 sc1 lds
    v_exp_f32 v18, v114
    v_add_f32 v5, v5, v16
    v_add_f32 v5, v5, v17
    v_mfma_f32_16x16x32_bf16 a[172:175], v[172:175], v[32:35], a[172:175]
    ds_read_b128 v[28:31], v22 offset:13056
    v_cvt_pk_bf16_f32 v152, v146, v150
    v_mfma_f32_16x16x32_bf16 a[172:175], v[188:191], v[36:39], a[172:175]
    s_waitcnt lgkmcnt(2)
    v_exp_f32 v19, v115
    v_cvt_pk_bf16_f32 v82, v16, v17
    v_exp_f32 v16, v84
    v_add_f32 v5, v5, v18
    v_mfma_f32_16x16x32_bf16 a[128:131], v[168:171], v[40:43], a[128:131]
    ds_read_b128 v[32:35], v22 offset:1536
    v_add_f32 v5, v5, v19
    v_mfma_f32_16x16x32_bf16 a[128:131], v[184:187], v[44:47], a[128:131]
    buffer_load_dwordx4 v4, s[4:7], s27 offen offset:2048 sc1 lds
    v_exp_f32 v17, v85
    v_cvt_pk_bf16_f32 v83, v18, v19
    v_cvt_pk_bf16_f32 v153, v154, v158
    v_mfma_f32_16x16x32_bf16 a[176:179], v[172:175], v[40:43], a[176:179]
    ds_read_b128 v[36:39], v22 offset:13824
    v_cvt_pk_bf16_f32 v156, v147, v151
    v_mfma_f32_16x16x32_bf16 a[176:179], v[188:191], v[44:47], a[176:179]
    s_waitcnt lgkmcnt(2)
    v_exp_f32 v18, v86
    v_add_f32 v6, v6, v16
    v_add_f32 v6, v6, v17
    v_exp_f32 v19, v87
    v_mfma_f32_16x16x32_bf16 a[132:135], v[168:171], v[24:27], a[132:135]
    ds_read_b128 v[40:43], v22 offset:2304
    v_cvt_pk_bf16_f32 v84, v16, v17
    v_mfma_f32_16x16x32_bf16 a[132:135], v[184:187], v[28:31], a[132:135]
    s_waitcnt vmcnt(6)
    s_barrier
    v_exp_f32 v16, v116
    v_add_f32 v6, v6, v18
    v_add_f32 v6, v6, v19
    v_mfma_f32_16x16x32_bf16 a[180:183], v[172:175], v[24:27], a[180:183]
    ds_read_b128 v[44:47], v22 offset:14592
    v_cvt_pk_bf16_f32 v157, v155, v159
    v_mfma_f32_16x16x32_bf16 a[180:183], v[188:191], v[28:31], a[180:183]
    s_waitcnt lgkmcnt(2)
    v_exp_f32 v17, v117
    v_cvt_pk_bf16_f32 v85, v18, v19
    v_exp_f32 v18, v118
    v_add_f32 v6, v6, v16
    v_mfma_f32_16x16x32_bf16 a[136:139], v[168:171], v[32:35], a[136:139]
    ds_read_b128 v[24:27], v2 offset:0
    v_add_f32 v6, v6, v17
    v_mfma_f32_16x16x32_bf16 a[136:139], v[184:187], v[36:39], a[136:139]
    s_mov_b32 s27, 208896
    s_add_u32 s56, s56, 36864
    s_sub_u32 s58, s56, 147456
    s_min_u32 s56, s56, s58
    v_exp_f32 v19, v119
    v_cvt_pk_bf16_f32 v86, v16, v17
    v_mfma_f32_16x16x32_bf16 a[184:187], v[172:175], v[32:35], a[184:187]
    ds_read_b128 v[28:31], v3 offset:0
    v_add_f32 v6, v6, v18
    v_mfma_f32_16x16x32_bf16 a[184:187], v[188:191], v[36:39], a[184:187]
    s_waitcnt lgkmcnt(2)
    v_add_f32 v6, v6, v19
    v_cvt_pk_bf16_f32 v87, v18, v19
    s_waitcnt vmcnt(21)
    v_cvt_f32_i32 v240, v240
    v_cvt_f32_i32 v244, v244
    v_cvt_f32_i32 v241, v241
    v_mfma_f32_16x16x32_bf16 a[140:143], v[168:171], v[40:43], a[140:143]
    ds_read_b128 v[32:35], v2 offset:6144
    v_mfma_f32_16x16x32_bf16 a[140:143], v[184:187], v[44:47], a[140:143]
    v_mfma_f32_16x16x32_bf16 a[188:191], v[172:175], v[40:43], a[188:191]
    ds_read_b128 v[36:39], v3 offset:6144
    v_mfma_f32_16x16x32_bf16 a[188:191], v[188:191], v[44:47], a[188:191]
    s_waitcnt lgkmcnt(2)
    v_mfma_f32_16x16x32_bf16 v[160:163], v[24:27], a[192:195], v[128:131]
    ds_read_b128 v[40:43], v2 offset:128
    v_bfe_u32 v53, v4, 4, 6
    v_mfma_f32_16x16x32_bf16 v[160:163], v[28:31], a[196:199], v[160:163]
    v_exp_f32 v16, v88
    v_mfma_f32_16x16x32_bf16 v[164:167], v[24:27], a[216:219], v[132:135]
    v_lshlrev_b32 v53, 2, v53
    v_cvt_f32_i32 v245, v245
    v_mfma_f32_16x16x32_bf16 v[164:167], v[28:31], a[220:223], v[164:167]
    buffer_load_dword v52, v53, s[20:23], 0 offen sc1
    v_mfma_f32_16x16x32_bf16 v[168:171], v[24:27], a[240:243], v[136:139]
    ds_read_b128 v[44:47], v3 offset:128
    v_fma_f32 v240, v240, v48, v50
    v_mfma_f32_16x16x32_bf16 v[168:171], v[28:31], a[244:247], v[168:171]
    v_exp_f32 v17, v89
    v_mfma_f32_16x16x32_bf16 v[172:175], v[24:27], v[200:203], v[140:143]
    v_exp_f32 v18, v90
    v_mfma_f32_16x16x32_bf16 v[172:175], v[28:31], v[204:207], v[172:175]
    s_waitcnt lgkmcnt(2)
    v_add_f32 v7, v7, v16
    v_add_f32 v7, v7, v17
    v_mfma_f32_16x16x32_bf16 v[96:99], v[32:35], a[192:195], v[128:131]
    ds_read_b128 v[24:27], v2 offset:6272
    v_fma_f32 v244, v244, v49, v51
    v_mfma_f32_16x16x32_bf16 v[96:99], v[36:39], a[196:199], v[96:99]
    s_add_u32 s33, s33, 196608
    v_exp_f32 v19, v91
    v_mfma_f32_16x16x32_bf16 v[100:103], v[32:35], a[216:219], v[132:135]
    s_sub_u32 s34, s33, 1572864
    v_cvt_pk_bf16_f32 v88, v16, v17
    v_fma_f32 v241, v241, v48, v50
    v_mfma_f32_16x16x32_bf16 v[100:103], v[36:39], a[220:223], v[100:103]
    s_min_u32 s33, s33, s34
    v_exp_f32 v16, v120
    v_mfma_f32_16x16x32_bf16 v[104:107], v[32:35], a[240:243], v[136:139]
    ds_read_b128 v[28:31], v3 offset:6272
    v_add_f32 v7, v7, v18
    v_mfma_f32_16x16x32_bf16 v[104:107], v[36:39], a[244:247], v[104:107]
    s_add_u32 s34, s33, 3072
    v_add_f32 v7, v7, v19
    v_fma_f32 v245, v245, v49, v51
    v_mfma_f32_16x16x32_bf16 v[108:111], v[32:35], v[200:203], v[140:143]
    v_exp_f32 v17, v121
    v_mfma_f32_16x16x32_bf16 v[108:111], v[36:39], v[204:207], v[108:111]
    s_waitcnt lgkmcnt(2)
    v_cvt_f32_i32 v242, v242
    v_cvt_pk_bf16_f32 v89, v18, v19
    v_mfma_f32_16x16x32_bf16 v[160:163], v[40:43], a[200:203], v[160:163]
    s_add_u32 s37, s37, 196608
    ds_read_b128 v[32:35], v2 offset:256
    v_cvt_f32_i32 v246, v246
    v_mfma_f32_16x16x32_bf16 v[160:163], v[44:47], a[204:207], v[160:163]
    v_exp_f32 v18, v122
    v_mfma_f32_16x16x32_bf16 v[164:167], v[40:43], a[224:227], v[164:167]
    s_add_u32 s80, s80, 196608
    v_add_f32 v7, v7, v16
    v_cvt_f32_i32 v243, v243
    v_mfma_f32_16x16x32_bf16 v[164:167], v[44:47], a[228:231], v[164:167]
    v_add_f32 v7, v7, v17
    v_cvt_f32_i32 v247, v247
    v_mfma_f32_16x16x32_bf16 v[168:171], v[40:43], a[248:251], v[168:171]
    ds_read_b128 v[36:39], v3 offset:256
    v_fma_f32 v242, v242, v48, v50
    v_mfma_f32_16x16x32_bf16 v[168:171], v[44:47], a[252:255], v[168:171]
    v_exp_f32 v19, v123
    v_mfma_f32_16x16x32_bf16 v[172:175], v[40:43], v[208:211], v[172:175]
    v_cvt_pk_bf16_f32 v90, v16, v17
    v_mfma_f32_16x16x32_bf16 v[172:175], v[44:47], v[212:215], v[172:175]
    s_waitcnt lgkmcnt(2)
    buffer_load_dwordx4 v[224:227], v9, s[64:67], s33 offen offset:0 nt
    v_mfma_f32_16x16x32_bf16 v[96:99], v[24:27], a[200:203], v[96:99]
    ds_read_b128 v[40:43], v2 offset:6400
    v_fma_f32 v246, v246, v49, v51
    v_mfma_f32_16x16x32_bf16 v[96:99], v[28:31], a[204:207], v[96:99]
    v_exp_f32 v16, v92
    v_mfma_f32_16x16x32_bf16 v[100:103], v[24:27], a[224:227], v[100:103]
    v_add_f32 v7, v7, v18
    v_add_f32 v7, v7, v19
    v_mfma_f32_16x16x32_bf16 v[100:103], v[28:31], a[228:231], v[100:103]
    buffer_load_dwordx4 v[228:231], v9, s[64:67], s33 offen offset:1536 nt
    v_mfma_f32_16x16x32_bf16 v[104:107], v[24:27], a[248:251], v[104:107]
    ds_read_b128 v[44:47], v3 offset:6400
    v_fma_f32 v243, v243, v48, v50
    v_mfma_f32_16x16x32_bf16 v[104:107], v[28:31], a[252:255], v[104:107]
    v_exp_f32 v17, v93
    v_mfma_f32_16x16x32_bf16 v[108:111], v[24:27], v[208:211], v[108:111]
    s_add_u32 s29, s30, 49152
    v_cvt_pk_bf16_f32 v91, v18, v19
    v_fma_f32 v247, v247, v49, v51
    v_mfma_f32_16x16x32_bf16 v[108:111], v[28:31], v[212:215], v[108:111]
    s_waitcnt lgkmcnt(2)
    buffer_load_dwordx4 v[232:235], v9, s[64:67], s34 offen offset:0 nt
    v_mfma_f32_16x16x32_bf16 v[160:163], v[32:35], a[208:211], v[160:163]
    s_sub_u32 s3, s29, 147456
    ds_read_b128 v[24:27], v2 offset:12288
    v_mfma_f32_16x16x32_bf16 v[160:163], v[36:39], a[212:215], v[160:163]
    v_exp_f32 v18, v94
    v_mfma_f32_16x16x32_bf16 v[164:167], v[32:35], a[232:235], v[164:167]
    v_add_f32 v8, v8, v16
    v_add_f32 v8, v8, v17
    v_mfma_f32_16x16x32_bf16 v[164:167], v[36:39], a[236:239], v[164:167]
    v_exp_f32 v19, v95
    v_mfma_f32_16x16x32_bf16 v[168:171], v[32:35], v[192:195], v[168:171]
    ds_read_b128 v[28:31], v3 offset:12288
    v_cvt_pk_bf16_f32 v92, v16, v17
    v_mfma_f32_16x16x32_bf16 v[168:171], v[36:39], v[196:199], v[168:171]
    buffer_load_dwordx4 v[236:239], v9, s[64:67], s34 offen offset:1536 nt
    v_mfma_f32_16x16x32_bf16 v[172:175], v[32:35], v[216:219], v[172:175]
    s_min_u32 s29, s29, s3
    v_exp_f32 v16, v124
    v_mfma_f32_16x16x32_bf16 v[172:175], v[36:39], v[220:223], v[172:175]
    s_waitcnt lgkmcnt(2)
    v_add_f32 v8, v8, v18
    v_add_f32 v8, v8, v19
    v_mfma_f32_16x16x32_bf16 v[96:99], v[40:43], a[208:211], v[96:99]
    ds_read_b128 v[32:35], v2 offset:18432
    v_mfma_f32_16x16x32_bf16 v[96:99], v[44:47], a[212:215], v[96:99]
    v_exp_f32 v17, v125
    v_mfma_f32_16x16x32_bf16 v[100:103], v[40:43], a[232:235], v[100:103]
    ds_read_b128 v[48:51], v10 offset:0
    v_cvt_pk_bf16_f32 v93, v18, v19
    v_mfma_f32_16x16x32_bf16 v[100:103], v[44:47], a[236:239], v[100:103]
    v_exp_f32 v18, v126
    v_mfma_f32_16x16x32_bf16 v[104:107], v[40:43], v[192:195], v[104:107]
    s_sub_u32 s3, s29, s30
    ds_read_b128 v[36:39], v3 offset:18432
    v_cvt_pk_bf16_f32 v146, v240, v244
    v_mfma_f32_16x16x32_bf16 v[104:107], v[44:47], v[196:199], v[104:107]
    v_add_f32 v8, v8, v16
    v_add_f32 v8, v8, v17
    v_mfma_f32_16x16x32_bf16 v[108:111], v[40:43], v[216:219], v[108:111]
    v_exp_f32 v19, v127
    v_mfma_f32_16x16x32_bf16 v[108:111], v[44:47], v[220:223], v[108:111]
    s_waitcnt lgkmcnt(3)
    v_cvt_pk_bf16_f32 v150, v241, v245
    v_cvt_pk_bf16_f32 v154, v242, v246
    v_mfma_f32_16x16x32_bf16 v[176:179], v[24:27], a[192:195], v[128:131]
    ds_read_b128 v[40:43], v2 offset:12416
    v_cvt_pk_bf16_f32 v94, v16, v17
    v_mfma_f32_16x16x32_bf16 v[176:179], v[28:31], a[196:199], v[176:179]
    v_add_f32 v8, v8, v18
    v_add_f32 v8, v8, v19
    v_mfma_f32_16x16x32_bf16 v[180:183], v[24:27], a[216:219], v[132:135]
    s_mov_b32 s30, s29
    v_cvt_pk_bf16_f32 v95, v18, v19
    v_cvt_pk_bf16_f32 v158, v243, v247
    v_mfma_f32_16x16x32_bf16 v[180:183], v[28:31], a[220:223], v[180:183]
    s_waitcnt vmcnt(24)
    v_cvt_f32_i32 v248, v248
    v_cvt_f32_i32 v252, v252
    v_mfma_f32_16x16x32_bf16 v[184:187], v[24:27], a[240:243], v[136:139]
    ds_read_b128 v[44:47], v3 offset:12416
    v_cvt_f32_i32 v249, v249
    v_mfma_f32_16x16x32_bf16 v[184:187], v[28:31], a[244:247], v[184:187]
    s_waitcnt vmcnt(4)
    v_subrev_u32 v52, s92, v52
    v_cmp_lt_u32 vcc, 15, v52
    v_mfma_f32_16x16x32_bf16 v[188:191], v[24:27], v[200:203], v[140:143]
    v_exp_f32 v16, v160
    v_mfma_f32_16x16x32_bf16 v[188:191], v[28:31], v[204:207], v[188:191]
    s_waitcnt lgkmcnt(2)
    v_exp_f32 v17, v161
    v_mfma_f32_16x16x32_bf16 v[112:115], v[32:35], a[192:195], v[128:131]
    s_and_b32 s59, vcc_lo, 0xff
    ds_read_b128 v[24:27], v2 offset:18560
    v_cvt_f32_i32 v253, v253
    v_mfma_f32_16x16x32_bf16 v[112:115], v[36:39], a[196:199], v[112:115]
    s_cbranch_scc1 L_pollslow0
L_pollok0:
    v_mfma_f32_16x16x32_bf16 v[116:119], v[32:35], a[216:219], v[132:135]
    s_add_u32 s92, s92, 1
    v_exp_f32 v18, v162
    v_mfma_f32_16x16x32_bf16 v[116:119], v[36:39], a[220:223], v[116:119]
    s_mov_b32 m0, s26
    v_add_f32 v5, v5, v16
    v_add_f32 v5, v5, v17
    v_mfma_f32_16x16x32_bf16 v[120:123], v[32:35], a[240:243], v[136:139]
    ds_read_b128 v[28:31], v3 offset:18560
    v_fma_f32 v248, v248, v56, v58
    v_mfma_f32_16x16x32_bf16 v[120:123], v[36:39], a[244:247], v[120:123]
    buffer_load_dwordx4 v4, s[4:7], s32 offen offset:0 sc1 lds
    v_mfma_f32_16x16x32_bf16 v[124:127], v[32:35], v[200:203], v[140:143]
    v_exp_f32 v19, v163
    v_mfma_f32_16x16x32_bf16 v[124:127], v[36:39], v[204:207], v[124:127]
    s_waitcnt lgkmcnt(2)
    v_cvt_pk_bf16_f32 v160, v16, v17
    v_fma_f32 v252, v252, v57, v59
    v_mfma_f32_16x16x32_bf16 v[176:179], v[40:43], a[200:203], v[176:179]
    ds_read_b128 v[32:35], v2 offset:12544
    v_add_u32 v1, s3, v1
    v_mfma_f32_16x16x32_bf16 v[176:179], v[44:47], a[204:207], v[176:179]
    buffer_load_dwordx4 v4, s[4:7], s32 offen offset:1024 sc1 lds
    v_mfma_f32_16x16x32_bf16 v[180:183], v[40:43], a[224:227], v[180:183]
    v_exp_f32 v16, v96
    v_mfma_f32_16x16x32_bf16 v[180:183], v[44:47], a[228:231], v[180:183]
    v_add_f32 v5, v5, v18
    v_add_f32 v5, v5, v19
    v_mfma_f32_16x16x32_bf16 v[184:187], v[40:43], a[248:251], v[184:187]
    ds_read_b128 v[36:39], v3 offset:12544
    v_fma_f32 v249, v249, v56, v58
    v_mfma_f32_16x16x32_bf16 v[184:187], v[44:47], a[252:255], v[184:187]
    buffer_load_dwordx4 v4, s[4:7], s32 offen offset:2048 sc1 lds
    v_mfma_f32_16x16x32_bf16 v[188:191], v[40:43], v[208:211], v[188:191]
    v_exp_f32 v17, v97
    v_mfma_f32_16x16x32_bf16 v[188:191], v[44:47], v[212:215], v[188:191]
    s_waitcnt lgkmcnt(2)
    v_cvt_pk_bf16_f32 v161, v18, v19
    v_exp_f32 v18, v98
    v_mfma_f32_16x16x32_bf16 v[112:115], v[24:27], a[200:203], v[112:115]
    s_add_u32 s32, s32, 24576
    ds_read_b128 v[40:43], v2 offset:18688
    v_add_f32 v5, v5, v16
    v_mfma_f32_16x16x32_bf16 v[112:115], v[28:31], a[204:207], v[112:115]
    v_add_f32 v5, v5, v17
    v_fma_f32 v253, v253, v57, v59
    v_mfma_f32_16x16x32_bf16 v[116:119], v[24:27], a[224:227], v[116:119]
    s_add_u32 s26, s26, 12288
    v_exp_f32 v19, v99
    v_mfma_f32_16x16x32_bf16 v[116:119], v[28:31], a[228:231], v[116:119]
    v_cvt_pk_bf16_f32 v162, v16, v17
    v_add_u32 v21, s3, v21
    v_mfma_f32_16x16x32_bf16 v[120:123], v[24:27], a[248:251], v[120:123]
    ds_read_b128 v[44:47], v3 offset:18688
    v_add_u32 v22, s3, v22
    v_mfma_f32_16x16x32_bf16 v[120:123], v[28:31], a[252:255], v[120:123]
    s_waitcnt lgkmcnt(2)
    v_exp_f32 v16, v164
    v_add_f32 v5, v5, v18
    v_mfma_f32_16x16x32_bf16 v[124:127], v[24:27], v[208:211], v[124:127]
    s_waitcnt vmcnt(20)
    v_add_f32 v5, v5, v19
    v_cvt_f32_i32 v250, v250
    v_mfma_f32_16x16x32_bf16 v[124:127], v[28:31], v[212:215], v[124:127]
    s_barrier
    v_exp_f32 v17, v165
    v_mfma_f32_16x16x32_bf16 v[176:179], v[32:35], a[208:211], v[176:179]
    s_mov_b32 m0, s26
    ds_read_b128 v[24:27], v1 offset:0
    v_cvt_pk_bf16_f32 v163, v18, v19
    v_mfma_f32_16x16x32_bf16 v[176:179], v[36:39], a[212:215], v[176:179]
    buffer_load_dwordx4 v4, s[4:7], s32 offen offset:0 sc1 lds
    v_mfma_f32_16x16x32_bf16 v[180:183], v[32:35], a[232:235], v[180:183]
    v_exp_f32 v18, v166
    v_mfma_f32_16x16x32_bf16 v[180:183], v[36:39], a[236:239], v[180:183]
    v_add_f32 v6, v6, v16
    v_cvt_f32_i32 v254, v254
    v_mfma_f32_16x16x32_bf16 v[184:187], v[32:35], v[192:195], v[184:187]
    ds_read_b128 v[28:31], v1 offset:12288
    v_add_f32 v6, v6, v17
    v_mfma_f32_16x16x32_bf16 v[184:187], v[36:39], v[196:199], v[184:187]
    buffer_load_dwordx4 v4, s[4:7], s32 offen offset:1024 sc1 lds
    v_mfma_f32_16x16x32_bf16 v[188:191], v[32:35], v[216:219], v[188:191]
    v_exp_f32 v19, v167
    v_mfma_f32_16x16x32_bf16 v[188:191], v[36:39], v[220:223], v[188:191]
    s_waitcnt lgkmcnt(2)
    v_cvt_pk_bf16_f32 v164, v16, v17
    v_exp_f32 v16, v100
    v_mfma_f32_16x16x32_bf16 v[112:115], v[40:43], a[208:211], v[112:115]
    ds_read_b128 v[32:35], v1 offset:768
    v_cvt_f32_i32 v251, v251
    v_mfma_f32_16x16x32_bf16 v[112:115], v[44:47], a[212:215], v[112:115]
    buffer_load_dwordx4 v4, s[4:7], s32 offen offset:2048 sc1 lds
    v_add_f32 v6, v6, v18
    v_mfma_f32_16x16x32_bf16 v[116:119], v[40:43], a[232:235], v[116:119]
    v_add_f32 v6, v6, v19
    v_cvt_f32_i32 v255, v255
    v_mfma_f32_16x16x32_bf16 v[116:119], v[44:47], a[236:239], v[116:119]
    v_exp_f32 v17, v101
    v_fma_f32 v250, v250, v56, v58
    v_mfma_f32_16x16x32_bf16 v[120:123], v[40:43], v[192:195], v[120:123]
    ds_read_b128 v[36:39], v1 offset:13056
    v_cvt_pk_bf16_f32 v165, v18, v19
    v_mfma_f32_16x16x32_bf16 v[120:123], v[44:47], v[196:199], v[120:123]
    v_exp_f32 v18, v102
    v_fma_f32 v254, v254, v57, v59
    v_mfma_f32_16x16x32_bf16 v[124:127], v[40:43], v[216:219], v[124:127]
    s_add_u32 s32, s32, 24576
    v_add_f32 v6, v6, v16
    v_add_f32 v6, v6, v17
    v_mfma_f32_16x16x32_bf16 v[124:127], v[44:47], v[220:223], v[124:127]
    s_waitcnt lgkmcnt(2)
    v_exp_f32 v19, v103
    v_fma_f32 v251, v251, v56, v58
    v_fma_f32 v255, v255, v57, v59
    v_cvt_pk_bf16_f32 v166, v16, v17
    v_cvt_pk_bf16_f32 v147, v248, v252
    v_add_f32 v6, v6, v18
    s_add_u32 s26, s26, 36864
    v_cvt_pk_bf16_f32 v151, v249, v253
    v_add_f32 v6, v6, v19
    s_sub_u32 s57, s26, 147456
    v_cvt_pk_bf16_f32 v155, v250, v254
    v_cvt_pk_bf16_f32 v167, v18, v19
    s_min_u32 s26, s26, s57
    v_cvt_pk_bf16_f32 v159, v251, v255
    v_mfma_f32_16x16x32_bf16 a[0:3], v[64:67], v[24:27], a[0:3]
    ds_read_b128 v[40:43], v1 offset:1536
    v_mfma_f32_16x16x32_bf16 a[0:3], v[80:83], v[28:31], a[0:3]
    buffer_store_dwordx4 v[144:147], v20, s[4:7], s81 offen offset:0 sc1
    v_mfma_f32_16x16x32_bf16 a[48:51], v[68:71], v[24:27], a[48:51]
    v_exp_f32 v16, v168
    v_mfma_f32_16x16x32_bf16 a[48:51], v[84:87], v[28:31], a[48:51]
    v_exp_f32 v17, v169
    v_mfma_f32_16x16x32_bf16 a[96:99], v[72:75], v[24:27], a[96:99]
    ds_read_b128 v[44:47], v1 offset:13824
    v_mfma_f32_16x16x32_bf16 a[96:99], v[88:91], v[28:31], a[96:99]
    v_exp_f32 v18, v170
    v_mfma_f32_16x16x32_bf16 a[144:147], v[76:79], v[24:27], a[144:147]
    v_add_f32 v7, v7, v16
    v_add_f32 v7, v7, v17
    v_mfma_f32_16x16x32_bf16 a[144:147], v[92:95], v[28:31], a[144:147]
    s_waitcnt lgkmcnt(2)
    v_exp_f32 v19, v171
    v_mfma_f32_16x16x32_bf16 a[4:7], v[64:67], v[32:35], a[4:7]
    ds_read_b128 v[24:27], v1 offset:2304
    v_cvt_pk_bf16_f32 v168, v16, v17
    v_mfma_f32_16x16x32_bf16 a[4:7], v[80:83], v[36:39], a[4:7]
    buffer_store_dwordx4 v[148:151], v20, s[4:7], s81 offen offset:768 sc1
    v_mfma_f32_16x16x32_bf16 a[52:55], v[68:71], v[32:35], a[52:55]
    v_exp_f32 v16, v104
    v_mfma_f32_16x16x32_bf16 a[52:55], v[84:87], v[36:39], a[52:55]
    v_add_f32 v7, v7, v18
    v_add_f32 v7, v7, v19
    v_mfma_f32_16x16x32_bf16 a[100:103], v[72:75], v[32:35], a[100:103]
    ds_read_b128 v[28:31], v1 offset:14592
    v_mfma_f32_16x16x32_bf16 a[100:103], v[88:91], v[36:39], a[100:103]
    v_exp_f32 v17, v105
    v_mfma_f32_16x16x32_bf16 a[148:151], v[76:79], v[32:35], a[148:151]
    v_cvt_pk_bf16_f32 v169, v18, v19
    v_mfma_f32_16x16x32_bf16 a[148:151], v[92:95], v[36:39], a[148:151]
    s_waitcnt lgkmcnt(2)
    v_exp_f32 v18, v106
    v_mfma_f32_16x16x32_bf16 a[8:11], v[64:67], v[40:43], a[8:11]
    ds_read_b128 v[32:35], v21 offset:0
    v_add_f32 v7, v7, v16
    v_mfma_f32_16x16x32_bf16 a[8:11], v[80:83], v[44:47], a[8:11]
    buffer_store_dwordx4 v[152:155], v20, s[4:7], s81 offen offset:1536 sc1
    v_mfma_f32_16x16x32_bf16 a[56:59], v[68:71], v[40:43], a[56:59]
    v_add_f32 v7, v7, v17
    v_mfma_f32_16x16x32_bf16 a[56:59], v[84:87], v[44:47], a[56:59]
    v_exp_f32 v19, v107
    v_mfma_f32_16x16x32_bf16 a[104:107], v[72:75], v[40:43], a[104:107]
    ds_read_b128 v[36:39], v21 offset:12288
    v_cvt_pk_bf16_f32 v170, v16, v17
    v_mfma_f32_16x16x32_bf16 a[104:107], v[88:91], v[44:47], a[104:107]
    v_exp_f32 v16, v172
    v_mfma_f32_16x16x32_bf16 a[152:155], v[76:79], v[40:43], a[152:155]
    v_add_f32 v7, v7, v18
    v_mfma_f32_16x16x32_bf16 a[152:155], v[92:95], v[44:47], a[152:155]
    s_waitcnt lgkmcnt(2)
    v_add_f32 v7, v7, v19
    v_mfma_f32_16x16x32_bf16 a[12:15], v[64:67], v[24:27], a[12:15]
    ds_read_b128 v[40:43], v21 offset:768
    v_mfma_f32_16x16x32_bf16 a[12:15], v[80:83], v[28:31], a[12:15]
    buffer_store_dwordx4 v[156:159], v20, s[4:7], s81 offen offset:2304 sc1
    v_mfma_f32_16x16x32_bf16 a[60:63], v[68:71], v[24:27], a[60:63]
    v_exp_f32 v17, v173
    v_mfma_f32_16x16x32_bf16 a[60:63], v[84:87], v[28:31], a[60:63]
    v_cvt_pk_bf16_f32 v171, v18, v19
    v_mfma_f32_16x16x32_bf16 a[108:111], v[72:75], v[24:27], a[108:111]
    ds_read_b128 v[44:47], v21 offset:13056
    v_mfma_f32_16x16x32_bf16 a[108:111], v[88:91], v[28:31], a[108:111]
    v_exp_f32 v18, v174
    v_mfma_f32_16x16x32_bf16 a[156:159], v[76:79], v[24:27], a[156:159]
    s_add_u32 s29, s28, 49152
    v_add_f32 v8, v8, v16
    v_add_f32 v8, v8, v17
    v_mfma_f32_16x16x32_bf16 a[156:159], v[92:95], v[28:31], a[156:159]
    s_waitcnt lgkmcnt(2)
    v_exp_f32 v19, v175
    v_mfma_f32_16x16x32_bf16 a[16:19], v[64:67], v[32:35], a[16:19]
    ds_read_b128 v[24:27], v21 offset:1536
    v_cvt_pk_bf16_f32 v172, v16, v17
    v_mfma_f32_16x16x32_bf16 a[16:19], v[80:83], v[36:39], a[16:19]
    s_sub_u32 s3, s29, 147456
    buffer_load_dwordx4 v[240:243], v9, s[64:67], s33 offen offset:384 nt
    v_mfma_f32_16x16x32_bf16 a[64:67], v[68:71], v[32:35], a[64:67]
    ds_read_b128 v[56:59], v10 offset:384
    s_waitcnt vmcnt(13)
    v_mfma_f32_16x16x32_bf16 a[64:67], v[84:87], v[36:39], a[64:67]
    v_exp_f32 v16, v108
    v_mfma_f32_16x16x32_bf16 a[112:115], v[72:75], v[32:35], a[112:115]
    ds_read_b128 v[28:31], v21 offset:13824
    v_add_f32 v8, v8, v18
    v_mfma_f32_16x16x32_bf16 a[112:115], v[88:91], v[36:39], a[112:115]
    v_add_f32 v8, v8, v19
    v_cvt_f32_i32 v224, v224
    v_mfma_f32_16x16x32_bf16 a[160:163], v[76:79], v[32:35], a[160:163]
    v_exp_f32 v17, v109
    v_mfma_f32_16x16x32_bf16 a[160:163], v[92:95], v[36:39], a[160:163]
    s_waitcnt lgkmcnt(3)
    buffer_load_dwordx4 v[244:247], v9, s[64:67], s33 offen offset:1920 nt
    v_mfma_f32_16x16x32_bf16 a[20:23], v[64:67], v[40:43], a[20:23]
    s_min_u32 s29, s29, s3
    ds_read_b128 v[32:35], v21 offset:2304
    v_cvt_pk_bf16_f32 v173, v18, v19
    v_mfma_f32_16x16x32_bf16 a[20:23], v[80:83], v[44:47], a[20:23]
    v_exp_f32 v18, v110
    v_mfma_f32_16x16x32_bf16 a[68:71], v[68:71], v[40:43], a[68:71]
    v_cvt_f32_i32 v225, v225
    v_add_f32 v8, v8, v16
    v_mfma_f32_16x16x32_bf16 a[68:71], v[84:87], v[44:47], a[68:71]
    v_add_f32 v8, v8, v17
    v_cvt_f32_i32 v228, v228
    v_mfma_f32_16x16x32_bf16 a[116:119], v[72:75], v[40:43], a[116:119]
    ds_read_b128 v[36:39], v21 offset:14592
    v_mfma_f32_16x16x32_bf16 a[116:119], v[88:91], v[44:47], a[116:119]
    buffer_load_dwordx4 v[248:251], v9, s[64:67], s34 offen offset:384 nt
    v_mfma_f32_16x16x32_bf16 a[164:167], v[76:79], v[40:43], a[164:167]
    s_sub_u32 s3, s29, s28
    v_exp_f32 v19, v111
    v_mfma_f32_16x16x32_bf16 a[164:167], v[92:95], v[44:47], a[164:167]
    s_waitcnt lgkmcnt(2)
    v_cvt_pk_bf16_f32 v174, v16, v17
    v_add_f32 v8, v8, v18
    v_mfma_f32_16x16x32_bf16 a[24:27], v[64:67], v[24:27], a[24:27]
    ds_read_b128 v[40:43], v22 offset:0
    v_add_f32 v8, v8, v19
    v_mfma_f32_16x16x32_bf16 a[24:27], v[80:83], v[28:31], a[24:27]
    ds_read_b128 v[60:63], v10 offset:768
    v_cvt_pk_bf16_f32 v175, v18, v19
    v_mfma_f32_16x16x32_bf16 a[72:75], v[68:71], v[24:27], a[72:75]
    v_exp_f32 v16, v176
    v_mfma_f32_16x16x32_bf16 a[72:75], v[84:87], v[28:31], a[72:75]
    buffer_load_dwordx4 v[252:255], v9, s[64:67], s34 offen offset:1920 nt
    v_mfma_f32_16x16x32_bf16 a[120:123], v[72:75], v[24:27], a[120:123]
    ds_read_b128 v[44:47], v22 offset:12288
    v_cvt_f32_i32 v229, v229
    v_mfma_f32_16x16x32_bf16 a[120:123], v[88:91], v[28:31], a[120:123]
    s_mov_b32 s28, s29
    v_exp_f32 v17, v177
    v_mfma_f32_16x16x32_bf16 a[168:171], v[76:79], v[24:27], a[168:171]
    v_exp_f32 v18, v178
    v_mfma_f32_16x16x32_bf16 a[168:171], v[92:95], v[28:31], a[168:171]
    s_waitcnt lgkmcnt(3)
    v_fma_f32 v224, v224, v48, v50
    v_add_f32 v5, v5, v16
    v_mfma_f32_16x16x32_bf16 a[28:31], v[64:67], v[32:35], a[28:31]
    ds_read_b128 v[24:27], v22 offset:768
    v_add_f32 v5, v5, v17
    v_mfma_f32_16x16x32_bf16 a[28:31], v[80:83], v[36:39], a[28:31]
    v_fma_f32 v225, v225, v49, v51
    v_fma_f32 v228, v228, v48, v50
    v_mfma_f32_16x16x32_bf16 a[76:79], v[68:71], v[32:35], a[76:79]
    s_mov_b32 m0, s26
    v_exp_f32 v19, v179
    v_mfma_f32_16x16x32_bf16 a[76:79], v[84:87], v[36:39], a[76:79]
    v_cvt_pk_bf16_f32 v176, v16, v17
    v_fma_f32 v229, v229, v49, v51
    v_mfma_f32_16x16x32_bf16 a[124:127], v[72:75], v[32:35], a[124:127]
    ds_read_b128 v[28:31], v22 offset:13056
    v_cvt_pk_bf16_f32 v224, v224, v225
    v_mfma_f32_16x16x32_bf16 a[124:127], v[88:91], v[36:39], a[124:127]
    buffer_load_dwordx4 v4, s[4:7], s32 offen offset:0 sc1 lds
    v_mfma_f32_16x16x32_bf16 a[172:175], v[76:79], v[32:35], a[172:175]
    v_exp_f32 v16, v112
    v_mfma_f32_16x16x32_bf16 a[172:175], v[92:95], v[36:39], a[172:175]
    s_waitcnt lgkmcnt(2)
    v_add_f32 v5, v5, v18
    v_add_f32 v5, v5, v19
    v_mfma_f32_16x16x32_bf16 a[32:35], v[64:67], v[40:43], a[32:35]
    ds_read_b128 v[32:35], v22 offset:1536
    v_cvt_pk_bf16_f32 v228, v228, v229
    v_mfma_f32_16x16x32_bf16 a[32:35], v[80:83], v[44:47], a[32:35]
    buffer_load_dwordx4 v4, s[4:7], s32 offen offset:1024 sc1 lds
    v_mfma_f32_16x16x32_bf16 a[80:83], v[68:71], v[40:43], a[80:83]
    v_exp_f32 v17, v113
    v_mfma_f32_16x16x32_bf16 a[80:83], v[84:87], v[44:47], a[80:83]
    v_cvt_pk_bf16_f32 v177, v18, v19
    v_cvt_f32_i32 v226, v226
    v_mfma_f32_16x16x32_bf16 a[128:131], v[72:75], v[40:43], a[128:131]
    ds_read_b128 v[36:39], v22 offset:13824
    v_cvt_f32_i32 v227, v227
    v_mfma_f32_16x16x32_bf16 a[128:131], v[88:91], v[44:47], a[128:131]
    buffer_load_dwordx4 v4, s[4:7], s32 offen offset:2048 sc1 lds
    v_mfma_f32_16x16x32_bf16 a[176:179], v[76:79], v[40:43], a[176:179]
    v_exp_f32 v18, v114
    v_mfma_f32_16x16x32_bf16 a[176:179], v[92:95], v[44:47], a[176:179]
    s_waitcnt lgkmcnt(2)
    v_add_f32 v5, v5, v16
    v_add_f32 v5, v5, v17
    v_mfma_f32_16x16x32_bf16 a[36:39], v[64:67], v[24:27], a[36:39]
    s_add_u32 s32, s32, 24576
    ds_read_b128 v[40:43], v22 offset:2304
    v_cvt_f32_i32 v230, v230
    v_mfma_f32_16x16x32_bf16 a[36:39], v[80:83], v[28:31], a[36:39]
    v_exp_f32 v19, v115
    v_cvt_pk_bf16_f32 v178, v16, v17
    v_mfma_f32_16x16x32_bf16 a[84:87], v[68:71], v[24:27], a[84:87]
    s_add_u32 s26, s26, 12288
    v_exp_f32 v16, v180
    v_mfma_f32_16x16x32_bf16 a[84:87], v[84:87], v[28:31], a[84:87]
    v_add_u32 v2, s3, v2
    v_add_f32 v5, v5, v18
    v_mfma_f32_16x16x32_bf16 a[132:135], v[72:75], v[24:27], a[132:135]
    s_mov_b32 m0, s26
    ds_read_b128 v[44:47], v22 offset:14592
    v_add_u32 v3, s3, v3
    v_mfma_f32_16x16x32_bf16 a[132:135], v[88:91], v[28:31], a[132:135]
    s_waitcnt lgkmcnt(2)
    v_add_f32 v5, v5, v19
    v_cvt_f32_i32 v231, v231
    v_mfma_f32_16x16x32_bf16 a[180:183], v[76:79], v[24:27], a[180:183]
    s_waitcnt vmcnt(7)
    v_exp_f32 v17, v181
    v_mfma_f32_16x16x32_bf16 a[180:183], v[92:95], v[28:31], a[180:183]
    s_barrier
    v_cvt_pk_bf16_f32 v179, v18, v19
    v_mfma_f32_16x16x32_bf16 a[40:43], v[64:67], v[32:35], a[40:43]
    ds_read_b128 v[24:27], v2 offset:0
    v_fma_f32 v226, v226, v56, v58
    v_mfma_f32_16x16x32_bf16 a[40:43], v[80:83], v[36:39], a[40:43]
    buffer_load_dwordx4 v4, s[4:7], s32 offen offset:0 sc1 lds
    v_mfma_f32_16x16x32_bf16 a[88:91], v[68:71], v[32:35], a[88:91]
    v_exp_f32 v18, v182
    v_mfma_f32_16x16x32_bf16 a[88:91], v[84:87], v[36:39], a[88:91]
    v_add_f32 v6, v6, v16
    v_add_f32 v6, v6, v17
    v_mfma_f32_16x16x32_bf16 a[136:139], v[72:75], v[32:35], a[136:139]
    ds_read_b128 v[28:31], v3 offset:0
    v_fma_f32 v227, v227, v57, v59
    v_mfma_f32_16x16x32_bf16 a[136:139], v[88:91], v[36:39], a[136:139]
    buffer_load_dwordx4 v4, s[4:7], s32 offen offset:1024 sc1 lds
    v_mfma_f32_16x16x32_bf16 a[184:187], v[76:79], v[32:35], a[184:187]
    v_exp_f32 v19, v183
    v_mfma_f32_16x16x32_bf16 a[184:187], v[92:95], v[36:39], a[184:187]
    s_waitcnt lgkmcnt(2)
    v_cvt_pk_bf16_f32 v180, v16, v17
    v_exp_f32 v16, v116
    v_mfma_f32_16x16x32_bf16 a[44:47], v[64:67], v[40:43], a[44:47]
    ds_read_b128 v[32:35], v2 offset:6144
    v_add_f32 v6, v6, v18
    v_mfma_f32_16x16x32_bf16 a[44:47], v[80:83], v[44:47], a[44:47]
    buffer_load_dwordx4 v4, s[4:7], s32 offen offset:2048 sc1 lds
    v_add_f32 v6, v6, v19
    v_mfma_f32_16x16x32_bf16 a[92:95], v[68:71], v[40:43], a[92:95]
    v_exp_f32 v17, v117
    v_mfma_f32_16x16x32_bf16 a[92:95], v[84:87], v[44:47], a[92:95]
    v_fma_f32 v230, v230, v56, v58
    v_cvt_pk_bf16_f32 v181, v18, v19
    v_fma_f32 v231, v231, v57, v59
    v_mfma_f32_16x16x32_bf16 a[140:143], v[72:75], v[40:43], a[140:143]
    ds_read_b128 v[36:39], v3 offset:6144
    v_cvt_pk_bf16_f32 v225, v226, v227
    v_mfma_f32_16x16x32_bf16 a[140:143], v[88:91], v[44:47], a[140:143]
    v_add_u32 v55, 1, v55
    buffer_store_dword v55, v13, s[20:23], 0 offen sc1
    v_mfma_f32_16x16x32_bf16 a[188:191], v[76:79], v[40:43], a[188:191]
    s_add_u32 s32, s32, 24576
    v_exp_f32 v18, v118
    v_mfma_f32_16x16x32_bf16 a[188:191], v[92:95], v[44:47], a[188:191]
    s_waitcnt lgkmcnt(2)
    v_add_f32 v6, v6, v16
    v_add_f32 v6, v6, v17
    v_exp_f32 v19, v119
    v_cvt_pk_bf16_f32 v229, v230, v231
    s_waitcnt vmcnt(21)
    v_cvt_pk_bf16_f32 v182, v16, v17
    v_cvt_f32_i32 v232, v232
    v_add_f32 v6, v6, v18
    s_add_u32 s26, s26, 36864
    v_cvt_f32_i32 v233, v233
    v_add_f32 v6, v6, v19
    s_sub_u32 s57, s26, 147456
    v_cvt_f32_i32 v236, v236
    v_cvt_pk_bf16_f32 v183, v18, v19
    s_min_u32 s26, s26, s57
    v_cvt_f32_i32 v237, v237
    v_mfma_f32_16x16x32_bf16 v[64:67], v[24:27], a[192:195], v[128:131]
    ds_read_b128 v[40:43], v2 offset:128
    s_add_u32 s35, s35, 196608
    v_mfma_f32_16x16x32_bf16 v[64:67], v[28:31], a[196:199], v[64:67]
    s_sub_u32 s36, s35, 1572864
    v_exp_f32 v16, v184
    v_mfma_f32_16x16x32_bf16 v[68:71], v[24:27], a[216:219], v[132:135]
    v_exp_f32 v17, v185
    v_mfma_f32_16x16x32_bf16 v[68:71], v[28:31], a[220:223], v[68:71]
    s_min_u32 s35, s35, s36
    v_fma_f32 v232, v232, v48, v50
    v_fma_f32 v233, v233, v49, v51
    v_mfma_f32_16x16x32_bf16 v[72:75], v[24:27], a[240:243], v[136:139]
    ds_read_b128 v[44:47], v3 offset:128
    v_fma_f32 v236, v236, v48, v50
    v_mfma_f32_16x16x32_bf16 v[72:75], v[28:31], a[244:247], v[72:75]
    s_add_u32 s36, s35, 3072
    v_exp_f32 v18, v186
    v_mfma_f32_16x16x32_bf16 v[76:79], v[24:27], v[200:203], v[140:143]
    v_add_f32 v7, v7, v16
    v_add_f32 v7, v7, v17
    v_mfma_f32_16x16x32_bf16 v[76:79], v[28:31], v[204:207], v[76:79]
    s_waitcnt lgkmcnt(2)
    v_exp_f32 v19, v187
    v_mfma_f32_16x16x32_bf16 v[96:99], v[32:35], a[192:195], v[128:131]
    s_add_u32 s81, s81, 196608
    ds_read_b128 v[24:27], v2 offset:6272
    v_fma_f32 v237, v237, v49, v51
    v_mfma_f32_16x16x32_bf16 v[96:99], v[36:39], a[196:199], v[96:99]
    v_cvt_pk_bf16_f32 v184, v16, v17
    v_cvt_pk_bf16_f32 v232, v232, v233
    v_mfma_f32_16x16x32_bf16 v[100:103], v[32:35], a[216:219], v[132:135]
    v_exp_f32 v16, v120
    v_mfma_f32_16x16x32_bf16 v[100:103], v[36:39], a[220:223], v[100:103]
    buffer_load_dwordx4 v[144:147], v12, s[68:71], s35 offen offset:0 nt
    v_mfma_f32_16x16x32_bf16 v[104:107], v[32:35], a[240:243], v[136:139]
    ds_read_b128 v[28:31], v3 offset:6272
    v_add_f32 v7, v7, v18
    v_mfma_f32_16x16x32_bf16 v[104:107], v[36:39], a[244:247], v[104:107]
    v_add_f32 v7, v7, v19
    v_cvt_pk_bf16_f32 v236, v236, v237
    v_mfma_f32_16x16x32_bf16 v[108:111], v[32:35], v[200:203], v[140:143]
    v_exp_f32 v17, v121
    v_mfma_f32_16x16x32_bf16 v[108:111], v[36:39], v[204:207], v[108:111]
    s_waitcnt lgkmcnt(2)
    v_cvt_pk_bf16_f32 v185, v18, v19
    v_cvt_f32_i32 v234, v234
    v_mfma_f32_16x16x32_bf16 v[64:67], v[40:43], a[200:203], v[64:67]
    ds_read_b128 v[32:35], v2 offset:256
    v_mfma_f32_16x16x32_bf16 v[64:67], v[44:47], a[204:207], v[64:67]
    buffer_load_dwordx4 v[148:151], v12, s[68:71], s35 offen offset:768 nt
    v_mfma_f32_16x16x32_bf16 v[68:71], v[40:43], a[224:227], v[68:71]
    v_exp_f32 v18, v122
    v_mfma_f32_16x16x32_bf16 v[68:71], v[44:47], a[228:231], v[68:71]
    v_add_f32 v7, v7, v16
    v_add_f32 v7, v7, v17
    v_mfma_f32_16x16x32_bf16 v[72:75], v[40:43], a[248:251], v[72:75]
    ds_read_b128 v[36:39], v3 offset:256
    v_cvt_f32_i32 v235, v235
    v_mfma_f32_16x16x32_bf16 v[72:75], v[44:47], a[252:255], v[72:75]
    buffer_load_dwordx4 v[152:155], v12, s[68:71], s35 offen offset:1536 nt
    v_mfma_f32_16x16x32_bf16 v[76:79], v[40:43], v[208:211], v[76:79]
    v_exp_f32 v19, v123
    v_mfma_f32_16x16x32_bf16 v[76:79], v[44:47], v[212:215], v[76:79]
    s_waitcnt lgkmcnt(2)
    v_cvt_pk_bf16_f32 v186, v16, v17
    v_cvt_f32_i32 v238, v238
    v_mfma_f32_16x16x32_bf16 v[96:99], v[24:27], a[200:203], v[96:99]
    ds_read_b128 v[40:43], v2 offset:6400
    v_cvt_f32_i32 v239, v239
    v_mfma_f32_16x16x32_bf16 v[96:99], v[28:31], a[204:207], v[96:99]
    v_exp_f32 v16, v188
    v_mfma_f32_16x16x32_bf16 v[100:103], v[24:27], a[224:227], v[100:103]
    v_add_f32 v7, v7, v18
    v_add_f32 v7, v7, v19
    v_mfma_f32_16x16x32_bf16 v[100:103], v[28:31], a[228:231], v[100:103]
    buffer_load_dwordx4 v[156:159], v12, s[68:71], s35 offen offset:2304 nt
    v_mfma_f32_16x16x32_bf16 v[104:107], v[24:27], a[248:251], v[104:107]
    ds_read_b128 v[44:47], v3 offset:6400
    v_fma_f32 v234, v234, v56, v58
    v_mfma_f32_16x16x32_bf16 v[104:107], v[28:31], a[252:255], v[104:107]
    v_exp_f32 v17, v189
    v_mfma_f32_16x16x32_bf16 v[108:111], v[24:27], v[208:211], v[108:111]
    s_add_u32 s29, s30, 49152
    v_cvt_pk_bf16_f32 v187, v18, v19
    v_fma_f32 v235, v235, v57, v59
    v_mfma_f32_16x16x32_bf16 v[108:111], v[28:31], v[212:215], v[108:111]
    s_waitcnt lgkmcnt(2)
    v_exp_f32 v18, v190
    v_mfma_f32_16x16x32_bf16 v[64:67], v[32:35], a[208:211], v[64:67]
    s_mov_b32 m0, s26
    ds_read_b128 v[24:27], v2 offset:12288
    v_add_f32 v8, v8, v16
    v_mfma_f32_16x16x32_bf16 v[64:67], v[36:39], a[212:215], v[64:67]
    s_sub_u32 s3, s29, 147456
    buffer_load_dwordx4 v4, s[4:7], s32 offen offset:0 sc1 lds
    v_mfma_f32_16x16x32_bf16 v[68:71], v[32:35], a[232:235], v[68:71]
    v_add_f32 v8, v8, v17
    v_fma_f32 v238, v238, v56, v58
    v_mfma_f32_16x16x32_bf16 v[68:71], v[36:39], a[236:239], v[68:71]
    v_exp_f32 v19, v191
    v_mfma_f32_16x16x32_bf16 v[72:75], v[32:35], v[192:195], v[72:75]
    ds_read_b128 v[28:31], v3 offset:12288
    v_cvt_pk_bf16_f32 v188, v16, v17
    v_mfma_f32_16x16x32_bf16 v[72:75], v[36:39], v[196:199], v[72:75]
    buffer_load_dwordx4 v4, s[4:7], s32 offen offset:1024 sc1 lds
    v_mfma_f32_16x16x32_bf16 v[76:79], v[32:35], v[216:219], v[76:79]
    s_min_u32 s29, s29, s3
    v_exp_f32 v16, v124
    v_mfma_f32_16x16x32_bf16 v[76:79], v[36:39], v[220:223], v[76:79]
    s_waitcnt lgkmcnt(2)
    v_add_f32 v8, v8, v18
    v_add_f32 v8, v8, v19
    v_mfma_f32_16x16x32_bf16 v[96:99], v[40:43], a[208:211], v[96:99]
    ds_read_b128 v[32:35], v2 offset:18432
    v_fma_f32 v239, v239, v57, v59
    v_mfma_f32_16x16x32_bf16 v[96:99], v[44:47], a[212:215], v[96:99]
    buffer_load_dwordx4 v4, s[4:7], s32 offen offset:2048 sc1 lds
    v_mfma_f32_16x16x32_bf16 v[100:103], v[40:43], a[232:235], v[100:103]
    v_exp_f32 v17, v125
    v_mfma_f32_16x16x32_bf16 v[100:103], v[44:47], a[236:239], v[100:103]
    v_cvt_pk_bf16_f32 v189, v18, v19
    v_cvt_pk_bf16_f32 v233, v234, v235
    v_mfma_f32_16x16x32_bf16 v[104:107], v[40:43], v[192:195], v[104:107]
    s_add_u32 s32, s32, 24576
    ds_read_b128 v[36:39], v3 offset:18432
    v_cvt_pk_bf16_f32 v237, v238, v239
    v_mfma_f32_16x16x32_bf16 v[104:107], v[44:47], v[196:199], v[104:107]
    s_sub_u32 s3, s29, s30
    v_exp_f32 v18, v126
    v_mfma_f32_16x16x32_bf16 v[108:111], v[40:43], v[216:219], v[108:111]
    s_add_u32 s26, s26, 12288
    v_add_f32 v8, v8, v16
    v_add_f32 v8, v8, v17
    v_mfma_f32_16x16x32_bf16 v[108:111], v[44:47], v[220:223], v[108:111]
    s_waitcnt lgkmcnt(2)
    v_exp_f32 v19, v127
    v_mfma_f32_16x16x32_bf16 v[80:83], v[24:27], a[192:195], v[128:131]
    s_mov_b32 m0, s26
    ds_read_b128 v[40:43], v2 offset:12416
    v_cvt_pk_bf16_f32 v190, v16, v17
    v_mfma_f32_16x16x32_bf16 v[80:83], v[28:31], a[196:199], v[80:83]
    v_add_f32 v8, v8, v18
    v_add_f32 v8, v8, v19
    v_mfma_f32_16x16x32_bf16 v[84:87], v[24:27], a[216:219], v[132:135]
    s_mov_b32 s30, s29
    ds_read_b128 v[48:51], v10 offset:1152
    v_cvt_pk_bf16_f32 v191, v18, v19
    v_mfma_f32_16x16x32_bf16 v[84:87], v[28:31], a[220:223], v[84:87]
    s_waitcnt vmcnt(16)
    buffer_load_dwordx4 v4, s[4:7], s32 offen offset:0 sc1 lds
    v_mfma_f32_16x16x32_bf16 v[88:91], v[24:27], a[240:243], v[136:139]
    ds_read_b128 v[44:47], v3 offset:12416
    v_cvt_f32_i32 v240, v240
    v_mfma_f32_16x16x32_bf16 v[88:91], v[28:31], a[244:247], v[88:91]
    v_exp_f32 v16, v64
    v_mfma_f32_16x16x32_bf16 v[92:95], v[24:27], v[200:203], v[140:143]
    v_exp_f32 v17, v65
    v_mfma_f32_16x16x32_bf16 v[92:95], v[28:31], v[204:207], v[92:95]
    s_waitcnt lgkmcnt(3)
    buffer_load_dwordx4 v4, s[4:7], s32 offen offset:1024 sc1 lds
    v_mfma_f32_16x16x32_bf16 v[112:115], v[32:35], a[192:195], v[128:131]
    ds_read_b128 v[24:27], v2 offset:18560
    v_cvt_f32_i32 v241, v241
    v_mfma_f32_16x16x32_bf16 v[112:115], v[36:39], a[196:199], v[112:115]
    v_exp_f32 v18, v66
    v_mfma_f32_16x16x32_bf16 v[116:119], v[32:35], a[216:219], v[132:135]
    v_add_f32 v5, v5, v16
    v_add_f32 v5, v5, v17
    v_mfma_f32_16x16x32_bf16 v[116:119], v[36:39], a[220:223], v[116:119]
    buffer_load_dwordx4 v4, s[4:7], s32 offen offset:2048 sc1 lds
    v_mfma_f32_16x16x32_bf16 v[120:123], v[32:35], a[240:243], v[136:139]
    ds_read_b128 v[28:31], v3 offset:18560
    v_cvt_f32_i32 v244, v244
    v_mfma_f32_16x16x32_bf16 v[120:123], v[36:39], a[244:247], v[120:123]
    v_exp_f32 v19, v67
    v_mfma_f32_16x16x32_bf16 v[124:127], v[32:35], v[200:203], v[140:143]
    ds_read_b128 v[56:59], v23 offset:0
    v_cvt_pk_bf16_f32 v64, v16, v17
    v_mfma_f32_16x16x32_bf16 v[124:127], v[36:39], v[204:207], v[124:127]
    s_waitcnt lgkmcnt(3)
    v_exp_f32 v16, v96
    v_mfma_f32_16x16x32_bf16 v[80:83], v[40:43], a[200:203], v[80:83]
    s_add_u32 s32, s32, 24576
    ds_read_b128 v[32:35], v2 offset:12544
    v_add_f32 v5, v5, v18
    v_mfma_f32_16x16x32_bf16 v[80:83], v[44:47], a[204:207], v[80:83]
    s_add_u32 s26, s26, 36864
    v_add_f32 v5, v5, v19
    v_add_u32 v10, 1792, v10
    v_mfma_f32_16x16x32_bf16 v[84:87], v[40:43], a[224:227], v[84:87]
    v_exp_f32 v17, v97
    v_mfma_f32_16x16x32_bf16 v[84:87], v[44:47], a[228:231], v[84:87]
    s_sub_u32 s57, s26, 147456
    v_cvt_pk_bf16_f32 v65, v18, v19
    v_bfe_u32 v53, v4, 4, 6
    v_mfma_f32_16x16x32_bf16 v[88:91], v[40:43], a[248:251], v[88:91]
    ds_read_b128 v[36:39], v3 offset:12544
    v_add_u32 v1, s3, v1
    v_mfma_f32_16x16x32_bf16 v[88:91], v[44:47], a[252:255], v[88:91]
    v_exp_f32 v18, v98
    v_mfma_f32_16x16x32_bf16 v[92:95], v[40:43], v[208:211], v[92:95]
    s_min_u32 s26, s26, s57
    v_lshlrev_b32 v53, 2, v53
    v_add_f32 v5, v5, v16
    v_mfma_f32_16x16x32_bf16 v[92:95], v[44:47], v[212:215], v[92:95]
    s_waitcnt lgkmcnt(3)
    buffer_load_dword v52, v53, s[20:23], 0 offen sc1
    v_mfma_f32_16x16x32_bf16 v[112:115], v[24:27], a[200:203], v[112:115]
    ds_read_b128 v[40:43], v2 offset:18688
    v_add_f32 v5, v5, v17
    v_mfma_f32_16x16x32_bf16 v[112:115], v[28:31], a[204:207], v[112:115]
    v_exp_f32 v19, v99
    v_mfma_f32_16x16x32_bf16 v[116:119], v[24:27], a[224:227], v[116:119]
    v_cvt_pk_bf16_f32 v66, v16, v17
    v_add_u32 v21, s3, v21
    v_mfma_f32_16x16x32_bf16 v[116:119], v[28:31], a[228:231], v[116:119]
    v_exp_f32 v16, v68
    v_mfma_f32_16x16x32_bf16 v[120:123], v[24:27], a[248:251], v[120:123]
    ds_read_b128 v[44:47], v3 offset:18688
    v_add_u32 v22, s3, v22
    v_mfma_f32_16x16x32_bf16 v[120:123], v[28:31], a[252:255], v[120:123]
    s_waitcnt lgkmcnt(2)
    v_add_f32 v5, v5, v18
    v_cvt_f32_i32 v245, v245
    v_mfma_f32_16x16x32_bf16 v[124:127], v[24:27], v[208:211], v[124:127]
    s_waitcnt vmcnt(37)
    v_add_f32 v5, v5, v19
    v_fma_f32 v240, v240, v60, v62
    v_mfma_f32_16x16x32_bf16 v[124:127], v[28:31], v[212:215], v[124:127]
    s_barrier
    v_exp_f32 v17, v69
    v_mfma_f32_16x16x32_bf16 v[80:83], v[32:35], a[208:211], v[80:83]
    ds_read_b128 v[24:27], v1 offset:0
    v_cvt_pk_bf16_f32 v67, v18, v19
    v_mfma_f32_16x16x32_bf16 v[80:83], v[36:39], a[212:215], v[80:83]
    v_exp_f32 v18, v70
    v_mfma_f32_16x16x32_bf16 v[84:87], v[32:35], a[232:235], v[84:87]
    v_add_f32 v6, v6, v16
    v_fma_f32 v241, v241, v61, v63
    v_mfma_f32_16x16x32_bf16 v[84:87], v[36:39], a[236:239], v[84:87]
    v_add_f32 v6, v6, v17
    v_fma_f32 v244, v244, v60, v62
    v_mfma_f32_16x16x32_bf16 v[88:91], v[32:35], v[192:195], v[88:91]
    ds_read_b128 v[28:31], v1 offset:12288
    v_fma_f32 v245, v245, v61, v63
    v_mfma_f32_16x16x32_bf16 v[88:91], v[36:39], v[196:199], v[88:91]
    v_exp_f32 v19, v71
    v_mfma_f32_16x16x32_bf16 v[92:95], v[32:35], v[216:219], v[92:95]
    v_cvt_pk_bf16_f32 v68, v16, v17
    v_cvt_pk_bf16_f32 v226, v240, v241
    v_mfma_f32_16x16x32_bf16 v[92:95], v[36:39], v[220:223], v[92:95]
    s_waitcnt lgkmcnt(2)
    v_exp_f32 v16, v100
    v_mfma_f32_16x16x32_bf16 v[112:115], v[40:43], a[208:211], v[112:115]
    ds_read_b128 v[32:35], v1 offset:768
    v_add_f32 v6, v6, v18
    v_mfma_f32_16x16x32_bf16 v[112:115], v[44:47], a[212:215], v[112:115]
    v_add_f32 v6, v6, v19
    v_cvt_pk_bf16_f32 v230, v244, v245
    v_mfma_f32_16x16x32_bf16 v[116:119], v[40:43], a[232:235], v[116:119]
    v_exp_f32 v17, v101
    v_mfma_f32_16x16x32_bf16 v[116:119], v[44:47], a[236:239], v[116:119]
    v_cvt_pk_bf16_f32 v69, v18, v19
    v_cvt_f32_i32 v242, v242
    v_mfma_f32_16x16x32_bf16 v[120:123], v[40:43], v[192:195], v[120:123]
    ds_read_b128 v[36:39], v1 offset:13056
    v_cvt_f32_i32 v243, v243
    v_mfma_f32_16x16x32_bf16 v[120:123], v[44:47], v[196:199], v[120:123]
    v_exp_f32 v18, v102
    v_mfma_f32_16x16x32_bf16 v[124:127], v[40:43], v[216:219], v[124:127]
    v_add_f32 v6, v6, v16
    v_add_f32 v6, v6, v17
    v_mfma_f32_16x16x32_bf16 v[124:127], v[44:47], v[220:223], v[124:127]
    s_waitcnt lgkmcnt(2)
    v_exp_f32 v19, v103
    v_cvt_pk_bf16_f32 v70, v16, v17
    v_add_f32 v6, v6, v18
    v_cvt_f32_i32 v246, v246
    v_add_f32 v6, v6, v19
    v_cvt_f32_i32 v247, v247
    v_cvt_pk_bf16_f32 v71, v18, v19
    v_fma_f32 v242, v242, v48, v50
    v_mfma_f32_16x16x32_bf16 a[0:3], v[160:163], v[24:27], a[0:3]
    ds_read_b128 v[40:43], v1 offset:1536
    v_fma_f32 v243, v243, v49, v51
    v_mfma_f32_16x16x32_bf16 a[0:3], v[176:179], v[28:31], a[0:3]
    v_exp_f32 v16, v72
    v_mfma_f32_16x16x32_bf16 a[48:51], v[164:167], v[24:27], a[48:51]
    v_exp_f32 v17, v73
    v_mfma_f32_16x16x32_bf16 a[48:51], v[180:183], v[28:31], a[48:51]
    v_exp_f32 v18, v74
    v_mfma_f32_16x16x32_bf16 a[96:99], v[168:171], v[24:27], a[96:99]
    ds_read_b128 v[44:47], v1 offset:13824
    v_fma_f32 v246, v246, v48, v50
    v_mfma_f32_16x16x32_bf16 a[96:99], v[184:187], v[28:31], a[96:99]
    v_add_f32 v7, v7, v16
    v_add_f32 v7, v7, v17
    v_mfma_f32_16x16x32_bf16 a[144:147], v[172:175], v[24:27], a[144:147]
    v_exp_f32 v19, v75
    v_mfma_f32_16x16x32_bf16 a[144:147], v[188:191], v[28:31], a[144:147]
    s_waitcnt lgkmcnt(2)
    v_fma_f32 v247, v247, v49, v51
    v_mfma_f32_16x16x32_bf16 a[4:7], v[160:163], v[32:35], a[4:7]
    ds_read_b128 v[24:27], v1 offset:2304
    v_cvt_pk_bf16_f32 v72, v16, v17
    v_mfma_f32_16x16x32_bf16 a[4:7], v[176:179], v[36:39], a[4:7]
    v_exp_f32 v16, v104
    v_mfma_f32_16x16x32_bf16 a[52:55], v[164:167], v[32:35], a[52:55]
    v_cvt_pk_bf16_f32 v227, v242, v243
    v_add_f32 v7, v7, v18
    v_mfma_f32_16x16x32_bf16 a[52:55], v[180:183], v[36:39], a[52:55]
    v_add_f32 v7, v7, v19
    v_mfma_f32_16x16x32_bf16 a[100:103], v[168:171], v[32:35], a[100:103]
    ds_read_b128 v[28:31], v1 offset:14592
    v_cvt_pk_bf16_f32 v231, v246, v247
    v_mfma_f32_16x16x32_bf16 a[100:103], v[184:187], v[36:39], a[100:103]
    v_exp_f32 v17, v105
    v_mfma_f32_16x16x32_bf16 a[148:151], v[172:175], v[32:35], a[148:151]
    v_cvt_pk_bf16_f32 v73, v18, v19
    v_mfma_f32_16x16x32_bf16 a[148:151], v[188:191], v[36:39], a[148:151]
    s_waitcnt lgkmcnt(2)
    v_exp_f32 v18, v106
    v_mfma_f32_16x16x32_bf16 a[8:11], v[160:163], v[40:43], a[8:11]
    s_waitcnt vmcnt(18)
    ds_read_b128 v[32:35], v21 offset:0
    v_add_f32 v7, v7, v16
    v_mfma_f32_16x16x32_bf16 a[8:11], v[176:179], v[44:47], a[8:11]
    v_add_f32 v7, v7, v17
    v_mfma_f32_16x16x32_bf16 a[56:59], v[164:167], v[40:43], a[56:59]
    v_exp_f32 v19, v107
    v_mfma_f32_16x16x32_bf16 a[56:59], v[180:183], v[44:47], a[56:59]
    v_mfma_f32_16x16x32_bf16 a[104:107], v[168:171], v[40:43], a[104:107]
    ds_read_b128 v[36:39], v21 offset:12288
    v_cvt_pk_bf16_f32 v74, v16, v17
    v_mfma_f32_16x16x32_bf16 a[104:107], v[184:187], v[44:47], a[104:107]
    v_exp_f32 v16, v76
    v_mfma_f32_16x16x32_bf16 a[152:155], v[172:175], v[40:43], a[152:155]
    v_cvt_f32_i32 v248, v248
    v_add_f32 v7, v7, v18
    v_mfma_f32_16x16x32_bf16 a[152:155], v[188:191], v[44:47], a[152:155]
    s_waitcnt lgkmcnt(2)
    v_add_f32 v7, v7, v19
    v_cvt_f32_i32 v249, v249
    v_mfma_f32_16x16x32_bf16 a[12:15], v[160:163], v[24:27], a[12:15]
    ds_read_b128 v[40:43], v21 offset:768
    v_mfma_f32_16x16x32_bf16 a[12:15], v[176:179], v[28:31], a[12:15]
    buffer_load_dwordx4 v[240:243], v12, s[68:71], s36 offen offset:0 nt
    v_mfma_f32_16x16x32_bf16 a[60:63], v[164:167], v[24:27], a[60:63]
    v_exp_f32 v17, v77
    v_mfma_f32_16x16x32_bf16 a[60:63], v[180:183], v[28:31], a[60:63]
    v_cvt_pk_bf16_f32 v75, v18, v19
    v_cvt_f32_i32 v252, v252
    v_mfma_f32_16x16x32_bf16 a[108:111], v[168:171], v[24:27], a[108:111]
    ds_read_b128 v[44:47], v21 offset:13056
    v_mfma_f32_16x16x32_bf16 a[108:111], v[184:187], v[28:31], a[108:111]
    v_exp_f32 v18, v78
    v_mfma_f32_16x16x32_bf16 a[156:159], v[172:175], v[24:27], a[156:159]
    s_add_u32 s29, s28, 49152
    v_add_f32 v8, v8, v16
    v_add_f32 v8, v8, v17
    v_mfma_f32_16x16x32_bf16 a[156:159], v[188:191], v[28:31], a[156:159]
    s_waitcnt lgkmcnt(2)
    v_exp_f32 v19, v79
    v_mfma_f32_16x16x32_bf16 a[16:19], v[160:163], v[32:35], a[16:19]
    ds_read_b128 v[24:27], v21 offset:1536
    v_cvt_pk_bf16_f32 v76, v16, v17
    v_mfma_f32_16x16x32_bf16 a[16:19], v[176:179], v[36:39], a[16:19]
    s_sub_u32 s3, s29, 147456
    buffer_load_dwordx4 v[244:247], v12, s[68:71], s36 offen offset:768 nt
    v_mfma_f32_16x16x32_bf16 a[64:67], v[164:167], v[32:35], a[64:67]
    v_exp_f32 v16, v108
    v_mfma_f32_16x16x32_bf16 a[64:67], v[180:183], v[36:39], a[64:67]
    v_add_f32 v8, v8, v18
    v_cvt_f32_i32 v253, v253
    v_mfma_f32_16x16x32_bf16 a[112:115], v[168:171], v[32:35], a[112:115]
    ds_read_b128 v[28:31], v21 offset:13824
    v_add_f32 v8, v8, v19
    v_mfma_f32_16x16x32_bf16 a[112:115], v[184:187], v[36:39], a[112:115]
    v_exp_f32 v17, v109
    v_mfma_f32_16x16x32_bf16 a[160:163], v[172:175], v[32:35], a[160:163]
    v_fma_f32 v248, v248, v60, v62
    v_cvt_pk_bf16_f32 v77, v18, v19
    v_mfma_f32_16x16x32_bf16 a[160:163], v[188:191], v[36:39], a[160:163]
    s_waitcnt lgkmcnt(2)
    v_exp_f32 v18, v110
    v_mfma_f32_16x16x32_bf16 a[20:23], v[160:163], v[40:43], a[20:23]
    s_min_u32 s29, s29, s3
    ds_read_b128 v[32:35], v21 offset:2304
    v_fma_f32 v249, v249, v61, v63
    v_mfma_f32_16x16x32_bf16 a[20:23], v[176:179], v[44:47], a[20:23]
    v_add_f32 v8, v8, v16
    v_add_f32 v8, v8, v17
    v_mfma_f32_16x16x32_bf16 a[68:71], v[164:167], v[40:43], a[68:71]
    v_exp_f32 v19, v111
    v_mfma_f32_16x16x32_bf16 a[68:71], v[180:183], v[44:47], a[68:71]
    v_fma_f32 v252, v252, v60, v62
    v_mfma_f32_16x16x32_bf16 a[116:119], v[168:171], v[40:43], a[116:119]
    ds_read_b128 v[36:39], v21 offset:14592
    v_cvt_pk_bf16_f32 v78, v16, v17
    v_mfma_f32_16x16x32_bf16 a[116:119], v[184:187], v[44:47], a[116:119]
    s_waitcnt vmcnt(2)
    v_subrev_u32 v52, s92, v52
    v_cmp_lt_u32 vcc, 15, v52
    v_mfma_f32_16x16x32_bf16 a[164:167], v[172:175], v[40:43], a[164:167]
    s_sub_u32 s3, s29, s28
    v_add_f32 v8, v8, v18
    v_add_f32 v8, v8, v19
    v_mfma_f32_16x16x32_bf16 a[164:167], v[188:191], v[44:47], a[164:167]
    s_waitcnt lgkmcnt(2)
    v_cvt_pk_bf16_f32 v79, v18, v19
    v_fma_f32 v253, v253, v61, v63
    v_mfma_f32_16x16x32_bf16 a[24:27], v[160:163], v[24:27], a[24:27]
    s_and_b32 s59, vcc_lo, 0xff
    ds_read_b128 v[40:43], v22 offset:0
    v_mfma_f32_16x16x32_bf16 a[24:27], v[176:179], v[28:31], a[24:27]
    s_cbranch_scc1 L_pollslow1
L_pollok1:
    v_mfma_f32_16x16x32_bf16 a[72:75], v[164:167], v[24:27], a[72:75]
    s_add_u32 s92, s92, 1
    v_exp_f32 v16, v80
    v_mfma_f32_16x16x32_bf16 a[72:75], v[180:183], v[28:31], a[72:75]
    s_mov_b32 m0, s56
    v_exp_f32 v17, v81
    v_mfma_f32_16x16x32_bf16 a[120:123], v[168:171], v[24:27], a[120:123]
    ds_read_b128 v[44:47], v22 offset:12288
    v_cvt_pk_bf16_f32 v234, v248, v249
    v_mfma_f32_16x16x32_bf16 a[120:123], v[184:187], v[28:31], a[120:123]
    s_mov_b32 s28, s29
    buffer_load_dwordx4 v4, s[4:7], s27 offen offset:0 sc1 lds
    v_mfma_f32_16x16x32_bf16 a[168:171], v[172:175], v[24:27], a[168:171]
    v_exp_f32 v18, v82
    v_mfma_f32_16x16x32_bf16 a[168:171], v[188:191], v[28:31], a[168:171]
    s_waitcnt lgkmcnt(2)
    v_add_f32 v5, v5, v16
    v_add_f32 v5, v5, v17
    v_mfma_f32_16x16x32_bf16 a[28:31], v[160:163], v[32:35], a[28:31]
    ds_read_b128 v[24:27], v22 offset:768
    v_cvt_pk_bf16_f32 v238, v252, v253
    v_mfma_f32_16x16x32_bf16 a[28:31], v[176:179], v[36:39], a[28:31]
    buffer_load_dwordx4 v4, s[4:7], s27 offen offset:1024 sc1 lds
    v_mfma_f32_16x16x32_bf16 a[76:79], v[164:167], v[32:35], a[76:79]
    v_exp_f32 v19, v83
    v_mfma_f32_16x16x32_bf16 a[76:79], v[180:183], v[36:39], a[76:79]
    v_cvt_pk_bf16_f32 v80, v16, v17
    v_cvt_f32_i32 v250, v250
    v_mfma_f32_16x16x32_bf16 a[124:127], v[168:171], v[32:35], a[124:127]
    ds_read_b128 v[28:31], v22 offset:13056
    v_cvt_f32_i32 v251, v251
    v_mfma_f32_16x16x32_bf16 a[124:127], v[184:187], v[36:39], a[124:127]
    buffer_load_dwordx4 v4, s[4:7], s27 offen offset:2048 sc1 lds
    v_mfma_f32_16x16x32_bf16 a[172:175], v[172:175], v[32:35], a[172:175]
    v_exp_f32 v16, v112
    v_mfma_f32_16x16x32_bf16 a[172:175], v[188:191], v[36:39], a[172:175]
    s_waitcnt lgkmcnt(2)
    v_add_f32 v5, v5, v18
    v_add_f32 v5, v5, v19
    v_mfma_f32_16x16x32_bf16 a[32:35], v[160:163], v[40:43], a[32:35]
    s_add_u32 s27, s27, 24576
    ds_read_b128 v[32:35], v22 offset:1536
    v_add_u32 v2, s3, v2
    v_mfma_f32_16x16x32_bf16 a[32:35], v[176:179], v[44:47], a[32:35]
    v_exp_f32 v17, v113
    v_mfma_f32_16x16x32_bf16 a[80:83], v[164:167], v[40:43], a[80:83]
    s_add_u32 s56, s56, 12288
    v_cvt_pk_bf16_f32 v81, v18, v19
    v_cvt_f32_i32 v254, v254
    v_mfma_f32_16x16x32_bf16 a[80:83], v[180:183], v[44:47], a[80:83]
    v_exp_f32 v18, v114
    v_mfma_f32_16x16x32_bf16 a[128:131], v[168:171], v[40:43], a[128:131]
    ds_read_b128 v[36:39], v22 offset:13824
    v_add_f32 v5, v5, v16
    v_mfma_f32_16x16x32_bf16 a[128:131], v[184:187], v[44:47], a[128:131]
    s_mov_b32 m0, s56
    v_add_f32 v5, v5, v17
    v_cvt_f32_i32 v255, v255
    v_mfma_f32_16x16x32_bf16 a[176:179], v[172:175], v[40:43], a[176:179]
    v_exp_f32 v19, v115
    v_mfma_f32_16x16x32_bf16 a[176:179], v[188:191], v[44:47], a[176:179]
    s_waitcnt lgkmcnt(2)
    v_cvt_pk_bf16_f32 v82, v16, v17
    v_add_u32 v3, s3, v3
    v_mfma_f32_16x16x32_bf16 a[36:39], v[160:163], v[24:27], a[36:39]
    ds_read_b128 v[40:43], v22 offset:2304
    v_fma_f32 v250, v250, v48, v50
    v_mfma_f32_16x16x32_bf16 a[36:39], v[176:179], v[28:31], a[36:39]
    buffer_load_dwordx4 v4, s[4:7], s27 offen offset:0 sc1 lds
    v_mfma_f32_16x16x32_bf16 a[84:87], v[164:167], v[24:27], a[84:87]
    v_exp_f32 v16, v84
    v_mfma_f32_16x16x32_bf16 a[84:87], v[180:183], v[28:31], a[84:87]
    v_add_f32 v5, v5, v18
    v_add_f32 v5, v5, v19
    v_mfma_f32_16x16x32_bf16 a[132:135], v[168:171], v[24:27], a[132:135]
    ds_read_b128 v[44:47], v22 offset:14592
    v_fma_f32 v251, v251, v49, v51
    v_mfma_f32_16x16x32_bf16 a[132:135], v[184:187], v[28:31], a[132:135]
    s_waitcnt lgkmcnt(2)
    buffer_load_dwordx4 v4, s[4:7], s27 offen offset:1024 sc1 lds
    v_mfma_f32_16x16x32_bf16 a[180:183], v[172:175], v[24:27], a[180:183]
    s_waitcnt vmcnt(19)
    v_exp_f32 v17, v85
    v_mfma_f32_16x16x32_bf16 a[180:183], v[188:191], v[28:31], a[180:183]
    s_barrier
    v_cvt_pk_bf16_f32 v83, v18, v19
    v_mfma_f32_16x16x32_bf16 a[40:43], v[160:163], v[32:35], a[40:43]
    ds_read_b128 v[24:27], v2 offset:0
    v_fma_f32 v254, v254, v48, v50
    v_mfma_f32_16x16x32_bf16 a[40:43], v[176:179], v[36:39], a[40:43]
    buffer_load_dwordx4 v4, s[4:7], s27 offen offset:2048 sc1 lds
    v_mfma_f32_16x16x32_bf16 a[88:91], v[164:167], v[32:35], a[88:91]
    v_exp_f32 v18, v86
    v_mfma_f32_16x16x32_bf16 a[88:91], v[180:183], v[36:39], a[88:91]
    v_add_f32 v6, v6, v16
    v_add_f32 v6, v6, v17
    v_mfma_f32_16x16x32_bf16 a[136:139], v[168:171], v[32:35], a[136:139]
    ds_read_b128 v[28:31], v3 offset:0
    v_fma_f32 v255, v255, v49, v51
    v_mfma_f32_16x16x32_bf16 a[136:139], v[184:187], v[36:39], a[136:139]
    v_exp_f32 v19, v87
    v_cvt_pk_bf16_f32 v84, v16, v17
    v_mfma_f32_16x16x32_bf16 a[184:187], v[172:175], v[32:35], a[184:187]
    s_add_u32 s27, s27, 24576
    v_exp_f32 v16, v116
    v_mfma_f32_16x16x32_bf16 a[184:187], v[188:191], v[36:39], a[184:187]
    s_waitcnt lgkmcnt(2)
    v_add_f32 v6, v6, v18
    v_add_f32 v6, v6, v19
    v_mfma_f32_16x16x32_bf16 a[44:47], v[160:163], v[40:43], a[44:47]
    s_add_u32 s56, s56, 36864
    ds_read_b128 v[32:35], v2 offset:6144
    v_cvt_pk_bf16_f32 v235, v250, v251
    v_mfma_f32_16x16x32_bf16 a[44:47], v[176:179], v[44:47], a[44:47]
    s_sub_u32 s58, s56, 147456
    v_exp_f32 v17, v117
    v_mfma_f32_16x16x32_bf16 a[92:95], v[164:167], v[40:43], a[92:95]
    v_cvt_pk_bf16_f32 v85, v18, v19
    v_cvt_pk_bf16_f32 v239, v254, v255
    v_mfma_f32_16x16x32_bf16 a[92:95], v[180:183], v[44:47], a[92:95]
    s_min_u32 s56, s56, s58
    v_exp_f32 v18, v118
    v_mfma_f32_16x16x32_bf16 a[140:143], v[168:171], v[40:43], a[140:143]
    ds_read_b128 v[36:39], v3 offset:6144
    v_add_f32 v6, v6, v16
    v_mfma_f32_16x16x32_bf16 a[140:143], v[184:187], v[44:47], a[140:143]
    v_add_f32 v6, v6, v17
    v_mfma_f32_16x16x32_bf16 a[188:191], v[172:175], v[40:43], a[188:191]
    v_exp_f32 v19, v119
    v_mfma_f32_16x16x32_bf16 a[188:191], v[188:191], v[44:47], a[188:191]
    s_waitcnt lgkmcnt(2)
    v_cvt_pk_bf16_f32 v86, v16, v17
    v_add_f32 v6, v6, v18
    v_add_f32 v6, v6, v19
    v_cvt_pk_bf16_f32 v87, v18, v19
    v_mfma_f32_16x16x32_bf16 v[160:163], v[24:27], a[192:195], v[128:131]
    ds_read_b128 v[40:43], v2 offset:128
    v_mfma_f32_16x16x32_bf16 v[160:163], v[28:31], a[196:199], v[160:163]
    buffer_store_dwordx4 v[224:227], v11, s[4:7], s37 offen offset:0 sc1
    v_mfma_f32_16x16x32_bf16 v[164:167], v[24:27], a[216:219], v[132:135]
    v_exp_f32 v16, v88
    v_mfma_f32_16x16x32_bf16 v[164:167], v[28:31], a[220:223], v[164:167]
    v_exp_f32 v17, v89
    v_mfma_f32_16x16x32_bf16 v[168:171], v[24:27], a[240:243], v[136:139]
    ds_read_b128 v[44:47], v3 offset:128
    v_mfma_f32_16x16x32_bf16 v[168:171], v[28:31], a[244:247], v[168:171]
    v_exp_f32 v18, v90
    v_mfma_f32_16x16x32_bf16 v[172:175], v[24:27], v[200:203], v[140:143]
    v_add_f32 v7, v7, v16
    v_add_f32 v7, v7, v17
    v_mfma_f32_16x16x32_bf16 v[172:175], v[28:31], v[204:207], v[172:175]
    s_waitcnt lgkmcnt(2)
    v_exp_f32 v19, v91
    v_mfma_f32_16x16x32_bf16 v[96:99], v[32:35], a[192:195], v[128:131]
    ds_read_b128 v[24:27], v2 offset:6272
    v_cvt_pk_bf16_f32 v88, v16, v17
    v_mfma_f32_16x16x32_bf16 v[96:99], v[36:39], a[196:199], v[96:99]
    buffer_store_dwordx4 v[228:231], v54, s[4:7], s37 offen offset:768 sc1
    v_mfma_f32_16x16x32_bf16 v[100:103], v[32:35], a[216:219], v[132:135]
    v_exp_f32 v16, v120
    v_mfma_f32_16x16x32_bf16 v[100:103], v[36:39], a[220:223], v[100:103]
    v_add_f32 v7, v7, v18
    v_mfma_f32_16x16x32_bf16 v[104:107], v[32:35], a[240:243], v[136:139]
    ds_read_b128 v[28:31], v3 offset:6272
    v_add_f32 v7, v7, v19
    v_mfma_f32_16x16x32_bf16 v[104:107], v[36:39], a[244:247], v[104:107]
    v_exp_f32 v17, v121
    v_mfma_f32_16x16x32_bf16 v[108:111], v[32:35], v[200:203], v[140:143]
    v_mfma_f32_16x16x32_bf16 v[108:111], v[36:39], v[204:207], v[108:111]
    s_waitcnt lgkmcnt(2)
    v_cvt_pk_bf16_f32 v89, v18, v19
    v_mfma_f32_16x16x32_bf16 v[160:163], v[40:43], a[200:203], v[160:163]
    ds_read_b128 v[32:35], v2 offset:256
    v_mfma_f32_16x16x32_bf16 v[160:163], v[44:47], a[204:207], v[160:163]
    buffer_store_dwordx4 v[232:235], v11, s[4:7], s80 offen offset:0 sc1
    v_mfma_f32_16x16x32_bf16 v[164:167], v[40:43], a[224:227], v[164:167]
    v_exp_f32 v18, v122
    v_mfma_f32_16x16x32_bf16 v[164:167], v[44:47], a[228:231], v[164:167]
    v_add_f32 v7, v7, v16
    v_add_f32 v7, v7, v17
    v_mfma_f32_16x16x32_bf16 v[168:171], v[40:43], a[248:251], v[168:171]
    ds_read_b128 v[36:39], v3 offset:256
    v_mfma_f32_16x16x32_bf16 v[168:171], v[44:47], a[252:255], v[168:171]
    v_exp_f32 v19, v123
    v_mfma_f32_16x16x32_bf16 v[172:175], v[40:43], v[208:211], v[172:175]
    v_cvt_pk_bf16_f32 v90, v16, v17
    v_mfma_f32_16x16x32_bf16 v[172:175], v[44:47], v[212:215], v[172:175]
    s_waitcnt lgkmcnt(2)
    v_exp_f32 v16, v92
    v_mfma_f32_16x16x32_bf16 v[96:99], v[24:27], a[200:203], v[96:99]
    ds_read_b128 v[40:43], v2 offset:6400
    v_add_f32 v7, v7, v18
    v_mfma_f32_16x16x32_bf16 v[96:99], v[28:31], a[204:207], v[96:99]
    buffer_store_dwordx4 v[236:239], v54, s[4:7], s80 offen offset:768 sc1
    v_mfma_f32_16x16x32_bf16 v[100:103], v[24:27], a[224:227], v[100:103]
    v_add_f32 v7, v7, v19
    v_mfma_f32_16x16x32_bf16 v[100:103], v[28:31], a[228:231], v[100:103]
    v_exp_f32 v17, v93
    v_mfma_f32_16x16x32_bf16 v[104:107], v[24:27], a[248:251], v[104:107]
    ds_read_b128 v[44:47], v3 offset:6400
    v_cvt_pk_bf16_f32 v91, v18, v19
    v_mfma_f32_16x16x32_bf16 v[104:107], v[28:31], a[252:255], v[104:107]
    v_exp_f32 v18, v94
    v_mfma_f32_16x16x32_bf16 v[108:111], v[24:27], v[208:211], v[108:111]
    s_add_u32 s29, s30, 49152
    ds_read_b128 v[60:63], v23 offset:16
    v_add_f32 v8, v8, v16
    v_mfma_f32_16x16x32_bf16 v[108:111], v[28:31], v[212:215], v[108:111]
    s_waitcnt lgkmcnt(3)
    v_add_f32 v8, v8, v17
    s_waitcnt vmcnt(21)
    v_mfma_f32_16x16x32_bf16 v[160:163], v[32:35], a[208:211], v[160:163]
    ds_read_b128 v[24:27], v2 offset:12288
    s_sub_u32 s3, s29, 147456
    v_mfma_f32_16x16x32_bf16 v[160:163], v[36:39], a[212:215], v[160:163]
    buffer_load_dwordx4 v[248:251], v12, s[68:71], s36 offen offset:1536 nt
    v_mfma_f32_16x16x32_bf16 v[164:167], v[32:35], a[232:235], v[164:167]
    v_exp_f32 v19, v95
    v_mfma_f32_16x16x32_bf16 v[164:167], v[36:39], a[236:239], v[164:167]
    v_cvt_pk_bf16_f32 v92, v16, v17
    v_cvt_f32_i32 v144, v144
    v_mfma_f32_16x16x32_bf16 v[168:171], v[32:35], v[192:195], v[168:171]
    ds_read_b128 v[28:31], v3 offset:12288
    v_cvt_f32_i32 v148, v148
    v_mfma_f32_16x16x32_bf16 v[168:171], v[36:39], v[196:199], v[168:171]
    buffer_load_dwordx4 v[252:255], v12, s[68:71], s36 offen offset:2304 nt
    v_mfma_f32_16x16x32_bf16 v[172:175], v[32:35], v[216:219], v[172:175]
    s_min_u32 s29, s29, s3
    v_exp_f32 v16, v124
    v_mfma_f32_16x16x32_bf16 v[172:175], v[36:39], v[220:223], v[172:175]
    s_waitcnt lgkmcnt(3)
    v_add_f32 v8, v8, v18
    v_add_f32 v8, v8, v19
    v_mfma_f32_16x16x32_bf16 v[96:99], v[40:43], a[208:211], v[96:99]
    ds_read_b128 v[32:35], v2 offset:18432
    v_cvt_f32_i32 v145, v145
    v_mfma_f32_16x16x32_bf16 v[96:99], v[44:47], a[212:215], v[96:99]
    v_exp_f32 v17, v125
    v_mfma_f32_16x16x32_bf16 v[100:103], v[40:43], a[232:235], v[100:103]
    ds_read_b128 v[48:51], v23 offset:32
    v_cvt_pk_bf16_f32 v93, v18, v19
    v_mfma_f32_16x16x32_bf16 v[100:103], v[44:47], a[236:239], v[100:103]
    v_exp_f32 v18, v126
    v_mfma_f32_16x16x32_bf16 v[104:107], v[40:43], v[192:195], v[104:107]
    s_mov_b32 m0, s56
    ds_read_b128 v[36:39], v3 offset:18432
    v_add_f32 v8, v8, v16
    v_mfma_f32_16x16x32_bf16 v[104:107], v[44:47], v[196:199], v[104:107]
    s_sub_u32 s3, s29, s30
    v_add_f32 v8, v8, v17
    v_cvt_f32_i32 v149, v149
    v_mfma_f32_16x16x32_bf16 v[108:111], v[40:43], v[216:219], v[108:111]
    v_exp_f32 v19, v127
    v_mfma_f32_16x16x32_bf16 v[108:111], v[44:47], v[220:223], v[108:111]
    s_waitcnt lgkmcnt(3)
    buffer_load_dwordx4 v4, s[4:7], s27 offen offset:0 sc1 lds
    v_mfma_f32_16x16x32_bf16 v[176:179], v[24:27], a[192:195], v[128:131]
    ds_read_b128 v[40:43], v2 offset:12416
    v_cvt_pk_bf16_f32 v94, v16, v17
    v_mfma_f32_16x16x32_bf16 v[176:179], v[28:31], a[196:199], v[176:179]
    v_add_f32 v8, v8, v18
    v_add_f32 v8, v8, v19
    v_mfma_f32_16x16x32_bf16 v[180:183], v[24:27], a[216:219], v[132:135]
    s_mov_b32 s30, s29
    v_cvt_pk_bf16_f32 v95, v18, v19
    v_fma_f32 v144, v144, v56, v58
    v_mfma_f32_16x16x32_bf16 v[180:183], v[28:31], a[220:223], v[180:183]
    v_fma_f32 v148, v148, v57, v59
    v_fma_f32 v145, v145, v56, v58
    v_mfma_f32_16x16x32_bf16 v[184:187], v[24:27], a[240:243], v[136:139]
    ds_read_b128 v[44:47], v3 offset:12416
    v_fma_f32 v149, v149, v57, v59
    v_mfma_f32_16x16x32_bf16 v[184:187], v[28:31], a[244:247], v[184:187]
    buffer_load_dwordx4 v4, s[4:7], s27 offen offset:1024 sc1 lds
    v_mfma_f32_16x16x32_bf16 v[188:191], v[24:27], v[200:203], v[140:143]
    v_exp_f32 v16, v160
    v_mfma_f32_16x16x32_bf16 v[188:191], v[28:31], v[204:207], v[188:191]
    s_waitcnt lgkmcnt(2)
    v_exp_f32 v17, v161
    v_mfma_f32_16x16x32_bf16 v[112:115], v[32:35], a[192:195], v[128:131]
    ds_read_b128 v[24:27], v2 offset:18560
    v_cvt_f32_i32 v146, v146
    v_mfma_f32_16x16x32_bf16 v[112:115], v[36:39], a[196:199], v[112:115]
    v_exp_f32 v18, v162
    v_mfma_f32_16x16x32_bf16 v[116:119], v[32:35], a[216:219], v[132:135]
    v_add_f32 v5, v5, v16
    v_add_f32 v5, v5, v17
    v_mfma_f32_16x16x32_bf16 v[116:119], v[36:39], a[220:223], v[116:119]
    buffer_load_dwordx4 v4, s[4:7], s27 offen offset:2048 sc1 lds
    v_mfma_f32_16x16x32_bf16 v[120:123], v[32:35], a[240:243], v[136:139]
    ds_read_b128 v[28:31], v3 offset:18560
    v_cvt_f32_i32 v150, v150
    v_mfma_f32_16x16x32_bf16 v[120:123], v[36:39], a[244:247], v[120:123]
    v_exp_f32 v19, v163
    v_mfma_f32_16x16x32_bf16 v[124:127], v[32:35], v[200:203], v[140:143]
    v_cvt_pk_bf16_f32 v160, v16, v17
    v_cvt_f32_i32 v147, v147
    v_mfma_f32_16x16x32_bf16 v[124:127], v[36:39], v[204:207], v[124:127]
    s_waitcnt lgkmcnt(2)
    v_exp_f32 v16, v96
    v_mfma_f32_16x16x32_bf16 v[176:179], v[40:43], a[200:203], v[176:179]
    s_add_u32 s27, s27, 24576
    ds_read_b128 v[32:35], v2 offset:12544
    v_add_f32 v5, v5, v18
    v_mfma_f32_16x16x32_bf16 v[176:179], v[44:47], a[204:207], v[176:179]
    v_add_f32 v5, v5, v19
    v_cvt_f32_i32 v151, v151
    v_mfma_f32_16x16x32_bf16 v[180:183], v[40:43], a[224:227], v[180:183]
    s_add_u32 s56, s56, 12288
    v_exp_f32 v17, v97
    v_mfma_f32_16x16x32_bf16 v[180:183], v[44:47], a[228:231], v[180:183]
    v_cvt_pk_bf16_f32 v161, v18, v19
    v_add_u32 v1, s3, v1
    v_mfma_f32_16x16x32_bf16 v[184:187], v[40:43], a[248:251], v[184:187]
    ds_read_b128 v[36:39], v3 offset:12544
    v_fma_f32 v146, v146, v56, v58
    v_mfma_f32_16x16x32_bf16 v[184:187], v[44:47], a[252:255], v[184:187]
    v_exp_f32 v18, v98
    v_mfma_f32_16x16x32_bf16 v[188:191], v[40:43], v[208:211], v[188:191]
    s_mov_b32 m0, s56
    v_add_f32 v5, v5, v16
    v_add_f32 v5, v5, v17
    v_mfma_f32_16x16x32_bf16 v[188:191], v[44:47], v[212:215], v[188:191]
    s_waitcnt lgkmcnt(2)
    v_exp_f32 v19, v99
    v_mfma_f32_16x16x32_bf16 v[112:115], v[24:27], a[200:203], v[112:115]
    ds_read_b128 v[40:43], v2 offset:18688
    v_fma_f32 v150, v150, v57, v59
    v_mfma_f32_16x16x32_bf16 v[112:115], v[28:31], a[204:207], v[112:115]
    v_cvt_pk_bf16_f32 v162, v16, v17
    v_add_u32 v21, s3, v21
    v_mfma_f32_16x16x32_bf16 v[116:119], v[24:27], a[224:227], v[116:119]
    v_exp_f32 v16, v164
    v_mfma_f32_16x16x32_bf16 v[116:119], v[28:31], a[228:231], v[116:119]
    buffer_load_dwordx4 v4, s[4:7], s27 offen offset:0 sc1 lds
    v_mfma_f32_16x16x32_bf16 v[120:123], v[24:27], a[248:251], v[120:123]
    ds_read_b128 v[44:47], v3 offset:18688
    v_add_u32 v22, s3, v22
    v_mfma_f32_16x16x32_bf16 v[120:123], v[28:31], a[252:255], v[120:123]
    s_waitcnt lgkmcnt(2)
    v_add_f32 v5, v5, v18
    v_add_f32 v5, v5, v19
    v_mfma_f32_16x16x32_bf16 v[124:127], v[24:27], v[208:211], v[124:127]
    s_waitcnt vmcnt(6)
    v_exp_f32 v17, v165
    v_mfma_f32_16x16x32_bf16 v[124:127], v[28:31], v[212:215], v[124:127]
    s_barrier
    v_fma_f32 v147, v147, v56, v58
    v_mfma_f32_16x16x32_bf16 v[176:179], v[32:35], a[208:211], v[176:179]
    ds_read_b128 v[24:27], v1 offset:0
    v_cvt_pk_bf16_f32 v163, v18, v19
    v_mfma_f32_16x16x32_bf16 v[176:179], v[36:39], a[212:215], v[176:179]
    buffer_load_dwordx4 v4, s[4:7], s27 offen offset:1024 sc1 lds
    v_mfma_f32_16x16x32_bf16 v[180:183], v[32:35], a[232:235], v[180:183]
    v_exp_f32 v18, v166
    v_mfma_f32_16x16x32_bf16 v[180:183], v[36:39], a[236:239], v[180:183]
    v_add_f32 v6, v6, v16
    v_add_f32 v6, v6, v17
    v_mfma_f32_16x16x32_bf16 v[184:187], v[32:35], v[192:195], v[184:187]
    ds_read_b128 v[28:31], v1 offset:12288
    v_fma_f32 v151, v151, v57, v59
    v_mfma_f32_16x16x32_bf16 v[184:187], v[36:39], v[196:199], v[184:187]
    v_exp_f32 v19, v167
    v_mfma_f32_16x16x32_bf16 v[188:191], v[32:35], v[216:219], v[188:191]
    ds_read_b128 v[56:59], v23 offset:48
    v_cvt_pk_bf16_f32 v164, v16, v17
    v_mfma_f32_16x16x32_bf16 v[188:191], v[36:39], v[220:223], v[188:191]
    s_waitcnt lgkmcnt(3)
    buffer_load_dwordx4 v4, s[4:7], s27 offen offset:2048 sc1 lds
    v_mfma_f32_16x16x32_bf16 v[112:115], v[40:43], a[208:211], v[112:115]
    s_waitcnt vmcnt(27)
    ds_read_b128 v[32:35], v1 offset:768
    v_cvt_f32_i32 v152, v152
    v_mfma_f32_16x16x32_bf16 v[112:115], v[44:47], a[212:215], v[112:115]
    v_exp_f32 v16, v100
    v_add_f32 v6, v6, v18
    v_mfma_f32_16x16x32_bf16 v[116:119], v[40:43], a[232:235], v[116:119]
    v_add_f32 v6, v6, v19
    v_cvt_f32_i32 v156, v156
    v_mfma_f32_16x16x32_bf16 v[116:119], v[44:47], a[236:239], v[116:119]
    v_exp_f32 v17, v101
    v_mfma_f32_16x16x32_bf16 v[120:123], v[40:43], v[192:195], v[120:123]
    ds_read_b128 v[36:39], v1 offset:13056
    v_cvt_pk_bf16_f32 v165, v18, v19
    v_mfma_f32_16x16x32_bf16 v[120:123], v[44:47], v[196:199], v[120:123]
    v_add_u32 v55, 1, v55
    buffer_store_dword v55, v13, s[20:23], 0 offen sc1
    v_mfma_f32_16x16x32_bf16 v[124:127], v[40:43], v[216:219], v[124:127]
    s_add_u32 s27, s27, 24576
    v_exp_f32 v18, v102
    v_mfma_f32_16x16x32_bf16 v[124:127], v[44:47], v[220:223], v[124:127]
    s_waitcnt lgkmcnt(3)
    v_add_f32 v6, v6, v16
    v_add_f32 v6, v6, v17
    v_exp_f32 v19, v103
    v_cvt_f32_i32 v153, v153
    v_add_u32 v23, 1792, v23
    v_cvt_pk_bf16_f32 v166, v16, v17
    v_cvt_f32_i32 v157, v157
    v_add_f32 v6, v6, v18
    s_add_u32 s56, s56, 36864
    v_fma_f32 v152, v152, v60, v62
    v_add_f32 v6, v6, v19
    s_sub_u32 s58, s56, 147456
    v_fma_f32 v156, v156, v61, v63
    v_cvt_pk_bf16_f32 v167, v18, v19
    s_min_u32 s56, s56, s58
    v_fma_f32 v153, v153, v60, v62
    v_mfma_f32_16x16x32_bf16 a[0:3], v[64:67], v[24:27], a[0:3]
    s_mov_b32 m0, s26
    ds_read_b128 v[40:43], v1 offset:1536
    v_fma_f32 v157, v157, v61, v63
    v_mfma_f32_16x16x32_bf16 a[0:3], v[80:83], v[28:31], a[0:3]
    v_exp_f32 v16, v168
    v_mfma_f32_16x16x32_bf16 a[48:51], v[68:71], v[24:27], a[48:51]
    v_exp_f32 v17, v169
    v_mfma_f32_16x16x32_bf16 a[48:51], v[84:87], v[28:31], a[48:51]
    buffer_load_dwordx4 v4, s[4:7], s32 offen offset:0 sc1 lds
    v_mfma_f32_16x16x32_bf16 a[96:99], v[72:75], v[24:27], a[96:99]
    ds_read_b128 v[44:47], v1 offset:13824
    v_cvt_f32_i32 v154, v154
    v_mfma_f32_16x16x32_bf16 a[96:99], v[88:91], v[28:31], a[96:99]
    v_exp_f32 v18, v170
    v_mfma_f32_16x16x32_bf16 a[144:147], v[76:79], v[24:27], a[144:147]
    v_add_f32 v7, v7, v16
    v_add_f32 v7, v7, v17
    v_mfma_f32_16x16x32_bf16 a[144:147], v[92:95], v[28:31], a[144:147]
    s_waitcnt lgkmcnt(2)
    buffer_load_dwordx4 v4, s[4:7], s32 offen offset:1024 sc1 lds
    v_mfma_f32_16x16x32_bf16 a[4:7], v[64:67], v[32:35], a[4:7]
    ds_read_b128 v[24:27], v1 offset:2304
    v_cvt_f32_i32 v158, v158
    v_mfma_f32_16x16x32_bf16 a[4:7], v[80:83], v[36:39], a[4:7]
    v_exp_f32 v19, v171
    v_mfma_f32_16x16x32_bf16 a[52:55], v[68:71], v[32:35], a[52:55]
    v_cvt_pk_bf16_f32 v168, v16, v17
    v_cvt_f32_i32 v155, v155
    v_mfma_f32_16x16x32_bf16 a[52:55], v[84:87], v[36:39], a[52:55]
    v_exp_f32 v16, v104
    v_mfma_f32_16x16x32_bf16 a[100:103], v[72:75], v[32:35], a[100:103]
    ds_read_b128 v[28:31], v1 offset:14592
    v_add_f32 v7, v7, v18
    v_mfma_f32_16x16x32_bf16 a[100:103], v[88:91], v[36:39], a[100:103]
    buffer_load_dwordx4 v4, s[4:7], s32 offen offset:2048 sc1 lds
    v_mfma_f32_16x16x32_bf16 a[148:151], v[76:79], v[32:35], a[148:151]
    v_add_f32 v7, v7, v19
    v_cvt_f32_i32 v159, v159
    v_mfma_f32_16x16x32_bf16 a[148:151], v[92:95], v[36:39], a[148:151]
    s_waitcnt lgkmcnt(2)
    v_exp_f32 v17, v105
    v_mfma_f32_16x16x32_bf16 a[8:11], v[64:67], v[40:43], a[8:11]
    s_add_u32 s32, s32, 24576
    ds_read_b128 v[32:35], v21 offset:0
    v_cvt_pk_bf16_f32 v169, v18, v19
    v_mfma_f32_16x16x32_bf16 a[8:11], v[80:83], v[44:47], a[8:11]
    v_exp_f32 v18, v106
    v_mfma_f32_16x16x32_bf16 a[56:59], v[68:71], v[40:43], a[56:59]
    v_add_f32 v7, v7, v16
    v_add_f32 v7, v7, v17
    v_mfma_f32_16x16x32_bf16 a[56:59], v[84:87], v[44:47], a[56:59]
    s_add_u32 s26, s26, 12288
    v_fma_f32 v154, v154, v60, v62
    v_fma_f32 v158, v158, v61, v63
    v_mfma_f32_16x16x32_bf16 a[104:107], v[72:75], v[40:43], a[104:107]
    ds_read_b128 v[36:39], v21 offset:12288
    v_fma_f32 v155, v155, v60, v62
    v_mfma_f32_16x16x32_bf16 a[104:107], v[88:91], v[44:47], a[104:107]
    v_exp_f32 v19, v107
    v_mfma_f32_16x16x32_bf16 a[152:155], v[76:79], v[40:43], a[152:155]
    s_mov_b32 m0, s56
    v_cvt_pk_bf16_f32 v170, v16, v17
    v_mfma_f32_16x16x32_bf16 a[152:155], v[92:95], v[44:47], a[152:155]
    s_waitcnt lgkmcnt(2)
    v_exp_f32 v16, v172
    v_mfma_f32_16x16x32_bf16 a[12:15], v[64:67], v[24:27], a[12:15]
    ds_read_b128 v[40:43], v21 offset:768
    v_add_f32 v7, v7, v18
    v_mfma_f32_16x16x32_bf16 a[12:15], v[80:83], v[28:31], a[12:15]
    buffer_load_dwordx4 v4, s[4:7], s27 offen offset:0 sc1 lds
    v_mfma_f32_16x16x32_bf16 a[60:63], v[68:71], v[24:27], a[60:63]
    v_add_f32 v7, v7, v19
    v_fma_f32 v159, v159, v61, v63
    v_mfma_f32_16x16x32_bf16 a[60:63], v[84:87], v[28:31], a[60:63]
    v_exp_f32 v17, v173
    v_mfma_f32_16x16x32_bf16 a[108:111], v[72:75], v[24:27], a[108:111]
    ds_read_b128 v[44:47], v21 offset:13056
    v_cvt_pk_bf16_f32 v171, v18, v19
    v_mfma_f32_16x16x32_bf16 a[108:111], v[88:91], v[28:31], a[108:111]
    v_exp_f32 v18, v174
    v_mfma_f32_16x16x32_bf16 a[156:159], v[76:79], v[24:27], a[156:159]
    s_add_u32 s29, s28, 49152
    v_add_f32 v8, v8, v16
    v_add_f32 v8, v8, v17
    v_mfma_f32_16x16x32_bf16 a[156:159], v[92:95], v[28:31], a[156:159]
    s_waitcnt lgkmcnt(2)
    buffer_load_dwordx4 v4, s[4:7], s27 offen offset:1024 sc1 lds
    v_mfma_f32_16x16x32_bf16 a[16:19], v[64:67], v[32:35], a[16:19]
    ds_read_b128 v[24:27], v21 offset:1536
    v_cvt_pk_bf16_f32 v144, v144, v148
    v_mfma_f32_16x16x32_bf16 a[16:19], v[80:83], v[36:39], a[16:19]
    s_sub_u32 s3, s29, 147456
    v_exp_f32 v19, v175
    v_mfma_f32_16x16x32_bf16 a[64:67], v[68:71], v[32:35], a[64:67]
    v_cvt_pk_bf16_f32 v172, v16, v17
    v_cvt_pk_bf16_f32 v148, v145, v149
    v_mfma_f32_16x16x32_bf16 a[64:67], v[84:87], v[36:39], a[64:67]
    v_exp_f32 v16, v108
    v_mfma_f32_16x16x32_bf16 a[112:115], v[72:75], v[32:35], a[112:115]
    ds_read_b128 v[28:31], v21 offset:13824
    v_add_f32 v8, v8, v18
    v_mfma_f32_16x16x32_bf16 a[112:115], v[88:91], v[36:39], a[112:115]
    buffer_load_dwordx4 v4, s[4:7], s27 offen offset:2048 sc1 lds
    v_mfma_f32_16x16x32_bf16 a[160:163], v[76:79], v[32:35], a[160:163]
    v_add_f32 v8, v8, v19
    v_cvt_pk_bf16_f32 v145, v152, v156
    v_mfma_f32_16x16x32_bf16 a[160:163], v[92:95], v[36:39], a[160:163]
    s_waitcnt lgkmcnt(2)
    v_exp_f32 v17, v109
    v_mfma_f32_16x16x32_bf16 a[20:23], v[64:67], v[40:43], a[20:23]
    s_add_u32 s27, s27, 24576
    ds_read_b128 v[32:35], v21 offset:2304
    v_cvt_pk_bf16_f32 v173, v18, v19
    v_mfma_f32_16x16x32_bf16 a[20:23], v[80:83], v[44:47], a[20:23]
    s_min_u32 s29, s29, s3
    v_exp_f32 v18, v110
    v_mfma_f32_16x16x32_bf16 a[68:71], v[68:71], v[40:43], a[68:71]
    s_add_u32 s56, s56, 12288
    v_add_f32 v8, v8, v16
    v_cvt_pk_bf16_f32 v149, v153, v157
    v_mfma_f32_16x16x32_bf16 a[68:71], v[84:87], v[44:47], a[68:71]
    v_add_f32 v8, v8, v17
    v_cvt_pk_bf16_f32 v152, v146, v150
    v_mfma_f32_16x16x32_bf16 a[116:119], v[72:75], v[40:43], a[116:119]
    ds_read_b128 v[36:39], v21 offset:14592
    v_cvt_pk_bf16_f32 v153, v154, v158
    v_mfma_f32_16x16x32_bf16 a[116:119], v[88:91], v[44:47], a[116:119]
    s_mov_b32 m0, s56
    v_exp_f32 v19, v111
    v_mfma_f32_16x16x32_bf16 a[164:167], v[76:79], v[40:43], a[164:167]
    s_sub_u32 s3, s29, s28
    v_cvt_pk_bf16_f32 v174, v16, v17
    v_add_f32 v8, v8, v18
    v_mfma_f32_16x16x32_bf16 a[164:167], v[92:95], v[44:47], a[164:167]
    s_waitcnt lgkmcnt(2)
    v_add_f32 v8, v8, v19
    v_cvt_pk_bf16_f32 v175, v18, v19
    v_mfma_f32_16x16x32_bf16 a[24:27], v[64:67], v[24:27], a[24:27]
    ds_read_b128 v[40:43], v22 offset:0
    v_cvt_pk_bf16_f32 v156, v147, v151
    v_mfma_f32_16x16x32_bf16 a[24:27], v[80:83], v[28:31], a[24:27]
    buffer_load_dwordx4 v4, s[4:7], s27 offen offset:0 sc1 lds
    v_mfma_f32_16x16x32_bf16 a[72:75], v[68:71], v[24:27], a[72:75]
    v_exp_f32 v16, v176
    v_mfma_f32_16x16x32_bf16 a[72:75], v[84:87], v[28:31], a[72:75]
    v_exp_f32 v17, v177
    v_mfma_f32_16x16x32_bf16 a[120:123], v[72:75], v[24:27], a[120:123]
    ds_read_b128 v[44:47], v22 offset:12288
    v_cvt_pk_bf16_f32 v157, v155, v159
    v_mfma_f32_16x16x32_bf16 a[120:123], v[88:91], v[28:31], a[120:123]
    s_waitcnt vmcnt(26)
    v_exp_f32 v18, v178
    v_mfma_f32_16x16x32_bf16 a[168:171], v[76:79], v[24:27], a[168:171]
    s_mov_b32 s28, s29
    v_add_f32 v5, v5, v16
    v_add_f32 v5, v5, v17
    v_mfma_f32_16x16x32_bf16 a[168:171], v[92:95], v[28:31], a[168:171]
    s_waitcnt lgkmcnt(2)
    buffer_load_dwordx4 v4, s[4:7], s27 offen offset:1024 sc1 lds
    v_mfma_f32_16x16x32_bf16 a[28:31], v[64:67], v[32:35], a[28:31]
    ds_read_b128 v[24:27], v22 offset:768
    v_cvt_f32_i32 v240, v240
    v_mfma_f32_16x16x32_bf16 a[28:31], v[80:83], v[36:39], a[28:31]
    v_exp_f32 v19, v179
    v_mfma_f32_16x16x32_bf16 a[76:79], v[68:71], v[32:35], a[76:79]
    v_cvt_pk_bf16_f32 v176, v16, v17
    v_cvt_f32_i32 v244, v244
    v_mfma_f32_16x16x32_bf16 a[76:79], v[84:87], v[36:39], a[76:79]
    buffer_load_dwordx4 v4, s[4:7], s27 offen offset:2048 sc1 lds
    v_mfma_f32_16x16x32_bf16 a[124:127], v[72:75], v[32:35], a[124:127]
    ds_read_b128 v[28:31], v22 offset:13056
    v_cvt_f32_i32 v241, v241
    v_mfma_f32_16x16x32_bf16 a[124:127], v[88:91], v[36:39], a[124:127]
    v_exp_f32 v16, v112
    v_mfma_f32_16x16x32_bf16 a[172:175], v[76:79], v[32:35], a[172:175]
    v_add_f32 v5, v5, v18
    v_add_f32 v5, v5, v19
    v_mfma_f32_16x16x32_bf16 a[172:175], v[92:95], v[36:39], a[172:175]
    s_waitcnt lgkmcnt(2)
    v_exp_f32 v17, v113
    v_mfma_f32_16x16x32_bf16 a[32:35], v[64:67], v[40:43], a[32:35]
    ds_read_b128 v[32:35], v22 offset:1536
    v_cvt_pk_bf16_f32 v177, v18, v19
    v_mfma_f32_16x16x32_bf16 a[32:35], v[80:83], v[44:47], a[32:35]
    s_add_u32 s27, s27, 24576
    v_exp_f32 v18, v114
    v_mfma_f32_16x16x32_bf16 a[80:83], v[68:71], v[40:43], a[80:83]
    s_add_u32 s56, s56, 36864
    v_add_f32 v5, v5, v16
    v_add_f32 v5, v5, v17
    v_mfma_f32_16x16x32_bf16 a[80:83], v[84:87], v[44:47], a[80:83]
    v_exp_f32 v19, v115
    v_mfma_f32_16x16x32_bf16 a[128:131], v[72:75], v[40:43], a[128:131]
    ds_read_b128 v[36:39], v22 offset:13824
    v_add_u32 v2, s3, v2
    v_mfma_f32_16x16x32_bf16 a[128:131], v[88:91], v[44:47], a[128:131]
    s_sub_u32 s58, s56, 147456
    v_bfe_u32 v53, v4, 4, 6
    v_cvt_pk_bf16_f32 v178, v16, v17
    v_mfma_f32_16x16x32_bf16 a[176:179], v[76:79], v[40:43], a[176:179]
    v_cvt_f32_i32 v245, v245
    v_lshlrev_b32 v53, 2, v53
    v_mfma_f32_16x16x32_bf16 a[176:179], v[92:95], v[44:47], a[176:179]
    s_waitcnt lgkmcnt(2)
    buffer_load_dword v52, v53, s[20:23], 0 offen sc1
    v_mfma_f32_16x16x32_bf16 a[36:39], v[64:67], v[24:27], a[36:39]
    s_min_u32 s56, s56, s58
    ds_read_b128 v[40:43], v22 offset:2304
    v_fma_f32 v240, v240, v48, v50
    v_mfma_f32_16x16x32_bf16 a[36:39], v[80:83], v[28:31], a[36:39]
    v_exp_f32 v16, v180
    v_mfma_f32_16x16x32_bf16 a[84:87], v[68:71], v[24:27], a[84:87]
    v_add_f32 v5, v5, v18
    v_add_f32 v5, v5, v19
    v_mfma_f32_16x16x32_bf16 a[84:87], v[84:87], v[28:31], a[84:87]
    v_exp_f32 v17, v181
    v_mfma_f32_16x16x32_bf16 a[132:135], v[72:75], v[24:27], a[132:135]
    ds_read_b128 v[44:47], v22 offset:14592
    v_add_u32 v3, s3, v3
    v_mfma_f32_16x16x32_bf16 a[132:135], v[88:91], v[28:31], a[132:135]
    s_waitcnt lgkmcnt(2)
    v_cvt_pk_bf16_f32 v179, v18, v19
    v_fma_f32 v244, v244, v49, v51
    v_mfma_f32_16x16x32_bf16 a[180:183], v[76:79], v[24:27], a[180:183]
    s_waitcnt vmcnt(32)
    v_exp_f32 v18, v182
    v_mfma_f32_16x16x32_bf16 a[180:183], v[92:95], v[28:31], a[180:183]
    s_barrier
    v_add_f32 v6, v6, v16
    v_mfma_f32_16x16x32_bf16 a[40:43], v[64:67], v[32:35], a[40:43]
    s_add_u32 s33, s33, 196608
    ds_read_b128 v[24:27], v2 offset:0
    v_add_f32 v6, v6, v17
    v_mfma_f32_16x16x32_bf16 a[40:43], v[80:83], v[36:39], a[40:43]
    s_sub_u32 s34, s33, 1572864
    v_exp_f32 v19, v183
    v_mfma_f32_16x16x32_bf16 a[88:91], v[68:71], v[32:35], a[88:91]
    s_min_u32 s33, s33, s34
    v_cvt_pk_bf16_f32 v180, v16, v17
    v_fma_f32 v241, v241, v48, v50
    v_mfma_f32_16x16x32_bf16 a[88:91], v[84:87], v[36:39], a[88:91]
    s_add_u32 s34, s33, 3072
    v_exp_f32 v16, v116
    v_mfma_f32_16x16x32_bf16 a[136:139], v[72:75], v[32:35], a[136:139]
    s_add_u32 s37, s37, 196608
    ds_read_b128 v[28:31], v3 offset:0
    v_fma_f32 v245, v245, v49, v51
    v_mfma_f32_16x16x32_bf16 a[136:139], v[88:91], v[36:39], a[136:139]
    s_add_u32 s80, s80, 196608
    v_add_f32 v6, v6, v18
    v_add_f32 v6, v6, v19
    v_mfma_f32_16x16x32_bf16 a[184:187], v[76:79], v[32:35], a[184:187]
    v_exp_f32 v17, v117
    v_mfma_f32_16x16x32_bf16 a[184:187], v[92:95], v[36:39], a[184:187]
    s_waitcnt lgkmcnt(2)
    buffer_load_dwordx4 v[224:227], v9, s[64:67], s33 offen offset:0 nt
    v_mfma_f32_16x16x32_bf16 a[44:47], v[64:67], v[40:43], a[44:47]
    ds_read_b128 v[32:35], v2 offset:6144
    v_cvt_pk_bf16_f32 v181, v18, v19
    v_mfma_f32_16x16x32_bf16 a[44:47], v[80:83], v[44:47], a[44:47]
    v_cvt_f32_i32 v242, v242
    v_cvt_f32_i32 v246, v246
    v_mfma_f32_16x16x32_bf16 a[92:95], v[68:71], v[40:43], a[92:95]
    v_exp_f32 v18, v118
    v_mfma_f32_16x16x32_bf16 a[92:95], v[84:87], v[44:47], a[92:95]
    buffer_load_dwordx4 v[228:231], v9, s[64:67], s33 offen offset:1536 nt
    v_mfma_f32_16x16x32_bf16 a[140:143], v[72:75], v[40:43], a[140:143]
    ds_read_b128 v[36:39], v3 offset:6144
    v_add_f32 v6, v6, v16
    v_mfma_f32_16x16x32_bf16 a[140:143], v[88:91], v[44:47], a[140:143]
    v_add_f32 v6, v6, v17
    v_cvt_f32_i32 v243, v243
    v_mfma_f32_16x16x32_bf16 a[188:191], v[76:79], v[40:43], a[188:191]
    buffer_load_dwordx4 v[232:235], v9, s[64:67], s34 offen offset:0 nt
    buffer_load_dwordx4 v[236:239], v9, s[64:67], s34 offen offset:1536 nt
    v_mfma_f32_16x16x32_bf16 a[188:191], v[92:95], v[44:47], a[188:191]
    s_waitcnt lgkmcnt(2)
    v_exp_f32 v19, v119
    v_cvt_pk_bf16_f32 v182, v16, v17
    v_add_f32 v6, v6, v18
    v_add_f32 v6, v6, v19
    v_cvt_f32_i32 v247, v247
    v_cvt_pk_bf16_f32 v183, v18, v19
    v_fma_f32 v242, v242, v48, v50
    v_mfma_f32_16x16x32_bf16 v[64:67], v[24:27], a[192:195], v[128:131]
    s_mov_b32 m0, s26
    ds_read_b128 v[40:43], v2 offset:128
    v_fma_f32 v246, v246, v49, v51
    v_mfma_f32_16x16x32_bf16 v[64:67], v[28:31], a[196:199], v[64:67]
    v_exp_f32 v16, v184
    v_mfma_f32_16x16x32_bf16 v[68:71], v[24:27], a[216:219], v[132:135]
    v_exp_f32 v17, v185
    v_mfma_f32_16x16x32_bf16 v[68:71], v[28:31], a[220:223], v[68:71]
    buffer_load_dwordx4 v4, s[4:7], s32 offen offset:0 sc1 lds
    v_mfma_f32_16x16x32_bf16 v[72:75], v[24:27], a[240:243], v[136:139]
    ds_read_b128 v[44:47], v3 offset:128
    v_fma_f32 v243, v243, v48, v50
    v_mfma_f32_16x16x32_bf16 v[72:75], v[28:31], a[244:247], v[72:75]
    v_exp_f32 v18, v186
    v_mfma_f32_16x16x32_bf16 v[76:79], v[24:27], v[200:203], v[140:143]
    v_add_f32 v7, v7, v16
    v_add_f32 v7, v7, v17
    v_mfma_f32_16x16x32_bf16 v[76:79], v[28:31], v[204:207], v[76:79]
    s_waitcnt lgkmcnt(2)
    v_exp_f32 v19, v187
    v_mfma_f32_16x16x32_bf16 v[96:99], v[32:35], a[192:195], v[128:131]
    ds_read_b128 v[24:27], v2 offset:6272
    v_fma_f32 v247, v247, v49, v51
    v_mfma_f32_16x16x32_bf16 v[96:99], v[36:39], a[196:199], v[96:99]
    ds_read_b128 v[48:51], v10 offset:0
    v_cvt_pk_bf16_f32 v184, v16, v17
    v_mfma_f32_16x16x32_bf16 v[100:103], v[32:35], a[216:219], v[132:135]
    v_exp_f32 v16, v120
    v_mfma_f32_16x16x32_bf16 v[100:103], v[36:39], a[220:223], v[100:103]
    buffer_load_dwordx4 v4, s[4:7], s32 offen offset:1024 sc1 lds
    v_mfma_f32_16x16x32_bf16 v[104:107], v[32:35], a[240:243], v[136:139]
    ds_read_b128 v[28:31], v3 offset:6272
    v_add_f32 v7, v7, v18
    v_mfma_f32_16x16x32_bf16 v[104:107], v[36:39], a[244:247], v[104:107]
    v_add_f32 v7, v7, v19
    v_cvt_pk_bf16_f32 v146, v240, v244
    v_mfma_f32_16x16x32_bf16 v[108:111], v[32:35], v[200:203], v[140:143]
    v_exp_f32 v17, v121
    v_mfma_f32_16x16x32_bf16 v[108:111], v[36:39], v[204:207], v[108:111]
    s_waitcnt lgkmcnt(3)
    v_cvt_pk_bf16_f32 v185, v18, v19
    v_cvt_pk_bf16_f32 v150, v241, v245
    v_mfma_f32_16x16x32_bf16 v[64:67], v[40:43], a[200:203], v[64:67]
    ds_read_b128 v[32:35], v2 offset:256
    v_mfma_f32_16x16x32_bf16 v[64:67], v[44:47], a[204:207], v[64:67]
    buffer_load_dwordx4 v4, s[4:7], s32 offen offset:2048 sc1 lds
    v_mfma_f32_16x16x32_bf16 v[68:71], v[40:43], a[224:227], v[68:71]
    v_exp_f32 v18, v122
    v_mfma_f32_16x16x32_bf16 v[68:71], v[44:47], a[228:231], v[68:71]
    v_add_f32 v7, v7, v16
    v_add_f32 v7, v7, v17
    v_mfma_f32_16x16x32_bf16 v[72:75], v[40:43], a[248:251], v[72:75]
    ds_read_b128 v[36:39], v3 offset:256
    v_cvt_pk_bf16_f32 v154, v242, v246
    v_mfma_f32_16x16x32_bf16 v[72:75], v[44:47], a[252:255], v[72:75]
    v_exp_f32 v19, v123
    v_mfma_f32_16x16x32_bf16 v[76:79], v[40:43], v[208:211], v[76:79]
    v_cvt_pk_bf16_f32 v186, v16, v17
    v_cvt_pk_bf16_f32 v158, v243, v247
    v_mfma_f32_16x16x32_bf16 v[76:79], v[44:47], v[212:215], v[76:79]
    s_waitcnt lgkmcnt(2)
    v_exp_f32 v16, v188
    v_mfma_f32_16x16x32_bf16 v[96:99], v[24:27], a[200:203], v[96:99]
    s_waitcnt vmcnt(24)
    ds_read_b128 v[40:43], v2 offset:6400
    v_add_f32 v7, v7, v18
    v_mfma_f32_16x16x32_bf16 v[96:99], v[28:31], a[204:207], v[96:99]
    s_add_u32 s32, s32, 24576
    v_add_f32 v7, v7, v19
    v_mfma_f32_16x16x32_bf16 v[100:103], v[24:27], a[224:227], v[100:103]
    s_add_u32 s26, s26, 36864
    v_exp_f32 v17, v189
    v_mfma_f32_16x16x32_bf16 v[100:103], v[28:31], a[228:231], v[100:103]
    v_cvt_pk_bf16_f32 v187, v18, v19
    v_mfma_f32_16x16x32_bf16 v[104:107], v[24:27], a[248:251], v[104:107]
    ds_read_b128 v[44:47], v3 offset:6400
    v_cvt_f32_i32 v248, v248
    v_mfma_f32_16x16x32_bf16 v[104:107], v[28:31], a[252:255], v[104:107]
    s_sub_u32 s57, s26, 147456
    v_exp_f32 v18, v190
    v_mfma_f32_16x16x32_bf16 v[108:111], v[24:27], v[208:211], v[108:111]
    s_add_u32 s29, s30, 49152
    v_add_f32 v8, v8, v16
    v_mfma_f32_16x16x32_bf16 v[108:111], v[28:31], v[212:215], v[108:111]
    s_waitcnt lgkmcnt(2)
    buffer_load_dwordx4 v[240:243], v9, s[64:67], s33 offen offset:384 nt
    v_mfma_f32_16x16x32_bf16 v[64:67], v[32:35], a[208:211], v[64:67]
    s_sub_u32 s3, s29, 147456
    ds_read_b128 v[24:27], v2 offset:12288
    v_add_f32 v8, v8, v17
    v_mfma_f32_16x16x32_bf16 v[64:67], v[36:39], a[212:215], v[64:67]
    s_min_u32 s26, s26, s57
    v_exp_f32 v19, v191
    v_mfma_f32_16x16x32_bf16 v[68:71], v[32:35], a[232:235], v[68:71]
    v_cvt_pk_bf16_f32 v188, v16, v17
    v_cvt_f32_i32 v252, v252
    v_mfma_f32_16x16x32_bf16 v[68:71], v[36:39], a[236:239], v[68:71]
    buffer_load_dwordx4 v[244:247], v9, s[64:67], s33 offen offset:1920 nt
    v_mfma_f32_16x16x32_bf16 v[72:75], v[32:35], v[192:195], v[72:75]
    ds_read_b128 v[28:31], v3 offset:12288
    v_cvt_f32_i32 v249, v249
    v_mfma_f32_16x16x32_bf16 v[72:75], v[36:39], v[196:199], v[72:75]
    v_exp_f32 v16, v124
    v_mfma_f32_16x16x32_bf16 v[76:79], v[32:35], v[216:219], v[76:79]
    s_min_u32 s29, s29, s3
    v_add_f32 v8, v8, v18
    v_add_f32 v8, v8, v19
    v_mfma_f32_16x16x32_bf16 v[76:79], v[36:39], v[220:223], v[76:79]
    s_waitcnt lgkmcnt(2)
    v_exp_f32 v17, v125
    v_mfma_f32_16x16x32_bf16 v[96:99], v[40:43], a[208:211], v[96:99]
    ds_read_b128 v[32:35], v2 offset:18432
    v_cvt_f32_i32 v253, v253
    v_mfma_f32_16x16x32_bf16 v[96:99], v[44:47], a[212:215], v[96:99]
    v_cvt_pk_bf16_f32 v189, v18, v19
    v_fma_f32 v248, v248, v56, v58
    v_mfma_f32_16x16x32_bf16 v[100:103], v[40:43], a[232:235], v[100:103]
    v_exp_f32 v18, v126
    v_mfma_f32_16x16x32_bf16 v[100:103], v[44:47], a[236:239], v[100:103]
    v_add_f32 v8, v8, v16
    v_mfma_f32_16x16x32_bf16 v[104:107], v[40:43], v[192:195], v[104:107]
    s_sub_u32 s3, s29, s30
    ds_read_b128 v[36:39], v3 offset:18432
    v_add_f32 v8, v8, v17
    v_mfma_f32_16x16x32_bf16 v[104:107], v[44:47], v[196:199], v[104:107]
    s_waitcnt vmcnt(9)
    v_subrev_u32 v52, s92, v52
    v_cmp_lt_u32 vcc, 15, v52
    v_mfma_f32_16x16x32_bf16 v[108:111], v[40:43], v[216:219], v[108:111]
    v_exp_f32 v19, v127
    v_mfma_f32_16x16x32_bf16 v[108:111], v[44:47], v[220:223], v[108:111]
    s_waitcnt lgkmcnt(2)
    v_cvt_pk_bf16_f32 v190, v16, v17
    v_fma_f32 v252, v252, v57, v59
    v_mfma_f32_16x16x32_bf16 v[80:83], v[24:27], a[192:195], v[128:131]
    s_and_b32 s59, vcc_lo, 0xff
    ds_read_b128 v[40:43], v2 offset:12416
    v_add_f32 v8, v8, v18
    v_mfma_f32_16x16x32_bf16 v[80:83], v[28:31], a[196:199], v[80:83]
    s_cbranch_scc1 L_pollslow2
L_pollok2:
    v_mfma_f32_16x16x32_bf16 v[84:87], v[24:27], a[216:219], v[132:135]
    s_add_u32 s92, s92, 1
    v_add_f32 v8, v8, v19
    v_cvt_pk_bf16_f32 v191, v18, v19
    v_mfma_f32_16x16x32_bf16 v[84:87], v[28:31], a[220:223], v[84:87]
    s_mov_b32 m0, s26
    v_fma_f32 v249, v249, v56, v58
    v_fma_f32 v253, v253, v57, v59
    v_mfma_f32_16x16x32_bf16 v[88:91], v[24:27], a[240:243], v[136:139]
    s_mov_b32 s30, s29
    ds_read_b128 v[44:47], v3 offset:12416
    v_mfma_f32_16x16x32_bf16 v[88:91], v[28:31], a[244:247], v[88:91]
    buffer_load_dwordx4 v4, s[4:7], s32 offen offset:0 sc1 lds
    v_mfma_f32_16x16x32_bf16 v[92:95], v[24:27], v[200:203], v[140:143]
    v_exp_f32 v16, v64
    v_mfma_f32_16x16x32_bf16 v[92:95], v[28:31], v[204:207], v[92:95]
    s_waitcnt lgkmcnt(2)
    v_exp_f32 v17, v65
    v_mfma_f32_16x16x32_bf16 v[112:115], v[32:35], a[192:195], v[128:131]
    ds_read_b128 v[24:27], v2 offset:18560
    v_cvt_f32_i32 v250, v250
    v_mfma_f32_16x16x32_bf16 v[112:115], v[36:39], a[196:199], v[112:115]
    v_exp_f32 v18, v66
    v_mfma_f32_16x16x32_bf16 v[116:119], v[32:35], a[216:219], v[132:135]
    v_add_f32 v5, v5, v16
    v_add_f32 v5, v5, v17
    v_mfma_f32_16x16x32_bf16 v[116:119], v[36:39], a[220:223], v[116:119]
    buffer_load_dwordx4 v4, s[4:7], s32 offen offset:1024 sc1 lds
    v_mfma_f32_16x16x32_bf16 v[120:123], v[32:35], a[240:243], v[136:139]
    ds_read_b128 v[28:31], v3 offset:18560
    v_cvt_f32_i32 v254, v254
    v_mfma_f32_16x16x32_bf16 v[120:123], v[36:39], a[244:247], v[120:123]
    v_exp_f32 v19, v67
    v_mfma_f32_16x16x32_bf16 v[124:127], v[32:35], v[200:203], v[140:143]
    v_cvt_pk_bf16_f32 v64, v16, v17
    v_add_u32 v1, s3, v1
    v_mfma_f32_16x16x32_bf16 v[124:127], v[36:39], v[204:207], v[124:127]
    s_waitcnt lgkmcnt(2)
    v_exp_f32 v16, v96
    v_mfma_f32_16x16x32_bf16 v[80:83], v[40:43], a[200:203], v[80:83]
    ds_read_b128 v[32:35], v2 offset:12544
    v_add_f32 v5, v5, v18
    v_mfma_f32_16x16x32_bf16 v[80:83], v[44:47], a[204:207], v[80:83]
    buffer_load_dwordx4 v4, s[4:7], s32 offen offset:2048 sc1 lds
    v_mfma_f32_16x16x32_bf16 v[84:87], v[40:43], a[224:227], v[84:87]
    v_add_f32 v5, v5, v19
    v_cvt_f32_i32 v251, v251
    v_mfma_f32_16x16x32_bf16 v[84:87], v[44:47], a[228:231], v[84:87]
    v_exp_f32 v17, v97
    v_mfma_f32_16x16x32_bf16 v[88:91], v[40:43], a[248:251], v[88:91]
    s_add_u32 s32, s32, 24576
    ds_read_b128 v[36:39], v3 offset:12544
    v_cvt_pk_bf16_f32 v65, v18, v19
    v_mfma_f32_16x16x32_bf16 v[88:91], v[44:47], a[252:255], v[88:91]
    v_exp_f32 v18, v98
    v_mfma_f32_16x16x32_bf16 v[92:95], v[40:43], v[208:211], v[92:95]
    s_add_u32 s26, s26, 12288
    v_add_f32 v5, v5, v16
    v_add_f32 v5, v5, v17
    v_mfma_f32_16x16x32_bf16 v[92:95], v[44:47], v[212:215], v[92:95]
    s_waitcnt lgkmcnt(2)
    v_exp_f32 v19, v99
    v_mfma_f32_16x16x32_bf16 v[112:115], v[24:27], a[200:203], v[112:115]
    ds_read_b128 v[40:43], v2 offset:18688
    v_add_u32 v21, s3, v21
    v_mfma_f32_16x16x32_bf16 v[112:115], v[28:31], a[204:207], v[112:115]
    s_mov_b32 m0, s26
    v_cvt_pk_bf16_f32 v66, v16, v17
    v_cvt_f32_i32 v255, v255
    v_mfma_f32_16x16x32_bf16 v[116:119], v[24:27], a[224:227], v[116:119]
    v_exp_f32 v16, v68
    v_mfma_f32_16x16x32_bf16 v[116:119], v[28:31], a[228:231], v[116:119]
    v_add_f32 v5, v5, v18
    v_add_u32 v22, s3, v22
    v_mfma_f32_16x16x32_bf16 v[120:123], v[24:27], a[248:251], v[120:123]
    ds_read_b128 v[44:47], v3 offset:18688
    v_add_f32 v5, v5, v19
    v_mfma_f32_16x16x32_bf16 v[120:123], v[28:31], a[252:255], v[120:123]
    s_waitcnt lgkmcnt(2)
    buffer_load_dwordx4 v4, s[4:7], s32 offen offset:0 sc1 lds
    v_mfma_f32_16x16x32_bf16 v[124:127], v[24:27], v[208:211], v[124:127]
    s_waitcnt vmcnt(24)
    v_exp_f32 v17, v69
    v_mfma_f32_16x16x32_bf16 v[124:127], v[28:31], v[212:215], v[124:127]
    s_barrier
    v_cvt_pk_bf16_f32 v67, v18, v19
    v_mfma_f32_16x16x32_bf16 v[80:83], v[32:35], a[208:211], v[80:83]
    ds_read_b128 v[24:27], v1 offset:0
    v_fma_f32 v250, v250, v56, v58
    v_mfma_f32_16x16x32_bf16 v[80:83], v[36:39], a[212:215], v[80:83]
    v_exp_f32 v18, v70
    v_mfma_f32_16x16x32_bf16 v[84:87], v[32:35], a[232:235], v[84:87]
    v_add_f32 v6, v6, v16
    v_add_f32 v6, v6, v17
    v_mfma_f32_16x16x32_bf16 v[84:87], v[36:39], a[236:239], v[84:87]
    buffer_load_dwordx4 v4, s[4:7], s32 offen offset:1024 sc1 lds
    v_mfma_f32_16x16x32_bf16 v[88:91], v[32:35], v[192:195], v[88:91]
    ds_read_b128 v[28:31], v1 offset:12288
    v_fma_f32 v254, v254, v57, v59
    v_mfma_f32_16x16x32_bf16 v[88:91], v[36:39], v[196:199], v[88:91]
    v_exp_f32 v19, v71
    v_mfma_f32_16x16x32_bf16 v[92:95], v[32:35], v[216:219], v[92:95]
    v_cvt_pk_bf16_f32 v68, v16, v17
    v_fma_f32 v251, v251, v56, v58
    v_mfma_f32_16x16x32_bf16 v[92:95], v[36:39], v[220:223], v[92:95]
    s_waitcnt lgkmcnt(2)
    buffer_load_dwordx4 v4, s[4:7], s32 offen offset:2048 sc1 lds
    v_mfma_f32_16x16x32_bf16 v[112:115], v[40:43], a[208:211], v[112:115]
    ds_read_b128 v[32:35], v1 offset:768
    v_fma_f32 v255, v255, v57, v59
    v_mfma_f32_16x16x32_bf16 v[112:115], v[44:47], a[212:215], v[112:115]
    v_exp_f32 v16, v100
    v_add_f32 v6, v6, v18
    v_mfma_f32_16x16x32_bf16 v[116:119], v[40:43], a[232:235], v[116:119]
    v_add_f32 v6, v6, v19
    v_cvt_pk_bf16_f32 v147, v248, v252
    v_mfma_f32_16x16x32_bf16 v[116:119], v[44:47], a[236:239], v[116:119]
    v_exp_f32 v17, v101
    v_mfma_f32_16x16x32_bf16 v[120:123], v[40:43], v[192:195], v[120:123]
    ds_read_b128 v[36:39], v1 offset:13056
    v_cvt_pk_bf16_f32 v69, v18, v19
    v_mfma_f32_16x16x32_bf16 v[120:123], v[44:47], v[196:199], v[120:123]
    s_add_u32 s32, s32, 24576
    v_exp_f32 v18, v102
    v_mfma_f32_16x16x32_bf16 v[124:127], v[40:43], v[216:219], v[124:127]
    s_add_u32 s26, s26, 36864
    v_add_f32 v6, v6, v16
    v_add_f32 v6, v6, v17
    v_mfma_f32_16x16x32_bf16 v[124:127], v[44:47], v[220:223], v[124:127]
    s_waitcnt lgkmcnt(2)
    v_exp_f32 v19, v103
    v_cvt_pk_bf16_f32 v70, v16, v17
    v_add_f32 v6, v6, v18
    v_cvt_pk_bf16_f32 v151, v249, v253
    v_add_f32 v6, v6, v19
    s_sub_u32 s57, s26, 147456
    v_cvt_pk_bf16_f32 v155, v250, v254
    v_cvt_pk_bf16_f32 v71, v18, v19
    s_min_u32 s26, s26, s57
    v_cvt_pk_bf16_f32 v159, v251, v255
    v_mfma_f32_16x16x32_bf16 a[0:3], v[160:163], v[24:27], a[0:3]
    ds_read_b128 v[40:43], v1 offset:1536
    v_mfma_f32_16x16x32_bf16 a[0:3], v[176:179], v[28:31], a[0:3]
    buffer_store_dwordx4 v[144:147], v20, s[4:7], s81 offen offset:0 sc1
    v_mfma_f32_16x16x32_bf16 a[48:51], v[164:167], v[24:27], a[48:51]
    v_exp_f32 v16, v72
    v_mfma_f32_16x16x32_bf16 a[48:51], v[180:183], v[28:31], a[48:51]
    v_exp_f32 v17, v73
    v_mfma_f32_16x16x32_bf16 a[96:99], v[168:171], v[24:27], a[96:99]
    ds_read_b128 v[44:47], v1 offset:13824
    v_mfma_f32_16x16x32_bf16 a[96:99], v[184:187], v[28:31], a[96:99]
    v_exp_f32 v18, v74
    v_mfma_f32_16x16x32_bf16 a[144:147], v[172:175], v[24:27], a[144:147]
    v_add_f32 v7, v7, v16
    v_add_f32 v7, v7, v17
    v_mfma_f32_16x16x32_bf16 a[144:147], v[188:191], v[28:31], a[144:147]
    s_waitcnt lgkmcnt(2)
    v_exp_f32 v19, v75
    v_mfma_f32_16x16x32_bf16 a[4:7], v[160:163], v[32:35], a[4:7]
    ds_read_b128 v[24:27], v1 offset:2304
    v_cvt_pk_bf16_f32 v72, v16, v17
    v_mfma_f32_16x16x32_bf16 a[4:7], v[176:179], v[36:39], a[4:7]
    buffer_store_dwordx4 v[148:151], v20, s[4:7], s81 offen offset:768 sc1
    v_mfma_f32_16x16x32_bf16 a[52:55], v[164:167], v[32:35], a[52:55]
    v_exp_f32 v16, v104
    v_mfma_f32_16x16x32_bf16 a[52:55], v[180:183], v[36:39], a[52:55]
    v_add_f32 v7, v7, v18
    v_add_f32 v7, v7, v19
    v_mfma_f32_16x16x32_bf16 a[100:103], v[168:171], v[32:35], a[100:103]
    ds_read_b128 v[28:31], v1 offset:14592
    v_mfma_f32_16x16x32_bf16 a[100:103], v[184:187], v[36:39], a[100:103]
    v_exp_f32 v17, v105
    v_mfma_f32_16x16x32_bf16 a[148:151], v[172:175], v[32:35], a[148:151]
    v_cvt_pk_bf16_f32 v73, v18, v19
    v_mfma_f32_16x16x32_bf16 a[148:151], v[188:191], v[36:39], a[148:151]
    s_waitcnt lgkmcnt(2)
    v_exp_f32 v18, v106
    v_mfma_f32_16x16x32_bf16 a[8:11], v[160:163], v[40:43], a[8:11]
    ds_read_b128 v[32:35], v21 offset:0
    v_add_f32 v7, v7, v16
    v_mfma_f32_16x16x32_bf16 a[8:11], v[176:179], v[44:47], a[8:11]
    buffer_store_dwordx4 v[152:155], v20, s[4:7], s81 offen offset:1536 sc1
    v_mfma_f32_16x16x32_bf16 a[56:59], v[164:167], v[40:43], a[56:59]
    v_add_f32 v7, v7, v17
    v_mfma_f32_16x16x32_bf16 a[56:59], v[180:183], v[44:47], a[56:59]
    v_exp_f32 v19, v107
    v_mfma_f32_16x16x32_bf16 a[104:107], v[168:171], v[40:43], a[104:107]
    ds_read_b128 v[36:39], v21 offset:12288
    v_cvt_pk_bf16_f32 v74, v16, v17
    v_mfma_f32_16x16x32_bf16 a[104:107], v[184:187], v[44:47], a[104:107]
    v_exp_f32 v16, v76
    v_mfma_f32_16x16x32_bf16 a[152:155], v[172:175], v[40:43], a[152:155]
    v_add_f32 v7, v7, v18
    v_mfma_f32_16x16x32_bf16 a[152:155], v[188:191], v[44:47], a[152:155]
    s_waitcnt lgkmcnt(2)
    v_add_f32 v7, v7, v19
    v_mfma_f32_16x16x32_bf16 a[12:15], v[160:163], v[24:27], a[12:15]
    ds_read_b128 v[40:43], v21 offset:768
    v_mfma_f32_16x16x32_bf16 a[12:15], v[176:179], v[28:31], a[12:15]
    buffer_store_dwordx4 v[156:159], v20, s[4:7], s81 offen offset:2304 sc1
    v_mfma_f32_16x16x32_bf16 a[60:63], v[164:167], v[24:27], a[60:63]
    v_exp_f32 v17, v77
    v_mfma_f32_16x16x32_bf16 a[60:63], v[180:183], v[28:31], a[60:63]
    v_cvt_pk_bf16_f32 v75, v18, v19
    v_mfma_f32_16x16x32_bf16 a[108:111], v[168:171], v[24:27], a[108:111]
    ds_read_b128 v[44:47], v21 offset:13056
    v_mfma_f32_16x16x32_bf16 a[108:111], v[184:187], v[28:31], a[108:111]
    v_exp_f32 v18, v78
    v_mfma_f32_16x16x32_bf16 a[156:159], v[172:175], v[24:27], a[156:159]
    s_add_u32 s29, s28, 49152
    v_add_f32 v8, v8, v16
    v_add_f32 v8, v8, v17
    v_mfma_f32_16x16x32_bf16 a[156:159], v[188:191], v[28:31], a[156:159]
    s_waitcnt lgkmcnt(2)
    v_exp_f32 v19, v79
    v_mfma_f32_16x16x32_bf16 a[16:19], v[160:163], v[32:35], a[16:19]
    ds_read_b128 v[24:27], v21 offset:1536
    v_cvt_pk_bf16_f32 v76, v16, v17
    v_mfma_f32_16x16x32_bf16 a[16:19], v[176:179], v[36:39], a[16:19]
    s_sub_u32 s3, s29, 147456
    buffer_load_dwordx4 v[248:251], v9, s[64:67], s34 offen offset:384 nt
    v_mfma_f32_16x16x32_bf16 a[64:67], v[164:167], v[32:35], a[64:67]
    v_exp_f32 v16, v108
    v_mfma_f32_16x16x32_bf16 a[64:67], v[180:183], v[36:39], a[64:67]
    ds_read_b128 v[56:59], v10 offset:384
    s_waitcnt vmcnt(18)
    v_mfma_f32_16x16x32_bf16 a[112:115], v[168:171], v[32:35], a[112:115]
    ds_read_b128 v[28:31], v21 offset:13824
    v_add_f32 v8, v8, v18
    v_mfma_f32_16x16x32_bf16 a[112:115], v[184:187], v[36:39], a[112:115]
    buffer_load_dwordx4 v[252:255], v9, s[64:67], s34 offen offset:1920 nt
    v_mfma_f32_16x16x32_bf16 a[160:163], v[172:175], v[32:35], a[160:163]
    v_add_f32 v8, v8, v19
    v_cvt_f32_i32 v224, v224
    v_mfma_f32_16x16x32_bf16 a[160:163], v[188:191], v[36:39], a[160:163]
    s_waitcnt lgkmcnt(3)
    v_exp_f32 v17, v109
    v_mfma_f32_16x16x32_bf16 a[20:23], v[160:163], v[40:43], a[20:23]
    s_min_u32 s29, s29, s3
    ds_read_b128 v[32:35], v21 offset:2304
    v_cvt_pk_bf16_f32 v77, v18, v19
    v_mfma_f32_16x16x32_bf16 a[20:23], v[176:179], v[44:47], a[20:23]
    v_exp_f32 v18, v110
    v_mfma_f32_16x16x32_bf16 a[68:71], v[164:167], v[40:43], a[68:71]
    s_mov_b32 m0, s56
    v_add_f32 v8, v8, v16
    v_cvt_f32_i32 v225, v225
    v_mfma_f32_16x16x32_bf16 a[68:71], v[180:183], v[44:47], a[68:71]
    v_add_f32 v8, v8, v17
    v_cvt_f32_i32 v228, v228
    v_mfma_f32_16x16x32_bf16 a[116:119], v[168:171], v[40:43], a[116:119]
    ds_read_b128 v[36:39], v21 offset:14592
    v_mfma_f32_16x16x32_bf16 a[116:119], v[184:187], v[44:47], a[116:119]
    buffer_load_dwordx4 v4, s[4:7], s27 offen offset:0 sc1 lds
    v_mfma_f32_16x16x32_bf16 a[164:167], v[172:175], v[40:43], a[164:167]
    s_sub_u32 s3, s29, s28
    v_exp_f32 v19, v111
    v_mfma_f32_16x16x32_bf16 a[164:167], v[188:191], v[44:47], a[164:167]
    s_waitcnt lgkmcnt(2)
    v_cvt_pk_bf16_f32 v78, v16, v17
    v_add_f32 v8, v8, v18
    v_mfma_f32_16x16x32_bf16 a[24:27], v[160:163], v[24:27], a[24:27]
    ds_read_b128 v[40:43], v22 offset:0
    v_add_f32 v8, v8, v19
    v_mfma_f32_16x16x32_bf16 a[24:27], v[176:179], v[28:31], a[24:27]
    buffer_load_dwordx4 v4, s[4:7], s27 offen offset:1024 sc1 lds
    v_mfma_f32_16x16x32_bf16 a[72:75], v[164:167], v[24:27], a[72:75]
    ds_read_b128 v[60:63], v10 offset:768
    v_cvt_pk_bf16_f32 v79, v18, v19
    v_mfma_f32_16x16x32_bf16 a[72:75], v[180:183], v[28:31], a[72:75]
    v_exp_f32 v16, v80
    v_mfma_f32_16x16x32_bf16 a[120:123], v[168:171], v[24:27], a[120:123]
    ds_read_b128 v[44:47], v22 offset:12288
    v_cvt_f32_i32 v229, v229
    v_mfma_f32_16x16x32_bf16 a[120:123], v[184:187], v[28:31], a[120:123]
    s_mov_b32 s28, s29
    buffer_load_dwordx4 v4, s[4:7], s27 offen offset:2048 sc1 lds
    v_mfma_f32_16x16x32_bf16 a[168:171], v[172:175], v[24:27], a[168:171]
    v_exp_f32 v17, v81
    v_mfma_f32_16x16x32_bf16 a[168:171], v[188:191], v[28:31], a[168:171]
    s_waitcnt lgkmcnt(3)
    v_exp_f32 v18, v82
    v_mfma_f32_16x16x32_bf16 a[28:31], v[160:163], v[32:35], a[28:31]
    s_add_u32 s27, s27, 24576
    ds_read_b128 v[24:27], v22 offset:768
    v_add_f32 v5, v5, v16
    v_mfma_f32_16x16x32_bf16 a[28:31], v[176:179], v[36:39], a[28:31]
    v_add_f32 v5, v5, v17
    v_fma_f32 v224, v224, v48, v50
    v_mfma_f32_16x16x32_bf16 a[76:79], v[164:167], v[32:35], a[76:79]
    s_add_u32 s56, s56, 12288
    v_exp_f32 v19, v83
    v_mfma_f32_16x16x32_bf16 a[76:79], v[180:183], v[36:39], a[76:79]
    v_cvt_pk_bf16_f32 v80, v16, v17
    v_fma_f32 v225, v225, v49, v51
    v_mfma_f32_16x16x32_bf16 a[124:127], v[168:171], v[32:35], a[124:127]
    s_mov_b32 m0, s56
    ds_read_b128 v[28:31], v22 offset:13056
    v_fma_f32 v228, v228, v48, v50
    v_mfma_f32_16x16x32_bf16 a[124:127], v[184:187], v[36:39], a[124:127]
    v_exp_f32 v16, v112
    v_mfma_f32_16x16x32_bf16 a[172:175], v[172:175], v[32:35], a[172:175]
    v_add_f32 v5, v5, v18
    v_add_f32 v5, v5, v19
    v_mfma_f32_16x16x32_bf16 a[172:175], v[188:191], v[36:39], a[172:175]
    s_waitcnt lgkmcnt(2)
    buffer_load_dwordx4 v4, s[4:7], s27 offen offset:0 sc1 lds
    v_mfma_f32_16x16x32_bf16 a[32:35], v[160:163], v[40:43], a[32:35]
    ds_read_b128 v[32:35], v22 offset:1536
    v_fma_f32 v229, v229, v49, v51
    v_mfma_f32_16x16x32_bf16 a[32:35], v[176:179], v[44:47], a[32:35]
    v_exp_f32 v17, v113
    v_mfma_f32_16x16x32_bf16 a[80:83], v[164:167], v[40:43], a[80:83]
    v_cvt_pk_bf16_f32 v81, v18, v19
    v_cvt_pk_bf16_f32 v224, v224, v225
    v_mfma_f32_16x16x32_bf16 a[80:83], v[180:183], v[44:47], a[80:83]
    v_exp_f32 v18, v114
    v_mfma_f32_16x16x32_bf16 a[128:131], v[168:171], v[40:43], a[128:131]
    ds_read_b128 v[36:39], v22 offset:13824
    v_add_f32 v5, v5, v16
    v_mfma_f32_16x16x32_bf16 a[128:131], v[184:187], v[44:47], a[128:131]
    buffer_load_dwordx4 v4, s[4:7], s27 offen offset:1024 sc1 lds
    v_mfma_f32_16x16x32_bf16 a[176:179], v[172:175], v[40:43], a[176:179]
    v_add_f32 v5, v5, v17
    v_cvt_pk_bf16_f32 v228, v228, v229
    v_mfma_f32_16x16x32_bf16 a[176:179], v[188:191], v[44:47], a[176:179]
    s_waitcnt lgkmcnt(2)
    v_exp_f32 v19, v115
    v_mfma_f32_16x16x32_bf16 a[36:39], v[160:163], v[24:27], a[36:39]
    ds_read_b128 v[40:43], v22 offset:2304
    v_cvt_pk_bf16_f32 v82, v16, v17
    v_mfma_f32_16x16x32_bf16 a[36:39], v[176:179], v[28:31], a[36:39]
    buffer_load_dwordx4 v4, s[4:7], s27 offen offset:2048 sc1 lds
    v_mfma_f32_16x16x32_bf16 a[84:87], v[164:167], v[24:27], a[84:87]
    v_exp_f32 v16, v84
    v_mfma_f32_16x16x32_bf16 a[84:87], v[180:183], v[28:31], a[84:87]
    v_add_u32 v2, s3, v2
    v_add_f32 v5, v5, v18
    v_mfma_f32_16x16x32_bf16 a[132:135], v[168:171], v[24:27], a[132:135]
    ds_read_b128 v[44:47], v22 offset:14592
    v_add_u32 v3, s3, v3
    v_mfma_f32_16x16x32_bf16 a[132:135], v[184:187], v[28:31], a[132:135]
    s_waitcnt lgkmcnt(2)
    v_add_f32 v5, v5, v19
    v_cvt_f32_i32 v226, v226
    v_mfma_f32_16x16x32_bf16 a[180:183], v[172:175], v[24:27], a[180:183]
    s_waitcnt vmcnt(8)
    v_exp_f32 v17, v85
    v_mfma_f32_16x16x32_bf16 a[180:183], v[188:191], v[28:31], a[180:183]
    s_barrier
    v_cvt_pk_bf16_f32 v83, v18, v19
    v_mfma_f32_16x16x32_bf16 a[40:43], v[160:163], v[32:35], a[40:43]
    s_add_u32 s27, s27, 24576
    ds_read_b128 v[24:27], v2 offset:0
    v_cvt_f32_i32 v227, v227
    v_mfma_f32_16x16x32_bf16 a[40:43], v[176:179], v[36:39], a[40:43]
    s_add_u32 s56, s56, 36864
    v_exp_f32 v18, v86
    v_mfma_f32_16x16x32_bf16 a[88:91], v[164:167], v[32:35], a[88:91]
    s_sub_u32 s58, s56, 147456
    v_add_f32 v6, v6, v16
    v_add_f32 v6, v6, v17
    v_mfma_f32_16x16x32_bf16 a[88:91], v[180:183], v[36:39], a[88:91]
    v_exp_f32 v19, v87
    v_mfma_f32_16x16x32_bf16 a[136:139], v[168:171], v[32:35], a[136:139]
    s_min_u32 s56, s56, s58
    ds_read_b128 v[28:31], v3 offset:0
    v_cvt_pk_bf16_f32 v84, v16, v17
    v_mfma_f32_16x16x32_bf16 a[136:139], v[184:187], v[36:39], a[136:139]
    v_exp_f32 v16, v116
    v_mfma_f32_16x16x32_bf16 a[184:187], v[172:175], v[32:35], a[184:187]
    v_cvt_f32_i32 v230, v230
    v_add_f32 v6, v6, v18
    v_mfma_f32_16x16x32_bf16 a[184:187], v[188:191], v[36:39], a[184:187]
    s_waitcnt lgkmcnt(2)
    v_add_f32 v6, v6, v19
    v_cvt_f32_i32 v231, v231
    v_mfma_f32_16x16x32_bf16 a[44:47], v[160:163], v[40:43], a[44:47]
    ds_read_b128 v[32:35], v2 offset:6144
    v_fma_f32 v226, v226, v56, v58
    v_mfma_f32_16x16x32_bf16 a[44:47], v[176:179], v[44:47], a[44:47]
    v_exp_f32 v17, v117
    v_mfma_f32_16x16x32_bf16 a[92:95], v[164:167], v[40:43], a[92:95]
    v_cvt_pk_bf16_f32 v85, v18, v19
    v_fma_f32 v227, v227, v57, v59
    v_mfma_f32_16x16x32_bf16 a[92:95], v[180:183], v[44:47], a[92:95]
    v_exp_f32 v18, v118
    v_mfma_f32_16x16x32_bf16 a[140:143], v[168:171], v[40:43], a[140:143]
    ds_read_b128 v[36:39], v3 offset:6144
    v_add_f32 v6, v6, v16
    v_mfma_f32_16x16x32_bf16 a[140:143], v[184:187], v[44:47], a[140:143]
    v_add_u32 v55, 1, v55
    buffer_store_dword v55, v13, s[20:23], 0 offen sc1
    v_mfma_f32_16x16x32_bf16 a[188:191], v[172:175], v[40:43], a[188:191]
    v_add_f32 v6, v6, v17
    v_fma_f32 v230, v230, v56, v58
    v_mfma_f32_16x16x32_bf16 a[188:191], v[188:191], v[44:47], a[188:191]
    s_waitcnt lgkmcnt(2)
    v_exp_f32 v19, v119
    v_cvt_pk_bf16_f32 v86, v16, v17
    v_add_f32 v6, v6, v18
    v_fma_f32 v231, v231, v57, v59
    v_add_f32 v6, v6, v19
    v_cvt_pk_bf16_f32 v225, v226, v227
    v_cvt_pk_bf16_f32 v87, v18, v19
    v_cvt_pk_bf16_f32 v229, v230, v231
    v_mfma_f32_16x16x32_bf16 v[160:163], v[24:27], a[192:195], v[128:131]
    ds_read_b128 v[40:43], v2 offset:128
    s_add_u32 s35, s35, 196608
    v_mfma_f32_16x16x32_bf16 v[160:163], v[28:31], a[196:199], v[160:163]
    s_waitcnt vmcnt(24)
    v_exp_f32 v16, v88
    v_mfma_f32_16x16x32_bf16 v[164:167], v[24:27], a[216:219], v[132:135]
    s_sub_u32 s36, s35, 1572864
    v_exp_f32 v17, v89
    v_mfma_f32_16x16x32_bf16 v[164:167], v[28:31], a[220:223], v[164:167]
    s_min_u32 s35, s35, s36
    v_exp_f32 v18, v90
    v_mfma_f32_16x16x32_bf16 v[168:171], v[24:27], a[240:243], v[136:139]
    ds_read_b128 v[44:47], v3 offset:128
    v_cvt_f32_i32 v232, v232
    v_mfma_f32_16x16x32_bf16 v[168:171], v[28:31], a[244:247], v[168:171]
    s_add_u32 s36, s35, 3072
    v_add_f32 v7, v7, v16
    v_cvt_f32_i32 v233, v233
    v_mfma_f32_16x16x32_bf16 v[172:175], v[24:27], v[200:203], v[140:143]
    v_add_f32 v7, v7, v17
    v_mfma_f32_16x16x32_bf16 v[172:175], v[28:31], v[204:207], v[172:175]
    s_waitcnt lgkmcnt(2)
    v_exp_f32 v19, v91
    v_mfma_f32_16x16x32_bf16 v[96:99], v[32:35], a[192:195], v[128:131]
    s_add_u32 s81, s81, 196608
    ds_read_b128 v[24:27], v2 offset:6272
    v_cvt_f32_i32 v236, v236
    v_mfma_f32_16x16x32_bf16 v[96:99], v[36:39], a[196:199], v[96:99]
    v_cvt_pk_bf16_f32 v88, v16, v17
    v_mfma_f32_16x16x32_bf16 v[100:103], v[32:35], a[216:219], v[132:135]
    v_exp_f32 v16, v120
    v_mfma_f32_16x16x32_bf16 v[100:103], v[36:39], a[220:223], v[100:103]
    buffer_load_dwordx4 v[144:147], v12, s[68:71], s35 offen offset:0 nt
    v_mfma_f32_16x16x32_bf16 v[104:107], v[32:35], a[240:243], v[136:139]
    ds_read_b128 v[28:31], v3 offset:6272
    v_add_f32 v7, v7, v18
    v_mfma_f32_16x16x32_bf16 v[104:107], v[36:39], a[244:247], v[104:107]
    v_add_f32 v7, v7, v19
    v_cvt_f32_i32 v237, v237
    v_mfma_f32_16x16x32_bf16 v[108:111], v[32:35], v[200:203], v[140:143]
    v_exp_f32 v17, v121
    v_mfma_f32_16x16x32_bf16 v[108:111], v[36:39], v[204:207], v[108:111]
    s_waitcnt lgkmcnt(2)
    v_cvt_pk_bf16_f32 v89, v18, v19
    v_fma_f32 v232, v232, v48, v50
    v_mfma_f32_16x16x32_bf16 v[160:163], v[40:43], a[200:203], v[160:163]
    ds_read_b128 v[32:35], v2 offset:256
    v_fma_f32 v233, v233, v49, v51
    v_mfma_f32_16x16x32_bf16 v[160:163], v[44:47], a[204:207], v[160:163]
    buffer_load_dwordx4 v[148:151], v12, s[68:71], s35 offen offset:768 nt
    v_mfma_f32_16x16x32_bf16 v[164:167], v[40:43], a[224:227], v[164:167]
    v_exp_f32 v18, v122
    v_mfma_f32_16x16x32_bf16 v[164:167], v[44:47], a[228:231], v[164:167]
    v_add_f32 v7, v7, v16
    v_add_f32 v7, v7, v17
    v_mfma_f32_16x16x32_bf16 v[168:171], v[40:43], a[248:251], v[168:171]
    ds_read_b128 v[36:39], v3 offset:256
    v_fma_f32 v236, v236, v48, v50
    v_mfma_f32_16x16x32_bf16 v[168:171], v[44:47], a[252:255], v[168:171]
    buffer_load_dwordx4 v[152:155], v12, s[68:71], s35 offen offset:1536 nt
    v_mfma_f32_16x16x32_bf16 v[172:175], v[40:43], v[208:211], v[172:175]
    v_exp_f32 v19, v123
    v_mfma_f32_16x16x32_bf16 v[172:175], v[44:47], v[212:215], v[172:175]
    s_waitcnt lgkmcnt(2)
    v_cvt_pk_bf16_f32 v90, v16, v17
    v_fma_f32 v237, v237, v49, v51
    v_mfma_f32_16x16x32_bf16 v[96:99], v[24:27], a[200:203], v[96:99]
    ds_read_b128 v[40:43], v2 offset:6400
    v_mfma_f32_16x16x32_bf16 v[96:99], v[28:31], a[204:207], v[96:99]
    v_exp_f32 v16, v92
    v_mfma_f32_16x16x32_bf16 v[100:103], v[24:27], a[224:227], v[100:103]
    v_add_f32 v7, v7, v18
    v_add_f32 v7, v7, v19
    v_mfma_f32_16x16x32_bf16 v[100:103], v[28:31], a[228:231], v[100:103]
    buffer_load_dwordx4 v[156:159], v12, s[68:71], s35 offen offset:2304 nt
    v_mfma_f32_16x16x32_bf16 v[104:107], v[24:27], a[248:251], v[104:107]
    ds_read_b128 v[44:47], v3 offset:6400
    v_cvt_pk_bf16_f32 v232, v232, v233
    v_mfma_f32_16x16x32_bf16 v[104:107], v[28:31], a[252:255], v[104:107]
    v_exp_f32 v17, v93
    v_mfma_f32_16x16x32_bf16 v[108:111], v[24:27], v[208:211], v[108:111]
    s_add_u32 s29, s30, 49152
    v_cvt_pk_bf16_f32 v91, v18, v19
    v_cvt_pk_bf16_f32 v236, v236, v237
    v_mfma_f32_16x16x32_bf16 v[108:111], v[28:31], v[212:215], v[108:111]
    s_waitcnt lgkmcnt(2)
    v_exp_f32 v18, v94
    v_mfma_f32_16x16x32_bf16 v[160:163], v[32:35], a[208:211], v[160:163]
    s_mov_b32 m0, s26
    ds_read_b128 v[24:27], v2 offset:12288
    v_add_f32 v8, v8, v16
    v_mfma_f32_16x16x32_bf16 v[160:163], v[36:39], a[212:215], v[160:163]
    s_sub_u32 s3, s29, 147456
    buffer_load_dwordx4 v4, s[4:7], s32 offen offset:0 sc1 lds
    v_mfma_f32_16x16x32_bf16 v[164:167], v[32:35], a[232:235], v[164:167]
    v_add_f32 v8, v8, v17
    v_cvt_f32_i32 v234, v234
    v_mfma_f32_16x16x32_bf16 v[164:167], v[36:39], a[236:239], v[164:167]
    v_exp_f32 v19, v95
    v_mfma_f32_16x16x32_bf16 v[168:171], v[32:35], v[192:195], v[168:171]
    ds_read_b128 v[28:31], v3 offset:12288
    v_cvt_pk_bf16_f32 v92, v16, v17
    v_mfma_f32_16x16x32_bf16 v[168:171], v[36:39], v[196:199], v[168:171]
    buffer_load_dwordx4 v4, s[4:7], s32 offen offset:1024 sc1 lds
    v_mfma_f32_16x16x32_bf16 v[172:175], v[32:35], v[216:219], v[172:175]
    s_min_u32 s29, s29, s3
    v_exp_f32 v16, v124
    v_mfma_f32_16x16x32_bf16 v[172:175], v[36:39], v[220:223], v[172:175]
    s_waitcnt lgkmcnt(2)
    v_add_f32 v8, v8, v18
    v_add_f32 v8, v8, v19
    v_mfma_f32_16x16x32_bf16 v[96:99], v[40:43], a[208:211], v[96:99]
    ds_read_b128 v[32:35], v2 offset:18432
    v_cvt_f32_i32 v235, v235
    v_mfma_f32_16x16x32_bf16 v[96:99], v[44:47], a[212:215], v[96:99]
    buffer_load_dwordx4 v4, s[4:7], s32 offen offset:2048 sc1 lds
    v_mfma_f32_16x16x32_bf16 v[100:103], v[40:43], a[232:235], v[100:103]
    v_exp_f32 v17, v125
    v_mfma_f32_16x16x32_bf16 v[100:103], v[44:47], a[236:239], v[100:103]
    v_cvt_pk_bf16_f32 v93, v18, v19
    v_cvt_f32_i32 v238, v238
    v_mfma_f32_16x16x32_bf16 v[104:107], v[40:43], v[192:195], v[104:107]
    s_add_u32 s32, s32, 24576
    ds_read_b128 v[36:39], v3 offset:18432
    v_cvt_f32_i32 v239, v239
    v_mfma_f32_16x16x32_bf16 v[104:107], v[44:47], v[196:199], v[104:107]
    s_sub_u32 s3, s29, s30
    v_exp_f32 v18, v126
    v_mfma_f32_16x16x32_bf16 v[108:111], v[40:43], v[216:219], v[108:111]
    s_add_u32 s26, s26, 12288
    v_add_f32 v8, v8, v16
    v_add_f32 v8, v8, v17
    v_mfma_f32_16x16x32_bf16 v[108:111], v[44:47], v[220:223], v[108:111]
    s_waitcnt lgkmcnt(2)
    v_exp_f32 v19, v127
    v_mfma_f32_16x16x32_bf16 v[176:179], v[24:27], a[192:195], v[128:131]
    s_mov_b32 m0, s26
    ds_read_b128 v[40:43], v2 offset:12416
    v_cvt_pk_bf16_f32 v94, v16, v17
    v_mfma_f32_16x16x32_bf16 v[176:179], v[28:31], a[196:199], v[176:179]
    v_add_f32 v8, v8, v18
    v_add_f32 v8, v8, v19
    v_mfma_f32_16x16x32_bf16 v[180:183], v[24:27], a[216:219], v[132:135]
    s_mov_b32 s30, s29
    v_cvt_pk_bf16_f32 v95, v18, v19
    v_fma_f32 v234, v234, v56, v58
    v_mfma_f32_16x16x32_bf16 v[180:183], v[28:31], a[220:223], v[180:183]
    buffer_load_dwordx4 v4, s[4:7], s32 offen offset:0 sc1 lds
    v_mfma_f32_16x16x32_bf16 v[184:187], v[24:27], a[240:243], v[136:139]
    ds_read_b128 v[44:47], v3 offset:12416
    v_fma_f32 v235, v235, v57, v59
    v_mfma_f32_16x16x32_bf16 v[184:187], v[28:31], a[244:247], v[184:187]
    v_exp_f32 v16, v160
    v_mfma_f32_16x16x32_bf16 v[188:191], v[24:27], v[200:203], v[140:143]
    v_exp_f32 v17, v161
    v_mfma_f32_16x16x32_bf16 v[188:191], v[28:31], v[204:207], v[188:191]
    s_waitcnt lgkmcnt(2)
    buffer_load_dwordx4 v4, s[4:7], s32 offen offset:1024 sc1 lds
    v_mfma_f32_16x16x32_bf16 v[112:115], v[32:35], a[192:195], v[128:131]
    ds_read_b128 v[24:27], v2 offset:18560
    v_fma_f32 v238, v238, v56, v58
    v_mfma_f32_16x16x32_bf16 v[112:115], v[36:39], a[196:199], v[112:115]
    v_exp_f32 v18, v162
    v_mfma_f32_16x16x32_bf16 v[116:119], v[32:35], a[216:219], v[132:135]
    v_add_f32 v5, v5, v16
    v_add_f32 v5, v5, v17
    v_mfma_f32_16x16x32_bf16 v[116:119], v[36:39], a[220:223], v[116:119]
    buffer_load_dwordx4 v4, s[4:7], s32 offen offset:2048 sc1 lds
    v_mfma_f32_16x16x32_bf16 v[120:123], v[32:35], a[240:243], v[136:139]
    ds_read_b128 v[28:31], v3 offset:18560
    v_fma_f32 v239, v239, v57, v59
    v_mfma_f32_16x16x32_bf16 v[120:123], v[36:39], a[244:247], v[120:123]
    v_exp_f32 v19, v163
    v_mfma_f32_16x16x32_bf16 v[124:127], v[32:35], v[200:203], v[140:143]
    v_cvt_pk_bf16_f32 v160, v16, v17
    v_cvt_pk_bf16_f32 v233, v234, v235
    v_mfma_f32_16x16x32_bf16 v[124:127], v[36:39], v[204:207], v[124:127]
    s_waitcnt lgkmcnt(2)
    v_exp_f32 v16, v96
    v_mfma_f32_16x16x32_bf16 v[176:179], v[40:43], a[200:203], v[176:179]
    s_add_u32 s32, s32, 24576
    ds_read_b128 v[32:35], v2 offset:12544
    v_add_f32 v5, v5, v18
    v_mfma_f32_16x16x32_bf16 v[176:179], v[44:47], a[204:207], v[176:179]
    s_add_u32 s26, s26, 36864
    v_add_f32 v5, v5, v19
    v_cvt_pk_bf16_f32 v237, v238, v239
    v_mfma_f32_16x16x32_bf16 v[180:183], v[40:43], a[224:227], v[180:183]
    v_exp_f32 v17, v97
    v_mfma_f32_16x16x32_bf16 v[180:183], v[44:47], a[228:231], v[180:183]
    s_sub_u32 s57, s26, 147456
    v_cvt_pk_bf16_f32 v161, v18, v19
    v_bfe_u32 v53, v4, 4, 6
    v_mfma_f32_16x16x32_bf16 v[184:187], v[40:43], a[248:251], v[184:187]
    ds_read_b128 v[36:39], v3 offset:12544
    v_add_u32 v1, s3, v1
    v_mfma_f32_16x16x32_bf16 v[184:187], v[44:47], a[252:255], v[184:187]
    v_exp_f32 v18, v98
    v_mfma_f32_16x16x32_bf16 v[188:191], v[40:43], v[208:211], v[188:191]
    s_min_u32 s26, s26, s57
    v_lshlrev_b32 v53, 2, v53
    v_add_f32 v5, v5, v16
    v_mfma_f32_16x16x32_bf16 v[188:191], v[44:47], v[212:215], v[188:191]
    s_waitcnt lgkmcnt(2)
    buffer_load_dword v52, v53, s[20:23], 0 offen sc1
    v_mfma_f32_16x16x32_bf16 v[112:115], v[24:27], a[200:203], v[112:115]
    ds_read_b128 v[40:43], v2 offset:18688
    v_add_f32 v5, v5, v17
    v_mfma_f32_16x16x32_bf16 v[112:115], v[28:31], a[204:207], v[112:115]
    v_exp_f32 v19, v99
    v_mfma_f32_16x16x32_bf16 v[116:119], v[24:27], a[224:227], v[116:119]
    v_cvt_pk_bf16_f32 v162, v16, v17
    v_add_u32 v21, s3, v21
    v_mfma_f32_16x16x32_bf16 v[116:119], v[28:31], a[228:231], v[116:119]
    v_exp_f32 v16, v164
    v_mfma_f32_16x16x32_bf16 v[120:123], v[24:27], a[248:251], v[120:123]
    ds_read_b128 v[44:47], v3 offset:18688
    v_add_u32 v22, s3, v22
    v_mfma_f32_16x16x32_bf16 v[120:123], v[28:31], a[252:255], v[120:123]
    s_waitcnt lgkmcnt(2)
    v_add_f32 v5, v5, v18
    v_add_f32 v5, v5, v19
    v_mfma_f32_16x16x32_bf16 v[124:127], v[24:27], v[208:211], v[124:127]
    s_waitcnt vmcnt(40)
    v_exp_f32 v17, v165
    v_mfma_f32_16x16x32_bf16 v[124:127], v[28:31], v[212:215], v[124:127]
    s_barrier
    ds_read_b128 v[48:51], v10 offset:1152
    v_mfma_f32_16x16x32_bf16 v[176:179], v[32:35], a[208:211], v[176:179]
    s_waitcnt vmcnt(30)
    ds_read_b128 v[24:27], v1 offset:0
    v_cvt_pk_bf16_f32 v163, v18, v19
    v_mfma_f32_16x16x32_bf16 v[176:179], v[36:39], a[212:215], v[176:179]
    v_exp_f32 v18, v166
    v_mfma_f32_16x16x32_bf16 v[180:183], v[32:35], a[232:235], v[180:183]
    v_add_f32 v6, v6, v16
    v_cvt_f32_i32 v240, v240
    v_mfma_f32_16x16x32_bf16 v[180:183], v[36:39], a[236:239], v[180:183]
    v_add_f32 v6, v6, v17
    v_cvt_f32_i32 v241, v241
    v_mfma_f32_16x16x32_bf16 v[184:187], v[32:35], v[192:195], v[184:187]
    ds_read_b128 v[28:31], v1 offset:12288
    v_cvt_f32_i32 v244, v244
    v_mfma_f32_16x16x32_bf16 v[184:187], v[36:39], v[196:199], v[184:187]
    v_exp_f32 v19, v167
    v_mfma_f32_16x16x32_bf16 v[188:191], v[32:35], v[216:219], v[188:191]
    ds_read_b128 v[56:59], v23 offset:0
    v_cvt_pk_bf16_f32 v164, v16, v17
    v_mfma_f32_16x16x32_bf16 v[188:191], v[36:39], v[220:223], v[188:191]
    s_waitcnt lgkmcnt(4)
    v_exp_f32 v16, v100
    v_mfma_f32_16x16x32_bf16 v[112:115], v[40:43], a[208:211], v[112:115]
    ds_read_b128 v[32:35], v1 offset:768
    v_add_f32 v6, v6, v18
    v_mfma_f32_16x16x32_bf16 v[112:115], v[44:47], a[212:215], v[112:115]
    v_add_f32 v6, v6, v19
    v_add_u32 v10, 1792, v10
    v_mfma_f32_16x16x32_bf16 v[116:119], v[40:43], a[232:235], v[116:119]
    v_exp_f32 v17, v101
    v_mfma_f32_16x16x32_bf16 v[116:119], v[44:47], a[236:239], v[116:119]
    v_cvt_pk_bf16_f32 v165, v18, v19
    v_cvt_f32_i32 v245, v245
    v_mfma_f32_16x16x32_bf16 v[120:123], v[40:43], v[192:195], v[120:123]
    ds_read_b128 v[36:39], v1 offset:13056
    v_fma_f32 v240, v240, v60, v62
    v_mfma_f32_16x16x32_bf16 v[120:123], v[44:47], v[196:199], v[120:123]
    v_exp_f32 v18, v102
    v_mfma_f32_16x16x32_bf16 v[124:127], v[40:43], v[216:219], v[124:127]
    v_add_f32 v6, v6, v16
    v_add_f32 v6, v6, v17
    v_mfma_f32_16x16x32_bf16 v[124:127], v[44:47], v[220:223], v[124:127]
    s_waitcnt lgkmcnt(3)
    v_exp_f32 v19, v103
    v_cvt_pk_bf16_f32 v166, v16, v17
    v_add_f32 v6, v6, v18
    v_add_f32 v6, v6, v19
    v_fma_f32 v241, v241, v61, v63
    v_cvt_pk_bf16_f32 v167, v18, v19
    v_fma_f32 v244, v244, v60, v62
    v_mfma_f32_16x16x32_bf16 a[0:3], v[64:67], v[24:27], a[0:3]
    ds_read_b128 v[40:43], v1 offset:1536
    v_fma_f32 v245, v245, v61, v63
    v_mfma_f32_16x16x32_bf16 a[0:3], v[80:83], v[28:31], a[0:3]
    v_exp_f32 v16, v168
    v_mfma_f32_16x16x32_bf16 a[48:51], v[68:71], v[24:27], a[48:51]
    v_exp_f32 v17, v169
    v_mfma_f32_16x16x32_bf16 a[48:51], v[84:87], v[28:31], a[48:51]
    v_exp_f32 v18, v170
    v_mfma_f32_16x16x32_bf16 a[96:99], v[72:75], v[24:27], a[96:99]
    ds_read_b128 v[44:47], v1 offset:13824
    v_cvt_pk_bf16_f32 v226, v240, v241
    v_mfma_f32_16x16x32_bf16 a[96:99], v[88:91], v[28:31], a[96:99]
    v_add_f32 v7, v7, v16
    v_add_f32 v7, v7, v17
    v_mfma_f32_16x16x32_bf16 a[144:147], v[76:79], v[24:27], a[144:147]
    v_exp_f32 v19, v171
    v_mfma_f32_16x16x32_bf16 a[144:147], v[92:95], v[28:31], a[144:147]
    s_waitcnt lgkmcnt(2)
    v_cvt_pk_bf16_f32 v230, v244, v245
    v_mfma_f32_16x16x32_bf16 a[4:7], v[64:67], v[32:35], a[4:7]
    ds_read_b128 v[24:27], v1 offset:2304
    v_cvt_pk_bf16_f32 v168, v16, v17
    v_mfma_f32_16x16x32_bf16 a[4:7], v[80:83], v[36:39], a[4:7]
    v_exp_f32 v16, v104
    v_mfma_f32_16x16x32_bf16 a[52:55], v[68:71], v[32:35], a[52:55]
    v_cvt_f32_i32 v242, v242
    v_add_f32 v7, v7, v18
    v_mfma_f32_16x16x32_bf16 a[52:55], v[84:87], v[36:39], a[52:55]
    v_add_f32 v7, v7, v19
    v_cvt_f32_i32 v243, v243
    v_mfma_f32_16x16x32_bf16 a[100:103], v[72:75], v[32:35], a[100:103]
    ds_read_b128 v[28:31], v1 offset:14592
    v_mfma_f32_16x16x32_bf16 a[100:103], v[88:91], v[36:39], a[100:103]
    v_exp_f32 v17, v105
    v_mfma_f32_16x16x32_bf16 a[148:151], v[76:79], v[32:35], a[148:151]
    v_cvt_pk_bf16_f32 v169, v18, v19
    v_cvt_f32_i32 v246, v246
    v_mfma_f32_16x16x32_bf16 a[148:151], v[92:95], v[36:39], a[148:151]
    s_waitcnt lgkmcnt(2)
    v_exp_f32 v18, v106
    v_mfma_f32_16x16x32_bf16 a[8:11], v[64:67], v[40:43], a[8:11]
    ds_read_b128 v[32:35], v21 offset:0
    v_add_f32 v7, v7, v16
    v_mfma_f32_16x16x32_bf16 a[8:11], v[80:83], v[44:47], a[8:11]
    v_add_f32 v7, v7, v17
    v_mfma_f32_16x16x32_bf16 a[56:59], v[68:71], v[40:43], a[56:59]
    v_exp_f32 v19, v107
    v_mfma_f32_16x16x32_bf16 a[56:59], v[84:87], v[44:47], a[56:59]
    v_cvt_f32_i32 v247, v247
    v_cvt_pk_bf16_f32 v170, v16, v17
    v_mfma_f32_16x16x32_bf16 a[104:107], v[72:75], v[40:43], a[104:107]
    ds_read_b128 v[36:39], v21 offset:12288
    v_mfma_f32_16x16x32_bf16 a[104:107], v[88:91], v[44:47], a[104:107]
    v_exp_f32 v16, v172
    v_mfma_f32_16x16x32_bf16 a[152:155], v[76:79], v[40:43], a[152:155]
    v_add_f32 v7, v7, v18
    v_fma_f32 v242, v242, v48, v50
    v_mfma_f32_16x16x32_bf16 a[152:155], v[92:95], v[44:47], a[152:155]
    s_waitcnt lgkmcnt(2)
    v_add_f32 v7, v7, v19
    v_mfma_f32_16x16x32_bf16 a[12:15], v[64:67], v[24:27], a[12:15]
    ds_read_b128 v[40:43], v21 offset:768
    v_fma_f32 v243, v243, v49, v51
    v_mfma_f32_16x16x32_bf16 a[12:15], v[80:83], v[28:31], a[12:15]
    v_exp_f32 v17, v173
    v_mfma_f32_16x16x32_bf16 a[60:63], v[68:71], v[24:27], a[60:63]
    v_cvt_pk_bf16_f32 v171, v18, v19
    v_mfma_f32_16x16x32_bf16 a[60:63], v[84:87], v[28:31], a[60:63]
    v_exp_f32 v18, v174
    v_mfma_f32_16x16x32_bf16 a[108:111], v[72:75], v[24:27], a[108:111]
    ds_read_b128 v[44:47], v21 offset:13056
    v_add_f32 v8, v8, v16
    v_mfma_f32_16x16x32_bf16 a[108:111], v[88:91], v[28:31], a[108:111]
    v_add_f32 v8, v8, v17
    v_fma_f32 v246, v246, v48, v50
    v_mfma_f32_16x16x32_bf16 a[156:159], v[76:79], v[24:27], a[156:159]
    s_add_u32 s29, s28, 49152
    v_exp_f32 v19, v175
    v_mfma_f32_16x16x32_bf16 a[156:159], v[92:95], v[28:31], a[156:159]
    s_waitcnt lgkmcnt(2)
    v_fma_f32 v247, v247, v49, v51
    v_cvt_pk_bf16_f32 v172, v16, v17
    v_mfma_f32_16x16x32_bf16 a[16:19], v[64:67], v[32:35], a[16:19]
    ds_read_b128 v[24:27], v21 offset:1536
    v_mfma_f32_16x16x32_bf16 a[16:19], v[80:83], v[36:39], a[16:19]
    s_sub_u32 s3, s29, 147456
    v_exp_f32 v16, v108
    v_mfma_f32_16x16x32_bf16 a[64:67], v[68:71], v[32:35], a[64:67]
    v_add_f32 v8, v8, v18
    v_cvt_pk_bf16_f32 v227, v242, v243
    v_mfma_f32_16x16x32_bf16 a[64:67], v[84:87], v[36:39], a[64:67]
    v_add_f32 v8, v8, v19
    v_mfma_f32_16x16x32_bf16 a[112:115], v[72:75], v[32:35], a[112:115]
    ds_read_b128 v[28:31], v21 offset:13824
    v_mfma_f32_16x16x32_bf16 a[112:115], v[88:91], v[36:39], a[112:115]
    v_exp_f32 v17, v109
    v_mfma_f32_16x16x32_bf16 a[160:163], v[76:79], v[32:35], a[160:163]
    v_cvt_pk_bf16_f32 v173, v18, v19
    v_cvt_pk_bf16_f32 v231, v246, v247
    v_mfma_f32_16x16x32_bf16 a[160:163], v[92:95], v[36:39], a[160:163]
    s_waitcnt lgkmcnt(2)
    v_exp_f32 v18, v110
    v_mfma_f32_16x16x32_bf16 a[20:23], v[64:67], v[40:43], a[20:23]
    s_min_u32 s29, s29, s3
    ds_read_b128 v[32:35], v21 offset:2304
    v_add_f32 v8, v8, v16
    v_mfma_f32_16x16x32_bf16 a[20:23], v[80:83], v[44:47], a[20:23]
    s_waitcnt vmcnt(18)
    v_add_f32 v8, v8, v17
    v_mfma_f32_16x16x32_bf16 a[68:71], v[68:71], v[40:43], a[68:71]
    v_exp_f32 v19, v111
    v_mfma_f32_16x16x32_bf16 a[68:71], v[84:87], v[44:47], a[68:71]
    v_cvt_pk_bf16_f32 v174, v16, v17
    v_mfma_f32_16x16x32_bf16 a[116:119], v[72:75], v[40:43], a[116:119]
    ds_read_b128 v[36:39], v21 offset:14592
    v_add_f32 v8, v8, v18
    v_mfma_f32_16x16x32_bf16 a[116:119], v[88:91], v[44:47], a[116:119]
    s_waitcnt vmcnt(0)
    v_subrev_u32 v52, s92, v52
    v_cmp_lt_u32 vcc, 15, v52
    v_mfma_f32_16x16x32_bf16 a[164:167], v[76:79], v[40:43], a[164:167]
    s_sub_u32 s3, s29, s28
    v_add_f32 v8, v8, v19
    v_cvt_pk_bf16_f32 v175, v18, v19
    v_mfma_f32_16x16x32_bf16 a[164:167], v[92:95], v[44:47], a[164:167]
    s_waitcnt lgkmcnt(2)
    v_cvt_f32_i32 v248, v248
    v_cvt_f32_i32 v249, v249
    v_mfma_f32_16x16x32_bf16 a[24:27], v[64:67], v[24:27], a[24:27]
    s_and_b32 s59, vcc_lo, 0xff
    ds_read_b128 v[40:43], v22 offset:0
    v_mfma_f32_16x16x32_bf16 a[24:27], v[80:83], v[28:31], a[24:27]
    s_cbranch_scc1 L_pollslow3
L_pollok3:
    v_mfma_f32_16x16x32_bf16 a[72:75], v[68:71], v[24:27], a[72:75]
    s_add_u32 s92, s92, 1
    v_exp_f32 v16, v176
    v_mfma_f32_16x16x32_bf16 a[72:75], v[84:87], v[28:31], a[72:75]
    s_mov_b32 m0, s56
    v_exp_f32 v17, v177
    v_mfma_f32_16x16x32_bf16 a[120:123], v[72:75], v[24:27], a[120:123]
    ds_read_b128 v[44:47], v22 offset:12288
    v_cvt_f32_i32 v252, v252
    v_mfma_f32_16x16x32_bf16 a[120:123], v[88:91], v[28:31], a[120:123]
    s_mov_b32 s28, s29
    buffer_load_dwordx4 v4, s[4:7], s27 offen offset:0 sc1 lds
    v_mfma_f32_16x16x32_bf16 a[168:171], v[76:79], v[24:27], a[168:171]
    v_exp_f32 v18, v178
    v_mfma_f32_16x16x32_bf16 a[168:171], v[92:95], v[28:31], a[168:171]
    s_waitcnt lgkmcnt(2)
    v_add_f32 v5, v5, v16
    v_add_f32 v5, v5, v17
    v_mfma_f32_16x16x32_bf16 a[28:31], v[64:67], v[32:35], a[28:31]
    ds_read_b128 v[24:27], v22 offset:768
    v_cvt_f32_i32 v253, v253
    v_mfma_f32_16x16x32_bf16 a[28:31], v[80:83], v[36:39], a[28:31]
    buffer_load_dwordx4 v4, s[4:7], s27 offen offset:1024 sc1 lds
    v_mfma_f32_16x16x32_bf16 a[76:79], v[68:71], v[32:35], a[76:79]
    v_exp_f32 v19, v179
    v_mfma_f32_16x16x32_bf16 a[76:79], v[84:87], v[36:39], a[76:79]
    v_cvt_pk_bf16_f32 v176, v16, v17
    v_fma_f32 v248, v248, v60, v62
    v_mfma_f32_16x16x32_bf16 a[124:127], v[72:75], v[32:35], a[124:127]
    ds_read_b128 v[28:31], v22 offset:13056
    v_fma_f32 v249, v249, v61, v63
    v_mfma_f32_16x16x32_bf16 a[124:127], v[88:91], v[36:39], a[124:127]
    buffer_load_dwordx4 v4, s[4:7], s27 offen offset:2048 sc1 lds
    v_mfma_f32_16x16x32_bf16 a[172:175], v[76:79], v[32:35], a[172:175]
    s_add_u32 s27, s27, 24576
    v_exp_f32 v16, v112
    v_mfma_f32_16x16x32_bf16 a[172:175], v[92:95], v[36:39], a[172:175]
    s_waitcnt lgkmcnt(2)
    v_add_f32 v5, v5, v18
    v_add_f32 v5, v5, v19
    v_mfma_f32_16x16x32_bf16 a[32:35], v[64:67], v[40:43], a[32:35]
    s_add_u32 s56, s56, 12288
    ds_read_b128 v[32:35], v22 offset:1536
    v_add_u32 v2, s3, v2
    v_mfma_f32_16x16x32_bf16 a[32:35], v[80:83], v[44:47], a[32:35]
    s_mov_b32 m0, s56
    v_exp_f32 v17, v113
    v_mfma_f32_16x16x32_bf16 a[80:83], v[68:71], v[40:43], a[80:83]
    v_cvt_pk_bf16_f32 v177, v18, v19
    v_fma_f32 v252, v252, v60, v62
    v_mfma_f32_16x16x32_bf16 a[80:83], v[84:87], v[44:47], a[80:83]
    v_exp_f32 v18, v114
    v_mfma_f32_16x16x32_bf16 a[128:131], v[72:75], v[40:43], a[128:131]
    ds_read_b128 v[36:39], v22 offset:13824
    v_add_f32 v5, v5, v16
    v_mfma_f32_16x16x32_bf16 a[128:131], v[88:91], v[44:47], a[128:131]
    buffer_load_dwordx4 v4, s[4:7], s27 offen offset:0 sc1 lds
    v_mfma_f32_16x16x32_bf16 a[176:179], v[76:79], v[40:43], a[176:179]
    v_add_f32 v5, v5, v17
    v_fma_f32 v253, v253, v61, v63
    v_mfma_f32_16x16x32_bf16 a[176:179], v[92:95], v[44:47], a[176:179]
    s_waitcnt lgkmcnt(2)
    v_exp_f32 v19, v115
    v_mfma_f32_16x16x32_bf16 a[36:39], v[64:67], v[24:27], a[36:39]
    ds_read_b128 v[40:43], v22 offset:2304
    v_cvt_pk_bf16_f32 v178, v16, v17
    v_mfma_f32_16x16x32_bf16 a[36:39], v[80:83], v[28:31], a[36:39]
    buffer_load_dwordx4 v4, s[4:7], s27 offen offset:1024 sc1 lds
    v_mfma_f32_16x16x32_bf16 a[84:87], v[68:71], v[24:27], a[84:87]
    v_exp_f32 v16, v180
    v_mfma_f32_16x16x32_bf16 a[84:87], v[84:87], v[28:31], a[84:87]
    v_add_f32 v5, v5, v18
    v_add_f32 v5, v5, v19
    v_mfma_f32_16x16x32_bf16 a[132:135], v[72:75], v[24:27], a[132:135]
    ds_read_b128 v[44:47], v22 offset:14592
    v_add_u32 v3, s3, v3
    v_mfma_f32_16x16x32_bf16 a[132:135], v[88:91], v[28:31], a[132:135]
    s_waitcnt lgkmcnt(2)
    buffer_load_dwordx4 v4, s[4:7], s27 offen offset:2048 sc1 lds
    v_mfma_f32_16x16x32_bf16 a[180:183], v[76:79], v[24:27], a[180:183]
    s_waitcnt vmcnt(30)
    v_exp_f32 v17, v181
    v_mfma_f32_16x16x32_bf16 a[180:183], v[92:95], v[28:31], a[180:183]
    s_barrier
    v_cvt_pk_bf16_f32 v179, v18, v19
    v_mfma_f32_16x16x32_bf16 a[40:43], v[64:67], v[32:35], a[40:43]
    s_add_u32 s27, s27, 24576
    ds_read_b128 v[24:27], v2 offset:0
    v_cvt_pk_bf16_f32 v234, v248, v249
    v_mfma_f32_16x16x32_bf16 a[40:43], v[80:83], v[36:39], a[40:43]
    v_exp_f32 v18, v182
    v_add_f32 v6, v6, v16
    v_mfma_f32_16x16x32_bf16 a[88:91], v[68:71], v[32:35], a[88:91]
    s_add_u32 s56, s56, 36864
    v_add_f32 v6, v6, v17
    v_cvt_pk_bf16_f32 v238, v252, v253
    v_mfma_f32_16x16x32_bf16 a[88:91], v[84:87], v[36:39], a[88:91]
    s_sub_u32 s58, s56, 147456
    v_exp_f32 v19, v183
    v_mfma_f32_16x16x32_bf16 a[136:139], v[72:75], v[32:35], a[136:139]
    ds_read_b128 v[28:31], v3 offset:0
    v_cvt_pk_bf16_f32 v180, v16, v17
    v_mfma_f32_16x16x32_bf16 a[136:139], v[88:91], v[36:39], a[136:139]
    buffer_load_dwordx4 v[240:243], v12, s[68:71], s36 offen offset:0 nt
    v_mfma_f32_16x16x32_bf16 a[184:187], v[76:79], v[32:35], a[184:187]
    s_min_u32 s56, s56, s58
    v_exp_f32 v16, v116
    v_mfma_f32_16x16x32_bf16 a[184:187], v[92:95], v[36:39], a[184:187]
    s_waitcnt lgkmcnt(2)
    v_add_f32 v6, v6, v18
    v_add_f32 v6, v6, v19
    v_mfma_f32_16x16x32_bf16 a[44:47], v[64:67], v[40:43], a[44:47]
    ds_read_b128 v[32:35], v2 offset:6144
    v_cvt_f32_i32 v250, v250
    v_mfma_f32_16x16x32_bf16 a[44:47], v[80:83], v[44:47], a[44:47]
    buffer_load_dwordx4 v[244:247], v12, s[68:71], s36 offen offset:768 nt
    v_mfma_f32_16x16x32_bf16 a[92:95], v[68:71], v[40:43], a[92:95]
    v_exp_f32 v17, v117
    v_mfma_f32_16x16x32_bf16 a[92:95], v[84:87], v[44:47], a[92:95]
    v_cvt_pk_bf16_f32 v181, v18, v19
    v_exp_f32 v18, v118
    v_mfma_f32_16x16x32_bf16 a[140:143], v[72:75], v[40:43], a[140:143]
    s_nop 0
    ds_read_b128 v[36:39], v3 offset:6144
    v_add_f32 v6, v6, v16
    v_mfma_f32_16x16x32_bf16 a[140:143], v[88:91], v[44:47], a[140:143]
    v_add_f32 v6, v6, v17
    v_cvt_f32_i32 v251, v251
    v_mfma_f32_16x16x32_bf16 a[188:191], v[76:79], v[40:43], a[188:191]
    s_waitcnt lgkmcnt(2)
    v_exp_f32 v19, v119
    v_cvt_pk_bf16_f32 v182, v16, v17
    v_add_f32 v6, v6, v18
    v_cvt_f32_i32 v254, v254
    v_add_f32 v6, v6, v19
    v_cvt_f32_i32 v255, v255
    v_cvt_pk_bf16_f32 v183, v18, v19
    v_fma_f32 v250, v250, v48, v50
    v_mfma_f32_16x16x32_bf16 a[188:191], v[92:95], v[44:47], a[188:191]
    s_branch L_join
.p2align 6
L_loop:
    v_mfma_f32_16x16x32_bf16 a[0:3], v[160:163], v[24:27], a[0:3]
    ds_read_b128 v[40:43], v1 offset:1536
    v_fma_f32 v145, v145, v56, v58
    v_mfma_f32_16x16x32_bf16 a[0:3], v[176:179], v[28:31], a[0:3]
    buffer_load_dwordx4 v[248:251], v12, s[68:71], s36 offen offset:1536 nt
    v_mfma_f32_16x16x32_bf16 a[48:51], v[164:167], v[24:27], a[48:51]
    v_exp_f32 v16, v72
    v_mfma_f32_16x16x32_bf16 a[48:51], v[180:183], v[28:31], a[48:51]
    v_exp_f32 v17, v73
    v_mfma_f32_16x16x32_bf16 a[96:99], v[168:171], v[24:27], a[96:99]
    ds_read_b128 v[44:47], v1 offset:13824
    v_fma_f32 v149, v149, v57, v59
    v_mfma_f32_16x16x32_bf16 a[96:99], v[184:187], v[28:31], a[96:99]
    v_exp_f32 v18, v74
    v_mfma_f32_16x16x32_bf16 a[144:147], v[172:175], v[24:27], a[144:147]
    v_add_f32 v7, v7, v16
    v_add_f32 v7, v7, v17
    v_mfma_f32_16x16x32_bf16 a[144:147], v[188:191], v[28:31], a[144:147]
    s_waitcnt lgkmcnt(2)
    buffer_load_dwordx4 v[252:255], v12, s[68:71], s36 offen offset:2304 nt
    v_mfma_f32_16x16x32_bf16 a[4:7], v[160:163], v[32:35], a[4:7]
    ds_read_b128 v[24:27], v1 offset:2304
    v_cvt_f32_i32 v146, v146
    v_mfma_f32_16x16x32_bf16 a[4:7], v[176:179], v[36:39], a[4:7]
    v_exp_f32 v19, v75
    v_mfma_f32_16x16x32_bf16 a[52:55], v[164:167], v[32:35], a[52:55]
    v_cvt_pk_bf16_f32 v72, v16, v17
    v_cvt_f32_i32 v150, v150
    v_mfma_f32_16x16x32_bf16 a[52:55], v[180:183], v[36:39], a[52:55]
    v_exp_f32 v16, v104
    v_mfma_f32_16x16x32_bf16 a[100:103], v[168:171], v[32:35], a[100:103]
    ds_read_b128 v[28:31], v1 offset:14592
    v_add_f32 v7, v7, v18
    v_mfma_f32_16x16x32_bf16 a[100:103], v[184:187], v[36:39], a[100:103]
    v_add_f32 v7, v7, v19
    v_cvt_f32_i32 v147, v147
    v_mfma_f32_16x16x32_bf16 a[148:151], v[172:175], v[32:35], a[148:151]
    v_exp_f32 v17, v105
    v_mfma_f32_16x16x32_bf16 a[148:151], v[188:191], v[36:39], a[148:151]
    s_waitcnt lgkmcnt(2)
    v_cvt_pk_bf16_f32 v73, v18, v19
    v_cvt_f32_i32 v151, v151
    v_mfma_f32_16x16x32_bf16 a[8:11], v[160:163], v[40:43], a[8:11]
    ds_read_b128 v[32:35], v21 offset:0
    s_add_u32 s33, s33, 196608
    v_mfma_f32_16x16x32_bf16 a[8:11], v[176:179], v[44:47], a[8:11]
    s_sub_u32 s34, s33, 1572864
    v_exp_f32 v18, v106
    v_mfma_f32_16x16x32_bf16 a[56:59], v[164:167], v[40:43], a[56:59]
    v_add_f32 v7, v7, v16
    v_add_f32 v7, v7, v17
    v_mfma_f32_16x16x32_bf16 a[56:59], v[180:183], v[44:47], a[56:59]
    s_min_u32 s33, s33, s34
    v_exp_f32 v19, v107
    v_mfma_f32_16x16x32_bf16 a[104:107], v[168:171], v[40:43], a[104:107]
    s_mov_b32 m0, s56
    ds_read_b128 v[36:39], v21 offset:12288
    v_fma_f32 v146, v146, v56, v58
    v_mfma_f32_16x16x32_bf16 a[104:107], v[184:187], v[44:47], a[104:107]
    v_cvt_pk_bf16_f32 v74, v16, v17
    v_fma_f32 v150, v150, v57, v59
    v_mfma_f32_16x16x32_bf16 a[152:155], v[172:175], v[40:43], a[152:155]
    s_add_u32 s34, s33, 3072
    v_exp_f32 v16, v76
    v_mfma_f32_16x16x32_bf16 a[152:155], v[188:191], v[44:47], a[152:155]
    s_waitcnt lgkmcnt(2)
    buffer_load_dwordx4 v4, s[4:7], s27 offen offset:0 sc1 lds
    v_mfma_f32_16x16x32_bf16 a[12:15], v[160:163], v[24:27], a[12:15]
    s_add_u32 s37, s37, 196608
    ds_read_b128 v[40:43], v21 offset:768
    v_add_f32 v7, v7, v18
    v_mfma_f32_16x16x32_bf16 a[12:15], v[176:179], v[28:31], a[12:15]
    v_add_f32 v7, v7, v19
    v_fma_f32 v147, v147, v56, v58
    v_mfma_f32_16x16x32_bf16 a[60:63], v[164:167], v[24:27], a[60:63]
    v_exp_f32 v17, v77
    v_mfma_f32_16x16x32_bf16 a[60:63], v[180:183], v[28:31], a[60:63]
    s_add_u32 s80, s80, 196608
    v_cvt_pk_bf16_f32 v75, v18, v19
    v_fma_f32 v151, v151, v57, v59
    v_mfma_f32_16x16x32_bf16 a[108:111], v[168:171], v[24:27], a[108:111]
    ds_read_b128 v[44:47], v21 offset:13056
    v_mfma_f32_16x16x32_bf16 a[108:111], v[184:187], v[28:31], a[108:111]
    v_exp_f32 v18, v78
    v_mfma_f32_16x16x32_bf16 a[156:159], v[172:175], v[24:27], a[156:159]
    s_add_u32 s29, s28, 49152
    v_add_f32 v8, v8, v16
    v_add_f32 v8, v8, v17
    v_mfma_f32_16x16x32_bf16 a[156:159], v[188:191], v[28:31], a[156:159]
    s_waitcnt lgkmcnt(2)
    buffer_load_dwordx4 v[224:227], v9, s[64:67], s33 offen offset:0 nt
    v_mfma_f32_16x16x32_bf16 a[16:19], v[160:163], v[32:35], a[16:19]
    ds_read_b128 v[24:27], v21 offset:1536
    v_mfma_f32_16x16x32_bf16 a[16:19], v[176:179], v[36:39], a[16:19]
    s_sub_u32 s3, s29, 147456
    v_exp_f32 v19, v79
    v_mfma_f32_16x16x32_bf16 a[64:67], v[164:167], v[32:35], a[64:67]
    ds_read_b128 v[56:59], v23 offset:48
    v_cvt_pk_bf16_f32 v76, v16, v17
    v_mfma_f32_16x16x32_bf16 a[64:67], v[180:183], v[36:39], a[64:67]
    s_waitcnt vmcnt(29)
    buffer_load_dwordx4 v4, s[4:7], s27 offen offset:1024 sc1 lds
    v_mfma_f32_16x16x32_bf16 a[112:115], v[168:171], v[32:35], a[112:115]
    ds_read_b128 v[28:31], v21 offset:13824
    v_cvt_f32_i32 v152, v152
    v_mfma_f32_16x16x32_bf16 a[112:115], v[184:187], v[36:39], a[112:115]
    v_exp_f32 v16, v108
    v_mfma_f32_16x16x32_bf16 a[160:163], v[172:175], v[32:35], a[160:163]
    v_add_f32 v8, v8, v18
    v_add_f32 v8, v8, v19
    v_mfma_f32_16x16x32_bf16 a[160:163], v[188:191], v[36:39], a[160:163]
    s_waitcnt lgkmcnt(3)
    buffer_load_dwordx4 v[228:231], v9, s[64:67], s33 offen offset:1536 nt
    v_mfma_f32_16x16x32_bf16 a[20:23], v[160:163], v[40:43], a[20:23]
    s_min_u32 s29, s29, s3
    ds_read_b128 v[32:35], v21 offset:2304
    v_cvt_f32_i32 v156, v156
    v_mfma_f32_16x16x32_bf16 a[20:23], v[176:179], v[44:47], a[20:23]
    v_exp_f32 v17, v109
    v_mfma_f32_16x16x32_bf16 a[68:71], v[164:167], v[40:43], a[68:71]
    v_cvt_pk_bf16_f32 v77, v18, v19
    v_cvt_f32_i32 v153, v153
    v_mfma_f32_16x16x32_bf16 a[68:71], v[180:183], v[44:47], a[68:71]
    buffer_load_dwordx4 v[232:235], v9, s[64:67], s34 offen offset:0 nt
    v_mfma_f32_16x16x32_bf16 a[116:119], v[168:171], v[40:43], a[116:119]
    ds_read_b128 v[36:39], v21 offset:14592
    v_add_u32 v23, 1792, v23
    v_mfma_f32_16x16x32_bf16 a[116:119], v[184:187], v[44:47], a[116:119]
    v_exp_f32 v18, v110
    v_mfma_f32_16x16x32_bf16 a[164:167], v[172:175], v[40:43], a[164:167]
    s_sub_u32 s3, s29, s28
    v_add_f32 v8, v8, v16
    v_add_f32 v8, v8, v17
    v_mfma_f32_16x16x32_bf16 a[164:167], v[188:191], v[44:47], a[164:167]
    s_waitcnt lgkmcnt(2)
    buffer_load_dwordx4 v4, s[4:7], s27 offen offset:2048 sc1 lds
    v_mfma_f32_16x16x32_bf16 a[24:27], v[160:163], v[24:27], a[24:27]
    s_add_u32 s27, s27, 24576
    ds_read_b128 v[40:43], v22 offset:0
    v_cvt_f32_i32 v157, v157
    v_mfma_f32_16x16x32_bf16 a[24:27], v[176:179], v[28:31], a[24:27]
    v_exp_f32 v19, v111
    v_cvt_pk_bf16_f32 v78, v16, v17
    v_mfma_f32_16x16x32_bf16 a[72:75], v[164:167], v[24:27], a[72:75]
    s_add_u32 s56, s56, 12288
    buffer_load_dwordx4 v[236:239], v9, s[64:67], s34 offen offset:1536 nt
    v_mfma_f32_16x16x32_bf16 a[72:75], v[180:183], v[28:31], a[72:75]
    s_mov_b32 m0, s56
    v_add_f32 v8, v8, v18
    v_add_f32 v8, v8, v19
    v_mfma_f32_16x16x32_bf16 a[120:123], v[168:171], v[24:27], a[120:123]
    ds_read_b128 v[44:47], v22 offset:12288
    v_cvt_pk_bf16_f32 v79, v18, v19
    v_mfma_f32_16x16x32_bf16 a[120:123], v[184:187], v[28:31], a[120:123]
    s_mov_b32 s28, s29
    v_exp_f32 v16, v80
    v_mfma_f32_16x16x32_bf16 a[168:171], v[172:175], v[24:27], a[168:171]
    v_exp_f32 v17, v81
    v_mfma_f32_16x16x32_bf16 a[168:171], v[188:191], v[28:31], a[168:171]
    s_waitcnt lgkmcnt(2)
    buffer_load_dwordx4 v4, s[4:7], s27 offen offset:0 sc1 lds
    v_mfma_f32_16x16x32_bf16 a[28:31], v[160:163], v[32:35], a[28:31]
    ds_read_b128 v[24:27], v22 offset:768
    v_fma_f32 v152, v152, v60, v62
    v_mfma_f32_16x16x32_bf16 a[28:31], v[176:179], v[36:39], a[28:31]
    v_exp_f32 v18, v82
    v_mfma_f32_16x16x32_bf16 a[76:79], v[164:167], v[32:35], a[76:79]
    v_add_f32 v5, v5, v16
    v_add_f32 v5, v5, v17
    v_mfma_f32_16x16x32_bf16 a[76:79], v[180:183], v[36:39], a[76:79]
    v_exp_f32 v19, v83
    v_mfma_f32_16x16x32_bf16 a[124:127], v[168:171], v[32:35], a[124:127]
    ds_read_b128 v[28:31], v22 offset:13056
    v_cvt_pk_bf16_f32 v80, v16, v17
    v_mfma_f32_16x16x32_bf16 a[124:127], v[184:187], v[36:39], a[124:127]
    buffer_load_dwordx4 v4, s[4:7], s27 offen offset:1024 sc1 lds
    v_mfma_f32_16x16x32_bf16 a[172:175], v[172:175], v[32:35], a[172:175]
    v_exp_f32 v16, v112
    v_mfma_f32_16x16x32_bf16 a[172:175], v[188:191], v[36:39], a[172:175]
    s_waitcnt lgkmcnt(2)
    v_add_f32 v5, v5, v18
    v_add_f32 v5, v5, v19
    v_mfma_f32_16x16x32_bf16 a[32:35], v[160:163], v[40:43], a[32:35]
    ds_read_b128 v[32:35], v22 offset:1536
    v_fma_f32 v156, v156, v61, v63
    v_mfma_f32_16x16x32_bf16 a[32:35], v[176:179], v[44:47], a[32:35]
    v_exp_f32 v17, v113
    v_mfma_f32_16x16x32_bf16 a[80:83], v[164:167], v[40:43], a[80:83]
    v_cvt_pk_bf16_f32 v81, v18, v19
    v_fma_f32 v153, v153, v60, v62
    v_mfma_f32_16x16x32_bf16 a[80:83], v[180:183], v[44:47], a[80:83]
    v_exp_f32 v18, v114
    v_mfma_f32_16x16x32_bf16 a[128:131], v[168:171], v[40:43], a[128:131]
    ds_read_b128 v[36:39], v22 offset:13824
    v_add_f32 v5, v5, v16
    v_mfma_f32_16x16x32_bf16 a[128:131], v[184:187], v[44:47], a[128:131]
    buffer_load_dwordx4 v4, s[4:7], s27 offen offset:2048 sc1 lds
    v_mfma_f32_16x16x32_bf16 a[176:179], v[172:175], v[40:43], a[176:179]
    v_add_f32 v5, v5, v17
    v_fma_f32 v157, v157, v61, v63
    v_mfma_f32_16x16x32_bf16 a[176:179], v[188:191], v[44:47], a[176:179]
    s_waitcnt lgkmcnt(2)
    v_exp_f32 v19, v115
    v_mfma_f32_16x16x32_bf16 a[36:39], v[160:163], v[24:27], a[36:39]
    ds_read_b128 v[40:43], v22 offset:2304
    v_cvt_pk_bf16_f32 v82, v16, v17
    v_mfma_f32_16x16x32_bf16 a[36:39], v[176:179], v[28:31], a[36:39]
    v_exp_f32 v16, v84
    v_mfma_f32_16x16x32_bf16 a[84:87], v[164:167], v[24:27], a[84:87]
    v_cvt_f32_i32 v154, v154
    v_add_u32 v2, s3, v2
    v_mfma_f32_16x16x32_bf16 a[84:87], v[180:183], v[28:31], a[84:87]
    s_add_u32 s27, s27, 24576
    v_add_f32 v5, v5, v18
    v_add_f32 v5, v5, v19
    v_mfma_f32_16x16x32_bf16 a[132:135], v[168:171], v[24:27], a[132:135]
    s_add_u32 s56, s56, 36864
    ds_read_b128 v[44:47], v22 offset:14592
    v_add_u32 v3, s3, v3
    v_mfma_f32_16x16x32_bf16 a[132:135], v[184:187], v[28:31], a[132:135]
    s_waitcnt lgkmcnt(2)
    v_exp_f32 v17, v85
    v_mfma_f32_16x16x32_bf16 a[180:183], v[172:175], v[24:27], a[180:183]
    s_waitcnt vmcnt(12)
    v_cvt_pk_bf16_f32 v83, v18, v19
    v_cvt_f32_i32 v158, v158
    v_mfma_f32_16x16x32_bf16 a[180:183], v[188:191], v[28:31], a[180:183]
    s_barrier
    v_cvt_f32_i32 v155, v155
    v_mfma_f32_16x16x32_bf16 a[40:43], v[160:163], v[32:35], a[40:43]
    s_sub_u32 s58, s56, 147456
    ds_read_b128 v[24:27], v2 offset:0
    v_cvt_f32_i32 v159, v159
    v_mfma_f32_16x16x32_bf16 a[40:43], v[176:179], v[36:39], a[40:43]
    v_exp_f32 v18, v86
    v_mfma_f32_16x16x32_bf16 a[88:91], v[164:167], v[32:35], a[88:91]
    s_min_u32 s56, s56, s58
    v_add_f32 v6, v6, v16
    v_add_f32 v6, v6, v17
    v_mfma_f32_16x16x32_bf16 a[88:91], v[180:183], v[36:39], a[88:91]
    v_exp_f32 v19, v87
    v_mfma_f32_16x16x32_bf16 a[136:139], v[168:171], v[32:35], a[136:139]
    ds_read_b128 v[28:31], v3 offset:0
    v_cvt_pk_bf16_f32 v84, v16, v17
    v_mfma_f32_16x16x32_bf16 a[136:139], v[184:187], v[36:39], a[136:139]
    v_exp_f32 v16, v116
    v_mfma_f32_16x16x32_bf16 a[184:187], v[172:175], v[32:35], a[184:187]
    v_fma_f32 v154, v154, v60, v62
    v_add_f32 v6, v6, v18
    v_mfma_f32_16x16x32_bf16 a[184:187], v[188:191], v[36:39], a[184:187]
    s_waitcnt lgkmcnt(2)
    v_add_f32 v6, v6, v19
    v_fma_f32 v158, v158, v61, v63
    v_mfma_f32_16x16x32_bf16 a[44:47], v[160:163], v[40:43], a[44:47]
    ds_read_b128 v[32:35], v2 offset:6144
    v_fma_f32 v155, v155, v60, v62
    v_mfma_f32_16x16x32_bf16 a[44:47], v[176:179], v[44:47], a[44:47]
    v_exp_f32 v17, v117
    v_mfma_f32_16x16x32_bf16 a[92:95], v[164:167], v[40:43], a[92:95]
    v_cvt_pk_bf16_f32 v85, v18, v19
    v_fma_f32 v159, v159, v61, v63
    v_mfma_f32_16x16x32_bf16 a[92:95], v[180:183], v[44:47], a[92:95]
    v_exp_f32 v18, v118
    v_mfma_f32_16x16x32_bf16 a[140:143], v[168:171], v[40:43], a[140:143]
    ds_read_b128 v[36:39], v3 offset:6144
    v_add_f32 v6, v6, v16
    v_mfma_f32_16x16x32_bf16 a[140:143], v[184:187], v[44:47], a[140:143]
    v_add_u32 v55, 1, v55
    buffer_store_dword v55, v13, s[20:23], 0 offen sc1
    v_mfma_f32_16x16x32_bf16 a[188:191], v[172:175], v[40:43], a[188:191]
    v_add_f32 v6, v6, v17
    v_cvt_pk_bf16_f32 v144, v144, v148
    v_mfma_f32_16x16x32_bf16 a[188:191], v[188:191], v[44:47], a[188:191]
    s_waitcnt lgkmcnt(2)
    v_exp_f32 v19, v119
    v_cvt_pk_bf16_f32 v86, v16, v17
    v_add_f32 v6, v6, v18
    v_cvt_pk_bf16_f32 v148, v145, v149
    v_add_f32 v6, v6, v19
    v_cvt_pk_bf16_f32 v145, v152, v156
    v_cvt_pk_bf16_f32 v87, v18, v19
    v_cvt_pk_bf16_f32 v149, v153, v157
    v_mfma_f32_16x16x32_bf16 v[160:163], v[24:27], a[192:195], v[128:131]
    s_mov_b32 m0, s26
    ds_read_b128 v[40:43], v2 offset:128
    v_cvt_pk_bf16_f32 v152, v146, v150
    v_mfma_f32_16x16x32_bf16 v[160:163], v[28:31], a[196:199], v[160:163]
    v_exp_f32 v16, v88
    v_mfma_f32_16x16x32_bf16 v[164:167], v[24:27], a[216:219], v[132:135]
    v_exp_f32 v17, v89
    v_mfma_f32_16x16x32_bf16 v[164:167], v[28:31], a[220:223], v[164:167]
    v_exp_f32 v18, v90
    v_mfma_f32_16x16x32_bf16 v[168:171], v[24:27], a[240:243], v[136:139]
    ds_read_b128 v[44:47], v3 offset:128
    v_cvt_pk_bf16_f32 v153, v154, v158
    v_mfma_f32_16x16x32_bf16 v[168:171], v[28:31], a[244:247], v[168:171]
    buffer_load_dwordx4 v4, s[4:7], s32 offen offset:0 sc1 lds
    v_mfma_f32_16x16x32_bf16 v[172:175], v[24:27], v[200:203], v[140:143]
    v_add_f32 v7, v7, v16
    v_add_f32 v7, v7, v17
    v_mfma_f32_16x16x32_bf16 v[172:175], v[28:31], v[204:207], v[172:175]
    s_waitcnt lgkmcnt(2)
    v_exp_f32 v19, v91
    v_mfma_f32_16x16x32_bf16 v[96:99], v[32:35], a[192:195], v[128:131]
    ds_read_b128 v[24:27], v2 offset:6272
    v_cvt_pk_bf16_f32 v156, v147, v151
    v_mfma_f32_16x16x32_bf16 v[96:99], v[36:39], a[196:199], v[96:99]
    v_cvt_pk_bf16_f32 v88, v16, v17
    v_cvt_pk_bf16_f32 v157, v155, v159
    v_mfma_f32_16x16x32_bf16 v[100:103], v[32:35], a[216:219], v[132:135]
    s_waitcnt vmcnt(24)
    v_exp_f32 v16, v120
    v_mfma_f32_16x16x32_bf16 v[100:103], v[36:39], a[220:223], v[100:103]
    v_add_f32 v7, v7, v18
    v_mfma_f32_16x16x32_bf16 v[104:107], v[32:35], a[240:243], v[136:139]
    ds_read_b128 v[28:31], v3 offset:6272
    v_add_f32 v7, v7, v19
    v_mfma_f32_16x16x32_bf16 v[104:107], v[36:39], a[244:247], v[104:107]
    v_exp_f32 v17, v121
    v_mfma_f32_16x16x32_bf16 v[108:111], v[32:35], v[200:203], v[140:143]
    v_cvt_f32_i32 v240, v240
    v_mfma_f32_16x16x32_bf16 v[108:111], v[36:39], v[204:207], v[108:111]
    s_waitcnt lgkmcnt(2)
    buffer_load_dwordx4 v4, s[4:7], s32 offen offset:1024 sc1 lds
    v_mfma_f32_16x16x32_bf16 v[160:163], v[40:43], a[200:203], v[160:163]
    ds_read_b128 v[32:35], v2 offset:256
    v_cvt_pk_bf16_f32 v89, v18, v19
    v_mfma_f32_16x16x32_bf16 v[160:163], v[44:47], a[204:207], v[160:163]
    v_exp_f32 v18, v122
    v_mfma_f32_16x16x32_bf16 v[164:167], v[40:43], a[224:227], v[164:167]
    v_add_f32 v7, v7, v16
    v_cvt_f32_i32 v244, v244
    v_mfma_f32_16x16x32_bf16 v[164:167], v[44:47], a[228:231], v[164:167]
    v_add_f32 v7, v7, v17
    v_cvt_f32_i32 v241, v241
    v_mfma_f32_16x16x32_bf16 v[168:171], v[40:43], a[248:251], v[168:171]
    ds_read_b128 v[36:39], v3 offset:256
    v_cvt_f32_i32 v245, v245
    v_mfma_f32_16x16x32_bf16 v[168:171], v[44:47], a[252:255], v[168:171]
    v_exp_f32 v19, v123
    v_mfma_f32_16x16x32_bf16 v[172:175], v[40:43], v[208:211], v[172:175]
    v_cvt_pk_bf16_f32 v90, v16, v17
    v_mfma_f32_16x16x32_bf16 v[172:175], v[44:47], v[212:215], v[172:175]
    s_waitcnt lgkmcnt(2)
    buffer_load_dwordx4 v4, s[4:7], s32 offen offset:2048 sc1 lds
    v_mfma_f32_16x16x32_bf16 v[96:99], v[24:27], a[200:203], v[96:99]
    ds_read_b128 v[40:43], v2 offset:6400
    v_fma_f32 v240, v240, v48, v50
    v_mfma_f32_16x16x32_bf16 v[96:99], v[28:31], a[204:207], v[96:99]
    v_exp_f32 v16, v92
    v_mfma_f32_16x16x32_bf16 v[100:103], v[24:27], a[224:227], v[100:103]
    v_add_f32 v7, v7, v18
    v_add_f32 v7, v7, v19
    v_mfma_f32_16x16x32_bf16 v[100:103], v[28:31], a[228:231], v[100:103]
    v_exp_f32 v17, v93
    v_mfma_f32_16x16x32_bf16 v[104:107], v[24:27], a[248:251], v[104:107]
    ds_read_b128 v[44:47], v3 offset:6400
    v_cvt_pk_bf16_f32 v91, v18, v19
    v_mfma_f32_16x16x32_bf16 v[104:107], v[28:31], a[252:255], v[104:107]
    v_exp_f32 v18, v94
    v_mfma_f32_16x16x32_bf16 v[108:111], v[24:27], v[208:211], v[108:111]
    s_add_u32 s29, s30, 49152
    v_fma_f32 v244, v244, v49, v51
    v_fma_f32 v241, v241, v48, v50
    v_mfma_f32_16x16x32_bf16 v[108:111], v[28:31], v[212:215], v[108:111]
    s_waitcnt lgkmcnt(2)
    v_add_f32 v8, v8, v16
    v_add_f32 v8, v8, v17
    v_mfma_f32_16x16x32_bf16 v[160:163], v[32:35], a[208:211], v[160:163]
    s_add_u32 s32, s32, 24576
    ds_read_b128 v[24:27], v2 offset:12288
    v_fma_f32 v245, v245, v49, v51
    v_mfma_f32_16x16x32_bf16 v[160:163], v[36:39], a[212:215], v[160:163]
    s_sub_u32 s3, s29, 147456
    v_exp_f32 v19, v95
    v_mfma_f32_16x16x32_bf16 v[164:167], v[32:35], a[232:235], v[164:167]
    v_cvt_pk_bf16_f32 v92, v16, v17
    v_cvt_f32_i32 v242, v242
    v_mfma_f32_16x16x32_bf16 v[164:167], v[36:39], a[236:239], v[164:167]
    s_add_u32 s26, s26, 12288
    v_exp_f32 v16, v124
    v_mfma_f32_16x16x32_bf16 v[168:171], v[32:35], v[192:195], v[168:171]
    ds_read_b128 v[28:31], v3 offset:12288
    v_add_f32 v8, v8, v18
    v_mfma_f32_16x16x32_bf16 v[168:171], v[36:39], v[196:199], v[168:171]
    v_cvt_f32_i32 v246, v246
    v_add_f32 v8, v8, v19
    v_mfma_f32_16x16x32_bf16 v[172:175], v[32:35], v[216:219], v[172:175]
    s_min_u32 s29, s29, s3
    v_mfma_f32_16x16x32_bf16 v[172:175], v[36:39], v[220:223], v[172:175]
    s_waitcnt lgkmcnt(2)
    v_exp_f32 v17, v125
    v_mfma_f32_16x16x32_bf16 v[96:99], v[40:43], a[208:211], v[96:99]
    s_mov_b32 m0, s26
    ds_read_b128 v[32:35], v2 offset:18432
    v_cvt_pk_bf16_f32 v93, v18, v19
    v_mfma_f32_16x16x32_bf16 v[96:99], v[44:47], a[212:215], v[96:99]
    v_cvt_f32_i32 v243, v243
    v_mfma_f32_16x16x32_bf16 v[100:103], v[40:43], a[232:235], v[100:103]
    v_exp_f32 v18, v126
    v_mfma_f32_16x16x32_bf16 v[100:103], v[44:47], a[236:239], v[100:103]
    v_add_f32 v8, v8, v16
    v_cvt_f32_i32 v247, v247
    v_mfma_f32_16x16x32_bf16 v[104:107], v[40:43], v[192:195], v[104:107]
    s_sub_u32 s3, s29, s30
    ds_read_b128 v[36:39], v3 offset:18432
    v_add_f32 v8, v8, v17
    v_mfma_f32_16x16x32_bf16 v[104:107], v[44:47], v[196:199], v[104:107]
    v_exp_f32 v19, v127
    v_mfma_f32_16x16x32_bf16 v[108:111], v[40:43], v[216:219], v[108:111]
    v_fma_f32 v242, v242, v48, v50
    v_cvt_pk_bf16_f32 v94, v16, v17
    v_mfma_f32_16x16x32_bf16 v[108:111], v[44:47], v[220:223], v[108:111]
    s_waitcnt lgkmcnt(2)
    buffer_load_dwordx4 v4, s[4:7], s32 offen offset:0 sc1 lds
    v_mfma_f32_16x16x32_bf16 v[176:179], v[24:27], a[192:195], v[128:131]
    ds_read_b128 v[40:43], v2 offset:12416
    v_add_f32 v8, v8, v18
    v_mfma_f32_16x16x32_bf16 v[176:179], v[28:31], a[196:199], v[176:179]
    v_add_f32 v8, v8, v19
    v_fma_f32 v246, v246, v49, v51
    v_mfma_f32_16x16x32_bf16 v[180:183], v[24:27], a[216:219], v[132:135]
    s_mov_b32 s30, s29
    v_cvt_pk_bf16_f32 v95, v18, v19
    v_fma_f32 v243, v243, v48, v50
    v_mfma_f32_16x16x32_bf16 v[180:183], v[28:31], a[220:223], v[180:183]
    v_mfma_f32_16x16x32_bf16 v[184:187], v[24:27], a[240:243], v[136:139]
    ds_read_b128 v[44:47], v3 offset:12416
    v_mfma_f32_16x16x32_bf16 v[184:187], v[28:31], a[244:247], v[184:187]
    v_exp_f32 v16, v160
    v_mfma_f32_16x16x32_bf16 v[188:191], v[24:27], v[200:203], v[140:143]
    v_exp_f32 v17, v161
    v_mfma_f32_16x16x32_bf16 v[188:191], v[28:31], v[204:207], v[188:191]
    s_waitcnt lgkmcnt(2)
    v_exp_f32 v18, v162
    v_mfma_f32_16x16x32_bf16 v[112:115], v[32:35], a[192:195], v[128:131]
    ds_read_b128 v[24:27], v2 offset:18560
    v_fma_f32 v247, v247, v49, v51
    v_mfma_f32_16x16x32_bf16 v[112:115], v[36:39], a[196:199], v[112:115]
    buffer_load_dwordx4 v4, s[4:7], s32 offen offset:1024 sc1 lds
    v_mfma_f32_16x16x32_bf16 v[116:119], v[32:35], a[216:219], v[132:135]
    v_add_f32 v5, v5, v16
    v_add_f32 v5, v5, v17
    v_mfma_f32_16x16x32_bf16 v[116:119], v[36:39], a[220:223], v[116:119]
    v_exp_f32 v19, v163
    v_mfma_f32_16x16x32_bf16 v[120:123], v[32:35], a[240:243], v[136:139]
    ds_read_b128 v[28:31], v3 offset:18560
    v_cvt_pk_bf16_f32 v160, v16, v17
    v_mfma_f32_16x16x32_bf16 v[120:123], v[36:39], a[244:247], v[120:123]
    v_exp_f32 v16, v96
    v_mfma_f32_16x16x32_bf16 v[124:127], v[32:35], v[200:203], v[140:143]
    ds_read_b128 v[48:51], v10 offset:0
    v_add_f32 v5, v5, v18
    v_mfma_f32_16x16x32_bf16 v[124:127], v[36:39], v[204:207], v[124:127]
    s_waitcnt lgkmcnt(3)
    v_cvt_pk_bf16_f32 v146, v240, v244
    v_add_f32 v5, v5, v19
    v_mfma_f32_16x16x32_bf16 v[176:179], v[40:43], a[200:203], v[176:179]
    ds_read_b128 v[32:35], v2 offset:12544
    v_add_u32 v1, s3, v1
    v_mfma_f32_16x16x32_bf16 v[176:179], v[44:47], a[204:207], v[176:179]
    buffer_load_dwordx4 v4, s[4:7], s32 offen offset:2048 sc1 lds
    v_mfma_f32_16x16x32_bf16 v[180:183], v[40:43], a[224:227], v[180:183]
    v_exp_f32 v17, v97
    v_mfma_f32_16x16x32_bf16 v[180:183], v[44:47], a[228:231], v[180:183]
    v_cvt_pk_bf16_f32 v161, v18, v19
    v_cvt_pk_bf16_f32 v150, v241, v245
    v_mfma_f32_16x16x32_bf16 v[184:187], v[40:43], a[248:251], v[184:187]
    ds_read_b128 v[36:39], v3 offset:12544
    v_cvt_pk_bf16_f32 v154, v242, v246
    v_mfma_f32_16x16x32_bf16 v[184:187], v[44:47], a[252:255], v[184:187]
    v_exp_f32 v18, v98
    v_mfma_f32_16x16x32_bf16 v[188:191], v[40:43], v[208:211], v[188:191]
    v_add_f32 v5, v5, v16
    v_add_f32 v5, v5, v17
    v_mfma_f32_16x16x32_bf16 v[188:191], v[44:47], v[212:215], v[188:191]
    s_waitcnt lgkmcnt(3)
    v_exp_f32 v19, v99
    v_mfma_f32_16x16x32_bf16 v[112:115], v[24:27], a[200:203], v[112:115]
    ds_read_b128 v[40:43], v2 offset:18688
    v_add_u32 v21, s3, v21
    v_mfma_f32_16x16x32_bf16 v[112:115], v[28:31], a[204:207], v[112:115]
    v_cvt_pk_bf16_f32 v162, v16, v17
    v_cvt_pk_bf16_f32 v158, v243, v247
    v_mfma_f32_16x16x32_bf16 v[116:119], v[24:27], a[224:227], v[116:119]
    s_waitcnt vmcnt(17)
    v_exp_f32 v16, v164
    v_mfma_f32_16x16x32_bf16 v[116:119], v[28:31], a[228:231], v[116:119]
    s_add_u32 s32, s32, 24576
    v_add_f32 v5, v5, v18
    v_add_u32 v22, s3, v22
    v_mfma_f32_16x16x32_bf16 v[120:123], v[24:27], a[248:251], v[120:123]
    ds_read_b128 v[44:47], v3 offset:18688
    v_add_f32 v5, v5, v19
    v_mfma_f32_16x16x32_bf16 v[120:123], v[28:31], a[252:255], v[120:123]
    s_waitcnt lgkmcnt(2)
    buffer_load_dwordx4 v[240:243], v9, s[64:67], s33 offen offset:384 nt
    v_mfma_f32_16x16x32_bf16 v[124:127], v[24:27], v[208:211], v[124:127]
    s_waitcnt vmcnt(32)
    v_exp_f32 v17, v165
    v_mfma_f32_16x16x32_bf16 v[124:127], v[28:31], v[212:215], v[124:127]
    s_barrier
    v_cvt_pk_bf16_f32 v163, v18, v19
    v_mfma_f32_16x16x32_bf16 v[176:179], v[32:35], a[208:211], v[176:179]
    s_add_u32 s26, s26, 36864
    ds_read_b128 v[24:27], v1 offset:0
    v_cvt_f32_i32 v248, v248
    v_mfma_f32_16x16x32_bf16 v[176:179], v[36:39], a[212:215], v[176:179]
    s_sub_u32 s57, s26, 147456
    v_exp_f32 v18, v166
    v_mfma_f32_16x16x32_bf16 v[180:183], v[32:35], a[232:235], v[180:183]
    s_min_u32 s26, s26, s57
    v_add_f32 v6, v6, v16
    v_add_f32 v6, v6, v17
    v_mfma_f32_16x16x32_bf16 v[180:183], v[36:39], a[236:239], v[180:183]
    v_exp_f32 v19, v167
    v_mfma_f32_16x16x32_bf16 v[184:187], v[32:35], v[192:195], v[184:187]
    ds_read_b128 v[28:31], v1 offset:12288
    v_cvt_pk_bf16_f32 v164, v16, v17
    v_mfma_f32_16x16x32_bf16 v[184:187], v[36:39], v[196:199], v[184:187]
    buffer_load_dwordx4 v[244:247], v9, s[64:67], s33 offen offset:1920 nt
    v_mfma_f32_16x16x32_bf16 v[188:191], v[32:35], v[216:219], v[188:191]
    v_exp_f32 v16, v100
    v_mfma_f32_16x16x32_bf16 v[188:191], v[36:39], v[220:223], v[188:191]
    s_waitcnt lgkmcnt(2)
    v_add_f32 v6, v6, v18
    v_cvt_f32_i32 v252, v252
    v_mfma_f32_16x16x32_bf16 v[112:115], v[40:43], a[208:211], v[112:115]
    ds_read_b128 v[32:35], v1 offset:768
    v_add_f32 v6, v6, v19
    v_mfma_f32_16x16x32_bf16 v[112:115], v[44:47], a[212:215], v[112:115]
    v_exp_f32 v17, v101
    v_mfma_f32_16x16x32_bf16 v[116:119], v[40:43], a[232:235], v[116:119]
    v_cvt_pk_bf16_f32 v165, v18, v19
    v_cvt_f32_i32 v249, v249
    v_mfma_f32_16x16x32_bf16 v[116:119], v[44:47], a[236:239], v[116:119]
    v_exp_f32 v18, v102
    v_mfma_f32_16x16x32_bf16 v[120:123], v[40:43], v[192:195], v[120:123]
    ds_read_b128 v[36:39], v1 offset:13056
    v_add_f32 v6, v6, v16
    v_mfma_f32_16x16x32_bf16 v[120:123], v[44:47], v[196:199], v[120:123]
    v_add_f32 v6, v6, v17
    v_cvt_f32_i32 v253, v253
    v_mfma_f32_16x16x32_bf16 v[124:127], v[40:43], v[216:219], v[124:127]
    v_exp_f32 v19, v103
    v_mfma_f32_16x16x32_bf16 v[124:127], v[44:47], v[220:223], v[124:127]
    s_waitcnt lgkmcnt(2)
    v_cvt_pk_bf16_f32 v166, v16, v17
    v_fma_f32 v248, v248, v56, v58
    v_add_f32 v6, v6, v18
    v_fma_f32 v252, v252, v57, v59
    v_add_f32 v6, v6, v19
    v_fma_f32 v249, v249, v56, v58
    v_cvt_pk_bf16_f32 v167, v18, v19
    v_fma_f32 v253, v253, v57, v59
    v_mfma_f32_16x16x32_bf16 a[0:3], v[64:67], v[24:27], a[0:3]
    s_mov_b32 m0, s56
    ds_read_b128 v[40:43], v1 offset:1536
    v_bfe_u32 v53, v4, 4, 6
    v_mfma_f32_16x16x32_bf16 a[0:3], v[80:83], v[28:31], a[0:3]
    v_exp_f32 v16, v168
    v_mfma_f32_16x16x32_bf16 a[48:51], v[68:71], v[24:27], a[48:51]
    v_exp_f32 v17, v169
    v_mfma_f32_16x16x32_bf16 a[48:51], v[84:87], v[28:31], a[48:51]
    buffer_load_dwordx4 v4, s[4:7], s27 offen offset:0 sc1 lds
    v_mfma_f32_16x16x32_bf16 a[96:99], v[72:75], v[24:27], a[96:99]
    ds_read_b128 v[44:47], v1 offset:13824
    v_lshlrev_b32 v53, 2, v53
    v_mfma_f32_16x16x32_bf16 a[96:99], v[88:91], v[28:31], a[96:99]
    v_exp_f32 v18, v170
    v_mfma_f32_16x16x32_bf16 a[144:147], v[76:79], v[24:27], a[144:147]
    v_add_f32 v7, v7, v16
    v_cvt_f32_i32 v250, v250
    v_mfma_f32_16x16x32_bf16 a[144:147], v[92:95], v[28:31], a[144:147]
    s_waitcnt lgkmcnt(2)
    buffer_load_dword v52, v53, s[20:23], 0 offen sc1
    v_mfma_f32_16x16x32_bf16 a[4:7], v[64:67], v[32:35], a[4:7]
    ds_read_b128 v[24:27], v1 offset:2304
    v_add_f32 v7, v7, v17
    v_mfma_f32_16x16x32_bf16 a[4:7], v[80:83], v[36:39], a[4:7]
    v_exp_f32 v19, v171
    v_mfma_f32_16x16x32_bf16 a[52:55], v[68:71], v[32:35], a[52:55]
    v_cvt_pk_bf16_f32 v168, v16, v17
    v_cvt_f32_i32 v254, v254
    v_mfma_f32_16x16x32_bf16 a[52:55], v[84:87], v[36:39], a[52:55]
    buffer_load_dwordx4 v4, s[4:7], s27 offen offset:1024 sc1 lds
    v_mfma_f32_16x16x32_bf16 a[100:103], v[72:75], v[32:35], a[100:103]
    ds_read_b128 v[28:31], v1 offset:14592
    v_cvt_f32_i32 v251, v251
    v_mfma_f32_16x16x32_bf16 a[100:103], v[88:91], v[36:39], a[100:103]
    v_exp_f32 v16, v104
    v_mfma_f32_16x16x32_bf16 a[148:151], v[76:79], v[32:35], a[148:151]
    v_add_f32 v7, v7, v18
    v_add_f32 v7, v7, v19
    v_mfma_f32_16x16x32_bf16 a[148:151], v[92:95], v[36:39], a[148:151]
    s_waitcnt lgkmcnt(2)
    buffer_load_dwordx4 v4, s[4:7], s27 offen offset:2048 sc1 lds
    v_mfma_f32_16x16x32_bf16 a[8:11], v[64:67], v[40:43], a[8:11]
    ds_read_b128 v[32:35], v21 offset:0
    v_cvt_f32_i32 v255, v255
    v_mfma_f32_16x16x32_bf16 a[8:11], v[80:83], v[44:47], a[8:11]
    v_exp_f32 v17, v105
    v_mfma_f32_16x16x32_bf16 a[56:59], v[68:71], v[40:43], a[56:59]
    v_cvt_pk_bf16_f32 v169, v18, v19
    v_fma_f32 v250, v250, v56, v58
    v_mfma_f32_16x16x32_bf16 a[56:59], v[84:87], v[44:47], a[56:59]
    v_exp_f32 v18, v106
    v_mfma_f32_16x16x32_bf16 a[104:107], v[72:75], v[40:43], a[104:107]
    s_add_u32 s27, s27, 24576
    ds_read_b128 v[36:39], v21 offset:12288
    v_add_f32 v7, v7, v16
    v_mfma_f32_16x16x32_bf16 a[104:107], v[88:91], v[44:47], a[104:107]
    v_add_f32 v7, v7, v17
    v_fma_f32 v254, v254, v57, v59
    v_mfma_f32_16x16x32_bf16 a[152:155], v[76:79], v[40:43], a[152:155]
    v_exp_f32 v19, v107
    v_mfma_f32_16x16x32_bf16 a[152:155], v[92:95], v[44:47], a[152:155]
    s_waitcnt lgkmcnt(2)
    v_cvt_pk_bf16_f32 v170, v16, v17
    s_add_u32 s56, s56, 12288
    v_mfma_f32_16x16x32_bf16 a[12:15], v[64:67], v[24:27], a[12:15]
    ds_read_b128 v[40:43], v21 offset:768
    v_mfma_f32_16x16x32_bf16 a[12:15], v[80:83], v[28:31], a[12:15]
    v_exp_f32 v16, v172
    v_mfma_f32_16x16x32_bf16 a[60:63], v[68:71], v[24:27], a[60:63]
    v_add_f32 v7, v7, v18
    v_add_f32 v7, v7, v19
    v_mfma_f32_16x16x32_bf16 a[60:63], v[84:87], v[28:31], a[60:63]
    s_mov_b32 m0, s56
    v_exp_f32 v17, v173
    v_mfma_f32_16x16x32_bf16 a[108:111], v[72:75], v[24:27], a[108:111]
    ds_read_b128 v[44:47], v21 offset:13056
    v_cvt_pk_bf16_f32 v171, v18, v19
    v_mfma_f32_16x16x32_bf16 a[108:111], v[88:91], v[28:31], a[108:111]
    v_exp_f32 v18, v174
    v_mfma_f32_16x16x32_bf16 a[156:159], v[76:79], v[24:27], a[156:159]
    s_add_u32 s29, s28, 49152
    v_add_f32 v8, v8, v16
    v_fma_f32 v251, v251, v56, v58
    v_mfma_f32_16x16x32_bf16 a[156:159], v[92:95], v[28:31], a[156:159]
    s_waitcnt lgkmcnt(2)
    buffer_load_dwordx4 v4, s[4:7], s27 offen offset:0 sc1 lds
    v_mfma_f32_16x16x32_bf16 a[16:19], v[64:67], v[32:35], a[16:19]
    ds_read_b128 v[24:27], v21 offset:1536
    v_add_f32 v8, v8, v17
    v_mfma_f32_16x16x32_bf16 a[16:19], v[80:83], v[36:39], a[16:19]
    s_sub_u32 s3, s29, 147456
    v_exp_f32 v19, v175
    v_mfma_f32_16x16x32_bf16 a[64:67], v[68:71], v[32:35], a[64:67]
    v_cvt_pk_bf16_f32 v172, v16, v17
    v_fma_f32 v255, v255, v57, v59
    v_mfma_f32_16x16x32_bf16 a[64:67], v[84:87], v[36:39], a[64:67]
    v_exp_f32 v16, v108
    v_mfma_f32_16x16x32_bf16 a[112:115], v[72:75], v[32:35], a[112:115]
    ds_read_b128 v[28:31], v21 offset:13824
    v_add_f32 v8, v8, v18
    v_mfma_f32_16x16x32_bf16 a[112:115], v[88:91], v[36:39], a[112:115]
    v_add_f32 v8, v8, v19
    v_cvt_pk_bf16_f32 v147, v248, v252
    v_mfma_f32_16x16x32_bf16 a[160:163], v[76:79], v[32:35], a[160:163]
    v_exp_f32 v17, v109
    v_mfma_f32_16x16x32_bf16 a[160:163], v[92:95], v[36:39], a[160:163]
    s_waitcnt lgkmcnt(2)
    buffer_load_dwordx4 v4, s[4:7], s27 offen offset:1024 sc1 lds
    v_mfma_f32_16x16x32_bf16 a[20:23], v[64:67], v[40:43], a[20:23]
    s_min_u32 s29, s29, s3
    ds_read_b128 v[32:35], v21 offset:2304
    v_cvt_pk_bf16_f32 v173, v18, v19
    v_mfma_f32_16x16x32_bf16 a[20:23], v[80:83], v[44:47], a[20:23]
    v_exp_f32 v18, v110
    v_mfma_f32_16x16x32_bf16 a[68:71], v[68:71], v[40:43], a[68:71]
    v_add_f32 v8, v8, v16
    v_add_f32 v8, v8, v17
    v_mfma_f32_16x16x32_bf16 a[68:71], v[84:87], v[44:47], a[68:71]
    v_exp_f32 v19, v111
    v_mfma_f32_16x16x32_bf16 a[116:119], v[72:75], v[40:43], a[116:119]
    ds_read_b128 v[36:39], v21 offset:14592
    v_cvt_pk_bf16_f32 v151, v249, v253
    v_mfma_f32_16x16x32_bf16 a[116:119], v[88:91], v[44:47], a[116:119]
    buffer_load_dwordx4 v4, s[4:7], s27 offen offset:2048 sc1 lds
    v_mfma_f32_16x16x32_bf16 a[164:167], v[76:79], v[40:43], a[164:167]
    s_sub_u32 s3, s29, s28
    v_cvt_pk_bf16_f32 v174, v16, v17
    v_add_f32 v8, v8, v18
    v_mfma_f32_16x16x32_bf16 a[164:167], v[92:95], v[44:47], a[164:167]
    s_waitcnt lgkmcnt(2)
    v_add_f32 v8, v8, v19
    v_cvt_pk_bf16_f32 v155, v250, v254
    v_mfma_f32_16x16x32_bf16 a[24:27], v[64:67], v[24:27], a[24:27]
    ds_read_b128 v[40:43], v22 offset:0
    v_cvt_pk_bf16_f32 v175, v18, v19
    v_mfma_f32_16x16x32_bf16 a[24:27], v[80:83], v[28:31], a[24:27]
    v_exp_f32 v16, v176
    v_mfma_f32_16x16x32_bf16 a[72:75], v[68:71], v[24:27], a[72:75]
    v_exp_f32 v17, v177
    v_mfma_f32_16x16x32_bf16 a[72:75], v[84:87], v[28:31], a[72:75]
    s_add_u32 s27, s27, 24576
    v_cvt_pk_bf16_f32 v159, v251, v255
    v_mfma_f32_16x16x32_bf16 a[120:123], v[72:75], v[24:27], a[120:123]
    s_add_u32 s56, s56, 36864
    ds_read_b128 v[44:47], v22 offset:12288
    v_mfma_f32_16x16x32_bf16 a[120:123], v[88:91], v[28:31], a[120:123]
    s_mov_b32 s28, s29
    v_exp_f32 v18, v178
    v_mfma_f32_16x16x32_bf16 a[168:171], v[76:79], v[24:27], a[168:171]
    v_add_f32 v5, v5, v16
    v_add_f32 v5, v5, v17
    v_mfma_f32_16x16x32_bf16 a[168:171], v[92:95], v[28:31], a[168:171]
    s_waitcnt lgkmcnt(2)
    v_exp_f32 v19, v179
    v_mfma_f32_16x16x32_bf16 a[28:31], v[64:67], v[32:35], a[28:31]
    s_sub_u32 s58, s56, 147456
    ds_read_b128 v[24:27], v22 offset:768
    v_cvt_pk_bf16_f32 v176, v16, v17
    v_mfma_f32_16x16x32_bf16 a[28:31], v[80:83], v[36:39], a[28:31]
    buffer_store_dwordx4 v[144:147], v20, s[4:7], s81 offen offset:0 sc1
    v_mfma_f32_16x16x32_bf16 a[76:79], v[68:71], v[32:35], a[76:79]
    s_min_u32 s56, s56, s58
    v_exp_f32 v16, v112
    v_mfma_f32_16x16x32_bf16 a[76:79], v[84:87], v[36:39], a[76:79]
    v_add_f32 v5, v5, v18
    v_add_f32 v5, v5, v19
    v_mfma_f32_16x16x32_bf16 a[124:127], v[72:75], v[32:35], a[124:127]
    ds_read_b128 v[28:31], v22 offset:13056
    v_add_u32 v2, s3, v2
    v_mfma_f32_16x16x32_bf16 a[124:127], v[88:91], v[36:39], a[124:127]
    v_exp_f32 v17, v113
    v_mfma_f32_16x16x32_bf16 a[172:175], v[76:79], v[32:35], a[172:175]
    v_cvt_pk_bf16_f32 v177, v18, v19
    v_mfma_f32_16x16x32_bf16 a[172:175], v[92:95], v[36:39], a[172:175]
    s_waitcnt lgkmcnt(2)
    v_exp_f32 v18, v114
    v_mfma_f32_16x16x32_bf16 a[32:35], v[64:67], v[40:43], a[32:35]
    ds_read_b128 v[32:35], v22 offset:1536
    v_add_f32 v5, v5, v16
    v_mfma_f32_16x16x32_bf16 a[32:35], v[80:83], v[44:47], a[32:35]
    buffer_store_dwordx4 v[148:151], v20, s[4:7], s81 offen offset:768 sc1
    v_mfma_f32_16x16x32_bf16 a[80:83], v[68:71], v[40:43], a[80:83]
    v_add_f32 v5, v5, v17
    v_add_u32 v3, s3, v3
    v_mfma_f32_16x16x32_bf16 a[80:83], v[84:87], v[44:47], a[80:83]
    v_exp_f32 v19, v115
    v_mfma_f32_16x16x32_bf16 a[128:131], v[72:75], v[40:43], a[128:131]
    ds_read_b128 v[36:39], v22 offset:13824
    v_cvt_pk_bf16_f32 v178, v16, v17
    v_mfma_f32_16x16x32_bf16 a[128:131], v[88:91], v[44:47], a[128:131]
    v_exp_f32 v16, v180
    v_mfma_f32_16x16x32_bf16 a[176:179], v[76:79], v[40:43], a[176:179]
    v_add_f32 v5, v5, v18
    v_mfma_f32_16x16x32_bf16 a[176:179], v[92:95], v[44:47], a[176:179]
    s_waitcnt lgkmcnt(2)
    v_add_f32 v5, v5, v19
    v_mfma_f32_16x16x32_bf16 a[36:39], v[64:67], v[24:27], a[36:39]
    ds_read_b128 v[40:43], v22 offset:2304
    v_mfma_f32_16x16x32_bf16 a[36:39], v[80:83], v[28:31], a[36:39]
    buffer_store_dwordx4 v[152:155], v20, s[4:7], s81 offen offset:1536 sc1
    v_mfma_f32_16x16x32_bf16 a[84:87], v[68:71], v[24:27], a[84:87]
    v_exp_f32 v17, v181
    v_mfma_f32_16x16x32_bf16 a[84:87], v[84:87], v[28:31], a[84:87]
    v_cvt_pk_bf16_f32 v179, v18, v19
    v_mfma_f32_16x16x32_bf16 a[132:135], v[72:75], v[24:27], a[132:135]
    ds_read_b128 v[44:47], v22 offset:14592
    v_mfma_f32_16x16x32_bf16 a[132:135], v[88:91], v[28:31], a[132:135]
    s_waitcnt lgkmcnt(2)
    v_exp_f32 v18, v182
    v_mfma_f32_16x16x32_bf16 a[180:183], v[76:79], v[24:27], a[180:183]
    s_waitcnt vmcnt(35)
    v_add_f32 v6, v6, v16
    v_add_f32 v6, v6, v17
    v_mfma_f32_16x16x32_bf16 a[180:183], v[92:95], v[28:31], a[180:183]
    s_barrier
    v_mfma_f32_16x16x32_bf16 a[40:43], v[64:67], v[32:35], a[40:43]
    ds_read_b128 v[24:27], v2 offset:0
    v_mfma_f32_16x16x32_bf16 a[40:43], v[80:83], v[36:39], a[40:43]
    v_exp_f32 v19, v183
    v_mfma_f32_16x16x32_bf16 a[88:91], v[68:71], v[32:35], a[88:91]
    v_cvt_pk_bf16_f32 v180, v16, v17
    v_mfma_f32_16x16x32_bf16 a[88:91], v[84:87], v[36:39], a[88:91]
    v_exp_f32 v16, v116
    v_mfma_f32_16x16x32_bf16 a[136:139], v[72:75], v[32:35], a[136:139]
    ds_read_b128 v[28:31], v3 offset:0
    v_add_f32 v6, v6, v18
    v_mfma_f32_16x16x32_bf16 a[136:139], v[88:91], v[36:39], a[136:139]
    buffer_store_dwordx4 v[156:159], v20, s[4:7], s81 offen offset:2304 sc1
    v_mfma_f32_16x16x32_bf16 a[184:187], v[76:79], v[32:35], a[184:187]
    v_add_f32 v6, v6, v19
    v_mfma_f32_16x16x32_bf16 a[184:187], v[92:95], v[36:39], a[184:187]
    s_waitcnt lgkmcnt(2)
    v_exp_f32 v17, v117
    v_mfma_f32_16x16x32_bf16 a[44:47], v[64:67], v[40:43], a[44:47]
    ds_read_b128 v[32:35], v2 offset:6144
    v_cvt_pk_bf16_f32 v181, v18, v19
    v_mfma_f32_16x16x32_bf16 a[44:47], v[80:83], v[44:47], a[44:47]
    v_exp_f32 v18, v118
    v_mfma_f32_16x16x32_bf16 a[92:95], v[68:71], v[40:43], a[92:95]
    v_add_f32 v6, v6, v16
    v_add_f32 v6, v6, v17
    v_mfma_f32_16x16x32_bf16 a[92:95], v[84:87], v[44:47], a[92:95]
    v_exp_f32 v19, v119
    v_mfma_f32_16x16x32_bf16 a[140:143], v[72:75], v[40:43], a[140:143]
    ds_read_b128 v[36:39], v3 offset:6144
    v_cvt_pk_bf16_f32 v182, v16, v17
    v_mfma_f32_16x16x32_bf16 a[140:143], v[88:91], v[44:47], a[140:143]
    v_add_f32 v6, v6, v18
    v_add_f32 v6, v6, v19
    v_mfma_f32_16x16x32_bf16 a[188:191], v[76:79], v[40:43], a[188:191]
    v_cvt_pk_bf16_f32 v183, v18, v19
    v_mfma_f32_16x16x32_bf16 a[188:191], v[92:95], v[44:47], a[188:191]
    s_waitcnt lgkmcnt(2)
    v_mfma_f32_16x16x32_bf16 v[64:67], v[24:27], a[192:195], v[128:131]
    ds_read_b128 v[40:43], v2 offset:128
    v_mfma_f32_16x16x32_bf16 v[64:67], v[28:31], a[196:199], v[64:67]
    buffer_load_dwordx4 v[248:251], v9, s[64:67], s34 offen offset:384 nt
    v_mfma_f32_16x16x32_bf16 v[68:71], v[24:27], a[216:219], v[132:135]
    v_exp_f32 v16, v184
    v_mfma_f32_16x16x32_bf16 v[68:71], v[28:31], a[220:223], v[68:71]
    v_exp_f32 v17, v185
    v_mfma_f32_16x16x32_bf16 v[72:75], v[24:27], a[240:243], v[136:139]
    ds_read_b128 v[44:47], v3 offset:128
    v_mfma_f32_16x16x32_bf16 v[72:75], v[28:31], a[244:247], v[72:75]
    v_exp_f32 v18, v186
    v_mfma_f32_16x16x32_bf16 v[76:79], v[24:27], v[200:203], v[140:143]
    ds_read_b128 v[56:59], v10 offset:384
    v_add_f32 v7, v7, v16
    v_mfma_f32_16x16x32_bf16 v[76:79], v[28:31], v[204:207], v[76:79]
    s_waitcnt lgkmcnt(3)
    v_add_f32 v7, v7, v17
    s_waitcnt vmcnt(27)
    v_mfma_f32_16x16x32_bf16 v[96:99], v[32:35], a[192:195], v[128:131]
    ds_read_b128 v[24:27], v2 offset:6272
    v_cvt_f32_i32 v224, v224
    v_mfma_f32_16x16x32_bf16 v[96:99], v[36:39], a[196:199], v[96:99]
    v_exp_f32 v19, v187
    v_mfma_f32_16x16x32_bf16 v[100:103], v[32:35], a[216:219], v[132:135]
    v_cvt_pk_bf16_f32 v184, v16, v17
    v_cvt_f32_i32 v225, v225
    v_mfma_f32_16x16x32_bf16 v[100:103], v[36:39], a[220:223], v[100:103]
    buffer_load_dwordx4 v[252:255], v9, s[64:67], s34 offen offset:1920 nt
    v_mfma_f32_16x16x32_bf16 v[104:107], v[32:35], a[240:243], v[136:139]
    ds_read_b128 v[28:31], v3 offset:6272
    v_mfma_f32_16x16x32_bf16 v[104:107], v[36:39], a[244:247], v[104:107]
    v_exp_f32 v16, v120
    v_mfma_f32_16x16x32_bf16 v[108:111], v[32:35], v[200:203], v[140:143]
    v_add_f32 v7, v7, v18
    v_add_f32 v7, v7, v19
    v_mfma_f32_16x16x32_bf16 v[108:111], v[36:39], v[204:207], v[108:111]
    s_waitcnt lgkmcnt(3)
    v_exp_f32 v17, v121
    v_mfma_f32_16x16x32_bf16 v[64:67], v[40:43], a[200:203], v[64:67]
    ds_read_b128 v[32:35], v2 offset:256
    v_cvt_pk_bf16_f32 v185, v18, v19
    v_mfma_f32_16x16x32_bf16 v[64:67], v[44:47], a[204:207], v[64:67]
    v_exp_f32 v18, v122
    v_mfma_f32_16x16x32_bf16 v[68:71], v[40:43], a[224:227], v[68:71]
    v_add_f32 v7, v7, v16
    v_cvt_f32_i32 v228, v228
    v_mfma_f32_16x16x32_bf16 v[68:71], v[44:47], a[228:231], v[68:71]
    ds_read_b128 v[60:63], v10 offset:768
    v_add_f32 v7, v7, v17
    v_mfma_f32_16x16x32_bf16 v[72:75], v[40:43], a[248:251], v[72:75]
    ds_read_b128 v[36:39], v3 offset:256
    v_mfma_f32_16x16x32_bf16 v[72:75], v[44:47], a[252:255], v[72:75]
    v_exp_f32 v19, v123
    v_mfma_f32_16x16x32_bf16 v[76:79], v[40:43], v[208:211], v[76:79]
    v_cvt_pk_bf16_f32 v186, v16, v17
    v_mfma_f32_16x16x32_bf16 v[76:79], v[44:47], v[212:215], v[76:79]
    s_waitcnt lgkmcnt(3)
    v_exp_f32 v16, v188
    v_mfma_f32_16x16x32_bf16 v[96:99], v[24:27], a[200:203], v[96:99]
    ds_read_b128 v[40:43], v2 offset:6400
    v_add_f32 v7, v7, v18
    v_mfma_f32_16x16x32_bf16 v[96:99], v[28:31], a[204:207], v[96:99]
    v_add_f32 v7, v7, v19
    v_cvt_f32_i32 v229, v229
    v_mfma_f32_16x16x32_bf16 v[100:103], v[24:27], a[224:227], v[100:103]
    v_exp_f32 v17, v189
    v_mfma_f32_16x16x32_bf16 v[100:103], v[28:31], a[228:231], v[100:103]
    v_cvt_pk_bf16_f32 v187, v18, v19
    v_mfma_f32_16x16x32_bf16 v[104:107], v[24:27], a[248:251], v[104:107]
    ds_read_b128 v[44:47], v3 offset:6400
    v_fma_f32 v224, v224, v48, v50
    v_mfma_f32_16x16x32_bf16 v[104:107], v[28:31], a[252:255], v[104:107]
    s_waitcnt vmcnt(11)
    v_subrev_u32 v52, s92, v52
    v_cmp_lt_u32 vcc, 15, v52
    v_mfma_f32_16x16x32_bf16 v[108:111], v[24:27], v[208:211], v[108:111]
    s_add_u32 s29, s30, 49152
    v_exp_f32 v18, v190
    v_mfma_f32_16x16x32_bf16 v[108:111], v[28:31], v[212:215], v[108:111]
    s_waitcnt lgkmcnt(2)
    v_add_f32 v8, v8, v16
    v_add_f32 v8, v8, v17
    v_mfma_f32_16x16x32_bf16 v[64:67], v[32:35], a[208:211], v[64:67]
    s_and_b32 s59, vcc_lo, 0xff
    ds_read_b128 v[24:27], v2 offset:12288
    v_fma_f32 v225, v225, v49, v51
    v_mfma_f32_16x16x32_bf16 v[64:67], v[36:39], a[212:215], v[64:67]
    s_cbranch_scc1 L_pollslow4
L_pollok4:
    v_mfma_f32_16x16x32_bf16 v[68:71], v[32:35], a[232:235], v[68:71]
    s_add_u32 s92, s92, 1
    v_exp_f32 v19, v191
    v_mfma_f32_16x16x32_bf16 v[68:71], v[36:39], a[236:239], v[68:71]
    s_sub_u32 s3, s29, 147456
    v_cvt_pk_bf16_f32 v188, v16, v17
    v_mfma_f32_16x16x32_bf16 v[72:75], v[32:35], v[192:195], v[72:75]
    s_mov_b32 m0, s26
    ds_read_b128 v[28:31], v3 offset:12288
    v_mfma_f32_16x16x32_bf16 v[72:75], v[36:39], v[196:199], v[72:75]
    v_exp_f32 v16, v124
    v_mfma_f32_16x16x32_bf16 v[76:79], v[32:35], v[216:219], v[76:79]
    s_min_u32 s29, s29, s3
    v_add_f32 v8, v8, v18
    v_add_f32 v8, v8, v19
    v_mfma_f32_16x16x32_bf16 v[76:79], v[36:39], v[220:223], v[76:79]
    s_waitcnt lgkmcnt(2)
    buffer_load_dwordx4 v4, s[4:7], s32 offen offset:0 sc1 lds
    v_mfma_f32_16x16x32_bf16 v[96:99], v[40:43], a[208:211], v[96:99]
    ds_read_b128 v[32:35], v2 offset:18432
    v_fma_f32 v228, v228, v48, v50
    v_mfma_f32_16x16x32_bf16 v[96:99], v[44:47], a[212:215], v[96:99]
    v_exp_f32 v17, v125
    v_mfma_f32_16x16x32_bf16 v[100:103], v[40:43], a[232:235], v[100:103]
    v_cvt_pk_bf16_f32 v189, v18, v19
    v_fma_f32 v229, v229, v49, v51
    v_mfma_f32_16x16x32_bf16 v[100:103], v[44:47], a[236:239], v[100:103]
    buffer_load_dwordx4 v4, s[4:7], s32 offen offset:1024 sc1 lds
    v_mfma_f32_16x16x32_bf16 v[104:107], v[40:43], v[192:195], v[104:107]
    s_sub_u32 s3, s29, s30
    ds_read_b128 v[36:39], v3 offset:18432
    v_mfma_f32_16x16x32_bf16 v[104:107], v[44:47], v[196:199], v[104:107]
    v_exp_f32 v18, v126
    v_mfma_f32_16x16x32_bf16 v[108:111], v[40:43], v[216:219], v[108:111]
    v_add_f32 v8, v8, v16
    v_add_f32 v8, v8, v17
    v_mfma_f32_16x16x32_bf16 v[108:111], v[44:47], v[220:223], v[108:111]
    s_waitcnt lgkmcnt(2)
    v_exp_f32 v19, v127
    v_mfma_f32_16x16x32_bf16 v[80:83], v[24:27], a[192:195], v[128:131]
    ds_read_b128 v[40:43], v2 offset:12416
    v_cvt_pk_bf16_f32 v190, v16, v17
    v_mfma_f32_16x16x32_bf16 v[80:83], v[28:31], a[196:199], v[80:83]
    buffer_load_dwordx4 v4, s[4:7], s32 offen offset:2048 sc1 lds
    v_mfma_f32_16x16x32_bf16 v[84:87], v[24:27], a[216:219], v[132:135]
    v_add_f32 v8, v8, v18
    v_add_f32 v8, v8, v19
    v_cvt_pk_bf16_f32 v191, v18, v19
    v_mfma_f32_16x16x32_bf16 v[84:87], v[28:31], a[220:223], v[84:87]
    s_mov_b32 s30, s29
    v_cvt_pk_bf16_f32 v224, v224, v225
    v_cvt_pk_bf16_f32 v228, v228, v229
    v_mfma_f32_16x16x32_bf16 v[88:91], v[24:27], a[240:243], v[136:139]
    s_add_u32 s32, s32, 24576
    ds_read_b128 v[44:47], v3 offset:12416
    v_mfma_f32_16x16x32_bf16 v[88:91], v[28:31], a[244:247], v[88:91]
    v_exp_f32 v16, v64
    v_mfma_f32_16x16x32_bf16 v[92:95], v[24:27], v[200:203], v[140:143]
    v_exp_f32 v17, v65
    v_mfma_f32_16x16x32_bf16 v[92:95], v[28:31], v[204:207], v[92:95]
    s_waitcnt lgkmcnt(2)
    v_exp_f32 v18, v66
    v_mfma_f32_16x16x32_bf16 v[112:115], v[32:35], a[192:195], v[128:131]
    s_add_u32 s26, s26, 12288
    ds_read_b128 v[24:27], v2 offset:18560
    v_add_f32 v5, v5, v16
    v_mfma_f32_16x16x32_bf16 v[112:115], v[36:39], a[196:199], v[112:115]
    s_mov_b32 m0, s26
    v_add_f32 v5, v5, v17
    v_cvt_f32_i32 v226, v226
    v_mfma_f32_16x16x32_bf16 v[116:119], v[32:35], a[216:219], v[132:135]
    v_exp_f32 v19, v67
    v_mfma_f32_16x16x32_bf16 v[116:119], v[36:39], a[220:223], v[116:119]
    v_cvt_pk_bf16_f32 v64, v16, v17
    v_add_u32 v1, s3, v1
    v_mfma_f32_16x16x32_bf16 v[120:123], v[32:35], a[240:243], v[136:139]
    ds_read_b128 v[28:31], v3 offset:18560
    v_cvt_f32_i32 v227, v227
    v_mfma_f32_16x16x32_bf16 v[120:123], v[36:39], a[244:247], v[120:123]
    buffer_load_dwordx4 v4, s[4:7], s32 offen offset:0 sc1 lds
    v_mfma_f32_16x16x32_bf16 v[124:127], v[32:35], v[200:203], v[140:143]
    v_exp_f32 v16, v96
    v_mfma_f32_16x16x32_bf16 v[124:127], v[36:39], v[204:207], v[124:127]
    s_waitcnt lgkmcnt(2)
    v_add_f32 v5, v5, v18
    v_add_f32 v5, v5, v19
    v_mfma_f32_16x16x32_bf16 v[80:83], v[40:43], a[200:203], v[80:83]
    ds_read_b128 v[32:35], v2 offset:12544
    v_add_u32 v21, s3, v21
    v_mfma_f32_16x16x32_bf16 v[80:83], v[44:47], a[204:207], v[80:83]
    v_exp_f32 v17, v97
    v_mfma_f32_16x16x32_bf16 v[84:87], v[40:43], a[224:227], v[84:87]
    v_cvt_pk_bf16_f32 v65, v18, v19
    v_cvt_f32_i32 v230, v230
    v_mfma_f32_16x16x32_bf16 v[84:87], v[44:47], a[228:231], v[84:87]
    buffer_load_dwordx4 v4, s[4:7], s32 offen offset:1024 sc1 lds
    v_mfma_f32_16x16x32_bf16 v[88:91], v[40:43], a[248:251], v[88:91]
    ds_read_b128 v[36:39], v3 offset:12544
    v_cvt_f32_i32 v231, v231
    v_mfma_f32_16x16x32_bf16 v[88:91], v[44:47], a[252:255], v[88:91]
    v_exp_f32 v18, v98
    v_mfma_f32_16x16x32_bf16 v[92:95], v[40:43], v[208:211], v[92:95]
    v_add_f32 v5, v5, v16
    v_add_f32 v5, v5, v17
    v_mfma_f32_16x16x32_bf16 v[92:95], v[44:47], v[212:215], v[92:95]
    s_waitcnt lgkmcnt(2)
    buffer_load_dwordx4 v4, s[4:7], s32 offen offset:2048 sc1 lds
    v_mfma_f32_16x16x32_bf16 v[112:115], v[24:27], a[200:203], v[112:115]
    ds_read_b128 v[40:43], v2 offset:18688
    v_add_u32 v22, s3, v22
    v_mfma_f32_16x16x32_bf16 v[112:115], v[28:31], a[204:207], v[112:115]
    v_exp_f32 v19, v99
    v_mfma_f32_16x16x32_bf16 v[116:119], v[24:27], a[224:227], v[116:119]
    v_cvt_pk_bf16_f32 v66, v16, v17
    v_fma_f32 v226, v226, v56, v58
    v_mfma_f32_16x16x32_bf16 v[116:119], v[28:31], a[228:231], v[116:119]
    v_exp_f32 v16, v68
    v_mfma_f32_16x16x32_bf16 v[120:123], v[24:27], a[248:251], v[120:123]
    ds_read_b128 v[44:47], v3 offset:18688
    v_add_f32 v5, v5, v18
    v_mfma_f32_16x16x32_bf16 v[120:123], v[28:31], a[252:255], v[120:123]
    s_waitcnt lgkmcnt(2)
    v_add_f32 v5, v5, v19
    s_add_u32 s32, s32, 24576
    v_mfma_f32_16x16x32_bf16 v[124:127], v[24:27], v[208:211], v[124:127]
    s_waitcnt vmcnt(8)
    v_exp_f32 v17, v69
    v_mfma_f32_16x16x32_bf16 v[124:127], v[28:31], v[212:215], v[124:127]
    s_barrier
    v_cvt_pk_bf16_f32 v67, v18, v19
    v_mfma_f32_16x16x32_bf16 v[80:83], v[32:35], a[208:211], v[80:83]
    s_add_u32 s26, s26, 36864
    ds_read_b128 v[24:27], v1 offset:0
    v_fma_f32 v227, v227, v57, v59
    v_mfma_f32_16x16x32_bf16 v[80:83], v[36:39], a[212:215], v[80:83]
    s_sub_u32 s57, s26, 147456
    v_exp_f32 v18, v70
    v_mfma_f32_16x16x32_bf16 v[84:87], v[32:35], a[232:235], v[84:87]
    v_add_f32 v6, v6, v16
    v_add_f32 v6, v6, v17
    v_mfma_f32_16x16x32_bf16 v[84:87], v[36:39], a[236:239], v[84:87]
    v_exp_f32 v19, v71
    v_mfma_f32_16x16x32_bf16 v[88:91], v[32:35], v[192:195], v[88:91]
    s_min_u32 s26, s26, s57
    ds_read_b128 v[28:31], v1 offset:12288
    v_cvt_pk_bf16_f32 v68, v16, v17
    v_mfma_f32_16x16x32_bf16 v[88:91], v[36:39], v[196:199], v[88:91]
    v_exp_f32 v16, v100
    v_mfma_f32_16x16x32_bf16 v[92:95], v[32:35], v[216:219], v[92:95]
    v_add_f32 v6, v6, v18
    v_add_f32 v6, v6, v19
    v_mfma_f32_16x16x32_bf16 v[92:95], v[36:39], v[220:223], v[92:95]
    s_waitcnt lgkmcnt(2)
    v_exp_f32 v17, v101
    v_mfma_f32_16x16x32_bf16 v[112:115], v[40:43], a[208:211], v[112:115]
    ds_read_b128 v[32:35], v1 offset:768
    v_add_u32 v55, 1, v55
    v_mfma_f32_16x16x32_bf16 v[112:115], v[44:47], a[212:215], v[112:115]
    buffer_store_dword v55, v13, s[20:23], 0 offen sc1
    v_mfma_f32_16x16x32_bf16 v[116:119], v[40:43], a[232:235], v[116:119]
    v_cvt_pk_bf16_f32 v69, v18, v19
    v_fma_f32 v230, v230, v56, v58
    v_mfma_f32_16x16x32_bf16 v[116:119], v[44:47], a[236:239], v[116:119]
    v_exp_f32 v18, v102
    v_mfma_f32_16x16x32_bf16 v[120:123], v[40:43], v[192:195], v[120:123]
    ds_read_b128 v[36:39], v1 offset:13056
    v_add_f32 v6, v6, v16
    v_mfma_f32_16x16x32_bf16 v[120:123], v[44:47], v[196:199], v[120:123]
    v_add_f32 v6, v6, v17
    v_fma_f32 v231, v231, v57, v59
    v_mfma_f32_16x16x32_bf16 v[124:127], v[40:43], v[216:219], v[124:127]
    v_exp_f32 v19, v103
    v_mfma_f32_16x16x32_bf16 v[124:127], v[44:47], v[220:223], v[124:127]
    s_waitcnt lgkmcnt(2)
    v_cvt_pk_bf16_f32 v70, v16, v17
    v_add_f32 v6, v6, v18
    v_add_f32 v6, v6, v19
    v_cvt_pk_bf16_f32 v71, v18, v19
    v_cvt_pk_bf16_f32 v225, v226, v227
    v_mfma_f32_16x16x32_bf16 a[0:3], v[160:163], v[24:27], a[0:3]
    ds_read_b128 v[40:43], v1 offset:1536
    s_add_u32 s35, s35, 196608
    v_mfma_f32_16x16x32_bf16 a[0:3], v[176:179], v[28:31], a[0:3]
    s_mov_b32 m0, s56
    v_exp_f32 v16, v72
    v_mfma_f32_16x16x32_bf16 a[48:51], v[164:167], v[24:27], a[48:51]
    s_sub_u32 s36, s35, 1572864
    v_exp_f32 v17, v73
    v_mfma_f32_16x16x32_bf16 a[48:51], v[180:183], v[28:31], a[48:51]
    v_cvt_pk_bf16_f32 v229, v230, v231
    s_waitcnt vmcnt(32)
    v_mfma_f32_16x16x32_bf16 a[96:99], v[168:171], v[24:27], a[96:99]
    ds_read_b128 v[44:47], v1 offset:13824
    v_mfma_f32_16x16x32_bf16 a[96:99], v[184:187], v[28:31], a[96:99]
    s_min_u32 s35, s35, s36
    buffer_load_dwordx4 v4, s[4:7], s27 offen offset:0 sc1 lds
    v_mfma_f32_16x16x32_bf16 a[144:147], v[172:175], v[24:27], a[144:147]
    v_exp_f32 v18, v74
    v_mfma_f32_16x16x32_bf16 a[144:147], v[188:191], v[28:31], a[144:147]
    s_waitcnt lgkmcnt(2)
    v_add_f32 v7, v7, v16
    v_add_f32 v7, v7, v17
    v_mfma_f32_16x16x32_bf16 a[4:7], v[160:163], v[32:35], a[4:7]
    s_add_u32 s36, s35, 3072
    ds_read_b128 v[24:27], v1 offset:2304
    v_cvt_f32_i32 v232, v232
    v_mfma_f32_16x16x32_bf16 a[4:7], v[176:179], v[36:39], a[4:7]
    v_exp_f32 v19, v75
    v_mfma_f32_16x16x32_bf16 a[52:55], v[164:167], v[32:35], a[52:55]
    v_cvt_pk_bf16_f32 v72, v16, v17
    v_mfma_f32_16x16x32_bf16 a[52:55], v[180:183], v[36:39], a[52:55]
    v_exp_f32 v16, v104
    v_mfma_f32_16x16x32_bf16 a[100:103], v[168:171], v[32:35], a[100:103]
    s_add_u32 s81, s81, 196608
    ds_read_b128 v[28:31], v1 offset:14592
    v_add_f32 v7, v7, v18
    v_mfma_f32_16x16x32_bf16 a[100:103], v[184:187], v[36:39], a[100:103]
    v_add_f32 v7, v7, v19
    v_cvt_f32_i32 v233, v233
    v_mfma_f32_16x16x32_bf16 a[148:151], v[172:175], v[32:35], a[148:151]
    v_exp_f32 v17, v105
    v_mfma_f32_16x16x32_bf16 a[148:151], v[188:191], v[36:39], a[148:151]
    s_waitcnt lgkmcnt(2)
    buffer_load_dwordx4 v4, s[4:7], s27 offen offset:1024 sc1 lds
    v_mfma_f32_16x16x32_bf16 a[8:11], v[160:163], v[40:43], a[8:11]
    ds_read_b128 v[32:35], v21 offset:0
    v_cvt_pk_bf16_f32 v73, v18, v19
    v_mfma_f32_16x16x32_bf16 a[8:11], v[176:179], v[44:47], a[8:11]
    v_exp_f32 v18, v106
    v_mfma_f32_16x16x32_bf16 a[56:59], v[164:167], v[40:43], a[56:59]
    v_add_f32 v7, v7, v16
    v_add_f32 v7, v7, v17
    v_mfma_f32_16x16x32_bf16 a[56:59], v[180:183], v[44:47], a[56:59]
    buffer_load_dwordx4 v[144:147], v12, s[68:71], s35 offen offset:0 nt
    v_mfma_f32_16x16x32_bf16 a[104:107], v[168:171], v[40:43], a[104:107]
    ds_read_b128 v[36:39], v21 offset:12288
    v_cvt_f32_i32 v236, v236
    v_mfma_f32_16x16x32_bf16 a[104:107], v[184:187], v[44:47], a[104:107]
    v_exp_f32 v19, v107
    v_mfma_f32_16x16x32_bf16 a[152:155], v[172:175], v[40:43], a[152:155]
    v_cvt_pk_bf16_f32 v74, v16, v17
    v_cvt_f32_i32 v237, v237
    v_mfma_f32_16x16x32_bf16 a[152:155], v[188:191], v[44:47], a[152:155]
    s_waitcnt lgkmcnt(2)
    buffer_load_dwordx4 v4, s[4:7], s27 offen offset:2048 sc1 lds
    v_mfma_f32_16x16x32_bf16 a[12:15], v[160:163], v[24:27], a[12:15]
    ds_read_b128 v[40:43], v21 offset:768
    v_mfma_f32_16x16x32_bf16 a[12:15], v[176:179], v[28:31], a[12:15]
    v_exp_f32 v16, v76
    v_mfma_f32_16x16x32_bf16 a[60:63], v[164:167], v[24:27], a[60:63]
    v_add_f32 v7, v7, v18
    v_add_f32 v7, v7, v19
    v_mfma_f32_16x16x32_bf16 a[60:63], v[180:183], v[28:31], a[60:63]
    buffer_load_dwordx4 v[148:151], v12, s[68:71], s35 offen offset:768 nt
    v_mfma_f32_16x16x32_bf16 a[108:111], v[168:171], v[24:27], a[108:111]
    ds_read_b128 v[44:47], v21 offset:13056
    v_fma_f32 v232, v232, v48, v50
    v_mfma_f32_16x16x32_bf16 a[108:111], v[184:187], v[28:31], a[108:111]
    v_exp_f32 v17, v77
    v_mfma_f32_16x16x32_bf16 a[156:159], v[172:175], v[24:27], a[156:159]
    s_add_u32 s29, s28, 49152
    v_cvt_pk_bf16_f32 v75, v18, v19
    s_add_u32 s27, s27, 24576
    v_mfma_f32_16x16x32_bf16 a[156:159], v[188:191], v[28:31], a[156:159]
    s_waitcnt lgkmcnt(2)
    buffer_load_dwordx4 v[152:155], v12, s[68:71], s35 offen offset:1536 nt
    v_mfma_f32_16x16x32_bf16 a[16:19], v[160:163], v[32:35], a[16:19]
    ds_read_b128 v[24:27], v21 offset:1536
    v_fma_f32 v233, v233, v49, v51
    v_mfma_f32_16x16x32_bf16 a[16:19], v[176:179], v[36:39], a[16:19]
    s_sub_u32 s3, s29, 147456
    v_exp_f32 v18, v78
    v_mfma_f32_16x16x32_bf16 a[64:67], v[164:167], v[32:35], a[64:67]
    v_add_f32 v8, v8, v16
    v_add_f32 v8, v8, v17
    v_mfma_f32_16x16x32_bf16 a[64:67], v[180:183], v[36:39], a[64:67]
    s_add_u32 s56, s56, 12288
    v_exp_f32 v19, v79
    v_mfma_f32_16x16x32_bf16 a[112:115], v[168:171], v[32:35], a[112:115]
    ds_read_b128 v[28:31], v21 offset:13824
    v_cvt_pk_bf16_f32 v76, v16, v17
    v_mfma_f32_16x16x32_bf16 a[112:115], v[184:187], v[36:39], a[112:115]
    v_exp_f32 v16, v108
    v_mfma_f32_16x16x32_bf16 a[160:163], v[172:175], v[32:35], a[160:163]
    v_add_f32 v8, v8, v18
    v_add_f32 v8, v8, v19
    v_mfma_f32_16x16x32_bf16 a[160:163], v[188:191], v[36:39], a[160:163]
    s_waitcnt lgkmcnt(2)
    buffer_load_dwordx4 v[156:159], v12, s[68:71], s35 offen offset:2304 nt
    v_mfma_f32_16x16x32_bf16 a[20:23], v[160:163], v[40:43], a[20:23]
    s_mov_b32 m0, s56
    ds_read_b128 v[32:35], v21 offset:2304
    v_fma_f32 v236, v236, v48, v50
    v_mfma_f32_16x16x32_bf16 a[20:23], v[176:179], v[44:47], a[20:23]
    s_min_u32 s29, s29, s3
    v_exp_f32 v17, v109
    v_mfma_f32_16x16x32_bf16 a[68:71], v[164:167], v[40:43], a[68:71]
    v_cvt_pk_bf16_f32 v77, v18, v19
    v_fma_f32 v237, v237, v49, v51
    v_mfma_f32_16x16x32_bf16 a[68:71], v[180:183], v[44:47], a[68:71]
    v_exp_f32 v18, v110
    v_mfma_f32_16x16x32_bf16 a[116:119], v[168:171], v[40:43], a[116:119]
    ds_read_b128 v[36:39], v21 offset:14592
    v_add_f32 v8, v8, v16
    v_mfma_f32_16x16x32_bf16 a[116:119], v[184:187], v[44:47], a[116:119]
    v_add_f32 v8, v8, v17
    v_cvt_pk_bf16_f32 v232, v232, v233
    v_mfma_f32_16x16x32_bf16 a[164:167], v[172:175], v[40:43], a[164:167]
    s_sub_u32 s3, s29, s28
    v_exp_f32 v19, v111
    v_mfma_f32_16x16x32_bf16 a[164:167], v[188:191], v[44:47], a[164:167]
    s_waitcnt lgkmcnt(2)
    buffer_load_dwordx4 v4, s[4:7], s27 offen offset:0 sc1 lds
    v_mfma_f32_16x16x32_bf16 a[24:27], v[160:163], v[24:27], a[24:27]
    ds_read_b128 v[40:43], v22 offset:0
    v_cvt_pk_bf16_f32 v78, v16, v17
    v_mfma_f32_16x16x32_bf16 a[24:27], v[176:179], v[28:31], a[24:27]
    v_add_f32 v8, v8, v18
    v_add_f32 v8, v8, v19
    v_mfma_f32_16x16x32_bf16 a[72:75], v[164:167], v[24:27], a[72:75]
    v_cvt_pk_bf16_f32 v79, v18, v19
    v_cvt_pk_bf16_f32 v236, v236, v237
    v_mfma_f32_16x16x32_bf16 a[72:75], v[180:183], v[28:31], a[72:75]
    v_exp_f32 v16, v80
    v_mfma_f32_16x16x32_bf16 a[120:123], v[168:171], v[24:27], a[120:123]
    ds_read_b128 v[44:47], v22 offset:12288
    v_mfma_f32_16x16x32_bf16 a[120:123], v[184:187], v[28:31], a[120:123]
    s_mov_b32 s28, s29
    v_exp_f32 v17, v81
    v_mfma_f32_16x16x32_bf16 a[168:171], v[172:175], v[24:27], a[168:171]
    v_exp_f32 v18, v82
    v_mfma_f32_16x16x32_bf16 a[168:171], v[188:191], v[28:31], a[168:171]
    s_waitcnt lgkmcnt(2)
    v_add_f32 v5, v5, v16
    v_add_f32 v5, v5, v17
    v_mfma_f32_16x16x32_bf16 a[28:31], v[160:163], v[32:35], a[28:31]
    ds_read_b128 v[24:27], v22 offset:768
    v_cvt_f32_i32 v234, v234
    v_mfma_f32_16x16x32_bf16 a[28:31], v[176:179], v[36:39], a[28:31]
    buffer_load_dwordx4 v4, s[4:7], s27 offen offset:1024 sc1 lds
    v_mfma_f32_16x16x32_bf16 a[76:79], v[164:167], v[32:35], a[76:79]
    v_exp_f32 v19, v83
    v_mfma_f32_16x16x32_bf16 a[76:79], v[180:183], v[36:39], a[76:79]
    v_cvt_pk_bf16_f32 v80, v16, v17
    v_cvt_f32_i32 v235, v235
    v_mfma_f32_16x16x32_bf16 a[124:127], v[168:171], v[32:35], a[124:127]
    ds_read_b128 v[28:31], v22 offset:13056
    v_add_u32 v2, s3, v2
    v_mfma_f32_16x16x32_bf16 a[124:127], v[184:187], v[36:39], a[124:127]
    v_exp_f32 v16, v112
    v_mfma_f32_16x16x32_bf16 a[172:175], v[172:175], v[32:35], a[172:175]
    v_add_f32 v5, v5, v18
    v_add_f32 v5, v5, v19
    v_mfma_f32_16x16x32_bf16 a[172:175], v[188:191], v[36:39], a[172:175]
    s_waitcnt lgkmcnt(2)
    v_exp_f32 v17, v113
    v_mfma_f32_16x16x32_bf16 a[32:35], v[160:163], v[40:43], a[32:35]
    ds_read_b128 v[32:35], v22 offset:1536
    v_cvt_pk_bf16_f32 v81, v18, v19
    v_mfma_f32_16x16x32_bf16 a[32:35], v[176:179], v[44:47], a[32:35]
    buffer_load_dwordx4 v4, s[4:7], s27 offen offset:2048 sc1 lds
    v_mfma_f32_16x16x32_bf16 a[80:83], v[164:167], v[40:43], a[80:83]
    v_exp_f32 v18, v114
    v_mfma_f32_16x16x32_bf16 a[80:83], v[180:183], v[44:47], a[80:83]
    v_add_f32 v5, v5, v16
    v_add_f32 v5, v5, v17
    v_mfma_f32_16x16x32_bf16 a[128:131], v[168:171], v[40:43], a[128:131]
    ds_read_b128 v[36:39], v22 offset:13824
    v_cvt_f32_i32 v238, v238
    v_mfma_f32_16x16x32_bf16 a[128:131], v[184:187], v[44:47], a[128:131]
    v_exp_f32 v19, v115
    v_mfma_f32_16x16x32_bf16 a[176:179], v[172:175], v[40:43], a[176:179]
    v_cvt_pk_bf16_f32 v82, v16, v17
    v_add_u32 v3, s3, v3
    v_mfma_f32_16x16x32_bf16 a[176:179], v[188:191], v[44:47], a[176:179]
    s_waitcnt lgkmcnt(2)
    v_exp_f32 v16, v84
    v_mfma_f32_16x16x32_bf16 a[36:39], v[160:163], v[24:27], a[36:39]
    ds_read_b128 v[40:43], v22 offset:2304
    v_add_f32 v5, v5, v18
    v_mfma_f32_16x16x32_bf16 a[36:39], v[176:179], v[28:31], a[36:39]
    v_add_f32 v5, v5, v19
    v_cvt_f32_i32 v239, v239
    v_mfma_f32_16x16x32_bf16 a[84:87], v[164:167], v[24:27], a[84:87]
    v_exp_f32 v17, v85
    v_mfma_f32_16x16x32_bf16 a[84:87], v[180:183], v[28:31], a[84:87]
    s_add_u32 s27, s27, 24576
    v_cvt_pk_bf16_f32 v83, v18, v19
    v_fma_f32 v234, v234, v56, v58
    v_mfma_f32_16x16x32_bf16 a[132:135], v[168:171], v[24:27], a[132:135]
    s_add_u32 s56, s56, 36864
    ds_read_b128 v[44:47], v22 offset:14592
    v_mfma_f32_16x16x32_bf16 a[132:135], v[184:187], v[28:31], a[132:135]
    s_waitcnt lgkmcnt(2)
    v_exp_f32 v18, v86
    v_mfma_f32_16x16x32_bf16 a[180:183], v[172:175], v[24:27], a[180:183]
    s_waitcnt vmcnt(32)
    v_add_f32 v6, v6, v16
    v_add_f32 v6, v6, v17
    v_mfma_f32_16x16x32_bf16 a[180:183], v[188:191], v[28:31], a[180:183]
    s_barrier
    v_fma_f32 v235, v235, v57, v59
    v_mfma_f32_16x16x32_bf16 a[40:43], v[160:163], v[32:35], a[40:43]
    s_sub_u32 s58, s56, 147456
    ds_read_b128 v[24:27], v2 offset:0
    v_mfma_f32_16x16x32_bf16 a[40:43], v[176:179], v[36:39], a[40:43]
    v_exp_f32 v19, v87
    v_mfma_f32_16x16x32_bf16 a[88:91], v[164:167], v[32:35], a[88:91]
    s_min_u32 s56, s56, s58
    v_cvt_pk_bf16_f32 v84, v16, v17
    v_mfma_f32_16x16x32_bf16 a[88:91], v[180:183], v[36:39], a[88:91]
    v_exp_f32 v16, v116
    v_mfma_f32_16x16x32_bf16 a[136:139], v[168:171], v[32:35], a[136:139]
    ds_read_b128 v[28:31], v3 offset:0
    v_add_f32 v6, v6, v18
    v_mfma_f32_16x16x32_bf16 a[136:139], v[184:187], v[36:39], a[136:139]
    v_add_f32 v6, v6, v19
    v_fma_f32 v238, v238, v56, v58
    v_mfma_f32_16x16x32_bf16 a[184:187], v[172:175], v[32:35], a[184:187]
    v_exp_f32 v17, v117
    v_mfma_f32_16x16x32_bf16 a[184:187], v[188:191], v[36:39], a[184:187]
    s_waitcnt lgkmcnt(2)
    v_cvt_pk_bf16_f32 v85, v18, v19
    v_mfma_f32_16x16x32_bf16 a[44:47], v[160:163], v[40:43], a[44:47]
    ds_read_b128 v[32:35], v2 offset:6144
    v_fma_f32 v239, v239, v57, v59
    v_mfma_f32_16x16x32_bf16 a[44:47], v[176:179], v[44:47], a[44:47]
    v_exp_f32 v18, v118
    v_mfma_f32_16x16x32_bf16 a[92:95], v[164:167], v[40:43], a[92:95]
    v_add_f32 v6, v6, v16
    v_add_f32 v6, v6, v17
    v_mfma_f32_16x16x32_bf16 a[92:95], v[180:183], v[44:47], a[92:95]
    v_exp_f32 v19, v119
    v_mfma_f32_16x16x32_bf16 a[140:143], v[168:171], v[40:43], a[140:143]
    ds_read_b128 v[36:39], v3 offset:6144
    v_cvt_pk_bf16_f32 v86, v16, v17
    v_mfma_f32_16x16x32_bf16 a[140:143], v[184:187], v[44:47], a[140:143]
    v_add_f32 v6, v6, v18
    v_add_f32 v6, v6, v19
    v_mfma_f32_16x16x32_bf16 a[188:191], v[172:175], v[40:43], a[188:191]
    v_cvt_pk_bf16_f32 v87, v18, v19
    v_mfma_f32_16x16x32_bf16 a[188:191], v[188:191], v[44:47], a[188:191]
    s_waitcnt lgkmcnt(2)
    v_mfma_f32_16x16x32_bf16 v[160:163], v[24:27], a[192:195], v[128:131]
    s_mov_b32 m0, s26
    ds_read_b128 v[40:43], v2 offset:128
    v_cvt_pk_bf16_f32 v233, v234, v235
    v_mfma_f32_16x16x32_bf16 v[160:163], v[28:31], a[196:199], v[160:163]
    v_exp_f32 v16, v88
    v_mfma_f32_16x16x32_bf16 v[164:167], v[24:27], a[216:219], v[132:135]
    v_exp_f32 v17, v89
    v_mfma_f32_16x16x32_bf16 v[164:167], v[28:31], a[220:223], v[164:167]
    v_bfe_u32 v53, v4, 4, 6
    v_cvt_pk_bf16_f32 v237, v238, v239
    v_mfma_f32_16x16x32_bf16 v[168:171], v[24:27], a[240:243], v[136:139]
    ds_read_b128 v[44:47], v3 offset:128
    v_lshlrev_b32 v53, 2, v53
    v_mfma_f32_16x16x32_bf16 v[168:171], v[28:31], a[244:247], v[168:171]
    buffer_load_dwordx4 v4, s[4:7], s32 offen offset:0 sc1 lds
    v_mfma_f32_16x16x32_bf16 v[172:175], v[24:27], v[200:203], v[140:143]
    v_exp_f32 v18, v90
    v_mfma_f32_16x16x32_bf16 v[172:175], v[28:31], v[204:207], v[172:175]
    s_waitcnt lgkmcnt(2)
    v_add_f32 v7, v7, v16
    v_add_f32 v7, v7, v17
    v_mfma_f32_16x16x32_bf16 v[96:99], v[32:35], a[192:195], v[128:131]
    ds_read_b128 v[24:27], v2 offset:6272
    v_mfma_f32_16x16x32_bf16 v[96:99], v[36:39], a[196:199], v[96:99]
    buffer_load_dword v52, v53, s[20:23], 0 offen sc1
    v_mfma_f32_16x16x32_bf16 v[100:103], v[32:35], a[216:219], v[132:135]
    v_exp_f32 v19, v91
    v_mfma_f32_16x16x32_bf16 v[100:103], v[36:39], a[220:223], v[100:103]
    ds_read_b128 v[48:51], v10 offset:1152
    v_cvt_pk_bf16_f32 v88, v16, v17
    v_mfma_f32_16x16x32_bf16 v[104:107], v[32:35], a[240:243], v[136:139]
    s_waitcnt vmcnt(32)
    ds_read_b128 v[28:31], v3 offset:6272
    v_mfma_f32_16x16x32_bf16 v[104:107], v[36:39], a[244:247], v[104:107]
    v_exp_f32 v16, v120
    v_mfma_f32_16x16x32_bf16 v[108:111], v[32:35], v[200:203], v[140:143]
    v_add_f32 v7, v7, v18
    v_add_f32 v7, v7, v19
    v_mfma_f32_16x16x32_bf16 v[108:111], v[36:39], v[204:207], v[108:111]
    s_waitcnt lgkmcnt(3)
    buffer_load_dwordx4 v4, s[4:7], s32 offen offset:1024 sc1 lds
    v_mfma_f32_16x16x32_bf16 v[160:163], v[40:43], a[200:203], v[160:163]
    ds_read_b128 v[32:35], v2 offset:256
    v_cvt_f32_i32 v240, v240
    v_mfma_f32_16x16x32_bf16 v[160:163], v[44:47], a[204:207], v[160:163]
    v_exp_f32 v17, v121
    v_mfma_f32_16x16x32_bf16 v[164:167], v[40:43], a[224:227], v[164:167]
    v_cvt_pk_bf16_f32 v89, v18, v19
    v_mfma_f32_16x16x32_bf16 v[164:167], v[44:47], a[228:231], v[164:167]
    v_exp_f32 v18, v122
    v_mfma_f32_16x16x32_bf16 v[168:171], v[40:43], a[248:251], v[168:171]
    ds_read_b128 v[36:39], v3 offset:256
    v_add_f32 v7, v7, v16
    v_mfma_f32_16x16x32_bf16 v[168:171], v[44:47], a[252:255], v[168:171]
    v_add_f32 v7, v7, v17
    v_cvt_f32_i32 v241, v241
    v_mfma_f32_16x16x32_bf16 v[172:175], v[40:43], v[208:211], v[172:175]
    v_exp_f32 v19, v123
    v_mfma_f32_16x16x32_bf16 v[172:175], v[44:47], v[212:215], v[172:175]
    s_waitcnt lgkmcnt(2)
    buffer_load_dwordx4 v4, s[4:7], s32 offen offset:2048 sc1 lds
    v_mfma_f32_16x16x32_bf16 v[96:99], v[24:27], a[200:203], v[96:99]
    ds_read_b128 v[40:43], v2 offset:6400
    v_cvt_pk_bf16_f32 v90, v16, v17
    v_mfma_f32_16x16x32_bf16 v[96:99], v[28:31], a[204:207], v[96:99]
    v_exp_f32 v16, v92
    v_mfma_f32_16x16x32_bf16 v[100:103], v[24:27], a[224:227], v[100:103]
    v_add_f32 v7, v7, v18
    v_add_f32 v7, v7, v19
    v_mfma_f32_16x16x32_bf16 v[100:103], v[28:31], a[228:231], v[100:103]
    v_exp_f32 v17, v93
    v_mfma_f32_16x16x32_bf16 v[104:107], v[24:27], a[248:251], v[104:107]
    ds_read_b128 v[44:47], v3 offset:6400
    v_cvt_pk_bf16_f32 v91, v18, v19
    v_mfma_f32_16x16x32_bf16 v[104:107], v[28:31], a[252:255], v[104:107]
    v_exp_f32 v18, v94
    v_mfma_f32_16x16x32_bf16 v[108:111], v[24:27], v[208:211], v[108:111]
    s_add_u32 s29, s30, 49152
    v_cvt_f32_i32 v244, v244
    v_add_f32 v8, v8, v16
    v_mfma_f32_16x16x32_bf16 v[108:111], v[28:31], v[212:215], v[108:111]
    s_waitcnt lgkmcnt(2)
    ds_read_b128 v[56:59], v23 offset:0
    v_add_f32 v8, v8, v17
    v_mfma_f32_16x16x32_bf16 v[160:163], v[32:35], a[208:211], v[160:163]
    s_add_u32 s32, s32, 24576
    ds_read_b128 v[24:27], v2 offset:12288
    v_add_u32 v10, 1792, v10
    v_mfma_f32_16x16x32_bf16 v[160:163], v[36:39], a[212:215], v[160:163]
    s_sub_u32 s3, s29, 147456
    v_exp_f32 v19, v95
    v_mfma_f32_16x16x32_bf16 v[164:167], v[32:35], a[232:235], v[164:167]
    v_cvt_pk_bf16_f32 v92, v16, v17
    v_mfma_f32_16x16x32_bf16 v[164:167], v[36:39], a[236:239], v[164:167]
    s_add_u32 s26, s26, 12288
    v_exp_f32 v16, v124
    v_mfma_f32_16x16x32_bf16 v[168:171], v[32:35], v[192:195], v[168:171]
    ds_read_b128 v[28:31], v3 offset:12288
    v_add_f32 v8, v8, v18
    v_mfma_f32_16x16x32_bf16 v[168:171], v[36:39], v[196:199], v[168:171]
    v_cvt_f32_i32 v245, v245
    v_add_f32 v8, v8, v19
    v_mfma_f32_16x16x32_bf16 v[172:175], v[32:35], v[216:219], v[172:175]
    s_min_u32 s29, s29, s3
    v_mfma_f32_16x16x32_bf16 v[172:175], v[36:39], v[220:223], v[172:175]
    s_waitcnt lgkmcnt(3)
    v_exp_f32 v17, v125
    v_mfma_f32_16x16x32_bf16 v[96:99], v[40:43], a[208:211], v[96:99]
    s_mov_b32 m0, s26
    ds_read_b128 v[32:35], v2 offset:18432
    v_cvt_pk_bf16_f32 v93, v18, v19
    v_mfma_f32_16x16x32_bf16 v[96:99], v[44:47], a[212:215], v[96:99]
    v_exp_f32 v18, v126
    v_mfma_f32_16x16x32_bf16 v[100:103], v[40:43], a[232:235], v[100:103]
    v_fma_f32 v240, v240, v60, v62
    v_mfma_f32_16x16x32_bf16 v[100:103], v[44:47], a[236:239], v[100:103]
    v_add_f32 v8, v8, v16
    v_mfma_f32_16x16x32_bf16 v[104:107], v[40:43], v[192:195], v[104:107]
    s_sub_u32 s3, s29, s30
    ds_read_b128 v[36:39], v3 offset:18432
    v_add_f32 v8, v8, v17
    v_mfma_f32_16x16x32_bf16 v[104:107], v[44:47], v[196:199], v[104:107]
    v_exp_f32 v19, v127
    v_mfma_f32_16x16x32_bf16 v[108:111], v[40:43], v[216:219], v[108:111]
    v_fma_f32 v241, v241, v61, v63
    v_cvt_pk_bf16_f32 v94, v16, v17
    v_mfma_f32_16x16x32_bf16 v[108:111], v[44:47], v[220:223], v[108:111]
    s_waitcnt lgkmcnt(2)
    buffer_load_dwordx4 v4, s[4:7], s32 offen offset:0 sc1 lds
    v_mfma_f32_16x16x32_bf16 v[176:179], v[24:27], a[192:195], v[128:131]
    ds_read_b128 v[40:43], v2 offset:12416
    v_add_f32 v8, v8, v18
    v_mfma_f32_16x16x32_bf16 v[176:179], v[28:31], a[196:199], v[176:179]
    v_add_f32 v8, v8, v19
    v_cvt_pk_bf16_f32 v95, v18, v19
    v_mfma_f32_16x16x32_bf16 v[180:183], v[24:27], a[216:219], v[132:135]
    s_mov_b32 s30, s29
    v_fma_f32 v244, v244, v60, v62
    v_mfma_f32_16x16x32_bf16 v[180:183], v[28:31], a[220:223], v[180:183]
    v_mfma_f32_16x16x32_bf16 v[184:187], v[24:27], a[240:243], v[136:139]
    ds_read_b128 v[44:47], v3 offset:12416
    v_mfma_f32_16x16x32_bf16 v[184:187], v[28:31], a[244:247], v[184:187]
    v_exp_f32 v16, v160
    v_mfma_f32_16x16x32_bf16 v[188:191], v[24:27], v[200:203], v[140:143]
    v_exp_f32 v17, v161
    v_mfma_f32_16x16x32_bf16 v[188:191], v[28:31], v[204:207], v[188:191]
    s_waitcnt lgkmcnt(2)
    v_exp_f32 v18, v162
    v_mfma_f32_16x16x32_bf16 v[112:115], v[32:35], a[192:195], v[128:131]
    ds_read_b128 v[24:27], v2 offset:18560
    v_add_f32 v5, v5, v16
    v_mfma_f32_16x16x32_bf16 v[112:115], v[36:39], a[196:199], v[112:115]
    buffer_load_dwordx4 v4, s[4:7], s32 offen offset:1024 sc1 lds
    v_mfma_f32_16x16x32_bf16 v[116:119], v[32:35], a[216:219], v[132:135]
    v_add_f32 v5, v5, v17
    v_fma_f32 v245, v245, v61, v63
    v_mfma_f32_16x16x32_bf16 v[116:119], v[36:39], a[220:223], v[116:119]
    v_exp_f32 v19, v163
    v_mfma_f32_16x16x32_bf16 v[120:123], v[32:35], a[240:243], v[136:139]
    ds_read_b128 v[28:31], v3 offset:18560
    v_cvt_pk_bf16_f32 v160, v16, v17
    v_mfma_f32_16x16x32_bf16 v[120:123], v[36:39], a[244:247], v[120:123]
    buffer_load_dword v15, v4, s[88:91], s93 offen
    v_mfma_f32_16x16x32_bf16 v[124:127], v[32:35], v[200:203], v[140:143]
    v_exp_f32 v16, v96
    v_mfma_f32_16x16x32_bf16 v[124:127], v[36:39], v[204:207], v[124:127]
    s_waitcnt lgkmcnt(2)
    v_add_f32 v5, v5, v18
    v_add_f32 v5, v5, v19
    v_mfma_f32_16x16x32_bf16 v[176:179], v[40:43], a[200:203], v[176:179]
    ds_read_b128 v[32:35], v2 offset:12544
    v_add_u32 v1, s3, v1
    v_mfma_f32_16x16x32_bf16 v[176:179], v[44:47], a[204:207], v[176:179]
    buffer_load_dwordx4 v4, s[4:7], s32 offen offset:2048 sc1 lds
    v_mfma_f32_16x16x32_bf16 v[180:183], v[40:43], a[224:227], v[180:183]
    v_exp_f32 v17, v97
    v_mfma_f32_16x16x32_bf16 v[180:183], v[44:47], a[228:231], v[180:183]
    v_cvt_pk_bf16_f32 v161, v18, v19
    v_cvt_pk_bf16_f32 v226, v240, v241
    v_mfma_f32_16x16x32_bf16 v[184:187], v[40:43], a[248:251], v[184:187]
    ds_read_b128 v[36:39], v3 offset:12544
    v_add_u32 v21, s3, v21
    v_mfma_f32_16x16x32_bf16 v[184:187], v[44:47], a[252:255], v[184:187]
    v_exp_f32 v18, v98
    v_mfma_f32_16x16x32_bf16 v[188:191], v[40:43], v[208:211], v[188:191]
    v_add_f32 v5, v5, v16
    v_add_f32 v5, v5, v17
    v_mfma_f32_16x16x32_bf16 v[188:191], v[44:47], v[212:215], v[188:191]
    s_waitcnt lgkmcnt(2)
    v_exp_f32 v19, v99
    v_mfma_f32_16x16x32_bf16 v[112:115], v[24:27], a[200:203], v[112:115]
    ds_read_b128 v[40:43], v2 offset:18688
    v_cvt_pk_bf16_f32 v162, v16, v17
    v_mfma_f32_16x16x32_bf16 v[112:115], v[28:31], a[204:207], v[112:115]
    v_exp_f32 v16, v164
    v_mfma_f32_16x16x32_bf16 v[116:119], v[24:27], a[224:227], v[116:119]
    v_add_f32 v5, v5, v18
    v_cvt_pk_bf16_f32 v230, v244, v245
    v_mfma_f32_16x16x32_bf16 v[116:119], v[28:31], a[228:231], v[116:119]
    s_add_u32 s32, s32, 24576
    v_add_u32 v22, s3, v22
    v_add_f32 v5, v5, v19
    v_mfma_f32_16x16x32_bf16 v[120:123], v[24:27], a[248:251], v[120:123]
    s_add_u32 s26, s26, 36864
    ds_read_b128 v[44:47], v3 offset:18688
    v_cvt_f32_i32 v242, v242
    v_mfma_f32_16x16x32_bf16 v[120:123], v[28:31], a[252:255], v[120:123]
    s_waitcnt lgkmcnt(2)
    v_exp_f32 v17, v165
    v_mfma_f32_16x16x32_bf16 v[124:127], v[24:27], v[208:211], v[124:127]
    s_waitcnt vmcnt(31)
    v_cvt_pk_bf16_f32 v163, v18, v19
    v_cvt_f32_i32 v243, v243
    v_mfma_f32_16x16x32_bf16 v[124:127], v[28:31], v[212:215], v[124:127]
    s_barrier
    v_cvt_f32_i32 v246, v246
    v_mfma_f32_16x16x32_bf16 v[176:179], v[32:35], a[208:211], v[176:179]
    s_sub_u32 s57, s26, 147456
    ds_read_b128 v[24:27], v1 offset:0
    v_cvt_f32_i32 v247, v247
    v_mfma_f32_16x16x32_bf16 v[176:179], v[36:39], a[212:215], v[176:179]
    v_exp_f32 v18, v166
    v_mfma_f32_16x16x32_bf16 v[180:183], v[32:35], a[232:235], v[180:183]
    s_min_u32 s26, s26, s57
    v_add_f32 v6, v6, v16
    v_add_f32 v6, v6, v17
    v_mfma_f32_16x16x32_bf16 v[180:183], v[36:39], a[236:239], v[180:183]
    v_exp_f32 v19, v167
    v_mfma_f32_16x16x32_bf16 v[184:187], v[32:35], v[192:195], v[184:187]
    ds_read_b128 v[28:31], v1 offset:12288
    v_cvt_pk_bf16_f32 v164, v16, v17
    v_mfma_f32_16x16x32_bf16 v[184:187], v[36:39], v[196:199], v[184:187]
    v_exp_f32 v16, v100
    v_mfma_f32_16x16x32_bf16 v[188:191], v[32:35], v[216:219], v[188:191]
    v_add_f32 v6, v6, v18
    v_add_f32 v6, v6, v19
    v_mfma_f32_16x16x32_bf16 v[188:191], v[36:39], v[220:223], v[188:191]
    s_waitcnt lgkmcnt(2)
    v_exp_f32 v17, v101
    v_mfma_f32_16x16x32_bf16 v[112:115], v[40:43], a[208:211], v[112:115]
    ds_read_b128 v[32:35], v1 offset:768
    v_cvt_pk_bf16_f32 v165, v18, v19
    v_mfma_f32_16x16x32_bf16 v[112:115], v[44:47], a[212:215], v[112:115]
    v_exp_f32 v18, v102
    v_mfma_f32_16x16x32_bf16 v[116:119], v[40:43], a[232:235], v[116:119]
    v_add_f32 v6, v6, v16
    v_fma_f32 v242, v242, v48, v50
    v_mfma_f32_16x16x32_bf16 v[116:119], v[44:47], a[236:239], v[116:119]
    v_add_f32 v6, v6, v17
    v_fma_f32 v243, v243, v49, v51
    v_mfma_f32_16x16x32_bf16 v[120:123], v[40:43], v[192:195], v[120:123]
    ds_read_b128 v[36:39], v1 offset:13056
    v_mfma_f32_16x16x32_bf16 v[120:123], v[44:47], v[196:199], v[120:123]
    v_exp_f32 v19, v103
    v_mfma_f32_16x16x32_bf16 v[124:127], v[40:43], v[216:219], v[124:127]
    v_cvt_pk_bf16_f32 v166, v16, v17
    v_add_f32 v6, v6, v18
    v_mfma_f32_16x16x32_bf16 v[124:127], v[44:47], v[220:223], v[124:127]
    s_waitcnt lgkmcnt(2)
    v_add_f32 v6, v6, v19
    v_cvt_pk_bf16_f32 v167, v18, v19
    v_mfma_f32_16x16x32_bf16 a[0:3], v[64:67], v[24:27], a[0:3]
    ds_read_b128 v[40:43], v1 offset:1536
    v_fma_f32 v246, v246, v48, v50
    v_mfma_f32_16x16x32_bf16 a[0:3], v[80:83], v[28:31], a[0:3]
    v_exp_f32 v16, v168
    v_mfma_f32_16x16x32_bf16 a[48:51], v[68:71], v[24:27], a[48:51]
    v_exp_f32 v17, v169
    v_mfma_f32_16x16x32_bf16 a[48:51], v[84:87], v[28:31], a[48:51]
    v_exp_f32 v18, v170
    v_mfma_f32_16x16x32_bf16 a[96:99], v[72:75], v[24:27], a[96:99]
    ds_read_b128 v[44:47], v1 offset:13824
    v_fma_f32 v247, v247, v49, v51
    v_mfma_f32_16x16x32_bf16 a[96:99], v[88:91], v[28:31], a[96:99]
    v_add_f32 v7, v7, v16
    v_add_f32 v7, v7, v17
    v_mfma_f32_16x16x32_bf16 a[144:147], v[76:79], v[24:27], a[144:147]
    v_exp_f32 v19, v171
    v_mfma_f32_16x16x32_bf16 a[144:147], v[92:95], v[28:31], a[144:147]
    s_waitcnt lgkmcnt(2)
    v_cvt_pk_bf16_f32 v227, v242, v243
    v_mfma_f32_16x16x32_bf16 a[4:7], v[64:67], v[32:35], a[4:7]
    ds_read_b128 v[24:27], v1 offset:2304
    v_cvt_pk_bf16_f32 v168, v16, v17
    v_mfma_f32_16x16x32_bf16 a[4:7], v[80:83], v[36:39], a[4:7]
    v_exp_f32 v16, v104
    v_mfma_f32_16x16x32_bf16 a[52:55], v[68:71], v[32:35], a[52:55]
    v_add_f32 v7, v7, v18
    v_mfma_f32_16x16x32_bf16 a[52:55], v[84:87], v[36:39], a[52:55]
    v_add_f32 v7, v7, v19
    v_cvt_pk_bf16_f32 v231, v246, v247
    v_mfma_f32_16x16x32_bf16 a[100:103], v[72:75], v[32:35], a[100:103]
    ds_read_b128 v[28:31], v1 offset:14592
    v_mfma_f32_16x16x32_bf16 a[100:103], v[88:91], v[36:39], a[100:103]
    v_exp_f32 v17, v105
    v_mfma_f32_16x16x32_bf16 a[148:151], v[76:79], v[32:35], a[148:151]
    v_cvt_pk_bf16_f32 v169, v18, v19
    v_mfma_f32_16x16x32_bf16 a[148:151], v[92:95], v[36:39], a[148:151]
    s_waitcnt lgkmcnt(2)
    v_exp_f32 v18, v106
    v_mfma_f32_16x16x32_bf16 a[8:11], v[64:67], v[40:43], a[8:11]
    s_waitcnt vmcnt(25)
    ds_read_b128 v[32:35], v21 offset:0
    v_add_f32 v7, v7, v16
    v_mfma_f32_16x16x32_bf16 a[8:11], v[80:83], v[44:47], a[8:11]
    v_add_f32 v7, v7, v17
    v_mfma_f32_16x16x32_bf16 a[56:59], v[68:71], v[40:43], a[56:59]
    v_exp_f32 v19, v107
    v_mfma_f32_16x16x32_bf16 a[56:59], v[84:87], v[44:47], a[56:59]
    v_mfma_f32_16x16x32_bf16 a[104:107], v[72:75], v[40:43], a[104:107]
    ds_read_b128 v[36:39], v21 offset:12288
    v_cvt_pk_bf16_f32 v170, v16, v17
    v_mfma_f32_16x16x32_bf16 a[104:107], v[88:91], v[44:47], a[104:107]
    v_exp_f32 v16, v172
    v_mfma_f32_16x16x32_bf16 a[152:155], v[76:79], v[40:43], a[152:155]
    v_add_f32 v7, v7, v18
    v_cvt_f32_i32 v248, v248
    v_mfma_f32_16x16x32_bf16 a[152:155], v[92:95], v[44:47], a[152:155]
    s_waitcnt lgkmcnt(2)
    v_add_f32 v7, v7, v19
    v_mfma_f32_16x16x32_bf16 a[12:15], v[64:67], v[24:27], a[12:15]
    ds_read_b128 v[40:43], v21 offset:768
    v_mfma_f32_16x16x32_bf16 a[12:15], v[80:83], v[28:31], a[12:15]
    v_exp_f32 v17, v173
    v_mfma_f32_16x16x32_bf16 a[60:63], v[68:71], v[24:27], a[60:63]
    v_cvt_pk_bf16_f32 v171, v18, v19
    v_cvt_f32_i32 v249, v249
    v_mfma_f32_16x16x32_bf16 a[60:63], v[84:87], v[28:31], a[60:63]
    v_exp_f32 v18, v174
    v_mfma_f32_16x16x32_bf16 a[108:111], v[72:75], v[24:27], a[108:111]
    ds_read_b128 v[44:47], v21 offset:13056
    v_add_f32 v8, v8, v16
    v_mfma_f32_16x16x32_bf16 a[108:111], v[88:91], v[28:31], a[108:111]
    s_waitcnt vmcnt(6)
    v_subrev_u32 v52, s92, v52
    v_cmp_lt_u32 vcc, 15, v52
    v_mfma_f32_16x16x32_bf16 a[156:159], v[76:79], v[24:27], a[156:159]
    s_add_u32 s29, s28, 49152
    v_add_f32 v8, v8, v17
    v_mfma_f32_16x16x32_bf16 a[156:159], v[92:95], v[28:31], a[156:159]
    s_waitcnt lgkmcnt(2)
    v_exp_f32 v19, v175
    v_mfma_f32_16x16x32_bf16 a[16:19], v[64:67], v[32:35], a[16:19]
    s_and_b32 s59, vcc_lo, 0xff
    ds_read_b128 v[24:27], v21 offset:1536
    v_cvt_pk_bf16_f32 v172, v16, v17
    v_mfma_f32_16x16x32_bf16 a[16:19], v[80:83], v[36:39], a[16:19]
    s_cbranch_scc1 L_pollslow5
L_pollok5:
    v_mfma_f32_16x16x32_bf16 a[64:67], v[68:71], v[32:35], a[64:67]
    s_add_u32 s92, s92, 1
    v_exp_f32 v16, v108
    v_mfma_f32_16x16x32_bf16 a[64:67], v[84:87], v[36:39], a[64:67]
    s_sub_u32 s3, s29, 147456
    v_add_f32 v8, v8, v18
    v_cvt_f32_i32 v252, v252
    v_mfma_f32_16x16x32_bf16 a[112:115], v[72:75], v[32:35], a[112:115]
    s_mov_b32 m0, s56
    ds_read_b128 v[28:31], v21 offset:13824
    v_add_f32 v8, v8, v19
    v_mfma_f32_16x16x32_bf16 a[112:115], v[88:91], v[36:39], a[112:115]
    v_exp_f32 v17, v109
    v_mfma_f32_16x16x32_bf16 a[160:163], v[76:79], v[32:35], a[160:163]
    v_cvt_pk_bf16_f32 v173, v18, v19
    v_cvt_f32_i32 v253, v253
    v_mfma_f32_16x16x32_bf16 a[160:163], v[92:95], v[36:39], a[160:163]
    s_waitcnt lgkmcnt(2)
    buffer_load_dwordx4 v4, s[4:7], s27 offen offset:0 sc1 lds
    v_mfma_f32_16x16x32_bf16 a[20:23], v[64:67], v[40:43], a[20:23]
    s_min_u32 s29, s29, s3
    ds_read_b128 v[32:35], v21 offset:2304
    v_fma_f32 v248, v248, v60, v62
    v_mfma_f32_16x16x32_bf16 a[20:23], v[80:83], v[44:47], a[20:23]
    v_exp_f32 v18, v110
    v_mfma_f32_16x16x32_bf16 a[68:71], v[68:71], v[40:43], a[68:71]
    v_add_f32 v8, v8, v16
    v_add_f32 v8, v8, v17
    v_mfma_f32_16x16x32_bf16 a[68:71], v[84:87], v[44:47], a[68:71]
    buffer_load_dwordx4 v4, s[4:7], s27 offen offset:1024 sc1 lds
    v_mfma_f32_16x16x32_bf16 a[116:119], v[72:75], v[40:43], a[116:119]
    ds_read_b128 v[36:39], v21 offset:14592
    v_mfma_f32_16x16x32_bf16 a[116:119], v[88:91], v[44:47], a[116:119]
    v_exp_f32 v19, v111
    v_mfma_f32_16x16x32_bf16 a[164:167], v[76:79], v[40:43], a[164:167]
    s_sub_u32 s3, s29, s28
    v_cvt_pk_bf16_f32 v174, v16, v17
    v_add_f32 v8, v8, v18
    v_mfma_f32_16x16x32_bf16 a[164:167], v[92:95], v[44:47], a[164:167]
    s_waitcnt lgkmcnt(2)
    v_add_f32 v8, v8, v19
    v_cvt_pk_bf16_f32 v175, v18, v19
    v_mfma_f32_16x16x32_bf16 a[24:27], v[64:67], v[24:27], a[24:27]
    ds_read_b128 v[40:43], v22 offset:0
    v_fma_f32 v249, v249, v61, v63
    v_mfma_f32_16x16x32_bf16 a[24:27], v[80:83], v[28:31], a[24:27]
    buffer_load_dwordx4 v4, s[4:7], s27 offen offset:2048 sc1 lds
    v_mfma_f32_16x16x32_bf16 a[72:75], v[68:71], v[24:27], a[72:75]
    v_exp_f32 v16, v176
    v_mfma_f32_16x16x32_bf16 a[72:75], v[84:87], v[28:31], a[72:75]
    v_exp_f32 v17, v177
    v_mfma_f32_16x16x32_bf16 a[120:123], v[72:75], v[24:27], a[120:123]
    s_add_u32 s27, s27, 24576
    ds_read_b128 v[44:47], v22 offset:12288
    v_fma_f32 v252, v252, v60, v62
    v_mfma_f32_16x16x32_bf16 a[120:123], v[88:91], v[28:31], a[120:123]
    s_mov_b32 s28, s29
    v_exp_f32 v18, v178
    v_mfma_f32_16x16x32_bf16 a[168:171], v[76:79], v[24:27], a[168:171]
    v_add_f32 v5, v5, v16
    v_add_f32 v5, v5, v17
    v_mfma_f32_16x16x32_bf16 a[168:171], v[92:95], v[28:31], a[168:171]
    s_waitcnt lgkmcnt(2)
    v_exp_f32 v19, v179
    v_mfma_f32_16x16x32_bf16 a[28:31], v[64:67], v[32:35], a[28:31]
    s_add_u32 s56, s56, 12288
    ds_read_b128 v[24:27], v22 offset:768
    v_cvt_pk_bf16_f32 v176, v16, v17
    v_mfma_f32_16x16x32_bf16 a[28:31], v[80:83], v[36:39], a[28:31]
    s_mov_b32 m0, s56
    v_exp_f32 v16, v112
    v_mfma_f32_16x16x32_bf16 a[76:79], v[68:71], v[32:35], a[76:79]
    v_fma_f32 v253, v253, v61, v63
    v_add_f32 v5, v5, v18
    v_mfma_f32_16x16x32_bf16 a[76:79], v[84:87], v[36:39], a[76:79]
    v_add_f32 v5, v5, v19
    v_cvt_pk_bf16_f32 v234, v248, v249
    v_mfma_f32_16x16x32_bf16 a[124:127], v[72:75], v[32:35], a[124:127]
    ds_read_b128 v[28:31], v22 offset:13056
    v_add_u32 v2, s3, v2
    v_mfma_f32_16x16x32_bf16 a[124:127], v[88:91], v[36:39], a[124:127]
    buffer_load_dwordx4 v4, s[4:7], s27 offen offset:0 sc1 lds
    v_mfma_f32_16x16x32_bf16 a[172:175], v[76:79], v[32:35], a[172:175]
    v_exp_f32 v17, v113
    v_mfma_f32_16x16x32_bf16 a[172:175], v[92:95], v[36:39], a[172:175]
    s_waitcnt lgkmcnt(2)
    v_cvt_pk_bf16_f32 v177, v18, v19
    v_mfma_f32_16x16x32_bf16 a[32:35], v[64:67], v[40:43], a[32:35]
    ds_read_b128 v[32:35], v22 offset:1536
    v_cvt_pk_bf16_f32 v238, v252, v253
    v_mfma_f32_16x16x32_bf16 a[32:35], v[80:83], v[44:47], a[32:35]
    v_exp_f32 v18, v114
    v_mfma_f32_16x16x32_bf16 a[80:83], v[68:71], v[40:43], a[80:83]
    v_add_f32 v5, v5, v16
    v_add_f32 v5, v5, v17
    v_mfma_f32_16x16x32_bf16 a[80:83], v[84:87], v[44:47], a[80:83]
    buffer_load_dwordx4 v4, s[4:7], s27 offen offset:1024 sc1 lds
    v_mfma_f32_16x16x32_bf16 a[128:131], v[72:75], v[40:43], a[128:131]
    ds_read_b128 v[36:39], v22 offset:13824
    v_add_u32 v3, s3, v3
    v_mfma_f32_16x16x32_bf16 a[128:131], v[88:91], v[44:47], a[128:131]
    v_exp_f32 v19, v115
    v_mfma_f32_16x16x32_bf16 a[176:179], v[76:79], v[40:43], a[176:179]
    v_cvt_pk_bf16_f32 v178, v16, v17
    v_cvt_f32_i32 v250, v250
    v_mfma_f32_16x16x32_bf16 a[176:179], v[92:95], v[44:47], a[176:179]
    s_waitcnt lgkmcnt(2)
    buffer_load_dwordx4 v4, s[4:7], s27 offen offset:2048 sc1 lds
    v_mfma_f32_16x16x32_bf16 a[36:39], v[64:67], v[24:27], a[36:39]
    ds_read_b128 v[40:43], v22 offset:2304
    v_mfma_f32_16x16x32_bf16 a[36:39], v[80:83], v[28:31], a[36:39]
    v_exp_f32 v16, v180
    v_mfma_f32_16x16x32_bf16 a[84:87], v[68:71], v[24:27], a[84:87]
    v_add_f32 v5, v5, v18
    v_add_f32 v5, v5, v19
    v_mfma_f32_16x16x32_bf16 a[84:87], v[84:87], v[28:31], a[84:87]
    v_exp_f32 v17, v181
    v_mfma_f32_16x16x32_bf16 a[132:135], v[72:75], v[24:27], a[132:135]
    ds_read_b128 v[44:47], v22 offset:14592
    v_cvt_pk_bf16_f32 v179, v18, v19
    v_mfma_f32_16x16x32_bf16 a[132:135], v[88:91], v[28:31], a[132:135]
    s_waitcnt lgkmcnt(2)
    v_exp_f32 v18, v182
    v_mfma_f32_16x16x32_bf16 a[180:183], v[76:79], v[24:27], a[180:183]
    s_waitcnt vmcnt(25)
    v_add_f32 v6, v6, v16
    v_add_f32 v6, v6, v17
    v_mfma_f32_16x16x32_bf16 a[180:183], v[92:95], v[28:31], a[180:183]
    s_barrier
    s_add_u32 s27, s27, 24576
    v_mfma_f32_16x16x32_bf16 a[40:43], v[64:67], v[32:35], a[40:43]
    ds_read_b128 v[24:27], v2 offset:0
    v_cvt_f32_i32 v251, v251
    v_mfma_f32_16x16x32_bf16 a[40:43], v[80:83], v[36:39], a[40:43]
    s_add_u32 s56, s56, 36864
    buffer_load_dwordx4 v[240:243], v12, s[68:71], s36 offen offset:0 nt
    v_mfma_f32_16x16x32_bf16 a[88:91], v[68:71], v[32:35], a[88:91]
    s_sub_u32 s58, s56, 147456
    v_exp_f32 v19, v183
    v_mfma_f32_16x16x32_bf16 a[88:91], v[84:87], v[36:39], a[88:91]
    v_cvt_pk_bf16_f32 v180, v16, v17
    v_cvt_f32_i32 v254, v254
    v_mfma_f32_16x16x32_bf16 a[136:139], v[72:75], v[32:35], a[136:139]
    s_min_u32 s56, s56, s58
    ds_read_b128 v[28:31], v3 offset:0
    v_cvt_f32_i32 v255, v255
    v_mfma_f32_16x16x32_bf16 a[136:139], v[88:91], v[36:39], a[136:139]
    v_exp_f32 v16, v116
    v_mfma_f32_16x16x32_bf16 a[184:187], v[76:79], v[32:35], a[184:187]
    v_add_f32 v6, v6, v18
    v_add_f32 v6, v6, v19
    v_mfma_f32_16x16x32_bf16 a[184:187], v[92:95], v[36:39], a[184:187]
    s_waitcnt lgkmcnt(2)
    buffer_load_dwordx4 v[244:247], v12, s[68:71], s36 offen offset:768 nt
    v_mfma_f32_16x16x32_bf16 a[44:47], v[64:67], v[40:43], a[44:47]
    ds_read_b128 v[32:35], v2 offset:6144
    v_fma_f32 v250, v250, v48, v50
    v_mfma_f32_16x16x32_bf16 a[44:47], v[80:83], v[44:47], a[44:47]
    v_exp_f32 v17, v117
    v_mfma_f32_16x16x32_bf16 a[92:95], v[68:71], v[40:43], a[92:95]
    v_cvt_pk_bf16_f32 v181, v18, v19
    v_mfma_f32_16x16x32_bf16 a[92:95], v[84:87], v[44:47], a[92:95]
    v_exp_f32 v18, v118
    v_mfma_f32_16x16x32_bf16 a[140:143], v[72:75], v[40:43], a[140:143]
    ds_read_b128 v[36:39], v3 offset:6144
    v_add_f32 v6, v6, v16
    v_mfma_f32_16x16x32_bf16 a[140:143], v[88:91], v[44:47], a[140:143]
    v_add_f32 v6, v6, v17
    v_mfma_f32_16x16x32_bf16 a[188:191], v[76:79], v[40:43], a[188:191]
    v_exp_f32 v19, v119
    v_mfma_f32_16x16x32_bf16 a[188:191], v[92:95], v[44:47], a[188:191]
    s_waitcnt lgkmcnt(2)
    v_cvt_pk_bf16_f32 v182, v16, v17
    v_add_f32 v6, v6, v18
    v_add_f32 v6, v6, v19
    v_cvt_pk_bf16_f32 v183, v18, v19
L_join:
    v_mfma_f32_16x16x32_bf16 v[64:67], v[24:27], a[192:195], v[128:131]
    s_mov_b32 m0, s26
    ds_read_b128 v[40:43], v2 offset:128
    v_fma_f32 v251, v251, v49, v51
    v_mfma_f32_16x16x32_bf16 v[64:67], v[28:31], a[196:199], v[64:67]
    v_exp_f32 v16, v184
    v_mfma_f32_16x16x32_bf16 v[68:71], v[24:27], a[216:219], v[132:135]
    v_exp_f32 v17, v185
    v_mfma_f32_16x16x32_bf16 v[68:71], v[28:31], a[220:223], v[68:71]
    buffer_load_dwordx4 v4, s[4:7], s32 offen offset:0 sc1 lds
    v_mfma_f32_16x16x32_bf16 v[72:75], v[24:27], a[240:243], v[136:139]
    ds_read_b128 v[44:47], v3 offset:128
    v_mfma_f32_16x16x32_bf16 v[72:75], v[28:31], a[244:247], v[72:75]
    v_exp_f32 v18, v186
    v_mfma_f32_16x16x32_bf16 v[76:79], v[24:27], v[200:203], v[140:143]
    v_add_f32 v7, v7, v16
    v_add_f32 v7, v7, v17
    v_mfma_f32_16x16x32_bf16 v[76:79], v[28:31], v[204:207], v[76:79]
    s_waitcnt lgkmcnt(2)
    v_exp_f32 v19, v187
    v_mfma_f32_16x16x32_bf16 v[96:99], v[32:35], a[192:195], v[128:131]
    ds_read_b128 v[24:27], v2 offset:6272
    v_cvt_pk_bf16_f32 v184, v16, v17
    v_mfma_f32_16x16x32_bf16 v[96:99], v[36:39], a[196:199], v[96:99]
    buffer_load_dwordx4 v4, s[4:7], s32 offen offset:1024 sc1 lds
    v_mfma_f32_16x16x32_bf16 v[100:103], v[32:35], a[216:219], v[132:135]
    v_exp_f32 v16, v120
    v_mfma_f32_16x16x32_bf16 v[100:103], v[36:39], a[220:223], v[100:103]
    v_add_f32 v7, v7, v18
    v_fma_f32 v254, v254, v48, v50
    v_mfma_f32_16x16x32_bf16 v[104:107], v[32:35], a[240:243], v[136:139]
    ds_read_b128 v[28:31], v3 offset:6272
    v_add_f32 v7, v7, v19
    v_mfma_f32_16x16x32_bf16 v[104:107], v[36:39], a[244:247], v[104:107]
    v_exp_f32 v17, v121
    v_mfma_f32_16x16x32_bf16 v[108:111], v[32:35], v[200:203], v[140:143]
    v_mfma_f32_16x16x32_bf16 v[108:111], v[36:39], v[204:207], v[108:111]
    s_waitcnt lgkmcnt(2)
    buffer_load_dwordx4 v4, s[4:7], s32 offen offset:2048 sc1 lds
    v_mfma_f32_16x16x32_bf16 v[64:67], v[40:43], a[200:203], v[64:67]
    ds_read_b128 v[32:35], v2 offset:256
    v_cvt_pk_bf16_f32 v185, v18, v19
    v_mfma_f32_16x16x32_bf16 v[64:67], v[44:47], a[204:207], v[64:67]
    v_exp_f32 v18, v122
    v_mfma_f32_16x16x32_bf16 v[68:71], v[40:43], a[224:227], v[68:71]
    v_add_f32 v7, v7, v16
    v_add_f32 v7, v7, v17
    v_mfma_f32_16x16x32_bf16 v[68:71], v[44:47], a[228:231], v[68:71]
    v_fma_f32 v255, v255, v49, v51
    v_mfma_f32_16x16x32_bf16 v[72:75], v[40:43], a[248:251], v[72:75]
    s_add_u32 s32, s32, 24576
    ds_read_b128 v[36:39], v3 offset:256
    v_mfma_f32_16x16x32_bf16 v[72:75], v[44:47], a[252:255], v[72:75]
    v_exp_f32 v19, v123
    v_mfma_f32_16x16x32_bf16 v[76:79], v[40:43], v[208:211], v[76:79]
    v_cvt_pk_bf16_f32 v186, v16, v17
    v_mfma_f32_16x16x32_bf16 v[76:79], v[44:47], v[212:215], v[76:79]
    s_waitcnt lgkmcnt(2)
    v_exp_f32 v16, v188
    v_mfma_f32_16x16x32_bf16 v[96:99], v[24:27], a[200:203], v[96:99]
    s_add_u32 s26, s26, 12288
    ds_read_b128 v[40:43], v2 offset:6400
    v_add_f32 v7, v7, v18
    v_mfma_f32_16x16x32_bf16 v[96:99], v[28:31], a[204:207], v[96:99]
    v_add_f32 v7, v7, v19
    v_mfma_f32_16x16x32_bf16 v[100:103], v[24:27], a[224:227], v[100:103]
    v_exp_f32 v17, v189
    v_mfma_f32_16x16x32_bf16 v[100:103], v[28:31], a[228:231], v[100:103]
    s_mov_b32 m0, s26
    v_cvt_pk_bf16_f32 v187, v18, v19
    v_cvt_pk_bf16_f32 v235, v250, v251
    v_mfma_f32_16x16x32_bf16 v[104:107], v[24:27], a[248:251], v[104:107]
    ds_read_b128 v[44:47], v3 offset:6400
    v_mfma_f32_16x16x32_bf16 v[104:107], v[28:31], a[252:255], v[104:107]
    v_exp_f32 v18, v190
    v_mfma_f32_16x16x32_bf16 v[108:111], v[24:27], v[208:211], v[108:111]
    s_add_u32 s29, s30, 49152
    v_add_f32 v8, v8, v16
    v_mfma_f32_16x16x32_bf16 v[108:111], v[28:31], v[212:215], v[108:111]
    s_waitcnt lgkmcnt(2)
    buffer_load_dwordx4 v4, s[4:7], s32 offen offset:0 sc1 lds
    v_mfma_f32_16x16x32_bf16 v[64:67], v[32:35], a[208:211], v[64:67]
    s_sub_u32 s3, s29, 147456
    ds_read_b128 v[24:27], v2 offset:12288
    v_add_f32 v8, v8, v17
    v_mfma_f32_16x16x32_bf16 v[64:67], v[36:39], a[212:215], v[64:67]
    v_exp_f32 v19, v191
    v_mfma_f32_16x16x32_bf16 v[68:71], v[32:35], a[232:235], v[68:71]
    v_cvt_pk_bf16_f32 v188, v16, v17
    v_mfma_f32_16x16x32_bf16 v[68:71], v[36:39], a[236:239], v[68:71]
    v_exp_f32 v16, v124
    v_mfma_f32_16x16x32_bf16 v[72:75], v[32:35], v[192:195], v[72:75]
    ds_read_b128 v[28:31], v3 offset:12288
    v_add_f32 v8, v8, v18
    v_mfma_f32_16x16x32_bf16 v[72:75], v[36:39], v[196:199], v[72:75]
    v_add_f32 v8, v8, v19
    v_mfma_f32_16x16x32_bf16 v[76:79], v[32:35], v[216:219], v[76:79]
    s_min_u32 s29, s29, s3
    v_cvt_pk_bf16_f32 v239, v254, v255
    v_mfma_f32_16x16x32_bf16 v[76:79], v[36:39], v[220:223], v[76:79]
    s_waitcnt lgkmcnt(2)
    buffer_load_dwordx4 v4, s[4:7], s32 offen offset:1024 sc1 lds
    v_mfma_f32_16x16x32_bf16 v[96:99], v[40:43], a[208:211], v[96:99]
    ds_read_b128 v[32:35], v2 offset:18432
    v_mfma_f32_16x16x32_bf16 v[96:99], v[44:47], a[212:215], v[96:99]
    v_exp_f32 v17, v125
    v_mfma_f32_16x16x32_bf16 v[100:103], v[40:43], a[232:235], v[100:103]
    v_cvt_pk_bf16_f32 v189, v18, v19
    v_mfma_f32_16x16x32_bf16 v[100:103], v[44:47], a[236:239], v[100:103]
    v_exp_f32 v18, v126
    v_mfma_f32_16x16x32_bf16 v[104:107], v[40:43], v[192:195], v[104:107]
    s_sub_u32 s3, s29, s30
    ds_read_b128 v[36:39], v3 offset:18432
    v_add_f32 v8, v8, v16
    v_mfma_f32_16x16x32_bf16 v[104:107], v[44:47], v[196:199], v[104:107]
    buffer_load_dwordx4 v4, s[4:7], s32 offen offset:2048 sc1 lds
    v_mfma_f32_16x16x32_bf16 v[108:111], v[40:43], v[216:219], v[108:111]
    v_add_f32 v8, v8, v17
    v_mfma_f32_16x16x32_bf16 v[108:111], v[44:47], v[220:223], v[108:111]
    s_waitcnt lgkmcnt(2)
    v_exp_f32 v19, v127
    v_mfma_f32_16x16x32_bf16 v[80:83], v[24:27], a[192:195], v[128:131]
    ds_read_b128 v[40:43], v2 offset:12416
    v_cvt_pk_bf16_f32 v190, v16, v17
    v_mfma_f32_16x16x32_bf16 v[80:83], v[28:31], a[196:199], v[80:83]
    v_add_f32 v8, v8, v18
    v_add_f32 v8, v8, v19
    v_mfma_f32_16x16x32_bf16 v[84:87], v[24:27], a[216:219], v[132:135]
    s_mov_b32 s30, s29
    v_cvt_pk_bf16_f32 v191, v18, v19
    v_mfma_f32_16x16x32_bf16 v[84:87], v[28:31], a[220:223], v[84:87]
    s_add_u32 s32, s32, 24576
    v_mfma_f32_16x16x32_bf16 v[88:91], v[24:27], a[240:243], v[136:139]
    s_add_u32 s26, s26, 36864
    ds_read_b128 v[44:47], v3 offset:12416
    v_mfma_f32_16x16x32_bf16 v[88:91], v[28:31], a[244:247], v[88:91]
    v_exp_f32 v16, v64
    v_mfma_f32_16x16x32_bf16 v[92:95], v[24:27], v[200:203], v[140:143]
    v_exp_f32 v17, v65
    v_mfma_f32_16x16x32_bf16 v[92:95], v[28:31], v[204:207], v[92:95]
    s_waitcnt lgkmcnt(2)
    v_exp_f32 v18, v66
    v_mfma_f32_16x16x32_bf16 v[112:115], v[32:35], a[192:195], v[128:131]
    s_sub_u32 s57, s26, 147456
    ds_read_b128 v[24:27], v2 offset:18560
    v_add_f32 v5, v5, v16
    v_mfma_f32_16x16x32_bf16 v[112:115], v[36:39], a[196:199], v[112:115]
    buffer_store_dwordx4 v[224:227], v11, s[4:7], s37 offen offset:0 sc1
    v_mfma_f32_16x16x32_bf16 v[116:119], v[32:35], a[216:219], v[132:135]
    s_min_u32 s26, s26, s57
    v_add_f32 v5, v5, v17
    v_add_u32 v1, s3, v1
    v_mfma_f32_16x16x32_bf16 v[116:119], v[36:39], a[220:223], v[116:119]
    v_exp_f32 v19, v67
    v_mfma_f32_16x16x32_bf16 v[120:123], v[32:35], a[240:243], v[136:139]
    ds_read_b128 v[28:31], v3 offset:18560
    v_cvt_pk_bf16_f32 v64, v16, v17
    v_mfma_f32_16x16x32_bf16 v[120:123], v[36:39], a[244:247], v[120:123]
    v_exp_f32 v16, v96
    v_mfma_f32_16x16x32_bf16 v[124:127], v[32:35], v[200:203], v[140:143]
    v_add_f32 v5, v5, v18
    v_add_f32 v5, v5, v19
    v_mfma_f32_16x16x32_bf16 v[124:127], v[36:39], v[204:207], v[124:127]
    s_waitcnt lgkmcnt(2)
    v_exp_f32 v17, v97
    v_mfma_f32_16x16x32_bf16 v[80:83], v[40:43], a[200:203], v[80:83]
    ds_read_b128 v[32:35], v2 offset:12544
    v_add_u32 v21, s3, v21
    v_mfma_f32_16x16x32_bf16 v[80:83], v[44:47], a[204:207], v[80:83]
    buffer_store_dwordx4 v[228:231], v54, s[4:7], s37 offen offset:768 sc1
    v_mfma_f32_16x16x32_bf16 v[84:87], v[40:43], a[224:227], v[84:87]
    ds_read_b128 v[60:63], v23 offset:16
    v_cvt_pk_bf16_f32 v65, v18, v19
    v_mfma_f32_16x16x32_bf16 v[84:87], v[44:47], a[228:231], v[84:87]
    s_waitcnt vmcnt(25)
    v_exp_f32 v18, v98
    v_mfma_f32_16x16x32_bf16 v[88:91], v[40:43], a[248:251], v[88:91]
    ds_read_b128 v[36:39], v3 offset:12544
    v_add_f32 v5, v5, v16
    v_mfma_f32_16x16x32_bf16 v[88:91], v[44:47], a[252:255], v[88:91]
    v_add_f32 v5, v5, v17
    v_cvt_f32_i32 v144, v144
    v_mfma_f32_16x16x32_bf16 v[92:95], v[40:43], v[208:211], v[92:95]
    v_exp_f32 v19, v99
    v_mfma_f32_16x16x32_bf16 v[92:95], v[44:47], v[212:215], v[92:95]
    s_waitcnt lgkmcnt(3)
    v_cvt_pk_bf16_f32 v66, v16, v17
    v_add_u32 v22, s3, v22
    v_mfma_f32_16x16x32_bf16 v[112:115], v[24:27], a[200:203], v[112:115]
    ds_read_b128 v[40:43], v2 offset:18688
    v_cvt_f32_i32 v148, v148
    v_mfma_f32_16x16x32_bf16 v[112:115], v[28:31], a[204:207], v[112:115]
    buffer_store_dwordx4 v[232:235], v11, s[4:7], s80 offen offset:0 sc1
    v_mfma_f32_16x16x32_bf16 v[116:119], v[24:27], a[224:227], v[116:119]
    v_exp_f32 v16, v68
    v_mfma_f32_16x16x32_bf16 v[116:119], v[28:31], a[228:231], v[116:119]
    v_add_f32 v5, v5, v18
    v_add_f32 v5, v5, v19
    v_mfma_f32_16x16x32_bf16 v[120:123], v[24:27], a[248:251], v[120:123]
    ds_read_b128 v[44:47], v3 offset:18688
    v_cvt_f32_i32 v145, v145
    v_mfma_f32_16x16x32_bf16 v[120:123], v[28:31], a[252:255], v[120:123]
    s_waitcnt lgkmcnt(2)
    v_exp_f32 v17, v69
    v_mfma_f32_16x16x32_bf16 v[124:127], v[24:27], v[208:211], v[124:127]
    s_waitcnt vmcnt(25)
    ds_read_b128 v[48:51], v23 offset:32
    v_cvt_pk_bf16_f32 v67, v18, v19
    v_mfma_f32_16x16x32_bf16 v[124:127], v[28:31], v[212:215], v[124:127]
    s_barrier
    v_mfma_f32_16x16x32_bf16 v[80:83], v[32:35], a[208:211], v[80:83]
    ds_read_b128 v[24:27], v1 offset:0
    v_mfma_f32_16x16x32_bf16 v[80:83], v[36:39], a[212:215], v[80:83]
    v_exp_f32 v18, v70
    v_mfma_f32_16x16x32_bf16 v[84:87], v[32:35], a[232:235], v[84:87]
    v_add_f32 v6, v6, v16
    v_add_f32 v6, v6, v17
    v_mfma_f32_16x16x32_bf16 v[84:87], v[36:39], a[236:239], v[84:87]
    v_exp_f32 v19, v71
    v_mfma_f32_16x16x32_bf16 v[88:91], v[32:35], v[192:195], v[88:91]
    ds_read_b128 v[28:31], v1 offset:12288
    v_cvt_pk_bf16_f32 v68, v16, v17
    v_mfma_f32_16x16x32_bf16 v[88:91], v[36:39], v[196:199], v[88:91]
    buffer_store_dwordx4 v[236:239], v54, s[4:7], s80 offen offset:768 sc1
    v_mfma_f32_16x16x32_bf16 v[92:95], v[32:35], v[216:219], v[92:95]
    v_exp_f32 v16, v100
    v_mfma_f32_16x16x32_bf16 v[92:95], v[36:39], v[220:223], v[92:95]
    s_waitcnt lgkmcnt(3)
    v_add_f32 v6, v6, v18
    v_add_f32 v6, v6, v19
    v_mfma_f32_16x16x32_bf16 v[112:115], v[40:43], a[208:211], v[112:115]
    ds_read_b128 v[32:35], v1 offset:768
    v_cvt_f32_i32 v149, v149
    v_mfma_f32_16x16x32_bf16 v[112:115], v[44:47], a[212:215], v[112:115]
    v_exp_f32 v17, v101
    v_mfma_f32_16x16x32_bf16 v[116:119], v[40:43], a[232:235], v[116:119]
    v_cvt_pk_bf16_f32 v69, v18, v19
    v_fma_f32 v144, v144, v56, v58
    v_mfma_f32_16x16x32_bf16 v[116:119], v[44:47], a[236:239], v[116:119]
    v_exp_f32 v18, v102
    v_mfma_f32_16x16x32_bf16 v[120:123], v[40:43], v[192:195], v[120:123]
    s_sub_u32 s31, s31, 1
    ds_read_b128 v[36:39], v1 offset:13056
    v_add_f32 v6, v6, v16
    v_mfma_f32_16x16x32_bf16 v[120:123], v[44:47], v[196:199], v[120:123]
    v_add_f32 v6, v6, v17
    v_fma_f32 v148, v148, v57, v59
    v_mfma_f32_16x16x32_bf16 v[124:127], v[40:43], v[216:219], v[124:127]
    s_waitcnt lgkmcnt(2)
    s_cmp_lg_u32 s31, 0
    v_exp_f32 v19, v103
    v_cvt_pk_bf16_f32 v70, v16, v17
    v_add_f32 v6, v6, v18
    v_add_f32 v6, v6, v19
    v_cvt_pk_bf16_f32 v71, v18, v19
    v_mfma_f32_16x16x32_bf16 v[124:127], v[44:47], v[220:223], v[124:127]
    s_cbranch_scc1 L_loop
    v_mfma_f32_16x16x32_bf16 a[0:3], v[160:163], v[24:27], a[0:3]
    ds_read_b128 v[40:43], v1 offset:1536
    v_fma_f32 v145, v145, v56, v58
    v_mfma_f32_16x16x32_bf16 a[0:3], v[176:179], v[28:31], a[0:3]
    buffer_load_dwordx4 v[248:251], v12, s[68:71], s36 offen offset:1536 nt
    v_mfma_f32_16x16x32_bf16 a[48:51], v[164:167], v[24:27], a[48:51]
    v_exp_f32 v16, v72
    v_mfma_f32_16x16x32_bf16 a[48:51], v[180:183], v[28:31], a[48:51]
    v_exp_f32 v17, v73
    v_mfma_f32_16x16x32_bf16 a[96:99], v[168:171], v[24:27], a[96:99]
    ds_read_b128 v[44:47], v1 offset:13824
    v_fma_f32 v149, v149, v57, v59
    v_mfma_f32_16x16x32_bf16 a[96:99], v[184:187], v[28:31], a[96:99]
    v_exp_f32 v18, v74
    v_mfma_f32_16x16x32_bf16 a[144:147], v[172:175], v[24:27], a[144:147]
    v_add_f32 v7, v7, v16
    v_add_f32 v7, v7, v17
    v_mfma_f32_16x16x32_bf16 a[144:147], v[188:191], v[28:31], a[144:147]
    s_waitcnt lgkmcnt(2)
    buffer_load_dwordx4 v[252:255], v12, s[68:71], s36 offen offset:2304 nt
    v_mfma_f32_16x16x32_bf16 a[4:7], v[160:163], v[32:35], a[4:7]
    ds_read_b128 v[24:27], v1 offset:2304
    v_cvt_f32_i32 v146, v146
    v_mfma_f32_16x16x32_bf16 a[4:7], v[176:179], v[36:39], a[4:7]
    v_exp_f32 v19, v75
    v_mfma_f32_16x16x32_bf16 a[52:55], v[164:167], v[32:35], a[52:55]
    v_cvt_pk_bf16_f32 v72, v16, v17
    v_cvt_f32_i32 v150, v150
    v_mfma_f32_16x16x32_bf16 a[52:55], v[180:183], v[36:39], a[52:55]
    v_exp_f32 v16, v104
    v_mfma_f32_16x16x32_bf16 a[100:103], v[168:171], v[32:35], a[100:103]
    ds_read_b128 v[28:31], v1 offset:14592
    v_add_f32 v7, v7, v18
    v_mfma_f32_16x16x32_bf16 a[100:103], v[184:187], v[36:39], a[100:103]
    v_add_f32 v7, v7, v19
    v_cvt_f32_i32 v147, v147
    v_mfma_f32_16x16x32_bf16 a[148:151], v[172:175], v[32:35], a[148:151]
    v_exp_f32 v17, v105
    v_mfma_f32_16x16x32_bf16 a[148:151], v[188:191], v[36:39], a[148:151]
    s_waitcnt lgkmcnt(2)
    v_cvt_pk_bf16_f32 v73, v18, v19
    v_cvt_f32_i32 v151, v151
    v_mfma_f32_16x16x32_bf16 a[8:11], v[160:163], v[40:43], a[8:11]
    ds_read_b128 v[32:35], v21 offset:0
    v_fma_f32 v146, v146, v56, v58
    v_mfma_f32_16x16x32_bf16 a[8:11], v[176:179], v[44:47], a[8:11]
    v_exp_f32 v18, v106
    v_mfma_f32_16x16x32_bf16 a[56:59], v[164:167], v[40:43], a[56:59]
    v_add_f32 v7, v7, v16
    v_add_f32 v7, v7, v17
    v_mfma_f32_16x16x32_bf16 a[56:59], v[180:183], v[44:47], a[56:59]
    v_exp_f32 v19, v107
    v_mfma_f32_16x16x32_bf16 a[104:107], v[168:171], v[40:43], a[104:107]
    s_mov_b32 m0, s56
    ds_read_b128 v[36:39], v21 offset:12288
    v_cvt_pk_bf16_f32 v74, v16, v17
    v_mfma_f32_16x16x32_bf16 a[104:107], v[184:187], v[44:47], a[104:107]
    v_exp_f32 v16, v76
    v_mfma_f32_16x16x32_bf16 a[152:155], v[172:175], v[40:43], a[152:155]
    v_fma_f32 v150, v150, v57, v59
    v_fma_f32 v147, v147, v56, v58
    v_mfma_f32_16x16x32_bf16 a[152:155], v[188:191], v[44:47], a[152:155]
    s_waitcnt lgkmcnt(2)
    buffer_load_dwordx4 v4, s[4:7], s27 offen offset:0 sc1 lds
    v_mfma_f32_16x16x32_bf16 a[12:15], v[160:163], v[24:27], a[12:15]
    ds_read_b128 v[40:43], v21 offset:768
    v_add_f32 v7, v7, v18
    v_mfma_f32_16x16x32_bf16 a[12:15], v[176:179], v[28:31], a[12:15]
    v_add_f32 v7, v7, v19
    v_fma_f32 v151, v151, v57, v59
    v_mfma_f32_16x16x32_bf16 a[60:63], v[164:167], v[24:27], a[60:63]
    v_exp_f32 v17, v77
    v_mfma_f32_16x16x32_bf16 a[60:63], v[180:183], v[28:31], a[60:63]
    ds_read_b128 v[56:59], v23 offset:48
    v_cvt_pk_bf16_f32 v75, v18, v19
    v_mfma_f32_16x16x32_bf16 a[108:111], v[168:171], v[24:27], a[108:111]
    ds_read_b128 v[44:47], v21 offset:13056
    v_mfma_f32_16x16x32_bf16 a[108:111], v[184:187], v[28:31], a[108:111]
    v_exp_f32 v18, v78
    v_mfma_f32_16x16x32_bf16 a[156:159], v[172:175], v[24:27], a[156:159]
    s_add_u32 s29, s28, 49152
    v_add_f32 v8, v8, v16
    v_add_f32 v8, v8, v17
    v_mfma_f32_16x16x32_bf16 a[156:159], v[188:191], v[28:31], a[156:159]
    s_waitcnt lgkmcnt(3)
    buffer_load_dwordx4 v4, s[4:7], s27 offen offset:1024 sc1 lds
    v_mfma_f32_16x16x32_bf16 a[16:19], v[160:163], v[32:35], a[16:19]
    s_waitcnt vmcnt(33)
    ds_read_b128 v[24:27], v21 offset:1536
    v_mfma_f32_16x16x32_bf16 a[16:19], v[176:179], v[36:39], a[16:19]
    s_sub_u32 s3, s29, 147456
    v_exp_f32 v19, v79
    v_mfma_f32_16x16x32_bf16 a[64:67], v[164:167], v[32:35], a[64:67]
    v_cvt_pk_bf16_f32 v76, v16, v17
    v_cvt_f32_i32 v152, v152
    v_mfma_f32_16x16x32_bf16 a[64:67], v[180:183], v[36:39], a[64:67]
    v_exp_f32 v16, v108
    v_mfma_f32_16x16x32_bf16 a[112:115], v[168:171], v[32:35], a[112:115]
    ds_read_b128 v[28:31], v21 offset:13824
    v_add_f32 v8, v8, v18
    v_mfma_f32_16x16x32_bf16 a[112:115], v[184:187], v[36:39], a[112:115]
    buffer_load_dwordx4 v4, s[4:7], s27 offen offset:2048 sc1 lds
    v_mfma_f32_16x16x32_bf16 a[160:163], v[172:175], v[32:35], a[160:163]
    v_add_f32 v8, v8, v19
    v_cvt_f32_i32 v156, v156
    v_mfma_f32_16x16x32_bf16 a[160:163], v[188:191], v[36:39], a[160:163]
    s_waitcnt lgkmcnt(2)
    v_exp_f32 v17, v109
    v_mfma_f32_16x16x32_bf16 a[20:23], v[160:163], v[40:43], a[20:23]
    s_min_u32 s29, s29, s3
    ds_read_b128 v[32:35], v21 offset:2304
    v_cvt_pk_bf16_f32 v77, v18, v19
    v_mfma_f32_16x16x32_bf16 a[20:23], v[176:179], v[44:47], a[20:23]
    v_exp_f32 v18, v110
    v_mfma_f32_16x16x32_bf16 a[68:71], v[164:167], v[40:43], a[68:71]
    s_add_u32 s27, s27, 24576
    v_add_f32 v8, v8, v16
    v_add_f32 v8, v8, v17
    v_mfma_f32_16x16x32_bf16 a[68:71], v[180:183], v[44:47], a[68:71]
    v_exp_f32 v19, v111
    v_mfma_f32_16x16x32_bf16 a[116:119], v[168:171], v[40:43], a[116:119]
    ds_read_b128 v[36:39], v21 offset:14592
    v_cvt_f32_i32 v153, v153
    v_mfma_f32_16x16x32_bf16 a[116:119], v[184:187], v[44:47], a[116:119]
    s_add_u32 s56, s56, 12288
    v_cvt_pk_bf16_f32 v78, v16, v17
    v_add_u32 v23, 1792, v23
    v_mfma_f32_16x16x32_bf16 a[164:167], v[172:175], v[40:43], a[164:167]
    s_sub_u32 s3, s29, s28
    v_add_f32 v8, v8, v18
    v_add_f32 v8, v8, v19
    v_mfma_f32_16x16x32_bf16 a[164:167], v[188:191], v[44:47], a[164:167]
    s_waitcnt lgkmcnt(2)
    v_cvt_pk_bf16_f32 v79, v18, v19
    v_cvt_f32_i32 v157, v157
    v_mfma_f32_16x16x32_bf16 a[24:27], v[160:163], v[24:27], a[24:27]
    ds_read_b128 v[40:43], v22 offset:0
    v_fma_f32 v152, v152, v60, v62
    v_mfma_f32_16x16x32_bf16 a[24:27], v[176:179], v[28:31], a[24:27]
    s_mov_b32 m0, s56
    v_exp_f32 v16, v80
    v_mfma_f32_16x16x32_bf16 a[72:75], v[164:167], v[24:27], a[72:75]
    v_exp_f32 v17, v81
    v_mfma_f32_16x16x32_bf16 a[72:75], v[180:183], v[28:31], a[72:75]
    v_exp_f32 v18, v82
    v_mfma_f32_16x16x32_bf16 a[120:123], v[168:171], v[24:27], a[120:123]
    ds_read_b128 v[44:47], v22 offset:12288
    v_fma_f32 v156, v156, v61, v63
    v_mfma_f32_16x16x32_bf16 a[120:123], v[184:187], v[28:31], a[120:123]
    s_mov_b32 s28, s29
    v_add_f32 v5, v5, v16
    v_add_f32 v5, v5, v17
    v_mfma_f32_16x16x32_bf16 a[168:171], v[172:175], v[24:27], a[168:171]
    v_exp_f32 v19, v83
    v_mfma_f32_16x16x32_bf16 a[168:171], v[188:191], v[28:31], a[168:171]
    s_waitcnt lgkmcnt(2)
    buffer_load_dwordx4 v4, s[4:7], s27 offen offset:0 sc1 lds
    v_mfma_f32_16x16x32_bf16 a[28:31], v[160:163], v[32:35], a[28:31]
    ds_read_b128 v[24:27], v22 offset:768
    v_fma_f32 v153, v153, v60, v62
    v_mfma_f32_16x16x32_bf16 a[28:31], v[176:179], v[36:39], a[28:31]
    v_cvt_pk_bf16_f32 v80, v16, v17
    v_fma_f32 v157, v157, v61, v63
    v_mfma_f32_16x16x32_bf16 a[76:79], v[164:167], v[32:35], a[76:79]
    v_exp_f32 v16, v112
    v_mfma_f32_16x16x32_bf16 a[76:79], v[180:183], v[36:39], a[76:79]
    v_add_f32 v5, v5, v18
    v_add_f32 v5, v5, v19
    v_mfma_f32_16x16x32_bf16 a[124:127], v[168:171], v[32:35], a[124:127]
    ds_read_b128 v[28:31], v22 offset:13056
    v_cvt_f32_i32 v154, v154
    v_mfma_f32_16x16x32_bf16 a[124:127], v[184:187], v[36:39], a[124:127]
    buffer_load_dwordx4 v4, s[4:7], s27 offen offset:1024 sc1 lds
    v_mfma_f32_16x16x32_bf16 a[172:175], v[172:175], v[32:35], a[172:175]
    v_exp_f32 v17, v113
    v_mfma_f32_16x16x32_bf16 a[172:175], v[188:191], v[36:39], a[172:175]
    s_waitcnt lgkmcnt(2)
    v_cvt_pk_bf16_f32 v81, v18, v19
    v_add_u32 v2, s3, v2
    v_mfma_f32_16x16x32_bf16 a[32:35], v[160:163], v[40:43], a[32:35]
    ds_read_b128 v[32:35], v22 offset:1536
    v_cvt_f32_i32 v158, v158
    v_mfma_f32_16x16x32_bf16 a[32:35], v[176:179], v[44:47], a[32:35]
    v_exp_f32 v18, v114
    v_mfma_f32_16x16x32_bf16 a[80:83], v[164:167], v[40:43], a[80:83]
    v_add_f32 v5, v5, v16
    v_add_f32 v5, v5, v17
    v_mfma_f32_16x16x32_bf16 a[80:83], v[180:183], v[44:47], a[80:83]
    v_exp_f32 v19, v115
    v_mfma_f32_16x16x32_bf16 a[128:131], v[168:171], v[40:43], a[128:131]
    ds_read_b128 v[36:39], v22 offset:13824
    v_cvt_f32_i32 v155, v155
    v_mfma_f32_16x16x32_bf16 a[128:131], v[184:187], v[44:47], a[128:131]
    buffer_load_dwordx4 v4, s[4:7], s27 offen offset:2048 sc1 lds
    v_mfma_f32_16x16x32_bf16 a[176:179], v[172:175], v[40:43], a[176:179]
    v_cvt_pk_bf16_f32 v82, v16, v17
    v_cvt_f32_i32 v159, v159
    v_mfma_f32_16x16x32_bf16 a[176:179], v[188:191], v[44:47], a[176:179]
    s_waitcnt lgkmcnt(2)
    v_exp_f32 v16, v84
    v_mfma_f32_16x16x32_bf16 a[36:39], v[160:163], v[24:27], a[36:39]
    ds_read_b128 v[40:43], v22 offset:2304
    v_add_f32 v5, v5, v18
    v_mfma_f32_16x16x32_bf16 a[36:39], v[176:179], v[28:31], a[36:39]
    v_add_f32 v5, v5, v19
    v_add_u32 v3, s3, v3
    v_mfma_f32_16x16x32_bf16 a[84:87], v[164:167], v[24:27], a[84:87]
    v_exp_f32 v17, v85
    v_mfma_f32_16x16x32_bf16 a[84:87], v[180:183], v[28:31], a[84:87]
    s_add_u32 s27, s27, 24576
    v_cvt_pk_bf16_f32 v83, v18, v19
    v_fma_f32 v154, v154, v60, v62
    v_mfma_f32_16x16x32_bf16 a[132:135], v[168:171], v[24:27], a[132:135]
    s_add_u32 s56, s56, 36864
    ds_read_b128 v[44:47], v22 offset:14592
    v_fma_f32 v158, v158, v61, v63
    v_mfma_f32_16x16x32_bf16 a[132:135], v[184:187], v[28:31], a[132:135]
    s_waitcnt lgkmcnt(2)
    v_exp_f32 v18, v86
    v_mfma_f32_16x16x32_bf16 a[180:183], v[172:175], v[24:27], a[180:183]
    s_waitcnt vmcnt(8)
    v_add_f32 v6, v6, v16
    v_add_f32 v6, v6, v17
    v_mfma_f32_16x16x32_bf16 a[180:183], v[188:191], v[28:31], a[180:183]
    s_barrier
    v_fma_f32 v155, v155, v60, v62
    v_mfma_f32_16x16x32_bf16 a[40:43], v[160:163], v[32:35], a[40:43]
    s_sub_u32 s58, s56, 147456
    ds_read_b128 v[24:27], v2 offset:0
    v_add_u32 v55, 1, v55
    v_mfma_f32_16x16x32_bf16 a[40:43], v[176:179], v[36:39], a[40:43]
    v_exp_f32 v19, v87
    v_mfma_f32_16x16x32_bf16 a[88:91], v[164:167], v[32:35], a[88:91]
    s_min_u32 s56, s56, s58
    v_cvt_pk_bf16_f32 v84, v16, v17
    v_fma_f32 v159, v159, v61, v63
    v_mfma_f32_16x16x32_bf16 a[88:91], v[180:183], v[36:39], a[88:91]
    v_exp_f32 v16, v116
    v_mfma_f32_16x16x32_bf16 a[136:139], v[168:171], v[32:35], a[136:139]
    ds_read_b128 v[28:31], v3 offset:0
    v_add_f32 v6, v6, v18
    v_mfma_f32_16x16x32_bf16 a[136:139], v[184:187], v[36:39], a[136:139]
    buffer_store_dword v55, v13, s[20:23], 0 offen sc1
    v_mfma_f32_16x16x32_bf16 a[184:187], v[172:175], v[32:35], a[184:187]
    v_add_f32 v6, v6, v19
    v_cvt_pk_bf16_f32 v144, v144, v148
    v_mfma_f32_16x16x32_bf16 a[184:187], v[188:191], v[36:39], a[184:187]
    s_waitcnt lgkmcnt(2)
    v_exp_f32 v17, v117
    v_mfma_f32_16x16x32_bf16 a[44:47], v[160:163], v[40:43], a[44:47]
    ds_read_b128 v[32:35], v2 offset:6144
    v_cvt_pk_bf16_f32 v85, v18, v19
    v_mfma_f32_16x16x32_bf16 a[44:47], v[176:179], v[44:47], a[44:47]
    v_exp_f32 v18, v118
    v_mfma_f32_16x16x32_bf16 a[92:95], v[164:167], v[40:43], a[92:95]
    v_add_f32 v6, v6, v16
    v_cvt_pk_bf16_f32 v148, v145, v149
    v_mfma_f32_16x16x32_bf16 a[92:95], v[180:183], v[44:47], a[92:95]
    v_add_f32 v6, v6, v17
    v_cvt_pk_bf16_f32 v145, v152, v156
    v_mfma_f32_16x16x32_bf16 a[140:143], v[168:171], v[40:43], a[140:143]
    ds_read_b128 v[36:39], v3 offset:6144
    v_cvt_pk_bf16_f32 v149, v153, v157
    v_mfma_f32_16x16x32_bf16 a[140:143], v[184:187], v[44:47], a[140:143]
    v_exp_f32 v19, v119
    v_mfma_f32_16x16x32_bf16 a[188:191], v[172:175], v[40:43], a[188:191]
    v_cvt_pk_bf16_f32 v86, v16, v17
    v_add_f32 v6, v6, v18
    v_mfma_f32_16x16x32_bf16 a[188:191], v[188:191], v[44:47], a[188:191]
    s_waitcnt lgkmcnt(2)
    v_add_f32 v6, v6, v19
    v_cvt_pk_bf16_f32 v87, v18, v19
    v_mfma_f32_16x16x32_bf16 v[160:163], v[24:27], a[192:195], v[128:131]
    s_mov_b32 m0, s26
    ds_read_b128 v[40:43], v2 offset:128
    v_cvt_pk_bf16_f32 v152, v146, v150
    v_mfma_f32_16x16x32_bf16 v[160:163], v[28:31], a[196:199], v[160:163]
    v_exp_f32 v16, v88
    v_mfma_f32_16x16x32_bf16 v[164:167], v[24:27], a[216:219], v[132:135]
    v_exp_f32 v17, v89
    v_mfma_f32_16x16x32_bf16 v[164:167], v[28:31], a[220:223], v[164:167]
    v_exp_f32 v18, v90
    v_mfma_f32_16x16x32_bf16 v[168:171], v[24:27], a[240:243], v[136:139]
    ds_read_b128 v[44:47], v3 offset:128
    v_cvt_pk_bf16_f32 v153, v154, v158
    v_mfma_f32_16x16x32_bf16 v[168:171], v[28:31], a[244:247], v[168:171]
    buffer_load_dwordx4 v4, s[4:7], s32 offen offset:0 sc1 lds
    v_mfma_f32_16x16x32_bf16 v[172:175], v[24:27], v[200:203], v[140:143]
    v_add_f32 v7, v7, v16
    v_add_f32 v7, v7, v17
    v_mfma_f32_16x16x32_bf16 v[172:175], v[28:31], v[204:207], v[172:175]
    s_waitcnt lgkmcnt(2)
    v_exp_f32 v19, v91
    v_mfma_f32_16x16x32_bf16 v[96:99], v[32:35], a[192:195], v[128:131]
    ds_read_b128 v[24:27], v2 offset:6272
    v_cvt_pk_bf16_f32 v156, v147, v151
    v_mfma_f32_16x16x32_bf16 v[96:99], v[36:39], a[196:199], v[96:99]
    v_cvt_pk_bf16_f32 v88, v16, v17
    v_cvt_pk_bf16_f32 v157, v155, v159
    v_mfma_f32_16x16x32_bf16 v[100:103], v[32:35], a[216:219], v[132:135]
    s_waitcnt vmcnt(20)
    v_exp_f32 v16, v120
    v_mfma_f32_16x16x32_bf16 v[100:103], v[36:39], a[220:223], v[100:103]
    v_add_f32 v7, v7, v18
    v_mfma_f32_16x16x32_bf16 v[104:107], v[32:35], a[240:243], v[136:139]
    ds_read_b128 v[28:31], v3 offset:6272
    v_add_f32 v7, v7, v19
    v_mfma_f32_16x16x32_bf16 v[104:107], v[36:39], a[244:247], v[104:107]
    v_exp_f32 v17, v121
    v_mfma_f32_16x16x32_bf16 v[108:111], v[32:35], v[200:203], v[140:143]
    v_cvt_f32_i32 v240, v240
    v_mfma_f32_16x16x32_bf16 v[108:111], v[36:39], v[204:207], v[108:111]
    s_waitcnt lgkmcnt(2)
    buffer_load_dwordx4 v4, s[4:7], s32 offen offset:1024 sc1 lds
    v_mfma_f32_16x16x32_bf16 v[160:163], v[40:43], a[200:203], v[160:163]
    ds_read_b128 v[32:35], v2 offset:256
    v_cvt_pk_bf16_f32 v89, v18, v19
    v_mfma_f32_16x16x32_bf16 v[160:163], v[44:47], a[204:207], v[160:163]
    v_exp_f32 v18, v122
    v_mfma_f32_16x16x32_bf16 v[164:167], v[40:43], a[224:227], v[164:167]
    v_add_f32 v7, v7, v16
    v_cvt_f32_i32 v244, v244
    v_mfma_f32_16x16x32_bf16 v[164:167], v[44:47], a[228:231], v[164:167]
    v_add_f32 v7, v7, v17
    v_cvt_f32_i32 v241, v241
    v_mfma_f32_16x16x32_bf16 v[168:171], v[40:43], a[248:251], v[168:171]
    ds_read_b128 v[36:39], v3 offset:256
    v_mfma_f32_16x16x32_bf16 v[168:171], v[44:47], a[252:255], v[168:171]
    v_exp_f32 v19, v123
    v_mfma_f32_16x16x32_bf16 v[172:175], v[40:43], v[208:211], v[172:175]
    v_cvt_pk_bf16_f32 v90, v16, v17
    v_cvt_f32_i32 v245, v245
    v_mfma_f32_16x16x32_bf16 v[172:175], v[44:47], v[212:215], v[172:175]
    s_waitcnt lgkmcnt(2)
    buffer_load_dwordx4 v4, s[4:7], s32 offen offset:2048 sc1 lds
    v_mfma_f32_16x16x32_bf16 v[96:99], v[24:27], a[200:203], v[96:99]
    ds_read_b128 v[40:43], v2 offset:6400
    v_fma_f32 v240, v240, v48, v50
    v_mfma_f32_16x16x32_bf16 v[96:99], v[28:31], a[204:207], v[96:99]
    v_exp_f32 v16, v92
    v_mfma_f32_16x16x32_bf16 v[100:103], v[24:27], a[224:227], v[100:103]
    v_add_f32 v7, v7, v18
    v_add_f32 v7, v7, v19
    v_mfma_f32_16x16x32_bf16 v[100:103], v[28:31], a[228:231], v[100:103]
    v_exp_f32 v17, v93
    v_mfma_f32_16x16x32_bf16 v[104:107], v[24:27], a[248:251], v[104:107]
    ds_read_b128 v[44:47], v3 offset:6400
    v_cvt_pk_bf16_f32 v91, v18, v19
    v_mfma_f32_16x16x32_bf16 v[104:107], v[28:31], a[252:255], v[104:107]
    v_exp_f32 v18, v94
    v_mfma_f32_16x16x32_bf16 v[108:111], v[24:27], v[208:211], v[108:111]
    s_add_u32 s29, s30, 49152
    v_fma_f32 v244, v244, v49, v51
    v_add_f32 v8, v8, v16
    v_mfma_f32_16x16x32_bf16 v[108:111], v[28:31], v[212:215], v[108:111]
    s_waitcnt lgkmcnt(2)
    v_fma_f32 v241, v241, v48, v50
    v_add_f32 v8, v8, v17
    v_mfma_f32_16x16x32_bf16 v[160:163], v[32:35], a[208:211], v[160:163]
    s_add_u32 s32, s32, 24576
    ds_read_b128 v[24:27], v2 offset:12288
    v_fma_f32 v245, v245, v49, v51
    v_mfma_f32_16x16x32_bf16 v[160:163], v[36:39], a[212:215], v[160:163]
    s_sub_u32 s3, s29, 147456
    v_exp_f32 v19, v95
    v_mfma_f32_16x16x32_bf16 v[164:167], v[32:35], a[232:235], v[164:167]
    v_cvt_pk_bf16_f32 v92, v16, v17
    v_mfma_f32_16x16x32_bf16 v[164:167], v[36:39], a[236:239], v[164:167]
    s_add_u32 s26, s26, 12288
    v_exp_f32 v16, v124
    v_mfma_f32_16x16x32_bf16 v[168:171], v[32:35], v[192:195], v[168:171]
    ds_read_b128 v[28:31], v3 offset:12288
    v_cvt_f32_i32 v242, v242
    v_mfma_f32_16x16x32_bf16 v[168:171], v[36:39], v[196:199], v[168:171]
    v_add_f32 v8, v8, v18
    v_add_f32 v8, v8, v19
    v_mfma_f32_16x16x32_bf16 v[172:175], v[32:35], v[216:219], v[172:175]
    s_min_u32 s29, s29, s3
    v_cvt_f32_i32 v246, v246
    v_mfma_f32_16x16x32_bf16 v[172:175], v[36:39], v[220:223], v[172:175]
    s_waitcnt lgkmcnt(2)
    v_exp_f32 v17, v125
    v_mfma_f32_16x16x32_bf16 v[96:99], v[40:43], a[208:211], v[96:99]
    s_mov_b32 m0, s26
    ds_read_b128 v[32:35], v2 offset:18432
    v_cvt_pk_bf16_f32 v93, v18, v19
    v_mfma_f32_16x16x32_bf16 v[96:99], v[44:47], a[212:215], v[96:99]
    v_exp_f32 v18, v126
    v_mfma_f32_16x16x32_bf16 v[100:103], v[40:43], a[232:235], v[100:103]
    v_cvt_f32_i32 v243, v243
    v_mfma_f32_16x16x32_bf16 v[100:103], v[44:47], a[236:239], v[100:103]
    v_add_f32 v8, v8, v16
    v_cvt_f32_i32 v247, v247
    v_mfma_f32_16x16x32_bf16 v[104:107], v[40:43], v[192:195], v[104:107]
    s_sub_u32 s3, s29, s30
    ds_read_b128 v[36:39], v3 offset:18432
    v_add_f32 v8, v8, v17
    v_mfma_f32_16x16x32_bf16 v[104:107], v[44:47], v[196:199], v[104:107]
    v_exp_f32 v19, v127
    v_mfma_f32_16x16x32_bf16 v[108:111], v[40:43], v[216:219], v[108:111]
    v_fma_f32 v242, v242, v48, v50
    v_cvt_pk_bf16_f32 v94, v16, v17
    v_mfma_f32_16x16x32_bf16 v[108:111], v[44:47], v[220:223], v[108:111]
    s_waitcnt lgkmcnt(2)
    buffer_load_dwordx4 v4, s[4:7], s32 offen offset:0 sc1 lds
    v_mfma_f32_16x16x32_bf16 v[176:179], v[24:27], a[192:195], v[128:131]
    ds_read_b128 v[40:43], v2 offset:12416
    v_add_f32 v8, v8, v18
    v_mfma_f32_16x16x32_bf16 v[176:179], v[28:31], a[196:199], v[176:179]
    v_add_f32 v8, v8, v19
    v_fma_f32 v246, v246, v49, v51
    v_mfma_f32_16x16x32_bf16 v[180:183], v[24:27], a[216:219], v[132:135]
    s_mov_b32 s30, s29
    v_cvt_pk_bf16_f32 v95, v18, v19
    v_mfma_f32_16x16x32_bf16 v[180:183], v[28:31], a[220:223], v[180:183]
    v_mfma_f32_16x16x32_bf16 v[184:187], v[24:27], a[240:243], v[136:139]
    ds_read_b128 v[44:47], v3 offset:12416
    v_fma_f32 v243, v243, v48, v50
    v_mfma_f32_16x16x32_bf16 v[184:187], v[28:31], a[244:247], v[184:187]
    v_exp_f32 v16, v160
    v_mfma_f32_16x16x32_bf16 v[188:191], v[24:27], v[200:203], v[140:143]
    v_exp_f32 v17, v161
    v_mfma_f32_16x16x32_bf16 v[188:191], v[28:31], v[204:207], v[188:191]
    s_waitcnt lgkmcnt(2)
    v_exp_f32 v18, v162
    v_mfma_f32_16x16x32_bf16 v[112:115], v[32:35], a[192:195], v[128:131]
    ds_read_b128 v[24:27], v2 offset:18560
    v_add_f32 v5, v5, v16
    v_mfma_f32_16x16x32_bf16 v[112:115], v[36:39], a[196:199], v[112:115]
    buffer_load_dwordx4 v4, s[4:7], s32 offen offset:1024 sc1 lds
    v_mfma_f32_16x16x32_bf16 v[116:119], v[32:35], a[216:219], v[132:135]
    v_add_f32 v5, v5, v17
    v_fma_f32 v247, v247, v49, v51
    v_mfma_f32_16x16x32_bf16 v[116:119], v[36:39], a[220:223], v[116:119]
    v_exp_f32 v19, v163
    v_mfma_f32_16x16x32_bf16 v[120:123], v[32:35], a[240:243], v[136:139]
    ds_read_b128 v[28:31], v3 offset:18560
    v_cvt_pk_bf16_f32 v160, v16, v17
    v_mfma_f32_16x16x32_bf16 v[120:123], v[36:39], a[244:247], v[120:123]
    v_exp_f32 v16, v96
    v_mfma_f32_16x16x32_bf16 v[124:127], v[32:35], v[200:203], v[140:143]
    v_cvt_pk_bf16_f32 v146, v240, v244
    v_add_f32 v5, v5, v18
    v_mfma_f32_16x16x32_bf16 v[124:127], v[36:39], v[204:207], v[124:127]
    s_waitcnt lgkmcnt(2)
    v_add_f32 v5, v5, v19
    v_add_u32 v1, s3, v1
    v_mfma_f32_16x16x32_bf16 v[176:179], v[40:43], a[200:203], v[176:179]
    ds_read_b128 v[32:35], v2 offset:12544
    v_cvt_pk_bf16_f32 v150, v241, v245
    v_mfma_f32_16x16x32_bf16 v[176:179], v[44:47], a[204:207], v[176:179]
    buffer_load_dwordx4 v4, s[4:7], s32 offen offset:2048 sc1 lds
    v_mfma_f32_16x16x32_bf16 v[180:183], v[40:43], a[224:227], v[180:183]
    v_exp_f32 v17, v97
    v_mfma_f32_16x16x32_bf16 v[180:183], v[44:47], a[228:231], v[180:183]
    v_cvt_pk_bf16_f32 v161, v18, v19
    v_cvt_pk_bf16_f32 v154, v242, v246
    v_mfma_f32_16x16x32_bf16 v[184:187], v[40:43], a[248:251], v[184:187]
    ds_read_b128 v[36:39], v3 offset:12544
    v_add_u32 v21, s3, v21
    v_mfma_f32_16x16x32_bf16 v[184:187], v[44:47], a[252:255], v[184:187]
    v_exp_f32 v18, v98
    v_mfma_f32_16x16x32_bf16 v[188:191], v[40:43], v[208:211], v[188:191]
    v_add_f32 v5, v5, v16
    v_add_f32 v5, v5, v17
    v_mfma_f32_16x16x32_bf16 v[188:191], v[44:47], v[212:215], v[188:191]
    s_waitcnt lgkmcnt(2)
    v_exp_f32 v19, v99
    v_mfma_f32_16x16x32_bf16 v[112:115], v[24:27], a[200:203], v[112:115]
    ds_read_b128 v[40:43], v2 offset:18688
    v_cvt_pk_bf16_f32 v162, v16, v17
    v_mfma_f32_16x16x32_bf16 v[112:115], v[28:31], a[204:207], v[112:115]
    v_exp_f32 v16, v164
    v_mfma_f32_16x16x32_bf16 v[116:119], v[24:27], a[224:227], v[116:119]
    v_cvt_pk_bf16_f32 v158, v243, v247
    v_add_f32 v5, v5, v18
    v_mfma_f32_16x16x32_bf16 v[116:119], v[28:31], a[228:231], v[116:119]
    s_waitcnt vmcnt(13)
    v_add_u32 v22, s3, v22
    v_add_f32 v5, v5, v19
    v_mfma_f32_16x16x32_bf16 v[120:123], v[24:27], a[248:251], v[120:123]
    s_add_u32 s32, s32, 24576
    ds_read_b128 v[44:47], v3 offset:18688
    v_cvt_f32_i32 v248, v248
    v_mfma_f32_16x16x32_bf16 v[120:123], v[28:31], a[252:255], v[120:123]
    s_waitcnt lgkmcnt(2)
    v_exp_f32 v17, v165
    v_mfma_f32_16x16x32_bf16 v[124:127], v[24:27], v[208:211], v[124:127]
    s_waitcnt vmcnt(27)
    v_cvt_pk_bf16_f32 v163, v18, v19
    v_cvt_f32_i32 v252, v252
    v_mfma_f32_16x16x32_bf16 v[124:127], v[28:31], v[212:215], v[124:127]
    s_barrier
    s_add_u32 s26, s26, 36864
    v_mfma_f32_16x16x32_bf16 v[176:179], v[32:35], a[208:211], v[176:179]
    s_sub_u32 s57, s26, 147456
    ds_read_b128 v[24:27], v1 offset:0
    v_cvt_f32_i32 v249, v249
    v_mfma_f32_16x16x32_bf16 v[176:179], v[36:39], a[212:215], v[176:179]
    v_exp_f32 v18, v166
    v_mfma_f32_16x16x32_bf16 v[180:183], v[32:35], a[232:235], v[180:183]
    s_min_u32 s26, s26, s57
    v_add_f32 v6, v6, v16
    v_add_f32 v6, v6, v17
    v_mfma_f32_16x16x32_bf16 v[180:183], v[36:39], a[236:239], v[180:183]
    v_exp_f32 v19, v167
    v_mfma_f32_16x16x32_bf16 v[184:187], v[32:35], v[192:195], v[184:187]
    ds_read_b128 v[28:31], v1 offset:12288
    v_cvt_pk_bf16_f32 v164, v16, v17
    v_mfma_f32_16x16x32_bf16 v[184:187], v[36:39], v[196:199], v[184:187]
    v_exp_f32 v16, v100
    v_mfma_f32_16x16x32_bf16 v[188:191], v[32:35], v[216:219], v[188:191]
    v_add_f32 v6, v6, v18
    v_add_f32 v6, v6, v19
    v_mfma_f32_16x16x32_bf16 v[188:191], v[36:39], v[220:223], v[188:191]
    s_waitcnt lgkmcnt(2)
    v_exp_f32 v17, v101
    v_mfma_f32_16x16x32_bf16 v[112:115], v[40:43], a[208:211], v[112:115]
    ds_read_b128 v[32:35], v1 offset:768
    v_cvt_f32_i32 v253, v253
    v_mfma_f32_16x16x32_bf16 v[112:115], v[44:47], a[212:215], v[112:115]
    v_cvt_pk_bf16_f32 v165, v18, v19
    v_fma_f32 v248, v248, v56, v58
    v_mfma_f32_16x16x32_bf16 v[116:119], v[40:43], a[232:235], v[116:119]
    v_exp_f32 v18, v102
    v_mfma_f32_16x16x32_bf16 v[116:119], v[44:47], a[236:239], v[116:119]
    v_add_f32 v6, v6, v16
    v_add_f32 v6, v6, v17
    v_mfma_f32_16x16x32_bf16 v[120:123], v[40:43], v[192:195], v[120:123]
    ds_read_b128 v[36:39], v1 offset:13056
    v_fma_f32 v252, v252, v57, v59
    v_mfma_f32_16x16x32_bf16 v[120:123], v[44:47], v[196:199], v[120:123]
    v_exp_f32 v19, v103
    v_mfma_f32_16x16x32_bf16 v[124:127], v[40:43], v[216:219], v[124:127]
    v_cvt_pk_bf16_f32 v166, v16, v17
    v_add_f32 v6, v6, v18
    v_mfma_f32_16x16x32_bf16 v[124:127], v[44:47], v[220:223], v[124:127]
    s_waitcnt lgkmcnt(2)
    v_add_f32 v6, v6, v19
    v_fma_f32 v249, v249, v56, v58
    v_cvt_pk_bf16_f32 v167, v18, v19
    v_fma_f32 v253, v253, v57, v59
    v_mfma_f32_16x16x32_bf16 a[0:3], v[64:67], v[24:27], a[0:3]
    s_mov_b32 m0, s56
    ds_read_b128 v[40:43], v1 offset:1536
    v_bfe_u32 v53, v4, 4, 6
    v_mfma_f32_16x16x32_bf16 a[0:3], v[80:83], v[28:31], a[0:3]
    v_exp_f32 v16, v168
    v_mfma_f32_16x16x32_bf16 a[48:51], v[68:71], v[24:27], a[48:51]
    v_exp_f32 v17, v169
    v_mfma_f32_16x16x32_bf16 a[48:51], v[84:87], v[28:31], a[48:51]
    buffer_load_dwordx4 v4, s[4:7], s27 offen offset:0 sc1 lds
    v_mfma_f32_16x16x32_bf16 a[96:99], v[72:75], v[24:27], a[96:99]
    ds_read_b128 v[44:47], v1 offset:13824
    v_lshlrev_b32 v53, 2, v53
    v_mfma_f32_16x16x32_bf16 a[96:99], v[88:91], v[28:31], a[96:99]
    v_exp_f32 v18, v170
    v_mfma_f32_16x16x32_bf16 a[144:147], v[76:79], v[24:27], a[144:147]
    v_add_f32 v7, v7, v16
    v_cvt_f32_i32 v250, v250
    v_mfma_f32_16x16x32_bf16 a[144:147], v[92:95], v[28:31], a[144:147]
    s_waitcnt lgkmcnt(2)
    buffer_load_dword v52, v53, s[20:23], 0 offen sc1
    v_mfma_f32_16x16x32_bf16 a[4:7], v[64:67], v[32:35], a[4:7]
    ds_read_b128 v[24:27], v1 offset:2304
    v_add_f32 v7, v7, v17
    v_mfma_f32_16x16x32_bf16 a[4:7], v[80:83], v[36:39], a[4:7]
    v_exp_f32 v19, v171
    v_mfma_f32_16x16x32_bf16 a[52:55], v[68:71], v[32:35], a[52:55]
    v_cvt_pk_bf16_f32 v168, v16, v17
    v_cvt_f32_i32 v254, v254
    v_mfma_f32_16x16x32_bf16 a[52:55], v[84:87], v[36:39], a[52:55]
    buffer_load_dwordx4 v4, s[4:7], s27 offen offset:1024 sc1 lds
    v_mfma_f32_16x16x32_bf16 a[100:103], v[72:75], v[32:35], a[100:103]
    ds_read_b128 v[28:31], v1 offset:14592
    v_cvt_f32_i32 v251, v251
    v_mfma_f32_16x16x32_bf16 a[100:103], v[88:91], v[36:39], a[100:103]
    v_exp_f32 v16, v104
    v_mfma_f32_16x16x32_bf16 a[148:151], v[76:79], v[32:35], a[148:151]
    v_add_f32 v7, v7, v18
    v_add_f32 v7, v7, v19
    v_mfma_f32_16x16x32_bf16 a[148:151], v[92:95], v[36:39], a[148:151]
    s_waitcnt lgkmcnt(2)
    buffer_load_dwordx4 v4, s[4:7], s27 offen offset:2048 sc1 lds
    v_mfma_f32_16x16x32_bf16 a[8:11], v[64:67], v[40:43], a[8:11]
    ds_read_b128 v[32:35], v21 offset:0
    v_cvt_f32_i32 v255, v255
    v_mfma_f32_16x16x32_bf16 a[8:11], v[80:83], v[44:47], a[8:11]
    v_exp_f32 v17, v105
    v_mfma_f32_16x16x32_bf16 a[56:59], v[68:71], v[40:43], a[56:59]
    v_cvt_pk_bf16_f32 v169, v18, v19
    v_fma_f32 v250, v250, v56, v58
    v_mfma_f32_16x16x32_bf16 a[56:59], v[84:87], v[44:47], a[56:59]
    v_exp_f32 v18, v106
    v_mfma_f32_16x16x32_bf16 a[104:107], v[72:75], v[40:43], a[104:107]
    s_add_u32 s27, s27, 24576
    ds_read_b128 v[36:39], v21 offset:12288
    v_add_f32 v7, v7, v16
    v_mfma_f32_16x16x32_bf16 a[104:107], v[88:91], v[44:47], a[104:107]
    v_add_f32 v7, v7, v17
    v_fma_f32 v254, v254, v57, v59
    v_mfma_f32_16x16x32_bf16 a[152:155], v[76:79], v[40:43], a[152:155]
    v_exp_f32 v19, v107
    v_mfma_f32_16x16x32_bf16 a[152:155], v[92:95], v[44:47], a[152:155]
    s_waitcnt lgkmcnt(2)
    v_cvt_pk_bf16_f32 v170, v16, v17
    s_add_u32 s56, s56, 12288
    v_mfma_f32_16x16x32_bf16 a[12:15], v[64:67], v[24:27], a[12:15]
    ds_read_b128 v[40:43], v21 offset:768
    v_mfma_f32_16x16x32_bf16 a[12:15], v[80:83], v[28:31], a[12:15]
    v_exp_f32 v16, v172
    v_mfma_f32_16x16x32_bf16 a[60:63], v[68:71], v[24:27], a[60:63]
    v_add_f32 v7, v7, v18
    v_add_f32 v7, v7, v19
    v_mfma_f32_16x16x32_bf16 a[60:63], v[84:87], v[28:31], a[60:63]
    s_mov_b32 m0, s56
    v_exp_f32 v17, v173
    v_mfma_f32_16x16x32_bf16 a[108:111], v[72:75], v[24:27], a[108:111]
    ds_read_b128 v[44:47], v21 offset:13056
    v_cvt_pk_bf16_f32 v171, v18, v19
    v_mfma_f32_16x16x32_bf16 a[108:111], v[88:91], v[28:31], a[108:111]
    v_exp_f32 v18, v174
    v_mfma_f32_16x16x32_bf16 a[156:159], v[76:79], v[24:27], a[156:159]
    s_add_u32 s29, s28, 49152
    v_add_f32 v8, v8, v16
    v_fma_f32 v251, v251, v56, v58
    v_mfma_f32_16x16x32_bf16 a[156:159], v[92:95], v[28:31], a[156:159]
    s_waitcnt lgkmcnt(2)
    buffer_load_dwordx4 v4, s[4:7], s27 offen offset:0 sc1 lds
    v_mfma_f32_16x16x32_bf16 a[16:19], v[64:67], v[32:35], a[16:19]
    ds_read_b128 v[24:27], v21 offset:1536
    v_add_f32 v8, v8, v17
    v_mfma_f32_16x16x32_bf16 a[16:19], v[80:83], v[36:39], a[16:19]
    s_sub_u32 s3, s29, 147456
    v_exp_f32 v19, v175
    v_mfma_f32_16x16x32_bf16 a[64:67], v[68:71], v[32:35], a[64:67]
    v_cvt_pk_bf16_f32 v172, v16, v17
    v_fma_f32 v255, v255, v57, v59
    v_mfma_f32_16x16x32_bf16 a[64:67], v[84:87], v[36:39], a[64:67]
    v_exp_f32 v16, v108
    v_mfma_f32_16x16x32_bf16 a[112:115], v[72:75], v[32:35], a[112:115]
    ds_read_b128 v[28:31], v21 offset:13824
    v_add_f32 v8, v8, v18
    v_mfma_f32_16x16x32_bf16 a[112:115], v[88:91], v[36:39], a[112:115]
    v_add_f32 v8, v8, v19
    v_cvt_pk_bf16_f32 v147, v248, v252
    v_mfma_f32_16x16x32_bf16 a[160:163], v[76:79], v[32:35], a[160:163]
    v_exp_f32 v17, v109
    v_mfma_f32_16x16x32_bf16 a[160:163], v[92:95], v[36:39], a[160:163]
    s_waitcnt lgkmcnt(2)
    buffer_load_dwordx4 v4, s[4:7], s27 offen offset:1024 sc1 lds
    v_mfma_f32_16x16x32_bf16 a[20:23], v[64:67], v[40:43], a[20:23]
    s_min_u32 s29, s29, s3
    ds_read_b128 v[32:35], v21 offset:2304
    v_cvt_pk_bf16_f32 v173, v18, v19
    v_mfma_f32_16x16x32_bf16 a[20:23], v[80:83], v[44:47], a[20:23]
    v_exp_f32 v18, v110
    v_mfma_f32_16x16x32_bf16 a[68:71], v[68:71], v[40:43], a[68:71]
    v_add_f32 v8, v8, v16
    v_add_f32 v8, v8, v17
    v_mfma_f32_16x16x32_bf16 a[68:71], v[84:87], v[44:47], a[68:71]
    v_exp_f32 v19, v111
    v_mfma_f32_16x16x32_bf16 a[116:119], v[72:75], v[40:43], a[116:119]
    ds_read_b128 v[36:39], v21 offset:14592
    v_cvt_pk_bf16_f32 v151, v249, v253
    v_mfma_f32_16x16x32_bf16 a[116:119], v[88:91], v[44:47], a[116:119]
    buffer_load_dwordx4 v4, s[4:7], s27 offen offset:2048 sc1 lds
    v_mfma_f32_16x16x32_bf16 a[164:167], v[76:79], v[40:43], a[164:167]
    s_sub_u32 s3, s29, s28
    v_cvt_pk_bf16_f32 v174, v16, v17
    v_add_f32 v8, v8, v18
    v_mfma_f32_16x16x32_bf16 a[164:167], v[92:95], v[44:47], a[164:167]
    s_waitcnt lgkmcnt(2)
    v_add_f32 v8, v8, v19
    v_cvt_pk_bf16_f32 v155, v250, v254
    v_mfma_f32_16x16x32_bf16 a[24:27], v[64:67], v[24:27], a[24:27]
    ds_read_b128 v[40:43], v22 offset:0
    v_cvt_pk_bf16_f32 v175, v18, v19
    v_mfma_f32_16x16x32_bf16 a[24:27], v[80:83], v[28:31], a[24:27]
    v_exp_f32 v16, v176
    v_mfma_f32_16x16x32_bf16 a[72:75], v[68:71], v[24:27], a[72:75]
    v_exp_f32 v17, v177
    v_mfma_f32_16x16x32_bf16 a[72:75], v[84:87], v[28:31], a[72:75]
    s_add_u32 s27, s27, 24576
    v_cvt_pk_bf16_f32 v159, v251, v255
    v_mfma_f32_16x16x32_bf16 a[120:123], v[72:75], v[24:27], a[120:123]
    s_add_u32 s56, s56, 36864
    ds_read_b128 v[44:47], v22 offset:12288
    v_mfma_f32_16x16x32_bf16 a[120:123], v[88:91], v[28:31], a[120:123]
    s_mov_b32 s28, s29
    v_exp_f32 v18, v178
    v_mfma_f32_16x16x32_bf16 a[168:171], v[76:79], v[24:27], a[168:171]
    v_add_f32 v5, v5, v16
    v_add_f32 v5, v5, v17
    v_mfma_f32_16x16x32_bf16 a[168:171], v[92:95], v[28:31], a[168:171]
    s_waitcnt lgkmcnt(2)
    v_exp_f32 v19, v179
    v_mfma_f32_16x16x32_bf16 a[28:31], v[64:67], v[32:35], a[28:31]
    s_sub_u32 s58, s56, 147456
    ds_read_b128 v[24:27], v22 offset:768
    v_cvt_pk_bf16_f32 v176, v16, v17
    v_mfma_f32_16x16x32_bf16 a[28:31], v[80:83], v[36:39], a[28:31]
    buffer_store_dwordx4 v[144:147], v20, s[4:7], s81 offen offset:0 sc1
    v_mfma_f32_16x16x32_bf16 a[76:79], v[68:71], v[32:35], a[76:79]
    s_min_u32 s56, s56, s58
    v_exp_f32 v16, v112
    v_mfma_f32_16x16x32_bf16 a[76:79], v[84:87], v[36:39], a[76:79]
    v_add_f32 v5, v5, v18
    v_add_f32 v5, v5, v19
    v_mfma_f32_16x16x32_bf16 a[124:127], v[72:75], v[32:35], a[124:127]
    ds_read_b128 v[28:31], v22 offset:13056
    v_add_u32 v2, s3, v2
    v_mfma_f32_16x16x32_bf16 a[124:127], v[88:91], v[36:39], a[124:127]
    v_exp_f32 v17, v113
    v_mfma_f32_16x16x32_bf16 a[172:175], v[76:79], v[32:35], a[172:175]
    v_cvt_pk_bf16_f32 v177, v18, v19
    v_mfma_f32_16x16x32_bf16 a[172:175], v[92:95], v[36:39], a[172:175]
    s_waitcnt lgkmcnt(2)
    v_exp_f32 v18, v114
    v_mfma_f32_16x16x32_bf16 a[32:35], v[64:67], v[40:43], a[32:35]
    ds_read_b128 v[32:35], v22 offset:1536
    v_add_f32 v5, v5, v16
    v_mfma_f32_16x16x32_bf16 a[32:35], v[80:83], v[44:47], a[32:35]
    buffer_store_dwordx4 v[148:151], v20, s[4:7], s81 offen offset:768 sc1
    v_mfma_f32_16x16x32_bf16 a[80:83], v[68:71], v[40:43], a[80:83]
    v_add_f32 v5, v5, v17
    v_add_u32 v3, s3, v3
    v_mfma_f32_16x16x32_bf16 a[80:83], v[84:87], v[44:47], a[80:83]
    v_exp_f32 v19, v115
    v_mfma_f32_16x16x32_bf16 a[128:131], v[72:75], v[40:43], a[128:131]
    ds_read_b128 v[36:39], v22 offset:13824
    v_cvt_pk_bf16_f32 v178, v16, v17
    v_mfma_f32_16x16x32_bf16 a[128:131], v[88:91], v[44:47], a[128:131]
    v_exp_f32 v16, v180
    v_mfma_f32_16x16x32_bf16 a[176:179], v[76:79], v[40:43], a[176:179]
    v_add_f32 v5, v5, v18
    v_mfma_f32_16x16x32_bf16 a[176:179], v[92:95], v[44:47], a[176:179]
    s_waitcnt lgkmcnt(2)
    v_add_f32 v5, v5, v19
    v_mfma_f32_16x16x32_bf16 a[36:39], v[64:67], v[24:27], a[36:39]
    ds_read_b128 v[40:43], v22 offset:2304
    v_mfma_f32_16x16x32_bf16 a[36:39], v[80:83], v[28:31], a[36:39]
    buffer_store_dwordx4 v[152:155], v20, s[4:7], s81 offen offset:1536 sc1
    v_mfma_f32_16x16x32_bf16 a[84:87], v[68:71], v[24:27], a[84:87]
    v_exp_f32 v17, v181
    v_mfma_f32_16x16x32_bf16 a[84:87], v[84:87], v[28:31], a[84:87]
    v_cvt_pk_bf16_f32 v179, v18, v19
    v_mfma_f32_16x16x32_bf16 a[132:135], v[72:75], v[24:27], a[132:135]
    ds_read_b128 v[44:47], v22 offset:14592
    v_mfma_f32_16x16x32_bf16 a[132:135], v[88:91], v[28:31], a[132:135]
    s_waitcnt lgkmcnt(2)
    v_exp_f32 v18, v182
    v_mfma_f32_16x16x32_bf16 a[180:183], v[76:79], v[24:27], a[180:183]
    s_waitcnt vmcnt(29)
    v_add_f32 v6, v6, v16
    v_add_f32 v6, v6, v17
    v_mfma_f32_16x16x32_bf16 a[180:183], v[92:95], v[28:31], a[180:183]
    s_barrier
    v_mfma_f32_16x16x32_bf16 a[40:43], v[64:67], v[32:35], a[40:43]
    ds_read_b128 v[24:27], v2 offset:0
    v_mfma_f32_16x16x32_bf16 a[40:43], v[80:83], v[36:39], a[40:43]
    v_exp_f32 v19, v183
    v_mfma_f32_16x16x32_bf16 a[88:91], v[68:71], v[32:35], a[88:91]
    v_cvt_pk_bf16_f32 v180, v16, v17
    v_mfma_f32_16x16x32_bf16 a[88:91], v[84:87], v[36:39], a[88:91]
    v_exp_f32 v16, v116
    v_mfma_f32_16x16x32_bf16 a[136:139], v[72:75], v[32:35], a[136:139]
    ds_read_b128 v[28:31], v3 offset:0
    v_add_f32 v6, v6, v18
    v_mfma_f32_16x16x32_bf16 a[136:139], v[88:91], v[36:39], a[136:139]
    buffer_store_dwordx4 v[156:159], v20, s[4:7], s81 offen offset:2304 sc1
    v_mfma_f32_16x16x32_bf16 a[184:187], v[76:79], v[32:35], a[184:187]
    v_add_f32 v6, v6, v19
    v_mfma_f32_16x16x32_bf16 a[184:187], v[92:95], v[36:39], a[184:187]
    s_waitcnt lgkmcnt(2)
    v_exp_f32 v17, v117
    v_mfma_f32_16x16x32_bf16 a[44:47], v[64:67], v[40:43], a[44:47]
    ds_read_b128 v[32:35], v2 offset:6144
    v_cvt_pk_bf16_f32 v181, v18, v19
    v_mfma_f32_16x16x32_bf16 a[44:47], v[80:83], v[44:47], a[44:47]
    v_exp_f32 v18, v118
    v_mfma_f32_16x16x32_bf16 a[92:95], v[68:71], v[40:43], a[92:95]
    v_add_f32 v6, v6, v16
    v_add_f32 v6, v6, v17
    v_mfma_f32_16x16x32_bf16 a[92:95], v[84:87], v[44:47], a[92:95]
    v_exp_f32 v19, v119
    v_mfma_f32_16x16x32_bf16 a[140:143], v[72:75], v[40:43], a[140:143]
    ds_read_b128 v[36:39], v3 offset:6144
    v_cvt_pk_bf16_f32 v182, v16, v17
    v_mfma_f32_16x16x32_bf16 a[140:143], v[88:91], v[44:47], a[140:143]
    v_add_f32 v6, v6, v18
    v_add_f32 v6, v6, v19
    v_mfma_f32_16x16x32_bf16 a[188:191], v[76:79], v[40:43], a[188:191]
    v_cvt_pk_bf16_f32 v183, v18, v19
    v_mfma_f32_16x16x32_bf16 a[188:191], v[92:95], v[44:47], a[188:191]
    s_waitcnt lgkmcnt(2)
    v_mfma_f32_16x16x32_bf16 v[64:67], v[24:27], a[192:195], v[128:131]
    ds_read_b128 v[40:43], v2 offset:128
    v_mfma_f32_16x16x32_bf16 v[64:67], v[28:31], a[196:199], v[64:67]
    v_exp_f32 v16, v184
    v_mfma_f32_16x16x32_bf16 v[68:71], v[24:27], a[216:219], v[132:135]
    v_exp_f32 v17, v185
    v_mfma_f32_16x16x32_bf16 v[68:71], v[28:31], a[220:223], v[68:71]
    v_exp_f32 v18, v186
    v_mfma_f32_16x16x32_bf16 v[72:75], v[24:27], a[240:243], v[136:139]
    ds_read_b128 v[44:47], v3 offset:128
    v_mfma_f32_16x16x32_bf16 v[72:75], v[28:31], a[244:247], v[72:75]
    v_add_f32 v7, v7, v16
    v_add_f32 v7, v7, v17
    v_mfma_f32_16x16x32_bf16 v[76:79], v[24:27], v[200:203], v[140:143]
    v_mfma_f32_16x16x32_bf16 v[76:79], v[28:31], v[204:207], v[76:79]
    s_waitcnt lgkmcnt(2)
    v_exp_f32 v19, v187
    v_mfma_f32_16x16x32_bf16 v[96:99], v[32:35], a[192:195], v[128:131]
    ds_read_b128 v[24:27], v2 offset:6272
    v_cvt_pk_bf16_f32 v184, v16, v17
    v_mfma_f32_16x16x32_bf16 v[96:99], v[36:39], a[196:199], v[96:99]
    v_mfma_f32_16x16x32_bf16 v[100:103], v[32:35], a[216:219], v[132:135]
    v_exp_f32 v16, v120
    v_mfma_f32_16x16x32_bf16 v[100:103], v[36:39], a[220:223], v[100:103]
    v_add_f32 v7, v7, v18
    v_mfma_f32_16x16x32_bf16 v[104:107], v[32:35], a[240:243], v[136:139]
    ds_read_b128 v[28:31], v3 offset:6272
    v_add_f32 v7, v7, v19
    v_mfma_f32_16x16x32_bf16 v[104:107], v[36:39], a[244:247], v[104:107]
    v_exp_f32 v17, v121
    v_mfma_f32_16x16x32_bf16 v[108:111], v[32:35], v[200:203], v[140:143]
    v_mfma_f32_16x16x32_bf16 v[108:111], v[36:39], v[204:207], v[108:111]
    s_waitcnt lgkmcnt(2)
    v_cvt_pk_bf16_f32 v185, v18, v19
    v_mfma_f32_16x16x32_bf16 v[64:67], v[40:43], a[200:203], v[64:67]
    ds_read_b128 v[32:35], v2 offset:256
    v_mfma_f32_16x16x32_bf16 v[64:67], v[44:47], a[204:207], v[64:67]
    v_exp_f32 v18, v122
    v_mfma_f32_16x16x32_bf16 v[68:71], v[40:43], a[224:227], v[68:71]
    v_add_f32 v7, v7, v16
    v_add_f32 v7, v7, v17
    v_mfma_f32_16x16x32_bf16 v[68:71], v[44:47], a[228:231], v[68:71]
    v_mfma_f32_16x16x32_bf16 v[72:75], v[40:43], a[248:251], v[72:75]
    ds_read_b128 v[36:39], v3 offset:256
    v_mfma_f32_16x16x32_bf16 v[72:75], v[44:47], a[252:255], v[72:75]
    v_exp_f32 v19, v123
    v_mfma_f32_16x16x32_bf16 v[76:79], v[40:43], v[208:211], v[76:79]
    v_cvt_pk_bf16_f32 v186, v16, v17
    v_mfma_f32_16x16x32_bf16 v[76:79], v[44:47], v[212:215], v[76:79]
    s_waitcnt lgkmcnt(2)
    v_exp_f32 v16, v188
    v_mfma_f32_16x16x32_bf16 v[96:99], v[24:27], a[200:203], v[96:99]
    ds_read_b128 v[40:43], v2 offset:6400
    v_add_f32 v7, v7, v18
    v_mfma_f32_16x16x32_bf16 v[96:99], v[28:31], a[204:207], v[96:99]
    v_add_f32 v7, v7, v19
    v_mfma_f32_16x16x32_bf16 v[100:103], v[24:27], a[224:227], v[100:103]
    v_exp_f32 v17, v189
    v_mfma_f32_16x16x32_bf16 v[100:103], v[28:31], a[228:231], v[100:103]
    v_cvt_pk_bf16_f32 v187, v18, v19
    v_mfma_f32_16x16x32_bf16 v[104:107], v[24:27], a[248:251], v[104:107]
    ds_read_b128 v[44:47], v3 offset:6400
    v_mfma_f32_16x16x32_bf16 v[104:107], v[28:31], a[252:255], v[104:107]
    s_waitcnt vmcnt(9)
    v_subrev_u32 v52, s92, v52
    v_cmp_lt_u32 vcc, 15, v52
    v_mfma_f32_16x16x32_bf16 v[108:111], v[24:27], v[208:211], v[108:111]
    s_add_u32 s29, s30, 49152
    v_exp_f32 v18, v190
    v_mfma_f32_16x16x32_bf16 v[108:111], v[28:31], v[212:215], v[108:111]
    s_waitcnt lgkmcnt(2)
    v_add_f32 v8, v8, v16
    v_add_f32 v8, v8, v17
    v_mfma_f32_16x16x32_bf16 v[64:67], v[32:35], a[208:211], v[64:67]
    s_and_b32 s59, vcc_lo, 0xff
    ds_read_b128 v[24:27], v2 offset:12288
    v_mfma_f32_16x16x32_bf16 v[64:67], v[36:39], a[212:215], v[64:67]
    s_cbranch_scc1 L_pollslow6
L_pollok6:
    v_mfma_f32_16x16x32_bf16 v[68:71], v[32:35], a[232:235], v[68:71]
    s_add_u32 s92, s92, 1
    v_exp_f32 v19, v191
    v_mfma_f32_16x16x32_bf16 v[68:71], v[36:39], a[236:239], v[68:71]
    s_sub_u32 s3, s29, 147456
    v_cvt_pk_bf16_f32 v188, v16, v17
    v_mfma_f32_16x16x32_bf16 v[72:75], v[32:35], v[192:195], v[72:75]
    s_mov_b32 m0, s26
    ds_read_b128 v[28:31], v3 offset:12288
    v_mfma_f32_16x16x32_bf16 v[72:75], v[36:39], v[196:199], v[72:75]
    v_exp_f32 v16, v124
    v_mfma_f32_16x16x32_bf16 v[76:79], v[32:35], v[216:219], v[76:79]
    s_min_u32 s29, s29, s3
    v_add_f32 v8, v8, v18
    v_add_f32 v8, v8, v19
    v_mfma_f32_16x16x32_bf16 v[76:79], v[36:39], v[220:223], v[76:79]
    s_waitcnt lgkmcnt(2)
    buffer_load_dwordx4 v4, s[4:7], s32 offen offset:0 sc1 lds
    v_mfma_f32_16x16x32_bf16 v[96:99], v[40:43], a[208:211], v[96:99]
    ds_read_b128 v[32:35], v2 offset:18432
    v_mfma_f32_16x16x32_bf16 v[96:99], v[44:47], a[212:215], v[96:99]
    v_exp_f32 v17, v125
    v_mfma_f32_16x16x32_bf16 v[100:103], v[40:43], a[232:235], v[100:103]
    v_cvt_pk_bf16_f32 v189, v18, v19
    v_mfma_f32_16x16x32_bf16 v[100:103], v[44:47], a[236:239], v[100:103]
    buffer_load_dwordx4 v4, s[4:7], s32 offen offset:1024 sc1 lds
    v_mfma_f32_16x16x32_bf16 v[104:107], v[40:43], v[192:195], v[104:107]
    s_sub_u32 s3, s29, s30
    ds_read_b128 v[36:39], v3 offset:18432
    v_mfma_f32_16x16x32_bf16 v[104:107], v[44:47], v[196:199], v[104:107]
    v_exp_f32 v18, v126
    v_mfma_f32_16x16x32_bf16 v[108:111], v[40:43], v[216:219], v[108:111]
    v_add_f32 v8, v8, v16
    v_add_f32 v8, v8, v17
    v_mfma_f32_16x16x32_bf16 v[108:111], v[44:47], v[220:223], v[108:111]
    s_waitcnt lgkmcnt(2)
    v_exp_f32 v19, v127
    v_mfma_f32_16x16x32_bf16 v[80:83], v[24:27], a[192:195], v[128:131]
    ds_read_b128 v[40:43], v2 offset:12416
    v_cvt_pk_bf16_f32 v190, v16, v17
    v_mfma_f32_16x16x32_bf16 v[80:83], v[28:31], a[196:199], v[80:83]
    buffer_load_dwordx4 v4, s[4:7], s32 offen offset:2048 sc1 lds
    v_mfma_f32_16x16x32_bf16 v[84:87], v[24:27], a[216:219], v[132:135]
    v_add_f32 v8, v8, v18
    v_add_f32 v8, v8, v19
    v_cvt_pk_bf16_f32 v191, v18, v19
    v_mfma_f32_16x16x32_bf16 v[84:87], v[28:31], a[220:223], v[84:87]
    s_mov_b32 s30, s29
    v_mfma_f32_16x16x32_bf16 v[88:91], v[24:27], a[240:243], v[136:139]
    s_add_u32 s32, s32, 24576
    ds_read_b128 v[44:47], v3 offset:12416
    v_mfma_f32_16x16x32_bf16 v[88:91], v[28:31], a[244:247], v[88:91]
    v_exp_f32 v16, v64
    v_mfma_f32_16x16x32_bf16 v[92:95], v[24:27], v[200:203], v[140:143]
    v_exp_f32 v17, v65
    v_mfma_f32_16x16x32_bf16 v[92:95], v[28:31], v[204:207], v[92:95]
    s_waitcnt lgkmcnt(2)
    v_exp_f32 v18, v66
    v_mfma_f32_16x16x32_bf16 v[112:115], v[32:35], a[192:195], v[128:131]
    s_add_u32 s26, s26, 12288
    ds_read_b128 v[24:27], v2 offset:18560
    v_add_f32 v5, v5, v16
    v_mfma_f32_16x16x32_bf16 v[112:115], v[36:39], a[196:199], v[112:115]
    s_mov_b32 m0, s26
    v_add_f32 v5, v5, v17
    v_add_u32 v1, s3, v1
    v_mfma_f32_16x16x32_bf16 v[116:119], v[32:35], a[216:219], v[132:135]
    v_exp_f32 v19, v67
    v_mfma_f32_16x16x32_bf16 v[116:119], v[36:39], a[220:223], v[116:119]
    v_cvt_pk_bf16_f32 v64, v16, v17
    v_mfma_f32_16x16x32_bf16 v[120:123], v[32:35], a[240:243], v[136:139]
    ds_read_b128 v[28:31], v3 offset:18560
    v_mfma_f32_16x16x32_bf16 v[120:123], v[36:39], a[244:247], v[120:123]
    buffer_load_dwordx4 v4, s[4:7], s32 offen offset:0 sc1 lds
    v_mfma_f32_16x16x32_bf16 v[124:127], v[32:35], v[200:203], v[140:143]
    v_exp_f32 v16, v96
    v_mfma_f32_16x16x32_bf16 v[124:127], v[36:39], v[204:207], v[124:127]
    s_waitcnt lgkmcnt(2)
    v_add_f32 v5, v5, v18
    v_add_f32 v5, v5, v19
    v_mfma_f32_16x16x32_bf16 v[80:83], v[40:43], a[200:203], v[80:83]
    ds_read_b128 v[32:35], v2 offset:12544
    v_add_u32 v21, s3, v21
    v_mfma_f32_16x16x32_bf16 v[80:83], v[44:47], a[204:207], v[80:83]
    v_exp_f32 v17, v97
    v_mfma_f32_16x16x32_bf16 v[84:87], v[40:43], a[224:227], v[84:87]
    v_cvt_pk_bf16_f32 v65, v18, v19
    v_mfma_f32_16x16x32_bf16 v[84:87], v[44:47], a[228:231], v[84:87]
    buffer_load_dwordx4 v4, s[4:7], s32 offen offset:1024 sc1 lds
    v_mfma_f32_16x16x32_bf16 v[88:91], v[40:43], a[248:251], v[88:91]
    ds_read_b128 v[36:39], v3 offset:12544
    v_add_u32 v22, s3, v22
    v_mfma_f32_16x16x32_bf16 v[88:91], v[44:47], a[252:255], v[88:91]
    v_exp_f32 v18, v98
    v_mfma_f32_16x16x32_bf16 v[92:95], v[40:43], v[208:211], v[92:95]
    v_add_f32 v5, v5, v16
    v_add_f32 v5, v5, v17
    v_mfma_f32_16x16x32_bf16 v[92:95], v[44:47], v[212:215], v[92:95]
    s_waitcnt lgkmcnt(2)
    buffer_load_dwordx4 v4, s[4:7], s32 offen offset:2048 sc1 lds
    v_mfma_f32_16x16x32_bf16 v[112:115], v[24:27], a[200:203], v[112:115]
    ds_read_b128 v[40:43], v2 offset:18688
    v_mfma_f32_16x16x32_bf16 v[112:115], v[28:31], a[204:207], v[112:115]
    v_exp_f32 v19, v99
    v_mfma_f32_16x16x32_bf16 v[116:119], v[24:27], a[224:227], v[116:119]
    v_cvt_pk_bf16_f32 v66, v16, v17
    v_mfma_f32_16x16x32_bf16 v[116:119], v[28:31], a[228:231], v[116:119]
    v_exp_f32 v16, v68
    v_mfma_f32_16x16x32_bf16 v[120:123], v[24:27], a[248:251], v[120:123]
    ds_read_b128 v[44:47], v3 offset:18688
    v_add_f32 v5, v5, v18
    v_mfma_f32_16x16x32_bf16 v[120:123], v[28:31], a[252:255], v[120:123]
    s_waitcnt lgkmcnt(2)
    v_add_f32 v5, v5, v19
    s_add_u32 s32, s32, 24576
    v_mfma_f32_16x16x32_bf16 v[124:127], v[24:27], v[208:211], v[124:127]
    s_waitcnt vmcnt(6)
    v_exp_f32 v17, v69
    v_mfma_f32_16x16x32_bf16 v[124:127], v[28:31], v[212:215], v[124:127]
    s_barrier
    v_cvt_pk_bf16_f32 v67, v18, v19
    v_mfma_f32_16x16x32_bf16 v[80:83], v[32:35], a[208:211], v[80:83]
    s_add_u32 s26, s26, 36864
    ds_read_b128 v[24:27], v1 offset:0
    v_add_u32 v55, 1, v55
    v_mfma_f32_16x16x32_bf16 v[80:83], v[36:39], a[212:215], v[80:83]
    s_sub_u32 s57, s26, 147456
    v_exp_f32 v18, v70
    v_mfma_f32_16x16x32_bf16 v[84:87], v[32:35], a[232:235], v[84:87]
    v_add_f32 v6, v6, v16
    v_add_f32 v6, v6, v17
    v_mfma_f32_16x16x32_bf16 v[84:87], v[36:39], a[236:239], v[84:87]
    v_exp_f32 v19, v71
    v_mfma_f32_16x16x32_bf16 v[88:91], v[32:35], v[192:195], v[88:91]
    s_min_u32 s26, s26, s57
    ds_read_b128 v[28:31], v1 offset:12288
    v_cvt_pk_bf16_f32 v68, v16, v17
    v_mfma_f32_16x16x32_bf16 v[88:91], v[36:39], v[196:199], v[88:91]
    buffer_store_dword v55, v13, s[20:23], 0 offen sc1
    v_mfma_f32_16x16x32_bf16 v[92:95], v[32:35], v[216:219], v[92:95]
    v_exp_f32 v16, v100
    v_mfma_f32_16x16x32_bf16 v[92:95], v[36:39], v[220:223], v[92:95]
    s_waitcnt lgkmcnt(2)
    v_add_f32 v6, v6, v18
    v_add_f32 v6, v6, v19
    v_mfma_f32_16x16x32_bf16 v[112:115], v[40:43], a[208:211], v[112:115]
    ds_read_b128 v[32:35], v1 offset:768
    v_mfma_f32_16x16x32_bf16 v[112:115], v[44:47], a[212:215], v[112:115]
    v_exp_f32 v17, v101
    v_mfma_f32_16x16x32_bf16 v[116:119], v[40:43], a[232:235], v[116:119]
    v_cvt_pk_bf16_f32 v69, v18, v19
    v_mfma_f32_16x16x32_bf16 v[116:119], v[44:47], a[236:239], v[116:119]
    v_exp_f32 v18, v102
    v_mfma_f32_16x16x32_bf16 v[120:123], v[40:43], v[192:195], v[120:123]
    ds_read_b128 v[36:39], v1 offset:13056
    v_add_f32 v6, v6, v16
    v_mfma_f32_16x16x32_bf16 v[120:123], v[44:47], v[196:199], v[120:123]
    v_add_f32 v6, v6, v17
    v_mfma_f32_16x16x32_bf16 v[124:127], v[40:43], v[216:219], v[124:127]
    v_exp_f32 v19, v103
    v_mfma_f32_16x16x32_bf16 v[124:127], v[44:47], v[220:223], v[124:127]
    s_waitcnt lgkmcnt(2)
    v_cvt_pk_bf16_f32 v70, v16, v17
    v_add_f32 v6, v6, v18
    v_add_f32 v6, v6, v19
    v_cvt_pk_bf16_f32 v71, v18, v19
    s_mov_b32 s31, 2
.p2align 6
L_loop2:
    v_mfma_f32_16x16x32_bf16 a[0:3], v[160:163], v[24:27], a[0:3]
    s_mov_b32 m0, s56
    ds_read_b128 v[40:43], v1 offset:1536
    v_mfma_f32_16x16x32_bf16 a[0:3], v[176:179], v[28:31], a[0:3]
    v_exp_f32 v16, v72
    v_mfma_f32_16x16x32_bf16 a[48:51], v[164:167], v[24:27], a[48:51]
    v_exp_f32 v17, v73
    v_mfma_f32_16x16x32_bf16 a[48:51], v[180:183], v[28:31], a[48:51]
    v_exp_f32 v18, v74
    v_mfma_f32_16x16x32_bf16 a[96:99], v[168:171], v[24:27], a[96:99]
    ds_read_b128 v[44:47], v1 offset:13824
    v_add_f32 v7, v7, v16
    v_mfma_f32_16x16x32_bf16 a[96:99], v[184:187], v[28:31], a[96:99]
    buffer_load_dwordx4 v4, s[4:7], s27 offen offset:0 sc1 lds
    v_mfma_f32_16x16x32_bf16 a[144:147], v[172:175], v[24:27], a[144:147]
    v_add_f32 v7, v7, v17
    v_mfma_f32_16x16x32_bf16 a[144:147], v[188:191], v[28:31], a[144:147]
    s_waitcnt lgkmcnt(2)
    v_exp_f32 v19, v75
    v_mfma_f32_16x16x32_bf16 a[4:7], v[160:163], v[32:35], a[4:7]
    ds_read_b128 v[24:27], v1 offset:2304
    v_cvt_pk_bf16_f32 v72, v16, v17
    v_mfma_f32_16x16x32_bf16 a[4:7], v[176:179], v[36:39], a[4:7]
    v_exp_f32 v16, v104
    v_mfma_f32_16x16x32_bf16 a[52:55], v[164:167], v[32:35], a[52:55]
    v_add_f32 v7, v7, v18
    v_mfma_f32_16x16x32_bf16 a[52:55], v[180:183], v[36:39], a[52:55]
    v_add_f32 v7, v7, v19
    v_mfma_f32_16x16x32_bf16 a[100:103], v[168:171], v[32:35], a[100:103]
    ds_read_b128 v[28:31], v1 offset:14592
    v_mfma_f32_16x16x32_bf16 a[100:103], v[184:187], v[36:39], a[100:103]
    v_exp_f32 v17, v105
    v_mfma_f32_16x16x32_bf16 a[148:151], v[172:175], v[32:35], a[148:151]
    v_cvt_pk_bf16_f32 v73, v18, v19
    v_mfma_f32_16x16x32_bf16 a[148:151], v[188:191], v[36:39], a[148:151]
    s_waitcnt lgkmcnt(2)
    buffer_load_dwordx4 v4, s[4:7], s27 offen offset:1024 sc1 lds
    v_mfma_f32_16x16x32_bf16 a[8:11], v[160:163], v[40:43], a[8:11]
    ds_read_b128 v[32:35], v21 offset:0
    v_mfma_f32_16x16x32_bf16 a[8:11], v[176:179], v[44:47], a[8:11]
    v_exp_f32 v18, v106
    v_mfma_f32_16x16x32_bf16 a[56:59], v[164:167], v[40:43], a[56:59]
    v_add_f32 v7, v7, v16
    v_add_f32 v7, v7, v17
    v_mfma_f32_16x16x32_bf16 a[56:59], v[180:183], v[44:47], a[56:59]
    v_exp_f32 v19, v107
    v_mfma_f32_16x16x32_bf16 a[104:107], v[168:171], v[40:43], a[104:107]
    ds_read_b128 v[36:39], v21 offset:12288
    v_cvt_pk_bf16_f32 v74, v16, v17
    v_mfma_f32_16x16x32_bf16 a[104:107], v[184:187], v[44:47], a[104:107]
    v_exp_f32 v16, v76
    v_mfma_f32_16x16x32_bf16 a[152:155], v[172:175], v[40:43], a[152:155]
    v_add_f32 v7, v7, v18
    v_mfma_f32_16x16x32_bf16 a[152:155], v[188:191], v[44:47], a[152:155]
    s_waitcnt lgkmcnt(2)
    buffer_load_dwordx4 v4, s[4:7], s27 offen offset:2048 sc1 lds
    v_mfma_f32_16x16x32_bf16 a[12:15], v[160:163], v[24:27], a[12:15]
    ds_read_b128 v[40:43], v21 offset:768
    v_add_f32 v7, v7, v19
    v_mfma_f32_16x16x32_bf16 a[12:15], v[176:179], v[28:31], a[12:15]
    v_exp_f32 v17, v77
    v_mfma_f32_16x16x32_bf16 a[60:63], v[164:167], v[24:27], a[60:63]
    v_cvt_pk_bf16_f32 v75, v18, v19
    v_mfma_f32_16x16x32_bf16 a[60:63], v[180:183], v[28:31], a[60:63]
    v_exp_f32 v18, v78
    v_mfma_f32_16x16x32_bf16 a[108:111], v[168:171], v[24:27], a[108:111]
    ds_read_b128 v[44:47], v21 offset:13056
    v_add_f32 v8, v8, v16
    v_mfma_f32_16x16x32_bf16 a[108:111], v[184:187], v[28:31], a[108:111]
    v_add_f32 v8, v8, v17
    v_mfma_f32_16x16x32_bf16 a[156:159], v[172:175], v[24:27], a[156:159]
    s_add_u32 s29, s28, 49152
    v_exp_f32 v19, v79
    v_mfma_f32_16x16x32_bf16 a[156:159], v[188:191], v[28:31], a[156:159]
    s_waitcnt lgkmcnt(2)
    s_add_u32 s27, s27, 24576
    v_mfma_f32_16x16x32_bf16 a[16:19], v[160:163], v[32:35], a[16:19]
    ds_read_b128 v[24:27], v21 offset:1536
    v_cvt_pk_bf16_f32 v76, v16, v17
    v_mfma_f32_16x16x32_bf16 a[16:19], v[176:179], v[36:39], a[16:19]
    s_sub_u32 s3, s29, 147456
    v_exp_f32 v16, v108
    v_mfma_f32_16x16x32_bf16 a[64:67], v[164:167], v[32:35], a[64:67]
    v_add_f32 v8, v8, v18
    v_mfma_f32_16x16x32_bf16 a[64:67], v[180:183], v[36:39], a[64:67]
    s_add_u32 s56, s56, 12288
    v_add_f32 v8, v8, v19
    v_mfma_f32_16x16x32_bf16 a[112:115], v[168:171], v[32:35], a[112:115]
    ds_read_b128 v[28:31], v21 offset:13824
    v_mfma_f32_16x16x32_bf16 a[112:115], v[184:187], v[36:39], a[112:115]
    v_exp_f32 v17, v109
    v_mfma_f32_16x16x32_bf16 a[160:163], v[172:175], v[32:35], a[160:163]
    v_cvt_pk_bf16_f32 v77, v18, v19
    v_mfma_f32_16x16x32_bf16 a[160:163], v[188:191], v[36:39], a[160:163]
    s_waitcnt lgkmcnt(2)
    v_exp_f32 v18, v110
    v_mfma_f32_16x16x32_bf16 a[20:23], v[160:163], v[40:43], a[20:23]
    s_mov_b32 m0, s56
    ds_read_b128 v[32:35], v21 offset:2304
    v_add_f32 v8, v8, v16
    v_mfma_f32_16x16x32_bf16 a[20:23], v[176:179], v[44:47], a[20:23]
    s_min_u32 s29, s29, s3
    v_add_f32 v8, v8, v17
    v_mfma_f32_16x16x32_bf16 a[68:71], v[164:167], v[40:43], a[68:71]
    v_exp_f32 v19, v111
    v_mfma_f32_16x16x32_bf16 a[68:71], v[180:183], v[44:47], a[68:71]
    v_mfma_f32_16x16x32_bf16 a[116:119], v[168:171], v[40:43], a[116:119]
    ds_read_b128 v[36:39], v21 offset:14592
    v_cvt_pk_bf16_f32 v78, v16, v17
    v_mfma_f32_16x16x32_bf16 a[116:119], v[184:187], v[44:47], a[116:119]
    v_add_f32 v8, v8, v18
    v_add_f32 v8, v8, v19
    v_mfma_f32_16x16x32_bf16 a[164:167], v[172:175], v[40:43], a[164:167]
    s_sub_u32 s3, s29, s28
    v_cvt_pk_bf16_f32 v79, v18, v19
    v_mfma_f32_16x16x32_bf16 a[164:167], v[188:191], v[44:47], a[164:167]
    s_waitcnt lgkmcnt(2)
    buffer_load_dwordx4 v4, s[4:7], s27 offen offset:0 sc1 lds
    v_mfma_f32_16x16x32_bf16 a[24:27], v[160:163], v[24:27], a[24:27]
    ds_read_b128 v[40:43], v22 offset:0
    v_mfma_f32_16x16x32_bf16 a[24:27], v[176:179], v[28:31], a[24:27]
    v_exp_f32 v16, v80
    v_mfma_f32_16x16x32_bf16 a[72:75], v[164:167], v[24:27], a[72:75]
    v_exp_f32 v17, v81
    v_mfma_f32_16x16x32_bf16 a[72:75], v[180:183], v[28:31], a[72:75]
    v_exp_f32 v18, v82
    v_mfma_f32_16x16x32_bf16 a[120:123], v[168:171], v[24:27], a[120:123]
    ds_read_b128 v[44:47], v22 offset:12288
    v_add_f32 v5, v5, v16
    v_mfma_f32_16x16x32_bf16 a[120:123], v[184:187], v[28:31], a[120:123]
    s_mov_b32 s28, s29
    v_add_f32 v5, v5, v17
    v_mfma_f32_16x16x32_bf16 a[168:171], v[172:175], v[24:27], a[168:171]
    v_exp_f32 v19, v83
    v_mfma_f32_16x16x32_bf16 a[168:171], v[188:191], v[28:31], a[168:171]
    s_waitcnt lgkmcnt(2)
    v_mfma_f32_16x16x32_bf16 a[28:31], v[160:163], v[32:35], a[28:31]
    ds_read_b128 v[24:27], v22 offset:768
    v_cvt_pk_bf16_f32 v80, v16, v17
    v_mfma_f32_16x16x32_bf16 a[28:31], v[176:179], v[36:39], a[28:31]
    buffer_load_dwordx4 v4, s[4:7], s27 offen offset:1024 sc1 lds
    v_mfma_f32_16x16x32_bf16 a[76:79], v[164:167], v[32:35], a[76:79]
    v_exp_f32 v16, v112
    v_mfma_f32_16x16x32_bf16 a[76:79], v[180:183], v[36:39], a[76:79]
    v_add_f32 v5, v5, v18
    v_add_f32 v5, v5, v19
    v_mfma_f32_16x16x32_bf16 a[124:127], v[168:171], v[32:35], a[124:127]
    ds_read_b128 v[28:31], v22 offset:13056
    v_add_u32 v2, s3, v2
    v_mfma_f32_16x16x32_bf16 a[124:127], v[184:187], v[36:39], a[124:127]
    v_exp_f32 v17, v113
    v_mfma_f32_16x16x32_bf16 a[172:175], v[172:175], v[32:35], a[172:175]
    v_cvt_pk_bf16_f32 v81, v18, v19
    v_mfma_f32_16x16x32_bf16 a[172:175], v[188:191], v[36:39], a[172:175]
    s_waitcnt lgkmcnt(2)
    v_exp_f32 v18, v114
    v_mfma_f32_16x16x32_bf16 a[32:35], v[160:163], v[40:43], a[32:35]
    ds_read_b128 v[32:35], v22 offset:1536
    v_add_f32 v5, v5, v16
    v_mfma_f32_16x16x32_bf16 a[32:35], v[176:179], v[44:47], a[32:35]
    buffer_load_dwordx4 v4, s[4:7], s27 offen offset:2048 sc1 lds
    v_mfma_f32_16x16x32_bf16 a[80:83], v[164:167], v[40:43], a[80:83]
    v_add_f32 v5, v5, v17
    v_add_u32 v3, s3, v3
    v_mfma_f32_16x16x32_bf16 a[80:83], v[180:183], v[44:47], a[80:83]
    v_exp_f32 v19, v115
    v_mfma_f32_16x16x32_bf16 a[128:131], v[168:171], v[40:43], a[128:131]
    ds_read_b128 v[36:39], v22 offset:13824
    v_cvt_pk_bf16_f32 v82, v16, v17
    v_mfma_f32_16x16x32_bf16 a[128:131], v[184:187], v[44:47], a[128:131]
    v_exp_f32 v16, v84
    v_mfma_f32_16x16x32_bf16 a[176:179], v[172:175], v[40:43], a[176:179]
    v_add_f32 v5, v5, v18
    v_mfma_f32_16x16x32_bf16 a[176:179], v[188:191], v[44:47], a[176:179]
    s_waitcnt lgkmcnt(2)
    v_add_f32 v5, v5, v19
    v_mfma_f32_16x16x32_bf16 a[36:39], v[160:163], v[24:27], a[36:39]
    ds_read_b128 v[40:43], v22 offset:2304
    v_mfma_f32_16x16x32_bf16 a[36:39], v[176:179], v[28:31], a[36:39]
    v_exp_f32 v17, v85
    v_mfma_f32_16x16x32_bf16 a[84:87], v[164:167], v[24:27], a[84:87]
    v_cvt_pk_bf16_f32 v83, v18, v19
    v_mfma_f32_16x16x32_bf16 a[84:87], v[180:183], v[28:31], a[84:87]
    s_add_u32 s27, s27, 24576
    v_exp_f32 v18, v86
    v_mfma_f32_16x16x32_bf16 a[132:135], v[168:171], v[24:27], a[132:135]
    s_add_u32 s56, s56, 36864
    ds_read_b128 v[44:47], v22 offset:14592
    v_add_f32 v6, v6, v16
    v_mfma_f32_16x16x32_bf16 a[132:135], v[184:187], v[28:31], a[132:135]
    s_waitcnt lgkmcnt(2)
    v_add_f32 v6, v6, v17
    v_mfma_f32_16x16x32_bf16 a[180:183], v[172:175], v[24:27], a[180:183]
    s_waitcnt vmcnt(24)
    v_exp_f32 v19, v87
    v_mfma_f32_16x16x32_bf16 a[180:183], v[188:191], v[28:31], a[180:183]
    s_barrier
    s_sub_u32 s58, s56, 147456
    v_mfma_f32_16x16x32_bf16 a[40:43], v[160:163], v[32:35], a[40:43]
    ds_read_b128 v[24:27], v2 offset:0
    v_cvt_pk_bf16_f32 v84, v16, v17
    v_mfma_f32_16x16x32_bf16 a[40:43], v[176:179], v[36:39], a[40:43]
    v_exp_f32 v16, v116
    v_mfma_f32_16x16x32_bf16 a[88:91], v[164:167], v[32:35], a[88:91]
    s_min_u32 s56, s56, s58
    v_add_f32 v6, v6, v18
    v_mfma_f32_16x16x32_bf16 a[88:91], v[180:183], v[36:39], a[88:91]
    v_add_f32 v6, v6, v19
    v_mfma_f32_16x16x32_bf16 a[136:139], v[168:171], v[32:35], a[136:139]
    ds_read_b128 v[28:31], v3 offset:0
    v_mfma_f32_16x16x32_bf16 a[136:139], v[184:187], v[36:39], a[136:139]
    v_exp_f32 v17, v117
    v_mfma_f32_16x16x32_bf16 a[184:187], v[172:175], v[32:35], a[184:187]
    v_cvt_pk_bf16_f32 v85, v18, v19
    v_mfma_f32_16x16x32_bf16 a[184:187], v[188:191], v[36:39], a[184:187]
    s_waitcnt lgkmcnt(2)
    v_exp_f32 v18, v118
    v_mfma_f32_16x16x32_bf16 a[44:47], v[160:163], v[40:43], a[44:47]
    ds_read_b128 v[32:35], v2 offset:6144
    v_add_f32 v6, v6, v16
    v_mfma_f32_16x16x32_bf16 a[44:47], v[176:179], v[44:47], a[44:47]
    v_add_f32 v6, v6, v17
    v_mfma_f32_16x16x32_bf16 a[92:95], v[164:167], v[40:43], a[92:95]
    v_exp_f32 v19, v119
    v_mfma_f32_16x16x32_bf16 a[92:95], v[180:183], v[44:47], a[92:95]
    v_mfma_f32_16x16x32_bf16 a[140:143], v[168:171], v[40:43], a[140:143]
    ds_read_b128 v[36:39], v3 offset:6144
    v_cvt_pk_bf16_f32 v86, v16, v17
    v_mfma_f32_16x16x32_bf16 a[140:143], v[184:187], v[44:47], a[140:143]
    v_add_f32 v6, v6, v18
    v_add_f32 v6, v6, v19
    v_mfma_f32_16x16x32_bf16 a[188:191], v[172:175], v[40:43], a[188:191]
    v_cvt_pk_bf16_f32 v87, v18, v19
    v_mfma_f32_16x16x32_bf16 a[188:191], v[188:191], v[44:47], a[188:191]
    s_waitcnt lgkmcnt(2)
    v_mfma_f32_16x16x32_bf16 v[160:163], v[24:27], a[192:195], v[128:131]
    s_mov_b32 m0, s26
    ds_read_b128 v[40:43], v2 offset:128
    v_mfma_f32_16x16x32_bf16 v[160:163], v[28:31], a[196:199], v[160:163]
    v_exp_f32 v16, v88
    v_mfma_f32_16x16x32_bf16 v[164:167], v[24:27], a[216:219], v[132:135]
    v_exp_f32 v17, v89
    v_mfma_f32_16x16x32_bf16 v[164:167], v[28:31], a[220:223], v[164:167]
    v_bfe_u32 v53, v4, 4, 6
    v_mfma_f32_16x16x32_bf16 v[168:171], v[24:27], a[240:243], v[136:139]
    ds_read_b128 v[44:47], v3 offset:128
    v_lshlrev_b32 v53, 2, v53
    v_mfma_f32_16x16x32_bf16 v[168:171], v[28:31], a[244:247], v[168:171]
    buffer_load_dwordx4 v4, s[4:7], s32 offen offset:0 sc1 lds
    v_mfma_f32_16x16x32_bf16 v[172:175], v[24:27], v[200:203], v[140:143]
    v_exp_f32 v18, v90
    v_mfma_f32_16x16x32_bf16 v[172:175], v[28:31], v[204:207], v[172:175]
    s_waitcnt lgkmcnt(2)
    v_add_f32 v7, v7, v16
    v_add_f32 v7, v7, v17
    v_mfma_f32_16x16x32_bf16 v[96:99], v[32:35], a[192:195], v[128:131]
    ds_read_b128 v[24:27], v2 offset:6272
    v_mfma_f32_16x16x32_bf16 v[96:99], v[36:39], a[196:199], v[96:99]
    buffer_load_dword v52, v53, s[20:23], 0 offen sc1
    v_mfma_f32_16x16x32_bf16 v[100:103], v[32:35], a[216:219], v[132:135]
    v_exp_f32 v19, v91
    v_mfma_f32_16x16x32_bf16 v[100:103], v[36:39], a[220:223], v[100:103]
    v_cvt_pk_bf16_f32 v88, v16, v17
    v_mfma_f32_16x16x32_bf16 v[104:107], v[32:35], a[240:243], v[136:139]
    ds_read_b128 v[28:31], v3 offset:6272
    v_mfma_f32_16x16x32_bf16 v[104:107], v[36:39], a[244:247], v[104:107]
    v_exp_f32 v16, v120
    v_mfma_f32_16x16x32_bf16 v[108:111], v[32:35], v[200:203], v[140:143]
    v_add_f32 v7, v7, v18
    v_add_f32 v7, v7, v19
    v_mfma_f32_16x16x32_bf16 v[108:111], v[36:39], v[204:207], v[108:111]
    s_waitcnt lgkmcnt(2)
    buffer_load_dwordx4 v4, s[4:7], s32 offen offset:1024 sc1 lds
    v_mfma_f32_16x16x32_bf16 v[160:163], v[40:43], a[200:203], v[160:163]
    ds_read_b128 v[32:35], v2 offset:256
    v_mfma_f32_16x16x32_bf16 v[160:163], v[44:47], a[204:207], v[160:163]
    v_exp_f32 v17, v121
    v_mfma_f32_16x16x32_bf16 v[164:167], v[40:43], a[224:227], v[164:167]
    v_cvt_pk_bf16_f32 v89, v18, v19
    v_mfma_f32_16x16x32_bf16 v[164:167], v[44:47], a[228:231], v[164:167]
    v_exp_f32 v18, v122
    v_mfma_f32_16x16x32_bf16 v[168:171], v[40:43], a[248:251], v[168:171]
    ds_read_b128 v[36:39], v3 offset:256
    v_add_f32 v7, v7, v16
    v_mfma_f32_16x16x32_bf16 v[168:171], v[44:47], a[252:255], v[168:171]
    v_add_f32 v7, v7, v17
    v_mfma_f32_16x16x32_bf16 v[172:175], v[40:43], v[208:211], v[172:175]
    v_exp_f32 v19, v123
    v_mfma_f32_16x16x32_bf16 v[172:175], v[44:47], v[212:215], v[172:175]
    s_waitcnt lgkmcnt(2)
    buffer_load_dwordx4 v4, s[4:7], s32 offen offset:2048 sc1 lds
    v_mfma_f32_16x16x32_bf16 v[96:99], v[24:27], a[200:203], v[96:99]
    ds_read_b128 v[40:43], v2 offset:6400
    v_cvt_pk_bf16_f32 v90, v16, v17
    v_mfma_f32_16x16x32_bf16 v[96:99], v[28:31], a[204:207], v[96:99]
    v_exp_f32 v16, v92
    v_mfma_f32_16x16x32_bf16 v[100:103], v[24:27], a[224:227], v[100:103]
    v_add_f32 v7, v7, v18
    v_add_f32 v7, v7, v19
    v_mfma_f32_16x16x32_bf16 v[100:103], v[28:31], a[228:231], v[100:103]
    v_exp_f32 v17, v93
    v_mfma_f32_16x16x32_bf16 v[104:107], v[24:27], a[248:251], v[104:107]
    ds_read_b128 v[44:47], v3 offset:6400
    v_cvt_pk_bf16_f32 v91, v18, v19
    v_mfma_f32_16x16x32_bf16 v[104:107], v[28:31], a[252:255], v[104:107]
    v_exp_f32 v18, v94
    v_mfma_f32_16x16x32_bf16 v[108:111], v[24:27], v[208:211], v[108:111]
    s_add_u32 s29, s30, 49152
    v_add_f32 v8, v8, v16
    s_add_u32 s32, s32, 24576
    v_mfma_f32_16x16x32_bf16 v[108:111], v[28:31], v[212:215], v[108:111]
    s_waitcnt lgkmcnt(2)
    v_add_f32 v8, v8, v17
    v_mfma_f32_16x16x32_bf16 v[160:163], v[32:35], a[208:211], v[160:163]
    s_sub_u32 s3, s29, 147456
    ds_read_b128 v[24:27], v2 offset:12288
    v_mfma_f32_16x16x32_bf16 v[160:163], v[36:39], a[212:215], v[160:163]
    v_exp_f32 v19, v95
    v_mfma_f32_16x16x32_bf16 v[164:167], v[32:35], a[232:235], v[164:167]
    v_cvt_pk_bf16_f32 v92, v16, v17
    v_mfma_f32_16x16x32_bf16 v[164:167], v[36:39], a[236:239], v[164:167]
    s_add_u32 s26, s26, 12288
    v_exp_f32 v16, v124
    v_mfma_f32_16x16x32_bf16 v[168:171], v[32:35], v[192:195], v[168:171]
    ds_read_b128 v[28:31], v3 offset:12288
    v_add_f32 v8, v8, v18
    v_mfma_f32_16x16x32_bf16 v[168:171], v[36:39], v[196:199], v[168:171]
    v_add_f32 v8, v8, v19
    v_mfma_f32_16x16x32_bf16 v[172:175], v[32:35], v[216:219], v[172:175]
    s_min_u32 s29, s29, s3
    v_mfma_f32_16x16x32_bf16 v[172:175], v[36:39], v[220:223], v[172:175]
    s_waitcnt lgkmcnt(2)
    v_exp_f32 v17, v125
    v_mfma_f32_16x16x32_bf16 v[96:99], v[40:43], a[208:211], v[96:99]
    s_mov_b32 m0, s26
    ds_read_b128 v[32:35], v2 offset:18432
    v_cvt_pk_bf16_f32 v93, v18, v19
    v_mfma_f32_16x16x32_bf16 v[96:99], v[44:47], a[212:215], v[96:99]
    v_exp_f32 v18, v126
    v_mfma_f32_16x16x32_bf16 v[100:103], v[40:43], a[232:235], v[100:103]
    v_mfma_f32_16x16x32_bf16 v[100:103], v[44:47], a[236:239], v[100:103]
    v_add_f32 v8, v8, v16
    v_mfma_f32_16x16x32_bf16 v[104:107], v[40:43], v[192:195], v[104:107]
    s_sub_u32 s3, s29, s30
    ds_read_b128 v[36:39], v3 offset:18432
    v_add_f32 v8, v8, v17
    v_mfma_f32_16x16x32_bf16 v[104:107], v[44:47], v[196:199], v[104:107]
    v_exp_f32 v19, v127
    v_mfma_f32_16x16x32_bf16 v[108:111], v[40:43], v[216:219], v[108:111]
    v_cvt_pk_bf16_f32 v94, v16, v17
    v_mfma_f32_16x16x32_bf16 v[108:111], v[44:47], v[220:223], v[108:111]
    s_waitcnt lgkmcnt(2)
    buffer_load_dwordx4 v4, s[4:7], s32 offen offset:0 sc1 lds
    v_mfma_f32_16x16x32_bf16 v[176:179], v[24:27], a[192:195], v[128:131]
    ds_read_b128 v[40:43], v2 offset:12416
    v_add_f32 v8, v8, v18
    v_mfma_f32_16x16x32_bf16 v[176:179], v[28:31], a[196:199], v[176:179]
    v_add_f32 v8, v8, v19
    v_cvt_pk_bf16_f32 v95, v18, v19
    v_mfma_f32_16x16x32_bf16 v[180:183], v[24:27], a[216:219], v[132:135]
    s_mov_b32 s30, s29
    v_mfma_f32_16x16x32_bf16 v[180:183], v[28:31], a[220:223], v[180:183]
    v_mfma_f32_16x16x32_bf16 v[184:187], v[24:27], a[240:243], v[136:139]
    ds_read_b128 v[44:47], v3 offset:12416
    v_mfma_f32_16x16x32_bf16 v[184:187], v[28:31], a[244:247], v[184:187]
    v_exp_f32 v16, v160
    v_mfma_f32_16x16x32_bf16 v[188:191], v[24:27], v[200:203], v[140:143]
    v_exp_f32 v17, v161
    v_mfma_f32_16x16x32_bf16 v[188:191], v[28:31], v[204:207], v[188:191]
    s_waitcnt lgkmcnt(2)
    v_exp_f32 v18, v162
    v_mfma_f32_16x16x32_bf16 v[112:115], v[32:35], a[192:195], v[128:131]
    ds_read_b128 v[24:27], v2 offset:18560
    v_add_f32 v5, v5, v16
    v_mfma_f32_16x16x32_bf16 v[112:115], v[36:39], a[196:199], v[112:115]
    buffer_load_dwordx4 v4, s[4:7], s32 offen offset:1024 sc1 lds
    v_mfma_f32_16x16x32_bf16 v[116:119], v[32:35], a[216:219], v[132:135]
    v_add_f32 v5, v5, v17
    v_add_u32 v1, s3, v1
    v_mfma_f32_16x16x32_bf16 v[116:119], v[36:39], a[220:223], v[116:119]
    v_exp_f32 v19, v163
    v_mfma_f32_16x16x32_bf16 v[120:123], v[32:35], a[240:243], v[136:139]
    ds_read_b128 v[28:31], v3 offset:18560
    v_cvt_pk_bf16_f32 v160, v16, v17
    v_mfma_f32_16x16x32_bf16 v[120:123], v[36:39], a[244:247], v[120:123]
    buffer_load_dword v15, v4, s[88:91], s93 offen
    v_mfma_f32_16x16x32_bf16 v[124:127], v[32:35], v[200:203], v[140:143]
    v_exp_f32 v16, v96
    v_mfma_f32_16x16x32_bf16 v[124:127], v[36:39], v[204:207], v[124:127]
    s_waitcnt lgkmcnt(2)
    v_add_f32 v5, v5, v18
    v_add_f32 v5, v5, v19
    v_mfma_f32_16x16x32_bf16 v[176:179], v[40:43], a[200:203], v[176:179]
    ds_read_b128 v[32:35], v2 offset:12544
    v_add_u32 v21, s3, v21
    v_mfma_f32_16x16x32_bf16 v[176:179], v[44:47], a[204:207], v[176:179]
    buffer_load_dwordx4 v4, s[4:7], s32 offen offset:2048 sc1 lds
    v_mfma_f32_16x16x32_bf16 v[180:183], v[40:43], a[224:227], v[180:183]
    v_exp_f32 v17, v97
    v_mfma_f32_16x16x32_bf16 v[180:183], v[44:47], a[228:231], v[180:183]
    v_cvt_pk_bf16_f32 v161, v18, v19
    v_mfma_f32_16x16x32_bf16 v[184:187], v[40:43], a[248:251], v[184:187]
    ds_read_b128 v[36:39], v3 offset:12544
    v_add_u32 v22, s3, v22
    v_mfma_f32_16x16x32_bf16 v[184:187], v[44:47], a[252:255], v[184:187]
    v_exp_f32 v18, v98
    v_mfma_f32_16x16x32_bf16 v[188:191], v[40:43], v[208:211], v[188:191]
    v_add_f32 v5, v5, v16
    v_add_f32 v5, v5, v17
    v_mfma_f32_16x16x32_bf16 v[188:191], v[44:47], v[212:215], v[188:191]
    s_waitcnt lgkmcnt(2)
    v_exp_f32 v19, v99
    v_mfma_f32_16x16x32_bf16 v[112:115], v[24:27], a[200:203], v[112:115]
    ds_read_b128 v[40:43], v2 offset:18688
    v_cvt_pk_bf16_f32 v162, v16, v17
    v_mfma_f32_16x16x32_bf16 v[112:115], v[28:31], a[204:207], v[112:115]
    v_exp_f32 v16, v164
    v_mfma_f32_16x16x32_bf16 v[116:119], v[24:27], a[224:227], v[116:119]
    v_add_f32 v5, v5, v18
    v_add_f32 v5, v5, v19
    v_mfma_f32_16x16x32_bf16 v[116:119], v[28:31], a[228:231], v[116:119]
    s_add_u32 s32, s32, 24576
    v_exp_f32 v17, v165
    v_mfma_f32_16x16x32_bf16 v[120:123], v[24:27], a[248:251], v[120:123]
    s_add_u32 s26, s26, 36864
    ds_read_b128 v[44:47], v3 offset:18688
    v_cvt_pk_bf16_f32 v163, v18, v19
    v_mfma_f32_16x16x32_bf16 v[120:123], v[28:31], a[252:255], v[120:123]
    s_waitcnt lgkmcnt(2)
    v_exp_f32 v18, v166
    v_mfma_f32_16x16x32_bf16 v[124:127], v[24:27], v[208:211], v[124:127]
    s_waitcnt vmcnt(25)
    v_add_f32 v6, v6, v16
    v_mfma_f32_16x16x32_bf16 v[124:127], v[28:31], v[212:215], v[124:127]
    s_barrier
    v_add_f32 v6, v6, v17
    v_mfma_f32_16x16x32_bf16 v[176:179], v[32:35], a[208:211], v[176:179]
    s_sub_u32 s57, s26, 147456
    ds_read_b128 v[24:27], v1 offset:0
    v_mfma_f32_16x16x32_bf16 v[176:179], v[36:39], a[212:215], v[176:179]
    v_exp_f32 v19, v167
    v_mfma_f32_16x16x32_bf16 v[180:183], v[32:35], a[232:235], v[180:183]
    s_min_u32 s26, s26, s57
    v_cvt_pk_bf16_f32 v164, v16, v17
    v_mfma_f32_16x16x32_bf16 v[180:183], v[36:39], a[236:239], v[180:183]
    v_exp_f32 v16, v100
    v_mfma_f32_16x16x32_bf16 v[184:187], v[32:35], v[192:195], v[184:187]
    ds_read_b128 v[28:31], v1 offset:12288
    v_add_f32 v6, v6, v18
    v_mfma_f32_16x16x32_bf16 v[184:187], v[36:39], v[196:199], v[184:187]
    v_add_f32 v6, v6, v19
    v_mfma_f32_16x16x32_bf16 v[188:191], v[32:35], v[216:219], v[188:191]
    v_exp_f32 v17, v101
    v_mfma_f32_16x16x32_bf16 v[188:191], v[36:39], v[220:223], v[188:191]
    s_waitcnt lgkmcnt(2)
    v_cvt_pk_bf16_f32 v165, v18, v19
    v_mfma_f32_16x16x32_bf16 v[112:115], v[40:43], a[208:211], v[112:115]
    ds_read_b128 v[32:35], v1 offset:768
    v_mfma_f32_16x16x32_bf16 v[112:115], v[44:47], a[212:215], v[112:115]
    v_exp_f32 v18, v102
    v_mfma_f32_16x16x32_bf16 v[116:119], v[40:43], a[232:235], v[116:119]
    v_add_f32 v6, v6, v16
    v_add_f32 v6, v6, v17
    v_mfma_f32_16x16x32_bf16 v[116:119], v[44:47], a[236:239], v[116:119]
    v_exp_f32 v19, v103
    v_mfma_f32_16x16x32_bf16 v[120:123], v[40:43], v[192:195], v[120:123]
    ds_read_b128 v[36:39], v1 offset:13056
    v_cvt_pk_bf16_f32 v166, v16, v17
    v_mfma_f32_16x16x32_bf16 v[120:123], v[44:47], v[196:199], v[120:123]
    v_add_f32 v6, v6, v18
    v_mfma_f32_16x16x32_bf16 v[124:127], v[40:43], v[216:219], v[124:127]
    v_add_f32 v6, v6, v19
    v_cvt_pk_bf16_f32 v167, v18, v19
    v_mfma_f32_16x16x32_bf16 v[124:127], v[44:47], v[220:223], v[124:127]
    s_waitcnt lgkmcnt(2)
    v_mfma_f32_16x16x32_bf16 a[0:3], v[64:67], v[24:27], a[0:3]
    ds_read_b128 v[40:43], v1 offset:1536
    v_mfma_f32_16x16x32_bf16 a[0:3], v[80:83], v[28:31], a[0:3]
    v_exp_f32 v16, v168
    v_mfma_f32_16x16x32_bf16 a[48:51], v[68:71], v[24:27], a[48:51]
    v_exp_f32 v17, v169
    v_mfma_f32_16x16x32_bf16 a[48:51], v[84:87], v[28:31], a[48:51]
    v_exp_f32 v18, v170
    v_mfma_f32_16x16x32_bf16 a[96:99], v[72:75], v[24:27], a[96:99]
    ds_read_b128 v[44:47], v1 offset:13824
    v_add_f32 v7, v7, v16
    v_mfma_f32_16x16x32_bf16 a[96:99], v[88:91], v[28:31], a[96:99]
    v_add_f32 v7, v7, v17
    v_mfma_f32_16x16x32_bf16 a[144:147], v[76:79], v[24:27], a[144:147]
    v_exp_f32 v19, v171
    v_mfma_f32_16x16x32_bf16 a[144:147], v[92:95], v[28:31], a[144:147]
    s_waitcnt lgkmcnt(2)
    v_mfma_f32_16x16x32_bf16 a[4:7], v[64:67], v[32:35], a[4:7]
    ds_read_b128 v[24:27], v1 offset:2304
    v_cvt_pk_bf16_f32 v168, v16, v17
    v_mfma_f32_16x16x32_bf16 a[4:7], v[80:83], v[36:39], a[4:7]
    v_exp_f32 v16, v104
    v_mfma_f32_16x16x32_bf16 a[52:55], v[68:71], v[32:35], a[52:55]
    v_add_f32 v7, v7, v18
    v_mfma_f32_16x16x32_bf16 a[52:55], v[84:87], v[36:39], a[52:55]
    v_add_f32 v7, v7, v19
    v_mfma_f32_16x16x32_bf16 a[100:103], v[72:75], v[32:35], a[100:103]
    ds_read_b128 v[28:31], v1 offset:14592
    v_mfma_f32_16x16x32_bf16 a[100:103], v[88:91], v[36:39], a[100:103]
    v_exp_f32 v17, v105
    v_mfma_f32_16x16x32_bf16 a[148:151], v[76:79], v[32:35], a[148:151]
    v_cvt_pk_bf16_f32 v169, v18, v19
    v_mfma_f32_16x16x32_bf16 a[148:151], v[92:95], v[36:39], a[148:151]
    s_waitcnt lgkmcnt(2)
    v_exp_f32 v18, v106
    v_mfma_f32_16x16x32_bf16 a[8:11], v[64:67], v[40:43], a[8:11]
    ds_read_b128 v[32:35], v21 offset:0
    v_add_f32 v7, v7, v16
    v_mfma_f32_16x16x32_bf16 a[8:11], v[80:83], v[44:47], a[8:11]
    v_add_f32 v7, v7, v17
    v_mfma_f32_16x16x32_bf16 a[56:59], v[68:71], v[40:43], a[56:59]
    v_exp_f32 v19, v107
    v_mfma_f32_16x16x32_bf16 a[56:59], v[84:87], v[44:47], a[56:59]
    v_mfma_f32_16x16x32_bf16 a[104:107], v[72:75], v[40:43], a[104:107]
    ds_read_b128 v[36:39], v21 offset:12288
    v_cvt_pk_bf16_f32 v170, v16, v17
    v_mfma_f32_16x16x32_bf16 a[104:107], v[88:91], v[44:47], a[104:107]
    v_exp_f32 v16, v172
    v_mfma_f32_16x16x32_bf16 a[152:155], v[76:79], v[40:43], a[152:155]
    v_add_f32 v7, v7, v18
    v_mfma_f32_16x16x32_bf16 a[152:155], v[92:95], v[44:47], a[152:155]
    s_waitcnt lgkmcnt(2)
    v_add_f32 v7, v7, v19
    v_mfma_f32_16x16x32_bf16 a[12:15], v[64:67], v[24:27], a[12:15]
    ds_read_b128 v[40:43], v21 offset:768
    v_mfma_f32_16x16x32_bf16 a[12:15], v[80:83], v[28:31], a[12:15]
    v_exp_f32 v17, v173
    v_mfma_f32_16x16x32_bf16 a[60:63], v[68:71], v[24:27], a[60:63]
    v_cvt_pk_bf16_f32 v171, v18, v19
    v_mfma_f32_16x16x32_bf16 a[60:63], v[84:87], v[28:31], a[60:63]
    v_exp_f32 v18, v174
    v_mfma_f32_16x16x32_bf16 a[108:111], v[72:75], v[24:27], a[108:111]
    ds_read_b128 v[44:47], v21 offset:13056
    v_add_f32 v8, v8, v16
    v_mfma_f32_16x16x32_bf16 a[108:111], v[88:91], v[28:31], a[108:111]
    s_waitcnt vmcnt(6)
    v_subrev_u32 v52, s92, v52
    v_cmp_lt_u32 vcc, 15, v52
    v_mfma_f32_16x16x32_bf16 a[156:159], v[76:79], v[24:27], a[156:159]
    s_add_u32 s29, s28, 49152
    v_add_f32 v8, v8, v17
    v_mfma_f32_16x16x32_bf16 a[156:159], v[92:95], v[28:31], a[156:159]
    s_waitcnt lgkmcnt(2)
    v_exp_f32 v19, v175
    v_mfma_f32_16x16x32_bf16 a[16:19], v[64:67], v[32:35], a[16:19]
    s_and_b32 s59, vcc_lo, 0xff
    ds_read_b128 v[24:27], v21 offset:1536
    v_cvt_pk_bf16_f32 v172, v16, v17
    v_mfma_f32_16x16x32_bf16 a[16:19], v[80:83], v[36:39], a[16:19]
    s_cbranch_scc1 L_pollslow7
L_pollok7:
    v_mfma_f32_16x16x32_bf16 a[64:67], v[68:71], v[32:35], a[64:67]
    s_sub_u32 s3, s29, 147456
    v_exp_f32 v16, v108
    v_mfma_f32_16x16x32_bf16 a[64:67], v[84:87], v[36:39], a[64:67]
    v_add_f32 v8, v8, v18
    v_add_f32 v8, v8, v19
    v_mfma_f32_16x16x32_bf16 a[112:115], v[72:75], v[32:35], a[112:115]
    s_mov_b32 m0, s56
    ds_read_b128 v[28:31], v21 offset:13824
    v_mfma_f32_16x16x32_bf16 a[112:115], v[88:91], v[36:39], a[112:115]
    v_exp_f32 v17, v109
    v_mfma_f32_16x16x32_bf16 a[160:163], v[76:79], v[32:35], a[160:163]
    v_cvt_pk_bf16_f32 v173, v18, v19
    v_mfma_f32_16x16x32_bf16 a[160:163], v[92:95], v[36:39], a[160:163]
    s_waitcnt lgkmcnt(2)
    buffer_load_dwordx4 v4, s[4:7], s27 offen offset:0 sc1 lds
    v_mfma_f32_16x16x32_bf16 a[20:23], v[64:67], v[40:43], a[20:23]
    s_min_u32 s29, s29, s3
    ds_read_b128 v[32:35], v21 offset:2304
    v_mfma_f32_16x16x32_bf16 a[20:23], v[80:83], v[44:47], a[20:23]
    v_exp_f32 v18, v110
    v_mfma_f32_16x16x32_bf16 a[68:71], v[68:71], v[40:43], a[68:71]
    v_add_f32 v8, v8, v16
    v_add_f32 v8, v8, v17
    v_mfma_f32_16x16x32_bf16 a[68:71], v[84:87], v[44:47], a[68:71]
    buffer_load_dwordx4 v4, s[4:7], s27 offen offset:1024 sc1 lds
    v_mfma_f32_16x16x32_bf16 a[116:119], v[72:75], v[40:43], a[116:119]
    ds_read_b128 v[36:39], v21 offset:14592
    v_mfma_f32_16x16x32_bf16 a[116:119], v[88:91], v[44:47], a[116:119]
    v_exp_f32 v19, v111
    v_mfma_f32_16x16x32_bf16 a[164:167], v[76:79], v[40:43], a[164:167]
    s_sub_u32 s3, s29, s28
    v_cvt_pk_bf16_f32 v174, v16, v17
    v_add_f32 v8, v8, v18
    v_mfma_f32_16x16x32_bf16 a[164:167], v[92:95], v[44:47], a[164:167]
    s_waitcnt lgkmcnt(2)
    v_add_f32 v8, v8, v19
    v_cvt_pk_bf16_f32 v175, v18, v19
    v_mfma_f32_16x16x32_bf16 a[24:27], v[64:67], v[24:27], a[24:27]
    ds_read_b128 v[40:43], v22 offset:0
    v_mfma_f32_16x16x32_bf16 a[24:27], v[80:83], v[28:31], a[24:27]
    buffer_load_dwordx4 v4, s[4:7], s27 offen offset:2048 sc1 lds
    v_mfma_f32_16x16x32_bf16 a[72:75], v[68:71], v[24:27], a[72:75]
    v_exp_f32 v16, v176
    v_mfma_f32_16x16x32_bf16 a[72:75], v[84:87], v[28:31], a[72:75]
    v_exp_f32 v17, v177
    v_mfma_f32_16x16x32_bf16 a[120:123], v[72:75], v[24:27], a[120:123]
    s_add_u32 s27, s27, 24576
    ds_read_b128 v[44:47], v22 offset:12288
    v_mfma_f32_16x16x32_bf16 a[120:123], v[88:91], v[28:31], a[120:123]
    s_mov_b32 s28, s29
    v_exp_f32 v18, v178
    v_mfma_f32_16x16x32_bf16 a[168:171], v[76:79], v[24:27], a[168:171]
    v_add_f32 v5, v5, v16
    v_add_f32 v5, v5, v17
    v_mfma_f32_16x16x32_bf16 a[168:171], v[92:95], v[28:31], a[168:171]
    s_waitcnt lgkmcnt(2)
    v_exp_f32 v19, v179
    v_mfma_f32_16x16x32_bf16 a[28:31], v[64:67], v[32:35], a[28:31]
    s_add_u32 s56, s56, 12288
    ds_read_b128 v[24:27], v22 offset:768
    v_cvt_pk_bf16_f32 v176, v16, v17
    v_mfma_f32_16x16x32_bf16 a[28:31], v[80:83], v[36:39], a[28:31]
    s_mov_b32 m0, s56
    v_exp_f32 v16, v112
    v_mfma_f32_16x16x32_bf16 a[76:79], v[68:71], v[32:35], a[76:79]
    v_add_f32 v5, v5, v18
    v_mfma_f32_16x16x32_bf16 a[76:79], v[84:87], v[36:39], a[76:79]
    v_add_f32 v5, v5, v19
    v_mfma_f32_16x16x32_bf16 a[124:127], v[72:75], v[32:35], a[124:127]
    ds_read_b128 v[28:31], v22 offset:13056
    v_add_u32 v2, s3, v2
    v_mfma_f32_16x16x32_bf16 a[124:127], v[88:91], v[36:39], a[124:127]
    buffer_load_dwordx4 v4, s[4:7], s27 offen offset:0 sc1 lds
    v_mfma_f32_16x16x32_bf16 a[172:175], v[76:79], v[32:35], a[172:175]
    v_exp_f32 v17, v113
    v_mfma_f32_16x16x32_bf16 a[172:175], v[92:95], v[36:39], a[172:175]
    s_waitcnt lgkmcnt(2)
    v_cvt_pk_bf16_f32 v177, v18, v19
    v_mfma_f32_16x16x32_bf16 a[32:35], v[64:67], v[40:43], a[32:35]
    ds_read_b128 v[32:35], v22 offset:1536
    v_mfma_f32_16x16x32_bf16 a[32:35], v[80:83], v[44:47], a[32:35]
    v_exp_f32 v18, v114
    v_mfma_f32_16x16x32_bf16 a[80:83], v[68:71], v[40:43], a[80:83]
    v_add_f32 v5, v5, v16
    v_add_f32 v5, v5, v17
    v_mfma_f32_16x16x32_bf16 a[80:83], v[84:87], v[44:47], a[80:83]
    buffer_load_dwordx4 v4, s[4:7], s27 offen offset:1024 sc1 lds
    v_mfma_f32_16x16x32_bf16 a[128:131], v[72:75], v[40:43], a[128:131]
    ds_read_b128 v[36:39], v22 offset:13824
    v_add_u32 v3, s3, v3
    v_mfma_f32_16x16x32_bf16 a[128:131], v[88:91], v[44:47], a[128:131]
    v_exp_f32 v19, v115
    v_mfma_f32_16x16x32_bf16 a[176:179], v[76:79], v[40:43], a[176:179]
    v_cvt_pk_bf16_f32 v178, v16, v17
    v_mfma_f32_16x16x32_bf16 a[176:179], v[92:95], v[44:47], a[176:179]
    s_waitcnt lgkmcnt(2)
    buffer_load_dwordx4 v4, s[4:7], s27 offen offset:2048 sc1 lds
    v_mfma_f32_16x16x32_bf16 a[36:39], v[64:67], v[24:27], a[36:39]
    ds_read_b128 v[40:43], v22 offset:2304
    v_mfma_f32_16x16x32_bf16 a[36:39], v[80:83], v[28:31], a[36:39]
    v_exp_f32 v16, v180
    v_mfma_f32_16x16x32_bf16 a[84:87], v[68:71], v[24:27], a[84:87]
    v_add_f32 v5, v5, v18
    v_add_f32 v5, v5, v19
    v_mfma_f32_16x16x32_bf16 a[84:87], v[84:87], v[28:31], a[84:87]
    v_exp_f32 v17, v181
    v_mfma_f32_16x16x32_bf16 a[132:135], v[72:75], v[24:27], a[132:135]
    ds_read_b128 v[44:47], v22 offset:14592
    v_cvt_pk_bf16_f32 v179, v18, v19
    v_mfma_f32_16x16x32_bf16 a[132:135], v[88:91], v[28:31], a[132:135]
    s_waitcnt lgkmcnt(2)
    v_exp_f32 v18, v182
    v_mfma_f32_16x16x32_bf16 a[180:183], v[76:79], v[24:27], a[180:183]
    s_waitcnt vmcnt(21)
    v_add_f32 v6, v6, v16
    v_add_f32 v6, v6, v17
    v_mfma_f32_16x16x32_bf16 a[180:183], v[92:95], v[28:31], a[180:183]
    s_barrier
    s_add_u32 s27, s27, 24576
    v_mfma_f32_16x16x32_bf16 a[40:43], v[64:67], v[32:35], a[40:43]
    s_add_u32 s56, s56, 36864
    ds_read_b128 v[24:27], v2 offset:0
    v_mfma_f32_16x16x32_bf16 a[40:43], v[80:83], v[36:39], a[40:43]
    s_sub_u32 s58, s56, 147456
    v_exp_f32 v19, v183
    v_mfma_f32_16x16x32_bf16 a[88:91], v[68:71], v[32:35], a[88:91]
    v_cvt_pk_bf16_f32 v180, v16, v17
    v_mfma_f32_16x16x32_bf16 a[88:91], v[84:87], v[36:39], a[88:91]
    v_exp_f32 v16, v116
    v_mfma_f32_16x16x32_bf16 a[136:139], v[72:75], v[32:35], a[136:139]
    s_min_u32 s56, s56, s58
    ds_read_b128 v[28:31], v3 offset:0
    v_add_f32 v6, v6, v18
    v_mfma_f32_16x16x32_bf16 a[136:139], v[88:91], v[36:39], a[136:139]
    v_add_f32 v6, v6, v19
    v_mfma_f32_16x16x32_bf16 a[184:187], v[76:79], v[32:35], a[184:187]
    v_exp_f32 v17, v117
    v_mfma_f32_16x16x32_bf16 a[184:187], v[92:95], v[36:39], a[184:187]
    s_waitcnt lgkmcnt(2)
    v_cvt_pk_bf16_f32 v181, v18, v19
    v_mfma_f32_16x16x32_bf16 a[44:47], v[64:67], v[40:43], a[44:47]
    ds_read_b128 v[32:35], v2 offset:6144
    v_mfma_f32_16x16x32_bf16 a[44:47], v[80:83], v[44:47], a[44:47]
    v_exp_f32 v18, v118
    v_mfma_f32_16x16x32_bf16 a[92:95], v[68:71], v[40:43], a[92:95]
    v_add_f32 v6, v6, v16
    v_add_f32 v6, v6, v17
    v_mfma_f32_16x16x32_bf16 a[92:95], v[84:87], v[44:47], a[92:95]
    v_exp_f32 v19, v119
    v_mfma_f32_16x16x32_bf16 a[140:143], v[72:75], v[40:43], a[140:143]
    ds_read_b128 v[36:39], v3 offset:6144
    v_cvt_pk_bf16_f32 v182, v16, v17
    v_mfma_f32_16x16x32_bf16 a[140:143], v[88:91], v[44:47], a[140:143]
    v_add_f32 v6, v6, v18
    v_add_f32 v6, v6, v19
    v_mfma_f32_16x16x32_bf16 a[188:191], v[76:79], v[40:43], a[188:191]
    v_cvt_pk_bf16_f32 v183, v18, v19
    v_mfma_f32_16x16x32_bf16 a[188:191], v[92:95], v[44:47], a[188:191]
    s_waitcnt lgkmcnt(2)
    v_mfma_f32_16x16x32_bf16 v[64:67], v[24:27], a[192:195], v[128:131]
    s_mov_b32 m0, s26
    ds_read_b128 v[40:43], v2 offset:128
    v_mfma_f32_16x16x32_bf16 v[64:67], v[28:31], a[196:199], v[64:67]
    v_exp_f32 v16, v184
    v_mfma_f32_16x16x32_bf16 v[68:71], v[24:27], a[216:219], v[132:135]
    v_exp_f32 v17, v185
    v_mfma_f32_16x16x32_bf16 v[68:71], v[28:31], a[220:223], v[68:71]
    v_exp_f32 v18, v186
    v_mfma_f32_16x16x32_bf16 v[72:75], v[24:27], a[240:243], v[136:139]
    ds_read_b128 v[44:47], v3 offset:128
    v_mfma_f32_16x16x32_bf16 v[72:75], v[28:31], a[244:247], v[72:75]
    buffer_load_dwordx4 v4, s[4:7], s32 offen offset:0 sc1 lds
    v_mfma_f32_16x16x32_bf16 v[76:79], v[24:27], v[200:203], v[140:143]
    v_add_f32 v7, v7, v16
    v_add_f32 v7, v7, v17
    v_mfma_f32_16x16x32_bf16 v[76:79], v[28:31], v[204:207], v[76:79]
    s_waitcnt lgkmcnt(2)
    v_exp_f32 v19, v187
    v_mfma_f32_16x16x32_bf16 v[96:99], v[32:35], a[192:195], v[128:131]
    ds_read_b128 v[24:27], v2 offset:6272
    v_cvt_pk_bf16_f32 v184, v16, v17
    v_mfma_f32_16x16x32_bf16 v[96:99], v[36:39], a[196:199], v[96:99]
    v_mfma_f32_16x16x32_bf16 v[100:103], v[32:35], a[216:219], v[132:135]
    v_exp_f32 v16, v120
    v_mfma_f32_16x16x32_bf16 v[100:103], v[36:39], a[220:223], v[100:103]
    v_add_f32 v7, v7, v18
    v_mfma_f32_16x16x32_bf16 v[104:107], v[32:35], a[240:243], v[136:139]
    ds_read_b128 v[28:31], v3 offset:6272
    v_add_f32 v7, v7, v19
    v_mfma_f32_16x16x32_bf16 v[104:107], v[36:39], a[244:247], v[104:107]
    v_exp_f32 v17, v121
    v_mfma_f32_16x16x32_bf16 v[108:111], v[32:35], v[200:203], v[140:143]
    v_mfma_f32_16x16x32_bf16 v[108:111], v[36:39], v[204:207], v[108:111]
    s_waitcnt lgkmcnt(2)
    buffer_load_dwordx4 v4, s[4:7], s32 offen offset:1024 sc1 lds
    v_mfma_f32_16x16x32_bf16 v[64:67], v[40:43], a[200:203], v[64:67]
    ds_read_b128 v[32:35], v2 offset:256
    v_cvt_pk_bf16_f32 v185, v18, v19
    v_mfma_f32_16x16x32_bf16 v[64:67], v[44:47], a[204:207], v[64:67]
    v_exp_f32 v18, v122
    v_mfma_f32_16x16x32_bf16 v[68:71], v[40:43], a[224:227], v[68:71]
    v_add_f32 v7, v7, v16
    v_add_f32 v7, v7, v17
    v_mfma_f32_16x16x32_bf16 v[68:71], v[44:47], a[228:231], v[68:71]
    v_mfma_f32_16x16x32_bf16 v[72:75], v[40:43], a[248:251], v[72:75]
    ds_read_b128 v[36:39], v3 offset:256
    v_mfma_f32_16x16x32_bf16 v[72:75], v[44:47], a[252:255], v[72:75]
    v_exp_f32 v19, v123
    v_mfma_f32_16x16x32_bf16 v[76:79], v[40:43], v[208:211], v[76:79]
    v_cvt_pk_bf16_f32 v186, v16, v17
    v_mfma_f32_16x16x32_bf16 v[76:79], v[44:47], v[212:215], v[76:79]
    s_waitcnt lgkmcnt(2)
    buffer_load_dwordx4 v4, s[4:7], s32 offen offset:2048 sc1 lds
    v_mfma_f32_16x16x32_bf16 v[96:99], v[24:27], a[200:203], v[96:99]
    ds_read_b128 v[40:43], v2 offset:6400
    v_mfma_f32_16x16x32_bf16 v[96:99], v[28:31], a[204:207], v[96:99]
    v_exp_f32 v16, v188
    v_mfma_f32_16x16x32_bf16 v[100:103], v[24:27], a[224:227], v[100:103]
    v_add_f32 v7, v7, v18
    v_add_f32 v7, v7, v19
    v_mfma_f32_16x16x32_bf16 v[100:103], v[28:31], a[228:231], v[100:103]
    v_exp_f32 v17, v189
    v_mfma_f32_16x16x32_bf16 v[104:107], v[24:27], a[248:251], v[104:107]
    ds_read_b128 v[44:47], v3 offset:6400
    v_cvt_pk_bf16_f32 v187, v18, v19
    v_mfma_f32_16x16x32_bf16 v[104:107], v[28:31], a[252:255], v[104:107]
    v_exp_f32 v18, v190
    v_mfma_f32_16x16x32_bf16 v[108:111], v[24:27], v[208:211], v[108:111]
    s_add_u32 s29, s30, 49152
    v_add_f32 v8, v8, v16
    s_add_u32 s32, s32, 24576
    v_mfma_f32_16x16x32_bf16 v[108:111], v[28:31], v[212:215], v[108:111]
    s_waitcnt lgkmcnt(2)
    v_add_f32 v8, v8, v17
    v_mfma_f32_16x16x32_bf16 v[64:67], v[32:35], a[208:211], v[64:67]
    s_sub_u32 s3, s29, 147456
    ds_read_b128 v[24:27], v2 offset:12288
    v_mfma_f32_16x16x32_bf16 v[64:67], v[36:39], a[212:215], v[64:67]
    v_exp_f32 v19, v191
    v_mfma_f32_16x16x32_bf16 v[68:71], v[32:35], a[232:235], v[68:71]
    v_cvt_pk_bf16_f32 v188, v16, v17
    v_mfma_f32_16x16x32_bf16 v[68:71], v[36:39], a[236:239], v[68:71]
    s_add_u32 s26, s26, 12288
    v_exp_f32 v16, v124
    v_mfma_f32_16x16x32_bf16 v[72:75], v[32:35], v[192:195], v[72:75]
    ds_read_b128 v[28:31], v3 offset:12288
    v_add_f32 v8, v8, v18
    v_mfma_f32_16x16x32_bf16 v[72:75], v[36:39], v[196:199], v[72:75]
    v_add_f32 v8, v8, v19
    v_mfma_f32_16x16x32_bf16 v[76:79], v[32:35], v[216:219], v[76:79]
    s_min_u32 s29, s29, s3
    v_mfma_f32_16x16x32_bf16 v[76:79], v[36:39], v[220:223], v[76:79]
    s_waitcnt lgkmcnt(2)
    v_exp_f32 v17, v125
    v_mfma_f32_16x16x32_bf16 v[96:99], v[40:43], a[208:211], v[96:99]
    s_mov_b32 m0, s26
    ds_read_b128 v[32:35], v2 offset:18432
    v_cvt_pk_bf16_f32 v189, v18, v19
    v_mfma_f32_16x16x32_bf16 v[96:99], v[44:47], a[212:215], v[96:99]
    v_exp_f32 v18, v126
    v_mfma_f32_16x16x32_bf16 v[100:103], v[40:43], a[232:235], v[100:103]
    v_mfma_f32_16x16x32_bf16 v[100:103], v[44:47], a[236:239], v[100:103]
    v_add_f32 v8, v8, v16
    v_mfma_f32_16x16x32_bf16 v[104:107], v[40:43], v[192:195], v[104:107]
    s_sub_u32 s3, s29, s30
    ds_read_b128 v[36:39], v3 offset:18432
    v_add_f32 v8, v8, v17
    v_mfma_f32_16x16x32_bf16 v[104:107], v[44:47], v[196:199], v[104:107]
    v_exp_f32 v19, v127
    v_mfma_f32_16x16x32_bf16 v[108:111], v[40:43], v[216:219], v[108:111]
    v_cvt_pk_bf16_f32 v190, v16, v17
    v_mfma_f32_16x16x32_bf16 v[108:111], v[44:47], v[220:223], v[108:111]
    s_waitcnt lgkmcnt(2)
    buffer_load_dwordx4 v4, s[4:7], s32 offen offset:0 sc1 lds
    v_mfma_f32_16x16x32_bf16 v[80:83], v[24:27], a[192:195], v[128:131]
    ds_read_b128 v[40:43], v2 offset:12416
    v_add_f32 v8, v8, v18
    v_mfma_f32_16x16x32_bf16 v[80:83], v[28:31], a[196:199], v[80:83]
    v_add_f32 v8, v8, v19
    v_cvt_pk_bf16_f32 v191, v18, v19
    v_mfma_f32_16x16x32_bf16 v[84:87], v[24:27], a[216:219], v[132:135]
    s_mov_b32 s30, s29
    v_mfma_f32_16x16x32_bf16 v[84:87], v[28:31], a[220:223], v[84:87]
    v_mfma_f32_16x16x32_bf16 v[88:91], v[24:27], a[240:243], v[136:139]
    ds_read_b128 v[44:47], v3 offset:12416
    v_mfma_f32_16x16x32_bf16 v[88:91], v[28:31], a[244:247], v[88:91]
    v_exp_f32 v16, v64
    v_mfma_f32_16x16x32_bf16 v[92:95], v[24:27], v[200:203], v[140:143]
    v_exp_f32 v17, v65
    v_mfma_f32_16x16x32_bf16 v[92:95], v[28:31], v[204:207], v[92:95]
    s_waitcnt lgkmcnt(2)
    v_exp_f32 v18, v66
    v_mfma_f32_16x16x32_bf16 v[112:115], v[32:35], a[192:195], v[128:131]
    ds_read_b128 v[24:27], v2 offset:18560
    v_add_f32 v5, v5, v16
    v_mfma_f32_16x16x32_bf16 v[112:115], v[36:39], a[196:199], v[112:115]
    buffer_load_dwordx4 v4, s[4:7], s32 offen offset:1024 sc1 lds
    v_mfma_f32_16x16x32_bf16 v[116:119], v[32:35], a[216:219], v[132:135]
    v_add_f32 v5, v5, v17
    v_add_u32 v1, s3, v1
    v_mfma_f32_16x16x32_bf16 v[116:119], v[36:39], a[220:223], v[116:119]
    v_exp_f32 v19, v67
    v_mfma_f32_16x16x32_bf16 v[120:123], v[32:35], a[240:243], v[136:139]
    ds_read_b128 v[28:31], v3 offset:18560
    v_cvt_pk_bf16_f32 v64, v16, v17
    v_mfma_f32_16x16x32_bf16 v[120:123], v[36:39], a[244:247], v[120:123]
    v_exp_f32 v16, v96
    v_mfma_f32_16x16x32_bf16 v[124:127], v[32:35], v[200:203], v[140:143]
    v_add_f32 v5, v5, v18
    v_add_f32 v5, v5, v19
    v_mfma_f32_16x16x32_bf16 v[124:127], v[36:39], v[204:207], v[124:127]
    s_waitcnt lgkmcnt(2)
    v_exp_f32 v17, v97
    v_mfma_f32_16x16x32_bf16 v[80:83], v[40:43], a[200:203], v[80:83]
    ds_read_b128 v[32:35], v2 offset:12544
    v_add_u32 v21, s3, v21
    v_mfma_f32_16x16x32_bf16 v[80:83], v[44:47], a[204:207], v[80:83]
    buffer_load_dwordx4 v4, s[4:7], s32 offen offset:2048 sc1 lds
    v_mfma_f32_16x16x32_bf16 v[84:87], v[40:43], a[224:227], v[84:87]
    v_cvt_pk_bf16_f32 v65, v18, v19
    v_mfma_f32_16x16x32_bf16 v[84:87], v[44:47], a[228:231], v[84:87]
    v_exp_f32 v18, v98
    v_mfma_f32_16x16x32_bf16 v[88:91], v[40:43], a[248:251], v[88:91]
    ds_read_b128 v[36:39], v3 offset:12544
    v_add_f32 v5, v5, v16
    v_mfma_f32_16x16x32_bf16 v[88:91], v[44:47], a[252:255], v[88:91]
    v_add_f32 v5, v5, v17
    v_add_u32 v22, s3, v22
    v_mfma_f32_16x16x32_bf16 v[92:95], v[40:43], v[208:211], v[92:95]
    v_exp_f32 v19, v99
    v_mfma_f32_16x16x32_bf16 v[92:95], v[44:47], v[212:215], v[92:95]
    s_waitcnt lgkmcnt(2)
    v_cvt_pk_bf16_f32 v66, v16, v17
    v_mfma_f32_16x16x32_bf16 v[112:115], v[24:27], a[200:203], v[112:115]
    ds_read_b128 v[40:43], v2 offset:18688
    v_mfma_f32_16x16x32_bf16 v[112:115], v[28:31], a[204:207], v[112:115]
    v_exp_f32 v16, v68
    v_mfma_f32_16x16x32_bf16 v[116:119], v[24:27], a[224:227], v[116:119]
    v_add_f32 v5, v5, v18
    v_add_f32 v5, v5, v19
    v_mfma_f32_16x16x32_bf16 v[116:119], v[28:31], a[228:231], v[116:119]
    s_add_u32 s32, s32, 24576
    v_exp_f32 v17, v69
    v_mfma_f32_16x16x32_bf16 v[120:123], v[24:27], a[248:251], v[120:123]
    s_add_u32 s26, s26, 36864
    ds_read_b128 v[44:47], v3 offset:18688
    v_cvt_pk_bf16_f32 v67, v18, v19
    v_mfma_f32_16x16x32_bf16 v[120:123], v[28:31], a[252:255], v[120:123]
    s_waitcnt lgkmcnt(2)
    v_exp_f32 v18, v70
    v_mfma_f32_16x16x32_bf16 v[124:127], v[24:27], v[208:211], v[124:127]
    s_waitcnt vmcnt(20)
    v_add_f32 v6, v6, v16
    v_add_f32 v6, v6, v17
    v_mfma_f32_16x16x32_bf16 v[124:127], v[28:31], v[212:215], v[124:127]
    s_barrier
    s_sub_u32 s57, s26, 147456
    v_mfma_f32_16x16x32_bf16 v[80:83], v[32:35], a[208:211], v[80:83]
    ds_read_b128 v[24:27], v1 offset:0
    v_mfma_f32_16x16x32_bf16 v[80:83], v[36:39], a[212:215], v[80:83]
    v_exp_f32 v19, v71
    v_mfma_f32_16x16x32_bf16 v[84:87], v[32:35], a[232:235], v[84:87]
    s_min_u32 s26, s26, s57
    v_cvt_pk_bf16_f32 v68, v16, v17
    v_mfma_f32_16x16x32_bf16 v[84:87], v[36:39], a[236:239], v[84:87]
    v_exp_f32 v16, v100
    v_mfma_f32_16x16x32_bf16 v[88:91], v[32:35], v[192:195], v[88:91]
    ds_read_b128 v[28:31], v1 offset:12288
    v_add_f32 v6, v6, v18
    v_mfma_f32_16x16x32_bf16 v[88:91], v[36:39], v[196:199], v[88:91]
    v_add_f32 v6, v6, v19
    v_mfma_f32_16x16x32_bf16 v[92:95], v[32:35], v[216:219], v[92:95]
    v_exp_f32 v17, v101
    v_mfma_f32_16x16x32_bf16 v[92:95], v[36:39], v[220:223], v[92:95]
    s_waitcnt lgkmcnt(2)
    v_cvt_pk_bf16_f32 v69, v18, v19
    v_mfma_f32_16x16x32_bf16 v[112:115], v[40:43], a[208:211], v[112:115]
    ds_read_b128 v[32:35], v1 offset:768
    v_mfma_f32_16x16x32_bf16 v[112:115], v[44:47], a[212:215], v[112:115]
    v_exp_f32 v18, v102
    v_mfma_f32_16x16x32_bf16 v[116:119], v[40:43], a[232:235], v[116:119]
    v_add_f32 v6, v6, v16
    v_add_f32 v6, v6, v17
    v_mfma_f32_16x16x32_bf16 v[116:119], v[44:47], a[236:239], v[116:119]
    v_exp_f32 v19, v103
    v_mfma_f32_16x16x32_bf16 v[120:123], v[40:43], v[192:195], v[120:123]
    s_sub_u32 s31, s31, 1
    ds_read_b128 v[36:39], v1 offset:13056
    v_cvt_pk_bf16_f32 v70, v16, v17
    v_mfma_f32_16x16x32_bf16 v[120:123], v[44:47], v[196:199], v[120:123]
    v_add_f32 v6, v6, v18
    v_add_f32 v6, v6, v19
    v_mfma_f32_16x16x32_bf16 v[124:127], v[40:43], v[216:219], v[124:127]
    s_waitcnt lgkmcnt(2)
    s_cmp_lg_u32 s31, 0
    v_cvt_pk_bf16_f32 v71, v18, v19
    v_mfma_f32_16x16x32_bf16 v[124:127], v[44:47], v[220:223], v[124:127]
    s_cbranch_scc1 L_loop2
    v_mfma_f32_16x16x32_bf16 a[0:3], v[160:163], v[24:27], a[0:3]
    ds_read_b128 v[40:43], v1 offset:1536
    ds_read_b128 v[44:47], v1 offset:13824
    v_mfma_f32_16x16x32_bf16 a[0:3], v[176:179], v[28:31], a[0:3]
    s_mov_b32 m0, s56
    s_add_u32 s29, s28, 49152
    s_sub_u32 s3, s29, 147456
    v_mfma_f32_16x16x32_bf16 a[48:51], v[164:167], v[24:27], a[48:51]
    ds_read_b128 v[240:243], v1 offset:2304
    s_min_u32 s29, s29, s3
    v_mfma_f32_16x16x32_bf16 a[48:51], v[180:183], v[28:31], a[48:51]
    s_waitcnt lgkmcnt(3)
    s_sub_u32 s3, s29, s28
    s_mov_b32 s28, s29
    v_mfma_f32_16x16x32_bf16 a[4:7], v[160:163], v[32:35], a[4:7]
    ds_read_b128 v[244:247], v1 offset:14592
    ds_read_b128 v[248:251], v21 offset:0
    v_mfma_f32_16x16x32_bf16 a[4:7], v[176:179], v[36:39], a[4:7]
    buffer_load_dwordx4 v4, s[4:7], s27 offen offset:0 sc1 lds
    v_mfma_f32_16x16x32_bf16 a[52:55], v[164:167], v[32:35], a[52:55]
    ds_read_b128 v[252:255], v21 offset:12288
    v_add_u32 v2, s3, v2
    v_mfma_f32_16x16x32_bf16 a[52:55], v[180:183], v[36:39], a[52:55]
    s_waitcnt lgkmcnt(4)
    v_add_u32 v3, s3, v3
    v_mfma_f32_16x16x32_bf16 a[8:11], v[160:163], v[40:43], a[8:11]
    ds_read_b128 v[24:27], v21 offset:768
    v_mfma_f32_16x16x32_bf16 a[8:11], v[176:179], v[44:47], a[8:11]
    buffer_load_dwordx4 v4, s[4:7], s27 offen offset:1024 sc1 lds
    v_mfma_f32_16x16x32_bf16 a[56:59], v[164:167], v[40:43], a[56:59]
    ds_read_b128 v[28:31], v21 offset:13056
    v_mfma_f32_16x16x32_bf16 a[56:59], v[180:183], v[44:47], a[56:59]
    s_waitcnt lgkmcnt(4)
    v_exp_f32 v16, v80
    v_mfma_f32_16x16x32_bf16 a[12:15], v[160:163], v[240:243], a[12:15]
    ds_read_b128 v[32:35], v21 offset:1536
    v_mfma_f32_16x16x32_bf16 a[12:15], v[176:179], v[244:247], a[12:15]
    buffer_load_dwordx4 v4, s[4:7], s27 offen offset:2048 sc1 lds
    v_mfma_f32_16x16x32_bf16 a[60:63], v[164:167], v[240:243], a[60:63]
    ds_read_b128 v[36:39], v21 offset:13824
    v_mfma_f32_16x16x32_bf16 a[60:63], v[180:183], v[244:247], a[60:63]
    s_waitcnt lgkmcnt(4)
    v_exp_f32 v17, v81
    v_mfma_f32_16x16x32_bf16 a[16:19], v[160:163], v[248:251], a[16:19]
    ds_read_b128 v[40:43], v21 offset:2304
    v_mfma_f32_16x16x32_bf16 a[16:19], v[176:179], v[252:255], a[16:19]
    s_add_u32 s27, s27, 24576
    s_add_u32 s56, s56, 12288
    s_mov_b32 m0, s56
    v_mfma_f32_16x16x32_bf16 a[64:67], v[164:167], v[248:251], a[64:67]
    ds_read_b128 v[44:47], v21 offset:14592
    v_mfma_f32_16x16x32_bf16 a[64:67], v[180:183], v[252:255], a[64:67]
    s_waitcnt lgkmcnt(4)
    v_exp_f32 v18, v82
    v_mfma_f32_16x16x32_bf16 a[20:23], v[160:163], v[24:27], a[20:23]
    ds_read_b128 v[240:243], v22 offset:0
    v_add_f32 v5, v5, v16
    v_mfma_f32_16x16x32_bf16 a[20:23], v[176:179], v[28:31], a[20:23]
    buffer_load_dwordx4 v4, s[4:7], s27 offen offset:0 sc1 lds
    v_mfma_f32_16x16x32_bf16 a[68:71], v[164:167], v[24:27], a[68:71]
    ds_read_b128 v[244:247], v22 offset:12288
    v_add_f32 v5, v5, v17
    v_mfma_f32_16x16x32_bf16 a[68:71], v[180:183], v[28:31], a[68:71]
    s_waitcnt lgkmcnt(4)
    v_exp_f32 v19, v83
    v_mfma_f32_16x16x32_bf16 a[24:27], v[160:163], v[32:35], a[24:27]
    ds_read_b128 v[248:251], v22 offset:768
    v_cvt_pk_bf16_f32 v80, v16, v17
    v_mfma_f32_16x16x32_bf16 a[24:27], v[176:179], v[36:39], a[24:27]
    buffer_load_dwordx4 v4, s[4:7], s27 offen offset:1024 sc1 lds
    v_mfma_f32_16x16x32_bf16 a[72:75], v[164:167], v[32:35], a[72:75]
    ds_read_b128 v[252:255], v22 offset:13056
    v_mfma_f32_16x16x32_bf16 a[72:75], v[180:183], v[36:39], a[72:75]
    s_waitcnt lgkmcnt(4)
    v_exp_f32 v16, v112
    v_mfma_f32_16x16x32_bf16 a[28:31], v[160:163], v[40:43], a[28:31]
    ds_read_b128 v[24:27], v22 offset:1536
    v_add_f32 v5, v5, v18
    v_mfma_f32_16x16x32_bf16 a[28:31], v[176:179], v[44:47], a[28:31]
    s_waitcnt vmcnt(63)
    s_barrier
    v_mfma_f32_16x16x32_bf16 a[76:79], v[164:167], v[40:43], a[76:79]
    ds_read_b128 v[28:31], v22 offset:13824
    v_add_f32 v5, v5, v19
    v_mfma_f32_16x16x32_bf16 a[76:79], v[180:183], v[44:47], a[76:79]
    s_waitcnt lgkmcnt(4)
    v_exp_f32 v17, v113
    v_mfma_f32_16x16x32_bf16 a[32:35], v[160:163], v[240:243], a[32:35]
    ds_read_b128 v[32:35], v22 offset:2304
    v_cvt_pk_bf16_f32 v81, v18, v19
    v_mfma_f32_16x16x32_bf16 a[32:35], v[176:179], v[244:247], a[32:35]
    buffer_load_dwordx4 v4, s[4:7], s27 offen offset:2048 sc1 lds
    v_mfma_f32_16x16x32_bf16 a[80:83], v[164:167], v[240:243], a[80:83]
    ds_read_b128 v[36:39], v22 offset:14592
    v_mfma_f32_16x16x32_bf16 a[80:83], v[180:183], v[244:247], a[80:83]
    s_waitcnt lgkmcnt(4)
    v_exp_f32 v18, v114
    v_mfma_f32_16x16x32_bf16 a[36:39], v[160:163], v[248:251], a[36:39]
    ds_read_b128 v[40:43], v2 offset:0
    v_add_f32 v5, v5, v16
    v_mfma_f32_16x16x32_bf16 a[36:39], v[176:179], v[252:255], a[36:39]
    v_add_f32 v5, v5, v17
    v_mfma_f32_16x16x32_bf16 a[84:87], v[164:167], v[248:251], a[84:87]
    ds_read_b128 v[44:47], v3 offset:0
    v_mfma_f32_16x16x32_bf16 a[84:87], v[180:183], v[252:255], a[84:87]
    s_waitcnt lgkmcnt(4)
    v_exp_f32 v19, v115
    v_mfma_f32_16x16x32_bf16 a[40:43], v[160:163], v[24:27], a[40:43]
    ds_read_b128 v[240:243], v2 offset:6144
    v_cvt_pk_bf16_f32 v82, v16, v17
    v_mfma_f32_16x16x32_bf16 a[40:43], v[176:179], v[28:31], a[40:43]
    v_exp_f32 v16, v84
    v_mfma_f32_16x16x32_bf16 a[88:91], v[164:167], v[24:27], a[88:91]
    ds_read_b128 v[244:247], v3 offset:6144
    v_add_f32 v5, v5, v18
    v_mfma_f32_16x16x32_bf16 a[88:91], v[180:183], v[28:31], a[88:91]
    s_waitcnt lgkmcnt(4)
    v_add_f32 v5, v5, v19
    v_mfma_f32_16x16x32_bf16 a[44:47], v[160:163], v[32:35], a[44:47]
    ds_read_b128 v[248:251], v2 offset:128
    v_mfma_f32_16x16x32_bf16 a[44:47], v[176:179], v[36:39], a[44:47]
    v_exp_f32 v17, v85
    v_mfma_f32_16x16x32_bf16 a[92:95], v[164:167], v[32:35], a[92:95]
    ds_read_b128 v[252:255], v3 offset:128
    v_cvt_pk_bf16_f32 v83, v18, v19
    v_mfma_f32_16x16x32_bf16 a[92:95], v[180:183], v[36:39], a[92:95]
    s_waitcnt lgkmcnt(4)
    v_exp_f32 v18, v86
    v_add_f32 v6, v6, v16
    v_add_f32 v6, v6, v17
    v_exp_f32 v19, v87
    v_cvt_pk_bf16_f32 v84, v16, v17
    v_exp_f32 v16, v116
    v_add_f32 v6, v6, v18
    v_add_f32 v6, v6, v19
    v_exp_f32 v17, v117
    v_cvt_pk_bf16_f32 v85, v18, v19
    v_exp_f32 v18, v118
    v_add_f32 v6, v6, v16
    v_add_f32 v6, v6, v17
    v_exp_f32 v19, v119
    v_cvt_pk_bf16_f32 v86, v16, v17
    v_add_f32 v6, v6, v18
    v_add_f32 v6, v6, v19
    v_cvt_pk_bf16_f32 v87, v18, v19
    v_mfma_f32_16x16x32_bf16 v[160:163], v[40:43], a[192:195], v[128:131]
    ds_read_b128 v[24:27], v2 offset:6272
    v_subrev_u32 v9, 98304, v1
    v_mfma_f32_16x16x32_bf16 v[160:163], v[44:47], a[196:199], v[160:163]
    v_subrev_u32 v10, 98304, v21
    v_subrev_u32 v11, 98304, v22
    v_mfma_f32_16x16x32_bf16 v[164:167], v[40:43], a[216:219], v[132:135]
    ds_read_b128 v[28:31], v3 offset:6272
    v_subrev_u32 v12, 49152, v1
    v_mfma_f32_16x16x32_bf16 v[164:167], v[44:47], a[220:223], v[164:167]
    s_waitcnt lgkmcnt(4)
    v_subrev_u32 v13, 49152, v21
    v_subrev_u32 v14, 49152, v22
    v_mfma_f32_16x16x32_bf16 v[96:99], v[240:243], a[192:195], v[128:131]
    ds_read_b128 v[32:35], v2 offset:256
    v_bfe_u32 v63, v4, 4, 6
    v_mfma_f32_16x16x32_bf16 v[96:99], v[244:247], a[196:199], v[96:99]
    v_and_b32 v62, 48, v63
    v_and_b32 v63, 15, v63
    v_mfma_f32_16x16x32_bf16 v[100:103], v[240:243], a[216:219], v[132:135]
    ds_read_b128 v[36:39], v3 offset:256
    v_mul_u32_u24 v61, 96, v62
    v_mfma_f32_16x16x32_bf16 v[100:103], v[244:247], a[220:223], v[100:103]
    s_waitcnt lgkmcnt(4)
    v_lshl_add_u32 v60, v63, 4, v61
    v_lshl_add_u32 v61, v63, 3, v61
    v_mfma_f32_16x16x32_bf16 v[160:163], v[248:251], a[200:203], v[160:163]
    ds_read_b128 v[40:43], v2 offset:6400
    s_lshl_b32 s24, s95, 2
    v_mfma_f32_16x16x32_bf16 v[160:163], v[252:255], a[204:207], v[160:163]
    s_add_u32 s24, s24, s25
    s_mul_i32 s24, s24, 24576
    v_mov_b32 v15, 1.0
    v_mfma_f32_16x16x32_bf16 v[164:167], v[248:251], a[224:227], v[164:167]
    ds_read_b128 v[44:47], v3 offset:6400
    s_add_u32 s33, s24, 0
    v_mfma_f32_16x16x32_bf16 v[164:167], v[252:255], a[228:231], v[164:167]
    s_waitcnt lgkmcnt(4)
    s_add_u32 s34, s24, 6144
    s_add_u32 s35, s24, 12288
    v_mfma_f32_16x16x32_bf16 v[96:99], v[24:27], a[200:203], v[96:99]
    ds_read_b128 v[240:243], v2 offset:12288
    s_add_u32 s36, s24, 18432
    v_mfma_f32_16x16x32_bf16 v[96:99], v[28:31], a[204:207], v[96:99]
    v_mfma_f32_16x16x32_bf16 v[100:103], v[24:27], a[224:227], v[100:103]
    ds_read_b128 v[244:247], v3 offset:12288
    v_mfma_f32_16x16x32_bf16 v[100:103], v[28:31], a[228:231], v[100:103]
    s_waitcnt lgkmcnt(4)
    v_mfma_f32_16x16x32_bf16 v[160:163], v[32:35], a[208:211], v[160:163]
    ds_read_b128 v[248:251], v2 offset:18432
    v_mfma_f32_16x16x32_bf16 v[160:163], v[36:39], a[212:215], v[160:163]
    v_mfma_f32_16x16x32_bf16 v[164:167], v[32:35], a[232:235], v[164:167]
    ds_read_b128 v[252:255], v3 offset:18432
    v_mfma_f32_16x16x32_bf16 v[164:167], v[36:39], a[236:239], v[164:167]
    s_waitcnt lgkmcnt(4)
    v_mfma_f32_16x16x32_bf16 v[96:99], v[40:43], a[208:211], v[96:99]
    ds_read_b128 v[24:27], v2 offset:12416
    v_mfma_f32_16x16x32_bf16 v[96:99], v[44:47], a[212:215], v[96:99]
    v_mfma_f32_16x16x32_bf16 v[100:103], v[40:43], a[232:235], v[100:103]
    ds_read_b128 v[28:31], v3 offset:12416
    v_mfma_f32_16x16x32_bf16 v[100:103], v[44:47], a[236:239], v[100:103]
    s_waitcnt lgkmcnt(4)
    v_mfma_f32_16x16x32_bf16 v[176:179], v[240:243], a[192:195], v[128:131]
    ds_read_b128 v[32:35], v2 offset:18560
    v_mfma_f32_16x16x32_bf16 v[176:179], v[244:247], a[196:199], v[176:179]
    v_mfma_f32_16x16x32_bf16 v[180:183], v[240:243], a[216:219], v[132:135]
    ds_read_b128 v[36:39], v3 offset:18560
    v_mfma_f32_16x16x32_bf16 v[180:183], v[244:247], a[220:223], v[180:183]
    s_waitcnt lgkmcnt(4)
    v_mfma_f32_16x16x32_bf16 v[112:115], v[248:251], a[192:195], v[128:131]
    ds_read_b128 v[40:43], v2 offset:12544
    v_mfma_f32_16x16x32_bf16 v[112:115], v[252:255], a[196:199], v[112:115]
    s_waitcnt vmcnt(63)
    s_barrier
    v_mfma_f32_16x16x32_bf16 v[116:119], v[248:251], a[216:219], v[132:135]
    ds_read_b128 v[44:47], v3 offset:12544
    v_mfma_f32_16x16x32_bf16 v[116:119], v[252:255], a[220:223], v[116:119]
    s_waitcnt lgkmcnt(4)
    v_exp_f32 v16, v160
    v_mfma_f32_16x16x32_bf16 v[176:179], v[24:27], a[200:203], v[176:179]
    ds_read_b128 v[240:243], v2 offset:18688
    v_mfma_f32_16x16x32_bf16 v[176:179], v[28:31], a[204:207], v[176:179]
    v_exp_f32 v17, v161
    v_mfma_f32_16x16x32_bf16 v[180:183], v[24:27], a[224:227], v[180:183]
    ds_read_b128 v[244:247], v3 offset:18688
    v_mfma_f32_16x16x32_bf16 v[180:183], v[28:31], a[228:231], v[180:183]
    s_waitcnt lgkmcnt(4)
    v_exp_f32 v18, v162
    v_mfma_f32_16x16x32_bf16 v[112:115], v[32:35], a[200:203], v[112:115]
    ds_read_b128 v[248:251], v9 offset:0
    v_add_f32 v5, v5, v16
    v_mfma_f32_16x16x32_bf16 v[112:115], v[36:39], a[204:207], v[112:115]
    v_add_f32 v5, v5, v17
    v_mfma_f32_16x16x32_bf16 v[116:119], v[32:35], a[224:227], v[116:119]
    ds_read_b128 v[252:255], v9 offset:12288
    v_mfma_f32_16x16x32_bf16 v[116:119], v[36:39], a[228:231], v[116:119]
    s_waitcnt lgkmcnt(4)
    v_exp_f32 v19, v163
    v_mfma_f32_16x16x32_bf16 v[176:179], v[40:43], a[208:211], v[176:179]
    ds_read_b128 v[24:27], v9 offset:768
    v_cvt_pk_bf16_f32 v160, v16, v17
    v_mfma_f32_16x16x32_bf16 v[176:179], v[44:47], a[212:215], v[176:179]
    v_exp_f32 v16, v96
    v_mfma_f32_16x16x32_bf16 v[180:183], v[40:43], a[232:235], v[180:183]
    ds_read_b128 v[28:31], v9 offset:13056
    v_add_f32 v5, v5, v18
    v_mfma_f32_16x16x32_bf16 v[180:183], v[44:47], a[236:239], v[180:183]
    s_waitcnt lgkmcnt(4)
    v_add_f32 v5, v5, v19
    v_mfma_f32_16x16x32_bf16 v[112:115], v[240:243], a[208:211], v[112:115]
    ds_read_b128 v[32:35], v9 offset:1536
    v_mfma_f32_16x16x32_bf16 v[112:115], v[244:247], a[212:215], v[112:115]
    v_exp_f32 v17, v97
    v_mfma_f32_16x16x32_bf16 v[116:119], v[240:243], a[232:235], v[116:119]
    ds_read_b128 v[36:39], v9 offset:13824
    v_cvt_pk_bf16_f32 v161, v18, v19
    v_mfma_f32_16x16x32_bf16 v[116:119], v[244:247], a[236:239], v[116:119]
    s_waitcnt lgkmcnt(4)
    v_exp_f32 v18, v98
    v_mfma_f32_16x16x32_bf16 a[0:3], v[64:67], v[248:251], a[0:3]
    ds_read_b128 v[40:43], v9 offset:2304
    v_add_f32 v5, v5, v16
    v_mfma_f32_16x16x32_bf16 a[0:3], v[80:83], v[252:255], a[0:3]
    v_add_f32 v5, v5, v17
    v_mfma_f32_16x16x32_bf16 a[48:51], v[68:71], v[248:251], a[48:51]
    ds_read_b128 v[44:47], v9 offset:14592
    v_mfma_f32_16x16x32_bf16 a[48:51], v[84:87], v[252:255], a[48:51]
    s_waitcnt lgkmcnt(4)
    v_exp_f32 v19, v99
    v_mfma_f32_16x16x32_bf16 a[4:7], v[64:67], v[24:27], a[4:7]
    ds_read_b128 v[240:243], v10 offset:0
    v_cvt_pk_bf16_f32 v162, v16, v17
    v_mfma_f32_16x16x32_bf16 a[4:7], v[80:83], v[28:31], a[4:7]
    v_exp_f32 v16, v164
    v_mfma_f32_16x16x32_bf16 a[52:55], v[68:71], v[24:27], a[52:55]
    ds_read_b128 v[244:247], v10 offset:12288
    v_add_f32 v5, v5, v18
    v_mfma_f32_16x16x32_bf16 a[52:55], v[84:87], v[28:31], a[52:55]
    s_waitcnt lgkmcnt(4)
    v_add_f32 v5, v5, v19
    v_mfma_f32_16x16x32_bf16 a[8:11], v[64:67], v[32:35], a[8:11]
    ds_read_b128 v[248:251], v10 offset:768
    v_mfma_f32_16x16x32_bf16 a[8:11], v[80:83], v[36:39], a[8:11]
    v_exp_f32 v17, v165
    v_mfma_f32_16x16x32_bf16 a[56:59], v[68:71], v[32:35], a[56:59]
    ds_read_b128 v[252:255], v10 offset:13056
    v_cvt_pk_bf16_f32 v163, v18, v19
    v_mfma_f32_16x16x32_bf16 a[56:59], v[84:87], v[36:39], a[56:59]
    s_waitcnt lgkmcnt(4)
    v_exp_f32 v18, v166
    v_mfma_f32_16x16x32_bf16 a[12:15], v[64:67], v[40:43], a[12:15]
    ds_read_b128 v[24:27], v10 offset:1536
    v_add_f32 v6, v6, v16
    v_mfma_f32_16x16x32_bf16 a[12:15], v[80:83], v[44:47], a[12:15]
    v_add_f32 v6, v6, v17
    v_mfma_f32_16x16x32_bf16 a[60:63], v[68:71], v[40:43], a[60:63]
    ds_read_b128 v[28:31], v10 offset:13824
    v_mfma_f32_16x16x32_bf16 a[60:63], v[84:87], v[44:47], a[60:63]
    s_waitcnt lgkmcnt(4)
    v_exp_f32 v19, v167
    v_mfma_f32_16x16x32_bf16 a[16:19], v[64:67], v[240:243], a[16:19]
    ds_read_b128 v[32:35], v10 offset:2304
    v_cvt_pk_bf16_f32 v164, v16, v17
    v_mfma_f32_16x16x32_bf16 a[16:19], v[80:83], v[244:247], a[16:19]
    v_exp_f32 v16, v100
    v_mfma_f32_16x16x32_bf16 a[64:67], v[68:71], v[240:243], a[64:67]
    ds_read_b128 v[36:39], v10 offset:14592
    v_add_f32 v6, v6, v18
    v_mfma_f32_16x16x32_bf16 a[64:67], v[84:87], v[244:247], a[64:67]
    s_waitcnt lgkmcnt(4)
    v_add_f32 v6, v6, v19
    v_mfma_f32_16x16x32_bf16 a[20:23], v[64:67], v[248:251], a[20:23]
    ds_read_b128 v[40:43], v11 offset:0
    v_mfma_f32_16x16x32_bf16 a[20:23], v[80:83], v[252:255], a[20:23]
    v_exp_f32 v17, v101
    v_mfma_f32_16x16x32_bf16 a[68:71], v[68:71], v[248:251], a[68:71]
    ds_read_b128 v[44:47], v11 offset:12288
    v_cvt_pk_bf16_f32 v165, v18, v19
    v_mfma_f32_16x16x32_bf16 a[68:71], v[84:87], v[252:255], a[68:71]
    s_waitcnt lgkmcnt(4)
    v_exp_f32 v18, v102
    v_mfma_f32_16x16x32_bf16 a[24:27], v[64:67], v[24:27], a[24:27]
    ds_read_b128 v[240:243], v11 offset:768
    v_add_f32 v6, v6, v16
    v_mfma_f32_16x16x32_bf16 a[24:27], v[80:83], v[28:31], a[24:27]
    v_add_f32 v6, v6, v17
    v_mfma_f32_16x16x32_bf16 a[72:75], v[68:71], v[24:27], a[72:75]
    ds_read_b128 v[244:247], v11 offset:13056
    v_mfma_f32_16x16x32_bf16 a[72:75], v[84:87], v[28:31], a[72:75]
    s_waitcnt lgkmcnt(4)
    v_exp_f32 v19, v103
    v_mfma_f32_16x16x32_bf16 a[28:31], v[64:67], v[32:35], a[28:31]
    ds_read_b128 v[248:251], v11 offset:1536
    v_cvt_pk_bf16_f32 v166, v16, v17
    v_mfma_f32_16x16x32_bf16 a[28:31], v[80:83], v[36:39], a[28:31]
    s_waitcnt vmcnt(0)
    s_barrier
    v_mfma_f32_16x16x32_bf16 a[76:79], v[68:71], v[32:35], a[76:79]
    ds_read_b128 v[252:255], v11 offset:13824
    v_add_f32 v6, v6, v18
    v_mfma_f32_16x16x32_bf16 a[76:79], v[84:87], v[36:39], a[76:79]
    s_waitcnt lgkmcnt(4)
    v_add_f32 v6, v6, v19
    v_cvt_pk_bf16_f32 v167, v18, v19
    v_mfma_f32_16x16x32_bf16 a[32:35], v[64:67], v[40:43], a[32:35]
    ds_read_b128 v[24:27], v11 offset:2304
    v_mfma_f32_16x16x32_bf16 a[32:35], v[80:83], v[44:47], a[32:35]
    v_exp_f32 v16, v176
    v_mfma_f32_16x16x32_bf16 a[80:83], v[68:71], v[40:43], a[80:83]
    ds_read_b128 v[28:31], v11 offset:14592
    v_mfma_f32_16x16x32_bf16 a[80:83], v[84:87], v[44:47], a[80:83]
    s_waitcnt lgkmcnt(4)
    v_exp_f32 v17, v177
    v_mfma_f32_16x16x32_bf16 a[36:39], v[64:67], v[240:243], a[36:39]
    ds_read_b128 v[32:35], v12 offset:0
    v_mfma_f32_16x16x32_bf16 a[36:39], v[80:83], v[244:247], a[36:39]
    v_exp_f32 v18, v178
    v_mfma_f32_16x16x32_bf16 a[84:87], v[68:71], v[240:243], a[84:87]
    ds_read_b128 v[36:39], v12 offset:12288
    v_add_f32 v5, v5, v16
    v_mfma_f32_16x16x32_bf16 a[84:87], v[84:87], v[244:247], a[84:87]
    s_waitcnt lgkmcnt(4)
    v_add_f32 v5, v5, v17
    v_mfma_f32_16x16x32_bf16 a[40:43], v[64:67], v[248:251], a[40:43]
    ds_read_b128 v[40:43], v12 offset:768
    v_mfma_f32_16x16x32_bf16 a[40:43], v[80:83], v[252:255], a[40:43]
    v_exp_f32 v19, v179
    v_mfma_f32_16x16x32_bf16 a[88:91], v[68:71], v[248:251], a[88:91]
    ds_read_b128 v[44:47], v12 offset:13056
    v_cvt_pk_bf16_f32 v176, v16, v17
    v_mfma_f32_16x16x32_bf16 a[88:91], v[84:87], v[252:255], a[88:91]
    s_waitcnt lgkmcnt(4)
    v_exp_f32 v16, v112
    v_mfma_f32_16x16x32_bf16 a[44:47], v[64:67], v[24:27], a[44:47]
    ds_read_b128 v[240:243], v12 offset:1536
    v_add_f32 v5, v5, v18
    v_mfma_f32_16x16x32_bf16 a[44:47], v[80:83], v[28:31], a[44:47]
    v_add_f32 v5, v5, v19
    v_mfma_f32_16x16x32_bf16 a[92:95], v[68:71], v[24:27], a[92:95]
    ds_read_b128 v[244:247], v12 offset:13824
    v_mfma_f32_16x16x32_bf16 a[92:95], v[84:87], v[28:31], a[92:95]
    s_waitcnt lgkmcnt(4)
    v_exp_f32 v17, v113
    v_cvt_pk_bf16_f32 v177, v18, v19
    v_exp_f32 v18, v114
    v_add_f32 v5, v5, v16
    v_add_f32 v5, v5, v17
    v_exp_f32 v19, v115
    v_cvt_pk_bf16_f32 v178, v16, v17
    v_exp_f32 v16, v180
    v_add_f32 v5, v5, v18
    v_add_f32 v5, v5, v19
    v_exp_f32 v17, v181
    v_cvt_pk_bf16_f32 v179, v18, v19
    v_exp_f32 v18, v182
    v_add_f32 v6, v6, v16
    v_add_f32 v6, v6, v17
    v_exp_f32 v19, v183
    v_cvt_pk_bf16_f32 v180, v16, v17
    v_exp_f32 v16, v116
    v_add_f32 v6, v6, v18
    v_add_f32 v6, v6, v19
    v_exp_f32 v17, v117
    v_cvt_pk_bf16_f32 v181, v18, v19
    v_exp_f32 v18, v118
    v_add_f32 v6, v6, v16
    v_add_f32 v6, v6, v17
    v_exp_f32 v19, v119
    v_cvt_pk_bf16_f32 v182, v16, v17
    v_add_f32 v6, v6, v18
    v_add_f32 v6, v6, v19
    v_cvt_pk_bf16_f32 v183, v18, v19
    v_max_f32 v20, v5, v6
    s_mov_b32 s29, 0x5f800000
    v_cmp_lt_f32 vcc, s29, v20
    v_mfma_f32_16x16x4_f32 v[48:51], v5, v15, 0
    v_mfma_f32_16x16x4_f32 v[52:55], v6, v15, 0
    s_cbranch_vccnz L_slow
    v_mfma_f32_16x16x32_bf16 a[0:3], v[160:163], v[32:35], a[0:3]
    ds_read_b128 v[248:251], v12 offset:2304
    v_mfma_f32_16x16x32_bf16 a[0:3], v[176:179], v[36:39], a[0:3]
    v_exp_f32 v16, v72
    v_mfma_f32_16x16x32_bf16 a[48:51], v[164:167], v[32:35], a[48:51]
    ds_read_b128 v[252:255], v12 offset:14592
    v_mfma_f32_16x16x32_bf16 a[48:51], v[180:183], v[36:39], a[48:51]
    s_waitcnt lgkmcnt(4)
    v_exp_f32 v17, v73
    v_mfma_f32_16x16x32_bf16 a[4:7], v[160:163], v[40:43], a[4:7]
    ds_read_b128 v[24:27], v13 offset:0
    v_mfma_f32_16x16x32_bf16 a[4:7], v[176:179], v[44:47], a[4:7]
    v_exp_f32 v18, v74
    v_mfma_f32_16x16x32_bf16 a[52:55], v[164:167], v[40:43], a[52:55]
    ds_read_b128 v[28:31], v13 offset:12288
    v_add_f32 v7, v7, v16
    v_mfma_f32_16x16x32_bf16 a[52:55], v[180:183], v[44:47], a[52:55]
    s_waitcnt lgkmcnt(4)
    v_add_f32 v7, v7, v17
    v_mfma_f32_16x16x32_bf16 a[8:11], v[160:163], v[240:243], a[8:11]
    ds_read_b128 v[32:35], v13 offset:768
    v_mfma_f32_16x16x32_bf16 a[8:11], v[176:179], v[244:247], a[8:11]
    v_exp_f32 v19, v75
    v_mfma_f32_16x16x32_bf16 a[56:59], v[164:167], v[240:243], a[56:59]
    ds_read_b128 v[36:39], v13 offset:13056
    v_cvt_pk_bf16_f32 v72, v16, v17
    v_mfma_f32_16x16x32_bf16 a[56:59], v[180:183], v[244:247], a[56:59]
    s_waitcnt lgkmcnt(4)
    v_exp_f32 v16, v104
    v_mfma_f32_16x16x32_bf16 a[12:15], v[160:163], v[248:251], a[12:15]
    ds_read_b128 v[40:43], v13 offset:1536
    v_add_f32 v7, v7, v18
    v_mfma_f32_16x16x32_bf16 a[12:15], v[176:179], v[252:255], a[12:15]
    v_add_f32 v7, v7, v19
    v_mfma_f32_16x16x32_bf16 a[60:63], v[164:167], v[248:251], a[60:63]
    ds_read_b128 v[44:47], v13 offset:13824
    v_mfma_f32_16x16x32_bf16 a[60:63], v[180:183], v[252:255], a[60:63]
    s_waitcnt lgkmcnt(4)
    v_exp_f32 v17, v105
    v_mfma_f32_16x16x32_bf16 a[16:19], v[160:163], v[24:27], a[16:19]
    ds_read_b128 v[240:243], v13 offset:2304
    v_cvt_pk_bf16_f32 v73, v18, v19
    v_mfma_f32_16x16x32_bf16 a[16:19], v[176:179], v[28:31], a[16:19]
    v_exp_f32 v18, v106
    v_mfma_f32_16x16x32_bf16 a[64:67], v[164:167], v[24:27], a[64:67]
    ds_read_b128 v[244:247], v13 offset:14592
    v_add_f32 v7, v7, v16
    v_mfma_f32_16x16x32_bf16 a[64:67], v[180:183], v[28:31], a[64:67]
    s_waitcnt lgkmcnt(4)
    v_add_f32 v7, v7, v17
    v_mfma_f32_16x16x32_bf16 a[20:23], v[160:163], v[32:35], a[20:23]
    ds_read_b128 v[248:251], v14 offset:0
    v_mfma_f32_16x16x32_bf16 a[20:23], v[176:179], v[36:39], a[20:23]
    v_exp_f32 v19, v107
    v_mfma_f32_16x16x32_bf16 a[68:71], v[164:167], v[32:35], a[68:71]
    ds_read_b128 v[252:255], v14 offset:12288
    v_cvt_pk_bf16_f32 v74, v16, v17
    v_mfma_f32_16x16x32_bf16 a[68:71], v[180:183], v[36:39], a[68:71]
    s_waitcnt lgkmcnt(4)
    v_exp_f32 v16, v76
    v_mfma_f32_16x16x32_bf16 a[24:27], v[160:163], v[40:43], a[24:27]
    ds_read_b128 v[24:27], v14 offset:768
    v_add_f32 v7, v7, v18
    v_mfma_f32_16x16x32_bf16 a[24:27], v[176:179], v[44:47], a[24:27]
    v_add_f32 v7, v7, v19
    v_mfma_f32_16x16x32_bf16 a[72:75], v[164:167], v[40:43], a[72:75]
    ds_read_b128 v[28:31], v14 offset:13056
    v_mfma_f32_16x16x32_bf16 a[72:75], v[180:183], v[44:47], a[72:75]
    s_waitcnt lgkmcnt(4)
    v_exp_f32 v17, v77
    v_mfma_f32_16x16x32_bf16 a[28:31], v[160:163], v[240:243], a[28:31]
    ds_read_b128 v[32:35], v14 offset:1536
    v_cvt_pk_bf16_f32 v75, v18, v19
    v_mfma_f32_16x16x32_bf16 a[28:31], v[176:179], v[244:247], a[28:31]
    v_exp_f32 v18, v78
    v_mfma_f32_16x16x32_bf16 a[76:79], v[164:167], v[240:243], a[76:79]
    ds_read_b128 v[36:39], v14 offset:13824
    v_add_f32 v8, v8, v16
    v_mfma_f32_16x16x32_bf16 a[76:79], v[180:183], v[244:247], a[76:79]
    s_waitcnt lgkmcnt(4)
    v_add_f32 v8, v8, v17
    v_mfma_f32_16x16x32_bf16 a[32:35], v[160:163], v[248:251], a[32:35]
    ds_read_b128 v[40:43], v14 offset:2304
    v_mfma_f32_16x16x32_bf16 a[32:35], v[176:179], v[252:255], a[32:35]
    v_exp_f32 v19, v79
    v_mfma_f32_16x16x32_bf16 a[80:83], v[164:167], v[248:251], a[80:83]
    ds_read_b128 v[44:47], v14 offset:14592
    v_cvt_pk_bf16_f32 v76, v16, v17
    v_mfma_f32_16x16x32_bf16 a[80:83], v[180:183], v[252:255], a[80:83]
    s_waitcnt lgkmcnt(4)
    v_exp_f32 v16, v108
    v_mfma_f32_16x16x32_bf16 a[36:39], v[160:163], v[24:27], a[36:39]
    ds_read_b128 v[240:243], v1 offset:0
    v_add_f32 v8, v8, v18
    v_mfma_f32_16x16x32_bf16 a[36:39], v[176:179], v[28:31], a[36:39]
    v_add_f32 v8, v8, v19
    v_mfma_f32_16x16x32_bf16 a[84:87], v[164:167], v[24:27], a[84:87]
    ds_read_b128 v[244:247], v1 offset:12288
    v_mfma_f32_16x16x32_bf16 a[84:87], v[180:183], v[28:31], a[84:87]
    s_waitcnt lgkmcnt(4)
    v_exp_f32 v17, v109
    v_mfma_f32_16x16x32_bf16 a[40:43], v[160:163], v[32:35], a[40:43]
    ds_read_b128 v[248:251], v1 offset:768
    v_cvt_pk_bf16_f32 v77, v18, v19
    v_mfma_f32_16x16x32_bf16 a[40:43], v[176:179], v[36:39], a[40:43]
    v_exp_f32 v18, v110
    v_mfma_f32_16x16x32_bf16 a[88:91], v[164:167], v[32:35], a[88:91]
    ds_read_b128 v[252:255], v1 offset:13056
    v_add_f32 v8, v8, v16
    v_mfma_f32_16x16x32_bf16 a[88:91], v[180:183], v[36:39], a[88:91]
    s_waitcnt lgkmcnt(4)
    v_add_f32 v8, v8, v17
    v_mfma_f32_16x16x32_bf16 a[44:47], v[160:163], v[40:43], a[44:47]
    ds_read_b128 v[24:27], v1 offset:1536
    v_mfma_f32_16x16x32_bf16 a[44:47], v[176:179], v[44:47], a[44:47]
    v_exp_f32 v19, v111
    v_mfma_f32_16x16x32_bf16 a[92:95], v[164:167], v[40:43], a[92:95]
    ds_read_b128 v[28:31], v1 offset:13824
    v_cvt_pk_bf16_f32 v78, v16, v17
    v_mfma_f32_16x16x32_bf16 a[92:95], v[180:183], v[44:47], a[92:95]
    s_waitcnt lgkmcnt(4)
    v_add_f32 v8, v8, v18
    v_add_f32 v8, v8, v19
    v_cvt_pk_bf16_f32 v79, v18, v19
    v_rcp_f32 v48, v48
    v_rcp_f32 v49, v49
    v_rcp_f32 v50, v50
    v_rcp_f32 v51, v51
    v_rcp_f32 v52, v52
    v_rcp_f32 v53, v53
    v_rcp_f32 v54, v54
    v_rcp_f32 v55, v55
    v_mfma_f32_16x16x32_bf16 a[96:99], v[168:171], v[240:243], a[96:99]
    ds_read_b128 v[32:35], v1 offset:2304
    v_accvgpr_read_b32 v224, a0
    v_mfma_f32_16x16x32_bf16 a[96:99], v[184:187], v[244:247], a[96:99]
    s_nop 3
    v_accvgpr_read_b32 v225, a4
    v_accvgpr_read_b32 v226, a8
    v_accvgpr_read_b32 v227, a12
    v_mfma_f32_16x16x32_bf16 a[144:147], v[172:175], v[240:243], a[144:147]
    ds_read_b128 v[36:39], v1 offset:14592
    v_accvgpr_read_b32 v228, a16
    v_mfma_f32_16x16x32_bf16 a[144:147], v[188:191], v[244:247], a[144:147]
    s_waitcnt lgkmcnt(4)
    v_accvgpr_read_b32 v229, a20
    v_accvgpr_read_b32 v230, a24
    v_accvgpr_read_b32 v231, a28
    v_accvgpr_read_b32 v232, a32
    v_accvgpr_read_b32 v233, a36
    v_accvgpr_read_b32 v234, a40
    v_mfma_f32_16x16x32_bf16 a[100:103], v[168:171], v[248:251], a[100:103]
    ds_read_b128 v[40:43], v21 offset:0
    v_accvgpr_read_b32 v235, a44
    v_mfma_f32_16x16x32_bf16 a[100:103], v[184:187], v[252:255], a[100:103]
    v_mul_f32 v224, v224, v48
    v_mul_f32 v225, v225, v48
    v_mul_f32 v226, v226, v48
    v_mul_f32 v227, v227, v48
    v_mul_f32 v228, v228, v48
    v_mul_f32 v229, v229, v48
    v_mfma_f32_16x16x32_bf16 a[148:151], v[172:175], v[248:251], a[148:151]
    ds_read_b128 v[44:47], v21 offset:12288
    v_mul_f32 v230, v230, v48
    v_mfma_f32_16x16x32_bf16 a[148:151], v[188:191], v[252:255], a[148:151]
    s_waitcnt lgkmcnt(4)
    v_mul_f32 v231, v231, v48
    v_mul_f32 v232, v232, v48
    v_mul_f32 v233, v233, v48
    v_mul_f32 v234, v234, v48
    v_mul_f32 v235, v235, v48
    v_cvt_pk_bf16_f32 v224, v224, v225
    v_mfma_f32_16x16x32_bf16 a[104:107], v[168:171], v[24:27], a[104:107]
    ds_read_b128 v[240:243], v21 offset:768
    v_cvt_pk_bf16_f32 v225, v226, v227
    v_mfma_f32_16x16x32_bf16 a[104:107], v[184:187], v[28:31], a[104:107]
    v_cvt_pk_bf16_f32 v226, v228, v229
    v_cvt_pk_bf16_f32 v227, v230, v231
    v_cvt_pk_bf16_f32 v228, v232, v233
    v_cvt_pk_bf16_f32 v229, v234, v235
    v_mfma_f32_16x16x32_bf16 a[152:155], v[172:175], v[24:27], a[152:155]
    ds_read_b128 v[244:247], v21 offset:13056
    v_mfma_f32_16x16x32_bf16 a[152:155], v[188:191], v[28:31], a[152:155]
    s_waitcnt lgkmcnt(4)
    buffer_store_dwordx4 v[224:227], v60, s[12:15], s33 offen offset:0 sc0 sc1
    buffer_store_dwordx2 v[228:229], v61, s[12:15], s33 offen offset:256 sc0 sc1
    v_mfma_f32_16x16x32_bf16 a[108:111], v[168:171], v[32:35], a[108:111]
    ds_read_b128 v[248:251], v21 offset:1536
    v_accvgpr_read_b32 v144, a1
    v_mfma_f32_16x16x32_bf16 a[108:111], v[184:187], v[36:39], a[108:111]
    v_accvgpr_read_b32 v145, a5
    v_accvgpr_read_b32 v146, a9
    v_accvgpr_read_b32 v147, a13
    v_accvgpr_read_b32 v148, a17
    v_accvgpr_read_b32 v149, a21
    v_accvgpr_read_b32 v150, a25
    v_mfma_f32_16x16x32_bf16 a[156:159], v[172:175], v[32:35], a[156:159]
    ds_read_b128 v[252:255], v21 offset:13824
    v_accvgpr_read_b32 v151, a29
    v_mfma_f32_16x16x32_bf16 a[156:159], v[188:191], v[36:39], a[156:159]
    s_waitcnt lgkmcnt(4)
    v_accvgpr_read_b32 v152, a33
    v_accvgpr_read_b32 v153, a37
    v_accvgpr_read_b32 v154, a41
    v_accvgpr_read_b32 v155, a45
    v_mul_f32 v144, v144, v49
    v_mul_f32 v145, v145, v49
    v_mfma_f32_16x16x32_bf16 a[112:115], v[168:171], v[40:43], a[112:115]
    ds_read_b128 v[24:27], v21 offset:2304
    v_mul_f32 v146, v146, v49
    v_mfma_f32_16x16x32_bf16 a[112:115], v[184:187], v[44:47], a[112:115]
    v_mul_f32 v147, v147, v49
    v_mul_f32 v148, v148, v49
    v_mul_f32 v149, v149, v49
    v_mul_f32 v150, v150, v49
    v_mul_f32 v151, v151, v49
    v_mul_f32 v152, v152, v49
    v_mfma_f32_16x16x32_bf16 a[160:163], v[172:175], v[40:43], a[160:163]
    ds_read_b128 v[28:31], v21 offset:14592
    v_mul_f32 v153, v153, v49
    v_mfma_f32_16x16x32_bf16 a[160:163], v[188:191], v[44:47], a[160:163]
    s_waitcnt lgkmcnt(4)
    v_mul_f32 v154, v154, v49
    v_mul_f32 v155, v155, v49
    v_cvt_pk_bf16_f32 v144, v144, v145
    v_cvt_pk_bf16_f32 v145, v146, v147
    v_cvt_pk_bf16_f32 v146, v148, v149
    v_cvt_pk_bf16_f32 v147, v150, v151
    v_mfma_f32_16x16x32_bf16 a[116:119], v[168:171], v[240:243], a[116:119]
    ds_read_b128 v[32:35], v22 offset:0
    v_cvt_pk_bf16_f32 v148, v152, v153
    v_mfma_f32_16x16x32_bf16 a[116:119], v[184:187], v[244:247], a[116:119]
    v_cvt_pk_bf16_f32 v149, v154, v155
    buffer_store_dwordx4 v[144:147], v60, s[12:15], s33 offen offset:384 sc0 sc1
    v_mfma_f32_16x16x32_bf16 a[164:167], v[172:175], v[240:243], a[164:167]
    ds_read_b128 v[36:39], v22 offset:12288
    v_mfma_f32_16x16x32_bf16 a[164:167], v[188:191], v[244:247], a[164:167]
    s_waitcnt lgkmcnt(4)
    buffer_store_dwordx2 v[148:149], v61, s[12:15], s33 offen offset:640 sc0 sc1
    v_accvgpr_read_b32 v224, a2
    v_accvgpr_read_b32 v225, a6
    v_accvgpr_read_b32 v226, a10
    v_mfma_f32_16x16x32_bf16 a[120:123], v[168:171], v[248:251], a[120:123]
    ds_read_b128 v[40:43], v22 offset:768
    v_accvgpr_read_b32 v227, a14
    v_mfma_f32_16x16x32_bf16 a[120:123], v[184:187], v[252:255], a[120:123]
    v_accvgpr_read_b32 v228, a18
    v_accvgpr_read_b32 v229, a22
    v_accvgpr_read_b32 v230, a26
    v_accvgpr_read_b32 v231, a30
    v_accvgpr_read_b32 v232, a34
    v_accvgpr_read_b32 v233, a38
    v_mfma_f32_16x16x32_bf16 a[168:171], v[172:175], v[248:251], a[168:171]
    ds_read_b128 v[44:47], v22 offset:13056
    v_accvgpr_read_b32 v234, a42
    v_mfma_f32_16x16x32_bf16 a[168:171], v[188:191], v[252:255], a[168:171]
    s_waitcnt lgkmcnt(4)
    v_accvgpr_read_b32 v235, a46
    v_mul_f32 v224, v224, v50
    v_mul_f32 v225, v225, v50
    v_mul_f32 v226, v226, v50
    v_mul_f32 v227, v227, v50
    v_mul_f32 v228, v228, v50
    v_mfma_f32_16x16x32_bf16 a[124:127], v[168:171], v[24:27], a[124:127]
    ds_read_b128 v[240:243], v22 offset:1536
    v_mul_f32 v229, v229, v50
    v_mfma_f32_16x16x32_bf16 a[124:127], v[184:187], v[28:31], a[124:127]
    v_exp_f32 v16, v88
    v_exp_f32 v17, v89
    v_exp_f32 v18, v90
    v_mfma_f32_16x16x32_bf16 a[172:175], v[172:175], v[24:27], a[172:175]
    ds_read_b128 v[244:247], v22 offset:13824
    v_add_f32 v7, v7, v16
    v_mfma_f32_16x16x32_bf16 a[172:175], v[188:191], v[28:31], a[172:175]
    s_waitcnt lgkmcnt(4)
    v_add_f32 v7, v7, v17
    v_exp_f32 v19, v91
    v_cvt_pk_bf16_f32 v88, v16, v17
    v_exp_f32 v16, v120
    v_mfma_f32_16x16x32_bf16 a[128:131], v[168:171], v[32:35], a[128:131]
    ds_read_b128 v[248:251], v22 offset:2304
    v_add_f32 v7, v7, v18
    v_mfma_f32_16x16x32_bf16 a[128:131], v[184:187], v[36:39], a[128:131]
    v_add_f32 v7, v7, v19
    v_exp_f32 v17, v121
    v_cvt_pk_bf16_f32 v89, v18, v19
    v_exp_f32 v18, v122
    v_mfma_f32_16x16x32_bf16 a[176:179], v[172:175], v[32:35], a[176:179]
    ds_read_b128 v[252:255], v22 offset:14592
    v_add_f32 v7, v7, v16
    v_mfma_f32_16x16x32_bf16 a[176:179], v[188:191], v[36:39], a[176:179]
    s_waitcnt lgkmcnt(4)
    v_add_f32 v7, v7, v17
    v_exp_f32 v19, v123
    v_cvt_pk_bf16_f32 v90, v16, v17
    v_add_f32 v7, v7, v18
    v_add_f32 v7, v7, v19
    v_mfma_f32_16x16x32_bf16 a[132:135], v[168:171], v[40:43], a[132:135]
    ds_read_b128 v[24:27], v2 offset:0
    v_cvt_pk_bf16_f32 v91, v18, v19
    v_mfma_f32_16x16x32_bf16 a[132:135], v[184:187], v[44:47], a[132:135]
    v_mul_f32 v230, v230, v50
    v_mul_f32 v231, v231, v50
    v_mul_f32 v232, v232, v50
    v_mul_f32 v233, v233, v50
    v_mul_f32 v234, v234, v50
    v_mul_f32 v235, v235, v50
    v_mfma_f32_16x16x32_bf16 a[180:183], v[172:175], v[40:43], a[180:183]
    ds_read_b128 v[28:31], v3 offset:0
    v_cvt_pk_bf16_f32 v224, v224, v225
    v_mfma_f32_16x16x32_bf16 a[180:183], v[188:191], v[44:47], a[180:183]
    s_waitcnt lgkmcnt(4)
    v_cvt_pk_bf16_f32 v225, v226, v227
    v_cvt_pk_bf16_f32 v226, v228, v229
    v_cvt_pk_bf16_f32 v227, v230, v231
    v_cvt_pk_bf16_f32 v228, v232, v233
    v_cvt_pk_bf16_f32 v229, v234, v235
    v_mfma_f32_16x16x32_bf16 a[136:139], v[168:171], v[240:243], a[136:139]
    ds_read_b128 v[32:35], v2 offset:6144
    v_mfma_f32_16x16x32_bf16 a[136:139], v[184:187], v[244:247], a[136:139]
    buffer_store_dwordx4 v[224:227], v60, s[12:15], s33 offen offset:768 sc0 sc1
    buffer_store_dwordx2 v[228:229], v61, s[12:15], s33 offen offset:1024 sc0 sc1
    v_mfma_f32_16x16x32_bf16 a[184:187], v[172:175], v[240:243], a[184:187]
    ds_read_b128 v[36:39], v3 offset:6144
    v_accvgpr_read_b32 v144, a3
    v_mfma_f32_16x16x32_bf16 a[184:187], v[188:191], v[244:247], a[184:187]
    s_waitcnt lgkmcnt(4)
    v_accvgpr_read_b32 v145, a7
    v_accvgpr_read_b32 v146, a11
    v_accvgpr_read_b32 v147, a15
    v_accvgpr_read_b32 v148, a19
    v_accvgpr_read_b32 v149, a23
    v_accvgpr_read_b32 v150, a27
    v_mfma_f32_16x16x32_bf16 a[140:143], v[168:171], v[248:251], a[140:143]
    ds_read_b128 v[40:43], v2 offset:128
    v_accvgpr_read_b32 v151, a31
    v_mfma_f32_16x16x32_bf16 a[140:143], v[184:187], v[252:255], a[140:143]
    v_accvgpr_read_b32 v152, a35
    v_accvgpr_read_b32 v153, a39
    v_accvgpr_read_b32 v154, a43
    v_accvgpr_read_b32 v155, a47
    v_mul_f32 v144, v144, v51
    v_mul_f32 v145, v145, v51
    v_mfma_f32_16x16x32_bf16 a[188:191], v[172:175], v[248:251], a[188:191]
    ds_read_b128 v[44:47], v3 offset:128
    v_mul_f32 v146, v146, v51
    v_mfma_f32_16x16x32_bf16 a[188:191], v[188:191], v[252:255], a[188:191]
    s_waitcnt lgkmcnt(4)
    v_mul_f32 v147, v147, v51
    v_mul_f32 v148, v148, v51
    v_mul_f32 v149, v149, v51
    v_mul_f32 v150, v150, v51
    v_mul_f32 v151, v151, v51
    v_mul_f32 v152, v152, v51
    v_mfma_f32_16x16x32_bf16 v[168:171], v[24:27], a[240:243], v[136:139]
    ds_read_b128 v[240:243], v2 offset:6272
    v_mul_f32 v153, v153, v51
    v_mfma_f32_16x16x32_bf16 v[168:171], v[28:31], a[244:247], v[168:171]
    v_exp_f32 v16, v92
    v_exp_f32 v17, v93
    v_exp_f32 v18, v94
    v_mfma_f32_16x16x32_bf16 v[172:175], v[24:27], v[200:203], v[140:143]
    ds_read_b128 v[244:247], v3 offset:6272
    v_add_f32 v8, v8, v16
    v_mfma_f32_16x16x32_bf16 v[172:175], v[28:31], v[204:207], v[172:175]
    s_waitcnt lgkmcnt(4)
    v_add_f32 v8, v8, v17
    v_exp_f32 v19, v95
    v_cvt_pk_bf16_f32 v92, v16, v17
    v_exp_f32 v16, v124
    v_mfma_f32_16x16x32_bf16 v[104:107], v[32:35], a[240:243], v[136:139]
    ds_read_b128 v[248:251], v2 offset:256
    v_add_f32 v8, v8, v18
    v_mfma_f32_16x16x32_bf16 v[104:107], v[36:39], a[244:247], v[104:107]
    v_add_f32 v8, v8, v19
    v_exp_f32 v17, v125
    v_cvt_pk_bf16_f32 v93, v18, v19
    v_exp_f32 v18, v126
    v_mfma_f32_16x16x32_bf16 v[108:111], v[32:35], v[200:203], v[140:143]
    ds_read_b128 v[252:255], v3 offset:256
    v_add_f32 v8, v8, v16
    v_mfma_f32_16x16x32_bf16 v[108:111], v[36:39], v[204:207], v[108:111]
    s_waitcnt lgkmcnt(4)
    v_add_f32 v8, v8, v17
    v_exp_f32 v19, v127
    v_cvt_pk_bf16_f32 v94, v16, v17
    v_add_f32 v8, v8, v18
    v_add_f32 v8, v8, v19
    v_mfma_f32_16x16x32_bf16 v[168:171], v[40:43], a[248:251], v[168:171]
    ds_read_b128 v[24:27], v2 offset:6400
    v_cvt_pk_bf16_f32 v95, v18, v19
    v_mfma_f32_16x16x32_bf16 v[168:171], v[44:47], a[252:255], v[168:171]
    v_mul_f32 v154, v154, v51
    v_mul_f32 v155, v155, v51
    v_cvt_pk_bf16_f32 v144, v144, v145
    v_cvt_pk_bf16_f32 v145, v146, v147
    v_cvt_pk_bf16_f32 v146, v148, v149
    v_cvt_pk_bf16_f32 v147, v150, v151
    v_mfma_f32_16x16x32_bf16 v[172:175], v[40:43], v[208:211], v[172:175]
    ds_read_b128 v[28:31], v3 offset:6400
    v_cvt_pk_bf16_f32 v148, v152, v153
    v_mfma_f32_16x16x32_bf16 v[172:175], v[44:47], v[212:215], v[172:175]
    s_waitcnt lgkmcnt(4)
    v_cvt_pk_bf16_f32 v149, v154, v155
    buffer_store_dwordx4 v[144:147], v60, s[12:15], s33 offen offset:1152 sc0 sc1
    v_mfma_f32_16x16x32_bf16 v[104:107], v[240:243], a[248:251], v[104:107]
    ds_read_b128 v[32:35], v2 offset:12288
    v_mfma_f32_16x16x32_bf16 v[104:107], v[244:247], a[252:255], v[104:107]
    buffer_store_dwordx2 v[148:149], v61, s[12:15], s33 offen offset:1408 sc0 sc1
    v_accvgpr_read_b32 v224, a48
    v_accvgpr_read_b32 v225, a52
    v_accvgpr_read_b32 v226, a56
    v_mfma_f32_16x16x32_bf16 v[108:111], v[240:243], v[208:211], v[108:111]
    ds_read_b128 v[36:39], v3 offset:12288
    v_accvgpr_read_b32 v227, a60
    v_mfma_f32_16x16x32_bf16 v[108:111], v[244:247], v[212:215], v[108:111]
    s_waitcnt lgkmcnt(4)
    v_accvgpr_read_b32 v228, a64
    v_accvgpr_read_b32 v229, a68
    v_accvgpr_read_b32 v230, a72
    v_accvgpr_read_b32 v231, a76
    v_accvgpr_read_b32 v232, a80
    v_accvgpr_read_b32 v233, a84
    v_mfma_f32_16x16x32_bf16 v[168:171], v[248:251], v[192:195], v[168:171]
    ds_read_b128 v[40:43], v2 offset:18432
    v_accvgpr_read_b32 v234, a88
    v_mfma_f32_16x16x32_bf16 v[168:171], v[252:255], v[196:199], v[168:171]
    v_accvgpr_read_b32 v235, a92
    v_mul_f32 v224, v224, v52
    v_mul_f32 v225, v225, v52
    v_mul_f32 v226, v226, v52
    v_mul_f32 v227, v227, v52
    v_mul_f32 v228, v228, v52
    v_mfma_f32_16x16x32_bf16 v[172:175], v[248:251], v[216:219], v[172:175]
    ds_read_b128 v[44:47], v3 offset:18432
    v_mul_f32 v229, v229, v52
    v_mfma_f32_16x16x32_bf16 v[172:175], v[252:255], v[220:223], v[172:175]
    s_waitcnt lgkmcnt(4)
    v_mul_f32 v230, v230, v52
    v_mul_f32 v231, v231, v52
    v_mul_f32 v232, v232, v52
    v_mul_f32 v233, v233, v52
    v_mul_f32 v234, v234, v52
    v_mul_f32 v235, v235, v52
    v_mfma_f32_16x16x32_bf16 v[104:107], v[24:27], v[192:195], v[104:107]
    ds_read_b128 v[240:243], v2 offset:12416
    v_cvt_pk_bf16_f32 v224, v224, v225
    v_mfma_f32_16x16x32_bf16 v[104:107], v[28:31], v[196:199], v[104:107]
    v_cvt_pk_bf16_f32 v225, v226, v227
    v_cvt_pk_bf16_f32 v226, v228, v229
    v_cvt_pk_bf16_f32 v227, v230, v231
    v_cvt_pk_bf16_f32 v228, v232, v233
    v_cvt_pk_bf16_f32 v229, v234, v235
    v_mfma_f32_16x16x32_bf16 v[108:111], v[24:27], v[216:219], v[108:111]
    ds_read_b128 v[244:247], v3 offset:12416
    v_mfma_f32_16x16x32_bf16 v[108:111], v[28:31], v[220:223], v[108:111]
    s_waitcnt lgkmcnt(4)
    buffer_store_dwordx4 v[224:227], v60, s[12:15], s34 offen offset:0 sc0 sc1
    buffer_store_dwordx2 v[228:229], v61, s[12:15], s34 offen offset:256 sc0 sc1
    v_mfma_f32_16x16x32_bf16 v[184:187], v[32:35], a[240:243], v[136:139]
    ds_read_b128 v[248:251], v2 offset:18560
    v_accvgpr_read_b32 v144, a49
    v_mfma_f32_16x16x32_bf16 v[184:187], v[36:39], a[244:247], v[184:187]
    v_accvgpr_read_b32 v145, a53
    v_accvgpr_read_b32 v146, a57
    v_accvgpr_read_b32 v147, a61
    v_accvgpr_read_b32 v148, a65
    v_accvgpr_read_b32 v149, a69
    v_accvgpr_read_b32 v150, a73
    v_mfma_f32_16x16x32_bf16 v[188:191], v[32:35], v[200:203], v[140:143]
    ds_read_b128 v[252:255], v3 offset:18560
    v_accvgpr_read_b32 v151, a77
    v_mfma_f32_16x16x32_bf16 v[188:191], v[36:39], v[204:207], v[188:191]
    s_waitcnt lgkmcnt(4)
    v_accvgpr_read_b32 v152, a81
    v_accvgpr_read_b32 v153, a85
    v_accvgpr_read_b32 v154, a89
    v_accvgpr_read_b32 v155, a93
    v_mul_f32 v144, v144, v53
    v_mul_f32 v145, v145, v53
    v_mfma_f32_16x16x32_bf16 v[120:123], v[40:43], a[240:243], v[136:139]
    ds_read_b128 v[24:27], v2 offset:12544
    v_mul_f32 v146, v146, v53
    v_mfma_f32_16x16x32_bf16 v[120:123], v[44:47], a[244:247], v[120:123]
    v_exp_f32 v16, v168
    v_exp_f32 v17, v169
    v_exp_f32 v18, v170
    v_mfma_f32_16x16x32_bf16 v[124:127], v[40:43], v[200:203], v[140:143]
    ds_read_b128 v[28:31], v3 offset:12544
    v_add_f32 v7, v7, v16
    v_mfma_f32_16x16x32_bf16 v[124:127], v[44:47], v[204:207], v[124:127]
    s_waitcnt lgkmcnt(4)
    v_add_f32 v7, v7, v17
    v_exp_f32 v19, v171
    v_cvt_pk_bf16_f32 v168, v16, v17
    v_exp_f32 v16, v104
    v_mfma_f32_16x16x32_bf16 v[184:187], v[240:243], a[248:251], v[184:187]
    ds_read_b128 v[32:35], v2 offset:18688
    v_add_f32 v7, v7, v18
    v_mfma_f32_16x16x32_bf16 v[184:187], v[244:247], a[252:255], v[184:187]
    v_add_f32 v7, v7, v19
    v_exp_f32 v17, v105
    v_cvt_pk_bf16_f32 v169, v18, v19
    v_exp_f32 v18, v106
    v_mfma_f32_16x16x32_bf16 v[188:191], v[240:243], v[208:211], v[188:191]
    ds_read_b128 v[36:39], v3 offset:18688
    v_add_f32 v7, v7, v16
    v_mfma_f32_16x16x32_bf16 v[188:191], v[244:247], v[212:215], v[188:191]
    s_waitcnt lgkmcnt(4)
    v_add_f32 v7, v7, v17
    v_exp_f32 v19, v107
    v_cvt_pk_bf16_f32 v170, v16, v17
    v_exp_f32 v16, v172
    v_mfma_f32_16x16x32_bf16 v[120:123], v[248:251], a[248:251], v[120:123]
    ds_read_b128 v[40:43], v9 offset:0
    v_add_f32 v7, v7, v18
    v_mfma_f32_16x16x32_bf16 v[120:123], v[252:255], a[252:255], v[120:123]
    v_add_f32 v7, v7, v19
    v_exp_f32 v17, v173
    v_cvt_pk_bf16_f32 v171, v18, v19
    v_exp_f32 v18, v174
    v_mfma_f32_16x16x32_bf16 v[124:127], v[248:251], v[208:211], v[124:127]
    ds_read_b128 v[44:47], v9 offset:12288
    v_add_f32 v8, v8, v16
    v_mfma_f32_16x16x32_bf16 v[124:127], v[252:255], v[212:215], v[124:127]
    s_waitcnt lgkmcnt(4)
    v_add_f32 v8, v8, v17
    v_exp_f32 v19, v175
    v_cvt_pk_bf16_f32 v172, v16, v17
    v_exp_f32 v16, v108
    v_mfma_f32_16x16x32_bf16 v[184:187], v[24:27], v[192:195], v[184:187]
    ds_read_b128 v[240:243], v9 offset:768
    v_add_f32 v8, v8, v18
    v_mfma_f32_16x16x32_bf16 v[184:187], v[28:31], v[196:199], v[184:187]
    v_add_f32 v8, v8, v19
    v_exp_f32 v17, v109
    v_cvt_pk_bf16_f32 v173, v18, v19
    v_exp_f32 v18, v110
    v_mfma_f32_16x16x32_bf16 v[188:191], v[24:27], v[216:219], v[188:191]
    ds_read_b128 v[244:247], v9 offset:13056
    v_add_f32 v8, v8, v16
    v_mfma_f32_16x16x32_bf16 v[188:191], v[28:31], v[220:223], v[188:191]
    s_waitcnt lgkmcnt(4)
    v_add_f32 v8, v8, v17
    v_exp_f32 v19, v111
    v_cvt_pk_bf16_f32 v174, v16, v17
    v_add_f32 v8, v8, v18
    v_add_f32 v8, v8, v19
    v_mfma_f32_16x16x32_bf16 v[120:123], v[32:35], v[192:195], v[120:123]
    ds_read_b128 v[248:251], v9 offset:1536
    v_cvt_pk_bf16_f32 v175, v18, v19
    v_mfma_f32_16x16x32_bf16 v[120:123], v[36:39], v[196:199], v[120:123]
    v_mul_f32 v147, v147, v53
    v_mul_f32 v148, v148, v53
    v_mul_f32 v149, v149, v53
    v_mul_f32 v150, v150, v53
    v_mul_f32 v151, v151, v53
    v_mul_f32 v152, v152, v53
    v_mfma_f32_16x16x32_bf16 v[124:127], v[32:35], v[216:219], v[124:127]
    ds_read_b128 v[252:255], v9 offset:13824
    v_mul_f32 v153, v153, v53
    v_mfma_f32_16x16x32_bf16 v[124:127], v[36:39], v[220:223], v[124:127]
    s_waitcnt lgkmcnt(4)
    v_mul_f32 v154, v154, v53
    v_mul_f32 v155, v155, v53
    v_cvt_pk_bf16_f32 v144, v144, v145
    v_cvt_pk_bf16_f32 v145, v146, v147
    v_cvt_pk_bf16_f32 v146, v148, v149
    v_cvt_pk_bf16_f32 v147, v150, v151
    v_mfma_f32_16x16x32_bf16 a[96:99], v[72:75], v[40:43], a[96:99]
    ds_read_b128 v[24:27], v9 offset:2304
    v_cvt_pk_bf16_f32 v148, v152, v153
    v_mfma_f32_16x16x32_bf16 a[96:99], v[88:91], v[44:47], a[96:99]
    v_exp_f32 v16, v184
    v_exp_f32 v17, v185
    v_exp_f32 v18, v186
    v_mfma_f32_16x16x32_bf16 a[144:147], v[76:79], v[40:43], a[144:147]
    ds_read_b128 v[28:31], v9 offset:14592
    v_add_f32 v7, v7, v16
    v_mfma_f32_16x16x32_bf16 a[144:147], v[92:95], v[44:47], a[144:147]
    s_waitcnt lgkmcnt(4)
    v_add_f32 v7, v7, v17
    v_exp_f32 v19, v187
    v_cvt_pk_bf16_f32 v184, v16, v17
    v_exp_f32 v16, v120
    v_mfma_f32_16x16x32_bf16 a[100:103], v[72:75], v[240:243], a[100:103]
    ds_read_b128 v[32:35], v10 offset:0
    v_add_f32 v7, v7, v18
    v_mfma_f32_16x16x32_bf16 a[100:103], v[88:91], v[244:247], a[100:103]
    v_add_f32 v7, v7, v19
    v_exp_f32 v17, v121
    v_cvt_pk_bf16_f32 v185, v18, v19
    v_exp_f32 v18, v122
    v_mfma_f32_16x16x32_bf16 a[148:151], v[76:79], v[240:243], a[148:151]
    ds_read_b128 v[36:39], v10 offset:12288
    v_add_f32 v7, v7, v16
    v_mfma_f32_16x16x32_bf16 a[148:151], v[92:95], v[244:247], a[148:151]
    s_waitcnt lgkmcnt(4)
    v_add_f32 v7, v7, v17
    v_exp_f32 v19, v123
    v_cvt_pk_bf16_f32 v186, v16, v17
    v_exp_f32 v16, v188
    v_mfma_f32_16x16x32_bf16 a[104:107], v[72:75], v[248:251], a[104:107]
    ds_read_b128 v[40:43], v10 offset:768
    v_add_f32 v7, v7, v18
    v_mfma_f32_16x16x32_bf16 a[104:107], v[88:91], v[252:255], a[104:107]
    v_add_f32 v7, v7, v19
    v_exp_f32 v17, v189
    v_cvt_pk_bf16_f32 v187, v18, v19
    v_exp_f32 v18, v190
    v_mfma_f32_16x16x32_bf16 a[152:155], v[76:79], v[248:251], a[152:155]
    ds_read_b128 v[44:47], v10 offset:13056
    v_add_f32 v8, v8, v16
    v_mfma_f32_16x16x32_bf16 a[152:155], v[92:95], v[252:255], a[152:155]
    s_waitcnt lgkmcnt(4)
    v_add_f32 v8, v8, v17
    v_exp_f32 v19, v191
    v_cvt_pk_bf16_f32 v188, v16, v17
    v_exp_f32 v16, v124
    v_mfma_f32_16x16x32_bf16 a[108:111], v[72:75], v[24:27], a[108:111]
    ds_read_b128 v[240:243], v10 offset:1536
    v_add_f32 v8, v8, v18
    v_mfma_f32_16x16x32_bf16 a[108:111], v[88:91], v[28:31], a[108:111]
    v_add_f32 v8, v8, v19
    v_exp_f32 v17, v125
    v_cvt_pk_bf16_f32 v189, v18, v19
    v_exp_f32 v18, v126
    v_mfma_f32_16x16x32_bf16 a[156:159], v[76:79], v[24:27], a[156:159]
    ds_read_b128 v[244:247], v10 offset:13824
    v_add_f32 v8, v8, v16
    v_mfma_f32_16x16x32_bf16 a[156:159], v[92:95], v[28:31], a[156:159]
    s_waitcnt lgkmcnt(4)
    v_add_f32 v8, v8, v17
    v_exp_f32 v19, v127
    v_cvt_pk_bf16_f32 v190, v16, v17
    v_add_f32 v8, v8, v18
    v_add_f32 v8, v8, v19
    v_mfma_f32_16x16x32_bf16 a[112:115], v[72:75], v[32:35], a[112:115]
    ds_read_b128 v[248:251], v10 offset:2304
    v_cvt_pk_bf16_f32 v191, v18, v19
    v_mfma_f32_16x16x32_bf16 a[112:115], v[88:91], v[36:39], a[112:115]
    v_max_f32 v20, v7, v8
    v_cmp_lt_f32 vcc, s29, v20
    v_cvt_pk_bf16_f32 v149, v154, v155
    v_mfma_f32_16x16x32_bf16 a[160:163], v[76:79], v[32:35], a[160:163]
    ds_read_b128 v[252:255], v10 offset:14592
    v_mfma_f32_16x16x32_bf16 a[160:163], v[92:95], v[36:39], a[160:163]
    s_waitcnt lgkmcnt(4)
    buffer_store_dwordx4 v[144:147], v60, s[12:15], s34 offen offset:384 sc0 sc1
    buffer_store_dwordx2 v[148:149], v61, s[12:15], s34 offen offset:640 sc0 sc1
    v_mfma_f32_16x16x32_bf16 a[116:119], v[72:75], v[40:43], a[116:119]
    ds_read_b128 v[24:27], v11 offset:0
    v_accvgpr_read_b32 v224, a50
    v_mfma_f32_16x16x32_bf16 a[116:119], v[88:91], v[44:47], a[116:119]
    v_accvgpr_read_b32 v225, a54
    v_accvgpr_read_b32 v226, a58
    v_accvgpr_read_b32 v227, a62
    v_accvgpr_read_b32 v228, a66
    v_accvgpr_read_b32 v229, a70
    v_accvgpr_read_b32 v230, a74
    v_mfma_f32_16x16x32_bf16 a[164:167], v[76:79], v[40:43], a[164:167]
    ds_read_b128 v[28:31], v11 offset:12288
    v_accvgpr_read_b32 v231, a78
    v_mfma_f32_16x16x32_bf16 a[164:167], v[92:95], v[44:47], a[164:167]
    s_waitcnt lgkmcnt(4)
    v_accvgpr_read_b32 v232, a82
    v_accvgpr_read_b32 v233, a86
    v_accvgpr_read_b32 v234, a90
    v_accvgpr_read_b32 v235, a94
    v_mul_f32 v224, v224, v54
    v_mul_f32 v225, v225, v54
    v_mfma_f32_16x16x32_bf16 a[120:123], v[72:75], v[240:243], a[120:123]
    ds_read_b128 v[32:35], v11 offset:768
    v_mul_f32 v226, v226, v54
    v_mfma_f32_16x16x32_bf16 a[120:123], v[88:91], v[244:247], a[120:123]
    v_mul_f32 v227, v227, v54
    v_mul_f32 v228, v228, v54
    v_mul_f32 v229, v229, v54
    v_mul_f32 v230, v230, v54
    v_mul_f32 v231, v231, v54
    v_mul_f32 v232, v232, v54
    v_mfma_f32_16x16x32_bf16 a[168:171], v[76:79], v[240:243], a[168:171]
    ds_read_b128 v[36:39], v11 offset:13056
    v_mul_f32 v233, v233, v54
    v_mfma_f32_16x16x32_bf16 a[168:171], v[92:95], v[244:247], a[168:171]
    s_waitcnt lgkmcnt(4)
    v_mul_f32 v234, v234, v54
    v_mul_f32 v235, v235, v54
    v_cvt_pk_bf16_f32 v224, v224, v225
    v_cvt_pk_bf16_f32 v225, v226, v227
    v_cvt_pk_bf16_f32 v226, v228, v229
    v_cvt_pk_bf16_f32 v227, v230, v231
    v_mfma_f32_16x16x32_bf16 a[124:127], v[72:75], v[248:251], a[124:127]
    ds_read_b128 v[40:43], v11 offset:1536
    v_cvt_pk_bf16_f32 v228, v232, v233
    v_mfma_f32_16x16x32_bf16 a[124:127], v[88:91], v[252:255], a[124:127]
    v_cvt_pk_bf16_f32 v229, v234, v235
    buffer_store_dwordx4 v[224:227], v60, s[12:15], s34 offen offset:768 sc0 sc1
    v_mfma_f32_16x16x32_bf16 a[172:175], v[76:79], v[248:251], a[172:175]
    ds_read_b128 v[44:47], v11 offset:13824
    v_mfma_f32_16x16x32_bf16 a[172:175], v[92:95], v[252:255], a[172:175]
    s_waitcnt lgkmcnt(4)
    buffer_store_dwordx2 v[228:229], v61, s[12:15], s34 offen offset:1024 sc0 sc1
    v_accvgpr_read_b32 v144, a51
    v_accvgpr_read_b32 v145, a55
    v_accvgpr_read_b32 v146, a59
    v_mfma_f32_16x16x32_bf16 a[128:131], v[72:75], v[24:27], a[128:131]
    ds_read_b128 v[240:243], v11 offset:2304
    v_accvgpr_read_b32 v147, a63
    v_mfma_f32_16x16x32_bf16 a[128:131], v[88:91], v[28:31], a[128:131]
    v_accvgpr_read_b32 v148, a67
    v_accvgpr_read_b32 v149, a71
    v_accvgpr_read_b32 v150, a75
    v_accvgpr_read_b32 v151, a79
    v_accvgpr_read_b32 v152, a83
    v_accvgpr_read_b32 v153, a87
    v_mfma_f32_16x16x32_bf16 a[176:179], v[76:79], v[24:27], a[176:179]
    ds_read_b128 v[244:247], v11 offset:14592
    v_accvgpr_read_b32 v154, a91
    v_mfma_f32_16x16x32_bf16 a[176:179], v[92:95], v[28:31], a[176:179]
    s_waitcnt lgkmcnt(4)
    v_accvgpr_read_b32 v155, a95
    v_mul_f32 v144, v144, v55
    v_mul_f32 v145, v145, v55
    v_mul_f32 v146, v146, v55
    v_mul_f32 v147, v147, v55
    v_mul_f32 v148, v148, v55
    v_mfma_f32_16x16x32_bf16 a[132:135], v[72:75], v[32:35], a[132:135]
    ds_read_b128 v[248:251], v12 offset:0
    v_mul_f32 v149, v149, v55
    v_mfma_f32_16x16x32_bf16 a[132:135], v[88:91], v[36:39], a[132:135]
    v_mul_f32 v150, v150, v55
    v_mul_f32 v151, v151, v55
    v_mul_f32 v152, v152, v55
    v_mul_f32 v153, v153, v55
    v_mul_f32 v154, v154, v55
    v_mul_f32 v155, v155, v55
    v_mfma_f32_16x16x32_bf16 a[180:183], v[76:79], v[32:35], a[180:183]
    ds_read_b128 v[252:255], v12 offset:12288
    v_cvt_pk_bf16_f32 v144, v144, v145
    v_mfma_f32_16x16x32_bf16 a[180:183], v[92:95], v[36:39], a[180:183]
    s_waitcnt lgkmcnt(4)
    v_cvt_pk_bf16_f32 v145, v146, v147
    v_cvt_pk_bf16_f32 v146, v148, v149
    v_cvt_pk_bf16_f32 v147, v150, v151
    v_cvt_pk_bf16_f32 v148, v152, v153
    v_cvt_pk_bf16_f32 v149, v154, v155
    v_mfma_f32_16x16x32_bf16 a[136:139], v[72:75], v[40:43], a[136:139]
    ds_read_b128 v[24:27], v12 offset:768
    v_mfma_f32_16x16x32_bf16 a[136:139], v[88:91], v[44:47], a[136:139]
    buffer_store_dwordx4 v[144:147], v60, s[12:15], s34 offen offset:1152 sc0 sc1
    buffer_store_dwordx2 v[148:149], v61, s[12:15], s34 offen offset:1408 sc0 sc1
    v_mfma_f32_16x16x32_bf16 a[184:187], v[76:79], v[40:43], a[184:187]
    ds_read_b128 v[28:31], v12 offset:13056
    v_mfma_f32_16x16x32_bf16 a[184:187], v[92:95], v[44:47], a[184:187]
    s_waitcnt lgkmcnt(4)
    v_mfma_f32_16x16x32_bf16 a[140:143], v[72:75], v[240:243], a[140:143]
    ds_read_b128 v[32:35], v12 offset:1536
    v_mfma_f32_16x16x32_bf16 a[140:143], v[88:91], v[244:247], a[140:143]
    v_mfma_f32_16x16x32_bf16 a[188:191], v[76:79], v[240:243], a[188:191]
    ds_read_b128 v[36:39], v12 offset:13824
    v_mfma_f32_16x16x32_bf16 a[188:191], v[92:95], v[244:247], a[188:191]
    s_waitcnt lgkmcnt(4)
    s_nop 0
    v_mfma_f32_16x16x4_f32 v[56:59], v7, v15, 0
    v_mfma_f32_16x16x4_f32 v[128:131], v8, v15, 0
    s_cbranch_vccnz L_slow
    v_mfma_f32_16x16x32_bf16 a[96:99], v[168:171], v[248:251], a[96:99]
    ds_read_b128 v[40:43], v12 offset:2304
    ds_read_b128 v[44:47], v12 offset:14592
    v_mfma_f32_16x16x32_bf16 a[96:99], v[184:187], v[252:255], a[96:99]
    s_waitcnt lgkmcnt(4)
    s_nop 3
    v_rcp_f32 v56, v56
    v_rcp_f32 v57, v57
    v_mfma_f32_16x16x32_bf16 a[100:103], v[168:171], v[24:27], a[100:103]
    ds_read_b128 v[240:243], v13 offset:0
    ds_read_b128 v[244:247], v13 offset:12288
    v_mfma_f32_16x16x32_bf16 a[100:103], v[184:187], v[28:31], a[100:103]
    s_waitcnt lgkmcnt(4)
    v_rcp_f32 v58, v58
    v_rcp_f32 v59, v59
    v_rcp_f32 v128, v128
    v_rcp_f32 v129, v129
    v_rcp_f32 v130, v130
    v_rcp_f32 v131, v131
    v_mfma_f32_16x16x32_bf16 a[104:107], v[168:171], v[32:35], a[104:107]
    ds_read_b128 v[248:251], v13 offset:768
    ds_read_b128 v[252:255], v13 offset:13056
    v_mfma_f32_16x16x32_bf16 a[104:107], v[184:187], v[36:39], a[104:107]
    s_waitcnt lgkmcnt(4)
    v_mfma_f32_16x16x32_bf16 a[108:111], v[168:171], v[40:43], a[108:111]
    ds_read_b128 v[24:27], v13 offset:1536
    ds_read_b128 v[28:31], v13 offset:13824
    v_mfma_f32_16x16x32_bf16 a[108:111], v[184:187], v[44:47], a[108:111]
    s_waitcnt lgkmcnt(4)
    v_mfma_f32_16x16x32_bf16 a[112:115], v[168:171], v[240:243], a[112:115]
    ds_read_b128 v[32:35], v13 offset:2304
    ds_read_b128 v[36:39], v13 offset:14592
    v_mfma_f32_16x16x32_bf16 a[112:115], v[184:187], v[244:247], a[112:115]
    s_waitcnt lgkmcnt(4)
    v_mfma_f32_16x16x32_bf16 a[116:119], v[168:171], v[248:251], a[116:119]
    ds_read_b128 v[40:43], v14 offset:0
    ds_read_b128 v[44:47], v14 offset:12288
    v_mfma_f32_16x16x32_bf16 a[116:119], v[184:187], v[252:255], a[116:119]
    s_waitcnt lgkmcnt(4)
    v_mfma_f32_16x16x32_bf16 a[120:123], v[168:171], v[24:27], a[120:123]
    ds_read_b128 v[240:243], v14 offset:768
    ds_read_b128 v[244:247], v14 offset:13056
    v_mfma_f32_16x16x32_bf16 a[120:123], v[184:187], v[28:31], a[120:123]
    s_waitcnt lgkmcnt(4)
    v_mfma_f32_16x16x32_bf16 a[124:127], v[168:171], v[32:35], a[124:127]
    ds_read_b128 v[248:251], v14 offset:1536
    ds_read_b128 v[252:255], v14 offset:13824
    v_mfma_f32_16x16x32_bf16 a[124:127], v[184:187], v[36:39], a[124:127]
    s_waitcnt lgkmcnt(4)
    v_mfma_f32_16x16x32_bf16 a[128:131], v[168:171], v[40:43], a[128:131]
    ds_read_b128 v[24:27], v14 offset:2304
    ds_read_b128 v[28:31], v14 offset:14592
    v_mfma_f32_16x16x32_bf16 a[128:131], v[184:187], v[44:47], a[128:131]
    s_waitcnt lgkmcnt(4)
    v_mfma_f32_16x16x32_bf16 a[132:135], v[168:171], v[240:243], a[132:135]
    ds_read_b128 v[32:35], v12 offset:0
    ds_read_b128 v[36:39], v12 offset:12288
    v_mfma_f32_16x16x32_bf16 a[132:135], v[184:187], v[244:247], a[132:135]
    s_waitcnt lgkmcnt(4)
    v_mfma_f32_16x16x32_bf16 a[136:139], v[168:171], v[248:251], a[136:139]
    ds_read_b128 v[40:43], v12 offset:768
    ds_read_b128 v[44:47], v12 offset:13056
    v_mfma_f32_16x16x32_bf16 a[136:139], v[184:187], v[252:255], a[136:139]
    s_waitcnt lgkmcnt(4)
    v_mfma_f32_16x16x32_bf16 a[140:143], v[168:171], v[24:27], a[140:143]
    ds_read_b128 v[240:243], v12 offset:1536
    ds_read_b128 v[244:247], v12 offset:13824
    v_mfma_f32_16x16x32_bf16 a[140:143], v[184:187], v[28:31], a[140:143]
    s_waitcnt lgkmcnt(4)
    v_mfma_f32_16x16x32_bf16 a[144:147], v[172:175], v[32:35], a[144:147]
    ds_read_b128 v[248:251], v12 offset:2304
    ds_read_b128 v[252:255], v12 offset:14592
    v_mfma_f32_16x16x32_bf16 a[144:147], v[188:191], v[36:39], a[144:147]
    s_waitcnt lgkmcnt(4)
    s_nop 3
    v_accvgpr_read_b32 v224, a96
    v_accvgpr_read_b32 v225, a100
    v_mfma_f32_16x16x32_bf16 a[148:151], v[172:175], v[40:43], a[148:151]
    ds_read_b128 v[24:27], v13 offset:0
    ds_read_b128 v[28:31], v13 offset:12288
    v_mfma_f32_16x16x32_bf16 a[148:151], v[188:191], v[44:47], a[148:151]
    s_waitcnt lgkmcnt(4)
    v_accvgpr_read_b32 v226, a104
    v_accvgpr_read_b32 v227, a108
    v_accvgpr_read_b32 v228, a112
    v_accvgpr_read_b32 v229, a116
    v_accvgpr_read_b32 v230, a120
    v_accvgpr_read_b32 v231, a124
    v_mfma_f32_16x16x32_bf16 a[152:155], v[172:175], v[240:243], a[152:155]
    ds_read_b128 v[32:35], v13 offset:768
    ds_read_b128 v[36:39], v13 offset:13056
    v_mfma_f32_16x16x32_bf16 a[152:155], v[188:191], v[244:247], a[152:155]
    s_waitcnt lgkmcnt(4)
    v_accvgpr_read_b32 v232, a128
    v_accvgpr_read_b32 v233, a132
    v_accvgpr_read_b32 v234, a136
    v_accvgpr_read_b32 v235, a140
    v_mul_f32 v224, v224, v56
    v_mul_f32 v225, v225, v56
    v_mfma_f32_16x16x32_bf16 a[156:159], v[172:175], v[248:251], a[156:159]
    ds_read_b128 v[40:43], v13 offset:1536
    ds_read_b128 v[44:47], v13 offset:13824
    v_mfma_f32_16x16x32_bf16 a[156:159], v[188:191], v[252:255], a[156:159]
    s_waitcnt lgkmcnt(4)
    v_mul_f32 v226, v226, v56
    v_mul_f32 v227, v227, v56
    v_mul_f32 v228, v228, v56
    v_mul_f32 v229, v229, v56
    v_mul_f32 v230, v230, v56
    v_mul_f32 v231, v231, v56
    v_mfma_f32_16x16x32_bf16 a[160:163], v[172:175], v[24:27], a[160:163]
    ds_read_b128 v[240:243], v13 offset:2304
    ds_read_b128 v[244:247], v13 offset:14592
    v_mfma_f32_16x16x32_bf16 a[160:163], v[188:191], v[28:31], a[160:163]
    s_waitcnt lgkmcnt(4)
    v_mul_f32 v232, v232, v56
    v_mul_f32 v233, v233, v56
    v_mul_f32 v234, v234, v56
    v_mul_f32 v235, v235, v56
    v_cvt_pk_bf16_f32 v224, v224, v225
    v_cvt_pk_bf16_f32 v225, v226, v227
    v_mfma_f32_16x16x32_bf16 a[164:167], v[172:175], v[32:35], a[164:167]
    ds_read_b128 v[248:251], v14 offset:0
    ds_read_b128 v[252:255], v14 offset:12288
    v_mfma_f32_16x16x32_bf16 a[164:167], v[188:191], v[36:39], a[164:167]
    s_waitcnt lgkmcnt(4)
    v_cvt_pk_bf16_f32 v226, v228, v229
    v_cvt_pk_bf16_f32 v227, v230, v231
    v_cvt_pk_bf16_f32 v228, v232, v233
    v_cvt_pk_bf16_f32 v229, v234, v235
    v_mfma_f32_16x16x32_bf16 a[168:171], v[172:175], v[40:43], a[168:171]
    ds_read_b128 v[24:27], v14 offset:768
    ds_read_b128 v[28:31], v14 offset:13056
    v_mfma_f32_16x16x32_bf16 a[168:171], v[188:191], v[44:47], a[168:171]
    s_waitcnt lgkmcnt(4)
    buffer_store_dwordx4 v[224:227], v60, s[12:15], s35 offen offset:0 sc0 sc1
    buffer_store_dwordx2 v[228:229], v61, s[12:15], s35 offen offset:256 sc0 sc1
    v_mfma_f32_16x16x32_bf16 a[172:175], v[172:175], v[240:243], a[172:175]
    ds_read_b128 v[32:35], v14 offset:1536
    ds_read_b128 v[36:39], v14 offset:13824
    v_mfma_f32_16x16x32_bf16 a[172:175], v[188:191], v[244:247], a[172:175]
    s_waitcnt lgkmcnt(4)
    v_accvgpr_read_b32 v144, a97
    v_accvgpr_read_b32 v145, a101
    v_accvgpr_read_b32 v146, a105
    v_accvgpr_read_b32 v147, a109
    v_accvgpr_read_b32 v148, a113
    v_accvgpr_read_b32 v149, a117
    v_mfma_f32_16x16x32_bf16 a[176:179], v[172:175], v[248:251], a[176:179]
    ds_read_b128 v[40:43], v14 offset:2304
    ds_read_b128 v[44:47], v14 offset:14592
    v_mfma_f32_16x16x32_bf16 a[176:179], v[188:191], v[252:255], a[176:179]
    s_waitcnt lgkmcnt(4)
    v_accvgpr_read_b32 v150, a121
    v_accvgpr_read_b32 v151, a125
    v_accvgpr_read_b32 v152, a129
    v_accvgpr_read_b32 v153, a133
    v_accvgpr_read_b32 v154, a137
    v_accvgpr_read_b32 v155, a141
    v_mfma_f32_16x16x32_bf16 a[180:183], v[172:175], v[24:27], a[180:183]
    v_mul_f32 v144, v144, v57
    v_mul_f32 v145, v145, v57
    v_mfma_f32_16x16x32_bf16 a[180:183], v[188:191], v[28:31], a[180:183]
    s_waitcnt lgkmcnt(2)
    v_mul_f32 v146, v146, v57
    v_mul_f32 v147, v147, v57
    v_mul_f32 v148, v148, v57
    v_mul_f32 v149, v149, v57
    v_mul_f32 v150, v150, v57
    v_mul_f32 v151, v151, v57
    v_mfma_f32_16x16x32_bf16 a[184:187], v[172:175], v[32:35], a[184:187]
    v_mul_f32 v152, v152, v57
    v_mul_f32 v153, v153, v57
    v_mfma_f32_16x16x32_bf16 a[184:187], v[188:191], v[36:39], a[184:187]
    s_waitcnt lgkmcnt(0)
    v_mul_f32 v154, v154, v57
    v_mul_f32 v155, v155, v57
    v_cvt_pk_bf16_f32 v144, v144, v145
    v_cvt_pk_bf16_f32 v145, v146, v147
    v_cvt_pk_bf16_f32 v146, v148, v149
    v_cvt_pk_bf16_f32 v147, v150, v151
    v_mfma_f32_16x16x32_bf16 a[188:191], v[172:175], v[40:43], a[188:191]
    v_cvt_pk_bf16_f32 v148, v152, v153
    v_cvt_pk_bf16_f32 v149, v154, v155
    v_mfma_f32_16x16x32_bf16 a[188:191], v[188:191], v[44:47], a[188:191]
    buffer_store_dwordx4 v[144:147], v60, s[12:15], s35 offen offset:384 sc0 sc1
    buffer_store_dwordx2 v[148:149], v61, s[12:15], s35 offen offset:640 sc0 sc1
    v_accvgpr_read_b32 v224, a98
    v_accvgpr_read_b32 v225, a102
    v_accvgpr_read_b32 v226, a106
    v_accvgpr_read_b32 v227, a110
    v_accvgpr_read_b32 v228, a114
    v_accvgpr_read_b32 v229, a118
    v_accvgpr_read_b32 v230, a122
    v_accvgpr_read_b32 v231, a126
    v_accvgpr_read_b32 v232, a130
    v_accvgpr_read_b32 v233, a134
    v_accvgpr_read_b32 v234, a138
    v_accvgpr_read_b32 v235, a142
    v_mul_f32 v224, v224, v58
    v_mul_f32 v225, v225, v58
    v_mul_f32 v226, v226, v58
    v_mul_f32 v227, v227, v58
    v_mul_f32 v228, v228, v58
    v_mul_f32 v229, v229, v58
    v_mul_f32 v230, v230, v58
    v_mul_f32 v231, v231, v58
    v_mul_f32 v232, v232, v58
    v_mul_f32 v233, v233, v58
    v_mul_f32 v234, v234, v58
    v_mul_f32 v235, v235, v58
    v_cvt_pk_bf16_f32 v224, v224, v225
    v_cvt_pk_bf16_f32 v225, v226, v227
    v_cvt_pk_bf16_f32 v226, v228, v229
    v_cvt_pk_bf16_f32 v227, v230, v231
    v_cvt_pk_bf16_f32 v228, v232, v233
    v_cvt_pk_bf16_f32 v229, v234, v235
    buffer_store_dwordx4 v[224:227], v60, s[12:15], s35 offen offset:768 sc0 sc1
    buffer_store_dwordx2 v[228:229], v61, s[12:15], s35 offen offset:1024 sc0 sc1
    v_accvgpr_read_b32 v144, a99
    v_accvgpr_read_b32 v145, a103
    v_accvgpr_read_b32 v146, a107
    v_accvgpr_read_b32 v147, a111
    v_accvgpr_read_b32 v148, a115
    v_accvgpr_read_b32 v149, a119
    v_accvgpr_read_b32 v150, a123
    v_accvgpr_read_b32 v151, a127
    v_accvgpr_read_b32 v152, a131
    v_accvgpr_read_b32 v153, a135
    v_accvgpr_read_b32 v154, a139
    v_accvgpr_read_b32 v155, a143
    v_mul_f32 v144, v144, v59
    v_mul_f32 v145, v145, v59
    v_mul_f32 v146, v146, v59
    v_mul_f32 v147, v147, v59
    v_mul_f32 v148, v148, v59
    v_mul_f32 v149, v149, v59
    v_mul_f32 v150, v150, v59
    v_mul_f32 v151, v151, v59
    v_mul_f32 v152, v152, v59
    v_mul_f32 v153, v153, v59
    v_mul_f32 v154, v154, v59
    v_mul_f32 v155, v155, v59
    v_cvt_pk_bf16_f32 v144, v144, v145
    v_cvt_pk_bf16_f32 v145, v146, v147
    v_cvt_pk_bf16_f32 v146, v148, v149
    v_cvt_pk_bf16_f32 v147, v150, v151
    v_cvt_pk_bf16_f32 v148, v152, v153
    v_cvt_pk_bf16_f32 v149, v154, v155
    buffer_store_dwordx4 v[144:147], v60, s[12:15], s35 offen offset:1152 sc0 sc1
    buffer_store_dwordx2 v[148:149], v61, s[12:15], s35 offen offset:1408 sc0 sc1
    s_nop 4
    v_accvgpr_read_b32 v88, a144
    v_accvgpr_read_b32 v89, a148
    v_accvgpr_read_b32 v90, a152
    v_accvgpr_read_b32 v91, a156
    v_accvgpr_read_b32 v92, a160
    v_accvgpr_read_b32 v93, a164
    v_accvgpr_read_b32 v94, a168
    v_accvgpr_read_b32 v95, a172
    v_accvgpr_read_b32 v96, a176
    v_accvgpr_read_b32 v97, a180
    v_accvgpr_read_b32 v98, a184
    v_accvgpr_read_b32 v99, a188
    v_pk_mul_f32 v[88:89], v[88:89], v[128:129] op_sel:[0,0] op_sel_hi:[1,0]
    v_pk_mul_f32 v[90:91], v[90:91], v[128:129] op_sel:[0,0] op_sel_hi:[1,0]
    v_pk_mul_f32 v[92:93], v[92:93], v[128:129] op_sel:[0,0] op_sel_hi:[1,0]
    v_pk_mul_f32 v[94:95], v[94:95], v[128:129] op_sel:[0,0] op_sel_hi:[1,0]
    v_pk_mul_f32 v[96:97], v[96:97], v[128:129] op_sel:[0,0] op_sel_hi:[1,0]
    v_pk_mul_f32 v[98:99], v[98:99], v[128:129] op_sel:[0,0] op_sel_hi:[1,0]
    v_cvt_pk_bf16_f32 v88, v88, v89
    v_cvt_pk_bf16_f32 v89, v90, v91
    v_cvt_pk_bf16_f32 v90, v92, v93
    v_cvt_pk_bf16_f32 v91, v94, v95
    v_cvt_pk_bf16_f32 v92, v96, v97
    v_cvt_pk_bf16_f32 v93, v98, v99
    buffer_store_dwordx4 v[88:91], v60, s[12:15], s36 offen offset:0 sc0 sc1
    buffer_store_dwordx2 v[92:93], v61, s[12:15], s36 offen offset:256 sc0 sc1
    v_accvgpr_read_b32 v100, a145
    v_accvgpr_read_b32 v101, a149
    v_accvgpr_read_b32 v102, a153
    v_accvgpr_read_b32 v103, a157
    v_accvgpr_read_b32 v104, a161
    v_accvgpr_read_b32 v105, a165
    v_accvgpr_read_b32 v106, a169
    v_accvgpr_read_b32 v107, a173
    v_accvgpr_read_b32 v108, a177
    v_accvgpr_read_b32 v109, a181
    v_accvgpr_read_b32 v110, a185
    v_accvgpr_read_b32 v111, a189
    v_pk_mul_f32 v[100:101], v[100:101], v[128:129] op_sel:[0,1] op_sel_hi:[1,1]
    v_pk_mul_f32 v[102:103], v[102:103], v[128:129] op_sel:[0,1] op_sel_hi:[1,1]
    v_pk_mul_f32 v[104:105], v[104:105], v[128:129] op_sel:[0,1] op_sel_hi:[1,1]
    v_pk_mul_f32 v[106:107], v[106:107], v[128:129] op_sel:[0,1] op_sel_hi:[1,1]
    v_pk_mul_f32 v[108:109], v[108:109], v[128:129] op_sel:[0,1] op_sel_hi:[1,1]
    v_pk_mul_f32 v[110:111], v[110:111], v[128:129] op_sel:[0,1] op_sel_hi:[1,1]
    v_cvt_pk_bf16_f32 v100, v100, v101
    v_cvt_pk_bf16_f32 v101, v102, v103
    v_cvt_pk_bf16_f32 v102, v104, v105
    v_cvt_pk_bf16_f32 v103, v106, v107
    v_cvt_pk_bf16_f32 v104, v108, v109
    v_cvt_pk_bf16_f32 v105, v110, v111
    buffer_store_dwordx4 v[100:103], v60, s[12:15], s36 offen offset:384 sc0 sc1
    buffer_store_dwordx2 v[104:105], v61, s[12:15], s36 offen offset:640 sc0 sc1
    v_accvgpr_read_b32 v112, a146
    v_accvgpr_read_b32 v113, a150
    v_accvgpr_read_b32 v114, a154
    v_accvgpr_read_b32 v115, a158
    v_accvgpr_read_b32 v116, a162
    v_accvgpr_read_b32 v117, a166
    v_accvgpr_read_b32 v118, a170
    v_accvgpr_read_b32 v119, a174
    v_accvgpr_read_b32 v120, a178
    v_accvgpr_read_b32 v121, a182
    v_accvgpr_read_b32 v122, a186
    v_accvgpr_read_b32 v123, a190
    v_pk_mul_f32 v[112:113], v[112:113], v[130:131] op_sel:[0,0] op_sel_hi:[1,0]
    v_pk_mul_f32 v[114:115], v[114:115], v[130:131] op_sel:[0,0] op_sel_hi:[1,0]
    v_pk_mul_f32 v[116:117], v[116:117], v[130:131] op_sel:[0,0] op_sel_hi:[1,0]
    v_pk_mul_f32 v[118:119], v[118:119], v[130:131] op_sel:[0,0] op_sel_hi:[1,0]
    v_pk_mul_f32 v[120:121], v[120:121], v[130:131] op_sel:[0,0] op_sel_hi:[1,0]
    v_pk_mul_f32 v[122:123], v[122:123], v[130:131] op_sel:[0,0] op_sel_hi:[1,0]
    v_cvt_pk_bf16_f32 v112, v112, v113
    v_cvt_pk_bf16_f32 v113, v114, v115
    v_cvt_pk_bf16_f32 v114, v116, v117
    v_cvt_pk_bf16_f32 v115, v118, v119
    v_cvt_pk_bf16_f32 v116, v120, v121
    v_cvt_pk_bf16_f32 v117, v122, v123
    buffer_store_dwordx4 v[112:115], v60, s[12:15], s36 offen offset:768 sc0 sc1
    buffer_store_dwordx2 v[116:117], v61, s[12:15], s36 offen offset:1024 sc0 sc1
    v_accvgpr_read_b32 v64, a147
    v_accvgpr_read_b32 v65, a151
    v_accvgpr_read_b32 v66, a155
    v_accvgpr_read_b32 v67, a159
    v_accvgpr_read_b32 v68, a163
    v_accvgpr_read_b32 v69, a167
    v_accvgpr_read_b32 v70, a171
    v_accvgpr_read_b32 v71, a175
    v_accvgpr_read_b32 v72, a179
    v_accvgpr_read_b32 v73, a183
    v_accvgpr_read_b32 v74, a187
    v_accvgpr_read_b32 v75, a191
    v_pk_mul_f32 v[64:65], v[64:65], v[130:131] op_sel:[0,1] op_sel_hi:[1,1]
    v_pk_mul_f32 v[66:67], v[66:67], v[130:131] op_sel:[0,1] op_sel_hi:[1,1]
    v_pk_mul_f32 v[68:69], v[68:69], v[130:131] op_sel:[0,1] op_sel_hi:[1,1]
    v_pk_mul_f32 v[70:71], v[70:71], v[130:131] op_sel:[0,1] op_sel_hi:[1,1]
    v_pk_mul_f32 v[72:73], v[72:73], v[130:131] op_sel:[0,1] op_sel_hi:[1,1]
    v_pk_mul_f32 v[74:75], v[74:75], v[130:131] op_sel:[0,1] op_sel_hi:[1,1]
    v_cvt_pk_bf16_f32 v64, v64, v65
    v_cvt_pk_bf16_f32 v65, v66, v67
    v_cvt_pk_bf16_f32 v66, v68, v69
    v_cvt_pk_bf16_f32 v67, v70, v71
    v_cvt_pk_bf16_f32 v68, v72, v73
    v_cvt_pk_bf16_f32 v69, v74, v75
    buffer_store_dwordx4 v[64:67], v60, s[12:15], s36 offen offset:1152 sc0 sc1
    buffer_store_dwordx2 v[68:69], v61, s[12:15], s36 offen offset:1408 sc0 sc1
L_fin:
L_done:
    s_endpgm
L_pollslow0:
    s_mov_b32 s59, 200
L_pollsm0:
    s_buffer_load_dwordx8 s[48:55], s[20:23], 0 glc
    s_waitcnt lgkmcnt(0)
    s_sub_u32 s48, s48, s92
    s_sub_u32 s49, s49, s92
    s_sub_u32 s50, s50, s92
    s_sub_u32 s51, s51, s92
    s_sub_u32 s52, s52, s92
    s_sub_u32 s53, s53, s92
    s_sub_u32 s54, s54, s92
    s_sub_u32 s55, s55, s92
    s_max_u32 s48, s48, s49
    s_max_u32 s48, s48, s50
    s_max_u32 s48, s48, s51
    s_max_u32 s48, s48, s52
    s_max_u32 s48, s48, s53
    s_max_u32 s48, s48, s54
    s_max_u32 s48, s48, s55
    s_cmp_lt_u32 s48, 16
    s_cbranch_scc1 L_pollok0
    s_sub_u32 s59, s59, 1
    s_cbranch_scc1 L_pollvec0
    s_sleep 1
    s_branch L_pollsm0
L_pollvec0:
    s_sub_u32 s96, s96, 1
    s_cbranch_scc1 L_pollgiveup0
    s_sleep 2
    buffer_load_dword v52, v53, s[20:23], 0 offen sc1
    s_waitcnt vmcnt(0)
    v_subrev_u32 v52, s92, v52
    v_cmp_lt_u32 vcc, 15, v52
    s_nop 0
    s_and_b32 s59, vcc_lo, 0xff
    s_cbranch_scc1 L_pollvec0
    s_branch L_pollok0
L_pollgiveup0:
    s_mov_b32 s96, 0
    s_branch L_pollok0
L_pollslow1:
    s_mov_b32 s59, 200
L_pollsm1:
    s_buffer_load_dwordx8 s[48:55], s[20:23], 0 glc
    s_waitcnt lgkmcnt(0)
    s_sub_u32 s48, s48, s92
    s_sub_u32 s49, s49, s92
    s_sub_u32 s50, s50, s92
    s_sub_u32 s51, s51, s92
    s_sub_u32 s52, s52, s92
    s_sub_u32 s53, s53, s92
    s_sub_u32 s54, s54, s92
    s_sub_u32 s55, s55, s92
    s_max_u32 s48, s48, s49
    s_max_u32 s48, s48, s50
    s_max_u32 s48, s48, s51
    s_max_u32 s48, s48, s52
    s_max_u32 s48, s48, s53
    s_max_u32 s48, s48, s54
    s_max_u32 s48, s48, s55
    s_cmp_lt_u32 s48, 16
    s_cbranch_scc1 L_pollok1
    s_sub_u32 s59, s59, 1
    s_cbranch_scc1 L_pollvec1
    s_sleep 1
    s_branch L_pollsm1
L_pollvec1:
    s_sub_u32 s96, s96, 1
    s_cbranch_scc1 L_pollgiveup1
    s_sleep 2
    buffer_load_dword v52, v53, s[20:23], 0 offen sc1
    s_waitcnt vmcnt(0)
    v_subrev_u32 v52, s92, v52
    v_cmp_lt_u32 vcc, 15, v52
    s_nop 0
    s_and_b32 s59, vcc_lo, 0xff
    s_cbranch_scc1 L_pollvec1
    s_branch L_pollok1
L_pollgiveup1:
    s_mov_b32 s96, 0
    s_branch L_pollok1
L_pollslow2:
    s_mov_b32 s59, 200
L_pollsm2:
    s_buffer_load_dwordx8 s[48:55], s[20:23], 0 glc
    s_waitcnt lgkmcnt(0)
    s_sub_u32 s48, s48, s92
    s_sub_u32 s49, s49, s92
    s_sub_u32 s50, s50, s92
    s_sub_u32 s51, s51, s92
    s_sub_u32 s52, s52, s92
    s_sub_u32 s53, s53, s92
    s_sub_u32 s54, s54, s92
    s_sub_u32 s55, s55, s92
    s_max_u32 s48, s48, s49
    s_max_u32 s48, s48, s50
    s_max_u32 s48, s48, s51
    s_max_u32 s48, s48, s52
    s_max_u32 s48, s48, s53
    s_max_u32 s48, s48, s54
    s_max_u32 s48, s48, s55
    s_cmp_lt_u32 s48, 16
    s_cbranch_scc1 L_pollok2
    s_sub_u32 s59, s59, 1
    s_cbranch_scc1 L_pollvec2
    s_sleep 1
    s_branch L_pollsm2
L_pollvec2:
    s_sub_u32 s96, s96, 1
    s_cbranch_scc1 L_pollgiveup2
    s_sleep 2
    buffer_load_dword v52, v53, s[20:23], 0 offen sc1
    s_waitcnt vmcnt(0)
    v_subrev_u32 v52, s92, v52
    v_cmp_lt_u32 vcc, 15, v52
    s_nop 0
    s_and_b32 s59, vcc_lo, 0xff
    s_cbranch_scc1 L_pollvec2
    s_branch L_pollok2
L_pollgiveup2:
    s_mov_b32 s96, 0
    s_branch L_pollok2
L_pollslow3:
    s_mov_b32 s59, 200
L_pollsm3:
    s_buffer_load_dwordx8 s[48:55], s[20:23], 0 glc
    s_waitcnt lgkmcnt(0)
    s_sub_u32 s48, s48, s92
    s_sub_u32 s49, s49, s92
    s_sub_u32 s50, s50, s92
    s_sub_u32 s51, s51, s92
    s_sub_u32 s52, s52, s92
    s_sub_u32 s53, s53, s92
    s_sub_u32 s54, s54, s92
    s_sub_u32 s55, s55, s92
    s_max_u32 s48, s48, s49
    s_max_u32 s48, s48, s50
    s_max_u32 s48, s48, s51
    s_max_u32 s48, s48, s52
    s_max_u32 s48, s48, s53
    s_max_u32 s48, s48, s54
    s_max_u32 s48, s48, s55
    s_cmp_lt_u32 s48, 16
    s_cbranch_scc1 L_pollok3
    s_sub_u32 s59, s59, 1
    s_cbranch_scc1 L_pollvec3
    s_sleep 1
    s_branch L_pollsm3
L_pollvec3:
    s_sub_u32 s96, s96, 1
    s_cbranch_scc1 L_pollgiveup3
    s_sleep 2
    buffer_load_dword v52, v53, s[20:23], 0 offen sc1
    s_waitcnt vmcnt(0)
    v_subrev_u32 v52, s92, v52
    v_cmp_lt_u32 vcc, 15, v52
    s_nop 0
    s_and_b32 s59, vcc_lo, 0xff
    s_cbranch_scc1 L_pollvec3
    s_branch L_pollok3
L_pollgiveup3:
    s_mov_b32 s96, 0
    s_branch L_pollok3
L_pollslow4:
    s_mov_b32 s59, 200
L_pollsm4:
    s_buffer_load_dwordx8 s[48:55], s[20:23], 0 glc
    s_waitcnt lgkmcnt(0)
    s_sub_u32 s48, s48, s92
    s_sub_u32 s49, s49, s92
    s_sub_u32 s50, s50, s92
    s_sub_u32 s51, s51, s92
    s_sub_u32 s52, s52, s92
    s_sub_u32 s53, s53, s92
    s_sub_u32 s54, s54, s92
    s_sub_u32 s55, s55, s92
    s_max_u32 s48, s48, s49
    s_max_u32 s48, s48, s50
    s_max_u32 s48, s48, s51
    s_max_u32 s48, s48, s52
    s_max_u32 s48, s48, s53
    s_max_u32 s48, s48, s54
    s_max_u32 s48, s48, s55
    s_cmp_lt_u32 s48, 16
    s_cbranch_scc1 L_pollok4
    s_sub_u32 s59, s59, 1
    s_cbranch_scc1 L_pollvec4
    s_sleep 1
    s_branch L_pollsm4
L_pollvec4:
    s_sub_u32 s96, s96, 1
    s_cbranch_scc1 L_pollgiveup4
    s_sleep 2
    buffer_load_dword v52, v53, s[20:23], 0 offen sc1
    s_waitcnt vmcnt(0)
    v_subrev_u32 v52, s92, v52
    v_cmp_lt_u32 vcc, 15, v52
    s_nop 0
    s_and_b32 s59, vcc_lo, 0xff
    s_cbranch_scc1 L_pollvec4
    s_branch L_pollok4
L_pollgiveup4:
    s_mov_b32 s96, 0
    s_branch L_pollok4
L_pollslow5:
    s_mov_b32 s59, 200
L_pollsm5:
    s_buffer_load_dwordx8 s[48:55], s[20:23], 0 glc
    s_waitcnt lgkmcnt(0)
    s_sub_u32 s48, s48, s92
    s_sub_u32 s49, s49, s92
    s_sub_u32 s50, s50, s92
    s_sub_u32 s51, s51, s92
    s_sub_u32 s52, s52, s92
    s_sub_u32 s53, s53, s92
    s_sub_u32 s54, s54, s92
    s_sub_u32 s55, s55, s92
    s_max_u32 s48, s48, s49
    s_max_u32 s48, s48, s50
    s_max_u32 s48, s48, s51
    s_max_u32 s48, s48, s52
    s_max_u32 s48, s48, s53
    s_max_u32 s48, s48, s54
    s_max_u32 s48, s48, s55
    s_cmp_lt_u32 s48, 16
    s_cbranch_scc1 L_pollok5
    s_sub_u32 s59, s59, 1
    s_cbranch_scc1 L_pollvec5
    s_sleep 1
    s_branch L_pollsm5
L_pollvec5:
    s_sub_u32 s96, s96, 1
    s_cbranch_scc1 L_pollgiveup5
    s_sleep 2
    buffer_load_dword v52, v53, s[20:23], 0 offen sc1
    s_waitcnt vmcnt(0)
    v_subrev_u32 v52, s92, v52
    v_cmp_lt_u32 vcc, 15, v52
    s_nop 0
    s_and_b32 s59, vcc_lo, 0xff
    s_cbranch_scc1 L_pollvec5
    s_branch L_pollok5
L_pollgiveup5:
    s_mov_b32 s96, 0
    s_branch L_pollok5
L_pollslow6:
    s_mov_b32 s59, 200
L_pollsm6:
    s_buffer_load_dwordx8 s[48:55], s[20:23], 0 glc
    s_waitcnt lgkmcnt(0)
    s_sub_u32 s48, s48, s92
    s_sub_u32 s49, s49, s92
    s_sub_u32 s50, s50, s92
    s_sub_u32 s51, s51, s92
    s_sub_u32 s52, s52, s92
    s_sub_u32 s53, s53, s92
    s_sub_u32 s54, s54, s92
    s_sub_u32 s55, s55, s92
    s_max_u32 s48, s48, s49
    s_max_u32 s48, s48, s50
    s_max_u32 s48, s48, s51
    s_max_u32 s48, s48, s52
    s_max_u32 s48, s48, s53
    s_max_u32 s48, s48, s54
    s_max_u32 s48, s48, s55
    s_cmp_lt_u32 s48, 16
    s_cbranch_scc1 L_pollok6
    s_sub_u32 s59, s59, 1
    s_cbranch_scc1 L_pollvec6
    s_sleep 1
    s_branch L_pollsm6
L_pollvec6:
    s_sub_u32 s96, s96, 1
    s_cbranch_scc1 L_pollgiveup6
    s_sleep 2
    buffer_load_dword v52, v53, s[20:23], 0 offen sc1
    s_waitcnt vmcnt(0)
    v_subrev_u32 v52, s92, v52
    v_cmp_lt_u32 vcc, 15, v52
    s_nop 0
    s_and_b32 s59, vcc_lo, 0xff
    s_cbranch_scc1 L_pollvec6
    s_branch L_pollok6
L_pollgiveup6:
    s_mov_b32 s96, 0
    s_branch L_pollok6
L_pollslow7:
    s_mov_b32 s59, 200
L_pollsm7:
    s_buffer_load_dwordx8 s[48:55], s[20:23], 0 glc
    s_waitcnt lgkmcnt(0)
    s_sub_u32 s48, s48, s92
    s_sub_u32 s49, s49, s92
    s_sub_u32 s50, s50, s92
    s_sub_u32 s51, s51, s92
    s_sub_u32 s52, s52, s92
    s_sub_u32 s53, s53, s92
    s_sub_u32 s54, s54, s92
    s_sub_u32 s55, s55, s92
    s_max_u32 s48, s48, s49
    s_max_u32 s48, s48, s50
    s_max_u32 s48, s48, s51
    s_max_u32 s48, s48, s52
    s_max_u32 s48, s48, s53
    s_max_u32 s48, s48, s54
    s_max_u32 s48, s48, s55
    s_cmp_lt_u32 s48, 16
    s_cbranch_scc1 L_pollok7
    s_sub_u32 s59, s59, 1
    s_cbranch_scc1 L_pollvec7
    s_sleep 1
    s_branch L_pollsm7
L_pollvec7:
    s_sub_u32 s96, s96, 1
    s_cbranch_scc1 L_pollgiveup7
    s_sleep 2
    buffer_load_dword v52, v53, s[20:23], 0 offen sc1
    s_waitcnt vmcnt(0)
    v_subrev_u32 v52, s92, v52
    v_cmp_lt_u32 vcc, 15, v52
    s_nop 0
    s_and_b32 s59, vcc_lo, 0xff
    s_cbranch_scc1 L_pollvec7
    s_branch L_pollok7
L_pollgiveup7:
    s_mov_b32 s96, 0
    s_branch L_pollok7
L_pollslowP:
L_pollvecP:
    s_sub_u32 s96, s96, 1
    s_cbranch_scc1 L_pollgiveupP
    s_sleep 2
    buffer_load_dword v52, v53, s[20:23], 0 offen sc1
    s_waitcnt vmcnt(0)
    v_subrev_u32 v52, s92, v52
    v_cmp_lt_u32 vcc, 15, v52
    s_nop 0
    s_and_b32 s59, vcc_lo, 0xff
    s_cbranch_scc1 L_pollvecP
    s_branch L_pollokP
L_pollgiveupP:
    s_mov_b32 s96, 0
    s_branch L_pollokP
L_tagslow:
    s_sub_u32 s96, s96, 1
    s_cbranch_scc1 L_taggiveup
    s_sleep 2
    buffer_load_dword v52, off, s[88:91], s93 sc1
    s_waitcnt vmcnt(0)
    v_readfirstlane_b32 s92, v52
    s_nop 0
    s_cmp_eq_u32 s92, 0
    s_cbranch_scc1 L_tagslow
    s_branch L_tagok
L_taggiveup:
    s_mov_b32 s96, 0
    s_branch L_tagok
L_slow:
    s_waitcnt vmcnt(0) lgkmcnt(0)
    s_nop 15
    v_accvgpr_write_b32 a0, 0
    v_accvgpr_write_b32 a1, 0
    v_accvgpr_write_b32 a2, 0
    v_accvgpr_write_b32 a3, 0
    v_accvgpr_write_b32 a4, 0
    v_accvgpr_write_b32 a5, 0
    v_accvgpr_write_b32 a6, 0
    v_accvgpr_write_b32 a7, 0
    v_accvgpr_write_b32 a8, 0
    v_accvgpr_write_b32 a9, 0
    v_accvgpr_write_b32 a10, 0
    v_accvgpr_write_b32 a11, 0
    v_accvgpr_write_b32 a12, 0
    v_accvgpr_write_b32 a13, 0
    v_accvgpr_write_b32 a14, 0
    v_accvgpr_write_b32 a15, 0
    v_accvgpr_write_b32 a16, 0
    v_accvgpr_write_b32 a17, 0
    v_accvgpr_write_b32 a18, 0
    v_accvgpr_write_b32 a19, 0
    v_accvgpr_write_b32 a20, 0
    v_accvgpr_write_b32 a21, 0
    v_accvgpr_write_b32 a22, 0
    v_accvgpr_write_b32 a23, 0
    v_accvgpr_write_b32 a24, 0
    v_accvgpr_write_b32 a25, 0
    v_accvgpr_write_b32 a26, 0
    v_accvgpr_write_b32 a27, 0
    v_accvgpr_write_b32 a28, 0
    v_accvgpr_write_b32 a29, 0
    v_accvgpr_write_b32 a30, 0
    v_accvgpr_write_b32 a31, 0
    v_accvgpr_write_b32 a32, 0
    v_accvgpr_write_b32 a33, 0
    v_accvgpr_write_b32 a34, 0
    v_accvgpr_write_b32 a35, 0
    v_accvgpr_write_b32 a36, 0
    v_accvgpr_write_b32 a37, 0
    v_accvgpr_write_b32 a38, 0
    v_accvgpr_write_b32 a39, 0
    v_accvgpr_write_b32 a40, 0
    v_accvgpr_write_b32 a41, 0
    v_accvgpr_write_b32 a42, 0
    v_accvgpr_write_b32 a43, 0
    v_accvgpr_write_b32 a44, 0
    v_accvgpr_write_b32 a45, 0
    v_accvgpr_write_b32 a46, 0
    v_accvgpr_write_b32 a47, 0
    v_accvgpr_write_b32 a48, 0
    v_accvgpr_write_b32 a49, 0
    v_accvgpr_write_b32 a50, 0
    v_accvgpr_write_b32 a51, 0
    v_accvgpr_write_b32 a52, 0
    v_accvgpr_write_b32 a53, 0
    v_accvgpr_write_b32 a54, 0
    v_accvgpr_write_b32 a55, 0
    v_accvgpr_write_b32 a56, 0
    v_accvgpr_write_b32 a57, 0
    v_accvgpr_write_b32 a58, 0
    v_accvgpr_write_b32 a59, 0
    v_accvgpr_write_b32 a60, 0
    v_accvgpr_write_b32 a61, 0
    v_accvgpr_write_b32 a62, 0
    v_accvgpr_write_b32 a63, 0
    v_accvgpr_write_b32 a64, 0
    v_accvgpr_write_b32 a65, 0
    v_accvgpr_write_b32 a66, 0
    v_accvgpr_write_b32 a67, 0
    v_accvgpr_write_b32 a68, 0
    v_accvgpr_write_b32 a69, 0
    v_accvgpr_write_b32 a70, 0
    v_accvgpr_write_b32 a71, 0
    v_accvgpr_write_b32 a72, 0
    v_accvgpr_write_b32 a73, 0
    v_accvgpr_write_b32 a74, 0
    v_accvgpr_write_b32 a75, 0
    v_accvgpr_write_b32 a76, 0
    v_accvgpr_write_b32 a77, 0
    v_accvgpr_write_b32 a78, 0
    v_accvgpr_write_b32 a79, 0
    v_accvgpr_write_b32 a80, 0
    v_accvgpr_write_b32 a81, 0
    v_accvgpr_write_b32 a82, 0
    v_accvgpr_write_b32 a83, 0
    v_accvgpr_write_b32 a84, 0
    v_accvgpr_write_b32 a85, 0
    v_accvgpr_write_b32 a86, 0
    v_accvgpr_write_b32 a87, 0
    v_accvgpr_write_b32 a88, 0
    v_accvgpr_write_b32 a89, 0
    v_accvgpr_write_b32 a90, 0
    v_accvgpr_write_b32 a91, 0
    v_accvgpr_write_b32 a92, 0
    v_accvgpr_write_b32 a93, 0
    v_accvgpr_write_b32 a94, 0
    v_accvgpr_write_b32 a95, 0
    v_accvgpr_write_b32 a96, 0
    v_accvgpr_write_b32 a97, 0
    v_accvgpr_write_b32 a98, 0
    v_accvgpr_write_b32 a99, 0
    v_accvgpr_write_b32 a100, 0
    v_accvgpr_write_b32 a101, 0
    v_accvgpr_write_b32 a102, 0
    v_accvgpr_write_b32 a103, 0
    v_accvgpr_write_b32 a104, 0
    v_accvgpr_write_b32 a105, 0
    v_accvgpr_write_b32 a106, 0
    v_accvgpr_write_b32 a107, 0
    v_accvgpr_write_b32 a108, 0
    v_accvgpr_write_b32 a109, 0
    v_accvgpr_write_b32 a110, 0
    v_accvgpr_write_b32 a111, 0
    v_accvgpr_write_b32 a112, 0
    v_accvgpr_write_b32 a113, 0
    v_accvgpr_write_b32 a114, 0
    v_accvgpr_write_b32 a115, 0
    v_accvgpr_write_b32 a116, 0
    v_accvgpr_write_b32 a117, 0
    v_accvgpr_write_b32 a118, 0
    v_accvgpr_write_b32 a119, 0
    v_accvgpr_write_b32 a120, 0
    v_accvgpr_write_b32 a121, 0
    v_accvgpr_write_b32 a122, 0
    v_accvgpr_write_b32 a123, 0
    v_accvgpr_write_b32 a124, 0
    v_accvgpr_write_b32 a125, 0
    v_accvgpr_write_b32 a126, 0
    v_accvgpr_write_b32 a127, 0
    v_accvgpr_write_b32 a128, 0
    v_accvgpr_write_b32 a129, 0
    v_accvgpr_write_b32 a130, 0
    v_accvgpr_write_b32 a131, 0
    v_accvgpr_write_b32 a132, 0
    v_accvgpr_write_b32 a133, 0
    v_accvgpr_write_b32 a134, 0
    v_accvgpr_write_b32 a135, 0
    v_accvgpr_write_b32 a136, 0
    v_accvgpr_write_b32 a137, 0
    v_accvgpr_write_b32 a138, 0
    v_accvgpr_write_b32 a139, 0
    v_accvgpr_write_b32 a140, 0
    v_accvgpr_write_b32 a141, 0
    v_accvgpr_write_b32 a142, 0
    v_accvgpr_write_b32 a143, 0
    v_accvgpr_write_b32 a144, 0
    v_accvgpr_write_b32 a145, 0
    v_accvgpr_write_b32 a146, 0
    v_accvgpr_write_b32 a147, 0
    v_accvgpr_write_b32 a148, 0
    v_accvgpr_write_b32 a149, 0
    v_accvgpr_write_b32 a150, 0
    v_accvgpr_write_b32 a151, 0
    v_accvgpr_write_b32 a152, 0
    v_accvgpr_write_b32 a153, 0
    v_accvgpr_write_b32 a154, 0
    v_accvgpr_write_b32 a155, 0
    v_accvgpr_write_b32 a156, 0
    v_accvgpr_write_b32 a157, 0
    v_accvgpr_write_b32 a158, 0
    v_accvgpr_write_b32 a159, 0
    v_accvgpr_write_b32 a160, 0
    v_accvgpr_write_b32 a161, 0
    v_accvgpr_write_b32 a162, 0
    v_accvgpr_write_b32 a163, 0
    v_accvgpr_write_b32 a164, 0
    v_accvgpr_write_b32 a165, 0
    v_accvgpr_write_b32 a166, 0
    v_accvgpr_write_b32 a167, 0
    v_accvgpr_write_b32 a168, 0
    v_accvgpr_write_b32 a169, 0
    v_accvgpr_write_b32 a170, 0
    v_accvgpr_write_b32 a171, 0
    v_accvgpr_write_b32 a172, 0
    v_accvgpr_write_b32 a173, 0
    v_accvgpr_write_b32 a174, 0
    v_accvgpr_write_b32 a175, 0
    v_accvgpr_write_b32 a176, 0
    v_accvgpr_write_b32 a177, 0
    v_accvgpr_write_b32 a178, 0
    v_accvgpr_write_b32 a179, 0
    v_accvgpr_write_b32 a180, 0
    v_accvgpr_write_b32 a181, 0
    v_accvgpr_write_b32 a182, 0
    v_accvgpr_write_b32 a183, 0
    v_accvgpr_write_b32 a184, 0
    v_accvgpr_write_b32 a185, 0
    v_accvgpr_write_b32 a186, 0
    v_accvgpr_write_b32 a187, 0
    v_accvgpr_write_b32 a188, 0
    v_accvgpr_write_b32 a189, 0
    v_accvgpr_write_b32 a190, 0
    v_accvgpr_write_b32 a191, 0
    v_mov_b32 v5, 0
    v_mov_b32 v240, 0xff7fffff
    v_mov_b32 v6, 0
    v_mov_b32 v241, 0xff7fffff
    v_mov_b32 v7, 0
    v_mov_b32 v242, 0xff7fffff
    v_mov_b32 v8, 0
    v_mov_b32 v243, 0xff7fffff
    v_subrev_u32 v244, s28, v2
    v_subrev_u32 v245, s28, v3
    v_subrev_u32 v246, s30, v1
    v_subrev_u32 v247, s30, v21
    v_subrev_u32 v248, s30, v22
    s_mov_b32 s48, 0
L_slowloop:
    s_add_u32 s49, s48, 6144
    s_add_u32 s50, s48, 12288
    buffer_load_dwordx4 v[64:67], v244, s[4:7], s48 offen offset:0 sc1
    buffer_load_dwordx4 v[68:71], v245, s[4:7], s48 offen offset:0 sc1
    buffer_load_dwordx4 v[72:75], v244, s[4:7], s49 offen offset:0 sc1
    buffer_load_dwordx4 v[76:79], v245, s[4:7], s49 offen offset:0 sc1
    buffer_load_dwordx4 v[80:83], v244, s[4:7], s48 offen offset:128 sc1
    buffer_load_dwordx4 v[84:87], v245, s[4:7], s48 offen offset:128 sc1
    buffer_load_dwordx4 v[88:91], v244, s[4:7], s49 offen offset:128 sc1
    buffer_load_dwordx4 v[92:95], v245, s[4:7], s49 offen offset:128 sc1
    buffer_load_dwordx4 v[96:99], v244, s[4:7], s48 offen offset:256 sc1
    buffer_load_dwordx4 v[100:103], v245, s[4:7], s48 offen offset:256 sc1
    buffer_load_dwordx4 v[104:107], v244, s[4:7], s49 offen offset:256 sc1
    buffer_load_dwordx4 v[108:111], v245, s[4:7], s49 offen offset:256 sc1
    buffer_load_dwordx4 v[112:115], v246, s[4:7], s50 offen offset:0 sc1
    buffer_load_dwordx4 v[116:119], v246, s[4:7], s50 offen offset:768 sc1
    buffer_load_dwordx4 v[120:123], v246, s[4:7], s50 offen offset:1536 sc1
    buffer_load_dwordx4 v[124:127], v246, s[4:7], s50 offen offset:2304 sc1
    buffer_load_dwordx4 v[128:131], v247, s[4:7], s50 offen offset:0 sc1
    buffer_load_dwordx4 v[132:135], v247, s[4:7], s50 offen offset:768 sc1
    buffer_load_dwordx4 v[136:139], v247, s[4:7], s50 offen offset:1536 sc1
    buffer_load_dwordx4 v[140:143], v247, s[4:7], s50 offen offset:2304 sc1
    buffer_load_dwordx4 v[144:147], v248, s[4:7], s50 offen offset:0 sc1
    buffer_load_dwordx4 v[148:151], v248, s[4:7], s50 offen offset:768 sc1
    buffer_load_dwordx4 v[152:155], v248, s[4:7], s50 offen offset:1536 sc1
    buffer_load_dwordx4 v[156:159], v248, s[4:7], s50 offen offset:2304 sc1
    s_waitcnt vmcnt(12)
    v_mfma_f32_16x16x32_bf16 v[160:163], v[64:67], a[192:195], 0
    v_mfma_f32_16x16x32_bf16 v[168:171], v[64:67], a[216:219], 0
    v_mfma_f32_16x16x32_bf16 v[176:179], v[64:67], a[240:243], 0
    v_mfma_f32_16x16x32_bf16 v[184:187], v[64:67], v[200:203], 0
    v_mfma_f32_16x16x32_bf16 v[160:163], v[68:71], a[196:199], v[160:163]
    v_mfma_f32_16x16x32_bf16 v[168:171], v[68:71], a[220:223], v[168:171]
    v_mfma_f32_16x16x32_bf16 v[176:179], v[68:71], a[244:247], v[176:179]
    v_mfma_f32_16x16x32_bf16 v[184:187], v[68:71], v[204:207], v[184:187]
    v_mfma_f32_16x16x32_bf16 v[164:167], v[72:75], a[192:195], 0
    v_mfma_f32_16x16x32_bf16 v[172:175], v[72:75], a[216:219], 0
    v_mfma_f32_16x16x32_bf16 v[180:183], v[72:75], a[240:243], 0
    v_mfma_f32_16x16x32_bf16 v[188:191], v[72:75], v[200:203], 0
    v_mfma_f32_16x16x32_bf16 v[164:167], v[76:79], a[196:199], v[164:167]
    v_mfma_f32_16x16x32_bf16 v[172:175], v[76:79], a[220:223], v[172:175]
    v_mfma_f32_16x16x32_bf16 v[180:183], v[76:79], a[244:247], v[180:183]
    v_mfma_f32_16x16x32_bf16 v[188:191], v[76:79], v[204:207], v[188:191]
    v_mfma_f32_16x16x32_bf16 v[160:163], v[80:83], a[200:203], v[160:163]
    v_mfma_f32_16x16x32_bf16 v[168:171], v[80:83], a[224:227], v[168:171]
    v_mfma_f32_16x16x32_bf16 v[176:179], v[80:83], a[248:251], v[176:179]
    v_mfma_f32_16x16x32_bf16 v[184:187], v[80:83], v[208:211], v[184:187]
    v_mfma_f32_16x16x32_bf16 v[160:163], v[84:87], a[204:207], v[160:163]
    v_mfma_f32_16x16x32_bf16 v[168:171], v[84:87], a[228:231], v[168:171]
    v_mfma_f32_16x16x32_bf16 v[176:179], v[84:87], a[252:255], v[176:179]
    v_mfma_f32_16x16x32_bf16 v[184:187], v[84:87], v[212:215], v[184:187]
    v_mfma_f32_16x16x32_bf16 v[164:167], v[88:91], a[200:203], v[164:167]
    v_mfma_f32_16x16x32_bf16 v[172:175], v[88:91], a[224:227], v[172:175]
    v_mfma_f32_16x16x32_bf16 v[180:183], v[88:91], a[248:251], v[180:183]
    v_mfma_f32_16x16x32_bf16 v[188:191], v[88:91], v[208:211], v[188:191]
    v_mfma_f32_16x16x32_bf16 v[164:167], v[92:95], a[204:207], v[164:167]
    v_mfma_f32_16x16x32_bf16 v[172:175], v[92:95], a[228:231], v[172:175]
    v_mfma_f32_16x16x32_bf16 v[180:183], v[92:95], a[252:255], v[180:183]
    v_mfma_f32_16x16x32_bf16 v[188:191], v[92:95], v[212:215], v[188:191]
    v_mfma_f32_16x16x32_bf16 v[160:163], v[96:99], a[208:211], v[160:163]
    v_mfma_f32_16x16x32_bf16 v[168:171], v[96:99], a[232:235], v[168:171]
    v_mfma_f32_16x16x32_bf16 v[176:179], v[96:99], v[192:195], v[176:179]
    v_mfma_f32_16x16x32_bf16 v[184:187], v[96:99], v[216:219], v[184:187]
    v_mfma_f32_16x16x32_bf16 v[160:163], v[100:103], a[212:215], v[160:163]
    v_mfma_f32_16x16x32_bf16 v[168:171], v[100:103], a[236:239], v[168:171]
    v_mfma_f32_16x16x32_bf16 v[176:179], v[100:103], v[196:199], v[176:179]
    v_mfma_f32_16x16x32_bf16 v[184:187], v[100:103], v[220:223], v[184:187]
    v_mfma_f32_16x16x32_bf16 v[164:167], v[104:107], a[208:211], v[164:167]
    v_mfma_f32_16x16x32_bf16 v[172:175], v[104:107], a[232:235], v[172:175]
    v_mfma_f32_16x16x32_bf16 v[180:183], v[104:107], v[192:195], v[180:183]
    v_mfma_f32_16x16x32_bf16 v[188:191], v[104:107], v[216:219], v[188:191]
    v_mfma_f32_16x16x32_bf16 v[164:167], v[108:111], a[212:215], v[164:167]
    v_mfma_f32_16x16x32_bf16 v[172:175], v[108:111], a[236:239], v[172:175]
    v_mfma_f32_16x16x32_bf16 v[180:183], v[108:111], v[196:199], v[180:183]
    v_mfma_f32_16x16x32_bf16 v[188:191], v[108:111], v[220:223], v[188:191]
    s_nop 9
    v_max3_f32 v16, v160, v161, v162
    v_max3_f32 v16, v16, v163, v164
    v_max3_f32 v16, v16, v165, v166
    v_max3_f32 v16, v16, v167, v240
    v_mov_b32 v17, v16
    s_nop 1
    v_permlane16_swap_b32 v16, v17
    s_nop 1
    v_max_f32 v16, v16, v17
    v_mov_b32 v17, v16
    s_nop 1
    v_permlane32_swap_b32 v16, v17
    s_nop 1
    v_max_f32 v16, v16, v17
    v_sub_f32 v17, v240, v16
    v_exp_f32 v17, v17
    v_mov_b32 v240, v16
    ds_bpermute_b32 v250, v62, v17 offset:0
    ds_bpermute_b32 v251, v62, v17 offset:4
    ds_bpermute_b32 v252, v62, v17 offset:8
    ds_bpermute_b32 v253, v62, v17 offset:12
    v_sub_f32 v160, v160, v16
    v_sub_f32 v161, v161, v16
    v_sub_f32 v162, v162, v16
    v_sub_f32 v163, v163, v16
    v_sub_f32 v164, v164, v16
    v_sub_f32 v165, v165, v16
    v_sub_f32 v166, v166, v16
    v_sub_f32 v167, v167, v16
    v_exp_f32 v160, v160
    v_exp_f32 v161, v161
    v_exp_f32 v162, v162
    v_exp_f32 v163, v163
    v_exp_f32 v164, v164
    v_exp_f32 v165, v165
    v_exp_f32 v166, v166
    v_exp_f32 v167, v167
    v_mul_f32 v5, v5, v17
    v_add_f32 v5, v5, v160
    v_add_f32 v5, v5, v161
    v_add_f32 v5, v5, v162
    v_add_f32 v5, v5, v163
    v_add_f32 v5, v5, v164
    v_add_f32 v5, v5, v165
    v_add_f32 v5, v5, v166
    v_add_f32 v5, v5, v167
    v_cvt_pk_bf16_f32 v224, v160, v161
    v_cvt_pk_bf16_f32 v225, v162, v163
    v_cvt_pk_bf16_f32 v226, v164, v165
    v_cvt_pk_bf16_f32 v227, v166, v167
    s_waitcnt lgkmcnt(0)
    v_accvgpr_read_b32 v18, a0
    v_mul_f32 v18, v18, v250
    v_accvgpr_write_b32 a0, v18
    v_accvgpr_read_b32 v19, a1
    v_mul_f32 v19, v19, v251
    v_accvgpr_write_b32 a1, v19
    v_accvgpr_read_b32 v18, a2
    v_mul_f32 v18, v18, v252
    v_accvgpr_write_b32 a2, v18
    v_accvgpr_read_b32 v19, a3
    v_mul_f32 v19, v19, v253
    v_accvgpr_write_b32 a3, v19
    v_accvgpr_read_b32 v18, a4
    v_mul_f32 v18, v18, v250
    v_accvgpr_write_b32 a4, v18
    v_accvgpr_read_b32 v19, a5
    v_mul_f32 v19, v19, v251
    v_accvgpr_write_b32 a5, v19
    v_accvgpr_read_b32 v18, a6
    v_mul_f32 v18, v18, v252
    v_accvgpr_write_b32 a6, v18
    v_accvgpr_read_b32 v19, a7
    v_mul_f32 v19, v19, v253
    v_accvgpr_write_b32 a7, v19
    v_accvgpr_read_b32 v18, a8
    v_mul_f32 v18, v18, v250
    v_accvgpr_write_b32 a8, v18
    v_accvgpr_read_b32 v19, a9
    v_mul_f32 v19, v19, v251
    v_accvgpr_write_b32 a9, v19
    v_accvgpr_read_b32 v18, a10
    v_mul_f32 v18, v18, v252
    v_accvgpr_write_b32 a10, v18
    v_accvgpr_read_b32 v19, a11
    v_mul_f32 v19, v19, v253
    v_accvgpr_write_b32 a11, v19
    v_accvgpr_read_b32 v18, a12
    v_mul_f32 v18, v18, v250
    v_accvgpr_write_b32 a12, v18
    v_accvgpr_read_b32 v19, a13
    v_mul_f32 v19, v19, v251
    v_accvgpr_write_b32 a13, v19
    v_accvgpr_read_b32 v18, a14
    v_mul_f32 v18, v18, v252
    v_accvgpr_write_b32 a14, v18
    v_accvgpr_read_b32 v19, a15
    v_mul_f32 v19, v19, v253
    v_accvgpr_write_b32 a15, v19
    v_accvgpr_read_b32 v18, a16
    v_mul_f32 v18, v18, v250
    v_accvgpr_write_b32 a16, v18
    v_accvgpr_read_b32 v19, a17
    v_mul_f32 v19, v19, v251
    v_accvgpr_write_b32 a17, v19
    v_accvgpr_read_b32 v18, a18
    v_mul_f32 v18, v18, v252
    v_accvgpr_write_b32 a18, v18
    v_accvgpr_read_b32 v19, a19
    v_mul_f32 v19, v19, v253
    v_accvgpr_write_b32 a19, v19
    v_accvgpr_read_b32 v18, a20
    v_mul_f32 v18, v18, v250
    v_accvgpr_write_b32 a20, v18
    v_accvgpr_read_b32 v19, a21
    v_mul_f32 v19, v19, v251
    v_accvgpr_write_b32 a21, v19
    v_accvgpr_read_b32 v18, a22
    v_mul_f32 v18, v18, v252
    v_accvgpr_write_b32 a22, v18
    v_accvgpr_read_b32 v19, a23
    v_mul_f32 v19, v19, v253
    v_accvgpr_write_b32 a23, v19
    v_accvgpr_read_b32 v18, a24
    v_mul_f32 v18, v18, v250
    v_accvgpr_write_b32 a24, v18
    v_accvgpr_read_b32 v19, a25
    v_mul_f32 v19, v19, v251
    v_accvgpr_write_b32 a25, v19
    v_accvgpr_read_b32 v18, a26
    v_mul_f32 v18, v18, v252
    v_accvgpr_write_b32 a26, v18
    v_accvgpr_read_b32 v19, a27
    v_mul_f32 v19, v19, v253
    v_accvgpr_write_b32 a27, v19
    v_accvgpr_read_b32 v18, a28
    v_mul_f32 v18, v18, v250
    v_accvgpr_write_b32 a28, v18
    v_accvgpr_read_b32 v19, a29
    v_mul_f32 v19, v19, v251
    v_accvgpr_write_b32 a29, v19
    v_accvgpr_read_b32 v18, a30
    v_mul_f32 v18, v18, v252
    v_accvgpr_write_b32 a30, v18
    v_accvgpr_read_b32 v19, a31
    v_mul_f32 v19, v19, v253
    v_accvgpr_write_b32 a31, v19
    v_accvgpr_read_b32 v18, a32
    v_mul_f32 v18, v18, v250
    v_accvgpr_write_b32 a32, v18
    v_accvgpr_read_b32 v19, a33
    v_mul_f32 v19, v19, v251
    v_accvgpr_write_b32 a33, v19
    v_accvgpr_read_b32 v18, a34
    v_mul_f32 v18, v18, v252
    v_accvgpr_write_b32 a34, v18
    v_accvgpr_read_b32 v19, a35
    v_mul_f32 v19, v19, v253
    v_accvgpr_write_b32 a35, v19
    v_accvgpr_read_b32 v18, a36
    v_mul_f32 v18, v18, v250
    v_accvgpr_write_b32 a36, v18
    v_accvgpr_read_b32 v19, a37
    v_mul_f32 v19, v19, v251
    v_accvgpr_write_b32 a37, v19
    v_accvgpr_read_b32 v18, a38
    v_mul_f32 v18, v18, v252
    v_accvgpr_write_b32 a38, v18
    v_accvgpr_read_b32 v19, a39
    v_mul_f32 v19, v19, v253
    v_accvgpr_write_b32 a39, v19
    v_accvgpr_read_b32 v18, a40
    v_mul_f32 v18, v18, v250
    v_accvgpr_write_b32 a40, v18
    v_accvgpr_read_b32 v19, a41
    v_mul_f32 v19, v19, v251
    v_accvgpr_write_b32 a41, v19
    v_accvgpr_read_b32 v18, a42
    v_mul_f32 v18, v18, v252
    v_accvgpr_write_b32 a42, v18
    v_accvgpr_read_b32 v19, a43
    v_mul_f32 v19, v19, v253
    v_accvgpr_write_b32 a43, v19
    v_accvgpr_read_b32 v18, a44
    v_mul_f32 v18, v18, v250
    v_accvgpr_write_b32 a44, v18
    v_accvgpr_read_b32 v19, a45
    v_mul_f32 v19, v19, v251
    v_accvgpr_write_b32 a45, v19
    v_accvgpr_read_b32 v18, a46
    v_mul_f32 v18, v18, v252
    v_accvgpr_write_b32 a46, v18
    v_accvgpr_read_b32 v19, a47
    v_mul_f32 v19, v19, v253
    v_accvgpr_write_b32 a47, v19
    v_max3_f32 v16, v168, v169, v170
    v_max3_f32 v16, v16, v171, v172
    v_max3_f32 v16, v16, v173, v174
    v_max3_f32 v16, v16, v175, v241
    v_mov_b32 v17, v16
    s_nop 1
    v_permlane16_swap_b32 v16, v17
    s_nop 1
    v_max_f32 v16, v16, v17
    v_mov_b32 v17, v16
    s_nop 1
    v_permlane32_swap_b32 v16, v17
    s_nop 1
    v_max_f32 v16, v16, v17
    v_sub_f32 v17, v241, v16
    v_exp_f32 v17, v17
    v_mov_b32 v241, v16
    ds_bpermute_b32 v250, v62, v17 offset:0
    ds_bpermute_b32 v251, v62, v17 offset:4
    ds_bpermute_b32 v252, v62, v17 offset:8
    ds_bpermute_b32 v253, v62, v17 offset:12
    v_sub_f32 v168, v168, v16
    v_sub_f32 v169, v169, v16
    v_sub_f32 v170, v170, v16
    v_sub_f32 v171, v171, v16
    v_sub_f32 v172, v172, v16
    v_sub_f32 v173, v173, v16
    v_sub_f32 v174, v174, v16
    v_sub_f32 v175, v175, v16
    v_exp_f32 v168, v168
    v_exp_f32 v169, v169
    v_exp_f32 v170, v170
    v_exp_f32 v171, v171
    v_exp_f32 v172, v172
    v_exp_f32 v173, v173
    v_exp_f32 v174, v174
    v_exp_f32 v175, v175
    v_mul_f32 v6, v6, v17
    v_add_f32 v6, v6, v168
    v_add_f32 v6, v6, v169
    v_add_f32 v6, v6, v170
    v_add_f32 v6, v6, v171
    v_add_f32 v6, v6, v172
    v_add_f32 v6, v6, v173
    v_add_f32 v6, v6, v174
    v_add_f32 v6, v6, v175
    v_cvt_pk_bf16_f32 v228, v168, v169
    v_cvt_pk_bf16_f32 v229, v170, v171
    v_cvt_pk_bf16_f32 v230, v172, v173
    v_cvt_pk_bf16_f32 v231, v174, v175
    s_waitcnt lgkmcnt(0)
    v_accvgpr_read_b32 v18, a48
    v_mul_f32 v18, v18, v250
    v_accvgpr_write_b32 a48, v18
    v_accvgpr_read_b32 v19, a49
    v_mul_f32 v19, v19, v251
    v_accvgpr_write_b32 a49, v19
    v_accvgpr_read_b32 v18, a50
    v_mul_f32 v18, v18, v252
    v_accvgpr_write_b32 a50, v18
    v_accvgpr_read_b32 v19, a51
    v_mul_f32 v19, v19, v253
    v_accvgpr_write_b32 a51, v19
    v_accvgpr_read_b32 v18, a52
    v_mul_f32 v18, v18, v250
    v_accvgpr_write_b32 a52, v18
    v_accvgpr_read_b32 v19, a53
    v_mul_f32 v19, v19, v251
    v_accvgpr_write_b32 a53, v19
    v_accvgpr_read_b32 v18, a54
    v_mul_f32 v18, v18, v252
    v_accvgpr_write_b32 a54, v18
    v_accvgpr_read_b32 v19, a55
    v_mul_f32 v19, v19, v253
    v_accvgpr_write_b32 a55, v19
    v_accvgpr_read_b32 v18, a56
    v_mul_f32 v18, v18, v250
    v_accvgpr_write_b32 a56, v18
    v_accvgpr_read_b32 v19, a57
    v_mul_f32 v19, v19, v251
    v_accvgpr_write_b32 a57, v19
    v_accvgpr_read_b32 v18, a58
    v_mul_f32 v18, v18, v252
    v_accvgpr_write_b32 a58, v18
    v_accvgpr_read_b32 v19, a59
    v_mul_f32 v19, v19, v253
    v_accvgpr_write_b32 a59, v19
    v_accvgpr_read_b32 v18, a60
    v_mul_f32 v18, v18, v250
    v_accvgpr_write_b32 a60, v18
    v_accvgpr_read_b32 v19, a61
    v_mul_f32 v19, v19, v251
    v_accvgpr_write_b32 a61, v19
    v_accvgpr_read_b32 v18, a62
    v_mul_f32 v18, v18, v252
    v_accvgpr_write_b32 a62, v18
    v_accvgpr_read_b32 v19, a63
    v_mul_f32 v19, v19, v253
    v_accvgpr_write_b32 a63, v19
    v_accvgpr_read_b32 v18, a64
    v_mul_f32 v18, v18, v250
    v_accvgpr_write_b32 a64, v18
    v_accvgpr_read_b32 v19, a65
    v_mul_f32 v19, v19, v251
    v_accvgpr_write_b32 a65, v19
    v_accvgpr_read_b32 v18, a66
    v_mul_f32 v18, v18, v252
    v_accvgpr_write_b32 a66, v18
    v_accvgpr_read_b32 v19, a67
    v_mul_f32 v19, v19, v253
    v_accvgpr_write_b32 a67, v19
    v_accvgpr_read_b32 v18, a68
    v_mul_f32 v18, v18, v250
    v_accvgpr_write_b32 a68, v18
    v_accvgpr_read_b32 v19, a69
    v_mul_f32 v19, v19, v251
    v_accvgpr_write_b32 a69, v19
    v_accvgpr_read_b32 v18, a70
    v_mul_f32 v18, v18, v252
    v_accvgpr_write_b32 a70, v18
    v_accvgpr_read_b32 v19, a71
    v_mul_f32 v19, v19, v253
    v_accvgpr_write_b32 a71, v19
    v_accvgpr_read_b32 v18, a72
    v_mul_f32 v18, v18, v250
    v_accvgpr_write_b32 a72, v18
    v_accvgpr_read_b32 v19, a73
    v_mul_f32 v19, v19, v251
    v_accvgpr_write_b32 a73, v19
    v_accvgpr_read_b32 v18, a74
    v_mul_f32 v18, v18, v252
    v_accvgpr_write_b32 a74, v18
    v_accvgpr_read_b32 v19, a75
    v_mul_f32 v19, v19, v253
    v_accvgpr_write_b32 a75, v19
    v_accvgpr_read_b32 v18, a76
    v_mul_f32 v18, v18, v250
    v_accvgpr_write_b32 a76, v18
    v_accvgpr_read_b32 v19, a77
    v_mul_f32 v19, v19, v251
    v_accvgpr_write_b32 a77, v19
    v_accvgpr_read_b32 v18, a78
    v_mul_f32 v18, v18, v252
    v_accvgpr_write_b32 a78, v18
    v_accvgpr_read_b32 v19, a79
    v_mul_f32 v19, v19, v253
    v_accvgpr_write_b32 a79, v19
    v_accvgpr_read_b32 v18, a80
    v_mul_f32 v18, v18, v250
    v_accvgpr_write_b32 a80, v18
    v_accvgpr_read_b32 v19, a81
    v_mul_f32 v19, v19, v251
    v_accvgpr_write_b32 a81, v19
    v_accvgpr_read_b32 v18, a82
    v_mul_f32 v18, v18, v252
    v_accvgpr_write_b32 a82, v18
    v_accvgpr_read_b32 v19, a83
    v_mul_f32 v19, v19, v253
    v_accvgpr_write_b32 a83, v19
    v_accvgpr_read_b32 v18, a84
    v_mul_f32 v18, v18, v250
    v_accvgpr_write_b32 a84, v18
    v_accvgpr_read_b32 v19, a85
    v_mul_f32 v19, v19, v251
    v_accvgpr_write_b32 a85, v19
    v_accvgpr_read_b32 v18, a86
    v_mul_f32 v18, v18, v252
    v_accvgpr_write_b32 a86, v18
    v_accvgpr_read_b32 v19, a87
    v_mul_f32 v19, v19, v253
    v_accvgpr_write_b32 a87, v19
    v_accvgpr_read_b32 v18, a88
    v_mul_f32 v18, v18, v250
    v_accvgpr_write_b32 a88, v18
    v_accvgpr_read_b32 v19, a89
    v_mul_f32 v19, v19, v251
    v_accvgpr_write_b32 a89, v19
    v_accvgpr_read_b32 v18, a90
    v_mul_f32 v18, v18, v252
    v_accvgpr_write_b32 a90, v18
    v_accvgpr_read_b32 v19, a91
    v_mul_f32 v19, v19, v253
    v_accvgpr_write_b32 a91, v19
    v_accvgpr_read_b32 v18, a92
    v_mul_f32 v18, v18, v250
    v_accvgpr_write_b32 a92, v18
    v_accvgpr_read_b32 v19, a93
    v_mul_f32 v19, v19, v251
    v_accvgpr_write_b32 a93, v19
    v_accvgpr_read_b32 v18, a94
    v_mul_f32 v18, v18, v252
    v_accvgpr_write_b32 a94, v18
    v_accvgpr_read_b32 v19, a95
    v_mul_f32 v19, v19, v253
    v_accvgpr_write_b32 a95, v19
    v_max3_f32 v16, v176, v177, v178
    v_max3_f32 v16, v16, v179, v180
    v_max3_f32 v16, v16, v181, v182
    v_max3_f32 v16, v16, v183, v242
    v_mov_b32 v17, v16
    s_nop 1
    v_permlane16_swap_b32 v16, v17
    s_nop 1
    v_max_f32 v16, v16, v17
    v_mov_b32 v17, v16
    s_nop 1
    v_permlane32_swap_b32 v16, v17
    s_nop 1
    v_max_f32 v16, v16, v17
    v_sub_f32 v17, v242, v16
    v_exp_f32 v17, v17
    v_mov_b32 v242, v16
    ds_bpermute_b32 v250, v62, v17 offset:0
    ds_bpermute_b32 v251, v62, v17 offset:4
    ds_bpermute_b32 v252, v62, v17 offset:8
    ds_bpermute_b32 v253, v62, v17 offset:12
    v_sub_f32 v176, v176, v16
    v_sub_f32 v177, v177, v16
    v_sub_f32 v178, v178, v16
    v_sub_f32 v179, v179, v16
    v_sub_f32 v180, v180, v16
    v_sub_f32 v181, v181, v16
    v_sub_f32 v182, v182, v16
    v_sub_f32 v183, v183, v16
    v_exp_f32 v176, v176
    v_exp_f32 v177, v177
    v_exp_f32 v178, v178
    v_exp_f32 v179, v179
    v_exp_f32 v180, v180
    v_exp_f32 v181, v181
    v_exp_f32 v182, v182
    v_exp_f32 v183, v183
    v_mul_f32 v7, v7, v17
    v_add_f32 v7, v7, v176
    v_add_f32 v7, v7, v177
    v_add_f32 v7, v7, v178
    v_add_f32 v7, v7, v179
    v_add_f32 v7, v7, v180
    v_add_f32 v7, v7, v181
    v_add_f32 v7, v7, v182
    v_add_f32 v7, v7, v183
    v_cvt_pk_bf16_f32 v232, v176, v177
    v_cvt_pk_bf16_f32 v233, v178, v179
    v_cvt_pk_bf16_f32 v234, v180, v181
    v_cvt_pk_bf16_f32 v235, v182, v183
    s_waitcnt lgkmcnt(0)
    v_accvgpr_read_b32 v18, a96
    v_mul_f32 v18, v18, v250
    v_accvgpr_write_b32 a96, v18
    v_accvgpr_read_b32 v19, a97
    v_mul_f32 v19, v19, v251
    v_accvgpr_write_b32 a97, v19
    v_accvgpr_read_b32 v18, a98
    v_mul_f32 v18, v18, v252
    v_accvgpr_write_b32 a98, v18
    v_accvgpr_read_b32 v19, a99
    v_mul_f32 v19, v19, v253
    v_accvgpr_write_b32 a99, v19
    v_accvgpr_read_b32 v18, a100
    v_mul_f32 v18, v18, v250
    v_accvgpr_write_b32 a100, v18
    v_accvgpr_read_b32 v19, a101
    v_mul_f32 v19, v19, v251
    v_accvgpr_write_b32 a101, v19
    v_accvgpr_read_b32 v18, a102
    v_mul_f32 v18, v18, v252
    v_accvgpr_write_b32 a102, v18
    v_accvgpr_read_b32 v19, a103
    v_mul_f32 v19, v19, v253
    v_accvgpr_write_b32 a103, v19
    v_accvgpr_read_b32 v18, a104
    v_mul_f32 v18, v18, v250
    v_accvgpr_write_b32 a104, v18
    v_accvgpr_read_b32 v19, a105
    v_mul_f32 v19, v19, v251
    v_accvgpr_write_b32 a105, v19
    v_accvgpr_read_b32 v18, a106
    v_mul_f32 v18, v18, v252
    v_accvgpr_write_b32 a106, v18
    v_accvgpr_read_b32 v19, a107
    v_mul_f32 v19, v19, v253
    v_accvgpr_write_b32 a107, v19
    v_accvgpr_read_b32 v18, a108
    v_mul_f32 v18, v18, v250
    v_accvgpr_write_b32 a108, v18
    v_accvgpr_read_b32 v19, a109
    v_mul_f32 v19, v19, v251
    v_accvgpr_write_b32 a109, v19
    v_accvgpr_read_b32 v18, a110
    v_mul_f32 v18, v18, v252
    v_accvgpr_write_b32 a110, v18
    v_accvgpr_read_b32 v19, a111
    v_mul_f32 v19, v19, v253
    v_accvgpr_write_b32 a111, v19
    v_accvgpr_read_b32 v18, a112
    v_mul_f32 v18, v18, v250
    v_accvgpr_write_b32 a112, v18
    v_accvgpr_read_b32 v19, a113
    v_mul_f32 v19, v19, v251
    v_accvgpr_write_b32 a113, v19
    v_accvgpr_read_b32 v18, a114
    v_mul_f32 v18, v18, v252
    v_accvgpr_write_b32 a114, v18
    v_accvgpr_read_b32 v19, a115
    v_mul_f32 v19, v19, v253
    v_accvgpr_write_b32 a115, v19
    v_accvgpr_read_b32 v18, a116
    v_mul_f32 v18, v18, v250
    v_accvgpr_write_b32 a116, v18
    v_accvgpr_read_b32 v19, a117
    v_mul_f32 v19, v19, v251
    v_accvgpr_write_b32 a117, v19
    v_accvgpr_read_b32 v18, a118
    v_mul_f32 v18, v18, v252
    v_accvgpr_write_b32 a118, v18
    v_accvgpr_read_b32 v19, a119
    v_mul_f32 v19, v19, v253
    v_accvgpr_write_b32 a119, v19
    v_accvgpr_read_b32 v18, a120
    v_mul_f32 v18, v18, v250
    v_accvgpr_write_b32 a120, v18
    v_accvgpr_read_b32 v19, a121
    v_mul_f32 v19, v19, v251
    v_accvgpr_write_b32 a121, v19
    v_accvgpr_read_b32 v18, a122
    v_mul_f32 v18, v18, v252
    v_accvgpr_write_b32 a122, v18
    v_accvgpr_read_b32 v19, a123
    v_mul_f32 v19, v19, v253
    v_accvgpr_write_b32 a123, v19
    v_accvgpr_read_b32 v18, a124
    v_mul_f32 v18, v18, v250
    v_accvgpr_write_b32 a124, v18
    v_accvgpr_read_b32 v19, a125
    v_mul_f32 v19, v19, v251
    v_accvgpr_write_b32 a125, v19
    v_accvgpr_read_b32 v18, a126
    v_mul_f32 v18, v18, v252
    v_accvgpr_write_b32 a126, v18
    v_accvgpr_read_b32 v19, a127
    v_mul_f32 v19, v19, v253
    v_accvgpr_write_b32 a127, v19
    v_accvgpr_read_b32 v18, a128
    v_mul_f32 v18, v18, v250
    v_accvgpr_write_b32 a128, v18
    v_accvgpr_read_b32 v19, a129
    v_mul_f32 v19, v19, v251
    v_accvgpr_write_b32 a129, v19
    v_accvgpr_read_b32 v18, a130
    v_mul_f32 v18, v18, v252
    v_accvgpr_write_b32 a130, v18
    v_accvgpr_read_b32 v19, a131
    v_mul_f32 v19, v19, v253
    v_accvgpr_write_b32 a131, v19
    v_accvgpr_read_b32 v18, a132
    v_mul_f32 v18, v18, v250
    v_accvgpr_write_b32 a132, v18
    v_accvgpr_read_b32 v19, a133
    v_mul_f32 v19, v19, v251
    v_accvgpr_write_b32 a133, v19
    v_accvgpr_read_b32 v18, a134
    v_mul_f32 v18, v18, v252
    v_accvgpr_write_b32 a134, v18
    v_accvgpr_read_b32 v19, a135
    v_mul_f32 v19, v19, v253
    v_accvgpr_write_b32 a135, v19
    v_accvgpr_read_b32 v18, a136
    v_mul_f32 v18, v18, v250
    v_accvgpr_write_b32 a136, v18
    v_accvgpr_read_b32 v19, a137
    v_mul_f32 v19, v19, v251
    v_accvgpr_write_b32 a137, v19
    v_accvgpr_read_b32 v18, a138
    v_mul_f32 v18, v18, v252
    v_accvgpr_write_b32 a138, v18
    v_accvgpr_read_b32 v19, a139
    v_mul_f32 v19, v19, v253
    v_accvgpr_write_b32 a139, v19
    v_accvgpr_read_b32 v18, a140
    v_mul_f32 v18, v18, v250
    v_accvgpr_write_b32 a140, v18
    v_accvgpr_read_b32 v19, a141
    v_mul_f32 v19, v19, v251
    v_accvgpr_write_b32 a141, v19
    v_accvgpr_read_b32 v18, a142
    v_mul_f32 v18, v18, v252
    v_accvgpr_write_b32 a142, v18
    v_accvgpr_read_b32 v19, a143
    v_mul_f32 v19, v19, v253
    v_accvgpr_write_b32 a143, v19
    v_max3_f32 v16, v184, v185, v186
    v_max3_f32 v16, v16, v187, v188
    v_max3_f32 v16, v16, v189, v190
    v_max3_f32 v16, v16, v191, v243
    v_mov_b32 v17, v16
    s_nop 1
    v_permlane16_swap_b32 v16, v17
    s_nop 1
    v_max_f32 v16, v16, v17
    v_mov_b32 v17, v16
    s_nop 1
    v_permlane32_swap_b32 v16, v17
    s_nop 1
    v_max_f32 v16, v16, v17
    v_sub_f32 v17, v243, v16
    v_exp_f32 v17, v17
    v_mov_b32 v243, v16
    ds_bpermute_b32 v250, v62, v17 offset:0
    ds_bpermute_b32 v251, v62, v17 offset:4
    ds_bpermute_b32 v252, v62, v17 offset:8
    ds_bpermute_b32 v253, v62, v17 offset:12
    v_sub_f32 v184, v184, v16
    v_sub_f32 v185, v185, v16
    v_sub_f32 v186, v186, v16
    v_sub_f32 v187, v187, v16
    v_sub_f32 v188, v188, v16
    v_sub_f32 v189, v189, v16
    v_sub_f32 v190, v190, v16
    v_sub_f32 v191, v191, v16
    v_exp_f32 v184, v184
    v_exp_f32 v185, v185
    v_exp_f32 v186, v186
    v_exp_f32 v187, v187
    v_exp_f32 v188, v188
    v_exp_f32 v189, v189
    v_exp_f32 v190, v190
    v_exp_f32 v191, v191
    v_mul_f32 v8, v8, v17
    v_add_f32 v8, v8, v184
    v_add_f32 v8, v8, v185
    v_add_f32 v8, v8, v186
    v_add_f32 v8, v8, v187
    v_add_f32 v8, v8, v188
    v_add_f32 v8, v8, v189
    v_add_f32 v8, v8, v190
    v_add_f32 v8, v8, v191
    v_cvt_pk_bf16_f32 v236, v184, v185
    v_cvt_pk_bf16_f32 v237, v186, v187
    v_cvt_pk_bf16_f32 v238, v188, v189
    v_cvt_pk_bf16_f32 v239, v190, v191
    s_waitcnt lgkmcnt(0)
    v_accvgpr_read_b32 v18, a144
    v_mul_f32 v18, v18, v250
    v_accvgpr_write_b32 a144, v18
    v_accvgpr_read_b32 v19, a145
    v_mul_f32 v19, v19, v251
    v_accvgpr_write_b32 a145, v19
    v_accvgpr_read_b32 v18, a146
    v_mul_f32 v18, v18, v252
    v_accvgpr_write_b32 a146, v18
    v_accvgpr_read_b32 v19, a147
    v_mul_f32 v19, v19, v253
    v_accvgpr_write_b32 a147, v19
    v_accvgpr_read_b32 v18, a148
    v_mul_f32 v18, v18, v250
    v_accvgpr_write_b32 a148, v18
    v_accvgpr_read_b32 v19, a149
    v_mul_f32 v19, v19, v251
    v_accvgpr_write_b32 a149, v19
    v_accvgpr_read_b32 v18, a150
    v_mul_f32 v18, v18, v252
    v_accvgpr_write_b32 a150, v18
    v_accvgpr_read_b32 v19, a151
    v_mul_f32 v19, v19, v253
    v_accvgpr_write_b32 a151, v19
    v_accvgpr_read_b32 v18, a152
    v_mul_f32 v18, v18, v250
    v_accvgpr_write_b32 a152, v18
    v_accvgpr_read_b32 v19, a153
    v_mul_f32 v19, v19, v251
    v_accvgpr_write_b32 a153, v19
    v_accvgpr_read_b32 v18, a154
    v_mul_f32 v18, v18, v252
    v_accvgpr_write_b32 a154, v18
    v_accvgpr_read_b32 v19, a155
    v_mul_f32 v19, v19, v253
    v_accvgpr_write_b32 a155, v19
    v_accvgpr_read_b32 v18, a156
    v_mul_f32 v18, v18, v250
    v_accvgpr_write_b32 a156, v18
    v_accvgpr_read_b32 v19, a157
    v_mul_f32 v19, v19, v251
    v_accvgpr_write_b32 a157, v19
    v_accvgpr_read_b32 v18, a158
    v_mul_f32 v18, v18, v252
    v_accvgpr_write_b32 a158, v18
    v_accvgpr_read_b32 v19, a159
    v_mul_f32 v19, v19, v253
    v_accvgpr_write_b32 a159, v19
    v_accvgpr_read_b32 v18, a160
    v_mul_f32 v18, v18, v250
    v_accvgpr_write_b32 a160, v18
    v_accvgpr_read_b32 v19, a161
    v_mul_f32 v19, v19, v251
    v_accvgpr_write_b32 a161, v19
    v_accvgpr_read_b32 v18, a162
    v_mul_f32 v18, v18, v252
    v_accvgpr_write_b32 a162, v18
    v_accvgpr_read_b32 v19, a163
    v_mul_f32 v19, v19, v253
    v_accvgpr_write_b32 a163, v19
    v_accvgpr_read_b32 v18, a164
    v_mul_f32 v18, v18, v250
    v_accvgpr_write_b32 a164, v18
    v_accvgpr_read_b32 v19, a165
    v_mul_f32 v19, v19, v251
    v_accvgpr_write_b32 a165, v19
    v_accvgpr_read_b32 v18, a166
    v_mul_f32 v18, v18, v252
    v_accvgpr_write_b32 a166, v18
    v_accvgpr_read_b32 v19, a167
    v_mul_f32 v19, v19, v253
    v_accvgpr_write_b32 a167, v19
    v_accvgpr_read_b32 v18, a168
    v_mul_f32 v18, v18, v250
    v_accvgpr_write_b32 a168, v18
    v_accvgpr_read_b32 v19, a169
    v_mul_f32 v19, v19, v251
    v_accvgpr_write_b32 a169, v19
    v_accvgpr_read_b32 v18, a170
    v_mul_f32 v18, v18, v252
    v_accvgpr_write_b32 a170, v18
    v_accvgpr_read_b32 v19, a171
    v_mul_f32 v19, v19, v253
    v_accvgpr_write_b32 a171, v19
    v_accvgpr_read_b32 v18, a172
    v_mul_f32 v18, v18, v250
    v_accvgpr_write_b32 a172, v18
    v_accvgpr_read_b32 v19, a173
    v_mul_f32 v19, v19, v251
    v_accvgpr_write_b32 a173, v19
    v_accvgpr_read_b32 v18, a174
    v_mul_f32 v18, v18, v252
    v_accvgpr_write_b32 a174, v18
    v_accvgpr_read_b32 v19, a175
    v_mul_f32 v19, v19, v253
    v_accvgpr_write_b32 a175, v19
    v_accvgpr_read_b32 v18, a176
    v_mul_f32 v18, v18, v250
    v_accvgpr_write_b32 a176, v18
    v_accvgpr_read_b32 v19, a177
    v_mul_f32 v19, v19, v251
    v_accvgpr_write_b32 a177, v19
    v_accvgpr_read_b32 v18, a178
    v_mul_f32 v18, v18, v252
    v_accvgpr_write_b32 a178, v18
    v_accvgpr_read_b32 v19, a179
    v_mul_f32 v19, v19, v253
    v_accvgpr_write_b32 a179, v19
    v_accvgpr_read_b32 v18, a180
    v_mul_f32 v18, v18, v250
    v_accvgpr_write_b32 a180, v18
    v_accvgpr_read_b32 v19, a181
    v_mul_f32 v19, v19, v251
    v_accvgpr_write_b32 a181, v19
    v_accvgpr_read_b32 v18, a182
    v_mul_f32 v18, v18, v252
    v_accvgpr_write_b32 a182, v18
    v_accvgpr_read_b32 v19, a183
    v_mul_f32 v19, v19, v253
    v_accvgpr_write_b32 a183, v19
    v_accvgpr_read_b32 v18, a184
    v_mul_f32 v18, v18, v250
    v_accvgpr_write_b32 a184, v18
    v_accvgpr_read_b32 v19, a185
    v_mul_f32 v19, v19, v251
    v_accvgpr_write_b32 a185, v19
    v_accvgpr_read_b32 v18, a186
    v_mul_f32 v18, v18, v252
    v_accvgpr_write_b32 a186, v18
    v_accvgpr_read_b32 v19, a187
    v_mul_f32 v19, v19, v253
    v_accvgpr_write_b32 a187, v19
    v_accvgpr_read_b32 v18, a188
    v_mul_f32 v18, v18, v250
    v_accvgpr_write_b32 a188, v18
    v_accvgpr_read_b32 v19, a189
    v_mul_f32 v19, v19, v251
    v_accvgpr_write_b32 a189, v19
    v_accvgpr_read_b32 v18, a190
    v_mul_f32 v18, v18, v252
    v_accvgpr_write_b32 a190, v18
    v_accvgpr_read_b32 v19, a191
    v_mul_f32 v19, v19, v253
    v_accvgpr_write_b32 a191, v19
    s_waitcnt vmcnt(0)
    s_nop 1
    v_mfma_f32_16x16x32_bf16 a[0:3], v[224:227], v[112:115], a[0:3]
    v_mfma_f32_16x16x32_bf16 a[48:51], v[228:231], v[112:115], a[48:51]
    v_mfma_f32_16x16x32_bf16 a[96:99], v[232:235], v[112:115], a[96:99]
    v_mfma_f32_16x16x32_bf16 a[144:147], v[236:239], v[112:115], a[144:147]
    v_mfma_f32_16x16x32_bf16 a[4:7], v[224:227], v[116:119], a[4:7]
    v_mfma_f32_16x16x32_bf16 a[52:55], v[228:231], v[116:119], a[52:55]
    v_mfma_f32_16x16x32_bf16 a[100:103], v[232:235], v[116:119], a[100:103]
    v_mfma_f32_16x16x32_bf16 a[148:151], v[236:239], v[116:119], a[148:151]
    v_mfma_f32_16x16x32_bf16 a[8:11], v[224:227], v[120:123], a[8:11]
    v_mfma_f32_16x16x32_bf16 a[56:59], v[228:231], v[120:123], a[56:59]
    v_mfma_f32_16x16x32_bf16 a[104:107], v[232:235], v[120:123], a[104:107]
    v_mfma_f32_16x16x32_bf16 a[152:155], v[236:239], v[120:123], a[152:155]
    v_mfma_f32_16x16x32_bf16 a[12:15], v[224:227], v[124:127], a[12:15]
    v_mfma_f32_16x16x32_bf16 a[60:63], v[228:231], v[124:127], a[60:63]
    v_mfma_f32_16x16x32_bf16 a[108:111], v[232:235], v[124:127], a[108:111]
    v_mfma_f32_16x16x32_bf16 a[156:159], v[236:239], v[124:127], a[156:159]
    v_mfma_f32_16x16x32_bf16 a[16:19], v[224:227], v[128:131], a[16:19]
    v_mfma_f32_16x16x32_bf16 a[64:67], v[228:231], v[128:131], a[64:67]
    v_mfma_f32_16x16x32_bf16 a[112:115], v[232:235], v[128:131], a[112:115]
    v_mfma_f32_16x16x32_bf16 a[160:163], v[236:239], v[128:131], a[160:163]
    v_mfma_f32_16x16x32_bf16 a[20:23], v[224:227], v[132:135], a[20:23]
    v_mfma_f32_16x16x32_bf16 a[68:71], v[228:231], v[132:135], a[68:71]
    v_mfma_f32_16x16x32_bf16 a[116:119], v[232:235], v[132:135], a[116:119]
    v_mfma_f32_16x16x32_bf16 a[164:167], v[236:239], v[132:135], a[164:167]
    v_mfma_f32_16x16x32_bf16 a[24:27], v[224:227], v[136:139], a[24:27]
    v_mfma_f32_16x16x32_bf16 a[72:75], v[228:231], v[136:139], a[72:75]
    v_mfma_f32_16x16x32_bf16 a[120:123], v[232:235], v[136:139], a[120:123]
    v_mfma_f32_16x16x32_bf16 a[168:171], v[236:239], v[136:139], a[168:171]
    v_mfma_f32_16x16x32_bf16 a[28:31], v[224:227], v[140:143], a[28:31]
    v_mfma_f32_16x16x32_bf16 a[76:79], v[228:231], v[140:143], a[76:79]
    v_mfma_f32_16x16x32_bf16 a[124:127], v[232:235], v[140:143], a[124:127]
    v_mfma_f32_16x16x32_bf16 a[172:175], v[236:239], v[140:143], a[172:175]
    v_mfma_f32_16x16x32_bf16 a[32:35], v[224:227], v[144:147], a[32:35]
    v_mfma_f32_16x16x32_bf16 a[80:83], v[228:231], v[144:147], a[80:83]
    v_mfma_f32_16x16x32_bf16 a[128:131], v[232:235], v[144:147], a[128:131]
    v_mfma_f32_16x16x32_bf16 a[176:179], v[236:239], v[144:147], a[176:179]
    v_mfma_f32_16x16x32_bf16 a[36:39], v[224:227], v[148:151], a[36:39]
    v_mfma_f32_16x16x32_bf16 a[84:87], v[228:231], v[148:151], a[84:87]
    v_mfma_f32_16x16x32_bf16 a[132:135], v[232:235], v[148:151], a[132:135]
    v_mfma_f32_16x16x32_bf16 a[180:183], v[236:239], v[148:151], a[180:183]
    v_mfma_f32_16x16x32_bf16 a[40:43], v[224:227], v[152:155], a[40:43]
    v_mfma_f32_16x16x32_bf16 a[88:91], v[228:231], v[152:155], a[88:91]
    v_mfma_f32_16x16x32_bf16 a[136:139], v[232:235], v[152:155], a[136:139]
    v_mfma_f32_16x16x32_bf16 a[184:187], v[236:239], v[152:155], a[184:187]
    v_mfma_f32_16x16x32_bf16 a[44:47], v[224:227], v[156:159], a[44:47]
    v_mfma_f32_16x16x32_bf16 a[92:95], v[228:231], v[156:159], a[92:95]
    v_mfma_f32_16x16x32_bf16 a[140:143], v[232:235], v[156:159], a[140:143]
    v_mfma_f32_16x16x32_bf16 a[188:191], v[236:239], v[156:159], a[188:191]
    s_add_u32 s48, s48, 24576
    s_cmp_lt_u32 s48, 1572864
    s_nop 7
    s_cbranch_scc1 L_slowloop
    s_nop 1
    v_mfma_f32_16x16x4_f32 v[48:51], v5, v15, 0
    v_mfma_f32_16x16x4_f32 v[52:55], v6, v15, 0
    v_mfma_f32_16x16x4_f32 v[56:59], v7, v15, 0
    v_mfma_f32_16x16x4_f32 v[128:131], v8, v15, 0
    s_nop 10
    v_rcp_f32 v48, v48
    v_rcp_f32 v49, v49
    v_rcp_f32 v50, v50
    v_rcp_f32 v51, v51
    v_rcp_f32 v52, v52
    v_rcp_f32 v53, v53
    v_rcp_f32 v54, v54
    v_rcp_f32 v55, v55
    v_rcp_f32 v56, v56
    v_rcp_f32 v57, v57
    v_rcp_f32 v58, v58
    v_rcp_f32 v59, v59
    v_rcp_f32 v128, v128
    v_rcp_f32 v129, v129
    v_rcp_f32 v130, v130
    v_rcp_f32 v131, v131
    s_nop 0
    v_accvgpr_read_b32 v64, a0
    v_accvgpr_read_b32 v65, a4
    v_accvgpr_read_b32 v66, a8
    v_accvgpr_read_b32 v67, a12
    v_accvgpr_read_b32 v68, a16
    v_accvgpr_read_b32 v69, a20
    v_accvgpr_read_b32 v70, a24
    v_accvgpr_read_b32 v71, a28
    v_accvgpr_read_b32 v72, a32
    v_accvgpr_read_b32 v73, a36
    v_accvgpr_read_b32 v74, a40
    v_accvgpr_read_b32 v75, a44
    v_pk_mul_f32 v[64:65], v[64:65], v[48:49] op_sel:[0,0] op_sel_hi:[1,0]
    v_pk_mul_f32 v[66:67], v[66:67], v[48:49] op_sel:[0,0] op_sel_hi:[1,0]
    v_pk_mul_f32 v[68:69], v[68:69], v[48:49] op_sel:[0,0] op_sel_hi:[1,0]
    v_pk_mul_f32 v[70:71], v[70:71], v[48:49] op_sel:[0,0] op_sel_hi:[1,0]
    v_pk_mul_f32 v[72:73], v[72:73], v[48:49] op_sel:[0,0] op_sel_hi:[1,0]
    v_pk_mul_f32 v[74:75], v[74:75], v[48:49] op_sel:[0,0] op_sel_hi:[1,0]
    v_cvt_pk_bf16_f32 v64, v64, v65
    v_cvt_pk_bf16_f32 v65, v66, v67
    v_cvt_pk_bf16_f32 v66, v68, v69
    v_cvt_pk_bf16_f32 v67, v70, v71
    v_cvt_pk_bf16_f32 v68, v72, v73
    v_cvt_pk_bf16_f32 v69, v74, v75
    buffer_store_dwordx4 v[64:67], v60, s[12:15], s33 offen offset:0 sc0 sc1
    buffer_store_dwordx2 v[68:69], v61, s[12:15], s33 offen offset:256 sc0 sc1
    v_accvgpr_read_b32 v76, a1
    v_accvgpr_read_b32 v77, a5
    v_accvgpr_read_b32 v78, a9
    v_accvgpr_read_b32 v79, a13
    v_accvgpr_read_b32 v80, a17
    v_accvgpr_read_b32 v81, a21
    v_accvgpr_read_b32 v82, a25
    v_accvgpr_read_b32 v83, a29
    v_accvgpr_read_b32 v84, a33
    v_accvgpr_read_b32 v85, a37
    v_accvgpr_read_b32 v86, a41
    v_accvgpr_read_b32 v87, a45
    v_pk_mul_f32 v[76:77], v[76:77], v[48:49] op_sel:[0,1] op_sel_hi:[1,1]
    v_pk_mul_f32 v[78:79], v[78:79], v[48:49] op_sel:[0,1] op_sel_hi:[1,1]
    v_pk_mul_f32 v[80:81], v[80:81], v[48:49] op_sel:[0,1] op_sel_hi:[1,1]
    v_pk_mul_f32 v[82:83], v[82:83], v[48:49] op_sel:[0,1] op_sel_hi:[1,1]
    v_pk_mul_f32 v[84:85], v[84:85], v[48:49] op_sel:[0,1] op_sel_hi:[1,1]
    v_pk_mul_f32 v[86:87], v[86:87], v[48:49] op_sel:[0,1] op_sel_hi:[1,1]
    v_cvt_pk_bf16_f32 v76, v76, v77
    v_cvt_pk_bf16_f32 v77, v78, v79
    v_cvt_pk_bf16_f32 v78, v80, v81
    v_cvt_pk_bf16_f32 v79, v82, v83
    v_cvt_pk_bf16_f32 v80, v84, v85
    v_cvt_pk_bf16_f32 v81, v86, v87
    buffer_store_dwordx4 v[76:79], v60, s[12:15], s33 offen offset:384 sc0 sc1
    buffer_store_dwordx2 v[80:81], v61, s[12:15], s33 offen offset:640 sc0 sc1
    v_accvgpr_read_b32 v88, a2
    v_accvgpr_read_b32 v89, a6
    v_accvgpr_read_b32 v90, a10
    v_accvgpr_read_b32 v91, a14
    v_accvgpr_read_b32 v92, a18
    v_accvgpr_read_b32 v93, a22
    v_accvgpr_read_b32 v94, a26
    v_accvgpr_read_b32 v95, a30
    v_accvgpr_read_b32 v96, a34
    v_accvgpr_read_b32 v97, a38
    v_accvgpr_read_b32 v98, a42
    v_accvgpr_read_b32 v99, a46
    v_pk_mul_f32 v[88:89], v[88:89], v[50:51] op_sel:[0,0] op_sel_hi:[1,0]
    v_pk_mul_f32 v[90:91], v[90:91], v[50:51] op_sel:[0,0] op_sel_hi:[1,0]
    v_pk_mul_f32 v[92:93], v[92:93], v[50:51] op_sel:[0,0] op_sel_hi:[1,0]
    v_pk_mul_f32 v[94:95], v[94:95], v[50:51] op_sel:[0,0] op_sel_hi:[1,0]
    v_pk_mul_f32 v[96:97], v[96:97], v[50:51] op_sel:[0,0] op_sel_hi:[1,0]
    v_pk_mul_f32 v[98:99], v[98:99], v[50:51] op_sel:[0,0] op_sel_hi:[1,0]
    v_cvt_pk_bf16_f32 v88, v88, v89
    v_cvt_pk_bf16_f32 v89, v90, v91
    v_cvt_pk_bf16_f32 v90, v92, v93
    v_cvt_pk_bf16_f32 v91, v94, v95
    v_cvt_pk_bf16_f32 v92, v96, v97
    v_cvt_pk_bf16_f32 v93, v98, v99
    buffer_store_dwordx4 v[88:91], v60, s[12:15], s33 offen offset:768 sc0 sc1
    buffer_store_dwordx2 v[92:93], v61, s[12:15], s33 offen offset:1024 sc0 sc1
    v_accvgpr_read_b32 v100, a3
    v_accvgpr_read_b32 v101, a7
    v_accvgpr_read_b32 v102, a11
    v_accvgpr_read_b32 v103, a15
    v_accvgpr_read_b32 v104, a19
    v_accvgpr_read_b32 v105, a23
    v_accvgpr_read_b32 v106, a27
    v_accvgpr_read_b32 v107, a31
    v_accvgpr_read_b32 v108, a35
    v_accvgpr_read_b32 v109, a39
    v_accvgpr_read_b32 v110, a43
    v_accvgpr_read_b32 v111, a47
    v_pk_mul_f32 v[100:101], v[100:101], v[50:51] op_sel:[0,1] op_sel_hi:[1,1]
    v_pk_mul_f32 v[102:103], v[102:103], v[50:51] op_sel:[0,1] op_sel_hi:[1,1]
    v_pk_mul_f32 v[104:105], v[104:105], v[50:51] op_sel:[0,1] op_sel_hi:[1,1]
    v_pk_mul_f32 v[106:107], v[106:107], v[50:51] op_sel:[0,1] op_sel_hi:[1,1]
    v_pk_mul_f32 v[108:109], v[108:109], v[50:51] op_sel:[0,1] op_sel_hi:[1,1]
    v_pk_mul_f32 v[110:111], v[110:111], v[50:51] op_sel:[0,1] op_sel_hi:[1,1]
    v_cvt_pk_bf16_f32 v100, v100, v101
    v_cvt_pk_bf16_f32 v101, v102, v103
    v_cvt_pk_bf16_f32 v102, v104, v105
    v_cvt_pk_bf16_f32 v103, v106, v107
    v_cvt_pk_bf16_f32 v104, v108, v109
    v_cvt_pk_bf16_f32 v105, v110, v111
    buffer_store_dwordx4 v[100:103], v60, s[12:15], s33 offen offset:1152 sc0 sc1
    buffer_store_dwordx2 v[104:105], v61, s[12:15], s33 offen offset:1408 sc0 sc1
    v_accvgpr_read_b32 v112, a48
    v_accvgpr_read_b32 v113, a52
    v_accvgpr_read_b32 v114, a56
    v_accvgpr_read_b32 v115, a60
    v_accvgpr_read_b32 v116, a64
    v_accvgpr_read_b32 v117, a68
    v_accvgpr_read_b32 v118, a72
    v_accvgpr_read_b32 v119, a76
    v_accvgpr_read_b32 v120, a80
    v_accvgpr_read_b32 v121, a84
    v_accvgpr_read_b32 v122, a88
    v_accvgpr_read_b32 v123, a92
    v_pk_mul_f32 v[112:113], v[112:113], v[52:53] op_sel:[0,0] op_sel_hi:[1,0]
    v_pk_mul_f32 v[114:115], v[114:115], v[52:53] op_sel:[0,0] op_sel_hi:[1,0]
    v_pk_mul_f32 v[116:117], v[116:117], v[52:53] op_sel:[0,0] op_sel_hi:[1,0]
    v_pk_mul_f32 v[118:119], v[118:119], v[52:53] op_sel:[0,0] op_sel_hi:[1,0]
    v_pk_mul_f32 v[120:121], v[120:121], v[52:53] op_sel:[0,0] op_sel_hi:[1,0]
    v_pk_mul_f32 v[122:123], v[122:123], v[52:53] op_sel:[0,0] op_sel_hi:[1,0]
    v_cvt_pk_bf16_f32 v112, v112, v113
    v_cvt_pk_bf16_f32 v113, v114, v115
    v_cvt_pk_bf16_f32 v114, v116, v117
    v_cvt_pk_bf16_f32 v115, v118, v119
    v_cvt_pk_bf16_f32 v116, v120, v121
    v_cvt_pk_bf16_f32 v117, v122, v123
    buffer_store_dwordx4 v[112:115], v60, s[12:15], s34 offen offset:0 sc0 sc1
    buffer_store_dwordx2 v[116:117], v61, s[12:15], s34 offen offset:256 sc0 sc1
    v_accvgpr_read_b32 v64, a49
    v_accvgpr_read_b32 v65, a53
    v_accvgpr_read_b32 v66, a57
    v_accvgpr_read_b32 v67, a61
    v_accvgpr_read_b32 v68, a65
    v_accvgpr_read_b32 v69, a69
    v_accvgpr_read_b32 v70, a73
    v_accvgpr_read_b32 v71, a77
    v_accvgpr_read_b32 v72, a81
    v_accvgpr_read_b32 v73, a85
    v_accvgpr_read_b32 v74, a89
    v_accvgpr_read_b32 v75, a93
    v_pk_mul_f32 v[64:65], v[64:65], v[52:53] op_sel:[0,1] op_sel_hi:[1,1]
    v_pk_mul_f32 v[66:67], v[66:67], v[52:53] op_sel:[0,1] op_sel_hi:[1,1]
    v_pk_mul_f32 v[68:69], v[68:69], v[52:53] op_sel:[0,1] op_sel_hi:[1,1]
    v_pk_mul_f32 v[70:71], v[70:71], v[52:53] op_sel:[0,1] op_sel_hi:[1,1]
    v_pk_mul_f32 v[72:73], v[72:73], v[52:53] op_sel:[0,1] op_sel_hi:[1,1]
    v_pk_mul_f32 v[74:75], v[74:75], v[52:53] op_sel:[0,1] op_sel_hi:[1,1]
    v_cvt_pk_bf16_f32 v64, v64, v65
    v_cvt_pk_bf16_f32 v65, v66, v67
    v_cvt_pk_bf16_f32 v66, v68, v69
    v_cvt_pk_bf16_f32 v67, v70, v71
    v_cvt_pk_bf16_f32 v68, v72, v73
    v_cvt_pk_bf16_f32 v69, v74, v75
    buffer_store_dwordx4 v[64:67], v60, s[12:15], s34 offen offset:384 sc0 sc1
    buffer_store_dwordx2 v[68:69], v61, s[12:15], s34 offen offset:640 sc0 sc1
    v_accvgpr_read_b32 v76, a50
    v_accvgpr_read_b32 v77, a54
    v_accvgpr_read_b32 v78, a58
    v_accvgpr_read_b32 v79, a62
    v_accvgpr_read_b32 v80, a66
    v_accvgpr_read_b32 v81, a70
    v_accvgpr_read_b32 v82, a74
    v_accvgpr_read_b32 v83, a78
    v_accvgpr_read_b32 v84, a82
    v_accvgpr_read_b32 v85, a86
    v_accvgpr_read_b32 v86, a90
    v_accvgpr_read_b32 v87, a94
    v_pk_mul_f32 v[76:77], v[76:77], v[54:55] op_sel:[0,0] op_sel_hi:[1,0]
    v_pk_mul_f32 v[78:79], v[78:79], v[54:55] op_sel:[0,0] op_sel_hi:[1,0]
    v_pk_mul_f32 v[80:81], v[80:81], v[54:55] op_sel:[0,0] op_sel_hi:[1,0]
    v_pk_mul_f32 v[82:83], v[82:83], v[54:55] op_sel:[0,0] op_sel_hi:[1,0]
    v_pk_mul_f32 v[84:85], v[84:85], v[54:55] op_sel:[0,0] op_sel_hi:[1,0]
    v_pk_mul_f32 v[86:87], v[86:87], v[54:55] op_sel:[0,0] op_sel_hi:[1,0]
    v_cvt_pk_bf16_f32 v76, v76, v77
    v_cvt_pk_bf16_f32 v77, v78, v79
    v_cvt_pk_bf16_f32 v78, v80, v81
    v_cvt_pk_bf16_f32 v79, v82, v83
    v_cvt_pk_bf16_f32 v80, v84, v85
    v_cvt_pk_bf16_f32 v81, v86, v87
    buffer_store_dwordx4 v[76:79], v60, s[12:15], s34 offen offset:768 sc0 sc1
    buffer_store_dwordx2 v[80:81], v61, s[12:15], s34 offen offset:1024 sc0 sc1
    v_accvgpr_read_b32 v88, a51
    v_accvgpr_read_b32 v89, a55
    v_accvgpr_read_b32 v90, a59
    v_accvgpr_read_b32 v91, a63
    v_accvgpr_read_b32 v92, a67
    v_accvgpr_read_b32 v93, a71
    v_accvgpr_read_b32 v94, a75
    v_accvgpr_read_b32 v95, a79
    v_accvgpr_read_b32 v96, a83
    v_accvgpr_read_b32 v97, a87
    v_accvgpr_read_b32 v98, a91
    v_accvgpr_read_b32 v99, a95
    v_pk_mul_f32 v[88:89], v[88:89], v[54:55] op_sel:[0,1] op_sel_hi:[1,1]
    v_pk_mul_f32 v[90:91], v[90:91], v[54:55] op_sel:[0,1] op_sel_hi:[1,1]
    v_pk_mul_f32 v[92:93], v[92:93], v[54:55] op_sel:[0,1] op_sel_hi:[1,1]
    v_pk_mul_f32 v[94:95], v[94:95], v[54:55] op_sel:[0,1] op_sel_hi:[1,1]
    v_pk_mul_f32 v[96:97], v[96:97], v[54:55] op_sel:[0,1] op_sel_hi:[1,1]
    v_pk_mul_f32 v[98:99], v[98:99], v[54:55] op_sel:[0,1] op_sel_hi:[1,1]
    v_cvt_pk_bf16_f32 v88, v88, v89
    v_cvt_pk_bf16_f32 v89, v90, v91
    v_cvt_pk_bf16_f32 v90, v92, v93
    v_cvt_pk_bf16_f32 v91, v94, v95
    v_cvt_pk_bf16_f32 v92, v96, v97
    v_cvt_pk_bf16_f32 v93, v98, v99
    buffer_store_dwordx4 v[88:91], v60, s[12:15], s34 offen offset:1152 sc0 sc1
    buffer_store_dwordx2 v[92:93], v61, s[12:15], s34 offen offset:1408 sc0 sc1
    v_accvgpr_read_b32 v100, a96
    v_accvgpr_read_b32 v101, a100
    v_accvgpr_read_b32 v102, a104
    v_accvgpr_read_b32 v103, a108
    v_accvgpr_read_b32 v104, a112
    v_accvgpr_read_b32 v105, a116
    v_accvgpr_read_b32 v106, a120
    v_accvgpr_read_b32 v107, a124
    v_accvgpr_read_b32 v108, a128
    v_accvgpr_read_b32 v109, a132
    v_accvgpr_read_b32 v110, a136
    v_accvgpr_read_b32 v111, a140
    v_pk_mul_f32 v[100:101], v[100:101], v[56:57] op_sel:[0,0] op_sel_hi:[1,0]
    v_pk_mul_f32 v[102:103], v[102:103], v[56:57] op_sel:[0,0] op_sel_hi:[1,0]
    v_pk_mul_f32 v[104:105], v[104:105], v[56:57] op_sel:[0,0] op_sel_hi:[1,0]
    v_pk_mul_f32 v[106:107], v[106:107], v[56:57] op_sel:[0,0] op_sel_hi:[1,0]
    v_pk_mul_f32 v[108:109], v[108:109], v[56:57] op_sel:[0,0] op_sel_hi:[1,0]
    v_pk_mul_f32 v[110:111], v[110:111], v[56:57] op_sel:[0,0] op_sel_hi:[1,0]
    v_cvt_pk_bf16_f32 v100, v100, v101
    v_cvt_pk_bf16_f32 v101, v102, v103
    v_cvt_pk_bf16_f32 v102, v104, v105
    v_cvt_pk_bf16_f32 v103, v106, v107
    v_cvt_pk_bf16_f32 v104, v108, v109
    v_cvt_pk_bf16_f32 v105, v110, v111
    buffer_store_dwordx4 v[100:103], v60, s[12:15], s35 offen offset:0 sc0 sc1
    buffer_store_dwordx2 v[104:105], v61, s[12:15], s35 offen offset:256 sc0 sc1
    v_accvgpr_read_b32 v112, a97
    v_accvgpr_read_b32 v113, a101
    v_accvgpr_read_b32 v114, a105
    v_accvgpr_read_b32 v115, a109
    v_accvgpr_read_b32 v116, a113
    v_accvgpr_read_b32 v117, a117
    v_accvgpr_read_b32 v118, a121
    v_accvgpr_read_b32 v119, a125
    v_accvgpr_read_b32 v120, a129
    v_accvgpr_read_b32 v121, a133
    v_accvgpr_read_b32 v122, a137
    v_accvgpr_read_b32 v123, a141
    v_pk_mul_f32 v[112:113], v[112:113], v[56:57] op_sel:[0,1] op_sel_hi:[1,1]
    v_pk_mul_f32 v[114:115], v[114:115], v[56:57] op_sel:[0,1] op_sel_hi:[1,1]
    v_pk_mul_f32 v[116:117], v[116:117], v[56:57] op_sel:[0,1] op_sel_hi:[1,1]
    v_pk_mul_f32 v[118:119], v[118:119], v[56:57] op_sel:[0,1] op_sel_hi:[1,1]
    v_pk_mul_f32 v[120:121], v[120:121], v[56:57] op_sel:[0,1] op_sel_hi:[1,1]
    v_pk_mul_f32 v[122:123], v[122:123], v[56:57] op_sel:[0,1] op_sel_hi:[1,1]
    v_cvt_pk_bf16_f32 v112, v112, v113
    v_cvt_pk_bf16_f32 v113, v114, v115
    v_cvt_pk_bf16_f32 v114, v116, v117
    v_cvt_pk_bf16_f32 v115, v118, v119
    v_cvt_pk_bf16_f32 v116, v120, v121
    v_cvt_pk_bf16_f32 v117, v122, v123
    buffer_store_dwordx4 v[112:115], v60, s[12:15], s35 offen offset:384 sc0 sc1
    buffer_store_dwordx2 v[116:117], v61, s[12:15], s35 offen offset:640 sc0 sc1
    v_accvgpr_read_b32 v64, a98
    v_accvgpr_read_b32 v65, a102
    v_accvgpr_read_b32 v66, a106
    v_accvgpr_read_b32 v67, a110
    v_accvgpr_read_b32 v68, a114
    v_accvgpr_read_b32 v69, a118
    v_accvgpr_read_b32 v70, a122
    v_accvgpr_read_b32 v71, a126
    v_accvgpr_read_b32 v72, a130
    v_accvgpr_read_b32 v73, a134
    v_accvgpr_read_b32 v74, a138
    v_accvgpr_read_b32 v75, a142
    v_pk_mul_f32 v[64:65], v[64:65], v[58:59] op_sel:[0,0] op_sel_hi:[1,0]
    v_pk_mul_f32 v[66:67], v[66:67], v[58:59] op_sel:[0,0] op_sel_hi:[1,0]
    v_pk_mul_f32 v[68:69], v[68:69], v[58:59] op_sel:[0,0] op_sel_hi:[1,0]
    v_pk_mul_f32 v[70:71], v[70:71], v[58:59] op_sel:[0,0] op_sel_hi:[1,0]
    v_pk_mul_f32 v[72:73], v[72:73], v[58:59] op_sel:[0,0] op_sel_hi:[1,0]
    v_pk_mul_f32 v[74:75], v[74:75], v[58:59] op_sel:[0,0] op_sel_hi:[1,0]
    v_cvt_pk_bf16_f32 v64, v64, v65
    v_cvt_pk_bf16_f32 v65, v66, v67
    v_cvt_pk_bf16_f32 v66, v68, v69
    v_cvt_pk_bf16_f32 v67, v70, v71
    v_cvt_pk_bf16_f32 v68, v72, v73
    v_cvt_pk_bf16_f32 v69, v74, v75
    buffer_store_dwordx4 v[64:67], v60, s[12:15], s35 offen offset:768 sc0 sc1
    buffer_store_dwordx2 v[68:69], v61, s[12:15], s35 offen offset:1024 sc0 sc1
    v_accvgpr_read_b32 v76, a99
    v_accvgpr_read_b32 v77, a103
    v_accvgpr_read_b32 v78, a107
    v_accvgpr_read_b32 v79, a111
    v_accvgpr_read_b32 v80, a115
    v_accvgpr_read_b32 v81, a119
    v_accvgpr_read_b32 v82, a123
    v_accvgpr_read_b32 v83, a127
    v_accvgpr_read_b32 v84, a131
    v_accvgpr_read_b32 v85, a135
    v_accvgpr_read_b32 v86, a139
    v_accvgpr_read_b32 v87, a143
    v_pk_mul_f32 v[76:77], v[76:77], v[58:59] op_sel:[0,1] op_sel_hi:[1,1]
    v_pk_mul_f32 v[78:79], v[78:79], v[58:59] op_sel:[0,1] op_sel_hi:[1,1]
    v_pk_mul_f32 v[80:81], v[80:81], v[58:59] op_sel:[0,1] op_sel_hi:[1,1]
    v_pk_mul_f32 v[82:83], v[82:83], v[58:59] op_sel:[0,1] op_sel_hi:[1,1]
    v_pk_mul_f32 v[84:85], v[84:85], v[58:59] op_sel:[0,1] op_sel_hi:[1,1]
    v_pk_mul_f32 v[86:87], v[86:87], v[58:59] op_sel:[0,1] op_sel_hi:[1,1]
    v_cvt_pk_bf16_f32 v76, v76, v77
    v_cvt_pk_bf16_f32 v77, v78, v79
    v_cvt_pk_bf16_f32 v78, v80, v81
    v_cvt_pk_bf16_f32 v79, v82, v83
    v_cvt_pk_bf16_f32 v80, v84, v85
    v_cvt_pk_bf16_f32 v81, v86, v87
    buffer_store_dwordx4 v[76:79], v60, s[12:15], s35 offen offset:1152 sc0 sc1
    buffer_store_dwordx2 v[80:81], v61, s[12:15], s35 offen offset:1408 sc0 sc1
    v_accvgpr_read_b32 v88, a144
    v_accvgpr_read_b32 v89, a148
    v_accvgpr_read_b32 v90, a152
    v_accvgpr_read_b32 v91, a156
    v_accvgpr_read_b32 v92, a160
    v_accvgpr_read_b32 v93, a164
    v_accvgpr_read_b32 v94, a168
    v_accvgpr_read_b32 v95, a172
    v_accvgpr_read_b32 v96, a176
    v_accvgpr_read_b32 v97, a180
    v_accvgpr_read_b32 v98, a184
    v_accvgpr_read_b32 v99, a188
    v_pk_mul_f32 v[88:89], v[88:89], v[128:129] op_sel:[0,0] op_sel_hi:[1,0]
    v_pk_mul_f32 v[90:91], v[90:91], v[128:129] op_sel:[0,0] op_sel_hi:[1,0]
    v_pk_mul_f32 v[92:93], v[92:93], v[128:129] op_sel:[0,0] op_sel_hi:[1,0]
    v_pk_mul_f32 v[94:95], v[94:95], v[128:129] op_sel:[0,0] op_sel_hi:[1,0]
    v_pk_mul_f32 v[96:97], v[96:97], v[128:129] op_sel:[0,0] op_sel_hi:[1,0]
    v_pk_mul_f32 v[98:99], v[98:99], v[128:129] op_sel:[0,0] op_sel_hi:[1,0]
    v_cvt_pk_bf16_f32 v88, v88, v89
    v_cvt_pk_bf16_f32 v89, v90, v91
    v_cvt_pk_bf16_f32 v90, v92, v93
    v_cvt_pk_bf16_f32 v91, v94, v95
    v_cvt_pk_bf16_f32 v92, v96, v97
    v_cvt_pk_bf16_f32 v93, v98, v99
    buffer_store_dwordx4 v[88:91], v60, s[12:15], s36 offen offset:0 sc0 sc1
    buffer_store_dwordx2 v[92:93], v61, s[12:15], s36 offen offset:256 sc0 sc1
    v_accvgpr_read_b32 v100, a145
    v_accvgpr_read_b32 v101, a149
    v_accvgpr_read_b32 v102, a153
    v_accvgpr_read_b32 v103, a157
    v_accvgpr_read_b32 v104, a161
    v_accvgpr_read_b32 v105, a165
    v_accvgpr_read_b32 v106, a169
    v_accvgpr_read_b32 v107, a173
    v_accvgpr_read_b32 v108, a177
    v_accvgpr_read_b32 v109, a181
    v_accvgpr_read_b32 v110, a185
    v_accvgpr_read_b32 v111, a189
    v_pk_mul_f32 v[100:101], v[100:101], v[128:129] op_sel:[0,1] op_sel_hi:[1,1]
    v_pk_mul_f32 v[102:103], v[102:103], v[128:129] op_sel:[0,1] op_sel_hi:[1,1]
    v_pk_mul_f32 v[104:105], v[104:105], v[128:129] op_sel:[0,1] op_sel_hi:[1,1]
    v_pk_mul_f32 v[106:107], v[106:107], v[128:129] op_sel:[0,1] op_sel_hi:[1,1]
    v_pk_mul_f32 v[108:109], v[108:109], v[128:129] op_sel:[0,1] op_sel_hi:[1,1]
    v_pk_mul_f32 v[110:111], v[110:111], v[128:129] op_sel:[0,1] op_sel_hi:[1,1]
    v_cvt_pk_bf16_f32 v100, v100, v101
    v_cvt_pk_bf16_f32 v101, v102, v103
    v_cvt_pk_bf16_f32 v102, v104, v105
    v_cvt_pk_bf16_f32 v103, v106, v107
    v_cvt_pk_bf16_f32 v104, v108, v109
    v_cvt_pk_bf16_f32 v105, v110, v111
    buffer_store_dwordx4 v[100:103], v60, s[12:15], s36 offen offset:384 sc0 sc1
    buffer_store_dwordx2 v[104:105], v61, s[12:15], s36 offen offset:640 sc0 sc1
    v_accvgpr_read_b32 v112, a146
    v_accvgpr_read_b32 v113, a150
    v_accvgpr_read_b32 v114, a154
    v_accvgpr_read_b32 v115, a158
    v_accvgpr_read_b32 v116, a162
    v_accvgpr_read_b32 v117, a166
    v_accvgpr_read_b32 v118, a170
    v_accvgpr_read_b32 v119, a174
    v_accvgpr_read_b32 v120, a178
    v_accvgpr_read_b32 v121, a182
    v_accvgpr_read_b32 v122, a186
    v_accvgpr_read_b32 v123, a190
    v_pk_mul_f32 v[112:113], v[112:113], v[130:131] op_sel:[0,0] op_sel_hi:[1,0]
    v_pk_mul_f32 v[114:115], v[114:115], v[130:131] op_sel:[0,0] op_sel_hi:[1,0]
    v_pk_mul_f32 v[116:117], v[116:117], v[130:131] op_sel:[0,0] op_sel_hi:[1,0]
    v_pk_mul_f32 v[118:119], v[118:119], v[130:131] op_sel:[0,0] op_sel_hi:[1,0]
    v_pk_mul_f32 v[120:121], v[120:121], v[130:131] op_sel:[0,0] op_sel_hi:[1,0]
    v_pk_mul_f32 v[122:123], v[122:123], v[130:131] op_sel:[0,0] op_sel_hi:[1,0]
    v_cvt_pk_bf16_f32 v112, v112, v113
    v_cvt_pk_bf16_f32 v113, v114, v115
    v_cvt_pk_bf16_f32 v114, v116, v117
    v_cvt_pk_bf16_f32 v115, v118, v119
    v_cvt_pk_bf16_f32 v116, v120, v121
    v_cvt_pk_bf16_f32 v117, v122, v123
    buffer_store_dwordx4 v[112:115], v60, s[12:15], s36 offen offset:768 sc0 sc1
    buffer_store_dwordx2 v[116:117], v61, s[12:15], s36 offen offset:1024 sc0 sc1
    v_accvgpr_read_b32 v64, a147
    v_accvgpr_read_b32 v65, a151
    v_accvgpr_read_b32 v66, a155
    v_accvgpr_read_b32 v67, a159
    v_accvgpr_read_b32 v68, a163
    v_accvgpr_read_b32 v69, a167
    v_accvgpr_read_b32 v70, a171
    v_accvgpr_read_b32 v71, a175
    v_accvgpr_read_b32 v72, a179
    v_accvgpr_read_b32 v73, a183
    v_accvgpr_read_b32 v74, a187
    v_accvgpr_read_b32 v75, a191
    v_pk_mul_f32 v[64:65], v[64:65], v[130:131] op_sel:[0,1] op_sel_hi:[1,1]
    v_pk_mul_f32 v[66:67], v[66:67], v[130:131] op_sel:[0,1] op_sel_hi:[1,1]
    v_pk_mul_f32 v[68:69], v[68:69], v[130:131] op_sel:[0,1] op_sel_hi:[1,1]
    v_pk_mul_f32 v[70:71], v[70:71], v[130:131] op_sel:[0,1] op_sel_hi:[1,1]
    v_pk_mul_f32 v[72:73], v[72:73], v[130:131] op_sel:[0,1] op_sel_hi:[1,1]
    v_pk_mul_f32 v[74:75], v[74:75], v[130:131] op_sel:[0,1] op_sel_hi:[1,1]
    v_cvt_pk_bf16_f32 v64, v64, v65
    v_cvt_pk_bf16_f32 v65, v66, v67
    v_cvt_pk_bf16_f32 v66, v68, v69
    v_cvt_pk_bf16_f32 v67, v70, v71
    v_cvt_pk_bf16_f32 v68, v72, v73
    v_cvt_pk_bf16_f32 v69, v74, v75
    buffer_store_dwordx4 v[64:67], v60, s[12:15], s36 offen offset:1152 sc0 sc1
    buffer_store_dwordx2 v[68:69], v61, s[12:15], s36 offen offset:1408 sc0 sc1
    s_branch L_fin
.section .rodata,"a"
.p2align 6
.amdhsa_kernel standalone__kv_cache_quant_int4_int2_kv_with_per_channel_or_per_token_scales__prompt_kernel
  .amdhsa_next_free_vgpr 512
  .amdhsa_next_free_sgpr 102
  .amdhsa_accum_offset 256
  .amdhsa_group_segment_fixed_size 0
  .amdhsa_kernarg_size 80
  .amdhsa_user_sgpr_count 2
  .amdhsa_user_sgpr_kernarg_segment_ptr 1
  .amdhsa_system_sgpr_workgroup_id_x 1
.end_amdhsa_kernel
```

```asm
; @launch grid=(256,1,1) block=(256,1,1) lds=161920
.amdgcn_target "amdgcn-amd-amdhsa--gfx950"
.text
.globl standalone__kv_cache_quant_int4_int2_kv_with_per_channel_or_per_token_scales__prompt_kernel
.p2align 8
.type standalone__kv_cache_quant_int4_int2_kv_with_per_channel_or_per_token_scales__prompt_kernel,@function
standalone__kv_cache_quant_int4_int2_kv_with_per_channel_or_per_token_scales__prompt_kernel:
    s_load_dwordx16 s[40:55], s[0:1], 0
    s_getpc_b64 s[60:61]
L_pc:
    s_movk_i32 s62, 0x4000
    s_lshl_b32 s63, 1, 17
    v_lshlrev_b32 v31, 6, v0
    buffer_load_dword v15, v31, s[60:63], 0 offen
    s_lshr_b32 s24, s2, 8
    s_cbranch_scc1 L_done
    s_load_dwordx4 s[16:19], s[0:1], 64
    v_lshlrev_b32 v30, 4, v0
    v_and_b32 v25, 63, v0
    v_lshrrev_b32 v24, 6, v0
    s_movk_i32 s24, 5120
    v_mul_u32_u24 v26, 43, v25
    v_mad_u32_u24 v12, v24, s24, v30
    s_movk_i32 s24, 384
    v_lshrrev_b32 v26, 10, v26
    s_and_b32 s22, s2, 7
    s_mul_i32 s29, s22, 264
    v_mad_u32_u24 v9, v26, s24, v12
    s_andn2_b32 s23, s2, 63
    s_bfe_u32 s95, s2, 0x30003
    s_add_u32 s29, s29, s23
    s_add_u32 s29, s29, s95
    s_lshr_b32 s23, s29, 1
    s_mulk_i32 s23, 384
    s_mul_i32 s24, s29, 24576
    v_lshl_add_u32 v27, v25, 3, s23
    s_addk_i32 s24, 2048
    s_mov_b32 exec_hi, 0xffff
    s_waitcnt lgkmcnt(0)
    global_load_dwordx2 v[32:33], v27, s[46:47]
    global_load_dwordx2 v[34:35], v27, s[48:49]
    s_add_u32 s56, s42, s24
    s_addc_u32 s57, s43, 0
    global_load_dwordx4 v[64:67], v9, s[56:57] offset:-2048 nt
    global_load_dwordx4 v[68:71], v9, s[56:57] offset:-512 nt
    global_load_dwordx4 v[72:75], v9, s[56:57] offset:1024 nt
    global_load_dwordx4 v[76:79], v9, s[56:57] offset:2560 nt
    global_load_dwordx4 v[80:83], v9, s[56:57] offset:-1664 nt
    global_load_dwordx4 v[84:87], v9, s[56:57] offset:-128 nt
    global_load_dwordx4 v[88:91], v9, s[56:57] offset:1408 nt
    global_load_dwordx4 v[92:95], v9, s[56:57] offset:2944 nt
    s_add_u32 s58, s44, s24
    s_addc_u32 s59, s45, 0
    global_load_dwordx4 v[96:99], v12, s[58:59] offset:-2048 nt
    global_load_dwordx4 v[100:103], v12, s[58:59] offset:-1280 nt
    global_load_dwordx4 v[104:107], v12, s[58:59] offset:-512 nt
    global_load_dwordx4 v[108:111], v12, s[58:59] offset:256 nt
    v_readfirstlane_b32 s25, v24
    s_lshl_b32 s23, s29, 6
    s_lshr_b32 s94, s29, 6
    s_lshl4_add_u32 s23, s25, s23
    s_load_dwordx4 s[64:67], s[50:51], s23
    s_load_dwordx4 s[68:71], s[52:53], s23
    s_lshl_b32 s22, s94, 10
    s_add_u32 s22, s22, 67108864
    s_or_b32 s83, s95, s25
    s_cbranch_scc1 L_notleader0
    s_load_dwordx8 s[72:79], s[18:19], s22 glc
L_notleader0:
    s_mov_b32 exec_hi, -1
    s_mov_b32 exec_hi, 0xffff
    global_load_dwordx4 v[112:115], v12, s[58:59] offset:1024 nt
    s_mov_b32 exec_hi, -1
    s_mul_i32 s24, s94, 786432
    s_add_u32 s8, s40, s24
    s_addc_u32 s9, s41, 0
    s_mov_b32 s10, 786432
    s_mov_b32 s11, 0x20000
    s_add_u32 s12, s54, s24
    s_addc_u32 s13, s55, 0
    s_mov_b32 s14, 786432
    s_mov_b32 s15, 0x20000
    s_lshl2_add_u32 s24, s95, s25
    s_mul_i32 s24, s24, 24576
    s_mul_i32 s82, s25, 6144
    s_add_u32 s82, s82, 73728
    v_add_u32 v208, 0, v25
    v_add_u32 v209, 64, v25
    v_add_u32 v210, 128, v25
    v_add_u32 v211, 192, v25
    v_add_u32 v212, 256, v25
    v_add_u32 v213, 320, v25
    v_mul_u32_u24 v216, 2731, v208
    v_mul_u32_u24 v217, 2731, v209
    v_mul_u32_u24 v218, 2731, v210
    v_mul_u32_u24 v219, 2731, v211
    v_mul_u32_u24 v220, 2731, v212
    s_mov_b32 exec_hi, 0xffff
    global_load_dwordx4 v[116:119], v12, s[58:59] offset:1792 nt
    s_mov_b32 exec_hi, -1
    v_mul_u32_u24 v221, 2731, v213
    v_bfe_u32 v216, v216, 17, 3
    v_bfe_u32 v217, v217, 17, 3
    v_bfe_u32 v218, v218, 17, 3
    v_bfe_u32 v219, v219, 17, 3
    v_bfe_u32 v220, v220, 17, 3
    v_bfe_u32 v221, v221, 17, 3
    v_xor_b32 v208, v208, v216
    v_xor_b32 v209, v209, v217
    v_xor_b32 v210, v210, v218
    v_xor_b32 v211, v211, v219
    v_xor_b32 v212, v212, v220
    v_xor_b32 v213, v213, v221
    v_lshl_add_u32 v208, v208, 4, s24
    v_lshl_add_u32 v209, v209, 4, s24
    v_lshl_add_u32 v210, v210, 4, s24
    v_lshl_add_u32 v211, v211, 4, s24
    v_lshl_add_u32 v212, v212, 4, s24
    v_lshl_add_u32 v213, v213, 4, s24
    v_mov_b32 v16, 0
    v_mov_b32 v17, 147456
    ds_write_b32 v17, v16
    s_mov_b32 s97, 0xffff0000
    s_mov_b32 s38, 0x3dd53b95
    v_mul_u32_u24 v27, 24, v26
    s_mov_b32 exec_hi, 0xffff
    global_load_dwordx4 v[120:123], v12, s[58:59] offset:2560 nt
    s_mov_b32 exec_hi, -1
    v_sub_u32 v27, v25, v27
    v_lshlrev_b32 v10, 4, v27
    v_add_u32 v10, 147584, v10
    v_mul_u32_u24 v36, 768, v26
    v_add_u32 v36, v36, v10
    s_waitcnt vmcnt(15)
    v_lshlrev_b32 v128, 16, v32
    v_and_b32 v129, s97, v32
    v_lshlrev_b32 v130, 16, v34
    v_and_b32 v131, s97, v34
    v_lshlrev_b32 v132, 16, v33
    v_and_b32 v133, s97, v33
    v_lshlrev_b32 v134, 16, v35
    v_and_b32 v135, s97, v35
    v_mul_f32 v128, s38, v128
    v_mul_f32 v129, s38, v129
    v_mul_f32 v132, s38, v132
    v_mul_f32 v133, s38, v133
    v_mul_f32_e64 v130, -v130, v128
    v_mul_f32_e64 v131, -v131, v129
    v_mul_f32_e64 v134, -v134, v132
    v_mul_f32_e64 v135, -v135, v133
    s_mov_b32 exec_hi, 0xffff
    ds_write_b128 v36, v[128:131] offset:0
    ds_write_b128 v36, v[132:135] offset:384
    s_mov_b32 exec_hi, -1
    ds_read_b128 v[128:131], v10 offset:0
    ds_read_b128 v[132:135], v10 offset:384
    s_mov_b32 exec_hi, 0xffff
    global_load_dwordx4 v[124:127], v12, s[58:59] offset:3328 nt
    s_mov_b32 exec_hi, -1
    ds_read_b128 v[136:139], v10 offset:768
    ds_read_b128 v[140:143], v10 offset:1152
    v_lshrrev_b32 v48, 1, v26
    v_lshlrev_b32 v48, 30, v48
    v_lshlrev_b32 v31, 4, v25
    v_mul_u32_u24 v30, 3072, v24
    v_add_u32 v8, v30, v31
    v_lshl_add_u32 v49, v24, 2, v26
    v_mul_u32_u24 v49, 384, v49
    v_lshlrev_b32 v50, 1, v24
    v_xor_b32 v50, v27, v50
    v_lshl_add_u32 v49, v50, 4, v49
    v_or_b32 v11, v49, v48
    v_xor_b32 v54, 16, v11
    v_lshrrev_b32 v49, 5, v25
    v_sub_u32 v49, 1, v49
    v_and_b32 v49, v49, v24
    v_lshlrev_b32 v49, 4, v49
    v_xor_b32 v49, v49, v8
    v_add_u32 v49, 12288, v49
    v_or_b32 v20, v49, v48
    s_mul_i32 s37, s95, 24576
    s_add_u32 s80, s37, 6144
    s_mov_b32 s81, s37
    s_mul_i32 s39, s94, 1769472
    s_mov_b32 s62, L_slow-L_pc
    s_bfe_u32 s24, s2, 0x20003
    s_add_u32 s24, s24, 1
    s_lshl_b32 s24, s24, 14
    v_lshlrev_b32 v15, 6, v0
    buffer_load_dword v15, v15, s[60:63], s24 offen
    v_or_b32 v9, v9, v48
    v_or_b32 v12, v12, v48
    s_waitcnt lgkmcnt(0)
    s_barrier
    s_add_u32 s4, s18, s39
    s_addc_u32 s5, s19, 0
    s_mov_b32 s6, 1572864
    s_mov_b32 s7, 0x20000
    s_add_u32 s20, s18, s22
    s_addc_u32 s21, s19, 0
    s_mov_b32 s22, 32
    s_mov_b32 s23, 0x20000
    s_mov_b32 s88, s16
    s_mov_b32 s89, s17
    s_movk_i32 s90, 256
    s_mov_b32 s91, s63
    s_lshl_b32 s93, s94, 3
    s_cmp_lg_u32 s83, 0
    s_cbranch_scc1 L_notleader
    s_mov_b32 s24, 1
    s_lshr_b32 s72, s72, 8
    s_min_u32 s72, s72, 31
    s_bitset1_b32 s24, s72
    s_lshr_b32 s73, s73, 8
    s_min_u32 s73, s73, 31
    s_bitset1_b32 s24, s73
    s_lshr_b32 s74, s74, 8
    s_min_u32 s74, s74, 31
    s_bitset1_b32 s24, s74
    s_lshr_b32 s75, s75, 8
    s_min_u32 s75, s75, 31
    s_bitset1_b32 s24, s75
    s_lshr_b32 s76, s76, 8
    s_min_u32 s76, s76, 31
    s_bitset1_b32 s24, s76
    s_lshr_b32 s77, s77, 8
    s_min_u32 s77, s77, 31
    s_bitset1_b32 s24, s77
    s_lshr_b32 s78, s78, 8
    s_min_u32 s78, s78, 31
    s_bitset1_b32 s24, s78
    s_lshr_b32 s79, s79, 8
    s_min_u32 s79, s79, 31
    s_bitset1_b32 s24, s79
    s_ff0_i32_b32 s24, s24
    s_lshl_b32 s24, s24, 8
    v_mov_b32 v52, s24
    s_mov_b64 exec, 1
    buffer_store_dword v52, off, s[88:91], s93 sc1
    s_mov_b64 exec, -1
L_notleader:
    s_add_u32 m0, s82, 0
    s_movk_i32 s24, 0
    buffer_load_dwordx4 v208, s[8:11], s24 offen nt lds
    s_waitcnt vmcnt(16)
    v_cvt_f32_i32 v64, v64
    v_cvt_f32_i32 v65, v65
    v_cvt_f32_i32 v68, v68
    v_cvt_f32_i32 v69, v69
    v_fma_f32 v64, v64, v128, v130
    v_fma_f32 v65, v65, v129, v131
    v_fma_f32 v68, v68, v128, v130
    v_fma_f32 v69, v69, v129, v131
    v_cvt_pk_bf16_f32 v64, v64, v65
    v_cvt_pk_bf16_f32 v68, v68, v69
    v_cvt_f32_i32 v66, v66
    v_cvt_f32_i32 v67, v67
    v_cvt_f32_i32 v70, v70
    v_cvt_f32_i32 v71, v71
    v_fma_f32 v66, v66, v132, v134
    v_fma_f32 v67, v67, v133, v135
    v_fma_f32 v70, v70, v132, v134
    v_fma_f32 v71, v71, v133, v135
    v_cvt_pk_bf16_f32 v65, v66, v67
    v_cvt_pk_bf16_f32 v69, v70, v71
    s_waitcnt vmcnt(14)
    v_cvt_f32_i32 v72, v72
    v_cvt_f32_i32 v73, v73
    v_cvt_f32_i32 v76, v76
    v_cvt_f32_i32 v77, v77
    v_fma_f32 v72, v72, v128, v130
    v_fma_f32 v73, v73, v129, v131
    s_add_u32 m0, s82, 1024
    s_movk_i32 s24, 0
    buffer_load_dwordx4 v209, s[8:11], s24 offen nt lds
    v_fma_f32 v76, v76, v128, v130
    v_fma_f32 v77, v77, v129, v131
    v_cvt_pk_bf16_f32 v72, v72, v73
    v_cvt_pk_bf16_f32 v76, v76, v77
    v_cvt_f32_i32 v74, v74
    v_cvt_f32_i32 v75, v75
    v_cvt_f32_i32 v78, v78
    v_cvt_f32_i32 v79, v79
    v_fma_f32 v74, v74, v132, v134
    v_fma_f32 v75, v75, v133, v135
    v_fma_f32 v78, v78, v132, v134
    v_fma_f32 v79, v79, v133, v135
    v_cvt_pk_bf16_f32 v73, v74, v75
    v_cvt_pk_bf16_f32 v77, v78, v79
    s_waitcnt vmcnt(13)
    v_cvt_f32_i32 v80, v80
    v_cvt_f32_i32 v81, v81
    v_cvt_f32_i32 v84, v84
    v_cvt_f32_i32 v85, v85
    v_fma_f32 v80, v80, v136, v138
    v_fma_f32 v81, v81, v137, v139
    v_fma_f32 v84, v84, v136, v138
    v_fma_f32 v85, v85, v137, v139
    v_cvt_pk_bf16_f32 v66, v80, v81
    v_cvt_pk_bf16_f32 v70, v84, v85
    v_cvt_f32_i32 v82, v82
    v_cvt_f32_i32 v83, v83
    v_cvt_f32_i32 v86, v86
    s_add_u32 m0, s82, 2048
    s_movk_i32 s24, 0
    buffer_load_dwordx4 v210, s[8:11], s24 offen nt lds
    v_cvt_f32_i32 v87, v87
    v_fma_f32 v82, v82, v140, v142
    v_fma_f32 v83, v83, v141, v143
    v_fma_f32 v86, v86, v140, v142
    v_fma_f32 v87, v87, v141, v143
    v_cvt_pk_bf16_f32 v67, v82, v83
    v_cvt_pk_bf16_f32 v71, v86, v87
    s_waitcnt vmcnt(12)
    v_cvt_f32_i32 v88, v88
    v_cvt_f32_i32 v89, v89
    v_cvt_f32_i32 v92, v92
    v_cvt_f32_i32 v93, v93
    v_fma_f32 v88, v88, v136, v138
    v_fma_f32 v89, v89, v137, v139
    v_fma_f32 v92, v92, v136, v138
    v_fma_f32 v93, v93, v137, v139
    v_cvt_pk_bf16_f32 v74, v88, v89
    v_cvt_pk_bf16_f32 v78, v92, v93
    v_cvt_f32_i32 v90, v90
    v_cvt_f32_i32 v91, v91
    v_cvt_f32_i32 v94, v94
    v_cvt_f32_i32 v95, v95
    v_fma_f32 v90, v90, v140, v142
    v_fma_f32 v91, v91, v141, v143
    v_fma_f32 v94, v94, v140, v142
    v_fma_f32 v95, v95, v141, v143
    v_cvt_pk_bf16_f32 v75, v90, v91
    v_cvt_pk_bf16_f32 v79, v94, v95
    buffer_store_dwordx4 v[64:67], v11, s[4:7], s37 offen offset:0 sc1
    buffer_store_dwordx4 v[68:71], v54, s[4:7], s37 offen offset:768 sc1
    buffer_store_dwordx4 v[72:75], v11, s[4:7], s80 offen offset:0 sc1
    buffer_store_dwordx4 v[76:79], v54, s[4:7], s80 offen offset:768 sc1
    s_mov_b32 exec_hi, 0xffff
    ds_write_b128 v11, v[64:67] offset:0
    ds_write_b128 v54, v[68:71] offset:768
    ds_write_b128 v11, v[72:75] offset:6144
    ds_write_b128 v54, v[76:79] offset:6912
    s_mov_b32 exec_hi, -1
    s_add_u32 m0, s82, 3072
    s_movk_i32 s24, 0
    buffer_load_dwordx4 v211, s[8:11], s24 offen nt lds
    s_lshl_b32 s57, s64, 16
    s_and_b32 s58, s64, s97
    v_mov_b32 v128, s57
    v_mov_b32 v129, s58
    s_lshl_b32 s57, s68, 16
    s_and_b32 s58, s68, s97
    v_mul_f32_e64 v130, -s57, v128
    v_mul_f32_e64 v131, -s58, v129
    s_lshl_b32 s57, s65, 16
    s_and_b32 s58, s65, s97
    v_mov_b32 v132, s57
    v_mov_b32 v133, s58
    s_lshl_b32 s57, s69, 16
    s_and_b32 s58, s69, s97
    v_mul_f32_e64 v134, -s57, v132
    v_mul_f32_e64 v135, -s58, v133
    s_lshl_b32 s57, s66, 16
    s_and_b32 s58, s66, s97
    v_mov_b32 v136, s57
    v_mov_b32 v137, s58
    s_lshl_b32 s57, s70, 16
    s_and_b32 s58, s70, s97
    v_mul_f32_e64 v138, -s57, v136
    v_mul_f32_e64 v139, -s58, v137
    s_lshl_b32 s57, s67, 16
    s_and_b32 s58, s67, s97
    v_mov_b32 v140, s57
    v_mov_b32 v141, s58
    s_lshl_b32 s57, s71, 16
    s_and_b32 s58, s71, s97
    v_mul_f32_e64 v142, -s57, v140
    v_mul_f32_e64 v143, -s58, v141
    s_waitcnt vmcnt(15)
    v_cvt_f32_i32 v96, v96
    v_cvt_f32_i32 v100, v100
    v_cvt_f32_i32 v97, v97
    v_cvt_f32_i32 v101, v101
    v_fma_f32 v96, v96, v128, v130
    s_add_u32 m0, s82, 4096
    s_movk_i32 s24, 0
    buffer_load_dwordx4 v212, s[8:11], s24 offen nt lds
    v_fma_f32 v100, v100, v129, v131
    v_fma_f32 v97, v97, v128, v130
    v_fma_f32 v101, v101, v129, v131
    v_cvt_f32_i32 v98, v98
    v_cvt_f32_i32 v102, v102
    v_cvt_f32_i32 v99, v99
    v_cvt_f32_i32 v103, v103
    v_fma_f32 v98, v98, v128, v130
    v_fma_f32 v102, v102, v129, v131
    v_fma_f32 v99, v99, v128, v130
    v_fma_f32 v103, v103, v129, v131
    s_waitcnt vmcnt(14)
    v_cvt_f32_i32 v104, v104
    v_cvt_f32_i32 v108, v108
    v_cvt_f32_i32 v105, v105
    v_cvt_f32_i32 v109, v109
    v_fma_f32 v104, v104, v132, v134
    v_fma_f32 v108, v108, v133, v135
    v_fma_f32 v105, v105, v132, v134
    v_fma_f32 v109, v109, v133, v135
    v_cvt_f32_i32 v106, v106
    v_cvt_f32_i32 v110, v110
    v_cvt_f32_i32 v107, v107
    v_cvt_f32_i32 v111, v111
    v_fma_f32 v106, v106, v132, v134
    v_fma_f32 v110, v110, v133, v135
    v_fma_f32 v107, v107, v132, v134
    v_fma_f32 v111, v111, v133, v135
    v_cvt_pk_bf16_f32 v96, v96, v100
    v_cvt_pk_bf16_f32 v100, v97, v101
    v_cvt_pk_bf16_f32 v97, v104, v108
    v_cvt_pk_bf16_f32 v101, v105, v109
    v_cvt_pk_bf16_f32 v104, v98, v102
    v_cvt_pk_bf16_f32 v105, v106, v110
    v_cvt_pk_bf16_f32 v108, v99, v103
    v_cvt_pk_bf16_f32 v109, v107, v111
    s_waitcnt vmcnt(12)
    v_cvt_f32_i32 v112, v112
    v_cvt_f32_i32 v116, v116
    s_add_u32 m0, s82, 5120
    s_movk_i32 s24, 0
    buffer_load_dwordx4 v213, s[8:11], s24 offen nt lds
    v_cvt_f32_i32 v113, v113
    v_cvt_f32_i32 v117, v117
    v_fma_f32 v112, v112, v136, v138
    v_fma_f32 v116, v116, v137, v139
    v_fma_f32 v113, v113, v136, v138
    v_fma_f32 v117, v117, v137, v139
    v_cvt_f32_i32 v114, v114
    v_cvt_f32_i32 v118, v118
    v_cvt_f32_i32 v115, v115
    v_cvt_f32_i32 v119, v119
    v_fma_f32 v114, v114, v136, v138
    v_fma_f32 v118, v118, v137, v139
    v_fma_f32 v115, v115, v136, v138
    v_fma_f32 v119, v119, v137, v139
    s_waitcnt vmcnt(11)
    v_cvt_f32_i32 v120, v120
    v_cvt_f32_i32 v124, v124
    v_cvt_f32_i32 v121, v121
    v_cvt_f32_i32 v125, v125
    v_fma_f32 v120, v120, v140, v142
    v_fma_f32 v124, v124, v141, v143
    v_fma_f32 v121, v121, v140, v142
    v_fma_f32 v125, v125, v141, v143
    v_cvt_f32_i32 v122, v122
    v_cvt_f32_i32 v126, v126
    v_cvt_f32_i32 v123, v123
    v_cvt_f32_i32 v127, v127
    v_fma_f32 v122, v122, v140, v142
    v_fma_f32 v126, v126, v141, v143
    v_fma_f32 v123, v123, v140, v142
    v_fma_f32 v127, v127, v141, v143
    v_cvt_pk_bf16_f32 v98, v112, v116
    v_cvt_pk_bf16_f32 v102, v113, v117
    v_cvt_pk_bf16_f32 v99, v120, v124
    v_cvt_pk_bf16_f32 v103, v121, v125
    v_cvt_pk_bf16_f32 v106, v114, v118
    v_cvt_pk_bf16_f32 v107, v122, v126
    v_cvt_pk_bf16_f32 v110, v115, v119
    v_cvt_pk_bf16_f32 v111, v123, v127
    buffer_store_dwordx4 v[96:99], v20, s[4:7], s81 offen offset:0 sc1
    buffer_store_dwordx4 v[100:103], v20, s[4:7], s81 offen offset:768 sc1
    buffer_store_dwordx4 v[104:107], v20, s[4:7], s81 offen offset:1536 sc1
    buffer_store_dwordx4 v[108:111], v20, s[4:7], s81 offen offset:2304 sc1
    s_mov_b32 exec_hi, 0xffff
    ds_write_b128 v20, v[96:99] offset:12288
    ds_write_b128 v20, v[100:103] offset:13056
    ds_write_b128 v20, v[104:107] offset:13824
    ds_write_b128 v20, v[108:111] offset:14592
    s_mov_b32 exec_hi, -1
    v_mov_b32 v52, 0
    buffer_load_dword v52, off, s[88:91], s93 sc1
    s_lshl_b32 s39, s95, 2
    v_lshl_add_u32 v13, v0, 2, s39
    v_cmp_lt_u32 vcc, 0, v0
    v_mov_b32 v30, 0x40000000
    s_mov_b32 s96, 100000
    v_cndmask_b32 v13, v13, v30, vcc
    s_mul_i32 s39, s94, 1572864
    s_add_u32 s64, s42, s39
    s_addc_u32 s65, s43, 0
    s_mov_b32 s66, 1572864
    s_mov_b32 s67, 0x20000
    s_add_u32 s68, s44, s39
    s_addc_u32 s69, s45, 0
    s_mov_b32 s70, 1572864
    s_mov_b32 s71, 0x20000
    s_waitcnt vmcnt(11)
    s_add_u32 m0, s82, 24576
    s_movk_i32 s24, 6144
    buffer_load_dwordx4 v208, s[8:11], s24 offen nt lds
    s_and_b32 s33, s29, 63
    s_mul_i32 s33, s33, 24576
    s_mov_b32 s35, s33
    s_mul_i32 s26, s25, 3072
    s_add_u32 s26, s26, 12288
    s_add_u32 s56, s26, 24576
    s_add_u32 s39, s95, 1
    s_and_b32 s39, s39, 7
    s_mul_i32 s32, s39, 24576
    s_waitcnt vmcnt(11)
    s_add_u32 m0, s82, 25600
    s_movk_i32 s24, 6144
    buffer_load_dwordx4 v209, s[8:11], s24 offen nt lds
    s_add_u32 s27, s32, 12288
    s_mov_b32 s28, 0
    s_mov_b32 s30, 24576
    v_and_b32 v26, 15, v25
    v_lshrrev_b32 v49, 4, v25
    v_bfe_u32 v28, v25, 1, 3
    v_xor_b32 v29, v49, v28
    v_mul_u32_u24 v30, 384, v26
    v_lshl_add_u32 v2, v29, 4, v30
    s_waitcnt vmcnt(11)
    s_add_u32 m0, s82, 26624
    s_movk_i32 s24, 6144
    buffer_load_dwordx4 v210, s[8:11], s24 offen nt lds
    v_xor_b32 v3, 64, v2
    v_mul_u32_u24 v50, 3072, v49
    v_add_u32 v50, 24576, v50
    v_and_b32 v51, 1, v49
    v_lshl_add_u32 v51, v26, 1, v51
    v_lshl_add_u32 v1, v51, 4, v50
    v_xor_b32 v21, 16, v1
    v_lshl_add_u32 v22, v26, 4, v50
    v_add_u32 v22, 512, v22
    s_waitcnt vmcnt(11)
    s_add_u32 m0, s82, 27648
    s_movk_i32 s24, 6144
    buffer_load_dwordx4 v211, s[8:11], s24 offen nt lds
    v_lshrrev_b32 v29, 1, v49
    v_xor_b32 v29, v29, v28
    v_lshl_add_u32 v31, v29, 4, v30
    v_and_b32 v29, 1, v49
    v_lshl_add_u32 v31, v29, 3, v31
    v_add_u32 v0, s82, v31
    v_mov_b32 v4, 0
    v_mov_b32 v5, 0
    v_mov_b32 v6, 0
    v_mov_b32 v7, 0
    s_branch L_anchor
.p2align 12
L_anchor:
    s_cmp_eq_u32 s25, 1
    s_cbranch_scc1 L_t1_1
    s_cmp_eq_u32 s25, 2
    s_cbranch_scc1 L_t1_2
    s_cmp_eq_u32 s25, 3
    s_cbranch_scc1 L_t1_3
L_t1_0:
    s_branch L_pad14
L_tb1_0:
    s_branch L_pad10
L_tb1_4:
    s_branch L_pad6
L_tb1_8:
    s_branch L_pad2
L_tb1_12:
    s_branch L_t1_end
L_t1_1:
    s_branch L_pad13
L_tb1_1:
    s_branch L_pad9
L_tb1_5:
    s_branch L_pad5
L_tb1_9:
    s_branch L_pad1
L_tb1_13:
    s_branch L_t1_end
L_t1_2:
    s_branch L_pad12
L_tb1_2:
    s_branch L_pad8
L_tb1_6:
    s_branch L_pad4
L_tb1_10:
    s_branch L_t1_end
L_t1_3:
    s_branch L_pad11
L_tb1_3:
    s_branch L_pad7
L_tb1_7:
    s_branch L_pad3
L_tb1_11:
L_t1_end:
    s_waitcnt vmcnt(4)
    v_readfirstlane_b32 s92, v52
    s_mov_b32 s39, 100
L_tagretry:
    s_cmp_lg_u32 s92, 0
    s_cbranch_scc1 L_tagok
    s_sub_u32 s39, s39, 1
    s_cbranch_scc1 L_tagslow
    s_sleep 8
    s_buffer_load_dword s92, s[88:91], s93 glc
    s_waitcnt lgkmcnt(0)
    s_branch L_tagretry
L_tagok:
    s_add_u32 s92, s92, 1
    v_mov_b32 v55, s92
    s_mov_b64 exec, 1
    v_mov_b32 v16, 1
    v_mov_b32 v17, 147456
    ds_add_rtn_u32 v16, v17, v16
    s_waitcnt lgkmcnt(0)
    v_readfirstlane_b32 s24, v16
    s_nop 0
    s_cmp_lg_u32 s24, 3
    s_cbranch_scc1 L_nopost
    s_lshl_b32 s39, s95, 2
    buffer_store_dword v55, off, s[20:23], s39 sc1
L_nopost:
    s_mov_b64 exec, -1
    s_waitcnt vmcnt(11)
    s_add_u32 m0, s82, 28672
    s_movk_i32 s24, 6144
    buffer_load_dwordx4 v212, s[8:11], s24 offen nt lds
    s_waitcnt vmcnt(11)
    s_add_u32 m0, s82, 29696
    s_movk_i32 s24, 6144
    buffer_load_dwordx4 v213, s[8:11], s24 offen nt lds
    s_lshl_b32 s24, s25, 4
    s_add_u32 s24, s24, s29
    s_and_b32 s58, s24, 63
    s_add_u32 s24, s24, 8
    s_and_b32 s57, s24, 63
    s_andn2_b32 s24, s29, 63
    s_or_b32 s58, s58, s24
    s_or_b32 s57, s57, s24
    v_mov_b32 v37, s58
    v_mov_b32 v38, s57
    v_cmp_lt_u32 vcc, 15, v25
    s_lshr_b32 s58, s58, 1
    s_lshr_b32 s57, s57, 1
    s_mulk_i32 s58, 384
    s_mulk_i32 s57, 384
    v_cndmask_b32 v37, v37, v38, vcc
    v_lshl_add_u32 v38, v25, 3, s58
    v_lshl_add_u32 v39, v25, 3, s57
    v_lshlrev_b32 v37, 6, v37
    v_lshl_add_u32 v37, v26, 2, v37
    s_mov_b32 exec_hi, 0xffff
    global_load_dwordx2 v[80:81], v38, s[46:47]
    global_load_dwordx2 v[82:83], v38, s[48:49]
    global_load_dwordx2 v[84:85], v39, s[46:47]
    global_load_dwordx2 v[86:87], v39, s[48:49]
    s_mov_b32 exec_hi, 0
    global_load_dword v88, v37, s[50:51]
    global_load_dword v89, v37, s[52:53]
    s_mov_b32 exec_hi, -1
    v_xor_b32 v17, 32, v0
    v_xor_b32 v18, 64, v0
    v_xor_b32 v19, 96, v0
    s_waitcnt vmcnt(17)
    ds_read_b64 a[192:193], v0 offset:0
    ds_read_b64 a[194:195], v18 offset:128
    ds_read_b64 a[196:197], v17 offset:0
    ds_read_b64 a[198:199], v19 offset:128
    ds_read_b64 a[200:201], v18 offset:0
    ds_read_b64 a[202:203], v0 offset:256
    ds_read_b64 a[204:205], v19 offset:0
    ds_read_b64 a[206:207], v17 offset:256
    ds_read_b64 a[208:209], v0 offset:128
    ds_read_b64 a[210:211], v18 offset:256
    ds_read_b64 a[212:213], v17 offset:128
    ds_read_b64 a[214:215], v19 offset:256
    s_waitcnt lgkmcnt(0)
    s_barrier
    ds_read_b128 v[144:147], v2 offset:0
    ds_read_b128 v[148:151], v3 offset:0
    ds_read_b128 v[152:155], v2 offset:6144
    ds_read_b128 v[156:159], v3 offset:6144
    ds_read_b128 v[160:163], v2 offset:128
    ds_read_b128 v[164:167], v3 offset:128
    ds_read_b128 v[168:171], v2 offset:6272
    ds_read_b128 v[172:175], v3 offset:6272
    ds_read_b128 v[176:179], v2 offset:256
    ds_read_b128 v[180:183], v3 offset:256
    ds_read_b128 v[184:187], v2 offset:6400
    ds_read_b128 v[188:191], v3 offset:6400
    s_waitcnt lgkmcnt(0)
    v_mfma_f32_16x16x32_bf16 v[64:67], v[144:147], a[192:195], 0
    v_mfma_f32_16x16x32_bf16 v[64:67], v[148:151], a[196:199], v[64:67]
    v_mfma_f32_16x16x32_bf16 v[64:67], v[160:163], a[200:203], v[64:67]
    v_mfma_f32_16x16x32_bf16 v[64:67], v[164:167], a[204:207], v[64:67]
    v_mfma_f32_16x16x32_bf16 v[64:67], v[176:179], a[208:211], v[64:67]
    v_mfma_f32_16x16x32_bf16 v[64:67], v[180:183], a[212:215], v[64:67]
    v_mfma_f32_16x16x32_bf16 v[96:99], v[152:155], a[192:195], 0
    v_mfma_f32_16x16x32_bf16 v[96:99], v[156:159], a[196:199], v[96:99]
    v_mfma_f32_16x16x32_bf16 v[96:99], v[168:171], a[200:203], v[96:99]
    v_mfma_f32_16x16x32_bf16 v[96:99], v[172:175], a[204:207], v[96:99]
    v_mfma_f32_16x16x32_bf16 v[96:99], v[184:187], a[208:211], v[96:99]
    v_mfma_f32_16x16x32_bf16 v[96:99], v[188:191], a[212:215], v[96:99]
    s_nop 7
    s_waitcnt vmcnt(11)
    s_add_u32 m0, s82, 49152
    s_movk_i32 s24, 12288
    buffer_load_dwordx4 v208, s[8:11], s24 offen nt lds
    v_max3_f32 v48, v64, v65, v66
    v_max3_f32 v48, v48, v67, v96
    v_max3_f32 v48, v48, v97, v98
    v_max_f32 v48, v48, v99
    v_mov_b32 v49, v48
    s_nop 1
    v_permlane16_swap_b32 v48, v49
    s_nop 1
    v_max_f32 v48, v48, v49
    v_mov_b32 v49, v48
    s_nop 1
    v_permlane32_swap_b32 v48, v49
    s_nop 1
    v_max_f32 v48, v48, v49
    v_sub_f32 v128, 0, v48
    v_sub_f32 v129, 0, v48
    v_sub_f32 v130, 0, v48
    v_sub_f32 v131, 0, v48
    v_sub_f32 v64, v64, v48
    v_sub_f32 v65, v65, v48
    v_sub_f32 v66, v66, v48
    v_sub_f32 v67, v67, v48
    v_sub_f32 v96, v96, v48
    s_waitcnt vmcnt(11)
    s_add_u32 m0, s82, 50176
    s_movk_i32 s24, 12288
    buffer_load_dwordx4 v209, s[8:11], s24 offen nt lds
    v_sub_f32 v97, v97, v48
    v_sub_f32 v98, v98, v48
    v_sub_f32 v99, v99, v48
    v_exp_f32 v64, v64
    v_exp_f32 v65, v65
    v_exp_f32 v66, v66
    v_exp_f32 v67, v67
    v_exp_f32 v96, v96
    v_exp_f32 v97, v97
    v_exp_f32 v98, v98
    v_exp_f32 v99, v99
    v_add_f32 v4, v4, v64
    v_add_f32 v4, v4, v65
    v_add_f32 v4, v4, v66
    v_add_f32 v4, v4, v67
    v_add_f32 v4, v4, v96
    v_add_f32 v4, v4, v97
    v_add_f32 v4, v4, v98
    v_add_f32 v4, v4, v99
    v_cvt_pk_bf16_f32 v64, v64, v65
    v_cvt_pk_bf16_f32 v65, v66, v67
    v_cvt_pk_bf16_f32 v66, v96, v97
    v_cvt_pk_bf16_f32 v67, v98, v99
    s_buffer_load_dwordx8 s[72:79], s[20:23], 0 glc
    s_waitcnt vmcnt(8)
    s_add_u32 m0, s82, 51200
    s_movk_i32 s24, 12288
    buffer_load_dwordx4 v210, s[8:11], s24 offen nt lds
    s_add_u32 s33, s33, 196608
    s_sub_u32 s34, s33, 1572864
    s_min_u32 s33, s33, s34
    s_add_u32 s34, s33, 3072
    s_add_u32 s37, s37, 196608
    s_add_u32 s80, s80, 196608
    s_add_u32 s35, s35, 196608
    s_sub_u32 s36, s35, 1572864
    s_min_u32 s35, s35, s36
    s_add_u32 s36, s35, 3072
    s_add_u32 s81, s81, 196608
    s_mov_b32 s88, s60
    s_mov_b32 s89, s61
    s_mov_b32 s90, L_slow-L_pc
    s_lshr_b32 s59, s2, 3
    s_mul_i32 s93, s59, 43
    s_lshr_b32 s93, s93, 7
    s_mul_i32 s39, s93, 3
    s_sub_u32 s59, s59, s39
    s_lshl_b32 s59, s59, 10
    s_mul_i32 s93, s93, 12288
    s_add_u32 s93, s93, s59
    s_waitcnt vmcnt(3)
    v_lshlrev_b32 v112, 16, v80
    v_and_b32 v113, s97, v80
    v_lshlrev_b32 v114, 16, v82
    v_and_b32 v115, s97, v82
    v_lshlrev_b32 v116, 16, v81
    v_and_b32 v117, s97, v81
    v_lshlrev_b32 v118, 16, v83
    v_and_b32 v119, s97, v83
    v_lshlrev_b32 v120, 16, v84
    v_and_b32 v121, s97, v84
    v_lshlrev_b32 v122, 16, v86
    v_and_b32 v123, s97, v86
    v_lshlrev_b32 v124, 16, v85
    v_and_b32 v125, s97, v85
    v_lshlrev_b32 v126, 16, v87
    v_and_b32 v127, s97, v87
    v_lshlrev_b32 v92, 16, v88
    v_and_b32 v93, s97, v88
    s_waitcnt vmcnt(8)
    s_add_u32 m0, s82, 52224
    s_movk_i32 s24, 12288
    buffer_load_dwordx4 v211, s[8:11], s24 offen nt lds
    v_lshlrev_b32 v94, 16, v89
    v_and_b32 v95, s97, v89
    v_mul_f32 v112, s38, v112
    v_mul_f32 v113, s38, v113
    v_mul_f32 v116, s38, v116
    v_mul_f32 v117, s38, v117
    v_mul_f32 v120, s38, v120
    v_mul_f32 v121, s38, v121
    v_mul_f32 v124, s38, v124
    v_mul_f32 v125, s38, v125
    v_mul_f32_e64 v114, -v114, v112
    v_mul_f32_e64 v115, -v115, v113
    v_mul_f32_e64 v118, -v118, v116
    v_mul_f32_e64 v119, -v119, v117
    v_mul_f32_e64 v122, -v122, v120
    v_mul_f32_e64 v123, -v123, v121
    v_mul_f32_e64 v126, -v126, v124
    v_mul_f32_e64 v127, -v127, v125
    v_mul_f32_e64 v94, -v94, v92
    v_mul_f32_e64 v95, -v95, v93
    s_mul_i32 s57, s25, 3584
    v_add_u32 v36, s57, v36
    s_add_u32 s57, s57, 147584
    v_lshrrev_b32 v37, 4, v25
    v_mul_u32_u24 v37, 1792, v37
    v_lshl_add_u32 v37, v26, 4, v37
    v_add_u32 v37, s57, v37
    s_mov_b32 exec_hi, 0xffff
    ds_write_b128 v36, v[112:115] offset:0
    ds_write_b128 v36, v[116:119] offset:384
    ds_write_b128 v36, v[120:123] offset:1792
    ds_write_b128 v36, v[124:127] offset:2176
    s_mov_b32 exec_hi, 0
    ds_write_b128 v37, v[92:95] offset:1536
    s_mov_b32 exec_hi, -1
    v_add_u32 v10, 1792, v10
    s_lshl_b32 s57, s25, 6
    s_add_u32 s57, s57, 150912
    v_mov_b32 v23, s57
    v_bfe_u32 v53, v8, 4, 6
    v_lshlrev_b32 v53, 2, v53
    s_mov_b32 s39, 200
    s_waitcnt lgkmcnt(0)
    s_sub_u32 s72, s72, s92
    s_sub_u32 s73, s73, s92
    s_sub_u32 s74, s74, s92
    s_sub_u32 s75, s75, s92
    s_sub_u32 s76, s76, s92
    s_sub_u32 s77, s77, s92
    s_sub_u32 s78, s78, s92
    s_sub_u32 s79, s79, s92
    s_max_u32 s72, s72, s73
    s_max_u32 s72, s72, s74
    s_max_u32 s72, s72, s75
    s_max_u32 s72, s72, s76
    s_max_u32 s72, s72, s77
    s_max_u32 s72, s72, s78
    s_max_u32 s72, s72, s79
    s_cmp_lt_u32 s72, 16
    s_cbranch_scc1 L_pollokP
L_pollretry:
    s_buffer_load_dwordx8 s[48:55], s[20:23], 0 glc
    s_waitcnt lgkmcnt(0)
    s_sub_u32 s48, s48, s92
    s_sub_u32 s49, s49, s92
    s_sub_u32 s50, s50, s92
    s_sub_u32 s51, s51, s92
    s_sub_u32 s52, s52, s92
    s_sub_u32 s53, s53, s92
    s_sub_u32 s54, s54, s92
    s_sub_u32 s55, s55, s92
    s_max_u32 s48, s48, s49
    s_max_u32 s48, s48, s50
    s_max_u32 s48, s48, s51
    s_max_u32 s48, s48, s52
    s_max_u32 s48, s48, s53
    s_max_u32 s48, s48, s54
    s_max_u32 s48, s48, s55
    s_cmp_lt_u32 s48, 16
    s_cbranch_scc1 L_pollokP
    s_sub_u32 s39, s39, 1
    s_cbranch_scc1 L_pollslowP
    s_sleep 1
    s_branch L_pollretry
L_pollokP:
    s_add_u32 s92, s92, 1
    s_mov_b32 m0, s26
    s_nop 0
    buffer_load_dwordx4 v8, s[4:7], s32 offen offset:0 sc1 lds
    buffer_load_dwordx4 v8, s[4:7], s32 offen offset:1024 sc1 lds
    buffer_load_dwordx4 v8, s[4:7], s32 offen offset:2048 sc1 lds
    s_add_u32 s32, s32, 24576
    s_sub_u32 s57, s32, 196608
    s_min_u32 s32, s32, s57
    s_add_u32 s26, s26, 36864
    s_sub_u32 s57, s26, 147456
    s_min_u32 s26, s26, s57
    v_xor_b32 v17, 32, v0
    v_xor_b32 v18, 64, v0
    v_xor_b32 v19, 96, v0
    s_waitcnt vmcnt(13)
    ds_read_b64 a[216:217], v0 offset:24576
    ds_read_b64 a[218:219], v18 offset:24704
    ds_read_b64 a[220:221], v17 offset:24576
    ds_read_b64 a[222:223], v19 offset:24704
    ds_read_b64 a[224:225], v18 offset:24576
    ds_read_b64 a[226:227], v0 offset:24832
    ds_read_b64 a[228:229], v19 offset:24576
    ds_read_b64 a[230:231], v17 offset:24832
    ds_read_b64 a[232:233], v0 offset:24704
    ds_read_b64 a[234:235], v18 offset:24832
    ds_read_b64 a[236:237], v17 offset:24704
    ds_read_b64 a[238:239], v19 offset:24832
    s_waitcnt lgkmcnt(0)
    v_mfma_f32_16x16x32_bf16 v[68:71], v[144:147], a[216:219], 0
    v_mfma_f32_16x16x32_bf16 v[68:71], v[148:151], a[220:223], v[68:71]
    v_mfma_f32_16x16x32_bf16 v[68:71], v[160:163], a[224:227], v[68:71]
    v_mfma_f32_16x16x32_bf16 v[68:71], v[164:167], a[228:231], v[68:71]
    v_mfma_f32_16x16x32_bf16 v[68:71], v[176:179], a[232:235], v[68:71]
    v_mfma_f32_16x16x32_bf16 v[68:71], v[180:183], a[236:239], v[68:71]
    v_mfma_f32_16x16x32_bf16 v[100:103], v[152:155], a[216:219], 0
    v_mfma_f32_16x16x32_bf16 v[100:103], v[156:159], a[220:223], v[100:103]
    v_mfma_f32_16x16x32_bf16 v[100:103], v[168:171], a[224:227], v[100:103]
    v_mfma_f32_16x16x32_bf16 v[100:103], v[172:175], a[228:231], v[100:103]
    v_mfma_f32_16x16x32_bf16 v[100:103], v[184:187], a[232:235], v[100:103]
    v_mfma_f32_16x16x32_bf16 v[100:103], v[188:191], a[236:239], v[100:103]
    s_nop 7
    s_mov_b32 m0, s26
    s_nop 0
    buffer_load_dwordx4 v8, s[4:7], s32 offen offset:0 sc1 lds
    buffer_load_dwordx4 v8, s[4:7], s32 offen offset:1024 sc1 lds
    buffer_load_dwordx4 v8, s[4:7], s32 offen offset:2048 sc1 lds
    s_add_u32 s32, s32, 24576
    s_sub_u32 s57, s32, 196608
    s_min_u32 s32, s32, s57
    s_add_u32 s26, s26, 12288
    v_max3_f32 v48, v68, v69, v70
    v_max3_f32 v48, v48, v71, v100
    v_max3_f32 v48, v48, v101, v102
    v_max_f32 v48, v48, v103
    v_mov_b32 v49, v48
    s_nop 1
    v_permlane16_swap_b32 v48, v49
    s_nop 1
    v_max_f32 v48, v48, v49
    v_mov_b32 v49, v48
    s_nop 1
    v_permlane32_swap_b32 v48, v49
    s_nop 1
    v_max_f32 v48, v48, v49
    v_sub_f32 v132, 0, v48
    s_mov_b32 m0, s26
    s_nop 0
    buffer_load_dwordx4 v8, s[4:7], s32 offen offset:0 sc1 lds
    buffer_load_dwordx4 v8, s[4:7], s32 offen offset:1024 sc1 lds
    buffer_load_dwordx4 v8, s[4:7], s32 offen offset:2048 sc1 lds
    s_add_u32 s32, s32, 24576
    s_sub_u32 s57, s32, 196608
    s_min_u32 s32, s32, s57
    s_add_u32 s26, s26, 36864
    s_sub_u32 s57, s26, 147456
    s_min_u32 s26, s26, s57
    v_sub_f32 v133, 0, v48
    v_sub_f32 v134, 0, v48
    v_sub_f32 v135, 0, v48
    v_sub_f32 v68, v68, v48
    v_sub_f32 v69, v69, v48
    v_sub_f32 v70, v70, v48
    v_sub_f32 v71, v71, v48
    v_sub_f32 v100, v100, v48
    v_sub_f32 v101, v101, v48
    v_sub_f32 v102, v102, v48
    v_sub_f32 v103, v103, v48
    v_exp_f32 v68, v68
    v_exp_f32 v69, v69
    v_exp_f32 v70, v70
    v_exp_f32 v71, v71
    s_mov_b32 m0, s56
    s_nop 0
    buffer_load_dwordx4 v8, s[4:7], s27 offen offset:0 sc1 lds
    buffer_load_dwordx4 v8, s[4:7], s27 offen offset:1024 sc1 lds
    buffer_load_dwordx4 v8, s[4:7], s27 offen offset:2048 sc1 lds
    s_add_u32 s27, s27, 24576
    s_sub_u32 s58, s27, 196608
    s_min_u32 s27, s27, s58
    s_add_u32 s56, s56, 36864
    s_sub_u32 s58, s56, 147456
    s_min_u32 s56, s56, s58
    v_exp_f32 v100, v100
    v_exp_f32 v101, v101
    v_exp_f32 v102, v102
    v_exp_f32 v103, v103
    v_add_f32 v5, v5, v68
    v_add_f32 v5, v5, v69
    v_add_f32 v5, v5, v70
    v_add_f32 v5, v5, v71
    v_add_f32 v5, v5, v100
    v_add_f32 v5, v5, v101
    v_add_f32 v5, v5, v102
    v_add_f32 v5, v5, v103
    v_cvt_pk_bf16_f32 v68, v68, v69
    v_cvt_pk_bf16_f32 v69, v70, v71
    v_cvt_pk_bf16_f32 v70, v100, v101
    v_cvt_pk_bf16_f32 v71, v102, v103
    s_waitcnt vmcnt(9)
    s_waitcnt lgkmcnt(0)
    s_barrier
    ds_read_b128 v[24:27], v2 offset:12288
    ds_read_b128 v[28:31], v3 offset:12288
    ds_read_b128 v[32:35], v2 offset:18432
    ds_read_b128 v[36:39], v3 offset:18432
    s_waitcnt lgkmcnt(2)
    v_mfma_f32_16x16x32_bf16 v[80:83], v[24:27], a[192:195], v[128:131]
    ds_read_b128 v[40:43], v2 offset:12416
    v_mfma_f32_16x16x32_bf16 v[80:83], v[28:31], a[196:199], v[80:83]
    s_add_u32 m0, s82, 53248
    s_movk_i32 s24, 12288
    buffer_load_dwordx4 v212, s[8:11], s24 offen nt lds
    v_mfma_f32_16x16x32_bf16 v[84:87], v[24:27], a[216:219], v[132:135]
    ds_read_b128 v[44:47], v3 offset:12416
    v_mfma_f32_16x16x32_bf16 v[84:87], v[28:31], a[220:223], v[84:87]
    s_waitcnt lgkmcnt(2)
    v_mfma_f32_16x16x32_bf16 v[112:115], v[32:35], a[192:195], v[128:131]
    ds_read_b128 v[24:27], v2 offset:18560
    v_mfma_f32_16x16x32_bf16 v[112:115], v[36:39], a[196:199], v[112:115]
    s_add_u32 m0, s82, 54272
    s_movk_i32 s24, 12288
    buffer_load_dwordx4 v213, s[8:11], s24 offen nt lds
    v_mfma_f32_16x16x32_bf16 v[116:119], v[32:35], a[216:219], v[132:135]
    ds_read_b128 v[28:31], v3 offset:18560
    v_mfma_f32_16x16x32_bf16 v[116:119], v[36:39], a[220:223], v[116:119]
    s_waitcnt lgkmcnt(2)
    v_mfma_f32_16x16x32_bf16 v[80:83], v[40:43], a[200:203], v[80:83]
    ds_read_b128 v[32:35], v2 offset:12544
    v_mfma_f32_16x16x32_bf16 v[80:83], v[44:47], a[204:207], v[80:83]
    s_add_u32 m0, s82, 24576
    s_movk_i32 s24, 18432
    buffer_load_dwordx4 v208, s[8:11], s24 offen nt lds
    v_mfma_f32_16x16x32_bf16 v[84:87], v[40:43], a[224:227], v[84:87]
    ds_read_b128 v[36:39], v3 offset:12544
    v_mfma_f32_16x16x32_bf16 v[84:87], v[44:47], a[228:231], v[84:87]
    s_waitcnt lgkmcnt(2)
    v_mfma_f32_16x16x32_bf16 v[112:115], v[24:27], a[200:203], v[112:115]
    ds_read_b128 v[40:43], v2 offset:18688
    v_mfma_f32_16x16x32_bf16 v[112:115], v[28:31], a[204:207], v[112:115]
    s_waitcnt vmcnt(6)
    s_barrier
    v_mfma_f32_16x16x32_bf16 v[116:119], v[24:27], a[224:227], v[116:119]
    ds_read_b128 v[44:47], v3 offset:18688
    v_mfma_f32_16x16x32_bf16 v[116:119], v[28:31], a[228:231], v[116:119]
    s_waitcnt lgkmcnt(2)
    v_mfma_f32_16x16x32_bf16 v[80:83], v[32:35], a[208:211], v[80:83]
    v_add_u32 v2, 49152, v2
    v_add_u32 v3, 49152, v3
    ds_read_b128 v[24:27], v2 offset:0
    v_mfma_f32_16x16x32_bf16 v[80:83], v[36:39], a[212:215], v[80:83]
    s_add_u32 m0, s82, 25600
    s_movk_i32 s24, 18432
    buffer_load_dwordx4 v209, s[8:11], s24 offen nt lds
    v_mfma_f32_16x16x32_bf16 v[84:87], v[32:35], a[232:235], v[84:87]
    ds_read_b128 v[28:31], v3 offset:0
    v_mfma_f32_16x16x32_bf16 v[84:87], v[36:39], a[236:239], v[84:87]
    s_waitcnt lgkmcnt(2)
    v_mfma_f32_16x16x32_bf16 v[112:115], v[40:43], a[208:211], v[112:115]
    ds_read_b128 v[32:35], v2 offset:6144
    v_mfma_f32_16x16x32_bf16 v[112:115], v[44:47], a[212:215], v[112:115]
    s_add_u32 m0, s82, 26624
    s_movk_i32 s24, 18432
    buffer_load_dwordx4 v210, s[8:11], s24 offen nt lds
    v_mfma_f32_16x16x32_bf16 v[116:119], v[40:43], a[232:235], v[116:119]
    ds_read_b128 v[36:39], v3 offset:6144
    v_mfma_f32_16x16x32_bf16 v[116:119], v[44:47], a[236:239], v[116:119]
    s_waitcnt lgkmcnt(2)
    v_mfma_f32_16x16x32_bf16 v[160:163], v[24:27], a[192:195], v[128:131]
    ds_read_b128 v[40:43], v2 offset:128
    v_mfma_f32_16x16x32_bf16 v[160:163], v[28:31], a[196:199], v[160:163]
    s_add_u32 m0, s82, 27648
    s_movk_i32 s24, 18432
    buffer_load_dwordx4 v211, s[8:11], s24 offen nt lds
    v_exp_f32 v16, v80
    v_mfma_f32_16x16x32_bf16 v[164:167], v[24:27], a[216:219], v[132:135]
    ds_read_b128 v[44:47], v3 offset:128
    v_mfma_f32_16x16x32_bf16 v[164:167], v[28:31], a[220:223], v[164:167]
    s_waitcnt lgkmcnt(2)
    v_exp_f32 v17, v81
    v_exp_f32 v18, v82
    v_add_f32 v4, v4, v16
    v_mfma_f32_16x16x32_bf16 v[96:99], v[32:35], a[192:195], v[128:131]
    ds_read_b128 v[24:27], v2 offset:6272
    v_add_f32 v4, v4, v17
    v_mfma_f32_16x16x32_bf16 v[96:99], v[36:39], a[196:199], v[96:99]
    s_add_u32 m0, s82, 28672
    s_movk_i32 s24, 18432
    buffer_load_dwordx4 v212, s[8:11], s24 offen nt lds
    v_exp_f32 v19, v83
    v_mfma_f32_16x16x32_bf16 v[100:103], v[32:35], a[216:219], v[132:135]
    ds_read_b128 v[28:31], v3 offset:6272
    v_cvt_pk_bf16_f32 v80, v16, v17
    v_mfma_f32_16x16x32_bf16 v[100:103], v[36:39], a[220:223], v[100:103]
    s_waitcnt lgkmcnt(2)
    v_exp_f32 v16, v112
    v_add_f32 v4, v4, v18
    v_add_f32 v4, v4, v19
    v_mfma_f32_16x16x32_bf16 v[160:163], v[40:43], a[200:203], v[160:163]
    ds_read_b128 v[32:35], v2 offset:256
    v_mfma_f32_16x16x32_bf16 v[160:163], v[44:47], a[204:207], v[160:163]
    s_add_u32 m0, s82, 29696
    s_movk_i32 s24, 18432
    buffer_load_dwordx4 v213, s[8:11], s24 offen nt lds
    v_exp_f32 v17, v113
    v_mfma_f32_16x16x32_bf16 v[164:167], v[40:43], a[224:227], v[164:167]
    ds_read_b128 v[36:39], v3 offset:256
    v_cvt_pk_bf16_f32 v81, v18, v19
    v_mfma_f32_16x16x32_bf16 v[164:167], v[44:47], a[228:231], v[164:167]
    s_waitcnt lgkmcnt(2)
    v_exp_f32 v18, v114
    v_add_f32 v4, v4, v16
    v_add_f32 v4, v4, v17
    v_mfma_f32_16x16x32_bf16 v[96:99], v[24:27], a[200:203], v[96:99]
    ds_read_b128 v[40:43], v2 offset:6400
    v_mfma_f32_16x16x32_bf16 v[96:99], v[28:31], a[204:207], v[96:99]
    s_mov_b32 m0, s56
    v_exp_f32 v19, v115
    v_cvt_pk_bf16_f32 v82, v16, v17
    v_exp_f32 v16, v84
    v_mfma_f32_16x16x32_bf16 v[100:103], v[24:27], a[224:227], v[100:103]
    ds_read_b128 v[44:47], v3 offset:6400
    v_add_f32 v4, v4, v18
    v_mfma_f32_16x16x32_bf16 v[100:103], v[28:31], a[228:231], v[100:103]
    s_waitcnt lgkmcnt(2)
    v_add_f32 v4, v4, v19
    v_exp_f32 v17, v85
    v_cvt_pk_bf16_f32 v83, v18, v19
    v_mfma_f32_16x16x32_bf16 v[160:163], v[32:35], a[208:211], v[160:163]
    ds_read_b128 v[24:27], v2 offset:12288
    v_mfma_f32_16x16x32_bf16 v[160:163], v[36:39], a[212:215], v[160:163]
    buffer_load_dwordx4 v8, s[4:7], s27 offen offset:0 sc1 lds
    v_exp_f32 v18, v86
    v_add_f32 v5, v5, v16
    v_mfma_f32_16x16x32_bf16 v[164:167], v[32:35], a[232:235], v[164:167]
    ds_read_b128 v[28:31], v3 offset:12288
    v_add_f32 v5, v5, v17
    v_mfma_f32_16x16x32_bf16 v[164:167], v[36:39], a[236:239], v[164:167]
    s_waitcnt lgkmcnt(2)
    v_exp_f32 v19, v87
    v_cvt_pk_bf16_f32 v84, v16, v17
    v_exp_f32 v16, v116
    v_mfma_f32_16x16x32_bf16 v[96:99], v[40:43], a[208:211], v[96:99]
    ds_read_b128 v[32:35], v2 offset:18432
    v_add_f32 v5, v5, v18
    v_mfma_f32_16x16x32_bf16 v[96:99], v[44:47], a[212:215], v[96:99]
    buffer_load_dwordx4 v8, s[4:7], s27 offen offset:1024 sc1 lds
    v_add_f32 v5, v5, v19
    v_exp_f32 v17, v117
    v_mfma_f32_16x16x32_bf16 v[100:103], v[40:43], a[232:235], v[100:103]
    ds_read_b128 v[36:39], v3 offset:18432
    v_cvt_pk_bf16_f32 v85, v18, v19
    v_mfma_f32_16x16x32_bf16 v[100:103], v[44:47], a[236:239], v[100:103]
    s_waitcnt lgkmcnt(2)
    v_exp_f32 v18, v118
    v_add_f32 v5, v5, v16
    v_add_f32 v5, v5, v17
    v_mfma_f32_16x16x32_bf16 v[176:179], v[24:27], a[192:195], v[128:131]
    ds_read_b128 v[40:43], v2 offset:12416
    v_mfma_f32_16x16x32_bf16 v[176:179], v[28:31], a[196:199], v[176:179]
    buffer_load_dwordx4 v8, s[4:7], s27 offen offset:2048 sc1 lds
    v_exp_f32 v19, v119
    v_cvt_pk_bf16_f32 v86, v16, v17
    v_mfma_f32_16x16x32_bf16 v[180:183], v[24:27], a[216:219], v[132:135]
    ds_read_b128 v[44:47], v3 offset:12416
    v_add_f32 v5, v5, v18
    v_mfma_f32_16x16x32_bf16 v[180:183], v[28:31], a[220:223], v[180:183]
    s_waitcnt lgkmcnt(2)
    v_add_f32 v5, v5, v19
    v_cvt_pk_bf16_f32 v87, v18, v19
    v_mfma_f32_16x16x32_bf16 v[120:123], v[32:35], a[192:195], v[128:131]
    ds_read_b128 v[24:27], v2 offset:18560
    v_mfma_f32_16x16x32_bf16 v[120:123], v[36:39], a[196:199], v[120:123]
    s_add_u32 s27, s27, 24576
    s_sub_u32 s58, s27, 196608
    s_min_u32 s27, s27, s58
    v_exp_f32 v16, v160
    v_mfma_f32_16x16x32_bf16 v[124:127], v[32:35], a[216:219], v[132:135]
    ds_read_b128 v[28:31], v3 offset:18560
    v_mfma_f32_16x16x32_bf16 v[124:127], v[36:39], a[220:223], v[124:127]
    s_waitcnt lgkmcnt(2)
    v_exp_f32 v17, v161
    v_exp_f32 v18, v162
    v_add_f32 v4, v4, v16
    v_mfma_f32_16x16x32_bf16 v[176:179], v[40:43], a[200:203], v[176:179]
    ds_read_b128 v[32:35], v2 offset:12544
    v_add_f32 v4, v4, v17
    v_mfma_f32_16x16x32_bf16 v[176:179], v[44:47], a[204:207], v[176:179]
    s_add_u32 s56, s56, 12288
    v_exp_f32 v19, v163
    v_cvt_pk_bf16_f32 v160, v16, v17
    v_exp_f32 v16, v96
    v_mfma_f32_16x16x32_bf16 v[180:183], v[40:43], a[224:227], v[180:183]
    ds_read_b128 v[36:39], v3 offset:12544
    v_add_f32 v4, v4, v18
    v_mfma_f32_16x16x32_bf16 v[180:183], v[44:47], a[228:231], v[180:183]
    s_waitcnt lgkmcnt(2)
    v_add_f32 v4, v4, v19
    v_exp_f32 v17, v97
    v_cvt_pk_bf16_f32 v161, v18, v19
    v_mfma_f32_16x16x32_bf16 v[120:123], v[24:27], a[200:203], v[120:123]
    ds_read_b128 v[40:43], v2 offset:18688
    v_mfma_f32_16x16x32_bf16 v[120:123], v[28:31], a[204:207], v[120:123]
    s_waitcnt vmcnt(11)
    s_barrier
    v_exp_f32 v18, v98
    v_add_f32 v4, v4, v16
    v_mfma_f32_16x16x32_bf16 v[124:127], v[24:27], a[224:227], v[124:127]
    ds_read_b128 v[44:47], v3 offset:18688
    v_add_f32 v4, v4, v17
    v_mfma_f32_16x16x32_bf16 v[124:127], v[28:31], a[228:231], v[124:127]
    s_waitcnt lgkmcnt(2)
    v_exp_f32 v19, v99
    v_cvt_pk_bf16_f32 v162, v16, v17
    v_exp_f32 v16, v164
    v_mfma_f32_16x16x32_bf16 v[176:179], v[32:35], a[208:211], v[176:179]
    ds_read_b128 v[24:27], v1 offset:0
    v_add_f32 v4, v4, v18
    v_mfma_f32_16x16x32_bf16 v[176:179], v[36:39], a[212:215], v[176:179]
    s_mov_b32 m0, s56
    v_add_f32 v4, v4, v19
    v_exp_f32 v17, v165
    v_cvt_pk_bf16_f32 v163, v18, v19
    v_mfma_f32_16x16x32_bf16 v[180:183], v[32:35], a[232:235], v[180:183]
    ds_read_b128 v[28:31], v1 offset:12288
    v_mfma_f32_16x16x32_bf16 v[180:183], v[36:39], a[236:239], v[180:183]
    s_waitcnt lgkmcnt(2)
    v_exp_f32 v18, v166
    v_add_f32 v5, v5, v16
    v_add_f32 v5, v5, v17
    v_mfma_f32_16x16x32_bf16 v[120:123], v[40:43], a[208:211], v[120:123]
    ds_read_b128 v[32:35], v1 offset:768
    v_mfma_f32_16x16x32_bf16 v[120:123], v[44:47], a[212:215], v[120:123]
    buffer_load_dwordx4 v8, s[4:7], s27 offen offset:0 sc1 lds
    v_exp_f32 v19, v167
    v_cvt_pk_bf16_f32 v164, v16, v17
    v_mfma_f32_16x16x32_bf16 v[124:127], v[40:43], a[232:235], v[124:127]
    ds_read_b128 v[36:39], v1 offset:13056
    v_mfma_f32_16x16x32_bf16 v[124:127], v[44:47], a[236:239], v[124:127]
    s_waitcnt lgkmcnt(2)
    v_exp_f32 v16, v100
    v_add_f32 v5, v5, v18
    v_add_f32 v5, v5, v19
    v_mfma_f32_16x16x32_bf16 a[0:3], v[64:67], v[24:27], 0
    ds_read_b128 v[40:43], v1 offset:1536
    v_mfma_f32_16x16x32_bf16 a[0:3], v[80:83], v[28:31], a[0:3]
    buffer_load_dwordx4 v8, s[4:7], s27 offen offset:1024 sc1 lds
    v_exp_f32 v17, v101
    v_cvt_pk_bf16_f32 v165, v18, v19
    v_mfma_f32_16x16x32_bf16 a[48:51], v[68:71], v[24:27], 0
    ds_read_b128 v[44:47], v1 offset:13824
    v_mfma_f32_16x16x32_bf16 a[48:51], v[84:87], v[28:31], a[48:51]
    s_waitcnt lgkmcnt(2)
    v_exp_f32 v18, v102
    v_add_f32 v5, v5, v16
    v_add_f32 v5, v5, v17
    v_mfma_f32_16x16x32_bf16 a[4:7], v[64:67], v[32:35], 0
    ds_read_b128 v[24:27], v1 offset:2304
    v_mfma_f32_16x16x32_bf16 a[4:7], v[80:83], v[36:39], a[4:7]
    buffer_load_dwordx4 v8, s[4:7], s27 offen offset:2048 sc1 lds
    v_exp_f32 v19, v103
    v_cvt_pk_bf16_f32 v166, v16, v17
    s_branch L_skip1
L_pad1:
    s_branch L_tb1_13
L_skip1:
    v_mfma_f32_16x16x32_bf16 a[52:55], v[68:71], v[32:35], 0
    ds_read_b128 v[28:31], v1 offset:14592
    v_add_f32 v5, v5, v18
    v_mfma_f32_16x16x32_bf16 a[52:55], v[84:87], v[36:39], a[52:55]
    s_waitcnt lgkmcnt(2)
    v_add_f32 v5, v5, v19
    v_cvt_pk_bf16_f32 v167, v18, v19
    v_exp_f32 v16, v176
    v_mfma_f32_16x16x32_bf16 a[8:11], v[64:67], v[40:43], 0
    ds_read_b128 v[32:35], v21 offset:0
    v_mfma_f32_16x16x32_bf16 a[8:11], v[80:83], v[44:47], a[8:11]
    s_add_u32 s27, s27, 24576
    s_sub_u32 s58, s27, 196608
    s_min_u32 s27, s27, s58
    v_exp_f32 v17, v177
    v_mfma_f32_16x16x32_bf16 a[56:59], v[68:71], v[40:43], 0
    ds_read_b128 v[36:39], v21 offset:12288
    v_mfma_f32_16x16x32_bf16 a[56:59], v[84:87], v[44:47], a[56:59]
    s_waitcnt lgkmcnt(2)
    v_exp_f32 v18, v178
    v_add_f32 v4, v4, v16
    v_add_f32 v4, v4, v17
    v_mfma_f32_16x16x32_bf16 a[12:15], v[64:67], v[24:27], 0
    ds_read_b128 v[40:43], v21 offset:768
    v_mfma_f32_16x16x32_bf16 a[12:15], v[80:83], v[28:31], a[12:15]
    s_add_u32 s56, s56, 36864
    s_sub_u32 s58, s56, 147456
    s_min_u32 s56, s56, s58
    v_exp_f32 v19, v179
    v_cvt_pk_bf16_f32 v176, v16, v17
    v_mfma_f32_16x16x32_bf16 a[60:63], v[68:71], v[24:27], 0
    ds_read_b128 v[44:47], v21 offset:13056
    v_mfma_f32_16x16x32_bf16 a[60:63], v[84:87], v[28:31], a[60:63]
    s_waitcnt lgkmcnt(2)
    v_exp_f32 v16, v120
    v_add_f32 v4, v4, v18
    v_add_f32 v4, v4, v19
    v_mfma_f32_16x16x32_bf16 a[16:19], v[64:67], v[32:35], 0
    ds_read_b128 v[24:27], v21 offset:1536
    v_mfma_f32_16x16x32_bf16 a[16:19], v[80:83], v[36:39], a[16:19]
    buffer_load_dwordx4 v[224:227], v9, s[64:67], s33 offen offset:0 nt
    v_exp_f32 v17, v121
    v_cvt_pk_bf16_f32 v177, v18, v19
    v_mfma_f32_16x16x32_bf16 a[64:67], v[68:71], v[32:35], 0
    ds_read_b128 v[28:31], v21 offset:13824
    v_mfma_f32_16x16x32_bf16 a[64:67], v[84:87], v[36:39], a[64:67]
    s_waitcnt lgkmcnt(2)
    v_exp_f32 v18, v122
    v_add_f32 v4, v4, v16
    v_add_f32 v4, v4, v17
    v_mfma_f32_16x16x32_bf16 a[20:23], v[64:67], v[40:43], 0
    ds_read_b128 v[32:35], v21 offset:2304
    v_mfma_f32_16x16x32_bf16 a[20:23], v[80:83], v[44:47], a[20:23]
    buffer_load_dwordx4 v[228:231], v9, s[64:67], s33 offen offset:1536 nt
    v_exp_f32 v19, v123
    v_cvt_pk_bf16_f32 v178, v16, v17
    v_mfma_f32_16x16x32_bf16 a[68:71], v[68:71], v[40:43], 0
    ds_read_b128 v[36:39], v21 offset:14592
    v_mfma_f32_16x16x32_bf16 a[68:71], v[84:87], v[44:47], a[68:71]
    s_waitcnt lgkmcnt(2)
    v_exp_f32 v16, v180
    v_add_f32 v4, v4, v18
    v_add_f32 v4, v4, v19
    v_mfma_f32_16x16x32_bf16 a[24:27], v[64:67], v[24:27], 0
    ds_read_b128 v[40:43], v22 offset:0
    v_mfma_f32_16x16x32_bf16 a[24:27], v[80:83], v[28:31], a[24:27]
    buffer_load_dwordx4 v[232:235], v9, s[64:67], s34 offen offset:0 nt
    v_exp_f32 v17, v181
    v_cvt_pk_bf16_f32 v179, v18, v19
    v_mfma_f32_16x16x32_bf16 a[72:75], v[68:71], v[24:27], 0
    ds_read_b128 v[44:47], v22 offset:12288
    v_mfma_f32_16x16x32_bf16 a[72:75], v[84:87], v[28:31], a[72:75]
    s_waitcnt lgkmcnt(2)
    v_exp_f32 v18, v182
    v_add_f32 v5, v5, v16
    v_add_f32 v5, v5, v17
    v_mfma_f32_16x16x32_bf16 a[28:31], v[64:67], v[32:35], 0
    ds_read_b128 v[24:27], v22 offset:768
    v_mfma_f32_16x16x32_bf16 a[28:31], v[80:83], v[36:39], a[28:31]
    buffer_load_dwordx4 v[236:239], v9, s[64:67], s34 offen offset:1536 nt
    v_exp_f32 v19, v183
    v_cvt_pk_bf16_f32 v180, v16, v17
    v_mfma_f32_16x16x32_bf16 a[76:79], v[68:71], v[32:35], 0
    ds_read_b128 v[28:31], v22 offset:13056
    v_mfma_f32_16x16x32_bf16 a[76:79], v[84:87], v[36:39], a[76:79]
    s_waitcnt lgkmcnt(2)
    v_exp_f32 v16, v124
    v_add_f32 v5, v5, v18
    v_add_f32 v5, v5, v19
    v_mfma_f32_16x16x32_bf16 a[32:35], v[64:67], v[40:43], 0
    ds_read_b128 v[32:35], v22 offset:1536
    v_mfma_f32_16x16x32_bf16 a[32:35], v[80:83], v[44:47], a[32:35]
    buffer_load_dwordx4 v[240:243], v9, s[64:67], s33 offen offset:384 nt
    v_exp_f32 v17, v125
    v_cvt_pk_bf16_f32 v181, v18, v19
    v_mfma_f32_16x16x32_bf16 a[80:83], v[68:71], v[40:43], 0
    ds_read_b128 v[36:39], v22 offset:13824
    v_mfma_f32_16x16x32_bf16 a[80:83], v[84:87], v[44:47], a[80:83]
    s_waitcnt lgkmcnt(2)
    v_exp_f32 v18, v126
    v_add_f32 v5, v5, v16
    v_add_f32 v5, v5, v17
    v_mfma_f32_16x16x32_bf16 a[36:39], v[64:67], v[24:27], 0
    ds_read_b128 v[40:43], v22 offset:2304
    v_mfma_f32_16x16x32_bf16 a[36:39], v[80:83], v[28:31], a[36:39]
    s_waitcnt vmcnt(5)
    s_barrier
    v_exp_f32 v19, v127
    v_cvt_pk_bf16_f32 v182, v16, v17
    v_mfma_f32_16x16x32_bf16 a[84:87], v[68:71], v[24:27], 0
    ds_read_b128 v[44:47], v22 offset:14592
    v_add_f32 v5, v5, v18
    v_mfma_f32_16x16x32_bf16 a[84:87], v[84:87], v[28:31], a[84:87]
    s_waitcnt lgkmcnt(2)
    v_add_f32 v5, v5, v19
    v_cvt_pk_bf16_f32 v183, v18, v19
    v_mfma_f32_16x16x32_bf16 a[40:43], v[64:67], v[32:35], 0
    v_add_u32 v1, 49152, v1
    v_add_u32 v21, 49152, v21
    v_add_u32 v22, 49152, v22
    ds_read_b128 v[24:27], v1 offset:0
    v_mfma_f32_16x16x32_bf16 a[40:43], v[80:83], v[36:39], a[40:43]
    buffer_load_dwordx4 v[244:247], v9, s[64:67], s33 offen offset:1920 nt
    v_mfma_f32_16x16x32_bf16 a[88:91], v[68:71], v[32:35], 0
    ds_read_b128 v[28:31], v1 offset:12288
    v_mfma_f32_16x16x32_bf16 a[88:91], v[84:87], v[36:39], a[88:91]
    s_waitcnt lgkmcnt(2)
    v_mfma_f32_16x16x32_bf16 a[44:47], v[64:67], v[40:43], 0
    ds_read_b128 v[32:35], v1 offset:768
    v_mfma_f32_16x16x32_bf16 a[44:47], v[80:83], v[44:47], a[44:47]
    buffer_load_dwordx4 v[248:251], v9, s[64:67], s34 offen offset:384 nt
    v_mfma_f32_16x16x32_bf16 a[92:95], v[68:71], v[40:43], 0
    ds_read_b128 v[36:39], v1 offset:13056
    v_mfma_f32_16x16x32_bf16 a[92:95], v[84:87], v[44:47], a[92:95]
    s_waitcnt lgkmcnt(2)
    v_xor_b32 v17, 32, v0
    v_xor_b32 v18, 64, v0
    v_xor_b32 v19, 96, v0
    s_waitcnt vmcnt(19)
    ds_read_b64 a[240:241], v0 offset:49152
    ds_read_b64 a[242:243], v18 offset:49280
    ds_read_b64 a[244:245], v17 offset:49152
    ds_read_b64 a[246:247], v19 offset:49280
    ds_read_b64 a[248:249], v18 offset:49152
    ds_read_b64 a[250:251], v0 offset:49408
    ds_read_b64 a[252:253], v19 offset:49152
    ds_read_b64 a[254:255], v17 offset:49408
    ds_read_b64 v[192:193], v0 offset:49280
    ds_read_b64 v[194:195], v18 offset:49408
    ds_read_b64 v[196:197], v17 offset:49280
    ds_read_b64 v[198:199], v19 offset:49408
    s_waitcnt lgkmcnt(0)
    v_mfma_f32_16x16x32_bf16 a[0:3], v[160:163], v[24:27], a[0:3]
    ds_read_b128 v[40:43], v1 offset:1536
    ds_read_b128 v[48:51], v10 offset:0
    v_mfma_f32_16x16x32_bf16 a[0:3], v[176:179], v[28:31], a[0:3]
    buffer_load_dwordx4 v[252:255], v9, s[64:67], s34 offen offset:1920 nt
    v_mfma_f32_16x16x32_bf16 a[48:51], v[164:167], v[24:27], a[48:51]
    ds_read_b128 v[44:47], v1 offset:13824
    v_mfma_f32_16x16x32_bf16 a[48:51], v[180:183], v[28:31], a[48:51]
    s_nop 0
    v_mfma_f32_16x16x32_bf16 a[4:7], v[160:163], v[32:35], a[4:7]
    ds_read_b128 v[24:27], v1 offset:2304
    v_mfma_f32_16x16x32_bf16 a[4:7], v[176:179], v[36:39], a[4:7]
    buffer_load_dwordx4 v[144:147], v12, s[68:71], s35 offen offset:0 nt
    v_mfma_f32_16x16x32_bf16 a[52:55], v[164:167], v[32:35], a[52:55]
    ds_read_b128 v[28:31], v1 offset:14592
    v_mfma_f32_16x16x32_bf16 a[52:55], v[180:183], v[36:39], a[52:55]
    s_waitcnt lgkmcnt(2)
    v_mfma_f32_16x16x32_bf16 a[8:11], v[160:163], v[40:43], a[8:11]
    ds_read_b128 v[32:35], v21 offset:0
    v_mfma_f32_16x16x32_bf16 a[8:11], v[176:179], v[44:47], a[8:11]
    buffer_load_dwordx4 v[148:151], v12, s[68:71], s35 offen offset:768 nt
    v_mfma_f32_16x16x32_bf16 a[56:59], v[164:167], v[40:43], a[56:59]
    ds_read_b128 v[36:39], v21 offset:12288
    v_mfma_f32_16x16x32_bf16 a[56:59], v[180:183], v[44:47], a[56:59]
    s_waitcnt lgkmcnt(2)
    v_mfma_f32_16x16x32_bf16 a[12:15], v[160:163], v[24:27], a[12:15]
    ds_read_b128 v[40:43], v21 offset:768
    v_mfma_f32_16x16x32_bf16 a[12:15], v[176:179], v[28:31], a[12:15]
    buffer_load_dwordx4 v[152:155], v12, s[68:71], s35 offen offset:1536 nt
    v_mfma_f32_16x16x32_bf16 a[60:63], v[164:167], v[24:27], a[60:63]
    ds_read_b128 v[44:47], v21 offset:13056
    v_mfma_f32_16x16x32_bf16 a[60:63], v[180:183], v[28:31], a[60:63]
    s_waitcnt lgkmcnt(2)
    v_mfma_f32_16x16x32_bf16 a[16:19], v[160:163], v[32:35], a[16:19]
    ds_read_b128 v[24:27], v21 offset:1536
    v_mfma_f32_16x16x32_bf16 a[16:19], v[176:179], v[36:39], a[16:19]
    buffer_load_dwordx4 v[156:159], v12, s[68:71], s35 offen offset:2304 nt
    v_mfma_f32_16x16x32_bf16 a[64:67], v[164:167], v[32:35], a[64:67]
    ds_read_b128 v[28:31], v21 offset:13824
    v_mfma_f32_16x16x32_bf16 a[64:67], v[180:183], v[36:39], a[64:67]
    s_waitcnt lgkmcnt(2)
    v_mfma_f32_16x16x32_bf16 a[20:23], v[160:163], v[40:43], a[20:23]
    ds_read_b128 v[32:35], v21 offset:2304
    v_mfma_f32_16x16x32_bf16 a[20:23], v[176:179], v[44:47], a[20:23]
    v_mfma_f32_16x16x32_bf16 a[68:71], v[164:167], v[40:43], a[68:71]
    ds_read_b128 v[36:39], v21 offset:14592
    v_mfma_f32_16x16x32_bf16 a[68:71], v[180:183], v[44:47], a[68:71]
    s_waitcnt lgkmcnt(2)
    v_mfma_f32_16x16x32_bf16 a[24:27], v[160:163], v[24:27], a[24:27]
    ds_read_b128 v[40:43], v22 offset:0
    v_mfma_f32_16x16x32_bf16 a[24:27], v[176:179], v[28:31], a[24:27]
    v_mfma_f32_16x16x32_bf16 a[72:75], v[164:167], v[24:27], a[72:75]
    ds_read_b128 v[44:47], v22 offset:12288
    v_mfma_f32_16x16x32_bf16 a[72:75], v[180:183], v[28:31], a[72:75]
    s_waitcnt lgkmcnt(2)
    v_mfma_f32_16x16x32_bf16 a[28:31], v[160:163], v[32:35], a[28:31]
    ds_read_b128 v[24:27], v22 offset:768
    v_mfma_f32_16x16x32_bf16 a[28:31], v[176:179], v[36:39], a[28:31]
    v_mfma_f32_16x16x32_bf16 a[76:79], v[164:167], v[32:35], a[76:79]
    ds_read_b128 v[28:31], v22 offset:13056
    v_mfma_f32_16x16x32_bf16 a[76:79], v[180:183], v[36:39], a[76:79]
    s_waitcnt lgkmcnt(2)
    v_mfma_f32_16x16x32_bf16 a[32:35], v[160:163], v[40:43], a[32:35]
    ds_read_b128 v[32:35], v22 offset:1536
    v_mfma_f32_16x16x32_bf16 a[32:35], v[176:179], v[44:47], a[32:35]
    v_mfma_f32_16x16x32_bf16 a[80:83], v[164:167], v[40:43], a[80:83]
    ds_read_b128 v[36:39], v22 offset:13824
    v_mfma_f32_16x16x32_bf16 a[80:83], v[180:183], v[44:47], a[80:83]
    s_waitcnt lgkmcnt(2)
    v_mfma_f32_16x16x32_bf16 a[36:39], v[160:163], v[24:27], a[36:39]
    ds_read_b128 v[40:43], v22 offset:2304
    v_mfma_f32_16x16x32_bf16 a[36:39], v[176:179], v[28:31], a[36:39]
    v_mfma_f32_16x16x32_bf16 a[84:87], v[164:167], v[24:27], a[84:87]
    ds_read_b128 v[44:47], v22 offset:14592
    v_mfma_f32_16x16x32_bf16 a[84:87], v[180:183], v[28:31], a[84:87]
    s_waitcnt lgkmcnt(2)
    v_mfma_f32_16x16x32_bf16 a[40:43], v[160:163], v[32:35], a[40:43]
    v_add_u32 v2, 4294918144, v2
    v_add_u32 v3, 4294918144, v3
    ds_read_b128 v[24:27], v2 offset:0
    v_mfma_f32_16x16x32_bf16 a[40:43], v[176:179], v[36:39], a[40:43]
    v_mfma_f32_16x16x32_bf16 a[88:91], v[164:167], v[32:35], a[88:91]
    ds_read_b128 v[28:31], v3 offset:0
    v_mfma_f32_16x16x32_bf16 a[88:91], v[180:183], v[36:39], a[88:91]
    s_waitcnt lgkmcnt(2)
    v_mfma_f32_16x16x32_bf16 a[44:47], v[160:163], v[40:43], a[44:47]
    ds_read_b128 v[32:35], v2 offset:6144
    v_mfma_f32_16x16x32_bf16 a[44:47], v[176:179], v[44:47], a[44:47]
    v_mfma_f32_16x16x32_bf16 a[92:95], v[164:167], v[40:43], a[92:95]
    ds_read_b128 v[36:39], v3 offset:6144
    v_mfma_f32_16x16x32_bf16 a[92:95], v[180:183], v[44:47], a[92:95]
    s_waitcnt lgkmcnt(2)
    s_cmp_eq_u32 s25, 1
    s_cbranch_scc1 L_t2_1
    s_cmp_eq_u32 s25, 2
    s_cbranch_scc1 L_t2_2
    s_cmp_eq_u32 s25, 3
    s_cbranch_scc1 L_t2_3
L_t2_0:
    s_branch L_pad15
L_tb2_0:
    s_branch L_t2_end
L_t2_1:
    s_branch L_pad16
L_tb2_1:
    s_branch L_t2_end
L_t2_2:
    s_branch L_t2_end
L_t2_3:
L_t2_end:
    v_xor_b32 v17, 32, v0
    v_xor_b32 v18, 64, v0
    v_xor_b32 v19, 96, v0
    s_waitcnt vmcnt(18)
    ds_read_b64 v[200:201], v0 offset:24576
    ds_read_b64 v[202:203], v18 offset:24704
    ds_read_b64 v[204:205], v17 offset:24576
    ds_read_b64 v[206:207], v19 offset:24704
    ds_read_b64 v[208:209], v18 offset:24576
    ds_read_b64 v[210:211], v0 offset:24832
    ds_read_b64 v[212:213], v19 offset:24576
    ds_read_b64 v[214:215], v17 offset:24832
    ds_read_b64 v[216:217], v0 offset:24704
    ds_read_b64 v[218:219], v18 offset:24832
    ds_read_b64 v[220:221], v17 offset:24704
    ds_read_b64 v[222:223], v19 offset:24832
    s_waitcnt lgkmcnt(0)
    s_barrier
    v_mfma_f32_16x16x32_bf16 v[72:75], v[24:27], a[240:243], 0
    ds_read_b128 v[40:43], v2 offset:128
    ds_read_b128 v[56:59], v10 offset:384
    v_mfma_f32_16x16x32_bf16 v[72:75], v[28:31], a[244:247], v[72:75]
    s_mov_b32 m0, s26
    s_waitcnt vmcnt(10)
    v_cvt_f32_i32 v224, v224
    v_cvt_f32_i32 v225, v225
    v_cvt_f32_i32 v228, v228
    v_mfma_f32_16x16x32_bf16 v[76:79], v[24:27], v[200:203], 0
    ds_read_b128 v[44:47], v3 offset:128
    ds_read_b128 v[60:63], v10 offset:768
    v_mfma_f32_16x16x32_bf16 v[76:79], v[28:31], v[204:207], v[76:79]
    s_nop 0
    v_cvt_f32_i32 v229, v229
    v_fma_f32 v224, v224, v48, v50
    v_fma_f32 v225, v225, v49, v51
    v_fma_f32 v228, v228, v48, v50
    v_fma_f32 v229, v229, v49, v51
    v_cvt_pk_bf16_f32 v224, v224, v225
    v_cvt_pk_bf16_f32 v228, v228, v229
    s_waitcnt lgkmcnt(2)
    v_cvt_f32_i32 v226, v226
    v_mfma_f32_16x16x32_bf16 v[104:107], v[32:35], a[240:243], 0
    ds_read_b128 v[24:27], v2 offset:6272
    v_cvt_f32_i32 v227, v227
    v_mfma_f32_16x16x32_bf16 v[104:107], v[36:39], a[244:247], v[104:107]
    buffer_load_dwordx4 v8, s[4:7], s32 offen offset:0 sc1 lds
    v_cvt_f32_i32 v230, v230
    v_cvt_f32_i32 v231, v231
    v_fma_f32 v226, v226, v56, v58
    v_fma_f32 v227, v227, v57, v59
    v_fma_f32 v230, v230, v56, v58
    v_fma_f32 v231, v231, v57, v59
    v_mfma_f32_16x16x32_bf16 v[108:111], v[32:35], v[200:203], 0
    ds_read_b128 v[28:31], v3 offset:6272
    v_cvt_pk_bf16_f32 v225, v226, v227
    v_mfma_f32_16x16x32_bf16 v[108:111], v[36:39], v[204:207], v[108:111]
    s_waitcnt lgkmcnt(3)
    v_cvt_pk_bf16_f32 v229, v230, v231
    s_waitcnt vmcnt(9)
    v_cvt_f32_i32 v232, v232
    v_cvt_f32_i32 v233, v233
    v_cvt_f32_i32 v236, v236
    v_cvt_f32_i32 v237, v237
    v_fma_f32 v232, v232, v48, v50
    v_fma_f32 v233, v233, v49, v51
    v_mfma_f32_16x16x32_bf16 v[72:75], v[40:43], a[248:251], v[72:75]
    ds_read_b128 v[32:35], v2 offset:256
    v_fma_f32 v236, v236, v48, v50
    v_mfma_f32_16x16x32_bf16 v[72:75], v[44:47], a[252:255], v[72:75]
    buffer_load_dwordx4 v8, s[4:7], s32 offen offset:1024 sc1 lds
    v_fma_f32 v237, v237, v49, v51
    v_cvt_pk_bf16_f32 v232, v232, v233
    v_cvt_pk_bf16_f32 v236, v236, v237
    v_cvt_f32_i32 v234, v234
    v_cvt_f32_i32 v235, v235
    v_cvt_f32_i32 v238, v238
    v_mfma_f32_16x16x32_bf16 v[76:79], v[40:43], v[208:211], v[76:79]
    ds_read_b128 v[36:39], v3 offset:256
    v_cvt_f32_i32 v239, v239
    v_mfma_f32_16x16x32_bf16 v[76:79], v[44:47], v[212:215], v[76:79]
    s_waitcnt lgkmcnt(2)
    v_fma_f32 v234, v234, v56, v58
    v_fma_f32 v235, v235, v57, v59
    v_fma_f32 v238, v238, v56, v58
    v_fma_f32 v239, v239, v57, v59
    v_cvt_pk_bf16_f32 v233, v234, v235
    v_cvt_pk_bf16_f32 v237, v238, v239
    v_mfma_f32_16x16x32_bf16 v[104:107], v[24:27], a[248:251], v[104:107]
    ds_read_b128 v[40:43], v2 offset:6400
    ds_read_b128 v[48:51], v10 offset:1152
    v_mfma_f32_16x16x32_bf16 v[104:107], v[28:31], a[252:255], v[104:107]
    buffer_load_dwordx4 v8, s[4:7], s32 offen offset:2048 sc1 lds
    s_waitcnt vmcnt(9)
    v_cvt_f32_i32 v240, v240
    v_cvt_f32_i32 v241, v241
    v_cvt_f32_i32 v244, v244
    v_mfma_f32_16x16x32_bf16 v[108:111], v[24:27], v[208:211], v[108:111]
    ds_read_b128 v[44:47], v3 offset:6400
    ds_read_b128 v[56:59], v23 offset:0
    v_mfma_f32_16x16x32_bf16 v[108:111], v[28:31], v[212:215], v[108:111]
    s_waitcnt lgkmcnt(4)
    v_add_u32 v10, 1792, v10
    v_cvt_f32_i32 v245, v245
    v_fma_f32 v240, v240, v60, v62
    v_fma_f32 v241, v241, v61, v63
    v_fma_f32 v244, v244, v60, v62
    v_fma_f32 v245, v245, v61, v63
    v_cvt_pk_bf16_f32 v226, v240, v241
    v_cvt_pk_bf16_f32 v230, v244, v245
    s_waitcnt lgkmcnt(2)
    v_mfma_f32_16x16x32_bf16 v[72:75], v[32:35], v[192:195], v[72:75]
    ds_read_b128 v[24:27], v2 offset:12288
    v_cvt_f32_i32 v242, v242
    v_mfma_f32_16x16x32_bf16 v[72:75], v[36:39], v[196:199], v[72:75]
    s_add_u32 s32, s32, 24576
    s_sub_u32 s57, s32, 196608
    s_min_u32 s32, s32, s57
    v_cvt_f32_i32 v243, v243
    v_cvt_f32_i32 v246, v246
    v_cvt_f32_i32 v247, v247
    v_fma_f32 v242, v242, v48, v50
    v_fma_f32 v243, v243, v49, v51
    v_fma_f32 v246, v246, v48, v50
    v_mfma_f32_16x16x32_bf16 v[76:79], v[32:35], v[216:219], v[76:79]
    ds_read_b128 v[28:31], v3 offset:12288
    v_fma_f32 v247, v247, v49, v51
    v_mfma_f32_16x16x32_bf16 v[76:79], v[36:39], v[220:223], v[76:79]
    s_waitcnt lgkmcnt(3)
    v_cvt_pk_bf16_f32 v227, v242, v243
    v_cvt_pk_bf16_f32 v231, v246, v247
    s_waitcnt vmcnt(7)
    v_cvt_f32_i32 v248, v248
    v_cvt_f32_i32 v249, v249
    v_cvt_f32_i32 v252, v252
    v_cvt_f32_i32 v253, v253
    v_fma_f32 v248, v248, v60, v62
    v_mfma_f32_16x16x32_bf16 v[104:107], v[40:43], v[192:195], v[104:107]
    ds_read_b128 v[32:35], v2 offset:18432
    v_fma_f32 v249, v249, v61, v63
    v_mfma_f32_16x16x32_bf16 v[104:107], v[44:47], v[196:199], v[104:107]
    s_add_u32 s26, s26, 12288
    v_fma_f32 v252, v252, v60, v62
    v_fma_f32 v253, v253, v61, v63
    v_cvt_pk_bf16_f32 v234, v248, v249
    v_cvt_pk_bf16_f32 v238, v252, v253
    v_cvt_f32_i32 v250, v250
    v_cvt_f32_i32 v251, v251
    v_cvt_f32_i32 v254, v254
    v_cvt_f32_i32 v255, v255
    v_mfma_f32_16x16x32_bf16 v[108:111], v[40:43], v[216:219], v[108:111]
    ds_read_b128 v[36:39], v3 offset:18432
    v_fma_f32 v250, v250, v48, v50
    v_mfma_f32_16x16x32_bf16 v[108:111], v[44:47], v[220:223], v[108:111]
    s_waitcnt lgkmcnt(2)
    v_fma_f32 v251, v251, v49, v51
    v_fma_f32 v254, v254, v48, v50
    v_fma_f32 v255, v255, v49, v51
    v_cvt_pk_bf16_f32 v235, v250, v251
    v_cvt_pk_bf16_f32 v239, v254, v255
    v_mfma_f32_16x16x32_bf16 v[88:91], v[24:27], a[240:243], 0
    ds_read_b128 v[40:43], v2 offset:12416
    v_mfma_f32_16x16x32_bf16 v[88:91], v[28:31], a[244:247], v[88:91]
    s_mov_b32 m0, s26
    v_mfma_f32_16x16x32_bf16 v[92:95], v[24:27], v[200:203], 0
    ds_read_b128 v[44:47], v3 offset:12416
    v_mfma_f32_16x16x32_bf16 v[92:95], v[28:31], v[204:207], v[92:95]
    s_waitcnt lgkmcnt(2)
    v_mfma_f32_16x16x32_bf16 v[120:123], v[32:35], a[240:243], 0
    ds_read_b128 v[24:27], v2 offset:18560
    v_max3_f32 v16, v72, v73, v74
    v_mfma_f32_16x16x32_bf16 v[120:123], v[36:39], a[244:247], v[120:123]
    buffer_load_dwordx4 v8, s[4:7], s32 offen offset:0 sc1 lds
    v_max3_f32 v18, v76, v77, v78
    v_max3_f32 v16, v16, v75, v104
    v_max3_f32 v18, v18, v79, v108
    v_max3_f32 v16, v16, v105, v106
    v_max3_f32 v18, v18, v109, v110
    v_max_f32 v16, v16, v107
    v_mfma_f32_16x16x32_bf16 v[124:127], v[32:35], v[200:203], 0
    ds_read_b128 v[28:31], v3 offset:18560
    v_max_f32 v18, v18, v111
    v_mfma_f32_16x16x32_bf16 v[124:127], v[36:39], v[204:207], v[124:127]
    s_waitcnt lgkmcnt(2)
    v_mov_b32 v17, v16
    v_mov_b32 v19, v18
    s_nop 0
    v_permlane16_swap_b32 v16, v17
    v_permlane16_swap_b32 v18, v19
    s_nop 0
    v_max_f32 v16, v16, v17
    v_max_f32 v18, v18, v19
    v_mfma_f32_16x16x32_bf16 v[88:91], v[40:43], a[248:251], v[88:91]
    ds_read_b128 v[32:35], v2 offset:12544
    v_mov_b32 v17, v16
    v_mfma_f32_16x16x32_bf16 v[88:91], v[44:47], a[252:255], v[88:91]
    buffer_load_dwordx4 v8, s[4:7], s32 offen offset:1024 sc1 lds
    v_mov_b32 v19, v18
    s_nop 0
    v_permlane32_swap_b32 v16, v17
    v_permlane32_swap_b32 v18, v19
    s_nop 0
    v_max_f32 v16, v16, v17
    v_mfma_f32_16x16x32_bf16 v[92:95], v[40:43], v[208:211], v[92:95]
    ds_read_b128 v[36:39], v3 offset:12544
    v_max_f32 v18, v18, v19
    v_mfma_f32_16x16x32_bf16 v[92:95], v[44:47], v[212:215], v[92:95]
    s_waitcnt lgkmcnt(2)
    v_sub_f32 v136, 0, v16
    v_sub_f32 v137, 0, v16
    v_sub_f32 v138, 0, v16
    v_sub_f32 v139, 0, v16
    v_sub_f32 v140, 0, v18
    v_sub_f32 v141, 0, v18
    v_sub_f32 v142, 0, v18
    v_sub_f32 v143, 0, v18
    v_mfma_f32_16x16x32_bf16 v[120:123], v[24:27], a[248:251], v[120:123]
    ds_read_b128 v[40:43], v2 offset:18688
    v_add_f32 v72, v72, v136
    v_mfma_f32_16x16x32_bf16 v[120:123], v[28:31], a[252:255], v[120:123]
    buffer_load_dwordx4 v8, s[4:7], s32 offen offset:2048 sc1 lds
    v_add_f32 v73, v73, v136
    v_add_f32 v74, v74, v136
    v_add_f32 v75, v75, v136
    v_add_f32 v104, v104, v136
    v_add_f32 v105, v105, v136
    v_add_f32 v106, v106, v136
    v_mfma_f32_16x16x32_bf16 v[124:127], v[24:27], v[208:211], v[124:127]
    ds_read_b128 v[44:47], v3 offset:18688
    v_add_f32 v107, v107, v136
    v_mfma_f32_16x16x32_bf16 v[124:127], v[28:31], v[212:215], v[124:127]
    s_waitcnt lgkmcnt(2)
    v_add_f32 v76, v76, v140
    v_add_f32 v77, v77, v140
    v_add_f32 v78, v78, v140
    v_add_f32 v79, v79, v140
    v_add_f32 v108, v108, v140
    v_add_f32 v109, v109, v140
    v_add_f32 v110, v110, v140
    v_add_f32 v111, v111, v140
    v_mfma_f32_16x16x32_bf16 v[88:91], v[32:35], v[192:195], v[88:91]
    v_add_u32 v2, 49152, v2
    v_add_u32 v3, 49152, v3
    ds_read_b128 v[24:27], v2 offset:0
    v_mfma_f32_16x16x32_bf16 v[88:91], v[36:39], v[196:199], v[88:91]
    s_add_u32 s32, s32, 24576
    s_sub_u32 s57, s32, 196608
    s_min_u32 s32, s32, s57
    v_exp_f32 v16, v72
    v_exp_f32 v17, v73
    v_exp_f32 v18, v74
    v_mfma_f32_16x16x32_bf16 v[92:95], v[32:35], v[216:219], v[92:95]
    ds_read_b128 v[28:31], v3 offset:0
    v_add_f32 v6, v6, v16
    v_mfma_f32_16x16x32_bf16 v[92:95], v[36:39], v[220:223], v[92:95]
    s_waitcnt lgkmcnt(2)
    v_add_f32 v6, v6, v17
    v_exp_f32 v19, v75
    v_cvt_pk_bf16_f32 v72, v16, v17
    v_exp_f32 v16, v104
    v_add_f32 v6, v6, v18
    v_add_f32 v6, v6, v19
    v_mfma_f32_16x16x32_bf16 v[120:123], v[40:43], v[192:195], v[120:123]
    ds_read_b128 v[32:35], v2 offset:6144
    v_mfma_f32_16x16x32_bf16 v[120:123], v[44:47], v[196:199], v[120:123]
    s_add_u32 s26, s26, 36864
    s_sub_u32 s57, s26, 147456
    s_min_u32 s26, s26, s57
    v_exp_f32 v17, v105
    v_cvt_pk_bf16_f32 v73, v18, v19
    v_exp_f32 v18, v106
    v_add_f32 v6, v6, v16
    v_mfma_f32_16x16x32_bf16 v[124:127], v[40:43], v[216:219], v[124:127]
    ds_read_b128 v[36:39], v3 offset:6144
    v_add_f32 v6, v6, v17
    v_mfma_f32_16x16x32_bf16 v[124:127], v[44:47], v[220:223], v[124:127]
    s_waitcnt lgkmcnt(2)
    v_exp_f32 v19, v107
    v_cvt_pk_bf16_f32 v74, v16, v17
    v_exp_f32 v16, v76
    v_add_f32 v6, v6, v18
    v_add_f32 v6, v6, v19
    s_nop 1
    v_mfma_f32_16x16x32_bf16 v[168:171], v[24:27], a[240:243], v[136:139]
    ds_read_b128 v[40:43], v2 offset:128
    v_mfma_f32_16x16x32_bf16 v[168:171], v[28:31], a[244:247], v[168:171]
    buffer_store_dwordx4 v[224:227], v11, s[4:7], s37 offen offset:0 sc1
    v_mfma_f32_16x16x32_bf16 v[172:175], v[24:27], v[200:203], v[140:143]
    ds_read_b128 v[44:47], v3 offset:128
    v_mfma_f32_16x16x32_bf16 v[172:175], v[28:31], v[204:207], v[172:175]
    s_waitcnt lgkmcnt(2)
    v_exp_f32 v17, v77
    v_cvt_pk_bf16_f32 v75, v18, v19
    v_exp_f32 v18, v78
    v_add_f32 v7, v7, v16
    v_mfma_f32_16x16x32_bf16 v[96:99], v[32:35], a[240:243], v[136:139]
    ds_read_b128 v[24:27], v2 offset:6272
    v_add_f32 v7, v7, v17
    v_mfma_f32_16x16x32_bf16 v[96:99], v[36:39], a[244:247], v[96:99]
    v_exp_f32 v19, v79
    v_cvt_pk_bf16_f32 v76, v16, v17
    v_exp_f32 v16, v108
    v_add_f32 v7, v7, v18
    v_mfma_f32_16x16x32_bf16 v[100:103], v[32:35], v[200:203], v[140:143]
    ds_read_b128 v[28:31], v3 offset:6272
    v_add_f32 v7, v7, v19
    v_mfma_f32_16x16x32_bf16 v[100:103], v[36:39], v[204:207], v[100:103]
    s_waitcnt lgkmcnt(2)
    v_exp_f32 v17, v109
    v_cvt_pk_bf16_f32 v77, v18, v19
    v_exp_f32 v18, v110
    v_add_f32 v7, v7, v16
    v_mfma_f32_16x16x32_bf16 v[168:171], v[40:43], a[248:251], v[168:171]
    ds_read_b128 v[32:35], v2 offset:256
    v_add_f32 v7, v7, v17
    v_mfma_f32_16x16x32_bf16 v[168:171], v[44:47], a[252:255], v[168:171]
    buffer_store_dwordx4 v[228:231], v54, s[4:7], s37 offen offset:768 sc1
    v_mfma_f32_16x16x32_bf16 v[172:175], v[40:43], v[208:211], v[172:175]
    ds_read_b128 v[36:39], v3 offset:256
    v_mfma_f32_16x16x32_bf16 v[172:175], v[44:47], v[212:215], v[172:175]
    s_waitcnt lgkmcnt(2)
    v_exp_f32 v19, v111
    v_cvt_pk_bf16_f32 v78, v16, v17
    v_add_f32 v7, v7, v18
    v_add_f32 v7, v7, v19
    v_cvt_pk_bf16_f32 v79, v18, v19
    v_mfma_f32_16x16x32_bf16 v[96:99], v[24:27], a[248:251], v[96:99]
    ds_read_b128 v[40:43], v2 offset:6400
    v_add_f32 v88, v88, v136
    v_mfma_f32_16x16x32_bf16 v[96:99], v[28:31], a[252:255], v[96:99]
    v_add_f32 v89, v89, v136
    v_add_f32 v90, v90, v136
    v_add_f32 v91, v91, v136
    v_add_f32 v120, v120, v136
    v_add_f32 v121, v121, v136
    v_add_f32 v122, v122, v136
    v_mfma_f32_16x16x32_bf16 v[100:103], v[24:27], v[208:211], v[100:103]
    ds_read_b128 v[44:47], v3 offset:6400
    v_add_f32 v123, v123, v136
    v_mfma_f32_16x16x32_bf16 v[100:103], v[28:31], v[212:215], v[100:103]
    s_waitcnt lgkmcnt(2)
    v_add_f32 v92, v92, v140
    v_add_f32 v93, v93, v140
    v_add_f32 v94, v94, v140
    v_add_f32 v95, v95, v140
    v_add_f32 v124, v124, v140
    v_add_f32 v125, v125, v140
    v_mfma_f32_16x16x32_bf16 v[168:171], v[32:35], v[192:195], v[168:171]
    ds_read_b128 v[24:27], v2 offset:12288
    v_add_f32 v126, v126, v140
    v_mfma_f32_16x16x32_bf16 v[168:171], v[36:39], v[196:199], v[168:171]
    buffer_store_dwordx4 v[232:235], v11, s[4:7], s80 offen offset:0 sc1
    v_add_f32 v127, v127, v140
    v_mfma_f32_16x16x32_bf16 v[172:175], v[32:35], v[216:219], v[172:175]
    ds_read_b128 v[28:31], v3 offset:12288
    v_mfma_f32_16x16x32_bf16 v[172:175], v[36:39], v[220:223], v[172:175]
    s_waitcnt lgkmcnt(2)
    v_exp_f32 v16, v88
    v_exp_f32 v17, v89
    v_exp_f32 v18, v90
    v_mfma_f32_16x16x32_bf16 v[96:99], v[40:43], v[192:195], v[96:99]
    ds_read_b128 v[32:35], v2 offset:18432
    v_add_f32 v6, v6, v16
    v_mfma_f32_16x16x32_bf16 v[96:99], v[44:47], v[196:199], v[96:99]
    v_add_f32 v6, v6, v17
    v_exp_f32 v19, v91
    v_cvt_pk_bf16_f32 v88, v16, v17
    v_exp_f32 v16, v120
    v_mfma_f32_16x16x32_bf16 v[100:103], v[40:43], v[216:219], v[100:103]
    ds_read_b128 v[36:39], v3 offset:18432
    v_add_f32 v6, v6, v18
    v_mfma_f32_16x16x32_bf16 v[100:103], v[44:47], v[220:223], v[100:103]
    s_waitcnt lgkmcnt(2)
    v_add_f32 v6, v6, v19
    v_exp_f32 v17, v121
    v_cvt_pk_bf16_f32 v89, v18, v19
    v_exp_f32 v18, v122
    s_branch L_skip2
L_pad2:
    s_branch L_tb1_12
L_skip2:
    v_mfma_f32_16x16x32_bf16 v[184:187], v[24:27], a[240:243], v[136:139]
    ds_read_b128 v[40:43], v2 offset:12416
    v_add_f32 v6, v6, v16
    v_mfma_f32_16x16x32_bf16 v[184:187], v[28:31], a[244:247], v[184:187]
    buffer_store_dwordx4 v[236:239], v54, s[4:7], s80 offen offset:768 sc1
    v_add_f32 v6, v6, v17
    v_mfma_f32_16x16x32_bf16 v[188:191], v[24:27], v[200:203], v[140:143]
    ds_read_b128 v[44:47], v3 offset:12416
    v_mfma_f32_16x16x32_bf16 v[188:191], v[28:31], v[204:207], v[188:191]
    s_waitcnt lgkmcnt(2)
    v_exp_f32 v19, v123
    v_cvt_pk_bf16_f32 v90, v16, v17
    v_exp_f32 v16, v92
    v_add_f32 v6, v6, v18
    v_mfma_f32_16x16x32_bf16 v[112:115], v[32:35], a[240:243], v[136:139]
    ds_read_b128 v[24:27], v2 offset:18560
    v_add_f32 v6, v6, v19
    v_mfma_f32_16x16x32_bf16 v[112:115], v[36:39], a[244:247], v[112:115]
    v_exp_f32 v17, v93
    v_cvt_pk_bf16_f32 v91, v18, v19
    v_exp_f32 v18, v94
    v_add_f32 v7, v7, v16
    v_mfma_f32_16x16x32_bf16 v[116:119], v[32:35], v[200:203], v[140:143]
    ds_read_b128 v[28:31], v3 offset:18560
    v_add_f32 v7, v7, v17
    v_mfma_f32_16x16x32_bf16 v[116:119], v[36:39], v[204:207], v[116:119]
    s_waitcnt lgkmcnt(2)
    v_exp_f32 v19, v95
    v_cvt_pk_bf16_f32 v92, v16, v17
    v_exp_f32 v16, v124
    v_add_f32 v7, v7, v18
    v_mfma_f32_16x16x32_bf16 v[184:187], v[40:43], a[248:251], v[184:187]
    ds_read_b128 v[32:35], v2 offset:12544
    v_add_f32 v7, v7, v19
    v_mfma_f32_16x16x32_bf16 v[184:187], v[44:47], a[252:255], v[184:187]
    buffer_load_dwordx4 v[240:243], v12, s[68:71], s36 offen offset:0 nt
    v_exp_f32 v17, v125
    v_cvt_pk_bf16_f32 v93, v18, v19
    v_mfma_f32_16x16x32_bf16 v[188:191], v[40:43], v[208:211], v[188:191]
    ds_read_b128 v[36:39], v3 offset:12544
    v_mfma_f32_16x16x32_bf16 v[188:191], v[44:47], v[212:215], v[188:191]
    s_waitcnt lgkmcnt(2)
    v_exp_f32 v18, v126
    v_add_f32 v7, v7, v16
    v_add_f32 v7, v7, v17
    v_exp_f32 v19, v127
    v_mfma_f32_16x16x32_bf16 v[112:115], v[24:27], a[248:251], v[112:115]
    ds_read_b128 v[40:43], v2 offset:18688
    v_cvt_pk_bf16_f32 v94, v16, v17
    v_mfma_f32_16x16x32_bf16 v[112:115], v[28:31], a[252:255], v[112:115]
    buffer_load_dwordx4 v[244:247], v12, s[68:71], s36 offen offset:768 nt
    v_add_f32 v7, v7, v18
    v_add_f32 v7, v7, v19
    v_cvt_pk_bf16_f32 v95, v18, v19
    v_mfma_f32_16x16x32_bf16 v[116:119], v[24:27], v[208:211], v[116:119]
    ds_read_b128 v[44:47], v3 offset:18688
    v_mfma_f32_16x16x32_bf16 v[116:119], v[28:31], v[212:215], v[116:119]
    s_waitcnt lgkmcnt(2)
    v_mfma_f32_16x16x32_bf16 v[184:187], v[32:35], v[192:195], v[184:187]
    v_add_u32 v1, 4294918144, v1
    v_add_u32 v21, 4294918144, v21
    v_add_u32 v22, 4294918144, v22
    ds_read_b128 v[24:27], v1 offset:0
    v_mfma_f32_16x16x32_bf16 v[184:187], v[36:39], v[196:199], v[184:187]
    buffer_load_dwordx4 v[248:251], v12, s[68:71], s36 offen offset:1536 nt
    v_mfma_f32_16x16x32_bf16 v[188:191], v[32:35], v[216:219], v[188:191]
    ds_read_b128 v[28:31], v1 offset:12288
    v_mfma_f32_16x16x32_bf16 v[188:191], v[36:39], v[220:223], v[188:191]
    s_waitcnt lgkmcnt(2)
    v_mfma_f32_16x16x32_bf16 v[112:115], v[40:43], v[192:195], v[112:115]
    ds_read_b128 v[32:35], v1 offset:768
    v_mfma_f32_16x16x32_bf16 v[112:115], v[44:47], v[196:199], v[112:115]
    buffer_load_dwordx4 v[252:255], v12, s[68:71], s36 offen offset:2304 nt
    v_mfma_f32_16x16x32_bf16 v[116:119], v[40:43], v[216:219], v[116:119]
    ds_read_b128 v[36:39], v1 offset:13056
    v_mfma_f32_16x16x32_bf16 v[116:119], v[44:47], v[220:223], v[116:119]
    s_waitcnt lgkmcnt(2)
    v_mfma_f32_16x16x32_bf16 a[96:99], v[72:75], v[24:27], 0
    ds_read_b128 v[40:43], v1 offset:1536
    ds_read_b128 v[60:63], v23 offset:16
    v_mfma_f32_16x16x32_bf16 a[96:99], v[88:91], v[28:31], a[96:99]
    s_mov_b32 m0, s56
    v_exp_f32 v16, v168
    v_exp_f32 v17, v169
    v_exp_f32 v18, v170
    v_mfma_f32_16x16x32_bf16 a[144:147], v[76:79], v[24:27], 0
    ds_read_b128 v[44:47], v1 offset:13824
    v_add_f32 v6, v6, v16
    v_mfma_f32_16x16x32_bf16 a[144:147], v[92:95], v[28:31], a[144:147]
    s_waitcnt lgkmcnt(3)
    v_add_f32 v6, v6, v17
    v_exp_f32 v19, v171
    v_cvt_pk_bf16_f32 v168, v16, v17
    v_exp_f32 v16, v96
    v_mfma_f32_16x16x32_bf16 a[100:103], v[72:75], v[32:35], 0
    ds_read_b128 v[24:27], v1 offset:2304
    v_add_f32 v6, v6, v18
    v_mfma_f32_16x16x32_bf16 a[100:103], v[88:91], v[36:39], a[100:103]
    buffer_load_dwordx4 v8, s[4:7], s27 offen offset:0 sc1 lds
    v_add_f32 v6, v6, v19
    v_exp_f32 v17, v97
    v_cvt_pk_bf16_f32 v169, v18, v19
    v_mfma_f32_16x16x32_bf16 a[148:151], v[76:79], v[32:35], 0
    ds_read_b128 v[28:31], v1 offset:14592
    s_waitcnt vmcnt(17)
    v_mfma_f32_16x16x32_bf16 a[148:151], v[92:95], v[36:39], a[148:151]
    s_waitcnt lgkmcnt(2)
    v_exp_f32 v18, v98
    v_add_f32 v6, v6, v16
    v_add_f32 v6, v6, v17
    v_exp_f32 v19, v99
    v_mfma_f32_16x16x32_bf16 a[104:107], v[72:75], v[40:43], 0
    ds_read_b128 v[32:35], v21 offset:0
    v_cvt_pk_bf16_f32 v170, v16, v17
    v_mfma_f32_16x16x32_bf16 a[104:107], v[88:91], v[44:47], a[104:107]
    buffer_load_dwordx4 v8, s[4:7], s27 offen offset:1024 sc1 lds
    v_exp_f32 v16, v172
    v_add_f32 v6, v6, v18
    v_add_f32 v6, v6, v19
    v_mfma_f32_16x16x32_bf16 a[152:155], v[76:79], v[40:43], 0
    ds_read_b128 v[36:39], v21 offset:12288
    v_cvt_f32_i32 v144, v144
    v_mfma_f32_16x16x32_bf16 a[152:155], v[92:95], v[44:47], a[152:155]
    s_waitcnt lgkmcnt(2)
    v_exp_f32 v17, v173
    v_cvt_pk_bf16_f32 v171, v18, v19
    v_exp_f32 v18, v174
    v_add_f32 v7, v7, v16
    v_mfma_f32_16x16x32_bf16 a[108:111], v[72:75], v[24:27], 0
    ds_read_b128 v[40:43], v21 offset:768
    v_add_f32 v7, v7, v17
    v_mfma_f32_16x16x32_bf16 a[108:111], v[88:91], v[28:31], a[108:111]
    buffer_load_dwordx4 v8, s[4:7], s27 offen offset:2048 sc1 lds
    v_exp_f32 v19, v175
    v_cvt_pk_bf16_f32 v172, v16, v17
    v_cvt_f32_i32 v148, v148
    v_mfma_f32_16x16x32_bf16 a[156:159], v[76:79], v[24:27], 0
    ds_read_b128 v[44:47], v21 offset:13056
    v_cvt_f32_i32 v145, v145
    v_mfma_f32_16x16x32_bf16 a[156:159], v[92:95], v[28:31], a[156:159]
    s_waitcnt lgkmcnt(2)
    v_exp_f32 v16, v100
    v_add_f32 v7, v7, v18
    v_add_f32 v7, v7, v19
    v_exp_f32 v17, v101
    v_mfma_f32_16x16x32_bf16 a[112:115], v[72:75], v[32:35], 0
    ds_read_b128 v[24:27], v21 offset:1536
    v_cvt_pk_bf16_f32 v173, v18, v19
    v_mfma_f32_16x16x32_bf16 a[112:115], v[88:91], v[36:39], a[112:115]
    s_add_u32 s27, s27, 24576
    s_sub_u32 s58, s27, 196608
    s_min_u32 s27, s27, s58
    v_exp_f32 v18, v102
    v_add_f32 v7, v7, v16
    v_add_f32 v7, v7, v17
    v_mfma_f32_16x16x32_bf16 a[160:163], v[76:79], v[32:35], 0
    ds_read_b128 v[28:31], v21 offset:13824
    ds_read_b128 v[48:51], v23 offset:32
    v_mfma_f32_16x16x32_bf16 a[160:163], v[92:95], v[36:39], a[160:163]
    s_waitcnt lgkmcnt(3)
    v_exp_f32 v19, v103
    v_cvt_pk_bf16_f32 v174, v16, v17
    v_add_f32 v7, v7, v18
    v_add_f32 v7, v7, v19
    v_cvt_pk_bf16_f32 v175, v18, v19
    v_mfma_f32_16x16x32_bf16 a[116:119], v[72:75], v[40:43], 0
    ds_read_b128 v[32:35], v21 offset:2304
    v_cvt_f32_i32 v149, v149
    v_mfma_f32_16x16x32_bf16 a[116:119], v[88:91], v[44:47], a[116:119]
    s_add_u32 s56, s56, 12288
    v_mfma_f32_16x16x32_bf16 a[164:167], v[76:79], v[40:43], 0
    ds_read_b128 v[36:39], v21 offset:14592
    v_mfma_f32_16x16x32_bf16 a[164:167], v[92:95], v[44:47], a[164:167]
    s_waitcnt lgkmcnt(3)
    v_mfma_f32_16x16x32_bf16 a[120:123], v[72:75], v[24:27], 0
    ds_read_b128 v[40:43], v22 offset:0
    v_mfma_f32_16x16x32_bf16 a[120:123], v[88:91], v[28:31], a[120:123]
    v_mfma_f32_16x16x32_bf16 a[168:171], v[76:79], v[24:27], 0
    ds_read_b128 v[44:47], v22 offset:12288
    v_mfma_f32_16x16x32_bf16 a[168:171], v[92:95], v[28:31], a[168:171]
    s_waitcnt lgkmcnt(2)
    v_mfma_f32_16x16x32_bf16 a[124:127], v[72:75], v[32:35], 0
    ds_read_b128 v[24:27], v22 offset:768
    v_mfma_f32_16x16x32_bf16 a[124:127], v[88:91], v[36:39], a[124:127]
    v_mfma_f32_16x16x32_bf16 a[172:175], v[76:79], v[32:35], 0
    ds_read_b128 v[28:31], v22 offset:13056
    v_mfma_f32_16x16x32_bf16 a[172:175], v[92:95], v[36:39], a[172:175]
    s_waitcnt lgkmcnt(2)
    v_mfma_f32_16x16x32_bf16 a[128:131], v[72:75], v[40:43], 0
    ds_read_b128 v[32:35], v22 offset:1536
    v_mfma_f32_16x16x32_bf16 a[128:131], v[88:91], v[44:47], a[128:131]
    v_mfma_f32_16x16x32_bf16 a[176:179], v[76:79], v[40:43], 0
    ds_read_b128 v[36:39], v22 offset:13824
    v_mfma_f32_16x16x32_bf16 a[176:179], v[92:95], v[44:47], a[176:179]
    s_waitcnt lgkmcnt(2)
    v_mfma_f32_16x16x32_bf16 a[132:135], v[72:75], v[24:27], 0
    ds_read_b128 v[40:43], v22 offset:2304
    v_mfma_f32_16x16x32_bf16 a[132:135], v[88:91], v[28:31], a[132:135]
    s_waitcnt vmcnt(7)
    s_barrier
    v_mfma_f32_16x16x32_bf16 a[180:183], v[76:79], v[24:27], 0
    ds_read_b128 v[44:47], v22 offset:14592
    v_mfma_f32_16x16x32_bf16 a[180:183], v[92:95], v[28:31], a[180:183]
    s_waitcnt lgkmcnt(2)
    v_mfma_f32_16x16x32_bf16 a[136:139], v[72:75], v[32:35], 0
    v_add_u32 v2, 49152, v2
    v_add_u32 v3, 49152, v3
    s_mov_b32 s28, 98304
    ds_read_b128 v[24:27], v2 offset:0
    v_mfma_f32_16x16x32_bf16 a[136:139], v[88:91], v[36:39], a[136:139]
    v_add_u32 v55, 1, v55
    buffer_store_dword v55, v13, s[20:23], 0 offen sc1
    v_mfma_f32_16x16x32_bf16 a[184:187], v[76:79], v[32:35], 0
    ds_read_b128 v[28:31], v3 offset:0
    v_mfma_f32_16x16x32_bf16 a[184:187], v[92:95], v[36:39], a[184:187]
    s_waitcnt lgkmcnt(2)
    v_mfma_f32_16x16x32_bf16 a[140:143], v[72:75], v[40:43], 0
    ds_read_b128 v[32:35], v2 offset:6144
    v_mfma_f32_16x16x32_bf16 a[140:143], v[88:91], v[44:47], a[140:143]
    v_mfma_f32_16x16x32_bf16 a[188:191], v[76:79], v[40:43], 0
    ds_read_b128 v[36:39], v3 offset:6144
    v_mfma_f32_16x16x32_bf16 a[188:191], v[92:95], v[44:47], a[188:191]
    s_waitcnt lgkmcnt(2)
    s_mov_b32 s31, 5
    v_mfma_f32_16x16x32_bf16 v[64:67], v[24:27], a[192:195], v[128:131]
    s_mov_b32 m0, s56
    ds_read_b128 v[40:43], v2 offset:128
    v_fma_f32 v144, v144, v56, v58
    v_mfma_f32_16x16x32_bf16 v[64:67], v[28:31], a[196:199], v[64:67]
    v_exp_f32 v16, v184
    v_mfma_f32_16x16x32_bf16 v[68:71], v[24:27], a[216:219], v[132:135]
    v_exp_f32 v17, v185
    v_mfma_f32_16x16x32_bf16 v[68:71], v[28:31], a[220:223], v[68:71]
    buffer_load_dwordx4 v8, s[4:7], s27 offen offset:0 sc1 lds
    v_mfma_f32_16x16x32_bf16 v[72:75], v[24:27], a[240:243], v[136:139]
    ds_read_b128 v[44:47], v3 offset:128
    v_fma_f32 v148, v148, v57, v59
    v_mfma_f32_16x16x32_bf16 v[72:75], v[28:31], a[244:247], v[72:75]
    v_exp_f32 v18, v186
    v_mfma_f32_16x16x32_bf16 v[76:79], v[24:27], v[200:203], v[140:143]
    v_add_f32 v6, v6, v16
    v_add_f32 v6, v6, v17
    v_mfma_f32_16x16x32_bf16 v[76:79], v[28:31], v[204:207], v[76:79]
    s_waitcnt lgkmcnt(2)
    buffer_load_dwordx4 v8, s[4:7], s27 offen offset:1024 sc1 lds
    v_mfma_f32_16x16x32_bf16 v[96:99], v[32:35], a[192:195], v[128:131]
    ds_read_b128 v[24:27], v2 offset:6272
    v_fma_f32 v145, v145, v56, v58
    v_mfma_f32_16x16x32_bf16 v[96:99], v[36:39], a[196:199], v[96:99]
    v_exp_f32 v19, v187
    v_mfma_f32_16x16x32_bf16 v[100:103], v[32:35], a[216:219], v[132:135]
    v_cvt_pk_bf16_f32 v184, v16, v17
    v_fma_f32 v149, v149, v57, v59
    v_mfma_f32_16x16x32_bf16 v[100:103], v[36:39], a[220:223], v[100:103]
    v_exp_f32 v16, v112
    v_mfma_f32_16x16x32_bf16 v[104:107], v[32:35], a[240:243], v[136:139]
    ds_read_b128 v[28:31], v3 offset:6272
    v_add_f32 v6, v6, v18
    v_mfma_f32_16x16x32_bf16 v[104:107], v[36:39], a[244:247], v[104:107]
    buffer_load_dwordx4 v8, s[4:7], s27 offen offset:2048 sc1 lds
    v_mfma_f32_16x16x32_bf16 v[108:111], v[32:35], v[200:203], v[140:143]
    v_add_f32 v6, v6, v19
    v_cvt_f32_i32 v146, v146
    v_mfma_f32_16x16x32_bf16 v[108:111], v[36:39], v[204:207], v[108:111]
    s_waitcnt lgkmcnt(2)
    v_exp_f32 v17, v113
    v_mfma_f32_16x16x32_bf16 v[64:67], v[40:43], a[200:203], v[64:67]
    s_add_u32 s27, s27, 24576
    ds_read_b128 v[32:35], v2 offset:256
    v_cvt_pk_bf16_f32 v185, v18, v19
    v_mfma_f32_16x16x32_bf16 v[64:67], v[44:47], a[204:207], v[64:67]
    v_exp_f32 v18, v114
    v_mfma_f32_16x16x32_bf16 v[68:71], v[40:43], a[224:227], v[68:71]
    s_sub_u32 s58, s27, 196608
    v_add_f32 v6, v6, v16
    v_cvt_f32_i32 v150, v150
    v_mfma_f32_16x16x32_bf16 v[68:71], v[44:47], a[228:231], v[68:71]
    v_add_f32 v6, v6, v17
    v_cvt_f32_i32 v147, v147
    v_mfma_f32_16x16x32_bf16 v[72:75], v[40:43], a[248:251], v[72:75]
    ds_read_b128 v[36:39], v3 offset:256
    v_mfma_f32_16x16x32_bf16 v[72:75], v[44:47], a[252:255], v[72:75]
    s_min_u32 s27, s27, s58
    v_exp_f32 v19, v115
    v_mfma_f32_16x16x32_bf16 v[76:79], v[40:43], v[208:211], v[76:79]
    v_cvt_pk_bf16_f32 v186, v16, v17
    v_cvt_f32_i32 v151, v151
    v_mfma_f32_16x16x32_bf16 v[76:79], v[44:47], v[212:215], v[76:79]
    s_waitcnt lgkmcnt(2)
    v_exp_f32 v16, v188
    v_mfma_f32_16x16x32_bf16 v[96:99], v[24:27], a[200:203], v[96:99]
    s_add_u32 s56, s56, 36864
    ds_read_b128 v[40:43], v2 offset:6400
    v_add_f32 v6, v6, v18
    v_mfma_f32_16x16x32_bf16 v[96:99], v[28:31], a[204:207], v[96:99]
    v_add_f32 v6, v6, v19
    v_fma_f32 v146, v146, v56, v58
    v_mfma_f32_16x16x32_bf16 v[100:103], v[24:27], a[224:227], v[100:103]
    s_sub_u32 s58, s56, 147456
    v_exp_f32 v17, v189
    v_mfma_f32_16x16x32_bf16 v[100:103], v[28:31], a[228:231], v[100:103]
    v_cvt_pk_bf16_f32 v187, v18, v19
    v_mfma_f32_16x16x32_bf16 v[104:107], v[24:27], a[248:251], v[104:107]
    s_min_u32 s56, s56, s58
    ds_read_b128 v[44:47], v3 offset:6400
    v_mfma_f32_16x16x32_bf16 v[104:107], v[28:31], a[252:255], v[104:107]
    v_exp_f32 v18, v190
    v_mfma_f32_16x16x32_bf16 v[108:111], v[24:27], v[208:211], v[108:111]
    s_add_u32 s29, s30, 49152
    v_add_f32 v7, v7, v16
    v_fma_f32 v150, v150, v57, v59
    v_mfma_f32_16x16x32_bf16 v[108:111], v[28:31], v[212:215], v[108:111]
    s_waitcnt lgkmcnt(2)
    v_add_f32 v7, v7, v17
    s_mov_b32 m0, s26
    v_mfma_f32_16x16x32_bf16 v[64:67], v[32:35], a[208:211], v[64:67]
    s_sub_u32 s3, s29, 147456
    ds_read_b128 v[24:27], v2 offset:12288
    v_fma_f32 v147, v147, v56, v58
    v_mfma_f32_16x16x32_bf16 v[64:67], v[36:39], a[212:215], v[64:67]
    v_exp_f32 v19, v191
    v_mfma_f32_16x16x32_bf16 v[68:71], v[32:35], a[232:235], v[68:71]
    v_cvt_pk_bf16_f32 v188, v16, v17
    v_mfma_f32_16x16x32_bf16 v[68:71], v[36:39], a[236:239], v[68:71]
    buffer_load_dwordx4 v8, s[4:7], s32 offen offset:0 sc1 lds
    v_mfma_f32_16x16x32_bf16 v[72:75], v[32:35], v[192:195], v[72:75]
    ds_read_b128 v[28:31], v3 offset:12288
    v_fma_f32 v151, v151, v57, v59
    v_mfma_f32_16x16x32_bf16 v[72:75], v[36:39], v[196:199], v[72:75]
    v_exp_f32 v16, v116
    v_mfma_f32_16x16x32_bf16 v[76:79], v[32:35], v[216:219], v[76:79]
    s_min_u32 s29, s29, s3
    v_add_f32 v7, v7, v18
    v_add_f32 v7, v7, v19
    v_mfma_f32_16x16x32_bf16 v[76:79], v[36:39], v[220:223], v[76:79]
    s_waitcnt lgkmcnt(2)
    buffer_load_dwordx4 v8, s[4:7], s32 offen offset:1024 sc1 lds
    v_mfma_f32_16x16x32_bf16 v[96:99], v[40:43], a[208:211], v[96:99]
    ds_read_b128 v[32:35], v2 offset:18432
    v_mfma_f32_16x16x32_bf16 v[96:99], v[44:47], a[212:215], v[96:99]
    v_exp_f32 v17, v117
    v_mfma_f32_16x16x32_bf16 v[100:103], v[40:43], a[232:235], v[100:103]
    ds_read_b128 v[56:59], v23 offset:48
    v_cvt_pk_bf16_f32 v189, v18, v19
    v_mfma_f32_16x16x32_bf16 v[100:103], v[44:47], a[236:239], v[100:103]
    s_waitcnt vmcnt(23)
    v_exp_f32 v18, v118
    v_mfma_f32_16x16x32_bf16 v[104:107], v[40:43], v[192:195], v[104:107]
    s_sub_u32 s3, s29, s30
    ds_read_b128 v[36:39], v3 offset:18432
    v_add_f32 v7, v7, v16
    v_mfma_f32_16x16x32_bf16 v[104:107], v[44:47], v[196:199], v[104:107]
    buffer_load_dwordx4 v8, s[4:7], s32 offen offset:2048 sc1 lds
    v_mfma_f32_16x16x32_bf16 v[108:111], v[40:43], v[216:219], v[108:111]
    v_add_f32 v7, v7, v17
    v_cvt_f32_i32 v152, v152
    v_mfma_f32_16x16x32_bf16 v[108:111], v[44:47], v[220:223], v[108:111]
    s_waitcnt lgkmcnt(3)
    v_exp_f32 v19, v119
    v_mfma_f32_16x16x32_bf16 v[80:83], v[24:27], a[192:195], v[128:131]
    s_add_u32 s32, s32, 24576
    ds_read_b128 v[40:43], v2 offset:12416
    v_cvt_pk_bf16_f32 v190, v16, v17
    v_mfma_f32_16x16x32_bf16 v[80:83], v[28:31], a[196:199], v[80:83]
    v_add_f32 v7, v7, v18
    v_add_f32 v7, v7, v19
    v_mfma_f32_16x16x32_bf16 v[84:87], v[24:27], a[216:219], v[132:135]
    s_mov_b32 s30, s29
    v_cvt_pk_bf16_f32 v191, v18, v19
    v_cvt_f32_i32 v156, v156
    v_mfma_f32_16x16x32_bf16 v[84:87], v[28:31], a[220:223], v[84:87]
    s_sub_u32 s57, s32, 196608
    v_mfma_f32_16x16x32_bf16 v[88:91], v[24:27], a[240:243], v[136:139]
    ds_read_b128 v[44:47], v3 offset:12416
    v_mfma_f32_16x16x32_bf16 v[88:91], v[28:31], a[244:247], v[88:91]
    s_min_u32 s32, s32, s57
    v_exp_f32 v16, v64
    v_mfma_f32_16x16x32_bf16 v[92:95], v[24:27], v[200:203], v[140:143]
    v_exp_f32 v17, v65
    v_mfma_f32_16x16x32_bf16 v[92:95], v[28:31], v[204:207], v[92:95]
    s_waitcnt lgkmcnt(2)
    v_exp_f32 v18, v66
    v_mfma_f32_16x16x32_bf16 v[112:115], v[32:35], a[192:195], v[128:131]
    s_add_u32 s26, s26, 12288
    ds_read_b128 v[24:27], v2 offset:18560
    v_cvt_f32_i32 v153, v153
    v_mfma_f32_16x16x32_bf16 v[112:115], v[36:39], a[196:199], v[112:115]
    v_add_f32 v4, v4, v16
    v_add_f32 v4, v4, v17
    v_mfma_f32_16x16x32_bf16 v[116:119], v[32:35], a[216:219], v[132:135]
    s_mov_b32 m0, s26
    v_exp_f32 v19, v67
    v_mfma_f32_16x16x32_bf16 v[116:119], v[36:39], a[220:223], v[116:119]
    v_add_u32 v23, 1792, v23
    v_cvt_pk_bf16_f32 v64, v16, v17
    v_mfma_f32_16x16x32_bf16 v[120:123], v[32:35], a[240:243], v[136:139]
    ds_read_b128 v[28:31], v3 offset:18560
    v_add_u32 v1, s3, v1
    v_mfma_f32_16x16x32_bf16 v[120:123], v[36:39], a[244:247], v[120:123]
    v_exp_f32 v16, v96
    v_mfma_f32_16x16x32_bf16 v[124:127], v[32:35], v[200:203], v[140:143]
    v_add_f32 v4, v4, v18
    v_cvt_f32_i32 v157, v157
    v_mfma_f32_16x16x32_bf16 v[124:127], v[36:39], v[204:207], v[124:127]
    s_waitcnt lgkmcnt(2)
    buffer_load_dwordx4 v8, s[4:7], s32 offen offset:0 sc1 lds
    v_mfma_f32_16x16x32_bf16 v[80:83], v[40:43], a[200:203], v[80:83]
    ds_read_b128 v[32:35], v2 offset:12544
    v_add_f32 v4, v4, v19
    v_mfma_f32_16x16x32_bf16 v[80:83], v[44:47], a[204:207], v[80:83]
    v_exp_f32 v17, v97
    v_mfma_f32_16x16x32_bf16 v[84:87], v[40:43], a[224:227], v[84:87]
    v_cvt_pk_bf16_f32 v65, v18, v19
    v_fma_f32 v152, v152, v60, v62
    v_mfma_f32_16x16x32_bf16 v[84:87], v[44:47], a[228:231], v[84:87]
    buffer_load_dwordx4 v8, s[4:7], s32 offen offset:1024 sc1 lds
    v_mfma_f32_16x16x32_bf16 v[88:91], v[40:43], a[248:251], v[88:91]
    ds_read_b128 v[36:39], v3 offset:12544
    v_add_u32 v21, s3, v21
    v_mfma_f32_16x16x32_bf16 v[88:91], v[44:47], a[252:255], v[88:91]
    v_exp_f32 v18, v98
    v_mfma_f32_16x16x32_bf16 v[92:95], v[40:43], v[208:211], v[92:95]
    v_add_f32 v4, v4, v16
    v_add_f32 v4, v4, v17
    v_mfma_f32_16x16x32_bf16 v[92:95], v[44:47], v[212:215], v[92:95]
    s_waitcnt lgkmcnt(2)
    v_exp_f32 v19, v99
    v_mfma_f32_16x16x32_bf16 v[112:115], v[24:27], a[200:203], v[112:115]
    ds_read_b128 v[40:43], v2 offset:18688
    v_cvt_pk_bf16_f32 v66, v16, v17
    v_mfma_f32_16x16x32_bf16 v[112:115], v[28:31], a[204:207], v[112:115]
    buffer_load_dwordx4 v8, s[4:7], s32 offen offset:2048 sc1 lds
    v_mfma_f32_16x16x32_bf16 v[116:119], v[24:27], a[224:227], v[116:119]
    v_exp_f32 v16, v68
    v_mfma_f32_16x16x32_bf16 v[116:119], v[28:31], a[228:231], v[116:119]
    v_add_f32 v4, v4, v18
    v_add_u32 v22, s3, v22
    v_mfma_f32_16x16x32_bf16 v[120:123], v[24:27], a[248:251], v[120:123]
    ds_read_b128 v[44:47], v3 offset:18688
    v_add_f32 v4, v4, v19
    v_mfma_f32_16x16x32_bf16 v[120:123], v[28:31], a[252:255], v[120:123]
    s_waitcnt lgkmcnt(2)
    v_exp_f32 v17, v69
    v_mfma_f32_16x16x32_bf16 v[124:127], v[24:27], v[208:211], v[124:127]
    s_waitcnt vmcnt(39)
    v_cvt_pk_bf16_f32 v67, v18, v19
    v_fma_f32 v156, v156, v61, v63
    v_mfma_f32_16x16x32_bf16 v[124:127], v[28:31], v[212:215], v[124:127]
    s_barrier
    v_fma_f32 v153, v153, v60, v62
    v_mfma_f32_16x16x32_bf16 v[80:83], v[32:35], a[208:211], v[80:83]
    s_mov_b32 s32, 196608
    ds_read_b128 v[24:27], v1 offset:0
    v_fma_f32 v157, v157, v61, v63
    v_mfma_f32_16x16x32_bf16 v[80:83], v[36:39], a[212:215], v[80:83]
    s_add_u32 s26, s26, 36864
    v_exp_f32 v18, v70
    v_mfma_f32_16x16x32_bf16 v[84:87], v[32:35], a[232:235], v[84:87]
    s_sub_u32 s57, s26, 147456
    v_add_f32 v5, v5, v16
    v_add_f32 v5, v5, v17
    v_mfma_f32_16x16x32_bf16 v[84:87], v[36:39], a[236:239], v[84:87]
    v_exp_f32 v19, v71
    v_mfma_f32_16x16x32_bf16 v[88:91], v[32:35], v[192:195], v[88:91]
    s_min_u32 s26, s26, s57
    ds_read_b128 v[28:31], v1 offset:12288
    v_cvt_pk_bf16_f32 v68, v16, v17
    v_mfma_f32_16x16x32_bf16 v[88:91], v[36:39], v[196:199], v[88:91]
    v_exp_f32 v16, v100
    v_mfma_f32_16x16x32_bf16 v[92:95], v[32:35], v[216:219], v[92:95]
    v_add_f32 v5, v5, v18
    v_add_f32 v5, v5, v19
    v_mfma_f32_16x16x32_bf16 v[92:95], v[36:39], v[220:223], v[92:95]
    s_waitcnt lgkmcnt(2)
    v_exp_f32 v17, v101
    v_mfma_f32_16x16x32_bf16 v[112:115], v[40:43], a[208:211], v[112:115]
    ds_read_b128 v[32:35], v1 offset:768
    v_cvt_f32_i32 v154, v154
    v_mfma_f32_16x16x32_bf16 v[112:115], v[44:47], a[212:215], v[112:115]
    v_cvt_pk_bf16_f32 v69, v18, v19
    v_cvt_f32_i32 v158, v158
    v_mfma_f32_16x16x32_bf16 v[116:119], v[40:43], a[232:235], v[116:119]
    v_exp_f32 v18, v102
    v_mfma_f32_16x16x32_bf16 v[116:119], v[44:47], a[236:239], v[116:119]
    v_add_f32 v5, v5, v16
    v_add_f32 v5, v5, v17
    v_mfma_f32_16x16x32_bf16 v[120:123], v[40:43], v[192:195], v[120:123]
    ds_read_b128 v[36:39], v1 offset:13056
    v_cvt_f32_i32 v155, v155
    v_mfma_f32_16x16x32_bf16 v[120:123], v[44:47], v[196:199], v[120:123]
    v_exp_f32 v19, v103
    v_mfma_f32_16x16x32_bf16 v[124:127], v[40:43], v[216:219], v[124:127]
    v_cvt_pk_bf16_f32 v70, v16, v17
    v_add_f32 v5, v5, v18
    v_mfma_f32_16x16x32_bf16 v[124:127], v[44:47], v[220:223], v[124:127]
    s_waitcnt lgkmcnt(2)
    v_add_f32 v5, v5, v19
    v_cvt_f32_i32 v159, v159
    v_cvt_pk_bf16_f32 v71, v18, v19
    v_fma_f32 v154, v154, v60, v62
    v_mfma_f32_16x16x32_bf16 a[96:99], v[168:171], v[24:27], a[96:99]
    ds_read_b128 v[40:43], v1 offset:1536
    s_add_u32 s29, s28, 49152
    v_mfma_f32_16x16x32_bf16 a[96:99], v[184:187], v[28:31], a[96:99]
    s_mov_b32 m0, s56
    s_sub_u32 s3, s29, 147456
    s_min_u32 s29, s29, s3
    s_sub_u32 s3, s29, s28
    s_mov_b32 s28, s29
    v_add_u32 v2, s3, v2
    v_add_u32 v3, s3, v3
    v_mfma_f32_16x16x32_bf16 a[144:147], v[172:175], v[24:27], a[144:147]
    ds_read_b128 v[44:47], v1 offset:13824
    v_fma_f32 v158, v158, v61, v63
    v_mfma_f32_16x16x32_bf16 a[144:147], v[188:191], v[28:31], a[144:147]
    s_waitcnt lgkmcnt(2)
    v_exp_f32 v16, v72
    v_exp_f32 v17, v73
    v_exp_f32 v18, v74
    v_mfma_f32_16x16x32_bf16 a[100:103], v[168:171], v[32:35], a[100:103]
    ds_read_b128 v[24:27], v1 offset:2304
    v_add_f32 v6, v6, v16
    v_mfma_f32_16x16x32_bf16 a[100:103], v[184:187], v[36:39], a[100:103]
    buffer_load_dwordx4 v8, s[4:7], s27 offen offset:0 sc1 lds
    v_add_f32 v6, v6, v17
    v_exp_f32 v19, v75
    v_cvt_pk_bf16_f32 v72, v16, v17
    v_mfma_f32_16x16x32_bf16 a[148:151], v[172:175], v[32:35], a[148:151]
    ds_read_b128 v[28:31], v1 offset:14592
    v_fma_f32 v155, v155, v60, v62
    v_mfma_f32_16x16x32_bf16 a[148:151], v[188:191], v[36:39], a[148:151]
    s_waitcnt lgkmcnt(2)
    v_exp_f32 v16, v104
    v_add_f32 v6, v6, v18
    v_add_f32 v6, v6, v19
    v_exp_f32 v17, v105
    v_mfma_f32_16x16x32_bf16 a[104:107], v[168:171], v[40:43], a[104:107]
    ds_read_b128 v[32:35], v21 offset:0
    v_cvt_pk_bf16_f32 v73, v18, v19
    v_mfma_f32_16x16x32_bf16 a[104:107], v[184:187], v[44:47], a[104:107]
    buffer_load_dwordx4 v8, s[4:7], s27 offen offset:1024 sc1 lds
    v_exp_f32 v18, v106
    v_add_f32 v6, v6, v16
    v_add_f32 v6, v6, v17
    v_mfma_f32_16x16x32_bf16 a[152:155], v[172:175], v[40:43], a[152:155]
    ds_read_b128 v[36:39], v21 offset:12288
    v_fma_f32 v159, v159, v61, v63
    v_mfma_f32_16x16x32_bf16 a[152:155], v[188:191], v[44:47], a[152:155]
    s_waitcnt lgkmcnt(2)
    v_exp_f32 v19, v107
    v_cvt_pk_bf16_f32 v74, v16, v17
    v_exp_f32 v16, v76
    v_add_f32 v6, v6, v18
    v_mfma_f32_16x16x32_bf16 a[108:111], v[168:171], v[24:27], a[108:111]
    ds_read_b128 v[40:43], v21 offset:768
    v_add_f32 v6, v6, v19
    v_mfma_f32_16x16x32_bf16 a[108:111], v[184:187], v[28:31], a[108:111]
    buffer_load_dwordx4 v8, s[4:7], s27 offen offset:2048 sc1 lds
    v_exp_f32 v17, v77
    v_cvt_pk_bf16_f32 v75, v18, v19
    v_cvt_pk_bf16_f32 v144, v144, v148
    v_mfma_f32_16x16x32_bf16 a[156:159], v[172:175], v[24:27], a[156:159]
    ds_read_b128 v[44:47], v21 offset:13056
    v_cvt_pk_bf16_f32 v148, v145, v149
    v_mfma_f32_16x16x32_bf16 a[156:159], v[188:191], v[28:31], a[156:159]
    s_waitcnt lgkmcnt(2)
    v_exp_f32 v18, v78
    v_add_f32 v7, v7, v16
    v_add_f32 v7, v7, v17
    v_exp_f32 v19, v79
    v_mfma_f32_16x16x32_bf16 a[112:115], v[168:171], v[32:35], a[112:115]
    ds_read_b128 v[24:27], v21 offset:1536
    v_cvt_pk_bf16_f32 v76, v16, v17
    v_mfma_f32_16x16x32_bf16 a[112:115], v[184:187], v[36:39], a[112:115]
    s_add_u32 s27, s27, 24576
    s_sub_u32 s58, s27, 196608
    s_min_u32 s27, s27, s58
    s_add_u32 s56, s56, 12288
    v_exp_f32 v16, v108
    v_add_f32 v7, v7, v18
    v_mfma_f32_16x16x32_bf16 a[160:163], v[172:175], v[32:35], a[160:163]
    ds_read_b128 v[28:31], v21 offset:13824
    v_add_f32 v7, v7, v19
    v_mfma_f32_16x16x32_bf16 a[160:163], v[188:191], v[36:39], a[160:163]
    s_waitcnt lgkmcnt(2)
    v_exp_f32 v17, v109
    v_cvt_pk_bf16_f32 v77, v18, v19
    v_exp_f32 v18, v110
    v_add_f32 v7, v7, v16
    v_mfma_f32_16x16x32_bf16 a[116:119], v[168:171], v[40:43], a[116:119]
    ds_read_b128 v[32:35], v21 offset:2304
    v_add_f32 v7, v7, v17
    v_mfma_f32_16x16x32_bf16 a[116:119], v[184:187], v[44:47], a[116:119]
    s_mov_b32 m0, s56
    v_exp_f32 v19, v111
    v_cvt_pk_bf16_f32 v78, v16, v17
    v_exp_f32 v16, v80
    v_add_f32 v7, v7, v18
    v_mfma_f32_16x16x32_bf16 a[164:167], v[172:175], v[40:43], a[164:167]
    ds_read_b128 v[36:39], v21 offset:14592
    v_add_f32 v7, v7, v19
    v_mfma_f32_16x16x32_bf16 a[164:167], v[188:191], v[44:47], a[164:167]
    s_waitcnt lgkmcnt(2)
    v_exp_f32 v17, v81
    v_cvt_pk_bf16_f32 v79, v18, v19
    v_exp_f32 v18, v82
    v_add_f32 v4, v4, v16
    v_mfma_f32_16x16x32_bf16 a[120:123], v[168:171], v[24:27], a[120:123]
    ds_read_b128 v[40:43], v22 offset:0
    v_add_f32 v4, v4, v17
    v_mfma_f32_16x16x32_bf16 a[120:123], v[184:187], v[28:31], a[120:123]
    buffer_load_dwordx4 v8, s[4:7], s27 offen offset:0 sc1 lds
    v_exp_f32 v19, v83
    v_cvt_pk_bf16_f32 v80, v16, v17
    v_cvt_pk_bf16_f32 v145, v152, v156
    v_mfma_f32_16x16x32_bf16 a[168:171], v[172:175], v[24:27], a[168:171]
    ds_read_b128 v[44:47], v22 offset:12288
    v_cvt_pk_bf16_f32 v149, v153, v157
    v_mfma_f32_16x16x32_bf16 a[168:171], v[188:191], v[28:31], a[168:171]
    s_waitcnt lgkmcnt(2)
    v_exp_f32 v16, v112
    v_add_f32 v4, v4, v18
    v_add_f32 v4, v4, v19
    v_exp_f32 v17, v113
    v_mfma_f32_16x16x32_bf16 a[124:127], v[168:171], v[32:35], a[124:127]
    ds_read_b128 v[24:27], v22 offset:768
    v_cvt_pk_bf16_f32 v81, v18, v19
    v_mfma_f32_16x16x32_bf16 a[124:127], v[184:187], v[36:39], a[124:127]
    buffer_load_dwordx4 v8, s[4:7], s27 offen offset:1024 sc1 lds
    v_exp_f32 v18, v114
    v_add_f32 v4, v4, v16
    v_add_f32 v4, v4, v17
    v_mfma_f32_16x16x32_bf16 a[172:175], v[172:175], v[32:35], a[172:175]
    ds_read_b128 v[28:31], v22 offset:13056
    v_cvt_pk_bf16_f32 v152, v146, v150
    v_mfma_f32_16x16x32_bf16 a[172:175], v[188:191], v[36:39], a[172:175]
    s_waitcnt lgkmcnt(2)
    v_exp_f32 v19, v115
    v_cvt_pk_bf16_f32 v82, v16, v17
    v_exp_f32 v16, v84
    v_add_f32 v4, v4, v18
    s_branch L_skip3
L_pad3:
    s_branch L_tb1_11
L_skip3:
    v_mfma_f32_16x16x32_bf16 a[128:131], v[168:171], v[40:43], a[128:131]
    ds_read_b128 v[32:35], v22 offset:1536
    v_add_f32 v4, v4, v19
    v_mfma_f32_16x16x32_bf16 a[128:131], v[184:187], v[44:47], a[128:131]
    buffer_load_dwordx4 v8, s[4:7], s27 offen offset:2048 sc1 lds
    v_exp_f32 v17, v85
    v_cvt_pk_bf16_f32 v83, v18, v19
    v_cvt_pk_bf16_f32 v153, v154, v158
    v_mfma_f32_16x16x32_bf16 a[176:179], v[172:175], v[40:43], a[176:179]
    ds_read_b128 v[36:39], v22 offset:13824
    v_cvt_pk_bf16_f32 v156, v147, v151
    v_mfma_f32_16x16x32_bf16 a[176:179], v[188:191], v[44:47], a[176:179]
    s_waitcnt lgkmcnt(2)
    v_exp_f32 v18, v86
    v_add_f32 v5, v5, v16
    v_add_f32 v5, v5, v17
    v_exp_f32 v19, v87
    v_mfma_f32_16x16x32_bf16 a[132:135], v[168:171], v[24:27], a[132:135]
    ds_read_b128 v[40:43], v22 offset:2304
    v_cvt_pk_bf16_f32 v84, v16, v17
    v_mfma_f32_16x16x32_bf16 a[132:135], v[184:187], v[28:31], a[132:135]
    s_waitcnt vmcnt(6)
    s_barrier
    v_exp_f32 v16, v116
    v_add_f32 v5, v5, v18
    v_add_f32 v5, v5, v19
    v_mfma_f32_16x16x32_bf16 a[180:183], v[172:175], v[24:27], a[180:183]
    ds_read_b128 v[44:47], v22 offset:14592
    v_cvt_pk_bf16_f32 v157, v155, v159
    v_mfma_f32_16x16x32_bf16 a[180:183], v[188:191], v[28:31], a[180:183]
    s_waitcnt lgkmcnt(2)
    v_exp_f32 v17, v117
    v_cvt_pk_bf16_f32 v85, v18, v19
    v_exp_f32 v18, v118
    v_add_f32 v5, v5, v16
    v_mfma_f32_16x16x32_bf16 a[136:139], v[168:171], v[32:35], a[136:139]
    ds_read_b128 v[24:27], v2 offset:0
    v_add_f32 v5, v5, v17
    v_mfma_f32_16x16x32_bf16 a[136:139], v[184:187], v[36:39], a[136:139]
    s_mov_b32 s27, 208896
    s_add_u32 s56, s56, 36864
    s_sub_u32 s58, s56, 147456
    s_min_u32 s56, s56, s58
    v_exp_f32 v19, v119
    v_cvt_pk_bf16_f32 v86, v16, v17
    v_mfma_f32_16x16x32_bf16 a[184:187], v[172:175], v[32:35], a[184:187]
    ds_read_b128 v[28:31], v3 offset:0
    v_add_f32 v5, v5, v18
    v_mfma_f32_16x16x32_bf16 a[184:187], v[188:191], v[36:39], a[184:187]
    s_waitcnt lgkmcnt(2)
    v_add_f32 v5, v5, v19
    v_cvt_pk_bf16_f32 v87, v18, v19
    s_waitcnt vmcnt(21)
    v_cvt_f32_i32 v240, v240
    v_cvt_f32_i32 v244, v244
    v_cvt_f32_i32 v241, v241
    v_mfma_f32_16x16x32_bf16 a[140:143], v[168:171], v[40:43], a[140:143]
    ds_read_b128 v[32:35], v2 offset:6144
    v_mfma_f32_16x16x32_bf16 a[140:143], v[184:187], v[44:47], a[140:143]
    v_mfma_f32_16x16x32_bf16 a[188:191], v[172:175], v[40:43], a[188:191]
    ds_read_b128 v[36:39], v3 offset:6144
    v_mfma_f32_16x16x32_bf16 a[188:191], v[188:191], v[44:47], a[188:191]
    s_waitcnt lgkmcnt(2)
    v_mfma_f32_16x16x32_bf16 v[160:163], v[24:27], a[192:195], v[128:131]
    ds_read_b128 v[40:43], v2 offset:128
    v_bfe_u32 v53, v8, 4, 6
    v_mfma_f32_16x16x32_bf16 v[160:163], v[28:31], a[196:199], v[160:163]
    v_exp_f32 v16, v88
    v_mfma_f32_16x16x32_bf16 v[164:167], v[24:27], a[216:219], v[132:135]
    v_lshlrev_b32 v53, 2, v53
    v_cvt_f32_i32 v245, v245
    v_mfma_f32_16x16x32_bf16 v[164:167], v[28:31], a[220:223], v[164:167]
    buffer_load_dword v52, v53, s[20:23], 0 offen sc1
    v_mfma_f32_16x16x32_bf16 v[168:171], v[24:27], a[240:243], v[136:139]
    ds_read_b128 v[44:47], v3 offset:128
    v_fma_f32 v240, v240, v48, v50
    v_mfma_f32_16x16x32_bf16 v[168:171], v[28:31], a[244:247], v[168:171]
    v_exp_f32 v17, v89
    v_mfma_f32_16x16x32_bf16 v[172:175], v[24:27], v[200:203], v[140:143]
    v_exp_f32 v18, v90
    v_mfma_f32_16x16x32_bf16 v[172:175], v[28:31], v[204:207], v[172:175]
    s_waitcnt lgkmcnt(2)
    v_add_f32 v6, v6, v16
    v_add_f32 v6, v6, v17
    v_mfma_f32_16x16x32_bf16 v[96:99], v[32:35], a[192:195], v[128:131]
    ds_read_b128 v[24:27], v2 offset:6272
    v_fma_f32 v244, v244, v49, v51
    v_mfma_f32_16x16x32_bf16 v[96:99], v[36:39], a[196:199], v[96:99]
    s_add_u32 s33, s33, 196608
    v_exp_f32 v19, v91
    v_mfma_f32_16x16x32_bf16 v[100:103], v[32:35], a[216:219], v[132:135]
    s_sub_u32 s34, s33, 1572864
    v_cvt_pk_bf16_f32 v88, v16, v17
    v_fma_f32 v241, v241, v48, v50
    v_mfma_f32_16x16x32_bf16 v[100:103], v[36:39], a[220:223], v[100:103]
    s_min_u32 s33, s33, s34
    v_exp_f32 v16, v120
    v_mfma_f32_16x16x32_bf16 v[104:107], v[32:35], a[240:243], v[136:139]
    ds_read_b128 v[28:31], v3 offset:6272
    v_add_f32 v6, v6, v18
    v_mfma_f32_16x16x32_bf16 v[104:107], v[36:39], a[244:247], v[104:107]
    s_add_u32 s34, s33, 3072
    v_add_f32 v6, v6, v19
    v_fma_f32 v245, v245, v49, v51
    v_mfma_f32_16x16x32_bf16 v[108:111], v[32:35], v[200:203], v[140:143]
    v_exp_f32 v17, v121
    v_mfma_f32_16x16x32_bf16 v[108:111], v[36:39], v[204:207], v[108:111]
    s_waitcnt lgkmcnt(2)
    v_cvt_f32_i32 v242, v242
    v_cvt_pk_bf16_f32 v89, v18, v19
    v_mfma_f32_16x16x32_bf16 v[160:163], v[40:43], a[200:203], v[160:163]
    s_add_u32 s37, s37, 196608
    ds_read_b128 v[32:35], v2 offset:256
    v_cvt_f32_i32 v246, v246
    v_mfma_f32_16x16x32_bf16 v[160:163], v[44:47], a[204:207], v[160:163]
    v_exp_f32 v18, v122
    v_mfma_f32_16x16x32_bf16 v[164:167], v[40:43], a[224:227], v[164:167]
    s_add_u32 s80, s80, 196608
    v_add_f32 v6, v6, v16
    v_cvt_f32_i32 v243, v243
    v_mfma_f32_16x16x32_bf16 v[164:167], v[44:47], a[228:231], v[164:167]
    v_add_f32 v6, v6, v17
    v_cvt_f32_i32 v247, v247
    v_mfma_f32_16x16x32_bf16 v[168:171], v[40:43], a[248:251], v[168:171]
    ds_read_b128 v[36:39], v3 offset:256
    v_fma_f32 v242, v242, v48, v50
    v_mfma_f32_16x16x32_bf16 v[168:171], v[44:47], a[252:255], v[168:171]
    v_exp_f32 v19, v123
    v_mfma_f32_16x16x32_bf16 v[172:175], v[40:43], v[208:211], v[172:175]
    v_cvt_pk_bf16_f32 v90, v16, v17
    v_mfma_f32_16x16x32_bf16 v[172:175], v[44:47], v[212:215], v[172:175]
    s_waitcnt lgkmcnt(2)
    buffer_load_dwordx4 v[224:227], v9, s[64:67], s33 offen offset:0 nt
    v_mfma_f32_16x16x32_bf16 v[96:99], v[24:27], a[200:203], v[96:99]
    ds_read_b128 v[40:43], v2 offset:6400
    v_fma_f32 v246, v246, v49, v51
    v_mfma_f32_16x16x32_bf16 v[96:99], v[28:31], a[204:207], v[96:99]
    v_exp_f32 v16, v92
    v_mfma_f32_16x16x32_bf16 v[100:103], v[24:27], a[224:227], v[100:103]
    v_add_f32 v6, v6, v18
    v_add_f32 v6, v6, v19
    v_mfma_f32_16x16x32_bf16 v[100:103], v[28:31], a[228:231], v[100:103]
    buffer_load_dwordx4 v[228:231], v9, s[64:67], s33 offen offset:1536 nt
    v_mfma_f32_16x16x32_bf16 v[104:107], v[24:27], a[248:251], v[104:107]
    ds_read_b128 v[44:47], v3 offset:6400
    v_fma_f32 v243, v243, v48, v50
    v_mfma_f32_16x16x32_bf16 v[104:107], v[28:31], a[252:255], v[104:107]
    v_exp_f32 v17, v93
    v_mfma_f32_16x16x32_bf16 v[108:111], v[24:27], v[208:211], v[108:111]
    s_add_u32 s29, s30, 49152
    v_cvt_pk_bf16_f32 v91, v18, v19
    v_fma_f32 v247, v247, v49, v51
    v_mfma_f32_16x16x32_bf16 v[108:111], v[28:31], v[212:215], v[108:111]
    s_waitcnt lgkmcnt(2)
    buffer_load_dwordx4 v[232:235], v9, s[64:67], s34 offen offset:0 nt
    v_mfma_f32_16x16x32_bf16 v[160:163], v[32:35], a[208:211], v[160:163]
    s_sub_u32 s3, s29, 147456
    ds_read_b128 v[24:27], v2 offset:12288
    v_mfma_f32_16x16x32_bf16 v[160:163], v[36:39], a[212:215], v[160:163]
    v_exp_f32 v18, v94
    v_mfma_f32_16x16x32_bf16 v[164:167], v[32:35], a[232:235], v[164:167]
    v_add_f32 v7, v7, v16
    v_add_f32 v7, v7, v17
    v_mfma_f32_16x16x32_bf16 v[164:167], v[36:39], a[236:239], v[164:167]
    v_exp_f32 v19, v95
    v_mfma_f32_16x16x32_bf16 v[168:171], v[32:35], v[192:195], v[168:171]
    ds_read_b128 v[28:31], v3 offset:12288
    v_cvt_pk_bf16_f32 v92, v16, v17
    v_mfma_f32_16x16x32_bf16 v[168:171], v[36:39], v[196:199], v[168:171]
    buffer_load_dwordx4 v[236:239], v9, s[64:67], s34 offen offset:1536 nt
    v_mfma_f32_16x16x32_bf16 v[172:175], v[32:35], v[216:219], v[172:175]
    s_min_u32 s29, s29, s3
    v_exp_f32 v16, v124
    v_mfma_f32_16x16x32_bf16 v[172:175], v[36:39], v[220:223], v[172:175]
    s_waitcnt lgkmcnt(2)
    v_add_f32 v7, v7, v18
    v_add_f32 v7, v7, v19
    v_mfma_f32_16x16x32_bf16 v[96:99], v[40:43], a[208:211], v[96:99]
    ds_read_b128 v[32:35], v2 offset:18432
    v_mfma_f32_16x16x32_bf16 v[96:99], v[44:47], a[212:215], v[96:99]
    v_exp_f32 v17, v125
    v_mfma_f32_16x16x32_bf16 v[100:103], v[40:43], a[232:235], v[100:103]
    ds_read_b128 v[48:51], v10 offset:0
    v_cvt_pk_bf16_f32 v93, v18, v19
    v_mfma_f32_16x16x32_bf16 v[100:103], v[44:47], a[236:239], v[100:103]
    v_exp_f32 v18, v126
    v_mfma_f32_16x16x32_bf16 v[104:107], v[40:43], v[192:195], v[104:107]
    s_sub_u32 s3, s29, s30
    ds_read_b128 v[36:39], v3 offset:18432
    v_cvt_pk_bf16_f32 v146, v240, v244
    v_mfma_f32_16x16x32_bf16 v[104:107], v[44:47], v[196:199], v[104:107]
    v_add_f32 v7, v7, v16
    v_add_f32 v7, v7, v17
    v_mfma_f32_16x16x32_bf16 v[108:111], v[40:43], v[216:219], v[108:111]
    v_exp_f32 v19, v127
    v_mfma_f32_16x16x32_bf16 v[108:111], v[44:47], v[220:223], v[108:111]
    s_waitcnt lgkmcnt(3)
    v_cvt_pk_bf16_f32 v150, v241, v245
    v_cvt_pk_bf16_f32 v154, v242, v246
    v_mfma_f32_16x16x32_bf16 v[176:179], v[24:27], a[192:195], v[128:131]
    ds_read_b128 v[40:43], v2 offset:12416
    v_cvt_pk_bf16_f32 v94, v16, v17
    v_mfma_f32_16x16x32_bf16 v[176:179], v[28:31], a[196:199], v[176:179]
    v_add_f32 v7, v7, v18
    v_add_f32 v7, v7, v19
    v_mfma_f32_16x16x32_bf16 v[180:183], v[24:27], a[216:219], v[132:135]
    s_mov_b32 s30, s29
    v_cvt_pk_bf16_f32 v95, v18, v19
    v_cvt_pk_bf16_f32 v158, v243, v247
    v_mfma_f32_16x16x32_bf16 v[180:183], v[28:31], a[220:223], v[180:183]
    s_waitcnt vmcnt(24)
    v_cvt_f32_i32 v248, v248
    v_cvt_f32_i32 v252, v252
    v_mfma_f32_16x16x32_bf16 v[184:187], v[24:27], a[240:243], v[136:139]
    ds_read_b128 v[44:47], v3 offset:12416
    v_cvt_f32_i32 v249, v249
    v_mfma_f32_16x16x32_bf16 v[184:187], v[28:31], a[244:247], v[184:187]
    s_waitcnt vmcnt(4)
    v_subrev_u32 v52, s92, v52
    v_cmp_lt_u32 vcc, 15, v52
    v_mfma_f32_16x16x32_bf16 v[188:191], v[24:27], v[200:203], v[140:143]
    v_exp_f32 v16, v160
    v_mfma_f32_16x16x32_bf16 v[188:191], v[28:31], v[204:207], v[188:191]
    s_waitcnt lgkmcnt(2)
    v_exp_f32 v17, v161
    v_mfma_f32_16x16x32_bf16 v[112:115], v[32:35], a[192:195], v[128:131]
    s_and_b32 s59, vcc_lo, 0xff
    ds_read_b128 v[24:27], v2 offset:18560
    v_cvt_f32_i32 v253, v253
    v_mfma_f32_16x16x32_bf16 v[112:115], v[36:39], a[196:199], v[112:115]
    s_cbranch_scc1 L_pollslow0
L_pollok0:
    v_mfma_f32_16x16x32_bf16 v[116:119], v[32:35], a[216:219], v[132:135]
    s_add_u32 s92, s92, 1
    v_exp_f32 v18, v162
    v_mfma_f32_16x16x32_bf16 v[116:119], v[36:39], a[220:223], v[116:119]
    s_mov_b32 m0, s26
    v_add_f32 v4, v4, v16
    v_add_f32 v4, v4, v17
    v_mfma_f32_16x16x32_bf16 v[120:123], v[32:35], a[240:243], v[136:139]
    ds_read_b128 v[28:31], v3 offset:18560
    v_fma_f32 v248, v248, v56, v58
    v_mfma_f32_16x16x32_bf16 v[120:123], v[36:39], a[244:247], v[120:123]
    buffer_load_dwordx4 v8, s[4:7], s32 offen offset:0 sc1 lds
    v_mfma_f32_16x16x32_bf16 v[124:127], v[32:35], v[200:203], v[140:143]
    v_exp_f32 v19, v163
    v_mfma_f32_16x16x32_bf16 v[124:127], v[36:39], v[204:207], v[124:127]
    s_waitcnt lgkmcnt(2)
    v_cvt_pk_bf16_f32 v160, v16, v17
    v_fma_f32 v252, v252, v57, v59
    v_mfma_f32_16x16x32_bf16 v[176:179], v[40:43], a[200:203], v[176:179]
    ds_read_b128 v[32:35], v2 offset:12544
    v_add_u32 v1, s3, v1
    v_mfma_f32_16x16x32_bf16 v[176:179], v[44:47], a[204:207], v[176:179]
    buffer_load_dwordx4 v8, s[4:7], s32 offen offset:1024 sc1 lds
    v_mfma_f32_16x16x32_bf16 v[180:183], v[40:43], a[224:227], v[180:183]
    v_exp_f32 v16, v96
    v_mfma_f32_16x16x32_bf16 v[180:183], v[44:47], a[228:231], v[180:183]
    v_add_f32 v4, v4, v18
    v_add_f32 v4, v4, v19
    v_mfma_f32_16x16x32_bf16 v[184:187], v[40:43], a[248:251], v[184:187]
    ds_read_b128 v[36:39], v3 offset:12544
    v_fma_f32 v249, v249, v56, v58
    v_mfma_f32_16x16x32_bf16 v[184:187], v[44:47], a[252:255], v[184:187]
    buffer_load_dwordx4 v8, s[4:7], s32 offen offset:2048 sc1 lds
    v_mfma_f32_16x16x32_bf16 v[188:191], v[40:43], v[208:211], v[188:191]
    v_exp_f32 v17, v97
    v_mfma_f32_16x16x32_bf16 v[188:191], v[44:47], v[212:215], v[188:191]
    s_waitcnt lgkmcnt(2)
    v_cvt_pk_bf16_f32 v161, v18, v19
    v_exp_f32 v18, v98
    v_mfma_f32_16x16x32_bf16 v[112:115], v[24:27], a[200:203], v[112:115]
    s_add_u32 s32, s32, 24576
    ds_read_b128 v[40:43], v2 offset:18688
    v_add_f32 v4, v4, v16
    v_mfma_f32_16x16x32_bf16 v[112:115], v[28:31], a[204:207], v[112:115]
    v_add_f32 v4, v4, v17
    v_fma_f32 v253, v253, v57, v59
    v_mfma_f32_16x16x32_bf16 v[116:119], v[24:27], a[224:227], v[116:119]
    s_add_u32 s26, s26, 12288
    v_exp_f32 v19, v99
    v_mfma_f32_16x16x32_bf16 v[116:119], v[28:31], a[228:231], v[116:119]
    v_cvt_pk_bf16_f32 v162, v16, v17
    v_add_u32 v21, s3, v21
    v_mfma_f32_16x16x32_bf16 v[120:123], v[24:27], a[248:251], v[120:123]
    ds_read_b128 v[44:47], v3 offset:18688
    v_add_u32 v22, s3, v22
    v_mfma_f32_16x16x32_bf16 v[120:123], v[28:31], a[252:255], v[120:123]
    s_waitcnt lgkmcnt(2)
    v_exp_f32 v16, v164
    v_add_f32 v4, v4, v18
    v_mfma_f32_16x16x32_bf16 v[124:127], v[24:27], v[208:211], v[124:127]
    s_waitcnt vmcnt(20)
    v_add_f32 v4, v4, v19
    v_cvt_f32_i32 v250, v250
    v_mfma_f32_16x16x32_bf16 v[124:127], v[28:31], v[212:215], v[124:127]
    s_barrier
    v_exp_f32 v17, v165
    v_mfma_f32_16x16x32_bf16 v[176:179], v[32:35], a[208:211], v[176:179]
    s_mov_b32 m0, s26
    ds_read_b128 v[24:27], v1 offset:0
    v_cvt_pk_bf16_f32 v163, v18, v19
    v_mfma_f32_16x16x32_bf16 v[176:179], v[36:39], a[212:215], v[176:179]
    buffer_load_dwordx4 v8, s[4:7], s32 offen offset:0 sc1 lds
    v_mfma_f32_16x16x32_bf16 v[180:183], v[32:35], a[232:235], v[180:183]
    v_exp_f32 v18, v166
    v_mfma_f32_16x16x32_bf16 v[180:183], v[36:39], a[236:239], v[180:183]
    v_add_f32 v5, v5, v16
    v_cvt_f32_i32 v254, v254
    v_mfma_f32_16x16x32_bf16 v[184:187], v[32:35], v[192:195], v[184:187]
    ds_read_b128 v[28:31], v1 offset:12288
    v_add_f32 v5, v5, v17
    v_mfma_f32_16x16x32_bf16 v[184:187], v[36:39], v[196:199], v[184:187]
    buffer_load_dwordx4 v8, s[4:7], s32 offen offset:1024 sc1 lds
    v_mfma_f32_16x16x32_bf16 v[188:191], v[32:35], v[216:219], v[188:191]
    v_exp_f32 v19, v167
    v_mfma_f32_16x16x32_bf16 v[188:191], v[36:39], v[220:223], v[188:191]
    s_waitcnt lgkmcnt(2)
    v_cvt_pk_bf16_f32 v164, v16, v17
    v_exp_f32 v16, v100
    v_mfma_f32_16x16x32_bf16 v[112:115], v[40:43], a[208:211], v[112:115]
    ds_read_b128 v[32:35], v1 offset:768
    v_cvt_f32_i32 v251, v251
    v_mfma_f32_16x16x32_bf16 v[112:115], v[44:47], a[212:215], v[112:115]
    buffer_load_dwordx4 v8, s[4:7], s32 offen offset:2048 sc1 lds
    v_add_f32 v5, v5, v18
    v_mfma_f32_16x16x32_bf16 v[116:119], v[40:43], a[232:235], v[116:119]
    v_add_f32 v5, v5, v19
    v_cvt_f32_i32 v255, v255
    v_mfma_f32_16x16x32_bf16 v[116:119], v[44:47], a[236:239], v[116:119]
    v_exp_f32 v17, v101
    v_fma_f32 v250, v250, v56, v58
    v_mfma_f32_16x16x32_bf16 v[120:123], v[40:43], v[192:195], v[120:123]
    ds_read_b128 v[36:39], v1 offset:13056
    v_cvt_pk_bf16_f32 v165, v18, v19
    v_mfma_f32_16x16x32_bf16 v[120:123], v[44:47], v[196:199], v[120:123]
    v_exp_f32 v18, v102
    v_fma_f32 v254, v254, v57, v59
    v_mfma_f32_16x16x32_bf16 v[124:127], v[40:43], v[216:219], v[124:127]
    s_add_u32 s32, s32, 24576
    v_add_f32 v5, v5, v16
    v_add_f32 v5, v5, v17
    v_mfma_f32_16x16x32_bf16 v[124:127], v[44:47], v[220:223], v[124:127]
    s_waitcnt lgkmcnt(2)
    v_exp_f32 v19, v103
    v_fma_f32 v251, v251, v56, v58
    v_fma_f32 v255, v255, v57, v59
    v_cvt_pk_bf16_f32 v166, v16, v17
    v_cvt_pk_bf16_f32 v147, v248, v252
    v_add_f32 v5, v5, v18
    s_add_u32 s26, s26, 36864
    v_cvt_pk_bf16_f32 v151, v249, v253
    v_add_f32 v5, v5, v19
    s_sub_u32 s57, s26, 147456
    v_cvt_pk_bf16_f32 v155, v250, v254
    v_cvt_pk_bf16_f32 v167, v18, v19
    s_min_u32 s26, s26, s57
    v_cvt_pk_bf16_f32 v159, v251, v255
    v_mfma_f32_16x16x32_bf16 a[0:3], v[64:67], v[24:27], a[0:3]
    ds_read_b128 v[40:43], v1 offset:1536
    v_mfma_f32_16x16x32_bf16 a[0:3], v[80:83], v[28:31], a[0:3]
    buffer_store_dwordx4 v[144:147], v20, s[4:7], s81 offen offset:0 sc1
    v_mfma_f32_16x16x32_bf16 a[48:51], v[68:71], v[24:27], a[48:51]
    v_exp_f32 v16, v168
    v_mfma_f32_16x16x32_bf16 a[48:51], v[84:87], v[28:31], a[48:51]
    v_exp_f32 v17, v169
    v_mfma_f32_16x16x32_bf16 a[96:99], v[72:75], v[24:27], a[96:99]
    ds_read_b128 v[44:47], v1 offset:13824
    v_mfma_f32_16x16x32_bf16 a[96:99], v[88:91], v[28:31], a[96:99]
    v_exp_f32 v18, v170
    v_mfma_f32_16x16x32_bf16 a[144:147], v[76:79], v[24:27], a[144:147]
    v_add_f32 v6, v6, v16
    v_add_f32 v6, v6, v17
    v_mfma_f32_16x16x32_bf16 a[144:147], v[92:95], v[28:31], a[144:147]
    s_waitcnt lgkmcnt(2)
    v_exp_f32 v19, v171
    v_mfma_f32_16x16x32_bf16 a[4:7], v[64:67], v[32:35], a[4:7]
    ds_read_b128 v[24:27], v1 offset:2304
    v_cvt_pk_bf16_f32 v168, v16, v17
    v_mfma_f32_16x16x32_bf16 a[4:7], v[80:83], v[36:39], a[4:7]
    buffer_store_dwordx4 v[148:151], v20, s[4:7], s81 offen offset:768 sc1
    v_mfma_f32_16x16x32_bf16 a[52:55], v[68:71], v[32:35], a[52:55]
    v_exp_f32 v16, v104
    v_mfma_f32_16x16x32_bf16 a[52:55], v[84:87], v[36:39], a[52:55]
    v_add_f32 v6, v6, v18
    v_add_f32 v6, v6, v19
    v_mfma_f32_16x16x32_bf16 a[100:103], v[72:75], v[32:35], a[100:103]
    ds_read_b128 v[28:31], v1 offset:14592
    v_mfma_f32_16x16x32_bf16 a[100:103], v[88:91], v[36:39], a[100:103]
    v_exp_f32 v17, v105
    v_mfma_f32_16x16x32_bf16 a[148:151], v[76:79], v[32:35], a[148:151]
    v_cvt_pk_bf16_f32 v169, v18, v19
    v_mfma_f32_16x16x32_bf16 a[148:151], v[92:95], v[36:39], a[148:151]
    s_waitcnt lgkmcnt(2)
    v_exp_f32 v18, v106
    v_mfma_f32_16x16x32_bf16 a[8:11], v[64:67], v[40:43], a[8:11]
    ds_read_b128 v[32:35], v21 offset:0
    v_add_f32 v6, v6, v16
    v_mfma_f32_16x16x32_bf16 a[8:11], v[80:83], v[44:47], a[8:11]
    buffer_store_dwordx4 v[152:155], v20, s[4:7], s81 offen offset:1536 sc1
    v_mfma_f32_16x16x32_bf16 a[56:59], v[68:71], v[40:43], a[56:59]
    v_add_f32 v6, v6, v17
    v_mfma_f32_16x16x32_bf16 a[56:59], v[84:87], v[44:47], a[56:59]
    v_exp_f32 v19, v107
    v_mfma_f32_16x16x32_bf16 a[104:107], v[72:75], v[40:43], a[104:107]
    ds_read_b128 v[36:39], v21 offset:12288
    v_cvt_pk_bf16_f32 v170, v16, v17
    v_mfma_f32_16x16x32_bf16 a[104:107], v[88:91], v[44:47], a[104:107]
    v_exp_f32 v16, v172
    v_mfma_f32_16x16x32_bf16 a[152:155], v[76:79], v[40:43], a[152:155]
    v_add_f32 v6, v6, v18
    v_mfma_f32_16x16x32_bf16 a[152:155], v[92:95], v[44:47], a[152:155]
    s_waitcnt lgkmcnt(2)
    v_add_f32 v6, v6, v19
    v_mfma_f32_16x16x32_bf16 a[12:15], v[64:67], v[24:27], a[12:15]
    ds_read_b128 v[40:43], v21 offset:768
    v_mfma_f32_16x16x32_bf16 a[12:15], v[80:83], v[28:31], a[12:15]
    buffer_store_dwordx4 v[156:159], v20, s[4:7], s81 offen offset:2304 sc1
    v_mfma_f32_16x16x32_bf16 a[60:63], v[68:71], v[24:27], a[60:63]
    v_exp_f32 v17, v173
    v_mfma_f32_16x16x32_bf16 a[60:63], v[84:87], v[28:31], a[60:63]
    v_cvt_pk_bf16_f32 v171, v18, v19
    v_mfma_f32_16x16x32_bf16 a[108:111], v[72:75], v[24:27], a[108:111]
    ds_read_b128 v[44:47], v21 offset:13056
    v_mfma_f32_16x16x32_bf16 a[108:111], v[88:91], v[28:31], a[108:111]
    v_exp_f32 v18, v174
    v_mfma_f32_16x16x32_bf16 a[156:159], v[76:79], v[24:27], a[156:159]
    s_add_u32 s29, s28, 49152
    v_add_f32 v7, v7, v16
    v_add_f32 v7, v7, v17
    v_mfma_f32_16x16x32_bf16 a[156:159], v[92:95], v[28:31], a[156:159]
    s_waitcnt lgkmcnt(2)
    v_exp_f32 v19, v175
    v_mfma_f32_16x16x32_bf16 a[16:19], v[64:67], v[32:35], a[16:19]
    ds_read_b128 v[24:27], v21 offset:1536
    v_cvt_pk_bf16_f32 v172, v16, v17
    v_mfma_f32_16x16x32_bf16 a[16:19], v[80:83], v[36:39], a[16:19]
    s_sub_u32 s3, s29, 147456
    buffer_load_dwordx4 v[240:243], v9, s[64:67], s33 offen offset:384 nt
    v_mfma_f32_16x16x32_bf16 a[64:67], v[68:71], v[32:35], a[64:67]
    ds_read_b128 v[56:59], v10 offset:384
    s_waitcnt vmcnt(13)
    v_mfma_f32_16x16x32_bf16 a[64:67], v[84:87], v[36:39], a[64:67]
    v_exp_f32 v16, v108
    v_mfma_f32_16x16x32_bf16 a[112:115], v[72:75], v[32:35], a[112:115]
    ds_read_b128 v[28:31], v21 offset:13824
    v_add_f32 v7, v7, v18
    v_mfma_f32_16x16x32_bf16 a[112:115], v[88:91], v[36:39], a[112:115]
    v_add_f32 v7, v7, v19
    v_cvt_f32_i32 v224, v224
    v_mfma_f32_16x16x32_bf16 a[160:163], v[76:79], v[32:35], a[160:163]
    v_exp_f32 v17, v109
    v_mfma_f32_16x16x32_bf16 a[160:163], v[92:95], v[36:39], a[160:163]
    s_waitcnt lgkmcnt(3)
    buffer_load_dwordx4 v[244:247], v9, s[64:67], s33 offen offset:1920 nt
    v_mfma_f32_16x16x32_bf16 a[20:23], v[64:67], v[40:43], a[20:23]
    s_min_u32 s29, s29, s3
    ds_read_b128 v[32:35], v21 offset:2304
    v_cvt_pk_bf16_f32 v173, v18, v19
    v_mfma_f32_16x16x32_bf16 a[20:23], v[80:83], v[44:47], a[20:23]
    v_exp_f32 v18, v110
    v_mfma_f32_16x16x32_bf16 a[68:71], v[68:71], v[40:43], a[68:71]
    v_cvt_f32_i32 v225, v225
    v_add_f32 v7, v7, v16
    v_mfma_f32_16x16x32_bf16 a[68:71], v[84:87], v[44:47], a[68:71]
    v_add_f32 v7, v7, v17
    v_cvt_f32_i32 v228, v228
    v_mfma_f32_16x16x32_bf16 a[116:119], v[72:75], v[40:43], a[116:119]
    ds_read_b128 v[36:39], v21 offset:14592
    v_mfma_f32_16x16x32_bf16 a[116:119], v[88:91], v[44:47], a[116:119]
    buffer_load_dwordx4 v[248:251], v9, s[64:67], s34 offen offset:384 nt
    v_mfma_f32_16x16x32_bf16 a[164:167], v[76:79], v[40:43], a[164:167]
    s_sub_u32 s3, s29, s28
    v_exp_f32 v19, v111
    v_mfma_f32_16x16x32_bf16 a[164:167], v[92:95], v[44:47], a[164:167]
    s_waitcnt lgkmcnt(2)
    ds_read_b128 v[60:63], v10 offset:768
    v_cvt_pk_bf16_f32 v174, v16, v17
    v_mfma_f32_16x16x32_bf16 a[24:27], v[64:67], v[24:27], a[24:27]
    ds_read_b128 v[40:43], v22 offset:0
    v_cvt_f32_i32 v229, v229
    v_mfma_f32_16x16x32_bf16 a[24:27], v[80:83], v[28:31], a[24:27]
    v_exp_f32 v16, v176
    v_mfma_f32_16x16x32_bf16 a[72:75], v[68:71], v[24:27], a[72:75]
    v_add_f32 v7, v7, v18
    v_add_f32 v7, v7, v19
    v_mfma_f32_16x16x32_bf16 a[72:75], v[84:87], v[28:31], a[72:75]
    buffer_load_dwordx4 v[252:255], v9, s[64:67], s34 offen offset:1920 nt
    v_mfma_f32_16x16x32_bf16 a[120:123], v[72:75], v[24:27], a[120:123]
    ds_read_b128 v[44:47], v22 offset:12288
    v_fma_f32 v224, v224, v48, v50
    v_mfma_f32_16x16x32_bf16 a[120:123], v[88:91], v[28:31], a[120:123]
    s_mov_b32 s28, s29
    v_exp_f32 v17, v177
    v_mfma_f32_16x16x32_bf16 a[168:171], v[76:79], v[24:27], a[168:171]
    v_cvt_pk_bf16_f32 v175, v18, v19
    v_fma_f32 v225, v225, v49, v51
    v_mfma_f32_16x16x32_bf16 a[168:171], v[92:95], v[28:31], a[168:171]
    s_waitcnt lgkmcnt(3)
    v_exp_f32 v18, v178
    v_mfma_f32_16x16x32_bf16 a[28:31], v[64:67], v[32:35], a[28:31]
    ds_read_b128 v[24:27], v22 offset:768
    v_add_f32 v4, v4, v16
    v_mfma_f32_16x16x32_bf16 a[28:31], v[80:83], v[36:39], a[28:31]
    v_add_f32 v4, v4, v17
    v_fma_f32 v228, v228, v48, v50
    v_mfma_f32_16x16x32_bf16 a[76:79], v[68:71], v[32:35], a[76:79]
    s_mov_b32 m0, s26
    v_exp_f32 v19, v179
    v_mfma_f32_16x16x32_bf16 a[76:79], v[84:87], v[36:39], a[76:79]
    v_cvt_pk_bf16_f32 v176, v16, v17
    v_fma_f32 v229, v229, v49, v51
    v_mfma_f32_16x16x32_bf16 a[124:127], v[72:75], v[32:35], a[124:127]
    ds_read_b128 v[28:31], v22 offset:13056
    v_cvt_pk_bf16_f32 v224, v224, v225
    v_mfma_f32_16x16x32_bf16 a[124:127], v[88:91], v[36:39], a[124:127]
    buffer_load_dwordx4 v8, s[4:7], s32 offen offset:0 sc1 lds
    v_mfma_f32_16x16x32_bf16 a[172:175], v[76:79], v[32:35], a[172:175]
    v_exp_f32 v16, v112
    v_mfma_f32_16x16x32_bf16 a[172:175], v[92:95], v[36:39], a[172:175]
    s_waitcnt lgkmcnt(2)
    v_add_f32 v4, v4, v18
    v_add_f32 v4, v4, v19
    v_mfma_f32_16x16x32_bf16 a[32:35], v[64:67], v[40:43], a[32:35]
    ds_read_b128 v[32:35], v22 offset:1536
    v_cvt_pk_bf16_f32 v228, v228, v229
    v_mfma_f32_16x16x32_bf16 a[32:35], v[80:83], v[44:47], a[32:35]
    buffer_load_dwordx4 v8, s[4:7], s32 offen offset:1024 sc1 lds
    v_mfma_f32_16x16x32_bf16 a[80:83], v[68:71], v[40:43], a[80:83]
    v_exp_f32 v17, v113
    v_mfma_f32_16x16x32_bf16 a[80:83], v[84:87], v[44:47], a[80:83]
    v_cvt_pk_bf16_f32 v177, v18, v19
    v_cvt_f32_i32 v226, v226
    v_mfma_f32_16x16x32_bf16 a[128:131], v[72:75], v[40:43], a[128:131]
    ds_read_b128 v[36:39], v22 offset:13824
    v_cvt_f32_i32 v227, v227
    v_mfma_f32_16x16x32_bf16 a[128:131], v[88:91], v[44:47], a[128:131]
    buffer_load_dwordx4 v8, s[4:7], s32 offen offset:2048 sc1 lds
    v_mfma_f32_16x16x32_bf16 a[176:179], v[76:79], v[40:43], a[176:179]
    v_exp_f32 v18, v114
    v_mfma_f32_16x16x32_bf16 a[176:179], v[92:95], v[44:47], a[176:179]
    s_waitcnt lgkmcnt(2)
    v_add_f32 v4, v4, v16
    v_add_f32 v4, v4, v17
    v_mfma_f32_16x16x32_bf16 a[36:39], v[64:67], v[24:27], a[36:39]
    s_add_u32 s32, s32, 24576
    ds_read_b128 v[40:43], v22 offset:2304
    v_cvt_f32_i32 v230, v230
    v_mfma_f32_16x16x32_bf16 a[36:39], v[80:83], v[28:31], a[36:39]
    v_exp_f32 v19, v115
    v_cvt_pk_bf16_f32 v178, v16, v17
    v_mfma_f32_16x16x32_bf16 a[84:87], v[68:71], v[24:27], a[84:87]
    s_add_u32 s26, s26, 12288
    v_exp_f32 v16, v180
    v_mfma_f32_16x16x32_bf16 a[84:87], v[84:87], v[28:31], a[84:87]
    v_add_u32 v2, s3, v2
    v_add_f32 v4, v4, v18
    v_mfma_f32_16x16x32_bf16 a[132:135], v[72:75], v[24:27], a[132:135]
    s_mov_b32 m0, s26
    ds_read_b128 v[44:47], v22 offset:14592
    v_add_u32 v3, s3, v3
    v_mfma_f32_16x16x32_bf16 a[132:135], v[88:91], v[28:31], a[132:135]
    s_waitcnt lgkmcnt(2)
    v_add_f32 v4, v4, v19
    v_cvt_f32_i32 v231, v231
    v_mfma_f32_16x16x32_bf16 a[180:183], v[76:79], v[24:27], a[180:183]
    s_waitcnt vmcnt(7)
    v_exp_f32 v17, v181
    v_mfma_f32_16x16x32_bf16 a[180:183], v[92:95], v[28:31], a[180:183]
    s_barrier
    v_cvt_pk_bf16_f32 v179, v18, v19
    v_mfma_f32_16x16x32_bf16 a[40:43], v[64:67], v[32:35], a[40:43]
    ds_read_b128 v[24:27], v2 offset:0
    v_fma_f32 v226, v226, v56, v58
    v_mfma_f32_16x16x32_bf16 a[40:43], v[80:83], v[36:39], a[40:43]
    buffer_load_dwordx4 v8, s[4:7], s32 offen offset:0 sc1 lds
    v_mfma_f32_16x16x32_bf16 a[88:91], v[68:71], v[32:35], a[88:91]
    v_exp_f32 v18, v182
    v_mfma_f32_16x16x32_bf16 a[88:91], v[84:87], v[36:39], a[88:91]
    v_add_f32 v5, v5, v16
    v_add_f32 v5, v5, v17
    v_mfma_f32_16x16x32_bf16 a[136:139], v[72:75], v[32:35], a[136:139]
    ds_read_b128 v[28:31], v3 offset:0
    v_fma_f32 v227, v227, v57, v59
    v_mfma_f32_16x16x32_bf16 a[136:139], v[88:91], v[36:39], a[136:139]
    buffer_load_dwordx4 v8, s[4:7], s32 offen offset:1024 sc1 lds
    v_mfma_f32_16x16x32_bf16 a[184:187], v[76:79], v[32:35], a[184:187]
    v_exp_f32 v19, v183
    v_mfma_f32_16x16x32_bf16 a[184:187], v[92:95], v[36:39], a[184:187]
    s_waitcnt lgkmcnt(2)
    v_cvt_pk_bf16_f32 v180, v16, v17
    v_exp_f32 v16, v116
    v_mfma_f32_16x16x32_bf16 a[44:47], v[64:67], v[40:43], a[44:47]
    ds_read_b128 v[32:35], v2 offset:6144
    v_add_f32 v5, v5, v18
    v_mfma_f32_16x16x32_bf16 a[44:47], v[80:83], v[44:47], a[44:47]
    buffer_load_dwordx4 v8, s[4:7], s32 offen offset:2048 sc1 lds
    v_add_f32 v5, v5, v19
    v_mfma_f32_16x16x32_bf16 a[92:95], v[68:71], v[40:43], a[92:95]
    v_exp_f32 v17, v117
    v_mfma_f32_16x16x32_bf16 a[92:95], v[84:87], v[44:47], a[92:95]
    v_fma_f32 v230, v230, v56, v58
    v_cvt_pk_bf16_f32 v181, v18, v19
    v_fma_f32 v231, v231, v57, v59
    v_mfma_f32_16x16x32_bf16 a[140:143], v[72:75], v[40:43], a[140:143]
    ds_read_b128 v[36:39], v3 offset:6144
    v_cvt_pk_bf16_f32 v225, v226, v227
    v_mfma_f32_16x16x32_bf16 a[140:143], v[88:91], v[44:47], a[140:143]
    v_add_u32 v55, 1, v55
    buffer_store_dword v55, v13, s[20:23], 0 offen sc1
    v_mfma_f32_16x16x32_bf16 a[188:191], v[76:79], v[40:43], a[188:191]
    s_add_u32 s32, s32, 24576
    v_exp_f32 v18, v118
    v_mfma_f32_16x16x32_bf16 a[188:191], v[92:95], v[44:47], a[188:191]
    s_waitcnt lgkmcnt(2)
    v_add_f32 v5, v5, v16
    v_add_f32 v5, v5, v17
    v_exp_f32 v19, v119
    v_cvt_pk_bf16_f32 v229, v230, v231
    s_waitcnt vmcnt(21)
    v_cvt_pk_bf16_f32 v182, v16, v17
    v_cvt_f32_i32 v232, v232
    v_add_f32 v5, v5, v18
    s_add_u32 s26, s26, 36864
    v_cvt_f32_i32 v233, v233
    v_add_f32 v5, v5, v19
    s_sub_u32 s57, s26, 147456
    v_cvt_f32_i32 v236, v236
    v_cvt_pk_bf16_f32 v183, v18, v19
    s_min_u32 s26, s26, s57
    v_cvt_f32_i32 v237, v237
    s_branch L_skip4
L_pad4:
    s_branch L_tb1_10
L_skip4:
    v_mfma_f32_16x16x32_bf16 v[64:67], v[24:27], a[192:195], v[128:131]
    ds_read_b128 v[40:43], v2 offset:128
    s_add_u32 s35, s35, 196608
    v_mfma_f32_16x16x32_bf16 v[64:67], v[28:31], a[196:199], v[64:67]
    s_sub_u32 s36, s35, 1572864
    v_exp_f32 v16, v184
    v_mfma_f32_16x16x32_bf16 v[68:71], v[24:27], a[216:219], v[132:135]
    v_exp_f32 v17, v185
    v_mfma_f32_16x16x32_bf16 v[68:71], v[28:31], a[220:223], v[68:71]
    s_min_u32 s35, s35, s36
    v_fma_f32 v232, v232, v48, v50
    v_fma_f32 v233, v233, v49, v51
    v_mfma_f32_16x16x32_bf16 v[72:75], v[24:27], a[240:243], v[136:139]
    ds_read_b128 v[44:47], v3 offset:128
    v_fma_f32 v236, v236, v48, v50
    v_mfma_f32_16x16x32_bf16 v[72:75], v[28:31], a[244:247], v[72:75]
    s_add_u32 s36, s35, 3072
    v_exp_f32 v18, v186
    v_mfma_f32_16x16x32_bf16 v[76:79], v[24:27], v[200:203], v[140:143]
    v_add_f32 v6, v6, v16
    v_add_f32 v6, v6, v17
    v_mfma_f32_16x16x32_bf16 v[76:79], v[28:31], v[204:207], v[76:79]
    s_waitcnt lgkmcnt(2)
    v_exp_f32 v19, v187
    v_mfma_f32_16x16x32_bf16 v[96:99], v[32:35], a[192:195], v[128:131]
    s_add_u32 s81, s81, 196608
    ds_read_b128 v[24:27], v2 offset:6272
    v_fma_f32 v237, v237, v49, v51
    v_mfma_f32_16x16x32_bf16 v[96:99], v[36:39], a[196:199], v[96:99]
    v_cvt_pk_bf16_f32 v184, v16, v17
    v_cvt_pk_bf16_f32 v232, v232, v233
    v_mfma_f32_16x16x32_bf16 v[100:103], v[32:35], a[216:219], v[132:135]
    v_exp_f32 v16, v120
    v_mfma_f32_16x16x32_bf16 v[100:103], v[36:39], a[220:223], v[100:103]
    buffer_load_dwordx4 v[144:147], v12, s[68:71], s35 offen offset:0 nt
    v_mfma_f32_16x16x32_bf16 v[104:107], v[32:35], a[240:243], v[136:139]
    ds_read_b128 v[28:31], v3 offset:6272
    v_add_f32 v6, v6, v18
    v_mfma_f32_16x16x32_bf16 v[104:107], v[36:39], a[244:247], v[104:107]
    v_add_f32 v6, v6, v19
    v_cvt_pk_bf16_f32 v236, v236, v237
    v_mfma_f32_16x16x32_bf16 v[108:111], v[32:35], v[200:203], v[140:143]
    v_exp_f32 v17, v121
    v_mfma_f32_16x16x32_bf16 v[108:111], v[36:39], v[204:207], v[108:111]
    s_waitcnt lgkmcnt(2)
    v_cvt_pk_bf16_f32 v185, v18, v19
    v_cvt_f32_i32 v234, v234
    v_mfma_f32_16x16x32_bf16 v[64:67], v[40:43], a[200:203], v[64:67]
    ds_read_b128 v[32:35], v2 offset:256
    v_mfma_f32_16x16x32_bf16 v[64:67], v[44:47], a[204:207], v[64:67]
    buffer_load_dwordx4 v[148:151], v12, s[68:71], s35 offen offset:768 nt
    v_mfma_f32_16x16x32_bf16 v[68:71], v[40:43], a[224:227], v[68:71]
    v_exp_f32 v18, v122
    v_mfma_f32_16x16x32_bf16 v[68:71], v[44:47], a[228:231], v[68:71]
    v_add_f32 v6, v6, v16
    v_add_f32 v6, v6, v17
    v_mfma_f32_16x16x32_bf16 v[72:75], v[40:43], a[248:251], v[72:75]
    ds_read_b128 v[36:39], v3 offset:256
    v_cvt_f32_i32 v235, v235
    v_mfma_f32_16x16x32_bf16 v[72:75], v[44:47], a[252:255], v[72:75]
    buffer_load_dwordx4 v[152:155], v12, s[68:71], s35 offen offset:1536 nt
    v_mfma_f32_16x16x32_bf16 v[76:79], v[40:43], v[208:211], v[76:79]
    v_exp_f32 v19, v123
    v_mfma_f32_16x16x32_bf16 v[76:79], v[44:47], v[212:215], v[76:79]
    s_waitcnt lgkmcnt(2)
    v_cvt_pk_bf16_f32 v186, v16, v17
    v_cvt_f32_i32 v238, v238
    v_mfma_f32_16x16x32_bf16 v[96:99], v[24:27], a[200:203], v[96:99]
    ds_read_b128 v[40:43], v2 offset:6400
    v_cvt_f32_i32 v239, v239
    v_mfma_f32_16x16x32_bf16 v[96:99], v[28:31], a[204:207], v[96:99]
    v_exp_f32 v16, v188
    v_mfma_f32_16x16x32_bf16 v[100:103], v[24:27], a[224:227], v[100:103]
    v_add_f32 v6, v6, v18
    v_add_f32 v6, v6, v19
    v_mfma_f32_16x16x32_bf16 v[100:103], v[28:31], a[228:231], v[100:103]
    buffer_load_dwordx4 v[156:159], v12, s[68:71], s35 offen offset:2304 nt
    v_mfma_f32_16x16x32_bf16 v[104:107], v[24:27], a[248:251], v[104:107]
    ds_read_b128 v[44:47], v3 offset:6400
    v_fma_f32 v234, v234, v56, v58
    v_mfma_f32_16x16x32_bf16 v[104:107], v[28:31], a[252:255], v[104:107]
    v_exp_f32 v17, v189
    v_mfma_f32_16x16x32_bf16 v[108:111], v[24:27], v[208:211], v[108:111]
    s_add_u32 s29, s30, 49152
    v_cvt_pk_bf16_f32 v187, v18, v19
    v_fma_f32 v235, v235, v57, v59
    v_mfma_f32_16x16x32_bf16 v[108:111], v[28:31], v[212:215], v[108:111]
    s_waitcnt lgkmcnt(2)
    v_exp_f32 v18, v190
    v_mfma_f32_16x16x32_bf16 v[64:67], v[32:35], a[208:211], v[64:67]
    s_mov_b32 m0, s26
    ds_read_b128 v[24:27], v2 offset:12288
    v_add_f32 v7, v7, v16
    v_mfma_f32_16x16x32_bf16 v[64:67], v[36:39], a[212:215], v[64:67]
    s_sub_u32 s3, s29, 147456
    buffer_load_dwordx4 v8, s[4:7], s32 offen offset:0 sc1 lds
    v_mfma_f32_16x16x32_bf16 v[68:71], v[32:35], a[232:235], v[68:71]
    v_add_f32 v7, v7, v17
    v_fma_f32 v238, v238, v56, v58
    v_mfma_f32_16x16x32_bf16 v[68:71], v[36:39], a[236:239], v[68:71]
    v_exp_f32 v19, v191
    v_mfma_f32_16x16x32_bf16 v[72:75], v[32:35], v[192:195], v[72:75]
    ds_read_b128 v[28:31], v3 offset:12288
    v_cvt_pk_bf16_f32 v188, v16, v17
    v_mfma_f32_16x16x32_bf16 v[72:75], v[36:39], v[196:199], v[72:75]
    buffer_load_dwordx4 v8, s[4:7], s32 offen offset:1024 sc1 lds
    v_mfma_f32_16x16x32_bf16 v[76:79], v[32:35], v[216:219], v[76:79]
    s_min_u32 s29, s29, s3
    v_exp_f32 v16, v124
    v_mfma_f32_16x16x32_bf16 v[76:79], v[36:39], v[220:223], v[76:79]
    s_waitcnt lgkmcnt(2)
    v_add_f32 v7, v7, v18
    v_add_f32 v7, v7, v19
    v_mfma_f32_16x16x32_bf16 v[96:99], v[40:43], a[208:211], v[96:99]
    ds_read_b128 v[32:35], v2 offset:18432
    v_fma_f32 v239, v239, v57, v59
    v_mfma_f32_16x16x32_bf16 v[96:99], v[44:47], a[212:215], v[96:99]
    buffer_load_dwordx4 v8, s[4:7], s32 offen offset:2048 sc1 lds
    v_mfma_f32_16x16x32_bf16 v[100:103], v[40:43], a[232:235], v[100:103]
    v_exp_f32 v17, v125
    v_mfma_f32_16x16x32_bf16 v[100:103], v[44:47], a[236:239], v[100:103]
    v_cvt_pk_bf16_f32 v189, v18, v19
    v_cvt_pk_bf16_f32 v233, v234, v235
    v_mfma_f32_16x16x32_bf16 v[104:107], v[40:43], v[192:195], v[104:107]
    s_add_u32 s32, s32, 24576
    ds_read_b128 v[36:39], v3 offset:18432
    v_cvt_pk_bf16_f32 v237, v238, v239
    v_mfma_f32_16x16x32_bf16 v[104:107], v[44:47], v[196:199], v[104:107]
    s_sub_u32 s3, s29, s30
    v_exp_f32 v18, v126
    v_mfma_f32_16x16x32_bf16 v[108:111], v[40:43], v[216:219], v[108:111]
    s_add_u32 s26, s26, 12288
    v_add_f32 v7, v7, v16
    v_add_f32 v7, v7, v17
    v_mfma_f32_16x16x32_bf16 v[108:111], v[44:47], v[220:223], v[108:111]
    s_waitcnt lgkmcnt(2)
    v_exp_f32 v19, v127
    v_mfma_f32_16x16x32_bf16 v[80:83], v[24:27], a[192:195], v[128:131]
    s_mov_b32 m0, s26
    ds_read_b128 v[40:43], v2 offset:12416
    v_cvt_pk_bf16_f32 v190, v16, v17
    v_mfma_f32_16x16x32_bf16 v[80:83], v[28:31], a[196:199], v[80:83]
    v_add_f32 v7, v7, v18
    v_add_f32 v7, v7, v19
    v_mfma_f32_16x16x32_bf16 v[84:87], v[24:27], a[216:219], v[132:135]
    s_mov_b32 s30, s29
    ds_read_b128 v[48:51], v10 offset:1152
    v_cvt_pk_bf16_f32 v191, v18, v19
    v_mfma_f32_16x16x32_bf16 v[84:87], v[28:31], a[220:223], v[84:87]
    s_waitcnt vmcnt(16)
    buffer_load_dwordx4 v8, s[4:7], s32 offen offset:0 sc1 lds
    v_mfma_f32_16x16x32_bf16 v[88:91], v[24:27], a[240:243], v[136:139]
    ds_read_b128 v[44:47], v3 offset:12416
    v_cvt_f32_i32 v240, v240
    v_mfma_f32_16x16x32_bf16 v[88:91], v[28:31], a[244:247], v[88:91]
    v_exp_f32 v16, v64
    v_mfma_f32_16x16x32_bf16 v[92:95], v[24:27], v[200:203], v[140:143]
    v_exp_f32 v17, v65
    v_mfma_f32_16x16x32_bf16 v[92:95], v[28:31], v[204:207], v[92:95]
    s_waitcnt lgkmcnt(3)
    buffer_load_dwordx4 v8, s[4:7], s32 offen offset:1024 sc1 lds
    v_mfma_f32_16x16x32_bf16 v[112:115], v[32:35], a[192:195], v[128:131]
    ds_read_b128 v[24:27], v2 offset:18560
    v_cvt_f32_i32 v241, v241
    v_mfma_f32_16x16x32_bf16 v[112:115], v[36:39], a[196:199], v[112:115]
    v_exp_f32 v18, v66
    v_mfma_f32_16x16x32_bf16 v[116:119], v[32:35], a[216:219], v[132:135]
    v_add_f32 v4, v4, v16
    v_add_f32 v4, v4, v17
    v_mfma_f32_16x16x32_bf16 v[116:119], v[36:39], a[220:223], v[116:119]
    buffer_load_dwordx4 v8, s[4:7], s32 offen offset:2048 sc1 lds
    v_mfma_f32_16x16x32_bf16 v[120:123], v[32:35], a[240:243], v[136:139]
    ds_read_b128 v[28:31], v3 offset:18560
    v_cvt_f32_i32 v244, v244
    v_mfma_f32_16x16x32_bf16 v[120:123], v[36:39], a[244:247], v[120:123]
    v_exp_f32 v19, v67
    v_mfma_f32_16x16x32_bf16 v[124:127], v[32:35], v[200:203], v[140:143]
    ds_read_b128 v[56:59], v23 offset:0
    v_cvt_pk_bf16_f32 v64, v16, v17
    v_mfma_f32_16x16x32_bf16 v[124:127], v[36:39], v[204:207], v[124:127]
    s_waitcnt lgkmcnt(3)
    v_exp_f32 v16, v96
    v_mfma_f32_16x16x32_bf16 v[80:83], v[40:43], a[200:203], v[80:83]
    s_add_u32 s32, s32, 24576
    ds_read_b128 v[32:35], v2 offset:12544
    v_add_f32 v4, v4, v18
    v_mfma_f32_16x16x32_bf16 v[80:83], v[44:47], a[204:207], v[80:83]
    s_add_u32 s26, s26, 36864
    v_add_f32 v4, v4, v19
    v_add_u32 v10, 1792, v10
    v_mfma_f32_16x16x32_bf16 v[84:87], v[40:43], a[224:227], v[84:87]
    v_exp_f32 v17, v97
    v_mfma_f32_16x16x32_bf16 v[84:87], v[44:47], a[228:231], v[84:87]
    s_sub_u32 s57, s26, 147456
    v_cvt_pk_bf16_f32 v65, v18, v19
    v_bfe_u32 v53, v8, 4, 6
    v_mfma_f32_16x16x32_bf16 v[88:91], v[40:43], a[248:251], v[88:91]
    ds_read_b128 v[36:39], v3 offset:12544
    v_add_u32 v1, s3, v1
    v_mfma_f32_16x16x32_bf16 v[88:91], v[44:47], a[252:255], v[88:91]
    v_exp_f32 v18, v98
    v_mfma_f32_16x16x32_bf16 v[92:95], v[40:43], v[208:211], v[92:95]
    s_min_u32 s26, s26, s57
    v_lshlrev_b32 v53, 2, v53
    v_add_f32 v4, v4, v16
    v_mfma_f32_16x16x32_bf16 v[92:95], v[44:47], v[212:215], v[92:95]
    s_waitcnt lgkmcnt(3)
    buffer_load_dword v52, v53, s[20:23], 0 offen sc1
    v_mfma_f32_16x16x32_bf16 v[112:115], v[24:27], a[200:203], v[112:115]
    ds_read_b128 v[40:43], v2 offset:18688
    v_add_f32 v4, v4, v17
    v_mfma_f32_16x16x32_bf16 v[112:115], v[28:31], a[204:207], v[112:115]
    v_exp_f32 v19, v99
    v_mfma_f32_16x16x32_bf16 v[116:119], v[24:27], a[224:227], v[116:119]
    v_cvt_pk_bf16_f32 v66, v16, v17
    v_add_u32 v21, s3, v21
    v_mfma_f32_16x16x32_bf16 v[116:119], v[28:31], a[228:231], v[116:119]
    v_exp_f32 v16, v68
    v_mfma_f32_16x16x32_bf16 v[120:123], v[24:27], a[248:251], v[120:123]
    ds_read_b128 v[44:47], v3 offset:18688
    v_add_u32 v22, s3, v22
    v_mfma_f32_16x16x32_bf16 v[120:123], v[28:31], a[252:255], v[120:123]
    s_waitcnt lgkmcnt(2)
    v_add_f32 v4, v4, v18
    v_cvt_f32_i32 v245, v245
    v_mfma_f32_16x16x32_bf16 v[124:127], v[24:27], v[208:211], v[124:127]
    s_waitcnt vmcnt(37)
    v_add_f32 v4, v4, v19
    v_fma_f32 v240, v240, v60, v62
    v_mfma_f32_16x16x32_bf16 v[124:127], v[28:31], v[212:215], v[124:127]
    s_barrier
    v_exp_f32 v17, v69
    v_mfma_f32_16x16x32_bf16 v[80:83], v[32:35], a[208:211], v[80:83]
    ds_read_b128 v[24:27], v1 offset:0
    v_cvt_pk_bf16_f32 v67, v18, v19
    v_mfma_f32_16x16x32_bf16 v[80:83], v[36:39], a[212:215], v[80:83]
    v_exp_f32 v18, v70
    v_mfma_f32_16x16x32_bf16 v[84:87], v[32:35], a[232:235], v[84:87]
    v_add_f32 v5, v5, v16
    v_fma_f32 v241, v241, v61, v63
    v_mfma_f32_16x16x32_bf16 v[84:87], v[36:39], a[236:239], v[84:87]
    v_add_f32 v5, v5, v17
    v_fma_f32 v244, v244, v60, v62
    v_mfma_f32_16x16x32_bf16 v[88:91], v[32:35], v[192:195], v[88:91]
    ds_read_b128 v[28:31], v1 offset:12288
    v_fma_f32 v245, v245, v61, v63
    v_mfma_f32_16x16x32_bf16 v[88:91], v[36:39], v[196:199], v[88:91]
    v_exp_f32 v19, v71
    v_mfma_f32_16x16x32_bf16 v[92:95], v[32:35], v[216:219], v[92:95]
    v_cvt_pk_bf16_f32 v68, v16, v17
    v_cvt_pk_bf16_f32 v226, v240, v241
    v_mfma_f32_16x16x32_bf16 v[92:95], v[36:39], v[220:223], v[92:95]
    s_waitcnt lgkmcnt(2)
    v_exp_f32 v16, v100
    v_mfma_f32_16x16x32_bf16 v[112:115], v[40:43], a[208:211], v[112:115]
    ds_read_b128 v[32:35], v1 offset:768
    v_add_f32 v5, v5, v18
    v_mfma_f32_16x16x32_bf16 v[112:115], v[44:47], a[212:215], v[112:115]
    v_add_f32 v5, v5, v19
    v_cvt_pk_bf16_f32 v230, v244, v245
    v_mfma_f32_16x16x32_bf16 v[116:119], v[40:43], a[232:235], v[116:119]
    v_exp_f32 v17, v101
    v_mfma_f32_16x16x32_bf16 v[116:119], v[44:47], a[236:239], v[116:119]
    v_cvt_pk_bf16_f32 v69, v18, v19
    v_cvt_f32_i32 v242, v242
    v_mfma_f32_16x16x32_bf16 v[120:123], v[40:43], v[192:195], v[120:123]
    ds_read_b128 v[36:39], v1 offset:13056
    v_cvt_f32_i32 v243, v243
    v_mfma_f32_16x16x32_bf16 v[120:123], v[44:47], v[196:199], v[120:123]
    v_exp_f32 v18, v102
    v_mfma_f32_16x16x32_bf16 v[124:127], v[40:43], v[216:219], v[124:127]
    v_add_f32 v5, v5, v16
    v_add_f32 v5, v5, v17
    v_mfma_f32_16x16x32_bf16 v[124:127], v[44:47], v[220:223], v[124:127]
    s_waitcnt lgkmcnt(2)
    v_exp_f32 v19, v103
    v_cvt_pk_bf16_f32 v70, v16, v17
    v_add_f32 v5, v5, v18
    v_cvt_f32_i32 v246, v246
    v_add_f32 v5, v5, v19
    v_cvt_f32_i32 v247, v247
    v_cvt_pk_bf16_f32 v71, v18, v19
    v_fma_f32 v242, v242, v48, v50
    v_mfma_f32_16x16x32_bf16 a[0:3], v[160:163], v[24:27], a[0:3]
    ds_read_b128 v[40:43], v1 offset:1536
    v_fma_f32 v243, v243, v49, v51
    v_mfma_f32_16x16x32_bf16 a[0:3], v[176:179], v[28:31], a[0:3]
    v_exp_f32 v16, v72
    v_mfma_f32_16x16x32_bf16 a[48:51], v[164:167], v[24:27], a[48:51]
    v_exp_f32 v17, v73
    v_mfma_f32_16x16x32_bf16 a[48:51], v[180:183], v[28:31], a[48:51]
    v_exp_f32 v18, v74
    v_mfma_f32_16x16x32_bf16 a[96:99], v[168:171], v[24:27], a[96:99]
    ds_read_b128 v[44:47], v1 offset:13824
    v_fma_f32 v246, v246, v48, v50
    v_mfma_f32_16x16x32_bf16 a[96:99], v[184:187], v[28:31], a[96:99]
    v_add_f32 v6, v6, v16
    v_add_f32 v6, v6, v17
    v_mfma_f32_16x16x32_bf16 a[144:147], v[172:175], v[24:27], a[144:147]
    v_exp_f32 v19, v75
    v_mfma_f32_16x16x32_bf16 a[144:147], v[188:191], v[28:31], a[144:147]
    s_waitcnt lgkmcnt(2)
    v_fma_f32 v247, v247, v49, v51
    v_mfma_f32_16x16x32_bf16 a[4:7], v[160:163], v[32:35], a[4:7]
    ds_read_b128 v[24:27], v1 offset:2304
    v_cvt_pk_bf16_f32 v72, v16, v17
    v_mfma_f32_16x16x32_bf16 a[4:7], v[176:179], v[36:39], a[4:7]
    v_exp_f32 v16, v104
    v_mfma_f32_16x16x32_bf16 a[52:55], v[164:167], v[32:35], a[52:55]
    v_cvt_pk_bf16_f32 v227, v242, v243
    v_add_f32 v6, v6, v18
    v_mfma_f32_16x16x32_bf16 a[52:55], v[180:183], v[36:39], a[52:55]
    v_add_f32 v6, v6, v19
    v_mfma_f32_16x16x32_bf16 a[100:103], v[168:171], v[32:35], a[100:103]
    ds_read_b128 v[28:31], v1 offset:14592
    v_cvt_pk_bf16_f32 v231, v246, v247
    v_mfma_f32_16x16x32_bf16 a[100:103], v[184:187], v[36:39], a[100:103]
    v_exp_f32 v17, v105
    v_mfma_f32_16x16x32_bf16 a[148:151], v[172:175], v[32:35], a[148:151]
    v_cvt_pk_bf16_f32 v73, v18, v19
    v_mfma_f32_16x16x32_bf16 a[148:151], v[188:191], v[36:39], a[148:151]
    s_waitcnt lgkmcnt(2)
    v_exp_f32 v18, v106
    v_mfma_f32_16x16x32_bf16 a[8:11], v[160:163], v[40:43], a[8:11]
    s_waitcnt vmcnt(18)
    ds_read_b128 v[32:35], v21 offset:0
    v_add_f32 v6, v6, v16
    v_mfma_f32_16x16x32_bf16 a[8:11], v[176:179], v[44:47], a[8:11]
    v_add_f32 v6, v6, v17
    v_mfma_f32_16x16x32_bf16 a[56:59], v[164:167], v[40:43], a[56:59]
    v_exp_f32 v19, v107
    v_mfma_f32_16x16x32_bf16 a[56:59], v[180:183], v[44:47], a[56:59]
    v_mfma_f32_16x16x32_bf16 a[104:107], v[168:171], v[40:43], a[104:107]
    ds_read_b128 v[36:39], v21 offset:12288
    v_cvt_pk_bf16_f32 v74, v16, v17
    v_mfma_f32_16x16x32_bf16 a[104:107], v[184:187], v[44:47], a[104:107]
    v_exp_f32 v16, v76
    v_mfma_f32_16x16x32_bf16 a[152:155], v[172:175], v[40:43], a[152:155]
    v_cvt_f32_i32 v248, v248
    v_add_f32 v6, v6, v18
    v_mfma_f32_16x16x32_bf16 a[152:155], v[188:191], v[44:47], a[152:155]
    s_waitcnt lgkmcnt(2)
    v_add_f32 v6, v6, v19
    v_cvt_f32_i32 v249, v249
    v_mfma_f32_16x16x32_bf16 a[12:15], v[160:163], v[24:27], a[12:15]
    ds_read_b128 v[40:43], v21 offset:768
    v_mfma_f32_16x16x32_bf16 a[12:15], v[176:179], v[28:31], a[12:15]
    buffer_load_dwordx4 v[240:243], v12, s[68:71], s36 offen offset:0 nt
    v_mfma_f32_16x16x32_bf16 a[60:63], v[164:167], v[24:27], a[60:63]
    v_exp_f32 v17, v77
    v_mfma_f32_16x16x32_bf16 a[60:63], v[180:183], v[28:31], a[60:63]
    v_cvt_pk_bf16_f32 v75, v18, v19
    v_cvt_f32_i32 v252, v252
    v_mfma_f32_16x16x32_bf16 a[108:111], v[168:171], v[24:27], a[108:111]
    ds_read_b128 v[44:47], v21 offset:13056
    v_mfma_f32_16x16x32_bf16 a[108:111], v[184:187], v[28:31], a[108:111]
    v_exp_f32 v18, v78
    v_mfma_f32_16x16x32_bf16 a[156:159], v[172:175], v[24:27], a[156:159]
    s_add_u32 s29, s28, 49152
    v_add_f32 v7, v7, v16
    v_add_f32 v7, v7, v17
    v_mfma_f32_16x16x32_bf16 a[156:159], v[188:191], v[28:31], a[156:159]
    s_waitcnt lgkmcnt(2)
    v_exp_f32 v19, v79
    v_mfma_f32_16x16x32_bf16 a[16:19], v[160:163], v[32:35], a[16:19]
    ds_read_b128 v[24:27], v21 offset:1536
    v_cvt_pk_bf16_f32 v76, v16, v17
    v_mfma_f32_16x16x32_bf16 a[16:19], v[176:179], v[36:39], a[16:19]
    s_sub_u32 s3, s29, 147456
    buffer_load_dwordx4 v[244:247], v12, s[68:71], s36 offen offset:768 nt
    v_mfma_f32_16x16x32_bf16 a[64:67], v[164:167], v[32:35], a[64:67]
    v_exp_f32 v16, v108
    v_mfma_f32_16x16x32_bf16 a[64:67], v[180:183], v[36:39], a[64:67]
    v_add_f32 v7, v7, v18
    v_cvt_f32_i32 v253, v253
    v_mfma_f32_16x16x32_bf16 a[112:115], v[168:171], v[32:35], a[112:115]
    ds_read_b128 v[28:31], v21 offset:13824
    v_add_f32 v7, v7, v19
    v_mfma_f32_16x16x32_bf16 a[112:115], v[184:187], v[36:39], a[112:115]
    v_exp_f32 v17, v109
    v_mfma_f32_16x16x32_bf16 a[160:163], v[172:175], v[32:35], a[160:163]
    v_fma_f32 v248, v248, v60, v62
    v_cvt_pk_bf16_f32 v77, v18, v19
    v_mfma_f32_16x16x32_bf16 a[160:163], v[188:191], v[36:39], a[160:163]
    s_waitcnt lgkmcnt(2)
    v_exp_f32 v18, v110
    v_mfma_f32_16x16x32_bf16 a[20:23], v[160:163], v[40:43], a[20:23]
    s_min_u32 s29, s29, s3
    ds_read_b128 v[32:35], v21 offset:2304
    v_fma_f32 v249, v249, v61, v63
    v_mfma_f32_16x16x32_bf16 a[20:23], v[176:179], v[44:47], a[20:23]
    v_add_f32 v7, v7, v16
    v_add_f32 v7, v7, v17
    v_mfma_f32_16x16x32_bf16 a[68:71], v[164:167], v[40:43], a[68:71]
    v_exp_f32 v19, v111
    v_mfma_f32_16x16x32_bf16 a[68:71], v[180:183], v[44:47], a[68:71]
    v_fma_f32 v252, v252, v60, v62
    v_mfma_f32_16x16x32_bf16 a[116:119], v[168:171], v[40:43], a[116:119]
    ds_read_b128 v[36:39], v21 offset:14592
    v_cvt_pk_bf16_f32 v78, v16, v17
    v_mfma_f32_16x16x32_bf16 a[116:119], v[184:187], v[44:47], a[116:119]
    s_waitcnt vmcnt(2)
    v_subrev_u32 v52, s92, v52
    v_cmp_lt_u32 vcc, 15, v52
    v_mfma_f32_16x16x32_bf16 a[164:167], v[172:175], v[40:43], a[164:167]
    s_sub_u32 s3, s29, s28
    v_exp_f32 v16, v80
    v_mfma_f32_16x16x32_bf16 a[164:167], v[188:191], v[44:47], a[164:167]
    s_waitcnt lgkmcnt(2)
    v_add_f32 v7, v7, v18
    v_add_f32 v7, v7, v19
    v_mfma_f32_16x16x32_bf16 a[24:27], v[160:163], v[24:27], a[24:27]
    s_and_b32 s59, vcc_lo, 0xff
    ds_read_b128 v[40:43], v22 offset:0
    v_fma_f32 v253, v253, v61, v63
    v_mfma_f32_16x16x32_bf16 a[24:27], v[176:179], v[28:31], a[24:27]
    s_cbranch_scc1 L_pollslow1
L_pollok1:
    v_mfma_f32_16x16x32_bf16 a[72:75], v[164:167], v[24:27], a[72:75]
    s_add_u32 s92, s92, 1
    v_exp_f32 v17, v81
    v_mfma_f32_16x16x32_bf16 a[72:75], v[180:183], v[28:31], a[72:75]
    s_mov_b32 m0, s56
    v_cvt_pk_bf16_f32 v79, v18, v19
    v_cvt_pk_bf16_f32 v234, v248, v249
    v_mfma_f32_16x16x32_bf16 a[120:123], v[168:171], v[24:27], a[120:123]
    ds_read_b128 v[44:47], v22 offset:12288
    v_mfma_f32_16x16x32_bf16 a[120:123], v[184:187], v[28:31], a[120:123]
    s_mov_b32 s28, s29
    buffer_load_dwordx4 v8, s[4:7], s27 offen offset:0 sc1 lds
    v_mfma_f32_16x16x32_bf16 a[168:171], v[172:175], v[24:27], a[168:171]
    v_exp_f32 v18, v82
    v_mfma_f32_16x16x32_bf16 a[168:171], v[188:191], v[28:31], a[168:171]
    s_waitcnt lgkmcnt(2)
    v_add_f32 v4, v4, v16
    v_add_f32 v4, v4, v17
    v_mfma_f32_16x16x32_bf16 a[28:31], v[160:163], v[32:35], a[28:31]
    ds_read_b128 v[24:27], v22 offset:768
    v_cvt_pk_bf16_f32 v238, v252, v253
    v_mfma_f32_16x16x32_bf16 a[28:31], v[176:179], v[36:39], a[28:31]
    buffer_load_dwordx4 v8, s[4:7], s27 offen offset:1024 sc1 lds
    v_mfma_f32_16x16x32_bf16 a[76:79], v[164:167], v[32:35], a[76:79]
    v_exp_f32 v19, v83
    v_mfma_f32_16x16x32_bf16 a[76:79], v[180:183], v[36:39], a[76:79]
    v_cvt_pk_bf16_f32 v80, v16, v17
    v_cvt_f32_i32 v250, v250
    v_mfma_f32_16x16x32_bf16 a[124:127], v[168:171], v[32:35], a[124:127]
    ds_read_b128 v[28:31], v22 offset:13056
    v_cvt_f32_i32 v251, v251
    v_mfma_f32_16x16x32_bf16 a[124:127], v[184:187], v[36:39], a[124:127]
    buffer_load_dwordx4 v8, s[4:7], s27 offen offset:2048 sc1 lds
    v_mfma_f32_16x16x32_bf16 a[172:175], v[172:175], v[32:35], a[172:175]
    v_exp_f32 v16, v112
    v_mfma_f32_16x16x32_bf16 a[172:175], v[188:191], v[36:39], a[172:175]
    s_waitcnt lgkmcnt(2)
    v_add_f32 v4, v4, v18
    v_add_f32 v4, v4, v19
    v_mfma_f32_16x16x32_bf16 a[32:35], v[160:163], v[40:43], a[32:35]
    s_add_u32 s27, s27, 24576
    ds_read_b128 v[32:35], v22 offset:1536
    v_add_u32 v2, s3, v2
    v_mfma_f32_16x16x32_bf16 a[32:35], v[176:179], v[44:47], a[32:35]
    v_exp_f32 v17, v113
    v_mfma_f32_16x16x32_bf16 a[80:83], v[164:167], v[40:43], a[80:83]
    s_add_u32 s56, s56, 12288
    v_cvt_pk_bf16_f32 v81, v18, v19
    v_cvt_f32_i32 v254, v254
    v_mfma_f32_16x16x32_bf16 a[80:83], v[180:183], v[44:47], a[80:83]
    v_exp_f32 v18, v114
    v_mfma_f32_16x16x32_bf16 a[128:131], v[168:171], v[40:43], a[128:131]
    ds_read_b128 v[36:39], v22 offset:13824
    v_add_f32 v4, v4, v16
    v_mfma_f32_16x16x32_bf16 a[128:131], v[184:187], v[44:47], a[128:131]
    s_mov_b32 m0, s56
    v_add_f32 v4, v4, v17
    v_cvt_f32_i32 v255, v255
    v_mfma_f32_16x16x32_bf16 a[176:179], v[172:175], v[40:43], a[176:179]
    v_exp_f32 v19, v115
    v_mfma_f32_16x16x32_bf16 a[176:179], v[188:191], v[44:47], a[176:179]
    s_waitcnt lgkmcnt(2)
    v_cvt_pk_bf16_f32 v82, v16, v17
    v_add_u32 v3, s3, v3
    v_mfma_f32_16x16x32_bf16 a[36:39], v[160:163], v[24:27], a[36:39]
    ds_read_b128 v[40:43], v22 offset:2304
    v_fma_f32 v250, v250, v48, v50
    v_mfma_f32_16x16x32_bf16 a[36:39], v[176:179], v[28:31], a[36:39]
    buffer_load_dwordx4 v8, s[4:7], s27 offen offset:0 sc1 lds
    v_mfma_f32_16x16x32_bf16 a[84:87], v[164:167], v[24:27], a[84:87]
    v_exp_f32 v16, v84
    v_mfma_f32_16x16x32_bf16 a[84:87], v[180:183], v[28:31], a[84:87]
    v_add_f32 v4, v4, v18
    v_add_f32 v4, v4, v19
    v_mfma_f32_16x16x32_bf16 a[132:135], v[168:171], v[24:27], a[132:135]
    ds_read_b128 v[44:47], v22 offset:14592
    v_fma_f32 v251, v251, v49, v51
    v_mfma_f32_16x16x32_bf16 a[132:135], v[184:187], v[28:31], a[132:135]
    s_waitcnt lgkmcnt(2)
    buffer_load_dwordx4 v8, s[4:7], s27 offen offset:1024 sc1 lds
    v_mfma_f32_16x16x32_bf16 a[180:183], v[172:175], v[24:27], a[180:183]
    s_waitcnt vmcnt(19)
    v_exp_f32 v17, v85
    v_mfma_f32_16x16x32_bf16 a[180:183], v[188:191], v[28:31], a[180:183]
    s_barrier
    v_cvt_pk_bf16_f32 v83, v18, v19
    v_mfma_f32_16x16x32_bf16 a[40:43], v[160:163], v[32:35], a[40:43]
    ds_read_b128 v[24:27], v2 offset:0
    v_fma_f32 v254, v254, v48, v50
    v_mfma_f32_16x16x32_bf16 a[40:43], v[176:179], v[36:39], a[40:43]
    buffer_load_dwordx4 v8, s[4:7], s27 offen offset:2048 sc1 lds
    v_mfma_f32_16x16x32_bf16 a[88:91], v[164:167], v[32:35], a[88:91]
    v_exp_f32 v18, v86
    v_mfma_f32_16x16x32_bf16 a[88:91], v[180:183], v[36:39], a[88:91]
    v_add_f32 v5, v5, v16
    v_add_f32 v5, v5, v17
    v_mfma_f32_16x16x32_bf16 a[136:139], v[168:171], v[32:35], a[136:139]
    ds_read_b128 v[28:31], v3 offset:0
    v_fma_f32 v255, v255, v49, v51
    v_mfma_f32_16x16x32_bf16 a[136:139], v[184:187], v[36:39], a[136:139]
    v_exp_f32 v19, v87
    v_cvt_pk_bf16_f32 v84, v16, v17
    v_mfma_f32_16x16x32_bf16 a[184:187], v[172:175], v[32:35], a[184:187]
    s_add_u32 s27, s27, 24576
    v_exp_f32 v16, v116
    v_mfma_f32_16x16x32_bf16 a[184:187], v[188:191], v[36:39], a[184:187]
    s_waitcnt lgkmcnt(2)
    v_add_f32 v5, v5, v18
    v_add_f32 v5, v5, v19
    v_mfma_f32_16x16x32_bf16 a[44:47], v[160:163], v[40:43], a[44:47]
    s_add_u32 s56, s56, 36864
    ds_read_b128 v[32:35], v2 offset:6144
    v_cvt_pk_bf16_f32 v235, v250, v251
    v_mfma_f32_16x16x32_bf16 a[44:47], v[176:179], v[44:47], a[44:47]
    s_sub_u32 s58, s56, 147456
    v_exp_f32 v17, v117
    v_mfma_f32_16x16x32_bf16 a[92:95], v[164:167], v[40:43], a[92:95]
    v_cvt_pk_bf16_f32 v85, v18, v19
    v_cvt_pk_bf16_f32 v239, v254, v255
    v_mfma_f32_16x16x32_bf16 a[92:95], v[180:183], v[44:47], a[92:95]
    s_min_u32 s56, s56, s58
    v_exp_f32 v18, v118
    v_mfma_f32_16x16x32_bf16 a[140:143], v[168:171], v[40:43], a[140:143]
    ds_read_b128 v[36:39], v3 offset:6144
    v_add_f32 v5, v5, v16
    v_mfma_f32_16x16x32_bf16 a[140:143], v[184:187], v[44:47], a[140:143]
    v_add_f32 v5, v5, v17
    v_mfma_f32_16x16x32_bf16 a[188:191], v[172:175], v[40:43], a[188:191]
    v_exp_f32 v19, v119
    v_mfma_f32_16x16x32_bf16 a[188:191], v[188:191], v[44:47], a[188:191]
    s_waitcnt lgkmcnt(2)
    v_cvt_pk_bf16_f32 v86, v16, v17
    v_add_f32 v5, v5, v18
    v_add_f32 v5, v5, v19
    v_cvt_pk_bf16_f32 v87, v18, v19
    v_mfma_f32_16x16x32_bf16 v[160:163], v[24:27], a[192:195], v[128:131]
    ds_read_b128 v[40:43], v2 offset:128
    v_mfma_f32_16x16x32_bf16 v[160:163], v[28:31], a[196:199], v[160:163]
    buffer_store_dwordx4 v[224:227], v11, s[4:7], s37 offen offset:0 sc1
    v_mfma_f32_16x16x32_bf16 v[164:167], v[24:27], a[216:219], v[132:135]
    v_exp_f32 v16, v88
    v_mfma_f32_16x16x32_bf16 v[164:167], v[28:31], a[220:223], v[164:167]
    v_exp_f32 v17, v89
    v_mfma_f32_16x16x32_bf16 v[168:171], v[24:27], a[240:243], v[136:139]
    ds_read_b128 v[44:47], v3 offset:128
    v_mfma_f32_16x16x32_bf16 v[168:171], v[28:31], a[244:247], v[168:171]
    v_exp_f32 v18, v90
    v_mfma_f32_16x16x32_bf16 v[172:175], v[24:27], v[200:203], v[140:143]
    v_add_f32 v6, v6, v16
    v_add_f32 v6, v6, v17
    v_mfma_f32_16x16x32_bf16 v[172:175], v[28:31], v[204:207], v[172:175]
    s_waitcnt lgkmcnt(2)
    v_exp_f32 v19, v91
    v_mfma_f32_16x16x32_bf16 v[96:99], v[32:35], a[192:195], v[128:131]
    ds_read_b128 v[24:27], v2 offset:6272
    v_cvt_pk_bf16_f32 v88, v16, v17
    v_mfma_f32_16x16x32_bf16 v[96:99], v[36:39], a[196:199], v[96:99]
    buffer_store_dwordx4 v[228:231], v54, s[4:7], s37 offen offset:768 sc1
    v_mfma_f32_16x16x32_bf16 v[100:103], v[32:35], a[216:219], v[132:135]
    v_exp_f32 v16, v120
    v_mfma_f32_16x16x32_bf16 v[100:103], v[36:39], a[220:223], v[100:103]
    v_add_f32 v6, v6, v18
    v_mfma_f32_16x16x32_bf16 v[104:107], v[32:35], a[240:243], v[136:139]
    ds_read_b128 v[28:31], v3 offset:6272
    v_add_f32 v6, v6, v19
    v_mfma_f32_16x16x32_bf16 v[104:107], v[36:39], a[244:247], v[104:107]
    v_exp_f32 v17, v121
    v_mfma_f32_16x16x32_bf16 v[108:111], v[32:35], v[200:203], v[140:143]
    v_mfma_f32_16x16x32_bf16 v[108:111], v[36:39], v[204:207], v[108:111]
    s_waitcnt lgkmcnt(2)
    v_cvt_pk_bf16_f32 v89, v18, v19
    v_mfma_f32_16x16x32_bf16 v[160:163], v[40:43], a[200:203], v[160:163]
    ds_read_b128 v[32:35], v2 offset:256
    v_mfma_f32_16x16x32_bf16 v[160:163], v[44:47], a[204:207], v[160:163]
    buffer_store_dwordx4 v[232:235], v11, s[4:7], s80 offen offset:0 sc1
    v_mfma_f32_16x16x32_bf16 v[164:167], v[40:43], a[224:227], v[164:167]
    v_exp_f32 v18, v122
    v_mfma_f32_16x16x32_bf16 v[164:167], v[44:47], a[228:231], v[164:167]
    v_add_f32 v6, v6, v16
    v_add_f32 v6, v6, v17
    v_mfma_f32_16x16x32_bf16 v[168:171], v[40:43], a[248:251], v[168:171]
    ds_read_b128 v[36:39], v3 offset:256
    v_mfma_f32_16x16x32_bf16 v[168:171], v[44:47], a[252:255], v[168:171]
    v_exp_f32 v19, v123
    v_mfma_f32_16x16x32_bf16 v[172:175], v[40:43], v[208:211], v[172:175]
    v_cvt_pk_bf16_f32 v90, v16, v17
    v_mfma_f32_16x16x32_bf16 v[172:175], v[44:47], v[212:215], v[172:175]
    s_waitcnt lgkmcnt(2)
    v_exp_f32 v16, v92
    v_mfma_f32_16x16x32_bf16 v[96:99], v[24:27], a[200:203], v[96:99]
    ds_read_b128 v[40:43], v2 offset:6400
    v_add_f32 v6, v6, v18
    v_mfma_f32_16x16x32_bf16 v[96:99], v[28:31], a[204:207], v[96:99]
    buffer_store_dwordx4 v[236:239], v54, s[4:7], s80 offen offset:768 sc1
    v_mfma_f32_16x16x32_bf16 v[100:103], v[24:27], a[224:227], v[100:103]
    v_add_f32 v6, v6, v19
    v_mfma_f32_16x16x32_bf16 v[100:103], v[28:31], a[228:231], v[100:103]
    v_exp_f32 v17, v93
    v_mfma_f32_16x16x32_bf16 v[104:107], v[24:27], a[248:251], v[104:107]
    ds_read_b128 v[44:47], v3 offset:6400
    v_cvt_pk_bf16_f32 v91, v18, v19
    v_mfma_f32_16x16x32_bf16 v[104:107], v[28:31], a[252:255], v[104:107]
    v_exp_f32 v18, v94
    s_branch L_skip5
L_pad5:
    s_branch L_tb1_9
L_skip5:
    v_mfma_f32_16x16x32_bf16 v[108:111], v[24:27], v[208:211], v[108:111]
    s_add_u32 s29, s30, 49152
    ds_read_b128 v[60:63], v23 offset:16
    v_add_f32 v7, v7, v16
    v_mfma_f32_16x16x32_bf16 v[108:111], v[28:31], v[212:215], v[108:111]
    s_waitcnt lgkmcnt(3)
    v_add_f32 v7, v7, v17
    s_waitcnt vmcnt(21)
    v_mfma_f32_16x16x32_bf16 v[160:163], v[32:35], a[208:211], v[160:163]
    ds_read_b128 v[24:27], v2 offset:12288
    s_sub_u32 s3, s29, 147456
    v_mfma_f32_16x16x32_bf16 v[160:163], v[36:39], a[212:215], v[160:163]
    buffer_load_dwordx4 v[248:251], v12, s[68:71], s36 offen offset:1536 nt
    v_mfma_f32_16x16x32_bf16 v[164:167], v[32:35], a[232:235], v[164:167]
    v_exp_f32 v19, v95
    v_mfma_f32_16x16x32_bf16 v[164:167], v[36:39], a[236:239], v[164:167]
    v_cvt_pk_bf16_f32 v92, v16, v17
    v_cvt_f32_i32 v144, v144
    v_mfma_f32_16x16x32_bf16 v[168:171], v[32:35], v[192:195], v[168:171]
    ds_read_b128 v[28:31], v3 offset:12288
    v_cvt_f32_i32 v148, v148
    v_mfma_f32_16x16x32_bf16 v[168:171], v[36:39], v[196:199], v[168:171]
    buffer_load_dwordx4 v[252:255], v12, s[68:71], s36 offen offset:2304 nt
    v_mfma_f32_16x16x32_bf16 v[172:175], v[32:35], v[216:219], v[172:175]
    s_min_u32 s29, s29, s3
    v_exp_f32 v16, v124
    v_mfma_f32_16x16x32_bf16 v[172:175], v[36:39], v[220:223], v[172:175]
    s_waitcnt lgkmcnt(3)
    v_add_f32 v7, v7, v18
    v_add_f32 v7, v7, v19
    v_mfma_f32_16x16x32_bf16 v[96:99], v[40:43], a[208:211], v[96:99]
    ds_read_b128 v[32:35], v2 offset:18432
    v_cvt_f32_i32 v145, v145
    v_mfma_f32_16x16x32_bf16 v[96:99], v[44:47], a[212:215], v[96:99]
    v_exp_f32 v17, v125
    v_mfma_f32_16x16x32_bf16 v[100:103], v[40:43], a[232:235], v[100:103]
    ds_read_b128 v[48:51], v23 offset:32
    v_cvt_pk_bf16_f32 v93, v18, v19
    v_mfma_f32_16x16x32_bf16 v[100:103], v[44:47], a[236:239], v[100:103]
    v_exp_f32 v18, v126
    v_mfma_f32_16x16x32_bf16 v[104:107], v[40:43], v[192:195], v[104:107]
    s_mov_b32 m0, s56
    ds_read_b128 v[36:39], v3 offset:18432
    v_add_f32 v7, v7, v16
    v_mfma_f32_16x16x32_bf16 v[104:107], v[44:47], v[196:199], v[104:107]
    s_sub_u32 s3, s29, s30
    v_add_f32 v7, v7, v17
    v_cvt_f32_i32 v149, v149
    v_mfma_f32_16x16x32_bf16 v[108:111], v[40:43], v[216:219], v[108:111]
    v_exp_f32 v19, v127
    v_mfma_f32_16x16x32_bf16 v[108:111], v[44:47], v[220:223], v[108:111]
    s_waitcnt lgkmcnt(3)
    buffer_load_dwordx4 v8, s[4:7], s27 offen offset:0 sc1 lds
    v_mfma_f32_16x16x32_bf16 v[176:179], v[24:27], a[192:195], v[128:131]
    ds_read_b128 v[40:43], v2 offset:12416
    v_cvt_pk_bf16_f32 v94, v16, v17
    v_mfma_f32_16x16x32_bf16 v[176:179], v[28:31], a[196:199], v[176:179]
    v_add_f32 v7, v7, v18
    v_add_f32 v7, v7, v19
    v_mfma_f32_16x16x32_bf16 v[180:183], v[24:27], a[216:219], v[132:135]
    s_mov_b32 s30, s29
    v_cvt_pk_bf16_f32 v95, v18, v19
    v_fma_f32 v144, v144, v56, v58
    v_mfma_f32_16x16x32_bf16 v[180:183], v[28:31], a[220:223], v[180:183]
    v_fma_f32 v148, v148, v57, v59
    v_fma_f32 v145, v145, v56, v58
    v_mfma_f32_16x16x32_bf16 v[184:187], v[24:27], a[240:243], v[136:139]
    ds_read_b128 v[44:47], v3 offset:12416
    v_fma_f32 v149, v149, v57, v59
    v_mfma_f32_16x16x32_bf16 v[184:187], v[28:31], a[244:247], v[184:187]
    buffer_load_dwordx4 v8, s[4:7], s27 offen offset:1024 sc1 lds
    v_mfma_f32_16x16x32_bf16 v[188:191], v[24:27], v[200:203], v[140:143]
    v_exp_f32 v16, v160
    v_mfma_f32_16x16x32_bf16 v[188:191], v[28:31], v[204:207], v[188:191]
    s_waitcnt lgkmcnt(2)
    v_exp_f32 v17, v161
    v_mfma_f32_16x16x32_bf16 v[112:115], v[32:35], a[192:195], v[128:131]
    ds_read_b128 v[24:27], v2 offset:18560
    v_cvt_f32_i32 v146, v146
    v_mfma_f32_16x16x32_bf16 v[112:115], v[36:39], a[196:199], v[112:115]
    v_exp_f32 v18, v162
    v_mfma_f32_16x16x32_bf16 v[116:119], v[32:35], a[216:219], v[132:135]
    v_add_f32 v4, v4, v16
    v_add_f32 v4, v4, v17
    v_mfma_f32_16x16x32_bf16 v[116:119], v[36:39], a[220:223], v[116:119]
    buffer_load_dwordx4 v8, s[4:7], s27 offen offset:2048 sc1 lds
    v_mfma_f32_16x16x32_bf16 v[120:123], v[32:35], a[240:243], v[136:139]
    ds_read_b128 v[28:31], v3 offset:18560
    v_cvt_f32_i32 v150, v150
    v_mfma_f32_16x16x32_bf16 v[120:123], v[36:39], a[244:247], v[120:123]
    v_exp_f32 v19, v163
    v_mfma_f32_16x16x32_bf16 v[124:127], v[32:35], v[200:203], v[140:143]
    v_cvt_pk_bf16_f32 v160, v16, v17
    v_cvt_f32_i32 v147, v147
    v_mfma_f32_16x16x32_bf16 v[124:127], v[36:39], v[204:207], v[124:127]
    s_waitcnt lgkmcnt(2)
    v_exp_f32 v16, v96
    v_mfma_f32_16x16x32_bf16 v[176:179], v[40:43], a[200:203], v[176:179]
    s_add_u32 s27, s27, 24576
    ds_read_b128 v[32:35], v2 offset:12544
    v_add_f32 v4, v4, v18
    v_mfma_f32_16x16x32_bf16 v[176:179], v[44:47], a[204:207], v[176:179]
    v_add_f32 v4, v4, v19
    v_cvt_f32_i32 v151, v151
    v_mfma_f32_16x16x32_bf16 v[180:183], v[40:43], a[224:227], v[180:183]
    s_add_u32 s56, s56, 12288
    v_exp_f32 v17, v97
    v_mfma_f32_16x16x32_bf16 v[180:183], v[44:47], a[228:231], v[180:183]
    v_cvt_pk_bf16_f32 v161, v18, v19
    v_add_u32 v1, s3, v1
    v_mfma_f32_16x16x32_bf16 v[184:187], v[40:43], a[248:251], v[184:187]
    ds_read_b128 v[36:39], v3 offset:12544
    v_fma_f32 v146, v146, v56, v58
    v_mfma_f32_16x16x32_bf16 v[184:187], v[44:47], a[252:255], v[184:187]
    v_exp_f32 v18, v98
    v_mfma_f32_16x16x32_bf16 v[188:191], v[40:43], v[208:211], v[188:191]
    s_mov_b32 m0, s56
    v_add_f32 v4, v4, v16
    v_add_f32 v4, v4, v17
    v_mfma_f32_16x16x32_bf16 v[188:191], v[44:47], v[212:215], v[188:191]
    s_waitcnt lgkmcnt(2)
    v_exp_f32 v19, v99
    v_mfma_f32_16x16x32_bf16 v[112:115], v[24:27], a[200:203], v[112:115]
    ds_read_b128 v[40:43], v2 offset:18688
    v_fma_f32 v150, v150, v57, v59
    v_mfma_f32_16x16x32_bf16 v[112:115], v[28:31], a[204:207], v[112:115]
    v_cvt_pk_bf16_f32 v162, v16, v17
    v_add_u32 v21, s3, v21
    v_mfma_f32_16x16x32_bf16 v[116:119], v[24:27], a[224:227], v[116:119]
    v_exp_f32 v16, v164
    v_mfma_f32_16x16x32_bf16 v[116:119], v[28:31], a[228:231], v[116:119]
    buffer_load_dwordx4 v8, s[4:7], s27 offen offset:0 sc1 lds
    v_mfma_f32_16x16x32_bf16 v[120:123], v[24:27], a[248:251], v[120:123]
    ds_read_b128 v[44:47], v3 offset:18688
    v_add_u32 v22, s3, v22
    v_mfma_f32_16x16x32_bf16 v[120:123], v[28:31], a[252:255], v[120:123]
    s_waitcnt lgkmcnt(2)
    v_add_f32 v4, v4, v18
    v_add_f32 v4, v4, v19
    v_mfma_f32_16x16x32_bf16 v[124:127], v[24:27], v[208:211], v[124:127]
    s_waitcnt vmcnt(6)
    v_exp_f32 v17, v165
    v_mfma_f32_16x16x32_bf16 v[124:127], v[28:31], v[212:215], v[124:127]
    s_barrier
    v_fma_f32 v147, v147, v56, v58
    v_mfma_f32_16x16x32_bf16 v[176:179], v[32:35], a[208:211], v[176:179]
    ds_read_b128 v[24:27], v1 offset:0
    v_cvt_pk_bf16_f32 v163, v18, v19
    v_mfma_f32_16x16x32_bf16 v[176:179], v[36:39], a[212:215], v[176:179]
    buffer_load_dwordx4 v8, s[4:7], s27 offen offset:1024 sc1 lds
    v_mfma_f32_16x16x32_bf16 v[180:183], v[32:35], a[232:235], v[180:183]
    v_exp_f32 v18, v166
    v_mfma_f32_16x16x32_bf16 v[180:183], v[36:39], a[236:239], v[180:183]
    v_add_f32 v5, v5, v16
    v_add_f32 v5, v5, v17
    v_mfma_f32_16x16x32_bf16 v[184:187], v[32:35], v[192:195], v[184:187]
    ds_read_b128 v[28:31], v1 offset:12288
    v_fma_f32 v151, v151, v57, v59
    v_mfma_f32_16x16x32_bf16 v[184:187], v[36:39], v[196:199], v[184:187]
    v_exp_f32 v19, v167
    v_mfma_f32_16x16x32_bf16 v[188:191], v[32:35], v[216:219], v[188:191]
    ds_read_b128 v[56:59], v23 offset:48
    v_cvt_pk_bf16_f32 v164, v16, v17
    v_mfma_f32_16x16x32_bf16 v[188:191], v[36:39], v[220:223], v[188:191]
    s_waitcnt lgkmcnt(3)
    buffer_load_dwordx4 v8, s[4:7], s27 offen offset:2048 sc1 lds
    v_mfma_f32_16x16x32_bf16 v[112:115], v[40:43], a[208:211], v[112:115]
    s_waitcnt vmcnt(27)
    ds_read_b128 v[32:35], v1 offset:768
    v_cvt_f32_i32 v152, v152
    v_mfma_f32_16x16x32_bf16 v[112:115], v[44:47], a[212:215], v[112:115]
    v_exp_f32 v16, v100
    v_add_f32 v5, v5, v18
    v_mfma_f32_16x16x32_bf16 v[116:119], v[40:43], a[232:235], v[116:119]
    v_add_f32 v5, v5, v19
    v_cvt_f32_i32 v156, v156
    v_mfma_f32_16x16x32_bf16 v[116:119], v[44:47], a[236:239], v[116:119]
    v_exp_f32 v17, v101
    v_mfma_f32_16x16x32_bf16 v[120:123], v[40:43], v[192:195], v[120:123]
    ds_read_b128 v[36:39], v1 offset:13056
    v_cvt_pk_bf16_f32 v165, v18, v19
    v_mfma_f32_16x16x32_bf16 v[120:123], v[44:47], v[196:199], v[120:123]
    v_add_u32 v55, 1, v55
    buffer_store_dword v55, v13, s[20:23], 0 offen sc1
    v_mfma_f32_16x16x32_bf16 v[124:127], v[40:43], v[216:219], v[124:127]
    s_add_u32 s27, s27, 24576
    v_exp_f32 v18, v102
    v_mfma_f32_16x16x32_bf16 v[124:127], v[44:47], v[220:223], v[124:127]
    s_waitcnt lgkmcnt(3)
    v_add_f32 v5, v5, v16
    v_add_f32 v5, v5, v17
    v_exp_f32 v19, v103
    v_cvt_f32_i32 v153, v153
    v_add_u32 v23, 1792, v23
    v_cvt_pk_bf16_f32 v166, v16, v17
    v_cvt_f32_i32 v157, v157
    v_add_f32 v5, v5, v18
    s_add_u32 s56, s56, 36864
    v_fma_f32 v152, v152, v60, v62
    v_add_f32 v5, v5, v19
    s_sub_u32 s58, s56, 147456
    v_fma_f32 v156, v156, v61, v63
    v_cvt_pk_bf16_f32 v167, v18, v19
    s_min_u32 s56, s56, s58
    v_fma_f32 v153, v153, v60, v62
    v_mfma_f32_16x16x32_bf16 a[0:3], v[64:67], v[24:27], a[0:3]
    s_mov_b32 m0, s26
    ds_read_b128 v[40:43], v1 offset:1536
    v_fma_f32 v157, v157, v61, v63
    v_mfma_f32_16x16x32_bf16 a[0:3], v[80:83], v[28:31], a[0:3]
    v_exp_f32 v16, v168
    v_mfma_f32_16x16x32_bf16 a[48:51], v[68:71], v[24:27], a[48:51]
    v_exp_f32 v17, v169
    v_mfma_f32_16x16x32_bf16 a[48:51], v[84:87], v[28:31], a[48:51]
    buffer_load_dwordx4 v8, s[4:7], s32 offen offset:0 sc1 lds
    v_mfma_f32_16x16x32_bf16 a[96:99], v[72:75], v[24:27], a[96:99]
    ds_read_b128 v[44:47], v1 offset:13824
    v_cvt_f32_i32 v154, v154
    v_mfma_f32_16x16x32_bf16 a[96:99], v[88:91], v[28:31], a[96:99]
    v_exp_f32 v18, v170
    v_mfma_f32_16x16x32_bf16 a[144:147], v[76:79], v[24:27], a[144:147]
    v_add_f32 v6, v6, v16
    v_add_f32 v6, v6, v17
    v_mfma_f32_16x16x32_bf16 a[144:147], v[92:95], v[28:31], a[144:147]
    s_waitcnt lgkmcnt(2)
    buffer_load_dwordx4 v8, s[4:7], s32 offen offset:1024 sc1 lds
    v_mfma_f32_16x16x32_bf16 a[4:7], v[64:67], v[32:35], a[4:7]
    ds_read_b128 v[24:27], v1 offset:2304
    v_cvt_f32_i32 v158, v158
    v_mfma_f32_16x16x32_bf16 a[4:7], v[80:83], v[36:39], a[4:7]
    v_exp_f32 v19, v171
    v_mfma_f32_16x16x32_bf16 a[52:55], v[68:71], v[32:35], a[52:55]
    v_cvt_pk_bf16_f32 v168, v16, v17
    v_cvt_f32_i32 v155, v155
    v_mfma_f32_16x16x32_bf16 a[52:55], v[84:87], v[36:39], a[52:55]
    v_exp_f32 v16, v104
    v_mfma_f32_16x16x32_bf16 a[100:103], v[72:75], v[32:35], a[100:103]
    ds_read_b128 v[28:31], v1 offset:14592
    v_add_f32 v6, v6, v18
    v_mfma_f32_16x16x32_bf16 a[100:103], v[88:91], v[36:39], a[100:103]
    buffer_load_dwordx4 v8, s[4:7], s32 offen offset:2048 sc1 lds
    v_mfma_f32_16x16x32_bf16 a[148:151], v[76:79], v[32:35], a[148:151]
    v_add_f32 v6, v6, v19
    v_cvt_f32_i32 v159, v159
    v_mfma_f32_16x16x32_bf16 a[148:151], v[92:95], v[36:39], a[148:151]
    s_waitcnt lgkmcnt(2)
    v_exp_f32 v17, v105
    v_mfma_f32_16x16x32_bf16 a[8:11], v[64:67], v[40:43], a[8:11]
    s_add_u32 s32, s32, 24576
    ds_read_b128 v[32:35], v21 offset:0
    v_cvt_pk_bf16_f32 v169, v18, v19
    v_mfma_f32_16x16x32_bf16 a[8:11], v[80:83], v[44:47], a[8:11]
    v_exp_f32 v18, v106
    v_mfma_f32_16x16x32_bf16 a[56:59], v[68:71], v[40:43], a[56:59]
    v_add_f32 v6, v6, v16
    v_add_f32 v6, v6, v17
    v_mfma_f32_16x16x32_bf16 a[56:59], v[84:87], v[44:47], a[56:59]
    s_add_u32 s26, s26, 12288
    v_fma_f32 v154, v154, v60, v62
    v_fma_f32 v158, v158, v61, v63
    v_mfma_f32_16x16x32_bf16 a[104:107], v[72:75], v[40:43], a[104:107]
    ds_read_b128 v[36:39], v21 offset:12288
    v_fma_f32 v155, v155, v60, v62
    v_mfma_f32_16x16x32_bf16 a[104:107], v[88:91], v[44:47], a[104:107]
    v_exp_f32 v19, v107
    v_mfma_f32_16x16x32_bf16 a[152:155], v[76:79], v[40:43], a[152:155]
    s_mov_b32 m0, s56
    v_cvt_pk_bf16_f32 v170, v16, v17
    v_mfma_f32_16x16x32_bf16 a[152:155], v[92:95], v[44:47], a[152:155]
    s_waitcnt lgkmcnt(2)
    v_exp_f32 v16, v172
    v_mfma_f32_16x16x32_bf16 a[12:15], v[64:67], v[24:27], a[12:15]
    ds_read_b128 v[40:43], v21 offset:768
    v_add_f32 v6, v6, v18
    v_mfma_f32_16x16x32_bf16 a[12:15], v[80:83], v[28:31], a[12:15]
    buffer_load_dwordx4 v8, s[4:7], s27 offen offset:0 sc1 lds
    v_mfma_f32_16x16x32_bf16 a[60:63], v[68:71], v[24:27], a[60:63]
    v_add_f32 v6, v6, v19
    v_fma_f32 v159, v159, v61, v63
    v_mfma_f32_16x16x32_bf16 a[60:63], v[84:87], v[28:31], a[60:63]
    v_exp_f32 v17, v173
    v_mfma_f32_16x16x32_bf16 a[108:111], v[72:75], v[24:27], a[108:111]
    ds_read_b128 v[44:47], v21 offset:13056
    v_cvt_pk_bf16_f32 v171, v18, v19
    v_mfma_f32_16x16x32_bf16 a[108:111], v[88:91], v[28:31], a[108:111]
    v_exp_f32 v18, v174
    v_mfma_f32_16x16x32_bf16 a[156:159], v[76:79], v[24:27], a[156:159]
    s_add_u32 s29, s28, 49152
    v_add_f32 v7, v7, v16
    v_add_f32 v7, v7, v17
    v_mfma_f32_16x16x32_bf16 a[156:159], v[92:95], v[28:31], a[156:159]
    s_waitcnt lgkmcnt(2)
    buffer_load_dwordx4 v8, s[4:7], s27 offen offset:1024 sc1 lds
    v_mfma_f32_16x16x32_bf16 a[16:19], v[64:67], v[32:35], a[16:19]
    ds_read_b128 v[24:27], v21 offset:1536
    v_cvt_pk_bf16_f32 v144, v144, v148
    v_mfma_f32_16x16x32_bf16 a[16:19], v[80:83], v[36:39], a[16:19]
    s_sub_u32 s3, s29, 147456
    v_exp_f32 v19, v175
    v_mfma_f32_16x16x32_bf16 a[64:67], v[68:71], v[32:35], a[64:67]
    v_cvt_pk_bf16_f32 v172, v16, v17
    v_cvt_pk_bf16_f32 v148, v145, v149
    v_mfma_f32_16x16x32_bf16 a[64:67], v[84:87], v[36:39], a[64:67]
    v_exp_f32 v16, v108
    v_mfma_f32_16x16x32_bf16 a[112:115], v[72:75], v[32:35], a[112:115]
    ds_read_b128 v[28:31], v21 offset:13824
    v_add_f32 v7, v7, v18
    v_mfma_f32_16x16x32_bf16 a[112:115], v[88:91], v[36:39], a[112:115]
    buffer_load_dwordx4 v8, s[4:7], s27 offen offset:2048 sc1 lds
    v_mfma_f32_16x16x32_bf16 a[160:163], v[76:79], v[32:35], a[160:163]
    v_add_f32 v7, v7, v19
    v_cvt_pk_bf16_f32 v145, v152, v156
    v_mfma_f32_16x16x32_bf16 a[160:163], v[92:95], v[36:39], a[160:163]
    s_waitcnt lgkmcnt(2)
    v_exp_f32 v17, v109
    v_mfma_f32_16x16x32_bf16 a[20:23], v[64:67], v[40:43], a[20:23]
    s_add_u32 s27, s27, 24576
    ds_read_b128 v[32:35], v21 offset:2304
    v_cvt_pk_bf16_f32 v173, v18, v19
    v_mfma_f32_16x16x32_bf16 a[20:23], v[80:83], v[44:47], a[20:23]
    s_min_u32 s29, s29, s3
    v_exp_f32 v18, v110
    v_mfma_f32_16x16x32_bf16 a[68:71], v[68:71], v[40:43], a[68:71]
    s_add_u32 s56, s56, 12288
    v_add_f32 v7, v7, v16
    v_cvt_pk_bf16_f32 v149, v153, v157
    v_mfma_f32_16x16x32_bf16 a[68:71], v[84:87], v[44:47], a[68:71]
    v_add_f32 v7, v7, v17
    v_cvt_pk_bf16_f32 v152, v146, v150
    v_mfma_f32_16x16x32_bf16 a[116:119], v[72:75], v[40:43], a[116:119]
    ds_read_b128 v[36:39], v21 offset:14592
    v_cvt_pk_bf16_f32 v153, v154, v158
    v_mfma_f32_16x16x32_bf16 a[116:119], v[88:91], v[44:47], a[116:119]
    s_mov_b32 m0, s56
    v_exp_f32 v19, v111
    v_mfma_f32_16x16x32_bf16 a[164:167], v[76:79], v[40:43], a[164:167]
    s_sub_u32 s3, s29, s28
    v_cvt_pk_bf16_f32 v174, v16, v17
    v_cvt_pk_bf16_f32 v156, v147, v151
    v_mfma_f32_16x16x32_bf16 a[164:167], v[92:95], v[44:47], a[164:167]
    s_waitcnt lgkmcnt(2)
    v_exp_f32 v16, v176
    v_mfma_f32_16x16x32_bf16 a[24:27], v[64:67], v[24:27], a[24:27]
    ds_read_b128 v[40:43], v22 offset:0
    v_add_f32 v7, v7, v18
    v_mfma_f32_16x16x32_bf16 a[24:27], v[80:83], v[28:31], a[24:27]
    buffer_load_dwordx4 v8, s[4:7], s27 offen offset:0 sc1 lds
    v_mfma_f32_16x16x32_bf16 a[72:75], v[68:71], v[24:27], a[72:75]
    v_add_f32 v7, v7, v19
    v_cvt_pk_bf16_f32 v157, v155, v159
    v_mfma_f32_16x16x32_bf16 a[72:75], v[84:87], v[28:31], a[72:75]
    s_waitcnt vmcnt(26)
    v_exp_f32 v17, v177
    v_mfma_f32_16x16x32_bf16 a[120:123], v[72:75], v[24:27], a[120:123]
    ds_read_b128 v[44:47], v22 offset:12288
    v_cvt_pk_bf16_f32 v175, v18, v19
    v_mfma_f32_16x16x32_bf16 a[120:123], v[88:91], v[28:31], a[120:123]
    s_mov_b32 s28, s29
    v_exp_f32 v18, v178
    v_mfma_f32_16x16x32_bf16 a[168:171], v[76:79], v[24:27], a[168:171]
    v_add_f32 v4, v4, v16
    v_add_f32 v4, v4, v17
    v_mfma_f32_16x16x32_bf16 a[168:171], v[92:95], v[28:31], a[168:171]
    s_waitcnt lgkmcnt(2)
    buffer_load_dwordx4 v8, s[4:7], s27 offen offset:1024 sc1 lds
    v_mfma_f32_16x16x32_bf16 a[28:31], v[64:67], v[32:35], a[28:31]
    ds_read_b128 v[24:27], v22 offset:768
    v_cvt_f32_i32 v240, v240
    v_mfma_f32_16x16x32_bf16 a[28:31], v[80:83], v[36:39], a[28:31]
    v_exp_f32 v19, v179
    v_mfma_f32_16x16x32_bf16 a[76:79], v[68:71], v[32:35], a[76:79]
    v_cvt_pk_bf16_f32 v176, v16, v17
    v_cvt_f32_i32 v244, v244
    v_mfma_f32_16x16x32_bf16 a[76:79], v[84:87], v[36:39], a[76:79]
    buffer_load_dwordx4 v8, s[4:7], s27 offen offset:2048 sc1 lds
    v_mfma_f32_16x16x32_bf16 a[124:127], v[72:75], v[32:35], a[124:127]
    ds_read_b128 v[28:31], v22 offset:13056
    v_cvt_f32_i32 v241, v241
    v_mfma_f32_16x16x32_bf16 a[124:127], v[88:91], v[36:39], a[124:127]
    v_exp_f32 v16, v112
    v_mfma_f32_16x16x32_bf16 a[172:175], v[76:79], v[32:35], a[172:175]
    v_add_f32 v4, v4, v18
    v_add_f32 v4, v4, v19
    v_mfma_f32_16x16x32_bf16 a[172:175], v[92:95], v[36:39], a[172:175]
    s_waitcnt lgkmcnt(2)
    v_exp_f32 v17, v113
    v_mfma_f32_16x16x32_bf16 a[32:35], v[64:67], v[40:43], a[32:35]
    ds_read_b128 v[32:35], v22 offset:1536
    v_cvt_pk_bf16_f32 v177, v18, v19
    v_mfma_f32_16x16x32_bf16 a[32:35], v[80:83], v[44:47], a[32:35]
    s_add_u32 s27, s27, 24576
    v_exp_f32 v18, v114
    v_mfma_f32_16x16x32_bf16 a[80:83], v[68:71], v[40:43], a[80:83]
    s_add_u32 s56, s56, 36864
    v_add_f32 v4, v4, v16
    v_add_f32 v4, v4, v17
    v_mfma_f32_16x16x32_bf16 a[80:83], v[84:87], v[44:47], a[80:83]
    v_exp_f32 v19, v115
    v_mfma_f32_16x16x32_bf16 a[128:131], v[72:75], v[40:43], a[128:131]
    ds_read_b128 v[36:39], v22 offset:13824
    v_add_u32 v2, s3, v2
    v_mfma_f32_16x16x32_bf16 a[128:131], v[88:91], v[44:47], a[128:131]
    s_sub_u32 s58, s56, 147456
    v_bfe_u32 v53, v8, 4, 6
    v_cvt_pk_bf16_f32 v178, v16, v17
    v_mfma_f32_16x16x32_bf16 a[176:179], v[76:79], v[40:43], a[176:179]
    v_cvt_f32_i32 v245, v245
    v_lshlrev_b32 v53, 2, v53
    v_mfma_f32_16x16x32_bf16 a[176:179], v[92:95], v[44:47], a[176:179]
    s_waitcnt lgkmcnt(2)
    buffer_load_dword v52, v53, s[20:23], 0 offen sc1
    v_mfma_f32_16x16x32_bf16 a[36:39], v[64:67], v[24:27], a[36:39]
    s_min_u32 s56, s56, s58
    ds_read_b128 v[40:43], v22 offset:2304
    v_fma_f32 v240, v240, v48, v50
    v_mfma_f32_16x16x32_bf16 a[36:39], v[80:83], v[28:31], a[36:39]
    v_exp_f32 v16, v180
    v_mfma_f32_16x16x32_bf16 a[84:87], v[68:71], v[24:27], a[84:87]
    v_add_f32 v4, v4, v18
    v_add_f32 v4, v4, v19
    v_mfma_f32_16x16x32_bf16 a[84:87], v[84:87], v[28:31], a[84:87]
    v_exp_f32 v17, v181
    v_mfma_f32_16x16x32_bf16 a[132:135], v[72:75], v[24:27], a[132:135]
    ds_read_b128 v[44:47], v22 offset:14592
    v_add_u32 v3, s3, v3
    v_mfma_f32_16x16x32_bf16 a[132:135], v[88:91], v[28:31], a[132:135]
    s_waitcnt lgkmcnt(2)
    v_cvt_pk_bf16_f32 v179, v18, v19
    v_fma_f32 v244, v244, v49, v51
    v_mfma_f32_16x16x32_bf16 a[180:183], v[76:79], v[24:27], a[180:183]
    s_waitcnt vmcnt(32)
    v_exp_f32 v18, v182
    v_mfma_f32_16x16x32_bf16 a[180:183], v[92:95], v[28:31], a[180:183]
    s_barrier
    v_add_f32 v5, v5, v16
    v_mfma_f32_16x16x32_bf16 a[40:43], v[64:67], v[32:35], a[40:43]
    s_add_u32 s33, s33, 196608
    ds_read_b128 v[24:27], v2 offset:0
    v_add_f32 v5, v5, v17
    v_mfma_f32_16x16x32_bf16 a[40:43], v[80:83], v[36:39], a[40:43]
    s_sub_u32 s34, s33, 1572864
    v_exp_f32 v19, v183
    v_mfma_f32_16x16x32_bf16 a[88:91], v[68:71], v[32:35], a[88:91]
    s_min_u32 s33, s33, s34
    v_cvt_pk_bf16_f32 v180, v16, v17
    v_fma_f32 v241, v241, v48, v50
    v_mfma_f32_16x16x32_bf16 a[88:91], v[84:87], v[36:39], a[88:91]
    s_add_u32 s34, s33, 3072
    v_exp_f32 v16, v116
    v_mfma_f32_16x16x32_bf16 a[136:139], v[72:75], v[32:35], a[136:139]
    s_add_u32 s37, s37, 196608
    ds_read_b128 v[28:31], v3 offset:0
    v_fma_f32 v245, v245, v49, v51
    v_mfma_f32_16x16x32_bf16 a[136:139], v[88:91], v[36:39], a[136:139]
    s_add_u32 s80, s80, 196608
    v_add_f32 v5, v5, v18
    v_add_f32 v5, v5, v19
    v_mfma_f32_16x16x32_bf16 a[184:187], v[76:79], v[32:35], a[184:187]
    v_exp_f32 v17, v117
    v_mfma_f32_16x16x32_bf16 a[184:187], v[92:95], v[36:39], a[184:187]
    s_waitcnt lgkmcnt(2)
    buffer_load_dwordx4 v[224:227], v9, s[64:67], s33 offen offset:0 nt
    v_mfma_f32_16x16x32_bf16 a[44:47], v[64:67], v[40:43], a[44:47]
    ds_read_b128 v[32:35], v2 offset:6144
    v_cvt_pk_bf16_f32 v181, v18, v19
    v_mfma_f32_16x16x32_bf16 a[44:47], v[80:83], v[44:47], a[44:47]
    v_cvt_f32_i32 v242, v242
    v_cvt_f32_i32 v246, v246
    v_mfma_f32_16x16x32_bf16 a[92:95], v[68:71], v[40:43], a[92:95]
    v_exp_f32 v18, v118
    v_mfma_f32_16x16x32_bf16 a[92:95], v[84:87], v[44:47], a[92:95]
    buffer_load_dwordx4 v[228:231], v9, s[64:67], s33 offen offset:1536 nt
    v_mfma_f32_16x16x32_bf16 a[140:143], v[72:75], v[40:43], a[140:143]
    ds_read_b128 v[36:39], v3 offset:6144
    v_add_f32 v5, v5, v16
    v_mfma_f32_16x16x32_bf16 a[140:143], v[88:91], v[44:47], a[140:143]
    v_add_f32 v5, v5, v17
    v_cvt_f32_i32 v243, v243
    v_mfma_f32_16x16x32_bf16 a[188:191], v[76:79], v[40:43], a[188:191]
    buffer_load_dwordx4 v[232:235], v9, s[64:67], s34 offen offset:0 nt
    buffer_load_dwordx4 v[236:239], v9, s[64:67], s34 offen offset:1536 nt
    v_mfma_f32_16x16x32_bf16 a[188:191], v[92:95], v[44:47], a[188:191]
    s_waitcnt lgkmcnt(2)
    v_exp_f32 v19, v119
    v_cvt_pk_bf16_f32 v182, v16, v17
    v_add_f32 v5, v5, v18
    v_add_f32 v5, v5, v19
    v_cvt_f32_i32 v247, v247
    v_cvt_pk_bf16_f32 v183, v18, v19
    v_fma_f32 v242, v242, v48, v50
    v_mfma_f32_16x16x32_bf16 v[64:67], v[24:27], a[192:195], v[128:131]
    s_mov_b32 m0, s26
    ds_read_b128 v[40:43], v2 offset:128
    v_fma_f32 v246, v246, v49, v51
    v_mfma_f32_16x16x32_bf16 v[64:67], v[28:31], a[196:199], v[64:67]
    v_exp_f32 v16, v184
    v_mfma_f32_16x16x32_bf16 v[68:71], v[24:27], a[216:219], v[132:135]
    v_exp_f32 v17, v185
    v_mfma_f32_16x16x32_bf16 v[68:71], v[28:31], a[220:223], v[68:71]
    buffer_load_dwordx4 v8, s[4:7], s32 offen offset:0 sc1 lds
    v_mfma_f32_16x16x32_bf16 v[72:75], v[24:27], a[240:243], v[136:139]
    ds_read_b128 v[44:47], v3 offset:128
    v_fma_f32 v243, v243, v48, v50
    v_mfma_f32_16x16x32_bf16 v[72:75], v[28:31], a[244:247], v[72:75]
    v_exp_f32 v18, v186
    v_mfma_f32_16x16x32_bf16 v[76:79], v[24:27], v[200:203], v[140:143]
    v_add_f32 v6, v6, v16
    v_add_f32 v6, v6, v17
    v_mfma_f32_16x16x32_bf16 v[76:79], v[28:31], v[204:207], v[76:79]
    s_waitcnt lgkmcnt(2)
    v_exp_f32 v19, v187
    v_mfma_f32_16x16x32_bf16 v[96:99], v[32:35], a[192:195], v[128:131]
    ds_read_b128 v[24:27], v2 offset:6272
    v_fma_f32 v247, v247, v49, v51
    v_mfma_f32_16x16x32_bf16 v[96:99], v[36:39], a[196:199], v[96:99]
    ds_read_b128 v[48:51], v10 offset:0
    v_cvt_pk_bf16_f32 v184, v16, v17
    v_mfma_f32_16x16x32_bf16 v[100:103], v[32:35], a[216:219], v[132:135]
    v_exp_f32 v16, v120
    v_mfma_f32_16x16x32_bf16 v[100:103], v[36:39], a[220:223], v[100:103]
    buffer_load_dwordx4 v8, s[4:7], s32 offen offset:1024 sc1 lds
    v_mfma_f32_16x16x32_bf16 v[104:107], v[32:35], a[240:243], v[136:139]
    ds_read_b128 v[28:31], v3 offset:6272
    v_add_f32 v6, v6, v18
    v_mfma_f32_16x16x32_bf16 v[104:107], v[36:39], a[244:247], v[104:107]
    v_add_f32 v6, v6, v19
    v_cvt_pk_bf16_f32 v146, v240, v244
    v_mfma_f32_16x16x32_bf16 v[108:111], v[32:35], v[200:203], v[140:143]
    v_exp_f32 v17, v121
    v_mfma_f32_16x16x32_bf16 v[108:111], v[36:39], v[204:207], v[108:111]
    s_waitcnt lgkmcnt(3)
    v_cvt_pk_bf16_f32 v185, v18, v19
    v_cvt_pk_bf16_f32 v150, v241, v245
    v_mfma_f32_16x16x32_bf16 v[64:67], v[40:43], a[200:203], v[64:67]
    ds_read_b128 v[32:35], v2 offset:256
    v_mfma_f32_16x16x32_bf16 v[64:67], v[44:47], a[204:207], v[64:67]
    buffer_load_dwordx4 v8, s[4:7], s32 offen offset:2048 sc1 lds
    v_mfma_f32_16x16x32_bf16 v[68:71], v[40:43], a[224:227], v[68:71]
    v_exp_f32 v18, v122
    v_mfma_f32_16x16x32_bf16 v[68:71], v[44:47], a[228:231], v[68:71]
    v_add_f32 v6, v6, v16
    v_add_f32 v6, v6, v17
    v_mfma_f32_16x16x32_bf16 v[72:75], v[40:43], a[248:251], v[72:75]
    ds_read_b128 v[36:39], v3 offset:256
    v_cvt_pk_bf16_f32 v154, v242, v246
    v_mfma_f32_16x16x32_bf16 v[72:75], v[44:47], a[252:255], v[72:75]
    v_exp_f32 v19, v123
    v_mfma_f32_16x16x32_bf16 v[76:79], v[40:43], v[208:211], v[76:79]
    v_cvt_pk_bf16_f32 v186, v16, v17
    v_cvt_pk_bf16_f32 v158, v243, v247
    v_mfma_f32_16x16x32_bf16 v[76:79], v[44:47], v[212:215], v[76:79]
    s_waitcnt lgkmcnt(2)
    v_exp_f32 v16, v188
    v_mfma_f32_16x16x32_bf16 v[96:99], v[24:27], a[200:203], v[96:99]
    s_waitcnt vmcnt(24)
    ds_read_b128 v[40:43], v2 offset:6400
    v_add_f32 v6, v6, v18
    v_mfma_f32_16x16x32_bf16 v[96:99], v[28:31], a[204:207], v[96:99]
    s_add_u32 s32, s32, 24576
    v_add_f32 v6, v6, v19
    v_mfma_f32_16x16x32_bf16 v[100:103], v[24:27], a[224:227], v[100:103]
    s_add_u32 s26, s26, 36864
    v_exp_f32 v17, v189
    v_mfma_f32_16x16x32_bf16 v[100:103], v[28:31], a[228:231], v[100:103]
    v_cvt_pk_bf16_f32 v187, v18, v19
    v_mfma_f32_16x16x32_bf16 v[104:107], v[24:27], a[248:251], v[104:107]
    ds_read_b128 v[44:47], v3 offset:6400
    v_cvt_f32_i32 v248, v248
    v_mfma_f32_16x16x32_bf16 v[104:107], v[28:31], a[252:255], v[104:107]
    s_sub_u32 s57, s26, 147456
    v_exp_f32 v18, v190
    v_mfma_f32_16x16x32_bf16 v[108:111], v[24:27], v[208:211], v[108:111]
    s_add_u32 s29, s30, 49152
    v_add_f32 v7, v7, v16
    v_mfma_f32_16x16x32_bf16 v[108:111], v[28:31], v[212:215], v[108:111]
    s_waitcnt lgkmcnt(2)
    buffer_load_dwordx4 v[240:243], v9, s[64:67], s33 offen offset:384 nt
    v_mfma_f32_16x16x32_bf16 v[64:67], v[32:35], a[208:211], v[64:67]
    s_sub_u32 s3, s29, 147456
    ds_read_b128 v[24:27], v2 offset:12288
    v_add_f32 v7, v7, v17
    v_mfma_f32_16x16x32_bf16 v[64:67], v[36:39], a[212:215], v[64:67]
    s_min_u32 s26, s26, s57
    v_exp_f32 v19, v191
    v_mfma_f32_16x16x32_bf16 v[68:71], v[32:35], a[232:235], v[68:71]
    v_cvt_pk_bf16_f32 v188, v16, v17
    v_cvt_f32_i32 v252, v252
    v_mfma_f32_16x16x32_bf16 v[68:71], v[36:39], a[236:239], v[68:71]
    buffer_load_dwordx4 v[244:247], v9, s[64:67], s33 offen offset:1920 nt
    v_mfma_f32_16x16x32_bf16 v[72:75], v[32:35], v[192:195], v[72:75]
    ds_read_b128 v[28:31], v3 offset:12288
    v_cvt_f32_i32 v249, v249
    v_mfma_f32_16x16x32_bf16 v[72:75], v[36:39], v[196:199], v[72:75]
    v_exp_f32 v16, v124
    v_mfma_f32_16x16x32_bf16 v[76:79], v[32:35], v[216:219], v[76:79]
    s_min_u32 s29, s29, s3
    v_add_f32 v7, v7, v18
    v_add_f32 v7, v7, v19
    v_mfma_f32_16x16x32_bf16 v[76:79], v[36:39], v[220:223], v[76:79]
    s_waitcnt lgkmcnt(2)
    v_exp_f32 v17, v125
    v_mfma_f32_16x16x32_bf16 v[96:99], v[40:43], a[208:211], v[96:99]
    ds_read_b128 v[32:35], v2 offset:18432
    v_cvt_f32_i32 v253, v253
    v_mfma_f32_16x16x32_bf16 v[96:99], v[44:47], a[212:215], v[96:99]
    v_cvt_pk_bf16_f32 v189, v18, v19
    v_fma_f32 v248, v248, v56, v58
    v_mfma_f32_16x16x32_bf16 v[100:103], v[40:43], a[232:235], v[100:103]
    v_exp_f32 v18, v126
    v_mfma_f32_16x16x32_bf16 v[100:103], v[44:47], a[236:239], v[100:103]
    v_add_f32 v7, v7, v16
    v_mfma_f32_16x16x32_bf16 v[104:107], v[40:43], v[192:195], v[104:107]
    s_sub_u32 s3, s29, s30
    ds_read_b128 v[36:39], v3 offset:18432
    v_add_f32 v7, v7, v17
    v_mfma_f32_16x16x32_bf16 v[104:107], v[44:47], v[196:199], v[104:107]
    s_waitcnt vmcnt(9)
    v_subrev_u32 v52, s92, v52
    v_cmp_lt_u32 vcc, 15, v52
    v_mfma_f32_16x16x32_bf16 v[108:111], v[40:43], v[216:219], v[108:111]
    v_exp_f32 v19, v127
    v_mfma_f32_16x16x32_bf16 v[108:111], v[44:47], v[220:223], v[108:111]
    s_waitcnt lgkmcnt(2)
    v_cvt_pk_bf16_f32 v190, v16, v17
    v_fma_f32 v252, v252, v57, v59
    s_branch L_skip6
L_pad6:
    s_branch L_tb1_8
L_skip6:
    v_mfma_f32_16x16x32_bf16 v[80:83], v[24:27], a[192:195], v[128:131]
    s_and_b32 s59, vcc_lo, 0xff
    ds_read_b128 v[40:43], v2 offset:12416
    v_add_f32 v7, v7, v18
    v_mfma_f32_16x16x32_bf16 v[80:83], v[28:31], a[196:199], v[80:83]
    s_cbranch_scc1 L_pollslow2
L_pollok2:
    v_mfma_f32_16x16x32_bf16 v[84:87], v[24:27], a[216:219], v[132:135]
    s_add_u32 s92, s92, 1
    v_add_f32 v7, v7, v19
    v_cvt_pk_bf16_f32 v191, v18, v19
    v_mfma_f32_16x16x32_bf16 v[84:87], v[28:31], a[220:223], v[84:87]
    s_mov_b32 m0, s26
    v_fma_f32 v249, v249, v56, v58
    v_fma_f32 v253, v253, v57, v59
    v_mfma_f32_16x16x32_bf16 v[88:91], v[24:27], a[240:243], v[136:139]
    s_mov_b32 s30, s29
    ds_read_b128 v[44:47], v3 offset:12416
    v_mfma_f32_16x16x32_bf16 v[88:91], v[28:31], a[244:247], v[88:91]
    buffer_load_dwordx4 v8, s[4:7], s32 offen offset:0 sc1 lds
    v_mfma_f32_16x16x32_bf16 v[92:95], v[24:27], v[200:203], v[140:143]
    v_exp_f32 v16, v64
    v_mfma_f32_16x16x32_bf16 v[92:95], v[28:31], v[204:207], v[92:95]
    s_waitcnt lgkmcnt(2)
    v_exp_f32 v17, v65
    v_mfma_f32_16x16x32_bf16 v[112:115], v[32:35], a[192:195], v[128:131]
    ds_read_b128 v[24:27], v2 offset:18560
    v_cvt_f32_i32 v250, v250
    v_mfma_f32_16x16x32_bf16 v[112:115], v[36:39], a[196:199], v[112:115]
    v_exp_f32 v18, v66
    v_mfma_f32_16x16x32_bf16 v[116:119], v[32:35], a[216:219], v[132:135]
    v_add_f32 v4, v4, v16
    v_add_f32 v4, v4, v17
    v_mfma_f32_16x16x32_bf16 v[116:119], v[36:39], a[220:223], v[116:119]
    buffer_load_dwordx4 v8, s[4:7], s32 offen offset:1024 sc1 lds
    v_mfma_f32_16x16x32_bf16 v[120:123], v[32:35], a[240:243], v[136:139]
    ds_read_b128 v[28:31], v3 offset:18560
    v_cvt_f32_i32 v254, v254
    v_mfma_f32_16x16x32_bf16 v[120:123], v[36:39], a[244:247], v[120:123]
    v_exp_f32 v19, v67
    v_mfma_f32_16x16x32_bf16 v[124:127], v[32:35], v[200:203], v[140:143]
    v_cvt_pk_bf16_f32 v64, v16, v17
    v_add_u32 v1, s3, v1
    v_mfma_f32_16x16x32_bf16 v[124:127], v[36:39], v[204:207], v[124:127]
    s_waitcnt lgkmcnt(2)
    v_exp_f32 v16, v96
    v_mfma_f32_16x16x32_bf16 v[80:83], v[40:43], a[200:203], v[80:83]
    ds_read_b128 v[32:35], v2 offset:12544
    v_add_f32 v4, v4, v18
    v_mfma_f32_16x16x32_bf16 v[80:83], v[44:47], a[204:207], v[80:83]
    buffer_load_dwordx4 v8, s[4:7], s32 offen offset:2048 sc1 lds
    v_mfma_f32_16x16x32_bf16 v[84:87], v[40:43], a[224:227], v[84:87]
    v_add_f32 v4, v4, v19
    v_cvt_f32_i32 v251, v251
    v_mfma_f32_16x16x32_bf16 v[84:87], v[44:47], a[228:231], v[84:87]
    v_exp_f32 v17, v97
    v_mfma_f32_16x16x32_bf16 v[88:91], v[40:43], a[248:251], v[88:91]
    s_add_u32 s32, s32, 24576
    ds_read_b128 v[36:39], v3 offset:12544
    v_cvt_pk_bf16_f32 v65, v18, v19
    v_mfma_f32_16x16x32_bf16 v[88:91], v[44:47], a[252:255], v[88:91]
    v_exp_f32 v18, v98
    v_mfma_f32_16x16x32_bf16 v[92:95], v[40:43], v[208:211], v[92:95]
    s_add_u32 s26, s26, 12288
    v_add_f32 v4, v4, v16
    v_add_f32 v4, v4, v17
    v_mfma_f32_16x16x32_bf16 v[92:95], v[44:47], v[212:215], v[92:95]
    s_waitcnt lgkmcnt(2)
    v_exp_f32 v19, v99
    v_mfma_f32_16x16x32_bf16 v[112:115], v[24:27], a[200:203], v[112:115]
    ds_read_b128 v[40:43], v2 offset:18688
    v_add_u32 v21, s3, v21
    v_mfma_f32_16x16x32_bf16 v[112:115], v[28:31], a[204:207], v[112:115]
    s_mov_b32 m0, s26
    v_cvt_pk_bf16_f32 v66, v16, v17
    v_cvt_f32_i32 v255, v255
    v_mfma_f32_16x16x32_bf16 v[116:119], v[24:27], a[224:227], v[116:119]
    v_exp_f32 v16, v68
    v_mfma_f32_16x16x32_bf16 v[116:119], v[28:31], a[228:231], v[116:119]
    v_add_f32 v4, v4, v18
    v_add_u32 v22, s3, v22
    v_mfma_f32_16x16x32_bf16 v[120:123], v[24:27], a[248:251], v[120:123]
    ds_read_b128 v[44:47], v3 offset:18688
    v_add_f32 v4, v4, v19
    v_mfma_f32_16x16x32_bf16 v[120:123], v[28:31], a[252:255], v[120:123]
    s_waitcnt lgkmcnt(2)
    buffer_load_dwordx4 v8, s[4:7], s32 offen offset:0 sc1 lds
    v_mfma_f32_16x16x32_bf16 v[124:127], v[24:27], v[208:211], v[124:127]
    s_waitcnt vmcnt(24)
    v_exp_f32 v17, v69
    v_mfma_f32_16x16x32_bf16 v[124:127], v[28:31], v[212:215], v[124:127]
    s_barrier
    v_cvt_pk_bf16_f32 v67, v18, v19
    v_mfma_f32_16x16x32_bf16 v[80:83], v[32:35], a[208:211], v[80:83]
    ds_read_b128 v[24:27], v1 offset:0
    v_fma_f32 v250, v250, v56, v58
    v_mfma_f32_16x16x32_bf16 v[80:83], v[36:39], a[212:215], v[80:83]
    v_exp_f32 v18, v70
    v_mfma_f32_16x16x32_bf16 v[84:87], v[32:35], a[232:235], v[84:87]
    v_add_f32 v5, v5, v16
    v_add_f32 v5, v5, v17
    v_mfma_f32_16x16x32_bf16 v[84:87], v[36:39], a[236:239], v[84:87]
    buffer_load_dwordx4 v8, s[4:7], s32 offen offset:1024 sc1 lds
    v_mfma_f32_16x16x32_bf16 v[88:91], v[32:35], v[192:195], v[88:91]
    ds_read_b128 v[28:31], v1 offset:12288
    v_fma_f32 v254, v254, v57, v59
    v_mfma_f32_16x16x32_bf16 v[88:91], v[36:39], v[196:199], v[88:91]
    v_exp_f32 v19, v71
    v_mfma_f32_16x16x32_bf16 v[92:95], v[32:35], v[216:219], v[92:95]
    v_cvt_pk_bf16_f32 v68, v16, v17
    v_fma_f32 v251, v251, v56, v58
    v_mfma_f32_16x16x32_bf16 v[92:95], v[36:39], v[220:223], v[92:95]
    s_waitcnt lgkmcnt(2)
    buffer_load_dwordx4 v8, s[4:7], s32 offen offset:2048 sc1 lds
    v_mfma_f32_16x16x32_bf16 v[112:115], v[40:43], a[208:211], v[112:115]
    ds_read_b128 v[32:35], v1 offset:768
    v_fma_f32 v255, v255, v57, v59
    v_mfma_f32_16x16x32_bf16 v[112:115], v[44:47], a[212:215], v[112:115]
    v_exp_f32 v16, v100
    v_add_f32 v5, v5, v18
    v_mfma_f32_16x16x32_bf16 v[116:119], v[40:43], a[232:235], v[116:119]
    v_add_f32 v5, v5, v19
    v_cvt_pk_bf16_f32 v147, v248, v252
    v_mfma_f32_16x16x32_bf16 v[116:119], v[44:47], a[236:239], v[116:119]
    v_exp_f32 v17, v101
    v_mfma_f32_16x16x32_bf16 v[120:123], v[40:43], v[192:195], v[120:123]
    ds_read_b128 v[36:39], v1 offset:13056
    v_cvt_pk_bf16_f32 v69, v18, v19
    v_mfma_f32_16x16x32_bf16 v[120:123], v[44:47], v[196:199], v[120:123]
    s_add_u32 s32, s32, 24576
    v_exp_f32 v18, v102
    v_mfma_f32_16x16x32_bf16 v[124:127], v[40:43], v[216:219], v[124:127]
    s_add_u32 s26, s26, 36864
    v_add_f32 v5, v5, v16
    v_add_f32 v5, v5, v17
    v_mfma_f32_16x16x32_bf16 v[124:127], v[44:47], v[220:223], v[124:127]
    s_waitcnt lgkmcnt(2)
    v_exp_f32 v19, v103
    v_cvt_pk_bf16_f32 v70, v16, v17
    v_add_f32 v5, v5, v18
    v_cvt_pk_bf16_f32 v151, v249, v253
    v_add_f32 v5, v5, v19
    s_sub_u32 s57, s26, 147456
    v_cvt_pk_bf16_f32 v155, v250, v254
    v_cvt_pk_bf16_f32 v71, v18, v19
    s_min_u32 s26, s26, s57
    v_cvt_pk_bf16_f32 v159, v251, v255
    v_mfma_f32_16x16x32_bf16 a[0:3], v[160:163], v[24:27], a[0:3]
    ds_read_b128 v[40:43], v1 offset:1536
    v_mfma_f32_16x16x32_bf16 a[0:3], v[176:179], v[28:31], a[0:3]
    buffer_store_dwordx4 v[144:147], v20, s[4:7], s81 offen offset:0 sc1
    v_mfma_f32_16x16x32_bf16 a[48:51], v[164:167], v[24:27], a[48:51]
    v_exp_f32 v16, v72
    v_mfma_f32_16x16x32_bf16 a[48:51], v[180:183], v[28:31], a[48:51]
    v_exp_f32 v17, v73
    v_mfma_f32_16x16x32_bf16 a[96:99], v[168:171], v[24:27], a[96:99]
    ds_read_b128 v[44:47], v1 offset:13824
    v_mfma_f32_16x16x32_bf16 a[96:99], v[184:187], v[28:31], a[96:99]
    v_exp_f32 v18, v74
    v_mfma_f32_16x16x32_bf16 a[144:147], v[172:175], v[24:27], a[144:147]
    v_add_f32 v6, v6, v16
    v_add_f32 v6, v6, v17
    v_mfma_f32_16x16x32_bf16 a[144:147], v[188:191], v[28:31], a[144:147]
    s_waitcnt lgkmcnt(2)
    v_exp_f32 v19, v75
    v_mfma_f32_16x16x32_bf16 a[4:7], v[160:163], v[32:35], a[4:7]
    ds_read_b128 v[24:27], v1 offset:2304
    v_cvt_pk_bf16_f32 v72, v16, v17
    v_mfma_f32_16x16x32_bf16 a[4:7], v[176:179], v[36:39], a[4:7]
    buffer_store_dwordx4 v[148:151], v20, s[4:7], s81 offen offset:768 sc1
    v_mfma_f32_16x16x32_bf16 a[52:55], v[164:167], v[32:35], a[52:55]
    v_exp_f32 v16, v104
    v_mfma_f32_16x16x32_bf16 a[52:55], v[180:183], v[36:39], a[52:55]
    v_add_f32 v6, v6, v18
    v_add_f32 v6, v6, v19
    v_mfma_f32_16x16x32_bf16 a[100:103], v[168:171], v[32:35], a[100:103]
    ds_read_b128 v[28:31], v1 offset:14592
    v_mfma_f32_16x16x32_bf16 a[100:103], v[184:187], v[36:39], a[100:103]
    v_exp_f32 v17, v105
    v_mfma_f32_16x16x32_bf16 a[148:151], v[172:175], v[32:35], a[148:151]
    v_cvt_pk_bf16_f32 v73, v18, v19
    v_mfma_f32_16x16x32_bf16 a[148:151], v[188:191], v[36:39], a[148:151]
    s_waitcnt lgkmcnt(2)
    v_exp_f32 v18, v106
    v_mfma_f32_16x16x32_bf16 a[8:11], v[160:163], v[40:43], a[8:11]
    ds_read_b128 v[32:35], v21 offset:0
    v_add_f32 v6, v6, v16
    v_mfma_f32_16x16x32_bf16 a[8:11], v[176:179], v[44:47], a[8:11]
    buffer_store_dwordx4 v[152:155], v20, s[4:7], s81 offen offset:1536 sc1
    v_mfma_f32_16x16x32_bf16 a[56:59], v[164:167], v[40:43], a[56:59]
    v_add_f32 v6, v6, v17
    v_mfma_f32_16x16x32_bf16 a[56:59], v[180:183], v[44:47], a[56:59]
    v_exp_f32 v19, v107
    v_mfma_f32_16x16x32_bf16 a[104:107], v[168:171], v[40:43], a[104:107]
    ds_read_b128 v[36:39], v21 offset:12288
    v_cvt_pk_bf16_f32 v74, v16, v17
    v_mfma_f32_16x16x32_bf16 a[104:107], v[184:187], v[44:47], a[104:107]
    v_exp_f32 v16, v76
    v_mfma_f32_16x16x32_bf16 a[152:155], v[172:175], v[40:43], a[152:155]
    v_add_f32 v6, v6, v18
    v_mfma_f32_16x16x32_bf16 a[152:155], v[188:191], v[44:47], a[152:155]
    s_waitcnt lgkmcnt(2)
    v_add_f32 v6, v6, v19
    v_mfma_f32_16x16x32_bf16 a[12:15], v[160:163], v[24:27], a[12:15]
    ds_read_b128 v[40:43], v21 offset:768
    v_mfma_f32_16x16x32_bf16 a[12:15], v[176:179], v[28:31], a[12:15]
    buffer_store_dwordx4 v[156:159], v20, s[4:7], s81 offen offset:2304 sc1
    v_mfma_f32_16x16x32_bf16 a[60:63], v[164:167], v[24:27], a[60:63]
    v_exp_f32 v17, v77
    v_mfma_f32_16x16x32_bf16 a[60:63], v[180:183], v[28:31], a[60:63]
    v_cvt_pk_bf16_f32 v75, v18, v19
    v_mfma_f32_16x16x32_bf16 a[108:111], v[168:171], v[24:27], a[108:111]
    ds_read_b128 v[44:47], v21 offset:13056
    v_mfma_f32_16x16x32_bf16 a[108:111], v[184:187], v[28:31], a[108:111]
    v_exp_f32 v18, v78
    v_mfma_f32_16x16x32_bf16 a[156:159], v[172:175], v[24:27], a[156:159]
    s_add_u32 s29, s28, 49152
    v_add_f32 v7, v7, v16
    v_add_f32 v7, v7, v17
    v_mfma_f32_16x16x32_bf16 a[156:159], v[188:191], v[28:31], a[156:159]
    s_waitcnt lgkmcnt(2)
    v_exp_f32 v19, v79
    v_mfma_f32_16x16x32_bf16 a[16:19], v[160:163], v[32:35], a[16:19]
    ds_read_b128 v[24:27], v21 offset:1536
    v_cvt_pk_bf16_f32 v76, v16, v17
    v_mfma_f32_16x16x32_bf16 a[16:19], v[176:179], v[36:39], a[16:19]
    s_sub_u32 s3, s29, 147456
    buffer_load_dwordx4 v[248:251], v9, s[64:67], s34 offen offset:384 nt
    v_mfma_f32_16x16x32_bf16 a[64:67], v[164:167], v[32:35], a[64:67]
    v_exp_f32 v16, v108
    v_mfma_f32_16x16x32_bf16 a[64:67], v[180:183], v[36:39], a[64:67]
    ds_read_b128 v[56:59], v10 offset:384
    s_waitcnt vmcnt(18)
    v_mfma_f32_16x16x32_bf16 a[112:115], v[168:171], v[32:35], a[112:115]
    ds_read_b128 v[28:31], v21 offset:13824
    v_add_f32 v7, v7, v18
    v_mfma_f32_16x16x32_bf16 a[112:115], v[184:187], v[36:39], a[112:115]
    buffer_load_dwordx4 v[252:255], v9, s[64:67], s34 offen offset:1920 nt
    v_mfma_f32_16x16x32_bf16 a[160:163], v[172:175], v[32:35], a[160:163]
    v_add_f32 v7, v7, v19
    v_cvt_f32_i32 v224, v224
    v_mfma_f32_16x16x32_bf16 a[160:163], v[188:191], v[36:39], a[160:163]
    s_waitcnt lgkmcnt(3)
    v_exp_f32 v17, v109
    v_mfma_f32_16x16x32_bf16 a[20:23], v[160:163], v[40:43], a[20:23]
    s_min_u32 s29, s29, s3
    ds_read_b128 v[32:35], v21 offset:2304
    v_cvt_pk_bf16_f32 v77, v18, v19
    v_mfma_f32_16x16x32_bf16 a[20:23], v[176:179], v[44:47], a[20:23]
    v_exp_f32 v18, v110
    v_mfma_f32_16x16x32_bf16 a[68:71], v[164:167], v[40:43], a[68:71]
    s_mov_b32 m0, s56
    v_add_f32 v7, v7, v16
    v_cvt_f32_i32 v225, v225
    v_mfma_f32_16x16x32_bf16 a[68:71], v[180:183], v[44:47], a[68:71]
    v_add_f32 v7, v7, v17
    v_cvt_f32_i32 v228, v228
    v_mfma_f32_16x16x32_bf16 a[116:119], v[168:171], v[40:43], a[116:119]
    ds_read_b128 v[36:39], v21 offset:14592
    v_mfma_f32_16x16x32_bf16 a[116:119], v[184:187], v[44:47], a[116:119]
    buffer_load_dwordx4 v8, s[4:7], s27 offen offset:0 sc1 lds
    v_mfma_f32_16x16x32_bf16 a[164:167], v[172:175], v[40:43], a[164:167]
    s_sub_u32 s3, s29, s28
    v_exp_f32 v19, v111
    v_mfma_f32_16x16x32_bf16 a[164:167], v[188:191], v[44:47], a[164:167]
    s_waitcnt lgkmcnt(2)
    ds_read_b128 v[60:63], v10 offset:768
    v_cvt_pk_bf16_f32 v78, v16, v17
    v_mfma_f32_16x16x32_bf16 a[24:27], v[160:163], v[24:27], a[24:27]
    ds_read_b128 v[40:43], v22 offset:0
    v_cvt_f32_i32 v229, v229
    v_mfma_f32_16x16x32_bf16 a[24:27], v[176:179], v[28:31], a[24:27]
    buffer_load_dwordx4 v8, s[4:7], s27 offen offset:1024 sc1 lds
    v_mfma_f32_16x16x32_bf16 a[72:75], v[164:167], v[24:27], a[72:75]
    v_exp_f32 v16, v80
    v_mfma_f32_16x16x32_bf16 a[72:75], v[180:183], v[28:31], a[72:75]
    v_add_f32 v7, v7, v18
    v_add_f32 v7, v7, v19
    v_mfma_f32_16x16x32_bf16 a[120:123], v[168:171], v[24:27], a[120:123]
    ds_read_b128 v[44:47], v22 offset:12288
    v_fma_f32 v224, v224, v48, v50
    v_mfma_f32_16x16x32_bf16 a[120:123], v[184:187], v[28:31], a[120:123]
    s_mov_b32 s28, s29
    buffer_load_dwordx4 v8, s[4:7], s27 offen offset:2048 sc1 lds
    v_mfma_f32_16x16x32_bf16 a[168:171], v[172:175], v[24:27], a[168:171]
    v_exp_f32 v17, v81
    v_mfma_f32_16x16x32_bf16 a[168:171], v[188:191], v[28:31], a[168:171]
    s_waitcnt lgkmcnt(3)
    v_cvt_pk_bf16_f32 v79, v18, v19
    v_fma_f32 v225, v225, v49, v51
    v_mfma_f32_16x16x32_bf16 a[28:31], v[160:163], v[32:35], a[28:31]
    s_add_u32 s27, s27, 24576
    ds_read_b128 v[24:27], v22 offset:768
    v_fma_f32 v228, v228, v48, v50
    v_mfma_f32_16x16x32_bf16 a[28:31], v[176:179], v[36:39], a[28:31]
    v_exp_f32 v18, v82
    v_mfma_f32_16x16x32_bf16 a[76:79], v[164:167], v[32:35], a[76:79]
    s_add_u32 s56, s56, 12288
    v_add_f32 v4, v4, v16
    v_add_f32 v4, v4, v17
    v_mfma_f32_16x16x32_bf16 a[76:79], v[180:183], v[36:39], a[76:79]
    v_exp_f32 v19, v83
    v_mfma_f32_16x16x32_bf16 a[124:127], v[168:171], v[32:35], a[124:127]
    s_mov_b32 m0, s56
    ds_read_b128 v[28:31], v22 offset:13056
    v_cvt_pk_bf16_f32 v80, v16, v17
    v_mfma_f32_16x16x32_bf16 a[124:127], v[184:187], v[36:39], a[124:127]
    v_exp_f32 v16, v112
    v_mfma_f32_16x16x32_bf16 a[172:175], v[172:175], v[32:35], a[172:175]
    v_add_f32 v4, v4, v18
    v_add_f32 v4, v4, v19
    v_mfma_f32_16x16x32_bf16 a[172:175], v[188:191], v[36:39], a[172:175]
    s_waitcnt lgkmcnt(2)
    buffer_load_dwordx4 v8, s[4:7], s27 offen offset:0 sc1 lds
    v_mfma_f32_16x16x32_bf16 a[32:35], v[160:163], v[40:43], a[32:35]
    ds_read_b128 v[32:35], v22 offset:1536
    v_fma_f32 v229, v229, v49, v51
    v_mfma_f32_16x16x32_bf16 a[32:35], v[176:179], v[44:47], a[32:35]
    v_exp_f32 v17, v113
    v_mfma_f32_16x16x32_bf16 a[80:83], v[164:167], v[40:43], a[80:83]
    v_cvt_pk_bf16_f32 v81, v18, v19
    v_cvt_pk_bf16_f32 v224, v224, v225
    v_mfma_f32_16x16x32_bf16 a[80:83], v[180:183], v[44:47], a[80:83]
    v_exp_f32 v18, v114
    v_mfma_f32_16x16x32_bf16 a[128:131], v[168:171], v[40:43], a[128:131]
    ds_read_b128 v[36:39], v22 offset:13824
    v_add_f32 v4, v4, v16
    v_mfma_f32_16x16x32_bf16 a[128:131], v[184:187], v[44:47], a[128:131]
    buffer_load_dwordx4 v8, s[4:7], s27 offen offset:1024 sc1 lds
    v_mfma_f32_16x16x32_bf16 a[176:179], v[172:175], v[40:43], a[176:179]
    v_add_f32 v4, v4, v17
    v_cvt_pk_bf16_f32 v228, v228, v229
    v_mfma_f32_16x16x32_bf16 a[176:179], v[188:191], v[44:47], a[176:179]
    s_waitcnt lgkmcnt(2)
    v_exp_f32 v19, v115
    v_mfma_f32_16x16x32_bf16 a[36:39], v[160:163], v[24:27], a[36:39]
    ds_read_b128 v[40:43], v22 offset:2304
    v_cvt_pk_bf16_f32 v82, v16, v17
    v_mfma_f32_16x16x32_bf16 a[36:39], v[176:179], v[28:31], a[36:39]
    buffer_load_dwordx4 v8, s[4:7], s27 offen offset:2048 sc1 lds
    v_mfma_f32_16x16x32_bf16 a[84:87], v[164:167], v[24:27], a[84:87]
    v_exp_f32 v16, v84
    v_mfma_f32_16x16x32_bf16 a[84:87], v[180:183], v[28:31], a[84:87]
    v_add_u32 v2, s3, v2
    v_add_f32 v4, v4, v18
    v_mfma_f32_16x16x32_bf16 a[132:135], v[168:171], v[24:27], a[132:135]
    ds_read_b128 v[44:47], v22 offset:14592
    v_add_u32 v3, s3, v3
    v_mfma_f32_16x16x32_bf16 a[132:135], v[184:187], v[28:31], a[132:135]
    s_waitcnt lgkmcnt(2)
    v_add_f32 v4, v4, v19
    v_cvt_f32_i32 v226, v226
    v_mfma_f32_16x16x32_bf16 a[180:183], v[172:175], v[24:27], a[180:183]
    s_waitcnt vmcnt(8)
    v_exp_f32 v17, v85
    v_mfma_f32_16x16x32_bf16 a[180:183], v[188:191], v[28:31], a[180:183]
    s_barrier
    v_cvt_pk_bf16_f32 v83, v18, v19
    v_mfma_f32_16x16x32_bf16 a[40:43], v[160:163], v[32:35], a[40:43]
    s_add_u32 s27, s27, 24576
    ds_read_b128 v[24:27], v2 offset:0
    v_cvt_f32_i32 v227, v227
    v_mfma_f32_16x16x32_bf16 a[40:43], v[176:179], v[36:39], a[40:43]
    s_add_u32 s56, s56, 36864
    v_exp_f32 v18, v86
    v_mfma_f32_16x16x32_bf16 a[88:91], v[164:167], v[32:35], a[88:91]
    s_sub_u32 s58, s56, 147456
    v_add_f32 v5, v5, v16
    v_add_f32 v5, v5, v17
    v_mfma_f32_16x16x32_bf16 a[88:91], v[180:183], v[36:39], a[88:91]
    v_exp_f32 v19, v87
    v_mfma_f32_16x16x32_bf16 a[136:139], v[168:171], v[32:35], a[136:139]
    s_min_u32 s56, s56, s58
    ds_read_b128 v[28:31], v3 offset:0
    v_cvt_pk_bf16_f32 v84, v16, v17
    v_mfma_f32_16x16x32_bf16 a[136:139], v[184:187], v[36:39], a[136:139]
    v_exp_f32 v16, v116
    v_mfma_f32_16x16x32_bf16 a[184:187], v[172:175], v[32:35], a[184:187]
    v_cvt_f32_i32 v230, v230
    v_add_f32 v5, v5, v18
    v_mfma_f32_16x16x32_bf16 a[184:187], v[188:191], v[36:39], a[184:187]
    s_waitcnt lgkmcnt(2)
    v_add_f32 v5, v5, v19
    v_cvt_f32_i32 v231, v231
    v_mfma_f32_16x16x32_bf16 a[44:47], v[160:163], v[40:43], a[44:47]
    ds_read_b128 v[32:35], v2 offset:6144
    v_fma_f32 v226, v226, v56, v58
    v_mfma_f32_16x16x32_bf16 a[44:47], v[176:179], v[44:47], a[44:47]
    v_exp_f32 v17, v117
    v_mfma_f32_16x16x32_bf16 a[92:95], v[164:167], v[40:43], a[92:95]
    v_cvt_pk_bf16_f32 v85, v18, v19
    v_fma_f32 v227, v227, v57, v59
    v_mfma_f32_16x16x32_bf16 a[92:95], v[180:183], v[44:47], a[92:95]
    v_exp_f32 v18, v118
    v_mfma_f32_16x16x32_bf16 a[140:143], v[168:171], v[40:43], a[140:143]
    ds_read_b128 v[36:39], v3 offset:6144
    v_add_f32 v5, v5, v16
    v_mfma_f32_16x16x32_bf16 a[140:143], v[184:187], v[44:47], a[140:143]
    v_add_u32 v55, 1, v55
    buffer_store_dword v55, v13, s[20:23], 0 offen sc1
    v_mfma_f32_16x16x32_bf16 a[188:191], v[172:175], v[40:43], a[188:191]
    v_add_f32 v5, v5, v17
    v_fma_f32 v230, v230, v56, v58
    v_mfma_f32_16x16x32_bf16 a[188:191], v[188:191], v[44:47], a[188:191]
    s_waitcnt lgkmcnt(2)
    v_exp_f32 v19, v119
    v_cvt_pk_bf16_f32 v86, v16, v17
    v_add_f32 v5, v5, v18
    v_fma_f32 v231, v231, v57, v59
    v_add_f32 v5, v5, v19
    v_cvt_pk_bf16_f32 v225, v226, v227
    v_cvt_pk_bf16_f32 v87, v18, v19
    v_cvt_pk_bf16_f32 v229, v230, v231
    v_mfma_f32_16x16x32_bf16 v[160:163], v[24:27], a[192:195], v[128:131]
    ds_read_b128 v[40:43], v2 offset:128
    s_add_u32 s35, s35, 196608
    v_mfma_f32_16x16x32_bf16 v[160:163], v[28:31], a[196:199], v[160:163]
    s_waitcnt vmcnt(24)
    v_exp_f32 v16, v88
    v_mfma_f32_16x16x32_bf16 v[164:167], v[24:27], a[216:219], v[132:135]
    s_sub_u32 s36, s35, 1572864
    v_exp_f32 v17, v89
    v_mfma_f32_16x16x32_bf16 v[164:167], v[28:31], a[220:223], v[164:167]
    s_min_u32 s35, s35, s36
    v_exp_f32 v18, v90
    v_mfma_f32_16x16x32_bf16 v[168:171], v[24:27], a[240:243], v[136:139]
    ds_read_b128 v[44:47], v3 offset:128
    v_cvt_f32_i32 v232, v232
    v_mfma_f32_16x16x32_bf16 v[168:171], v[28:31], a[244:247], v[168:171]
    s_add_u32 s36, s35, 3072
    v_add_f32 v6, v6, v16
    v_cvt_f32_i32 v233, v233
    v_mfma_f32_16x16x32_bf16 v[172:175], v[24:27], v[200:203], v[140:143]
    v_add_f32 v6, v6, v17
    v_mfma_f32_16x16x32_bf16 v[172:175], v[28:31], v[204:207], v[172:175]
    s_waitcnt lgkmcnt(2)
    v_exp_f32 v19, v91
    v_mfma_f32_16x16x32_bf16 v[96:99], v[32:35], a[192:195], v[128:131]
    s_add_u32 s81, s81, 196608
    ds_read_b128 v[24:27], v2 offset:6272
    v_cvt_f32_i32 v236, v236
    v_mfma_f32_16x16x32_bf16 v[96:99], v[36:39], a[196:199], v[96:99]
    v_cvt_pk_bf16_f32 v88, v16, v17
    v_mfma_f32_16x16x32_bf16 v[100:103], v[32:35], a[216:219], v[132:135]
    v_exp_f32 v16, v120
    v_mfma_f32_16x16x32_bf16 v[100:103], v[36:39], a[220:223], v[100:103]
    buffer_load_dwordx4 v[144:147], v12, s[68:71], s35 offen offset:0 nt
    v_mfma_f32_16x16x32_bf16 v[104:107], v[32:35], a[240:243], v[136:139]
    ds_read_b128 v[28:31], v3 offset:6272
    v_add_f32 v6, v6, v18
    v_mfma_f32_16x16x32_bf16 v[104:107], v[36:39], a[244:247], v[104:107]
    v_add_f32 v6, v6, v19
    v_cvt_f32_i32 v237, v237
    v_mfma_f32_16x16x32_bf16 v[108:111], v[32:35], v[200:203], v[140:143]
    v_exp_f32 v17, v121
    v_mfma_f32_16x16x32_bf16 v[108:111], v[36:39], v[204:207], v[108:111]
    s_waitcnt lgkmcnt(2)
    v_cvt_pk_bf16_f32 v89, v18, v19
    v_fma_f32 v232, v232, v48, v50
    v_mfma_f32_16x16x32_bf16 v[160:163], v[40:43], a[200:203], v[160:163]
    ds_read_b128 v[32:35], v2 offset:256
    v_fma_f32 v233, v233, v49, v51
    v_mfma_f32_16x16x32_bf16 v[160:163], v[44:47], a[204:207], v[160:163]
    buffer_load_dwordx4 v[148:151], v12, s[68:71], s35 offen offset:768 nt
    v_mfma_f32_16x16x32_bf16 v[164:167], v[40:43], a[224:227], v[164:167]
    v_exp_f32 v18, v122
    v_mfma_f32_16x16x32_bf16 v[164:167], v[44:47], a[228:231], v[164:167]
    v_add_f32 v6, v6, v16
    v_add_f32 v6, v6, v17
    v_mfma_f32_16x16x32_bf16 v[168:171], v[40:43], a[248:251], v[168:171]
    ds_read_b128 v[36:39], v3 offset:256
    v_fma_f32 v236, v236, v48, v50
    v_mfma_f32_16x16x32_bf16 v[168:171], v[44:47], a[252:255], v[168:171]
    buffer_load_dwordx4 v[152:155], v12, s[68:71], s35 offen offset:1536 nt
    v_mfma_f32_16x16x32_bf16 v[172:175], v[40:43], v[208:211], v[172:175]
    v_exp_f32 v19, v123
    v_mfma_f32_16x16x32_bf16 v[172:175], v[44:47], v[212:215], v[172:175]
    s_waitcnt lgkmcnt(2)
    v_cvt_pk_bf16_f32 v90, v16, v17
    v_fma_f32 v237, v237, v49, v51
    v_mfma_f32_16x16x32_bf16 v[96:99], v[24:27], a[200:203], v[96:99]
    ds_read_b128 v[40:43], v2 offset:6400
    v_mfma_f32_16x16x32_bf16 v[96:99], v[28:31], a[204:207], v[96:99]
    v_exp_f32 v16, v92
    v_mfma_f32_16x16x32_bf16 v[100:103], v[24:27], a[224:227], v[100:103]
    v_add_f32 v6, v6, v18
    v_add_f32 v6, v6, v19
    v_mfma_f32_16x16x32_bf16 v[100:103], v[28:31], a[228:231], v[100:103]
    buffer_load_dwordx4 v[156:159], v12, s[68:71], s35 offen offset:2304 nt
    v_mfma_f32_16x16x32_bf16 v[104:107], v[24:27], a[248:251], v[104:107]
    ds_read_b128 v[44:47], v3 offset:6400
    v_cvt_pk_bf16_f32 v232, v232, v233
    v_mfma_f32_16x16x32_bf16 v[104:107], v[28:31], a[252:255], v[104:107]
    v_exp_f32 v17, v93
    v_mfma_f32_16x16x32_bf16 v[108:111], v[24:27], v[208:211], v[108:111]
    s_add_u32 s29, s30, 49152
    v_cvt_pk_bf16_f32 v91, v18, v19
    v_cvt_pk_bf16_f32 v236, v236, v237
    v_mfma_f32_16x16x32_bf16 v[108:111], v[28:31], v[212:215], v[108:111]
    s_waitcnt lgkmcnt(2)
    v_exp_f32 v18, v94
    v_mfma_f32_16x16x32_bf16 v[160:163], v[32:35], a[208:211], v[160:163]
    s_mov_b32 m0, s26
    ds_read_b128 v[24:27], v2 offset:12288
    v_add_f32 v7, v7, v16
    v_mfma_f32_16x16x32_bf16 v[160:163], v[36:39], a[212:215], v[160:163]
    s_sub_u32 s3, s29, 147456
    buffer_load_dwordx4 v8, s[4:7], s32 offen offset:0 sc1 lds
    v_mfma_f32_16x16x32_bf16 v[164:167], v[32:35], a[232:235], v[164:167]
    v_add_f32 v7, v7, v17
    v_cvt_f32_i32 v234, v234
    v_mfma_f32_16x16x32_bf16 v[164:167], v[36:39], a[236:239], v[164:167]
    v_exp_f32 v19, v95
    v_mfma_f32_16x16x32_bf16 v[168:171], v[32:35], v[192:195], v[168:171]
    ds_read_b128 v[28:31], v3 offset:12288
    v_cvt_pk_bf16_f32 v92, v16, v17
    v_mfma_f32_16x16x32_bf16 v[168:171], v[36:39], v[196:199], v[168:171]
    buffer_load_dwordx4 v8, s[4:7], s32 offen offset:1024 sc1 lds
    v_mfma_f32_16x16x32_bf16 v[172:175], v[32:35], v[216:219], v[172:175]
    s_min_u32 s29, s29, s3
    v_exp_f32 v16, v124
    v_mfma_f32_16x16x32_bf16 v[172:175], v[36:39], v[220:223], v[172:175]
    s_waitcnt lgkmcnt(2)
    v_add_f32 v7, v7, v18
    v_add_f32 v7, v7, v19
    v_mfma_f32_16x16x32_bf16 v[96:99], v[40:43], a[208:211], v[96:99]
    ds_read_b128 v[32:35], v2 offset:18432
    v_cvt_f32_i32 v235, v235
    v_mfma_f32_16x16x32_bf16 v[96:99], v[44:47], a[212:215], v[96:99]
    buffer_load_dwordx4 v8, s[4:7], s32 offen offset:2048 sc1 lds
    v_mfma_f32_16x16x32_bf16 v[100:103], v[40:43], a[232:235], v[100:103]
    v_exp_f32 v17, v125
    v_mfma_f32_16x16x32_bf16 v[100:103], v[44:47], a[236:239], v[100:103]
    v_cvt_pk_bf16_f32 v93, v18, v19
    v_cvt_f32_i32 v238, v238
    v_mfma_f32_16x16x32_bf16 v[104:107], v[40:43], v[192:195], v[104:107]
    s_add_u32 s32, s32, 24576
    ds_read_b128 v[36:39], v3 offset:18432
    v_cvt_f32_i32 v239, v239
    v_mfma_f32_16x16x32_bf16 v[104:107], v[44:47], v[196:199], v[104:107]
    s_sub_u32 s3, s29, s30
    v_exp_f32 v18, v126
    v_mfma_f32_16x16x32_bf16 v[108:111], v[40:43], v[216:219], v[108:111]
    s_add_u32 s26, s26, 12288
    v_add_f32 v7, v7, v16
    v_add_f32 v7, v7, v17
    v_mfma_f32_16x16x32_bf16 v[108:111], v[44:47], v[220:223], v[108:111]
    s_waitcnt lgkmcnt(2)
    v_exp_f32 v19, v127
    v_mfma_f32_16x16x32_bf16 v[176:179], v[24:27], a[192:195], v[128:131]
    s_mov_b32 m0, s26
    ds_read_b128 v[40:43], v2 offset:12416
    v_cvt_pk_bf16_f32 v94, v16, v17
    v_mfma_f32_16x16x32_bf16 v[176:179], v[28:31], a[196:199], v[176:179]
    v_add_f32 v7, v7, v18
    v_add_f32 v7, v7, v19
    v_mfma_f32_16x16x32_bf16 v[180:183], v[24:27], a[216:219], v[132:135]
    s_mov_b32 s30, s29
    v_cvt_pk_bf16_f32 v95, v18, v19
    v_fma_f32 v234, v234, v56, v58
    v_mfma_f32_16x16x32_bf16 v[180:183], v[28:31], a[220:223], v[180:183]
    buffer_load_dwordx4 v8, s[4:7], s32 offen offset:0 sc1 lds
    v_mfma_f32_16x16x32_bf16 v[184:187], v[24:27], a[240:243], v[136:139]
    ds_read_b128 v[44:47], v3 offset:12416
    v_fma_f32 v235, v235, v57, v59
    v_mfma_f32_16x16x32_bf16 v[184:187], v[28:31], a[244:247], v[184:187]
    v_exp_f32 v16, v160
    v_mfma_f32_16x16x32_bf16 v[188:191], v[24:27], v[200:203], v[140:143]
    v_exp_f32 v17, v161
    v_mfma_f32_16x16x32_bf16 v[188:191], v[28:31], v[204:207], v[188:191]
    s_waitcnt lgkmcnt(2)
    buffer_load_dwordx4 v8, s[4:7], s32 offen offset:1024 sc1 lds
    v_mfma_f32_16x16x32_bf16 v[112:115], v[32:35], a[192:195], v[128:131]
    ds_read_b128 v[24:27], v2 offset:18560
    v_fma_f32 v238, v238, v56, v58
    v_mfma_f32_16x16x32_bf16 v[112:115], v[36:39], a[196:199], v[112:115]
    v_exp_f32 v18, v162
    v_mfma_f32_16x16x32_bf16 v[116:119], v[32:35], a[216:219], v[132:135]
    v_add_f32 v4, v4, v16
    v_add_f32 v4, v4, v17
    v_mfma_f32_16x16x32_bf16 v[116:119], v[36:39], a[220:223], v[116:119]
    buffer_load_dwordx4 v8, s[4:7], s32 offen offset:2048 sc1 lds
    v_mfma_f32_16x16x32_bf16 v[120:123], v[32:35], a[240:243], v[136:139]
    ds_read_b128 v[28:31], v3 offset:18560
    v_fma_f32 v239, v239, v57, v59
    v_mfma_f32_16x16x32_bf16 v[120:123], v[36:39], a[244:247], v[120:123]
    v_exp_f32 v19, v163
    v_mfma_f32_16x16x32_bf16 v[124:127], v[32:35], v[200:203], v[140:143]
    v_cvt_pk_bf16_f32 v160, v16, v17
    v_cvt_pk_bf16_f32 v233, v234, v235
    v_mfma_f32_16x16x32_bf16 v[124:127], v[36:39], v[204:207], v[124:127]
    s_waitcnt lgkmcnt(2)
    v_exp_f32 v16, v96
    v_mfma_f32_16x16x32_bf16 v[176:179], v[40:43], a[200:203], v[176:179]
    s_add_u32 s32, s32, 24576
    ds_read_b128 v[32:35], v2 offset:12544
    v_add_f32 v4, v4, v18
    v_mfma_f32_16x16x32_bf16 v[176:179], v[44:47], a[204:207], v[176:179]
    s_add_u32 s26, s26, 36864
    v_add_f32 v4, v4, v19
    v_cvt_pk_bf16_f32 v237, v238, v239
    v_mfma_f32_16x16x32_bf16 v[180:183], v[40:43], a[224:227], v[180:183]
    v_exp_f32 v17, v97
    v_mfma_f32_16x16x32_bf16 v[180:183], v[44:47], a[228:231], v[180:183]
    s_sub_u32 s57, s26, 147456
    v_cvt_pk_bf16_f32 v161, v18, v19
    v_bfe_u32 v53, v8, 4, 6
    v_mfma_f32_16x16x32_bf16 v[184:187], v[40:43], a[248:251], v[184:187]
    ds_read_b128 v[36:39], v3 offset:12544
    v_add_u32 v1, s3, v1
    v_mfma_f32_16x16x32_bf16 v[184:187], v[44:47], a[252:255], v[184:187]
    v_exp_f32 v18, v98
    v_mfma_f32_16x16x32_bf16 v[188:191], v[40:43], v[208:211], v[188:191]
    s_min_u32 s26, s26, s57
    v_lshlrev_b32 v53, 2, v53
    v_add_f32 v4, v4, v16
    v_mfma_f32_16x16x32_bf16 v[188:191], v[44:47], v[212:215], v[188:191]
    s_waitcnt lgkmcnt(2)
    buffer_load_dword v52, v53, s[20:23], 0 offen sc1
    v_mfma_f32_16x16x32_bf16 v[112:115], v[24:27], a[200:203], v[112:115]
    ds_read_b128 v[40:43], v2 offset:18688
    v_add_f32 v4, v4, v17
    v_mfma_f32_16x16x32_bf16 v[112:115], v[28:31], a[204:207], v[112:115]
    v_exp_f32 v19, v99
    s_branch L_skip7
L_pad7:
    s_branch L_tb1_7
L_skip7:
    v_mfma_f32_16x16x32_bf16 v[116:119], v[24:27], a[224:227], v[116:119]
    v_cvt_pk_bf16_f32 v162, v16, v17
    v_add_u32 v21, s3, v21
    v_mfma_f32_16x16x32_bf16 v[116:119], v[28:31], a[228:231], v[116:119]
    v_exp_f32 v16, v164
    v_mfma_f32_16x16x32_bf16 v[120:123], v[24:27], a[248:251], v[120:123]
    ds_read_b128 v[44:47], v3 offset:18688
    v_add_u32 v22, s3, v22
    v_mfma_f32_16x16x32_bf16 v[120:123], v[28:31], a[252:255], v[120:123]
    s_waitcnt lgkmcnt(2)
    v_add_f32 v4, v4, v18
    v_add_f32 v4, v4, v19
    v_mfma_f32_16x16x32_bf16 v[124:127], v[24:27], v[208:211], v[124:127]
    s_waitcnt vmcnt(40)
    v_exp_f32 v17, v165
    v_mfma_f32_16x16x32_bf16 v[124:127], v[28:31], v[212:215], v[124:127]
    s_barrier
    ds_read_b128 v[48:51], v10 offset:1152
    v_mfma_f32_16x16x32_bf16 v[176:179], v[32:35], a[208:211], v[176:179]
    s_waitcnt vmcnt(30)
    ds_read_b128 v[24:27], v1 offset:0
    v_cvt_pk_bf16_f32 v163, v18, v19
    v_mfma_f32_16x16x32_bf16 v[176:179], v[36:39], a[212:215], v[176:179]
    v_exp_f32 v18, v166
    v_mfma_f32_16x16x32_bf16 v[180:183], v[32:35], a[232:235], v[180:183]
    v_add_f32 v5, v5, v16
    v_cvt_f32_i32 v240, v240
    v_mfma_f32_16x16x32_bf16 v[180:183], v[36:39], a[236:239], v[180:183]
    v_add_f32 v5, v5, v17
    v_cvt_f32_i32 v241, v241
    v_mfma_f32_16x16x32_bf16 v[184:187], v[32:35], v[192:195], v[184:187]
    ds_read_b128 v[28:31], v1 offset:12288
    v_cvt_f32_i32 v244, v244
    v_mfma_f32_16x16x32_bf16 v[184:187], v[36:39], v[196:199], v[184:187]
    v_exp_f32 v19, v167
    v_mfma_f32_16x16x32_bf16 v[188:191], v[32:35], v[216:219], v[188:191]
    ds_read_b128 v[56:59], v23 offset:0
    v_cvt_pk_bf16_f32 v164, v16, v17
    v_mfma_f32_16x16x32_bf16 v[188:191], v[36:39], v[220:223], v[188:191]
    s_waitcnt lgkmcnt(4)
    v_exp_f32 v16, v100
    v_mfma_f32_16x16x32_bf16 v[112:115], v[40:43], a[208:211], v[112:115]
    ds_read_b128 v[32:35], v1 offset:768
    v_add_f32 v5, v5, v18
    v_mfma_f32_16x16x32_bf16 v[112:115], v[44:47], a[212:215], v[112:115]
    v_add_f32 v5, v5, v19
    v_add_u32 v10, 1792, v10
    v_mfma_f32_16x16x32_bf16 v[116:119], v[40:43], a[232:235], v[116:119]
    v_exp_f32 v17, v101
    v_mfma_f32_16x16x32_bf16 v[116:119], v[44:47], a[236:239], v[116:119]
    v_cvt_pk_bf16_f32 v165, v18, v19
    v_cvt_f32_i32 v245, v245
    v_mfma_f32_16x16x32_bf16 v[120:123], v[40:43], v[192:195], v[120:123]
    ds_read_b128 v[36:39], v1 offset:13056
    v_fma_f32 v240, v240, v60, v62
    v_mfma_f32_16x16x32_bf16 v[120:123], v[44:47], v[196:199], v[120:123]
    v_exp_f32 v18, v102
    v_mfma_f32_16x16x32_bf16 v[124:127], v[40:43], v[216:219], v[124:127]
    v_add_f32 v5, v5, v16
    v_add_f32 v5, v5, v17
    v_mfma_f32_16x16x32_bf16 v[124:127], v[44:47], v[220:223], v[124:127]
    s_waitcnt lgkmcnt(3)
    v_exp_f32 v19, v103
    v_cvt_pk_bf16_f32 v166, v16, v17
    v_add_f32 v5, v5, v18
    v_add_f32 v5, v5, v19
    v_fma_f32 v241, v241, v61, v63
    v_cvt_pk_bf16_f32 v167, v18, v19
    v_fma_f32 v244, v244, v60, v62
    v_mfma_f32_16x16x32_bf16 a[0:3], v[64:67], v[24:27], a[0:3]
    ds_read_b128 v[40:43], v1 offset:1536
    v_fma_f32 v245, v245, v61, v63
    v_mfma_f32_16x16x32_bf16 a[0:3], v[80:83], v[28:31], a[0:3]
    v_exp_f32 v16, v168
    v_mfma_f32_16x16x32_bf16 a[48:51], v[68:71], v[24:27], a[48:51]
    v_exp_f32 v17, v169
    v_mfma_f32_16x16x32_bf16 a[48:51], v[84:87], v[28:31], a[48:51]
    v_exp_f32 v18, v170
    v_mfma_f32_16x16x32_bf16 a[96:99], v[72:75], v[24:27], a[96:99]
    ds_read_b128 v[44:47], v1 offset:13824
    v_cvt_pk_bf16_f32 v226, v240, v241
    v_mfma_f32_16x16x32_bf16 a[96:99], v[88:91], v[28:31], a[96:99]
    v_add_f32 v6, v6, v16
    v_cvt_pk_bf16_f32 v230, v244, v245
    v_mfma_f32_16x16x32_bf16 a[144:147], v[76:79], v[24:27], a[144:147]
    v_add_f32 v6, v6, v17
    v_cvt_f32_i32 v242, v242
    v_mfma_f32_16x16x32_bf16 a[144:147], v[92:95], v[28:31], a[144:147]
    s_waitcnt lgkmcnt(2)
    v_exp_f32 v19, v171
    v_mfma_f32_16x16x32_bf16 a[4:7], v[64:67], v[32:35], a[4:7]
    ds_read_b128 v[24:27], v1 offset:2304
    v_cvt_pk_bf16_f32 v168, v16, v17
    v_mfma_f32_16x16x32_bf16 a[4:7], v[80:83], v[36:39], a[4:7]
    v_exp_f32 v16, v104
    v_mfma_f32_16x16x32_bf16 a[52:55], v[68:71], v[32:35], a[52:55]
    v_add_f32 v6, v6, v18
    v_cvt_f32_i32 v243, v243
    v_mfma_f32_16x16x32_bf16 a[52:55], v[84:87], v[36:39], a[52:55]
    v_add_f32 v6, v6, v19
    v_mfma_f32_16x16x32_bf16 a[100:103], v[72:75], v[32:35], a[100:103]
    ds_read_b128 v[28:31], v1 offset:14592
    v_cvt_f32_i32 v246, v246
    v_mfma_f32_16x16x32_bf16 a[100:103], v[88:91], v[36:39], a[100:103]
    v_exp_f32 v17, v105
    v_mfma_f32_16x16x32_bf16 a[148:151], v[76:79], v[32:35], a[148:151]
    v_cvt_pk_bf16_f32 v169, v18, v19
    v_mfma_f32_16x16x32_bf16 a[148:151], v[92:95], v[36:39], a[148:151]
    s_waitcnt lgkmcnt(2)
    v_exp_f32 v18, v106
    v_mfma_f32_16x16x32_bf16 a[8:11], v[64:67], v[40:43], a[8:11]
    ds_read_b128 v[32:35], v21 offset:0
    v_cvt_f32_i32 v247, v247
    v_mfma_f32_16x16x32_bf16 a[8:11], v[80:83], v[44:47], a[8:11]
    v_add_f32 v6, v6, v16
    v_add_f32 v6, v6, v17
    v_mfma_f32_16x16x32_bf16 a[56:59], v[68:71], v[40:43], a[56:59]
    v_exp_f32 v19, v107
    v_mfma_f32_16x16x32_bf16 a[56:59], v[84:87], v[44:47], a[56:59]
    v_fma_f32 v242, v242, v48, v50
    v_cvt_pk_bf16_f32 v170, v16, v17
    v_mfma_f32_16x16x32_bf16 a[104:107], v[72:75], v[40:43], a[104:107]
    ds_read_b128 v[36:39], v21 offset:12288
    v_fma_f32 v243, v243, v49, v51
    v_mfma_f32_16x16x32_bf16 a[104:107], v[88:91], v[44:47], a[104:107]
    v_exp_f32 v16, v172
    v_mfma_f32_16x16x32_bf16 a[152:155], v[76:79], v[40:43], a[152:155]
    v_add_f32 v6, v6, v18
    v_mfma_f32_16x16x32_bf16 a[152:155], v[92:95], v[44:47], a[152:155]
    s_waitcnt lgkmcnt(2)
    v_add_f32 v6, v6, v19
    v_fma_f32 v246, v246, v48, v50
    v_mfma_f32_16x16x32_bf16 a[12:15], v[64:67], v[24:27], a[12:15]
    ds_read_b128 v[40:43], v21 offset:768
    v_mfma_f32_16x16x32_bf16 a[12:15], v[80:83], v[28:31], a[12:15]
    v_exp_f32 v17, v173
    v_mfma_f32_16x16x32_bf16 a[60:63], v[68:71], v[24:27], a[60:63]
    v_cvt_pk_bf16_f32 v171, v18, v19
    v_fma_f32 v247, v247, v49, v51
    v_mfma_f32_16x16x32_bf16 a[60:63], v[84:87], v[28:31], a[60:63]
    v_exp_f32 v18, v174
    v_mfma_f32_16x16x32_bf16 a[108:111], v[72:75], v[24:27], a[108:111]
    ds_read_b128 v[44:47], v21 offset:13056
    v_add_f32 v7, v7, v16
    v_mfma_f32_16x16x32_bf16 a[108:111], v[88:91], v[28:31], a[108:111]
    v_add_f32 v7, v7, v17
    v_cvt_pk_bf16_f32 v227, v242, v243
    v_mfma_f32_16x16x32_bf16 a[156:159], v[76:79], v[24:27], a[156:159]
    s_add_u32 s29, s28, 49152
    v_exp_f32 v19, v175
    v_mfma_f32_16x16x32_bf16 a[156:159], v[92:95], v[28:31], a[156:159]
    s_waitcnt lgkmcnt(2)
    v_cvt_pk_bf16_f32 v172, v16, v17
    v_mfma_f32_16x16x32_bf16 a[16:19], v[64:67], v[32:35], a[16:19]
    ds_read_b128 v[24:27], v21 offset:1536
    v_cvt_pk_bf16_f32 v231, v246, v247
    v_mfma_f32_16x16x32_bf16 a[16:19], v[80:83], v[36:39], a[16:19]
    s_sub_u32 s3, s29, 147456
    v_exp_f32 v16, v108
    v_mfma_f32_16x16x32_bf16 a[64:67], v[68:71], v[32:35], a[64:67]
    s_waitcnt vmcnt(18)
    v_add_f32 v7, v7, v18
    v_mfma_f32_16x16x32_bf16 a[64:67], v[84:87], v[36:39], a[64:67]
    v_add_f32 v7, v7, v19
    v_mfma_f32_16x16x32_bf16 a[112:115], v[72:75], v[32:35], a[112:115]
    ds_read_b128 v[28:31], v21 offset:13824
    v_mfma_f32_16x16x32_bf16 a[112:115], v[88:91], v[36:39], a[112:115]
    v_exp_f32 v17, v109
    v_mfma_f32_16x16x32_bf16 a[160:163], v[76:79], v[32:35], a[160:163]
    v_cvt_pk_bf16_f32 v173, v18, v19
    v_cvt_f32_i32 v248, v248
    v_mfma_f32_16x16x32_bf16 a[160:163], v[92:95], v[36:39], a[160:163]
    s_waitcnt lgkmcnt(2)
    v_exp_f32 v18, v110
    v_mfma_f32_16x16x32_bf16 a[20:23], v[64:67], v[40:43], a[20:23]
    s_min_u32 s29, s29, s3
    ds_read_b128 v[32:35], v21 offset:2304
    v_add_f32 v7, v7, v16
    v_mfma_f32_16x16x32_bf16 a[20:23], v[80:83], v[44:47], a[20:23]
    v_add_f32 v7, v7, v17
    v_cvt_f32_i32 v249, v249
    v_mfma_f32_16x16x32_bf16 a[68:71], v[68:71], v[40:43], a[68:71]
    v_exp_f32 v19, v111
    v_mfma_f32_16x16x32_bf16 a[68:71], v[84:87], v[44:47], a[68:71]
    v_cvt_pk_bf16_f32 v174, v16, v17
    v_cvt_f32_i32 v252, v252
    v_mfma_f32_16x16x32_bf16 a[116:119], v[72:75], v[40:43], a[116:119]
    ds_read_b128 v[36:39], v21 offset:14592
    v_mfma_f32_16x16x32_bf16 a[116:119], v[88:91], v[44:47], a[116:119]
    s_waitcnt vmcnt(0)
    v_subrev_u32 v52, s92, v52
    v_cmp_lt_u32 vcc, 15, v52
    v_mfma_f32_16x16x32_bf16 a[164:167], v[76:79], v[40:43], a[164:167]
    s_sub_u32 s3, s29, s28
    v_exp_f32 v16, v176
    v_mfma_f32_16x16x32_bf16 a[164:167], v[92:95], v[44:47], a[164:167]
    s_waitcnt lgkmcnt(2)
    v_add_f32 v7, v7, v18
    v_add_f32 v7, v7, v19
    v_mfma_f32_16x16x32_bf16 a[24:27], v[64:67], v[24:27], a[24:27]
    s_and_b32 s59, vcc_lo, 0xff
    ds_read_b128 v[40:43], v22 offset:0
    v_cvt_f32_i32 v253, v253
    v_mfma_f32_16x16x32_bf16 a[24:27], v[80:83], v[28:31], a[24:27]
    s_cbranch_scc1 L_pollslow3
L_pollok3:
    v_mfma_f32_16x16x32_bf16 a[72:75], v[68:71], v[24:27], a[72:75]
    s_add_u32 s92, s92, 1
    v_exp_f32 v17, v177
    v_mfma_f32_16x16x32_bf16 a[72:75], v[84:87], v[28:31], a[72:75]
    s_mov_b32 m0, s56
    v_cvt_pk_bf16_f32 v175, v18, v19
    v_fma_f32 v248, v248, v60, v62
    v_mfma_f32_16x16x32_bf16 a[120:123], v[72:75], v[24:27], a[120:123]
    ds_read_b128 v[44:47], v22 offset:12288
    v_fma_f32 v249, v249, v61, v63
    v_mfma_f32_16x16x32_bf16 a[120:123], v[88:91], v[28:31], a[120:123]
    s_mov_b32 s28, s29
    buffer_load_dwordx4 v8, s[4:7], s27 offen offset:0 sc1 lds
    v_mfma_f32_16x16x32_bf16 a[168:171], v[76:79], v[24:27], a[168:171]
    v_exp_f32 v18, v178
    v_mfma_f32_16x16x32_bf16 a[168:171], v[92:95], v[28:31], a[168:171]
    s_waitcnt lgkmcnt(2)
    v_add_f32 v4, v4, v16
    v_add_f32 v4, v4, v17
    v_mfma_f32_16x16x32_bf16 a[28:31], v[64:67], v[32:35], a[28:31]
    ds_read_b128 v[24:27], v22 offset:768
    v_fma_f32 v252, v252, v60, v62
    v_mfma_f32_16x16x32_bf16 a[28:31], v[80:83], v[36:39], a[28:31]
    buffer_load_dwordx4 v8, s[4:7], s27 offen offset:1024 sc1 lds
    v_mfma_f32_16x16x32_bf16 a[76:79], v[68:71], v[32:35], a[76:79]
    v_exp_f32 v19, v179
    v_mfma_f32_16x16x32_bf16 a[76:79], v[84:87], v[36:39], a[76:79]
    v_cvt_pk_bf16_f32 v176, v16, v17
    v_fma_f32 v253, v253, v61, v63
    v_mfma_f32_16x16x32_bf16 a[124:127], v[72:75], v[32:35], a[124:127]
    ds_read_b128 v[28:31], v22 offset:13056
    v_cvt_pk_bf16_f32 v234, v248, v249
    v_mfma_f32_16x16x32_bf16 a[124:127], v[88:91], v[36:39], a[124:127]
    buffer_load_dwordx4 v8, s[4:7], s27 offen offset:2048 sc1 lds
    v_mfma_f32_16x16x32_bf16 a[172:175], v[76:79], v[32:35], a[172:175]
    s_add_u32 s27, s27, 24576
    v_exp_f32 v16, v112
    v_mfma_f32_16x16x32_bf16 a[172:175], v[92:95], v[36:39], a[172:175]
    s_waitcnt lgkmcnt(2)
    v_add_f32 v4, v4, v18
    v_add_f32 v4, v4, v19
    v_mfma_f32_16x16x32_bf16 a[32:35], v[64:67], v[40:43], a[32:35]
    s_add_u32 s56, s56, 12288
    ds_read_b128 v[32:35], v22 offset:1536
    v_add_u32 v2, s3, v2
    v_mfma_f32_16x16x32_bf16 a[32:35], v[80:83], v[44:47], a[32:35]
    s_mov_b32 m0, s56
    v_exp_f32 v17, v113
    v_mfma_f32_16x16x32_bf16 a[80:83], v[68:71], v[40:43], a[80:83]
    v_cvt_pk_bf16_f32 v177, v18, v19
    v_cvt_pk_bf16_f32 v238, v252, v253
    v_mfma_f32_16x16x32_bf16 a[80:83], v[84:87], v[44:47], a[80:83]
    v_exp_f32 v18, v114
    v_mfma_f32_16x16x32_bf16 a[128:131], v[72:75], v[40:43], a[128:131]
    ds_read_b128 v[36:39], v22 offset:13824
    v_add_f32 v4, v4, v16
    v_mfma_f32_16x16x32_bf16 a[128:131], v[88:91], v[44:47], a[128:131]
    buffer_load_dwordx4 v8, s[4:7], s27 offen offset:0 sc1 lds
    v_mfma_f32_16x16x32_bf16 a[176:179], v[76:79], v[40:43], a[176:179]
    v_add_f32 v4, v4, v17
    v_cvt_f32_i32 v250, v250
    v_mfma_f32_16x16x32_bf16 a[176:179], v[92:95], v[44:47], a[176:179]
    s_waitcnt lgkmcnt(2)
    v_exp_f32 v19, v115
    v_mfma_f32_16x16x32_bf16 a[36:39], v[64:67], v[24:27], a[36:39]
    ds_read_b128 v[40:43], v22 offset:2304
    v_cvt_pk_bf16_f32 v178, v16, v17
    v_mfma_f32_16x16x32_bf16 a[36:39], v[80:83], v[28:31], a[36:39]
    buffer_load_dwordx4 v8, s[4:7], s27 offen offset:1024 sc1 lds
    v_mfma_f32_16x16x32_bf16 a[84:87], v[68:71], v[24:27], a[84:87]
    v_exp_f32 v16, v180
    v_mfma_f32_16x16x32_bf16 a[84:87], v[84:87], v[28:31], a[84:87]
    v_add_f32 v4, v4, v18
    v_add_f32 v4, v4, v19
    v_mfma_f32_16x16x32_bf16 a[132:135], v[72:75], v[24:27], a[132:135]
    ds_read_b128 v[44:47], v22 offset:14592
    v_add_u32 v3, s3, v3
    v_mfma_f32_16x16x32_bf16 a[132:135], v[88:91], v[28:31], a[132:135]
    s_waitcnt lgkmcnt(2)
    buffer_load_dwordx4 v8, s[4:7], s27 offen offset:2048 sc1 lds
    v_mfma_f32_16x16x32_bf16 a[180:183], v[76:79], v[24:27], a[180:183]
    s_waitcnt vmcnt(30)
    v_exp_f32 v17, v181
    v_mfma_f32_16x16x32_bf16 a[180:183], v[92:95], v[28:31], a[180:183]
    s_barrier
    v_cvt_pk_bf16_f32 v179, v18, v19
    v_mfma_f32_16x16x32_bf16 a[40:43], v[64:67], v[32:35], a[40:43]
    s_add_u32 s27, s27, 24576
    ds_read_b128 v[24:27], v2 offset:0
    v_cvt_f32_i32 v251, v251
    v_mfma_f32_16x16x32_bf16 a[40:43], v[80:83], v[36:39], a[40:43]
    v_exp_f32 v18, v182
    v_add_f32 v5, v5, v16
    v_mfma_f32_16x16x32_bf16 a[88:91], v[68:71], v[32:35], a[88:91]
    s_add_u32 s56, s56, 36864
    v_add_f32 v5, v5, v17
    v_cvt_f32_i32 v254, v254
    v_mfma_f32_16x16x32_bf16 a[88:91], v[84:87], v[36:39], a[88:91]
    s_sub_u32 s58, s56, 147456
    v_exp_f32 v19, v183
    v_mfma_f32_16x16x32_bf16 a[136:139], v[72:75], v[32:35], a[136:139]
    ds_read_b128 v[28:31], v3 offset:0
    v_cvt_pk_bf16_f32 v180, v16, v17
    v_mfma_f32_16x16x32_bf16 a[136:139], v[88:91], v[36:39], a[136:139]
    buffer_load_dwordx4 v[240:243], v12, s[68:71], s36 offen offset:0 nt
    v_mfma_f32_16x16x32_bf16 a[184:187], v[76:79], v[32:35], a[184:187]
    s_min_u32 s56, s56, s58
    v_exp_f32 v16, v116
    v_mfma_f32_16x16x32_bf16 a[184:187], v[92:95], v[36:39], a[184:187]
    s_waitcnt lgkmcnt(2)
    v_add_f32 v5, v5, v18
    v_add_f32 v5, v5, v19
    v_mfma_f32_16x16x32_bf16 a[44:47], v[64:67], v[40:43], a[44:47]
    ds_read_b128 v[32:35], v2 offset:6144
    v_cvt_f32_i32 v255, v255
    v_mfma_f32_16x16x32_bf16 a[44:47], v[80:83], v[44:47], a[44:47]
    buffer_load_dwordx4 v[244:247], v12, s[68:71], s36 offen offset:768 nt
    v_mfma_f32_16x16x32_bf16 a[92:95], v[68:71], v[40:43], a[92:95]
    v_exp_f32 v17, v117
    v_mfma_f32_16x16x32_bf16 a[92:95], v[84:87], v[44:47], a[92:95]
    v_cvt_pk_bf16_f32 v181, v18, v19
    v_exp_f32 v18, v118
    v_mfma_f32_16x16x32_bf16 a[140:143], v[72:75], v[40:43], a[140:143]
    s_nop 0
    ds_read_b128 v[36:39], v3 offset:6144
    v_add_f32 v5, v5, v16
    v_mfma_f32_16x16x32_bf16 a[140:143], v[88:91], v[44:47], a[140:143]
    v_add_f32 v5, v5, v17
    v_fma_f32 v250, v250, v48, v50
    v_mfma_f32_16x16x32_bf16 a[188:191], v[76:79], v[40:43], a[188:191]
    s_waitcnt lgkmcnt(2)
    v_exp_f32 v19, v119
    v_fma_f32 v251, v251, v49, v51
    v_cvt_pk_bf16_f32 v182, v16, v17
    v_fma_f32 v254, v254, v48, v50
    v_add_f32 v5, v5, v18
    v_fma_f32 v255, v255, v49, v51
    v_add_f32 v5, v5, v19
    v_cvt_pk_bf16_f32 v235, v250, v251
    v_cvt_pk_bf16_f32 v183, v18, v19
    v_cvt_pk_bf16_f32 v239, v254, v255
    v_mfma_f32_16x16x32_bf16 a[188:191], v[92:95], v[44:47], a[188:191]
    s_branch L_join
.p2align 6
L_loop:
    v_mfma_f32_16x16x32_bf16 a[0:3], v[160:163], v[24:27], a[0:3]
    ds_read_b128 v[40:43], v1 offset:1536
    v_cvt_f32_i32 v154, v154
    v_mfma_f32_16x16x32_bf16 a[0:3], v[176:179], v[28:31], a[0:3]
    buffer_load_dwordx4 v[248:251], v12, s[68:71], s36 offen offset:1536 nt
    v_mfma_f32_16x16x32_bf16 a[48:51], v[164:167], v[24:27], a[48:51]
    v_exp_f32 v16, v72
    v_mfma_f32_16x16x32_bf16 a[48:51], v[180:183], v[28:31], a[48:51]
    v_exp_f32 v17, v73
    v_mfma_f32_16x16x32_bf16 a[96:99], v[168:171], v[24:27], a[96:99]
    ds_read_b128 v[44:47], v1 offset:13824
    v_cvt_f32_i32 v158, v158
    v_mfma_f32_16x16x32_bf16 a[96:99], v[184:187], v[28:31], a[96:99]
    v_exp_f32 v18, v74
    v_mfma_f32_16x16x32_bf16 a[144:147], v[172:175], v[24:27], a[144:147]
    v_add_f32 v6, v6, v16
    v_add_f32 v6, v6, v17
    v_mfma_f32_16x16x32_bf16 a[144:147], v[188:191], v[28:31], a[144:147]
    s_waitcnt lgkmcnt(2)
    buffer_load_dwordx4 v[252:255], v12, s[68:71], s36 offen offset:2304 nt
    v_mfma_f32_16x16x32_bf16 a[4:7], v[160:163], v[32:35], a[4:7]
    ds_read_b128 v[24:27], v1 offset:2304
    v_cvt_f32_i32 v155, v155
    v_mfma_f32_16x16x32_bf16 a[4:7], v[176:179], v[36:39], a[4:7]
    v_exp_f32 v19, v75
    v_mfma_f32_16x16x32_bf16 a[52:55], v[164:167], v[32:35], a[52:55]
    v_cvt_pk_bf16_f32 v72, v16, v17
    v_cvt_f32_i32 v159, v159
    v_mfma_f32_16x16x32_bf16 a[52:55], v[180:183], v[36:39], a[52:55]
    v_exp_f32 v16, v104
    v_mfma_f32_16x16x32_bf16 a[100:103], v[168:171], v[32:35], a[100:103]
    ds_read_b128 v[28:31], v1 offset:14592
    v_add_f32 v6, v6, v18
    v_mfma_f32_16x16x32_bf16 a[100:103], v[184:187], v[36:39], a[100:103]
    v_add_f32 v6, v6, v19
    v_fma_f32 v154, v154, v60, v62
    v_mfma_f32_16x16x32_bf16 a[148:151], v[172:175], v[32:35], a[148:151]
    v_exp_f32 v17, v105
    v_mfma_f32_16x16x32_bf16 a[148:151], v[188:191], v[36:39], a[148:151]
    s_waitcnt lgkmcnt(2)
    v_cvt_pk_bf16_f32 v73, v18, v19
    v_fma_f32 v158, v158, v61, v63
    v_mfma_f32_16x16x32_bf16 a[8:11], v[160:163], v[40:43], a[8:11]
    ds_read_b128 v[32:35], v21 offset:0
    s_add_u32 s33, s33, 196608
    v_mfma_f32_16x16x32_bf16 a[8:11], v[176:179], v[44:47], a[8:11]
    s_sub_u32 s34, s33, 1572864
    v_exp_f32 v18, v106
    v_mfma_f32_16x16x32_bf16 a[56:59], v[164:167], v[40:43], a[56:59]
    v_add_f32 v6, v6, v16
    v_add_f32 v6, v6, v17
    v_mfma_f32_16x16x32_bf16 a[56:59], v[180:183], v[44:47], a[56:59]
    s_min_u32 s33, s33, s34
    v_exp_f32 v19, v107
    v_mfma_f32_16x16x32_bf16 a[104:107], v[168:171], v[40:43], a[104:107]
    s_mov_b32 m0, s56
    ds_read_b128 v[36:39], v21 offset:12288
    v_cvt_pk_bf16_f32 v74, v16, v17
    v_mfma_f32_16x16x32_bf16 a[104:107], v[184:187], v[44:47], a[104:107]
    v_exp_f32 v16, v76
    v_mfma_f32_16x16x32_bf16 a[152:155], v[172:175], v[40:43], a[152:155]
    s_add_u32 s34, s33, 3072
    v_fma_f32 v155, v155, v60, v62
    v_fma_f32 v159, v159, v61, v63
    v_mfma_f32_16x16x32_bf16 a[152:155], v[188:191], v[44:47], a[152:155]
    s_waitcnt lgkmcnt(2)
    buffer_load_dwordx4 v8, s[4:7], s27 offen offset:0 sc1 lds
    v_mfma_f32_16x16x32_bf16 a[12:15], v[160:163], v[24:27], a[12:15]
    s_add_u32 s37, s37, 196608
    ds_read_b128 v[40:43], v21 offset:768
    v_add_f32 v6, v6, v18
    v_mfma_f32_16x16x32_bf16 a[12:15], v[176:179], v[28:31], a[12:15]
    v_add_f32 v6, v6, v19
    v_cvt_pk_bf16_f32 v144, v144, v148
    v_mfma_f32_16x16x32_bf16 a[60:63], v[164:167], v[24:27], a[60:63]
    v_exp_f32 v17, v77
    v_mfma_f32_16x16x32_bf16 a[60:63], v[180:183], v[28:31], a[60:63]
    s_add_u32 s80, s80, 196608
    v_cvt_pk_bf16_f32 v75, v18, v19
    v_mfma_f32_16x16x32_bf16 a[108:111], v[168:171], v[24:27], a[108:111]
    ds_read_b128 v[44:47], v21 offset:13056
    v_cvt_pk_bf16_f32 v148, v145, v149
    v_mfma_f32_16x16x32_bf16 a[108:111], v[184:187], v[28:31], a[108:111]
    v_exp_f32 v18, v78
    v_mfma_f32_16x16x32_bf16 a[156:159], v[172:175], v[24:27], a[156:159]
    s_add_u32 s29, s28, 49152
    v_add_f32 v7, v7, v16
    v_add_f32 v7, v7, v17
    v_mfma_f32_16x16x32_bf16 a[156:159], v[188:191], v[28:31], a[156:159]
    s_waitcnt lgkmcnt(2)
    buffer_load_dwordx4 v[224:227], v9, s[64:67], s33 offen offset:0 nt
    v_mfma_f32_16x16x32_bf16 a[16:19], v[160:163], v[32:35], a[16:19]
    ds_read_b128 v[24:27], v21 offset:1536
    v_cvt_pk_bf16_f32 v145, v152, v156
    v_mfma_f32_16x16x32_bf16 a[16:19], v[176:179], v[36:39], a[16:19]
    s_sub_u32 s3, s29, 147456
    v_exp_f32 v19, v79
    v_mfma_f32_16x16x32_bf16 a[64:67], v[164:167], v[32:35], a[64:67]
    v_cvt_pk_bf16_f32 v76, v16, v17
    v_cvt_pk_bf16_f32 v149, v153, v157
    v_mfma_f32_16x16x32_bf16 a[64:67], v[180:183], v[36:39], a[64:67]
    buffer_load_dwordx4 v8, s[4:7], s27 offen offset:1024 sc1 lds
    v_mfma_f32_16x16x32_bf16 a[112:115], v[168:171], v[32:35], a[112:115]
    ds_read_b128 v[28:31], v21 offset:13824
    v_mfma_f32_16x16x32_bf16 a[112:115], v[184:187], v[36:39], a[112:115]
    v_exp_f32 v16, v108
    v_mfma_f32_16x16x32_bf16 a[160:163], v[172:175], v[32:35], a[160:163]
    v_add_f32 v7, v7, v18
    v_add_f32 v7, v7, v19
    v_mfma_f32_16x16x32_bf16 a[160:163], v[188:191], v[36:39], a[160:163]
    s_waitcnt lgkmcnt(2)
    buffer_load_dwordx4 v[228:231], v9, s[64:67], s33 offen offset:1536 nt
    v_mfma_f32_16x16x32_bf16 a[20:23], v[160:163], v[40:43], a[20:23]
    s_min_u32 s29, s29, s3
    ds_read_b128 v[32:35], v21 offset:2304
    v_cvt_pk_bf16_f32 v152, v146, v150
    v_mfma_f32_16x16x32_bf16 a[20:23], v[176:179], v[44:47], a[20:23]
    v_exp_f32 v17, v109
    v_mfma_f32_16x16x32_bf16 a[68:71], v[164:167], v[40:43], a[68:71]
    v_cvt_pk_bf16_f32 v77, v18, v19
    v_cvt_pk_bf16_f32 v153, v154, v158
    v_mfma_f32_16x16x32_bf16 a[68:71], v[180:183], v[44:47], a[68:71]
    buffer_load_dwordx4 v[232:235], v9, s[64:67], s34 offen offset:0 nt
    v_mfma_f32_16x16x32_bf16 a[116:119], v[168:171], v[40:43], a[116:119]
    ds_read_b128 v[36:39], v21 offset:14592
    v_cvt_pk_bf16_f32 v156, v147, v151
    v_mfma_f32_16x16x32_bf16 a[116:119], v[184:187], v[44:47], a[116:119]
    v_exp_f32 v18, v110
    v_mfma_f32_16x16x32_bf16 a[164:167], v[172:175], v[40:43], a[164:167]
    s_sub_u32 s3, s29, s28
    v_add_f32 v7, v7, v16
    v_add_f32 v7, v7, v17
    v_mfma_f32_16x16x32_bf16 a[164:167], v[188:191], v[44:47], a[164:167]
    s_waitcnt lgkmcnt(2)
    buffer_load_dwordx4 v8, s[4:7], s27 offen offset:2048 sc1 lds
    v_mfma_f32_16x16x32_bf16 a[24:27], v[160:163], v[24:27], a[24:27]
    s_add_u32 s27, s27, 24576
    ds_read_b128 v[40:43], v22 offset:0
    s_add_u32 s56, s56, 12288
    v_mfma_f32_16x16x32_bf16 a[24:27], v[176:179], v[28:31], a[24:27]
    v_exp_f32 v19, v111
    v_cvt_pk_bf16_f32 v78, v16, v17
    v_mfma_f32_16x16x32_bf16 a[72:75], v[164:167], v[24:27], a[72:75]
    s_mov_b32 m0, s56
    s_nop 0
    buffer_load_dwordx4 v[236:239], v9, s[64:67], s34 offen offset:1536 nt
    v_mfma_f32_16x16x32_bf16 a[72:75], v[180:183], v[28:31], a[72:75]
    v_exp_f32 v16, v80
    v_mfma_f32_16x16x32_bf16 a[120:123], v[168:171], v[24:27], a[120:123]
    ds_read_b128 v[44:47], v22 offset:12288
    v_add_f32 v7, v7, v18
    v_mfma_f32_16x16x32_bf16 a[120:123], v[184:187], v[28:31], a[120:123]
    s_mov_b32 s28, s29
    v_add_f32 v7, v7, v19
    v_cvt_pk_bf16_f32 v157, v155, v159
    v_mfma_f32_16x16x32_bf16 a[168:171], v[172:175], v[24:27], a[168:171]
    s_waitcnt vmcnt(19)
    v_exp_f32 v17, v81
    v_mfma_f32_16x16x32_bf16 a[168:171], v[188:191], v[28:31], a[168:171]
    s_waitcnt lgkmcnt(2)
    buffer_load_dwordx4 v8, s[4:7], s27 offen offset:0 sc1 lds
    v_cvt_pk_bf16_f32 v79, v18, v19
    v_mfma_f32_16x16x32_bf16 a[28:31], v[160:163], v[32:35], a[28:31]
    ds_read_b128 v[24:27], v22 offset:768
    v_cvt_f32_i32 v240, v240
    v_mfma_f32_16x16x32_bf16 a[28:31], v[176:179], v[36:39], a[28:31]
    v_exp_f32 v18, v82
    v_mfma_f32_16x16x32_bf16 a[76:79], v[164:167], v[32:35], a[76:79]
    v_add_f32 v4, v4, v16
    v_add_f32 v4, v4, v17
    v_mfma_f32_16x16x32_bf16 a[76:79], v[180:183], v[36:39], a[76:79]
    v_exp_f32 v19, v83
    v_mfma_f32_16x16x32_bf16 a[124:127], v[168:171], v[32:35], a[124:127]
    ds_read_b128 v[28:31], v22 offset:13056
    v_cvt_pk_bf16_f32 v80, v16, v17
    v_mfma_f32_16x16x32_bf16 a[124:127], v[184:187], v[36:39], a[124:127]
    buffer_load_dwordx4 v8, s[4:7], s27 offen offset:1024 sc1 lds
    v_mfma_f32_16x16x32_bf16 a[172:175], v[172:175], v[32:35], a[172:175]
    v_exp_f32 v16, v112
    v_mfma_f32_16x16x32_bf16 a[172:175], v[188:191], v[36:39], a[172:175]
    s_waitcnt lgkmcnt(2)
    v_add_f32 v4, v4, v18
    v_add_f32 v4, v4, v19
    v_mfma_f32_16x16x32_bf16 a[32:35], v[160:163], v[40:43], a[32:35]
    ds_read_b128 v[32:35], v22 offset:1536
    v_cvt_f32_i32 v244, v244
    v_mfma_f32_16x16x32_bf16 a[32:35], v[176:179], v[44:47], a[32:35]
    v_exp_f32 v17, v113
    v_mfma_f32_16x16x32_bf16 a[80:83], v[164:167], v[40:43], a[80:83]
    v_cvt_pk_bf16_f32 v81, v18, v19
    v_cvt_f32_i32 v241, v241
    v_mfma_f32_16x16x32_bf16 a[80:83], v[180:183], v[44:47], a[80:83]
    v_exp_f32 v18, v114
    v_mfma_f32_16x16x32_bf16 a[128:131], v[168:171], v[40:43], a[128:131]
    ds_read_b128 v[36:39], v22 offset:13824
    v_add_f32 v4, v4, v16
    v_mfma_f32_16x16x32_bf16 a[128:131], v[184:187], v[44:47], a[128:131]
    buffer_load_dwordx4 v8, s[4:7], s27 offen offset:2048 sc1 lds
    v_mfma_f32_16x16x32_bf16 a[176:179], v[172:175], v[40:43], a[176:179]
    v_add_f32 v4, v4, v17
    v_add_u32 v2, s3, v2
    v_mfma_f32_16x16x32_bf16 a[176:179], v[188:191], v[44:47], a[176:179]
    s_waitcnt lgkmcnt(2)
    v_exp_f32 v19, v115
    v_mfma_f32_16x16x32_bf16 a[36:39], v[160:163], v[24:27], a[36:39]
    ds_read_b128 v[40:43], v22 offset:2304
    v_cvt_pk_bf16_f32 v82, v16, v17
    v_mfma_f32_16x16x32_bf16 a[36:39], v[176:179], v[28:31], a[36:39]
    v_exp_f32 v16, v84
    v_mfma_f32_16x16x32_bf16 a[84:87], v[164:167], v[24:27], a[84:87]
    v_add_f32 v4, v4, v18
    v_add_f32 v4, v4, v19
    v_mfma_f32_16x16x32_bf16 a[84:87], v[180:183], v[28:31], a[84:87]
    s_add_u32 s27, s27, 24576
    v_exp_f32 v17, v85
    v_mfma_f32_16x16x32_bf16 a[132:135], v[168:171], v[24:27], a[132:135]
    s_add_u32 s56, s56, 36864
    ds_read_b128 v[44:47], v22 offset:14592
    v_add_u32 v3, s3, v3
    v_mfma_f32_16x16x32_bf16 a[132:135], v[184:187], v[28:31], a[132:135]
    s_waitcnt lgkmcnt(2)
    v_cvt_pk_bf16_f32 v83, v18, v19
    v_cvt_f32_i32 v245, v245
    v_mfma_f32_16x16x32_bf16 a[180:183], v[172:175], v[24:27], a[180:183]
    s_waitcnt vmcnt(15)
    v_exp_f32 v18, v86
    v_mfma_f32_16x16x32_bf16 a[180:183], v[188:191], v[28:31], a[180:183]
    s_barrier
    v_add_f32 v5, v5, v16
    v_mfma_f32_16x16x32_bf16 a[40:43], v[160:163], v[32:35], a[40:43]
    s_sub_u32 s58, s56, 147456
    ds_read_b128 v[24:27], v2 offset:0
    v_add_f32 v5, v5, v17
    v_mfma_f32_16x16x32_bf16 a[40:43], v[176:179], v[36:39], a[40:43]
    v_fma_f32 v240, v240, v48, v50
    v_fma_f32 v244, v244, v49, v51
    v_mfma_f32_16x16x32_bf16 a[88:91], v[164:167], v[32:35], a[88:91]
    s_min_u32 s56, s56, s58
    v_exp_f32 v19, v87
    v_mfma_f32_16x16x32_bf16 a[88:91], v[180:183], v[36:39], a[88:91]
    v_cvt_pk_bf16_f32 v84, v16, v17
    v_fma_f32 v241, v241, v48, v50
    v_mfma_f32_16x16x32_bf16 a[136:139], v[168:171], v[32:35], a[136:139]
    ds_read_b128 v[28:31], v3 offset:0
    v_fma_f32 v245, v245, v49, v51
    v_mfma_f32_16x16x32_bf16 a[136:139], v[184:187], v[36:39], a[136:139]
    v_exp_f32 v16, v116
    v_mfma_f32_16x16x32_bf16 a[184:187], v[172:175], v[32:35], a[184:187]
    v_add_f32 v5, v5, v18
    v_add_f32 v5, v5, v19
    v_mfma_f32_16x16x32_bf16 a[184:187], v[188:191], v[36:39], a[184:187]
    s_waitcnt lgkmcnt(2)
    v_exp_f32 v17, v117
    v_mfma_f32_16x16x32_bf16 a[44:47], v[160:163], v[40:43], a[44:47]
    ds_read_b128 v[32:35], v2 offset:6144
    v_cvt_pk_bf16_f32 v85, v18, v19
    v_mfma_f32_16x16x32_bf16 a[44:47], v[176:179], v[44:47], a[44:47]
    v_exp_f32 v18, v118
    v_mfma_f32_16x16x32_bf16 a[92:95], v[164:167], v[40:43], a[92:95]
    v_add_u32 v55, 1, v55
    v_cvt_f32_i32 v242, v242
    v_mfma_f32_16x16x32_bf16 a[92:95], v[180:183], v[44:47], a[92:95]
    buffer_store_dword v55, v13, s[20:23], 0 offen sc1
    v_mfma_f32_16x16x32_bf16 a[140:143], v[168:171], v[40:43], a[140:143]
    ds_read_b128 v[36:39], v3 offset:6144
    v_add_f32 v5, v5, v16
    v_mfma_f32_16x16x32_bf16 a[140:143], v[184:187], v[44:47], a[140:143]
    v_add_f32 v5, v5, v17
    v_cvt_f32_i32 v246, v246
    v_mfma_f32_16x16x32_bf16 a[188:191], v[172:175], v[40:43], a[188:191]
    v_exp_f32 v19, v119
    v_mfma_f32_16x16x32_bf16 a[188:191], v[188:191], v[44:47], a[188:191]
    s_waitcnt lgkmcnt(2)
    v_cvt_pk_bf16_f32 v86, v16, v17
    v_add_f32 v5, v5, v18
    v_add_f32 v5, v5, v19
    v_cvt_f32_i32 v243, v243
    v_cvt_pk_bf16_f32 v87, v18, v19
    v_cvt_f32_i32 v247, v247
    s_branch L_skip8
L_pad8:
    s_branch L_tb1_6
L_skip8:
    v_mfma_f32_16x16x32_bf16 v[160:163], v[24:27], a[192:195], v[128:131]
    s_mov_b32 m0, s26
    ds_read_b128 v[40:43], v2 offset:128
    v_fma_f32 v242, v242, v48, v50
    v_mfma_f32_16x16x32_bf16 v[160:163], v[28:31], a[196:199], v[160:163]
    v_exp_f32 v16, v88
    v_mfma_f32_16x16x32_bf16 v[164:167], v[24:27], a[216:219], v[132:135]
    v_exp_f32 v17, v89
    v_mfma_f32_16x16x32_bf16 v[164:167], v[28:31], a[220:223], v[164:167]
    v_exp_f32 v18, v90
    v_mfma_f32_16x16x32_bf16 v[168:171], v[24:27], a[240:243], v[136:139]
    ds_read_b128 v[44:47], v3 offset:128
    v_fma_f32 v246, v246, v49, v51
    v_mfma_f32_16x16x32_bf16 v[168:171], v[28:31], a[244:247], v[168:171]
    buffer_load_dwordx4 v8, s[4:7], s32 offen offset:0 sc1 lds
    v_mfma_f32_16x16x32_bf16 v[172:175], v[24:27], v[200:203], v[140:143]
    v_add_f32 v6, v6, v16
    v_add_f32 v6, v6, v17
    v_mfma_f32_16x16x32_bf16 v[172:175], v[28:31], v[204:207], v[172:175]
    s_waitcnt lgkmcnt(2)
    v_exp_f32 v19, v91
    v_mfma_f32_16x16x32_bf16 v[96:99], v[32:35], a[192:195], v[128:131]
    ds_read_b128 v[24:27], v2 offset:6272
    v_fma_f32 v243, v243, v48, v50
    v_mfma_f32_16x16x32_bf16 v[96:99], v[36:39], a[196:199], v[96:99]
    v_cvt_pk_bf16_f32 v88, v16, v17
    v_fma_f32 v247, v247, v49, v51
    v_mfma_f32_16x16x32_bf16 v[100:103], v[32:35], a[216:219], v[132:135]
    v_exp_f32 v16, v120
    v_mfma_f32_16x16x32_bf16 v[100:103], v[36:39], a[220:223], v[100:103]
    ds_read_b128 v[48:51], v10 offset:0
    v_add_f32 v6, v6, v18
    v_mfma_f32_16x16x32_bf16 v[104:107], v[32:35], a[240:243], v[136:139]
    ds_read_b128 v[28:31], v3 offset:6272
    v_add_f32 v6, v6, v19
    v_mfma_f32_16x16x32_bf16 v[104:107], v[36:39], a[244:247], v[104:107]
    buffer_load_dwordx4 v8, s[4:7], s32 offen offset:1024 sc1 lds
    v_mfma_f32_16x16x32_bf16 v[108:111], v[32:35], v[200:203], v[140:143]
    v_exp_f32 v17, v121
    v_mfma_f32_16x16x32_bf16 v[108:111], v[36:39], v[204:207], v[108:111]
    s_waitcnt lgkmcnt(3)
    v_cvt_pk_bf16_f32 v89, v18, v19
    v_cvt_pk_bf16_f32 v146, v240, v244
    v_mfma_f32_16x16x32_bf16 v[160:163], v[40:43], a[200:203], v[160:163]
    ds_read_b128 v[32:35], v2 offset:256
    v_mfma_f32_16x16x32_bf16 v[160:163], v[44:47], a[204:207], v[160:163]
    v_exp_f32 v18, v122
    v_mfma_f32_16x16x32_bf16 v[164:167], v[40:43], a[224:227], v[164:167]
    v_add_f32 v6, v6, v16
    v_cvt_pk_bf16_f32 v150, v241, v245
    v_mfma_f32_16x16x32_bf16 v[164:167], v[44:47], a[228:231], v[164:167]
    v_add_f32 v6, v6, v17
    v_mfma_f32_16x16x32_bf16 v[168:171], v[40:43], a[248:251], v[168:171]
    ds_read_b128 v[36:39], v3 offset:256
    v_cvt_pk_bf16_f32 v154, v242, v246
    v_mfma_f32_16x16x32_bf16 v[168:171], v[44:47], a[252:255], v[168:171]
    v_exp_f32 v19, v123
    v_mfma_f32_16x16x32_bf16 v[172:175], v[40:43], v[208:211], v[172:175]
    v_cvt_pk_bf16_f32 v90, v16, v17
    v_mfma_f32_16x16x32_bf16 v[172:175], v[44:47], v[212:215], v[172:175]
    s_waitcnt lgkmcnt(2)
    buffer_load_dwordx4 v8, s[4:7], s32 offen offset:2048 sc1 lds
    v_mfma_f32_16x16x32_bf16 v[96:99], v[24:27], a[200:203], v[96:99]
    ds_read_b128 v[40:43], v2 offset:6400
    v_cvt_pk_bf16_f32 v158, v243, v247
    v_mfma_f32_16x16x32_bf16 v[96:99], v[28:31], a[204:207], v[96:99]
    v_exp_f32 v16, v92
    v_mfma_f32_16x16x32_bf16 v[100:103], v[24:27], a[224:227], v[100:103]
    v_add_f32 v6, v6, v18
    v_add_f32 v6, v6, v19
    v_mfma_f32_16x16x32_bf16 v[100:103], v[28:31], a[228:231], v[100:103]
    s_waitcnt vmcnt(14)
    v_exp_f32 v17, v93
    v_mfma_f32_16x16x32_bf16 v[104:107], v[24:27], a[248:251], v[104:107]
    ds_read_b128 v[44:47], v3 offset:6400
    v_cvt_pk_bf16_f32 v91, v18, v19
    v_mfma_f32_16x16x32_bf16 v[104:107], v[28:31], a[252:255], v[104:107]
    s_add_u32 s32, s32, 24576
    v_exp_f32 v18, v94
    v_mfma_f32_16x16x32_bf16 v[108:111], v[24:27], v[208:211], v[108:111]
    s_add_u32 s29, s30, 49152
    v_add_f32 v7, v7, v16
    v_cvt_f32_i32 v248, v248
    v_mfma_f32_16x16x32_bf16 v[108:111], v[28:31], v[212:215], v[108:111]
    s_waitcnt lgkmcnt(2)
    v_add_f32 v7, v7, v17
    v_mfma_f32_16x16x32_bf16 v[160:163], v[32:35], a[208:211], v[160:163]
    s_sub_u32 s3, s29, 147456
    ds_read_b128 v[24:27], v2 offset:12288
    v_mfma_f32_16x16x32_bf16 v[160:163], v[36:39], a[212:215], v[160:163]
    v_exp_f32 v19, v95
    v_mfma_f32_16x16x32_bf16 v[164:167], v[32:35], a[232:235], v[164:167]
    s_add_u32 s26, s26, 12288
    v_cvt_pk_bf16_f32 v92, v16, v17
    v_cvt_f32_i32 v252, v252
    v_mfma_f32_16x16x32_bf16 v[164:167], v[36:39], a[236:239], v[164:167]
    v_exp_f32 v16, v124
    v_mfma_f32_16x16x32_bf16 v[168:171], v[32:35], v[192:195], v[168:171]
    ds_read_b128 v[28:31], v3 offset:12288
    v_cvt_f32_i32 v249, v249
    v_mfma_f32_16x16x32_bf16 v[168:171], v[36:39], v[196:199], v[168:171]
    v_add_f32 v7, v7, v18
    v_add_f32 v7, v7, v19
    v_mfma_f32_16x16x32_bf16 v[172:175], v[32:35], v[216:219], v[172:175]
    s_min_u32 s29, s29, s3
    s_mov_b32 m0, s26
    v_mfma_f32_16x16x32_bf16 v[172:175], v[36:39], v[220:223], v[172:175]
    s_waitcnt lgkmcnt(2)
    v_exp_f32 v17, v125
    v_mfma_f32_16x16x32_bf16 v[96:99], v[40:43], a[208:211], v[96:99]
    ds_read_b128 v[32:35], v2 offset:18432
    v_cvt_pk_bf16_f32 v93, v18, v19
    v_mfma_f32_16x16x32_bf16 v[96:99], v[44:47], a[212:215], v[96:99]
    v_exp_f32 v18, v126
    v_mfma_f32_16x16x32_bf16 v[100:103], v[40:43], a[232:235], v[100:103]
    v_cvt_f32_i32 v253, v253
    v_mfma_f32_16x16x32_bf16 v[100:103], v[44:47], a[236:239], v[100:103]
    v_add_f32 v7, v7, v16
    v_fma_f32 v248, v248, v56, v58
    v_mfma_f32_16x16x32_bf16 v[104:107], v[40:43], v[192:195], v[104:107]
    s_sub_u32 s3, s29, s30
    ds_read_b128 v[36:39], v3 offset:18432
    v_add_f32 v7, v7, v17
    v_mfma_f32_16x16x32_bf16 v[104:107], v[44:47], v[196:199], v[104:107]
    buffer_load_dwordx4 v8, s[4:7], s32 offen offset:0 sc1 lds
    v_mfma_f32_16x16x32_bf16 v[108:111], v[40:43], v[216:219], v[108:111]
    v_exp_f32 v19, v127
    v_mfma_f32_16x16x32_bf16 v[108:111], v[44:47], v[220:223], v[108:111]
    s_waitcnt lgkmcnt(2)
    v_cvt_pk_bf16_f32 v94, v16, v17
    v_fma_f32 v252, v252, v57, v59
    v_mfma_f32_16x16x32_bf16 v[176:179], v[24:27], a[192:195], v[128:131]
    ds_read_b128 v[40:43], v2 offset:12416
    v_add_f32 v7, v7, v18
    v_mfma_f32_16x16x32_bf16 v[176:179], v[28:31], a[196:199], v[176:179]
    v_add_f32 v7, v7, v19
    v_fma_f32 v249, v249, v56, v58
    v_mfma_f32_16x16x32_bf16 v[180:183], v[24:27], a[216:219], v[132:135]
    s_mov_b32 s30, s29
    v_cvt_pk_bf16_f32 v95, v18, v19
    v_mfma_f32_16x16x32_bf16 v[180:183], v[28:31], a[220:223], v[180:183]
    v_mfma_f32_16x16x32_bf16 v[184:187], v[24:27], a[240:243], v[136:139]
    ds_read_b128 v[44:47], v3 offset:12416
    v_fma_f32 v253, v253, v57, v59
    v_mfma_f32_16x16x32_bf16 v[184:187], v[28:31], a[244:247], v[184:187]
    v_exp_f32 v16, v160
    v_mfma_f32_16x16x32_bf16 v[188:191], v[24:27], v[200:203], v[140:143]
    v_exp_f32 v17, v161
    v_mfma_f32_16x16x32_bf16 v[188:191], v[28:31], v[204:207], v[188:191]
    s_waitcnt lgkmcnt(2)
    buffer_load_dwordx4 v8, s[4:7], s32 offen offset:1024 sc1 lds
    v_mfma_f32_16x16x32_bf16 v[112:115], v[32:35], a[192:195], v[128:131]
    ds_read_b128 v[24:27], v2 offset:18560
    v_cvt_f32_i32 v250, v250
    v_mfma_f32_16x16x32_bf16 v[112:115], v[36:39], a[196:199], v[112:115]
    v_exp_f32 v18, v162
    v_mfma_f32_16x16x32_bf16 v[116:119], v[32:35], a[216:219], v[132:135]
    v_add_f32 v4, v4, v16
    v_add_f32 v4, v4, v17
    v_mfma_f32_16x16x32_bf16 v[116:119], v[36:39], a[220:223], v[116:119]
    v_exp_f32 v19, v163
    v_mfma_f32_16x16x32_bf16 v[120:123], v[32:35], a[240:243], v[136:139]
    ds_read_b128 v[28:31], v3 offset:18560
    v_cvt_pk_bf16_f32 v160, v16, v17
    v_mfma_f32_16x16x32_bf16 v[120:123], v[36:39], a[244:247], v[120:123]
    v_exp_f32 v16, v96
    v_mfma_f32_16x16x32_bf16 v[124:127], v[32:35], v[200:203], v[140:143]
    v_add_f32 v4, v4, v18
    v_add_u32 v1, s3, v1
    v_mfma_f32_16x16x32_bf16 v[124:127], v[36:39], v[204:207], v[124:127]
    s_waitcnt lgkmcnt(2)
    buffer_load_dwordx4 v8, s[4:7], s32 offen offset:2048 sc1 lds
    v_mfma_f32_16x16x32_bf16 v[176:179], v[40:43], a[200:203], v[176:179]
    ds_read_b128 v[32:35], v2 offset:12544
    v_add_f32 v4, v4, v19
    v_mfma_f32_16x16x32_bf16 v[176:179], v[44:47], a[204:207], v[176:179]
    v_exp_f32 v17, v97
    v_mfma_f32_16x16x32_bf16 v[180:183], v[40:43], a[224:227], v[180:183]
    v_cvt_pk_bf16_f32 v161, v18, v19
    v_cvt_f32_i32 v254, v254
    v_mfma_f32_16x16x32_bf16 v[180:183], v[44:47], a[228:231], v[180:183]
    v_exp_f32 v18, v98
    v_mfma_f32_16x16x32_bf16 v[184:187], v[40:43], a[248:251], v[184:187]
    ds_read_b128 v[36:39], v3 offset:12544
    v_add_f32 v4, v4, v16
    v_mfma_f32_16x16x32_bf16 v[184:187], v[44:47], a[252:255], v[184:187]
    v_add_f32 v4, v4, v17
    v_cvt_f32_i32 v251, v251
    v_mfma_f32_16x16x32_bf16 v[188:191], v[40:43], v[208:211], v[188:191]
    v_exp_f32 v19, v99
    v_mfma_f32_16x16x32_bf16 v[188:191], v[44:47], v[212:215], v[188:191]
    s_waitcnt lgkmcnt(2)
    v_add_u32 v21, s3, v21
    v_cvt_f32_i32 v255, v255
    v_mfma_f32_16x16x32_bf16 v[112:115], v[24:27], a[200:203], v[112:115]
    ds_read_b128 v[40:43], v2 offset:18688
    v_cvt_pk_bf16_f32 v162, v16, v17
    v_mfma_f32_16x16x32_bf16 v[112:115], v[28:31], a[204:207], v[112:115]
    s_add_u32 s32, s32, 24576
    v_exp_f32 v16, v164
    v_mfma_f32_16x16x32_bf16 v[116:119], v[24:27], a[224:227], v[116:119]
    s_add_u32 s26, s26, 36864
    v_add_f32 v4, v4, v18
    v_add_u32 v22, s3, v22
    v_mfma_f32_16x16x32_bf16 v[116:119], v[28:31], a[228:231], v[116:119]
    v_add_f32 v4, v4, v19
    v_fma_f32 v250, v250, v56, v58
    v_mfma_f32_16x16x32_bf16 v[120:123], v[24:27], a[248:251], v[120:123]
    ds_read_b128 v[44:47], v3 offset:18688
    v_fma_f32 v254, v254, v57, v59
    v_mfma_f32_16x16x32_bf16 v[120:123], v[28:31], a[252:255], v[120:123]
    s_waitcnt lgkmcnt(2)
    buffer_load_dwordx4 v[240:243], v9, s[64:67], s33 offen offset:384 nt
    v_mfma_f32_16x16x32_bf16 v[124:127], v[24:27], v[208:211], v[124:127]
    s_waitcnt vmcnt(32)
    v_exp_f32 v17, v165
    v_mfma_f32_16x16x32_bf16 v[124:127], v[28:31], v[212:215], v[124:127]
    s_barrier
    v_cvt_pk_bf16_f32 v163, v18, v19
    v_mfma_f32_16x16x32_bf16 v[176:179], v[32:35], a[208:211], v[176:179]
    s_sub_u32 s57, s26, 147456
    ds_read_b128 v[24:27], v1 offset:0
    v_fma_f32 v251, v251, v56, v58
    v_mfma_f32_16x16x32_bf16 v[176:179], v[36:39], a[212:215], v[176:179]
    s_min_u32 s26, s26, s57
    v_exp_f32 v18, v166
    v_mfma_f32_16x16x32_bf16 v[180:183], v[32:35], a[232:235], v[180:183]
    v_add_f32 v5, v5, v16
    v_add_f32 v5, v5, v17
    v_mfma_f32_16x16x32_bf16 v[180:183], v[36:39], a[236:239], v[180:183]
    v_exp_f32 v19, v167
    v_mfma_f32_16x16x32_bf16 v[184:187], v[32:35], v[192:195], v[184:187]
    ds_read_b128 v[28:31], v1 offset:12288
    v_cvt_pk_bf16_f32 v164, v16, v17
    v_mfma_f32_16x16x32_bf16 v[184:187], v[36:39], v[196:199], v[184:187]
    buffer_load_dwordx4 v[244:247], v9, s[64:67], s33 offen offset:1920 nt
    v_mfma_f32_16x16x32_bf16 v[188:191], v[32:35], v[216:219], v[188:191]
    v_exp_f32 v16, v100
    v_mfma_f32_16x16x32_bf16 v[188:191], v[36:39], v[220:223], v[188:191]
    s_waitcnt lgkmcnt(2)
    v_add_f32 v5, v5, v18
    v_add_f32 v5, v5, v19
    v_mfma_f32_16x16x32_bf16 v[112:115], v[40:43], a[208:211], v[112:115]
    ds_read_b128 v[32:35], v1 offset:768
    v_fma_f32 v255, v255, v57, v59
    v_mfma_f32_16x16x32_bf16 v[112:115], v[44:47], a[212:215], v[112:115]
    v_exp_f32 v17, v101
    v_mfma_f32_16x16x32_bf16 v[116:119], v[40:43], a[232:235], v[116:119]
    v_cvt_pk_bf16_f32 v165, v18, v19
    v_cvt_pk_bf16_f32 v147, v248, v252
    v_mfma_f32_16x16x32_bf16 v[116:119], v[44:47], a[236:239], v[116:119]
    v_exp_f32 v18, v102
    v_mfma_f32_16x16x32_bf16 v[120:123], v[40:43], v[192:195], v[120:123]
    ds_read_b128 v[36:39], v1 offset:13056
    v_add_f32 v5, v5, v16
    v_mfma_f32_16x16x32_bf16 v[120:123], v[44:47], v[196:199], v[120:123]
    v_add_f32 v5, v5, v17
    v_cvt_pk_bf16_f32 v151, v249, v253
    v_mfma_f32_16x16x32_bf16 v[124:127], v[40:43], v[216:219], v[124:127]
    v_exp_f32 v19, v103
    v_mfma_f32_16x16x32_bf16 v[124:127], v[44:47], v[220:223], v[124:127]
    s_waitcnt lgkmcnt(2)
    v_cvt_pk_bf16_f32 v166, v16, v17
    v_add_f32 v5, v5, v18
    v_add_f32 v5, v5, v19
    v_cvt_pk_bf16_f32 v155, v250, v254
    v_cvt_pk_bf16_f32 v167, v18, v19
    v_cvt_pk_bf16_f32 v159, v251, v255
    v_mfma_f32_16x16x32_bf16 a[0:3], v[64:67], v[24:27], a[0:3]
    ds_read_b128 v[40:43], v1 offset:1536
    v_bfe_u32 v53, v8, 4, 6
    v_mfma_f32_16x16x32_bf16 a[0:3], v[80:83], v[28:31], a[0:3]
    v_exp_f32 v16, v168
    v_mfma_f32_16x16x32_bf16 a[48:51], v[68:71], v[24:27], a[48:51]
    v_exp_f32 v17, v169
    v_mfma_f32_16x16x32_bf16 a[48:51], v[84:87], v[28:31], a[48:51]
    ds_read_b128 v[56:59], v10 offset:384
    v_lshlrev_b32 v53, 2, v53
    v_mfma_f32_16x16x32_bf16 a[96:99], v[72:75], v[24:27], a[96:99]
    s_waitcnt vmcnt(15)
    ds_read_b128 v[44:47], v1 offset:13824
    v_mfma_f32_16x16x32_bf16 a[96:99], v[88:91], v[28:31], a[96:99]
    buffer_store_dwordx4 v[144:147], v20, s[4:7], s81 offen offset:0 sc1
    v_mfma_f32_16x16x32_bf16 a[144:147], v[76:79], v[24:27], a[144:147]
    v_exp_f32 v18, v170
    v_mfma_f32_16x16x32_bf16 a[144:147], v[92:95], v[28:31], a[144:147]
    s_waitcnt lgkmcnt(3)
    v_add_f32 v6, v6, v16
    v_add_f32 v6, v6, v17
    v_mfma_f32_16x16x32_bf16 a[4:7], v[64:67], v[32:35], a[4:7]
    ds_read_b128 v[24:27], v1 offset:2304
    buffer_load_dword v52, v53, s[20:23], 0 offen sc1
    v_mfma_f32_16x16x32_bf16 a[4:7], v[80:83], v[36:39], a[4:7]
    v_exp_f32 v19, v171
    v_mfma_f32_16x16x32_bf16 a[52:55], v[68:71], v[32:35], a[52:55]
    s_mov_b32 m0, s56
    v_cvt_pk_bf16_f32 v168, v16, v17
    v_cvt_f32_i32 v224, v224
    v_mfma_f32_16x16x32_bf16 a[52:55], v[84:87], v[36:39], a[52:55]
    v_exp_f32 v16, v104
    v_mfma_f32_16x16x32_bf16 a[100:103], v[72:75], v[32:35], a[100:103]
    ds_read_b128 v[28:31], v1 offset:14592
    v_add_f32 v6, v6, v18
    v_mfma_f32_16x16x32_bf16 a[100:103], v[88:91], v[36:39], a[100:103]
    v_add_f32 v6, v6, v19
    v_mfma_f32_16x16x32_bf16 a[148:151], v[76:79], v[32:35], a[148:151]
    v_exp_f32 v17, v105
    v_mfma_f32_16x16x32_bf16 a[148:151], v[92:95], v[36:39], a[148:151]
    s_waitcnt lgkmcnt(2)
    buffer_load_dwordx4 v8, s[4:7], s27 offen offset:0 sc1 lds
    v_mfma_f32_16x16x32_bf16 a[8:11], v[64:67], v[40:43], a[8:11]
    ds_read_b128 v[32:35], v21 offset:0
    v_cvt_pk_bf16_f32 v169, v18, v19
    v_mfma_f32_16x16x32_bf16 a[8:11], v[80:83], v[44:47], a[8:11]
    v_exp_f32 v18, v106
    v_mfma_f32_16x16x32_bf16 a[56:59], v[68:71], v[40:43], a[56:59]
    v_add_f32 v6, v6, v16
    v_add_f32 v6, v6, v17
    v_mfma_f32_16x16x32_bf16 a[56:59], v[84:87], v[44:47], a[56:59]
    v_exp_f32 v19, v107
    v_mfma_f32_16x16x32_bf16 a[104:107], v[72:75], v[40:43], a[104:107]
    ds_read_b128 v[36:39], v21 offset:12288
    v_cvt_f32_i32 v225, v225
    v_mfma_f32_16x16x32_bf16 a[104:107], v[88:91], v[44:47], a[104:107]
    buffer_store_dwordx4 v[148:151], v20, s[4:7], s81 offen offset:768 sc1
    v_mfma_f32_16x16x32_bf16 a[152:155], v[76:79], v[40:43], a[152:155]
    v_cvt_pk_bf16_f32 v170, v16, v17
    v_cvt_f32_i32 v228, v228
    v_mfma_f32_16x16x32_bf16 a[152:155], v[92:95], v[44:47], a[152:155]
    s_waitcnt lgkmcnt(2)
    v_exp_f32 v16, v172
    v_mfma_f32_16x16x32_bf16 a[12:15], v[64:67], v[24:27], a[12:15]
    ds_read_b128 v[40:43], v21 offset:768
    v_add_f32 v6, v6, v18
    v_mfma_f32_16x16x32_bf16 a[12:15], v[80:83], v[28:31], a[12:15]
    buffer_load_dwordx4 v8, s[4:7], s27 offen offset:1024 sc1 lds
    v_mfma_f32_16x16x32_bf16 a[60:63], v[68:71], v[24:27], a[60:63]
    ds_read_b128 v[60:63], v10 offset:768
    v_add_f32 v6, v6, v19
    v_mfma_f32_16x16x32_bf16 a[60:63], v[84:87], v[28:31], a[60:63]
    v_exp_f32 v17, v173
    v_mfma_f32_16x16x32_bf16 a[108:111], v[72:75], v[24:27], a[108:111]
    ds_read_b128 v[44:47], v21 offset:13056
    v_cvt_pk_bf16_f32 v171, v18, v19
    v_mfma_f32_16x16x32_bf16 a[108:111], v[88:91], v[28:31], a[108:111]
    v_exp_f32 v18, v174
    v_mfma_f32_16x16x32_bf16 a[156:159], v[76:79], v[24:27], a[156:159]
    s_add_u32 s29, s28, 49152
    v_add_f32 v7, v7, v16
    v_add_f32 v7, v7, v17
    v_mfma_f32_16x16x32_bf16 a[156:159], v[92:95], v[28:31], a[156:159]
    s_waitcnt lgkmcnt(3)
    v_exp_f32 v19, v175
    v_mfma_f32_16x16x32_bf16 a[16:19], v[64:67], v[32:35], a[16:19]
    ds_read_b128 v[24:27], v21 offset:1536
    v_cvt_pk_bf16_f32 v172, v16, v17
    v_mfma_f32_16x16x32_bf16 a[16:19], v[80:83], v[36:39], a[16:19]
    s_sub_u32 s3, s29, 147456
    v_exp_f32 v16, v108
    v_mfma_f32_16x16x32_bf16 a[64:67], v[68:71], v[32:35], a[64:67]
    v_cvt_f32_i32 v229, v229
    v_add_f32 v7, v7, v18
    v_mfma_f32_16x16x32_bf16 a[64:67], v[84:87], v[36:39], a[64:67]
    v_add_f32 v7, v7, v19
    v_mfma_f32_16x16x32_bf16 a[112:115], v[72:75], v[32:35], a[112:115]
    ds_read_b128 v[28:31], v21 offset:13824
    v_fma_f32 v224, v224, v48, v50
    v_mfma_f32_16x16x32_bf16 a[112:115], v[88:91], v[36:39], a[112:115]
    buffer_store_dwordx4 v[152:155], v20, s[4:7], s81 offen offset:1536 sc1
    v_mfma_f32_16x16x32_bf16 a[160:163], v[76:79], v[32:35], a[160:163]
    v_exp_f32 v17, v109
    v_mfma_f32_16x16x32_bf16 a[160:163], v[92:95], v[36:39], a[160:163]
    s_waitcnt lgkmcnt(2)
    v_cvt_pk_bf16_f32 v173, v18, v19
    v_mfma_f32_16x16x32_bf16 a[20:23], v[64:67], v[40:43], a[20:23]
    s_min_u32 s29, s29, s3
    ds_read_b128 v[32:35], v21 offset:2304
    v_mfma_f32_16x16x32_bf16 a[20:23], v[80:83], v[44:47], a[20:23]
    buffer_load_dwordx4 v8, s[4:7], s27 offen offset:2048 sc1 lds
    v_mfma_f32_16x16x32_bf16 a[68:71], v[68:71], v[40:43], a[68:71]
    v_exp_f32 v18, v110
    v_mfma_f32_16x16x32_bf16 a[68:71], v[84:87], v[44:47], a[68:71]
    s_add_u32 s27, s27, 24576
    v_add_f32 v7, v7, v16
    v_add_f32 v7, v7, v17
    v_mfma_f32_16x16x32_bf16 a[116:119], v[72:75], v[40:43], a[116:119]
    ds_read_b128 v[36:39], v21 offset:14592
    v_fma_f32 v225, v225, v49, v51
    v_mfma_f32_16x16x32_bf16 a[116:119], v[88:91], v[44:47], a[116:119]
    v_exp_f32 v19, v111
    v_mfma_f32_16x16x32_bf16 a[164:167], v[76:79], v[40:43], a[164:167]
    s_sub_u32 s3, s29, s28
    v_cvt_pk_bf16_f32 v174, v16, v17
    v_mfma_f32_16x16x32_bf16 a[164:167], v[92:95], v[44:47], a[164:167]
    s_waitcnt lgkmcnt(2)
    v_exp_f32 v16, v176
    v_mfma_f32_16x16x32_bf16 a[24:27], v[64:67], v[24:27], a[24:27]
    s_add_u32 s56, s56, 12288
    ds_read_b128 v[40:43], v22 offset:0
    v_add_f32 v7, v7, v18
    v_mfma_f32_16x16x32_bf16 a[24:27], v[80:83], v[28:31], a[24:27]
    v_add_f32 v7, v7, v19
    v_fma_f32 v228, v228, v48, v50
    v_mfma_f32_16x16x32_bf16 a[72:75], v[68:71], v[24:27], a[72:75]
    v_exp_f32 v17, v177
    v_mfma_f32_16x16x32_bf16 a[72:75], v[84:87], v[28:31], a[72:75]
    v_cvt_pk_bf16_f32 v175, v18, v19
    v_mfma_f32_16x16x32_bf16 a[120:123], v[72:75], v[24:27], a[120:123]
    ds_read_b128 v[44:47], v22 offset:12288
    v_mfma_f32_16x16x32_bf16 a[120:123], v[88:91], v[28:31], a[120:123]
    buffer_store_dwordx4 v[156:159], v20, s[4:7], s81 offen offset:2304 sc1
    v_mfma_f32_16x16x32_bf16 a[168:171], v[76:79], v[24:27], a[168:171]
    s_mov_b32 m0, s56
    v_exp_f32 v18, v178
    v_mfma_f32_16x16x32_bf16 a[168:171], v[92:95], v[28:31], a[168:171]
    s_waitcnt lgkmcnt(2)
    v_add_f32 v4, v4, v16
    v_add_f32 v4, v4, v17
    v_mfma_f32_16x16x32_bf16 a[28:31], v[64:67], v[32:35], a[28:31]
    s_mov_b32 s28, s29
    ds_read_b128 v[24:27], v22 offset:768
    v_fma_f32 v229, v229, v49, v51
    v_mfma_f32_16x16x32_bf16 a[28:31], v[80:83], v[36:39], a[28:31]
    v_exp_f32 v19, v179
    v_mfma_f32_16x16x32_bf16 a[76:79], v[68:71], v[32:35], a[76:79]
    v_cvt_pk_bf16_f32 v176, v16, v17
    v_mfma_f32_16x16x32_bf16 a[76:79], v[84:87], v[36:39], a[76:79]
    v_exp_f32 v16, v112
    v_mfma_f32_16x16x32_bf16 a[124:127], v[72:75], v[32:35], a[124:127]
    ds_read_b128 v[28:31], v22 offset:13056
    v_add_f32 v4, v4, v18
    v_mfma_f32_16x16x32_bf16 a[124:127], v[88:91], v[36:39], a[124:127]
    buffer_load_dwordx4 v8, s[4:7], s27 offen offset:0 sc1 lds
    v_mfma_f32_16x16x32_bf16 a[172:175], v[76:79], v[32:35], a[172:175]
    v_add_f32 v4, v4, v19
    v_cvt_pk_bf16_f32 v224, v224, v225
    v_mfma_f32_16x16x32_bf16 a[172:175], v[92:95], v[36:39], a[172:175]
    s_waitcnt lgkmcnt(2)
    v_exp_f32 v17, v113
    v_mfma_f32_16x16x32_bf16 a[32:35], v[64:67], v[40:43], a[32:35]
    ds_read_b128 v[32:35], v22 offset:1536
    v_cvt_pk_bf16_f32 v177, v18, v19
    v_mfma_f32_16x16x32_bf16 a[32:35], v[80:83], v[44:47], a[32:35]
    v_exp_f32 v18, v114
    v_mfma_f32_16x16x32_bf16 a[80:83], v[68:71], v[40:43], a[80:83]
    v_add_f32 v4, v4, v16
    v_add_f32 v4, v4, v17
    v_mfma_f32_16x16x32_bf16 a[80:83], v[84:87], v[44:47], a[80:83]
    v_exp_f32 v19, v115
    v_mfma_f32_16x16x32_bf16 a[128:131], v[72:75], v[40:43], a[128:131]
    ds_read_b128 v[36:39], v22 offset:13824
    v_add_u32 v2, s3, v2
    v_mfma_f32_16x16x32_bf16 a[128:131], v[88:91], v[44:47], a[128:131]
    v_cvt_pk_bf16_f32 v178, v16, v17
    v_cvt_pk_bf16_f32 v228, v228, v229
    v_mfma_f32_16x16x32_bf16 a[176:179], v[76:79], v[40:43], a[176:179]
    v_exp_f32 v16, v180
    v_mfma_f32_16x16x32_bf16 a[176:179], v[92:95], v[44:47], a[176:179]
    s_waitcnt lgkmcnt(2)
    v_add_f32 v4, v4, v18
    v_add_u32 v3, s3, v3
    v_mfma_f32_16x16x32_bf16 a[36:39], v[64:67], v[24:27], a[36:39]
    ds_read_b128 v[40:43], v22 offset:2304
    v_add_f32 v4, v4, v19
    v_mfma_f32_16x16x32_bf16 a[36:39], v[80:83], v[28:31], a[36:39]
    buffer_load_dwordx4 v8, s[4:7], s27 offen offset:1024 sc1 lds
    v_mfma_f32_16x16x32_bf16 a[84:87], v[68:71], v[24:27], a[84:87]
    v_exp_f32 v17, v181
    v_mfma_f32_16x16x32_bf16 a[84:87], v[84:87], v[28:31], a[84:87]
    v_cvt_pk_bf16_f32 v179, v18, v19
    v_cvt_f32_i32 v226, v226
    v_mfma_f32_16x16x32_bf16 a[132:135], v[72:75], v[24:27], a[132:135]
    ds_read_b128 v[44:47], v22 offset:14592
    v_cvt_f32_i32 v227, v227
    v_mfma_f32_16x16x32_bf16 a[132:135], v[88:91], v[28:31], a[132:135]
    s_waitcnt lgkmcnt(2)
    v_exp_f32 v18, v182
    v_mfma_f32_16x16x32_bf16 a[180:183], v[76:79], v[24:27], a[180:183]
    s_waitcnt vmcnt(31)
    v_add_f32 v5, v5, v16
    v_add_f32 v5, v5, v17
    v_mfma_f32_16x16x32_bf16 a[180:183], v[92:95], v[28:31], a[180:183]
    s_barrier
    v_mfma_f32_16x16x32_bf16 a[40:43], v[64:67], v[32:35], a[40:43]
    ds_read_b128 v[24:27], v2 offset:0
    v_mfma_f32_16x16x32_bf16 a[40:43], v[80:83], v[36:39], a[40:43]
    v_exp_f32 v19, v183
    v_mfma_f32_16x16x32_bf16 a[88:91], v[68:71], v[32:35], a[88:91]
    v_cvt_pk_bf16_f32 v180, v16, v17
    v_cvt_f32_i32 v230, v230
    v_mfma_f32_16x16x32_bf16 a[88:91], v[84:87], v[36:39], a[88:91]
    buffer_load_dwordx4 v8, s[4:7], s27 offen offset:2048 sc1 lds
    v_mfma_f32_16x16x32_bf16 a[136:139], v[72:75], v[32:35], a[136:139]
    ds_read_b128 v[28:31], v3 offset:0
    v_mfma_f32_16x16x32_bf16 a[136:139], v[88:91], v[36:39], a[136:139]
    v_exp_f32 v16, v116
    v_mfma_f32_16x16x32_bf16 a[184:187], v[76:79], v[32:35], a[184:187]
    v_add_f32 v5, v5, v18
    v_add_f32 v5, v5, v19
    v_mfma_f32_16x16x32_bf16 a[184:187], v[92:95], v[36:39], a[184:187]
    s_waitcnt lgkmcnt(2)
    v_exp_f32 v17, v117
    v_mfma_f32_16x16x32_bf16 a[44:47], v[64:67], v[40:43], a[44:47]
    ds_read_b128 v[32:35], v2 offset:6144
    v_cvt_pk_bf16_f32 v181, v18, v19
    v_mfma_f32_16x16x32_bf16 a[44:47], v[80:83], v[44:47], a[44:47]
    v_exp_f32 v18, v118
    v_mfma_f32_16x16x32_bf16 a[92:95], v[68:71], v[40:43], a[92:95]
    v_add_f32 v5, v5, v16
    v_add_f32 v5, v5, v17
    v_mfma_f32_16x16x32_bf16 a[92:95], v[84:87], v[44:47], a[92:95]
    v_exp_f32 v19, v119
    v_mfma_f32_16x16x32_bf16 a[140:143], v[72:75], v[40:43], a[140:143]
    ds_read_b128 v[36:39], v3 offset:6144
    v_cvt_pk_bf16_f32 v182, v16, v17
    v_mfma_f32_16x16x32_bf16 a[140:143], v[88:91], v[44:47], a[140:143]
    s_add_u32 s27, s27, 24576
    v_add_f32 v5, v5, v18
    v_cvt_f32_i32 v231, v231
    v_mfma_f32_16x16x32_bf16 a[188:191], v[76:79], v[40:43], a[188:191]
    s_add_u32 s56, s56, 36864
    v_add_f32 v5, v5, v19
    s_sub_u32 s58, s56, 147456
    v_mfma_f32_16x16x32_bf16 a[188:191], v[92:95], v[44:47], a[188:191]
    s_waitcnt lgkmcnt(2)
    v_cvt_pk_bf16_f32 v183, v18, v19
    s_min_u32 s56, s56, s58
    v_mfma_f32_16x16x32_bf16 v[64:67], v[24:27], a[192:195], v[128:131]
    ds_read_b128 v[40:43], v2 offset:128
    v_fma_f32 v226, v226, v56, v58
    v_mfma_f32_16x16x32_bf16 v[64:67], v[28:31], a[196:199], v[64:67]
    buffer_load_dwordx4 v[248:251], v9, s[64:67], s34 offen offset:384 nt
    v_mfma_f32_16x16x32_bf16 v[68:71], v[24:27], a[216:219], v[132:135]
    v_exp_f32 v16, v184
    v_mfma_f32_16x16x32_bf16 v[68:71], v[28:31], a[220:223], v[68:71]
    v_exp_f32 v17, v185
    v_mfma_f32_16x16x32_bf16 v[72:75], v[24:27], a[240:243], v[136:139]
    ds_read_b128 v[44:47], v3 offset:128
    v_fma_f32 v227, v227, v57, v59
    v_mfma_f32_16x16x32_bf16 v[72:75], v[28:31], a[244:247], v[72:75]
    v_exp_f32 v18, v186
    v_mfma_f32_16x16x32_bf16 v[76:79], v[24:27], v[200:203], v[140:143]
    v_add_f32 v6, v6, v16
    v_add_f32 v6, v6, v17
    v_mfma_f32_16x16x32_bf16 v[76:79], v[28:31], v[204:207], v[76:79]
    s_waitcnt lgkmcnt(2)
    v_exp_f32 v19, v187
    v_mfma_f32_16x16x32_bf16 v[96:99], v[32:35], a[192:195], v[128:131]
    ds_read_b128 v[24:27], v2 offset:6272
    v_cvt_pk_bf16_f32 v184, v16, v17
    v_mfma_f32_16x16x32_bf16 v[96:99], v[36:39], a[196:199], v[96:99]
    v_fma_f32 v230, v230, v56, v58
    v_mfma_f32_16x16x32_bf16 v[100:103], v[32:35], a[216:219], v[132:135]
    v_exp_f32 v16, v120
    v_mfma_f32_16x16x32_bf16 v[100:103], v[36:39], a[220:223], v[100:103]
    buffer_load_dwordx4 v[252:255], v9, s[64:67], s34 offen offset:1920 nt
    v_mfma_f32_16x16x32_bf16 v[104:107], v[32:35], a[240:243], v[136:139]
    ds_read_b128 v[28:31], v3 offset:6272
    v_add_f32 v6, v6, v18
    v_mfma_f32_16x16x32_bf16 v[104:107], v[36:39], a[244:247], v[104:107]
    v_add_f32 v6, v6, v19
    v_fma_f32 v231, v231, v57, v59
    v_mfma_f32_16x16x32_bf16 v[108:111], v[32:35], v[200:203], v[140:143]
    v_exp_f32 v17, v121
    v_mfma_f32_16x16x32_bf16 v[108:111], v[36:39], v[204:207], v[108:111]
    s_waitcnt lgkmcnt(2)
    v_cvt_pk_bf16_f32 v185, v18, v19
    v_mfma_f32_16x16x32_bf16 v[64:67], v[40:43], a[200:203], v[64:67]
    ds_read_b128 v[32:35], v2 offset:256
    v_mfma_f32_16x16x32_bf16 v[64:67], v[44:47], a[204:207], v[64:67]
    v_exp_f32 v18, v122
    v_mfma_f32_16x16x32_bf16 v[68:71], v[40:43], a[224:227], v[68:71]
    v_add_f32 v6, v6, v16
    v_add_f32 v6, v6, v17
    v_mfma_f32_16x16x32_bf16 v[68:71], v[44:47], a[228:231], v[68:71]
    v_cvt_pk_bf16_f32 v225, v226, v227
    v_mfma_f32_16x16x32_bf16 v[72:75], v[40:43], a[248:251], v[72:75]
    ds_read_b128 v[36:39], v3 offset:256
    v_mfma_f32_16x16x32_bf16 v[72:75], v[44:47], a[252:255], v[72:75]
    v_exp_f32 v19, v123
    v_mfma_f32_16x16x32_bf16 v[76:79], v[40:43], v[208:211], v[76:79]
    v_cvt_pk_bf16_f32 v186, v16, v17
    v_mfma_f32_16x16x32_bf16 v[76:79], v[44:47], v[212:215], v[76:79]
    s_waitcnt lgkmcnt(2)
    v_exp_f32 v16, v188
    v_mfma_f32_16x16x32_bf16 v[96:99], v[24:27], a[200:203], v[96:99]
    ds_read_b128 v[40:43], v2 offset:6400
    v_add_f32 v6, v6, v18
    v_mfma_f32_16x16x32_bf16 v[96:99], v[28:31], a[204:207], v[96:99]
    v_add_f32 v6, v6, v19
    v_cvt_pk_bf16_f32 v229, v230, v231
    v_mfma_f32_16x16x32_bf16 v[100:103], v[24:27], a[224:227], v[100:103]
    v_exp_f32 v17, v189
    v_mfma_f32_16x16x32_bf16 v[100:103], v[28:31], a[228:231], v[100:103]
    v_cvt_pk_bf16_f32 v187, v18, v19
    v_mfma_f32_16x16x32_bf16 v[104:107], v[24:27], a[248:251], v[104:107]
    ds_read_b128 v[44:47], v3 offset:6400
    v_mfma_f32_16x16x32_bf16 v[104:107], v[28:31], a[252:255], v[104:107]
    s_waitcnt vmcnt(11)
    v_subrev_u32 v52, s92, v52
    v_cmp_lt_u32 vcc, 15, v52
    v_mfma_f32_16x16x32_bf16 v[108:111], v[24:27], v[208:211], v[108:111]
    s_add_u32 s29, s30, 49152
    v_exp_f32 v18, v190
    v_mfma_f32_16x16x32_bf16 v[108:111], v[28:31], v[212:215], v[108:111]
    s_waitcnt lgkmcnt(2)
    v_add_f32 v7, v7, v16
    v_add_f32 v7, v7, v17
    v_mfma_f32_16x16x32_bf16 v[64:67], v[32:35], a[208:211], v[64:67]
    s_and_b32 s59, vcc_lo, 0xff
    ds_read_b128 v[24:27], v2 offset:12288
    v_mfma_f32_16x16x32_bf16 v[64:67], v[36:39], a[212:215], v[64:67]
    s_cbranch_scc1 L_pollslow4
L_pollok4:
    v_mfma_f32_16x16x32_bf16 v[68:71], v[32:35], a[232:235], v[68:71]
    s_add_u32 s92, s92, 1
    v_exp_f32 v19, v191
    v_mfma_f32_16x16x32_bf16 v[68:71], v[36:39], a[236:239], v[68:71]
    s_waitcnt vmcnt(25)
    v_cvt_pk_bf16_f32 v188, v16, v17
    s_sub_u32 s3, s29, 147456
    s_branch L_skip9
L_pad9:
    s_branch L_tb1_5
L_skip9:
    v_mfma_f32_16x16x32_bf16 v[72:75], v[32:35], v[192:195], v[72:75]
    s_mov_b32 m0, s26
    ds_read_b128 v[28:31], v3 offset:12288
    v_cvt_f32_i32 v232, v232
    v_mfma_f32_16x16x32_bf16 v[72:75], v[36:39], v[196:199], v[72:75]
    v_exp_f32 v16, v124
    v_mfma_f32_16x16x32_bf16 v[76:79], v[32:35], v[216:219], v[76:79]
    s_min_u32 s29, s29, s3
    v_add_f32 v7, v7, v18
    v_add_f32 v7, v7, v19
    v_mfma_f32_16x16x32_bf16 v[76:79], v[36:39], v[220:223], v[76:79]
    s_waitcnt lgkmcnt(2)
    buffer_load_dwordx4 v8, s[4:7], s32 offen offset:0 sc1 lds
    v_mfma_f32_16x16x32_bf16 v[96:99], v[40:43], a[208:211], v[96:99]
    ds_read_b128 v[32:35], v2 offset:18432
    v_cvt_f32_i32 v233, v233
    v_mfma_f32_16x16x32_bf16 v[96:99], v[44:47], a[212:215], v[96:99]
    v_exp_f32 v17, v125
    v_mfma_f32_16x16x32_bf16 v[100:103], v[40:43], a[232:235], v[100:103]
    v_cvt_pk_bf16_f32 v189, v18, v19
    v_mfma_f32_16x16x32_bf16 v[100:103], v[44:47], a[236:239], v[100:103]
    buffer_load_dwordx4 v8, s[4:7], s32 offen offset:1024 sc1 lds
    v_mfma_f32_16x16x32_bf16 v[104:107], v[40:43], v[192:195], v[104:107]
    s_sub_u32 s3, s29, s30
    ds_read_b128 v[36:39], v3 offset:18432
    v_mfma_f32_16x16x32_bf16 v[104:107], v[44:47], v[196:199], v[104:107]
    v_exp_f32 v18, v126
    v_mfma_f32_16x16x32_bf16 v[108:111], v[40:43], v[216:219], v[108:111]
    v_add_f32 v7, v7, v16
    v_add_f32 v7, v7, v17
    v_mfma_f32_16x16x32_bf16 v[108:111], v[44:47], v[220:223], v[108:111]
    s_waitcnt lgkmcnt(2)
    v_exp_f32 v19, v127
    v_mfma_f32_16x16x32_bf16 v[80:83], v[24:27], a[192:195], v[128:131]
    ds_read_b128 v[40:43], v2 offset:12416
    v_cvt_pk_bf16_f32 v190, v16, v17
    v_mfma_f32_16x16x32_bf16 v[80:83], v[28:31], a[196:199], v[80:83]
    buffer_load_dwordx4 v8, s[4:7], s32 offen offset:2048 sc1 lds
    v_mfma_f32_16x16x32_bf16 v[84:87], v[24:27], a[216:219], v[132:135]
    v_add_f32 v7, v7, v18
    v_add_f32 v7, v7, v19
    v_cvt_pk_bf16_f32 v191, v18, v19
    v_mfma_f32_16x16x32_bf16 v[84:87], v[28:31], a[220:223], v[84:87]
    s_mov_b32 s30, s29
    v_cvt_f32_i32 v236, v236
    v_cvt_f32_i32 v237, v237
    v_mfma_f32_16x16x32_bf16 v[88:91], v[24:27], a[240:243], v[136:139]
    s_add_u32 s32, s32, 24576
    ds_read_b128 v[44:47], v3 offset:12416
    v_mfma_f32_16x16x32_bf16 v[88:91], v[28:31], a[244:247], v[88:91]
    v_exp_f32 v16, v64
    v_mfma_f32_16x16x32_bf16 v[92:95], v[24:27], v[200:203], v[140:143]
    v_exp_f32 v17, v65
    v_mfma_f32_16x16x32_bf16 v[92:95], v[28:31], v[204:207], v[92:95]
    s_waitcnt lgkmcnt(2)
    v_exp_f32 v18, v66
    v_mfma_f32_16x16x32_bf16 v[112:115], v[32:35], a[192:195], v[128:131]
    s_add_u32 s26, s26, 12288
    ds_read_b128 v[24:27], v2 offset:18560
    v_add_f32 v4, v4, v16
    v_mfma_f32_16x16x32_bf16 v[112:115], v[36:39], a[196:199], v[112:115]
    s_mov_b32 m0, s26
    v_add_f32 v4, v4, v17
    v_fma_f32 v232, v232, v48, v50
    v_mfma_f32_16x16x32_bf16 v[116:119], v[32:35], a[216:219], v[132:135]
    v_exp_f32 v19, v67
    v_mfma_f32_16x16x32_bf16 v[116:119], v[36:39], a[220:223], v[116:119]
    v_cvt_pk_bf16_f32 v64, v16, v17
    v_add_u32 v1, s3, v1
    v_mfma_f32_16x16x32_bf16 v[120:123], v[32:35], a[240:243], v[136:139]
    ds_read_b128 v[28:31], v3 offset:18560
    v_mfma_f32_16x16x32_bf16 v[120:123], v[36:39], a[244:247], v[120:123]
    buffer_load_dwordx4 v8, s[4:7], s32 offen offset:0 sc1 lds
    v_mfma_f32_16x16x32_bf16 v[124:127], v[32:35], v[200:203], v[140:143]
    v_exp_f32 v16, v96
    v_mfma_f32_16x16x32_bf16 v[124:127], v[36:39], v[204:207], v[124:127]
    s_waitcnt lgkmcnt(2)
    v_add_f32 v4, v4, v18
    v_add_f32 v4, v4, v19
    v_mfma_f32_16x16x32_bf16 v[80:83], v[40:43], a[200:203], v[80:83]
    ds_read_b128 v[32:35], v2 offset:12544
    v_fma_f32 v233, v233, v49, v51
    v_mfma_f32_16x16x32_bf16 v[80:83], v[44:47], a[204:207], v[80:83]
    v_exp_f32 v17, v97
    v_mfma_f32_16x16x32_bf16 v[84:87], v[40:43], a[224:227], v[84:87]
    v_cvt_pk_bf16_f32 v65, v18, v19
    v_add_u32 v21, s3, v21
    v_mfma_f32_16x16x32_bf16 v[84:87], v[44:47], a[228:231], v[84:87]
    buffer_load_dwordx4 v8, s[4:7], s32 offen offset:1024 sc1 lds
    v_mfma_f32_16x16x32_bf16 v[88:91], v[40:43], a[248:251], v[88:91]
    ds_read_b128 v[36:39], v3 offset:12544
    v_fma_f32 v236, v236, v48, v50
    v_mfma_f32_16x16x32_bf16 v[88:91], v[44:47], a[252:255], v[88:91]
    v_exp_f32 v18, v98
    v_mfma_f32_16x16x32_bf16 v[92:95], v[40:43], v[208:211], v[92:95]
    v_add_f32 v4, v4, v16
    v_add_f32 v4, v4, v17
    v_mfma_f32_16x16x32_bf16 v[92:95], v[44:47], v[212:215], v[92:95]
    s_waitcnt lgkmcnt(2)
    buffer_load_dwordx4 v8, s[4:7], s32 offen offset:2048 sc1 lds
    v_mfma_f32_16x16x32_bf16 v[112:115], v[24:27], a[200:203], v[112:115]
    ds_read_b128 v[40:43], v2 offset:18688
    v_add_u32 v22, s3, v22
    v_mfma_f32_16x16x32_bf16 v[112:115], v[28:31], a[204:207], v[112:115]
    v_exp_f32 v19, v99
    v_mfma_f32_16x16x32_bf16 v[116:119], v[24:27], a[224:227], v[116:119]
    v_cvt_pk_bf16_f32 v66, v16, v17
    v_fma_f32 v237, v237, v49, v51
    v_mfma_f32_16x16x32_bf16 v[116:119], v[28:31], a[228:231], v[116:119]
    v_exp_f32 v16, v68
    v_mfma_f32_16x16x32_bf16 v[120:123], v[24:27], a[248:251], v[120:123]
    ds_read_b128 v[44:47], v3 offset:18688
    v_add_f32 v4, v4, v18
    v_mfma_f32_16x16x32_bf16 v[120:123], v[28:31], a[252:255], v[120:123]
    s_waitcnt lgkmcnt(2)
    v_add_f32 v4, v4, v19
    s_add_u32 s32, s32, 24576
    v_mfma_f32_16x16x32_bf16 v[124:127], v[24:27], v[208:211], v[124:127]
    s_waitcnt vmcnt(11)
    v_exp_f32 v17, v69
    v_mfma_f32_16x16x32_bf16 v[124:127], v[28:31], v[212:215], v[124:127]
    s_barrier
    v_cvt_pk_bf16_f32 v67, v18, v19
    v_mfma_f32_16x16x32_bf16 v[80:83], v[32:35], a[208:211], v[80:83]
    s_add_u32 s26, s26, 36864
    ds_read_b128 v[24:27], v1 offset:0
    v_add_u32 v55, 1, v55
    v_mfma_f32_16x16x32_bf16 v[80:83], v[36:39], a[212:215], v[80:83]
    s_sub_u32 s57, s26, 147456
    v_exp_f32 v18, v70
    v_mfma_f32_16x16x32_bf16 v[84:87], v[32:35], a[232:235], v[84:87]
    v_add_f32 v5, v5, v16
    v_add_f32 v5, v5, v17
    v_mfma_f32_16x16x32_bf16 v[84:87], v[36:39], a[236:239], v[84:87]
    v_exp_f32 v19, v71
    v_mfma_f32_16x16x32_bf16 v[88:91], v[32:35], v[192:195], v[88:91]
    s_min_u32 s26, s26, s57
    ds_read_b128 v[28:31], v1 offset:12288
    v_cvt_pk_bf16_f32 v68, v16, v17
    v_mfma_f32_16x16x32_bf16 v[88:91], v[36:39], v[196:199], v[88:91]
    buffer_store_dword v55, v13, s[20:23], 0 offen sc1
    v_mfma_f32_16x16x32_bf16 v[92:95], v[32:35], v[216:219], v[92:95]
    v_exp_f32 v16, v100
    v_mfma_f32_16x16x32_bf16 v[92:95], v[36:39], v[220:223], v[92:95]
    s_waitcnt lgkmcnt(2)
    v_add_f32 v5, v5, v18
    v_add_f32 v5, v5, v19
    v_mfma_f32_16x16x32_bf16 v[112:115], v[40:43], a[208:211], v[112:115]
    ds_read_b128 v[32:35], v1 offset:768
    v_cvt_pk_bf16_f32 v232, v232, v233
    v_mfma_f32_16x16x32_bf16 v[112:115], v[44:47], a[212:215], v[112:115]
    v_exp_f32 v17, v101
    v_mfma_f32_16x16x32_bf16 v[116:119], v[40:43], a[232:235], v[116:119]
    v_cvt_pk_bf16_f32 v69, v18, v19
    v_cvt_pk_bf16_f32 v236, v236, v237
    v_mfma_f32_16x16x32_bf16 v[116:119], v[44:47], a[236:239], v[116:119]
    v_exp_f32 v18, v102
    v_mfma_f32_16x16x32_bf16 v[120:123], v[40:43], v[192:195], v[120:123]
    ds_read_b128 v[36:39], v1 offset:13056
    v_add_f32 v5, v5, v16
    v_mfma_f32_16x16x32_bf16 v[120:123], v[44:47], v[196:199], v[120:123]
    v_add_f32 v5, v5, v17
    v_cvt_f32_i32 v234, v234
    v_mfma_f32_16x16x32_bf16 v[124:127], v[40:43], v[216:219], v[124:127]
    v_exp_f32 v19, v103
    v_mfma_f32_16x16x32_bf16 v[124:127], v[44:47], v[220:223], v[124:127]
    s_waitcnt lgkmcnt(2)
    v_cvt_pk_bf16_f32 v70, v16, v17
    v_add_f32 v5, v5, v18
    v_add_f32 v5, v5, v19
    v_cvt_pk_bf16_f32 v71, v18, v19
    v_mfma_f32_16x16x32_bf16 a[0:3], v[160:163], v[24:27], a[0:3]
    ds_read_b128 v[40:43], v1 offset:1536
    s_add_u32 s35, s35, 196608
    v_mfma_f32_16x16x32_bf16 a[0:3], v[176:179], v[28:31], a[0:3]
    s_mov_b32 m0, s56
    v_exp_f32 v16, v72
    v_mfma_f32_16x16x32_bf16 a[48:51], v[164:167], v[24:27], a[48:51]
    s_sub_u32 s36, s35, 1572864
    v_exp_f32 v17, v73
    v_mfma_f32_16x16x32_bf16 a[48:51], v[180:183], v[28:31], a[48:51]
    v_cvt_f32_i32 v235, v235
    v_cvt_f32_i32 v238, v238
    v_mfma_f32_16x16x32_bf16 a[96:99], v[168:171], v[24:27], a[96:99]
    ds_read_b128 v[44:47], v1 offset:13824
    v_mfma_f32_16x16x32_bf16 a[96:99], v[184:187], v[28:31], a[96:99]
    s_min_u32 s35, s35, s36
    buffer_load_dwordx4 v8, s[4:7], s27 offen offset:0 sc1 lds
    v_mfma_f32_16x16x32_bf16 a[144:147], v[172:175], v[24:27], a[144:147]
    v_exp_f32 v18, v74
    v_mfma_f32_16x16x32_bf16 a[144:147], v[188:191], v[28:31], a[144:147]
    s_waitcnt lgkmcnt(2)
    v_add_f32 v6, v6, v16
    v_add_f32 v6, v6, v17
    v_mfma_f32_16x16x32_bf16 a[4:7], v[160:163], v[32:35], a[4:7]
    s_add_u32 s36, s35, 3072
    ds_read_b128 v[24:27], v1 offset:2304
    v_cvt_f32_i32 v239, v239
    v_mfma_f32_16x16x32_bf16 a[4:7], v[176:179], v[36:39], a[4:7]
    v_exp_f32 v19, v75
    v_mfma_f32_16x16x32_bf16 a[52:55], v[164:167], v[32:35], a[52:55]
    v_cvt_pk_bf16_f32 v72, v16, v17
    v_mfma_f32_16x16x32_bf16 a[52:55], v[180:183], v[36:39], a[52:55]
    v_exp_f32 v16, v104
    v_mfma_f32_16x16x32_bf16 a[100:103], v[168:171], v[32:35], a[100:103]
    s_add_u32 s81, s81, 196608
    ds_read_b128 v[28:31], v1 offset:14592
    v_add_f32 v6, v6, v18
    v_mfma_f32_16x16x32_bf16 a[100:103], v[184:187], v[36:39], a[100:103]
    v_add_f32 v6, v6, v19
    v_fma_f32 v234, v234, v56, v58
    v_mfma_f32_16x16x32_bf16 a[148:151], v[172:175], v[32:35], a[148:151]
    v_exp_f32 v17, v105
    v_mfma_f32_16x16x32_bf16 a[148:151], v[188:191], v[36:39], a[148:151]
    s_waitcnt lgkmcnt(2)
    buffer_load_dwordx4 v8, s[4:7], s27 offen offset:1024 sc1 lds
    v_mfma_f32_16x16x32_bf16 a[8:11], v[160:163], v[40:43], a[8:11]
    ds_read_b128 v[32:35], v21 offset:0
    v_cvt_pk_bf16_f32 v73, v18, v19
    v_mfma_f32_16x16x32_bf16 a[8:11], v[176:179], v[44:47], a[8:11]
    v_exp_f32 v18, v106
    v_mfma_f32_16x16x32_bf16 a[56:59], v[164:167], v[40:43], a[56:59]
    v_add_f32 v6, v6, v16
    v_add_f32 v6, v6, v17
    v_mfma_f32_16x16x32_bf16 a[56:59], v[180:183], v[44:47], a[56:59]
    buffer_load_dwordx4 v[144:147], v12, s[68:71], s35 offen offset:0 nt
    v_mfma_f32_16x16x32_bf16 a[104:107], v[168:171], v[40:43], a[104:107]
    ds_read_b128 v[36:39], v21 offset:12288
    v_fma_f32 v235, v235, v57, v59
    v_mfma_f32_16x16x32_bf16 a[104:107], v[184:187], v[44:47], a[104:107]
    v_exp_f32 v19, v107
    v_mfma_f32_16x16x32_bf16 a[152:155], v[172:175], v[40:43], a[152:155]
    v_cvt_pk_bf16_f32 v74, v16, v17
    v_fma_f32 v238, v238, v56, v58
    v_mfma_f32_16x16x32_bf16 a[152:155], v[188:191], v[44:47], a[152:155]
    s_waitcnt lgkmcnt(2)
    buffer_load_dwordx4 v8, s[4:7], s27 offen offset:2048 sc1 lds
    v_mfma_f32_16x16x32_bf16 a[12:15], v[160:163], v[24:27], a[12:15]
    ds_read_b128 v[40:43], v21 offset:768
    v_mfma_f32_16x16x32_bf16 a[12:15], v[176:179], v[28:31], a[12:15]
    v_exp_f32 v16, v76
    v_mfma_f32_16x16x32_bf16 a[60:63], v[164:167], v[24:27], a[60:63]
    v_add_f32 v6, v6, v18
    v_add_f32 v6, v6, v19
    v_mfma_f32_16x16x32_bf16 a[60:63], v[180:183], v[28:31], a[60:63]
    buffer_load_dwordx4 v[148:151], v12, s[68:71], s35 offen offset:768 nt
    v_mfma_f32_16x16x32_bf16 a[108:111], v[168:171], v[24:27], a[108:111]
    ds_read_b128 v[44:47], v21 offset:13056
    v_fma_f32 v239, v239, v57, v59
    v_mfma_f32_16x16x32_bf16 a[108:111], v[184:187], v[28:31], a[108:111]
    v_exp_f32 v17, v77
    v_mfma_f32_16x16x32_bf16 a[156:159], v[172:175], v[24:27], a[156:159]
    s_add_u32 s29, s28, 49152
    v_cvt_pk_bf16_f32 v75, v18, v19
    s_add_u32 s27, s27, 24576
    v_mfma_f32_16x16x32_bf16 a[156:159], v[188:191], v[28:31], a[156:159]
    s_waitcnt lgkmcnt(2)
    buffer_load_dwordx4 v[152:155], v12, s[68:71], s35 offen offset:1536 nt
    v_mfma_f32_16x16x32_bf16 a[16:19], v[160:163], v[32:35], a[16:19]
    ds_read_b128 v[24:27], v21 offset:1536
    v_cvt_pk_bf16_f32 v233, v234, v235
    v_mfma_f32_16x16x32_bf16 a[16:19], v[176:179], v[36:39], a[16:19]
    s_sub_u32 s3, s29, 147456
    v_exp_f32 v18, v78
    v_mfma_f32_16x16x32_bf16 a[64:67], v[164:167], v[32:35], a[64:67]
    v_add_f32 v7, v7, v16
    v_add_f32 v7, v7, v17
    v_mfma_f32_16x16x32_bf16 a[64:67], v[180:183], v[36:39], a[64:67]
    s_add_u32 s56, s56, 12288
    v_exp_f32 v19, v79
    v_mfma_f32_16x16x32_bf16 a[112:115], v[168:171], v[32:35], a[112:115]
    ds_read_b128 v[28:31], v21 offset:13824
    v_cvt_pk_bf16_f32 v76, v16, v17
    v_mfma_f32_16x16x32_bf16 a[112:115], v[184:187], v[36:39], a[112:115]
    v_exp_f32 v16, v108
    v_mfma_f32_16x16x32_bf16 a[160:163], v[172:175], v[32:35], a[160:163]
    v_add_f32 v7, v7, v18
    v_add_f32 v7, v7, v19
    v_mfma_f32_16x16x32_bf16 a[160:163], v[188:191], v[36:39], a[160:163]
    s_waitcnt lgkmcnt(2)
    buffer_load_dwordx4 v[156:159], v12, s[68:71], s35 offen offset:2304 nt
    v_mfma_f32_16x16x32_bf16 a[20:23], v[160:163], v[40:43], a[20:23]
    s_mov_b32 m0, s56
    ds_read_b128 v[32:35], v21 offset:2304
    v_cvt_pk_bf16_f32 v237, v238, v239
    v_mfma_f32_16x16x32_bf16 a[20:23], v[176:179], v[44:47], a[20:23]
    s_min_u32 s29, s29, s3
    v_exp_f32 v17, v109
    v_mfma_f32_16x16x32_bf16 a[68:71], v[164:167], v[40:43], a[68:71]
    ds_read_b128 v[48:51], v10 offset:1152
    v_cvt_pk_bf16_f32 v77, v18, v19
    v_mfma_f32_16x16x32_bf16 a[68:71], v[180:183], v[44:47], a[68:71]
    v_exp_f32 v18, v110
    v_mfma_f32_16x16x32_bf16 a[116:119], v[168:171], v[40:43], a[116:119]
    ds_read_b128 v[36:39], v21 offset:14592
    v_add_f32 v7, v7, v16
    v_mfma_f32_16x16x32_bf16 a[116:119], v[184:187], v[44:47], a[116:119]
    s_waitcnt vmcnt(27)
    v_add_f32 v7, v7, v17
    v_mfma_f32_16x16x32_bf16 a[164:167], v[172:175], v[40:43], a[164:167]
    s_sub_u32 s3, s29, s28
    v_exp_f32 v19, v111
    v_mfma_f32_16x16x32_bf16 a[164:167], v[188:191], v[44:47], a[164:167]
    s_waitcnt lgkmcnt(3)
    buffer_load_dwordx4 v8, s[4:7], s27 offen offset:0 sc1 lds
    v_mfma_f32_16x16x32_bf16 a[24:27], v[160:163], v[24:27], a[24:27]
    ds_read_b128 v[40:43], v22 offset:0
    v_cvt_pk_bf16_f32 v78, v16, v17
    v_mfma_f32_16x16x32_bf16 a[24:27], v[176:179], v[28:31], a[24:27]
    v_exp_f32 v16, v80
    v_mfma_f32_16x16x32_bf16 a[72:75], v[164:167], v[24:27], a[72:75]
    v_add_f32 v7, v7, v18
    v_add_f32 v7, v7, v19
    v_mfma_f32_16x16x32_bf16 a[72:75], v[180:183], v[28:31], a[72:75]
    v_exp_f32 v17, v81
    v_mfma_f32_16x16x32_bf16 a[120:123], v[168:171], v[24:27], a[120:123]
    ds_read_b128 v[44:47], v22 offset:12288
    v_cvt_pk_bf16_f32 v79, v18, v19
    v_mfma_f32_16x16x32_bf16 a[120:123], v[184:187], v[28:31], a[120:123]
    s_mov_b32 s28, s29
    v_exp_f32 v18, v82
    v_mfma_f32_16x16x32_bf16 a[168:171], v[172:175], v[24:27], a[168:171]
    v_add_f32 v4, v4, v16
    v_add_f32 v4, v4, v17
    v_mfma_f32_16x16x32_bf16 a[168:171], v[188:191], v[28:31], a[168:171]
    s_waitcnt lgkmcnt(2)
    v_exp_f32 v19, v83
    v_mfma_f32_16x16x32_bf16 a[28:31], v[160:163], v[32:35], a[28:31]
    ds_read_b128 v[24:27], v22 offset:768
    v_cvt_f32_i32 v240, v240
    v_mfma_f32_16x16x32_bf16 a[28:31], v[176:179], v[36:39], a[28:31]
    buffer_load_dwordx4 v8, s[4:7], s27 offen offset:1024 sc1 lds
    v_mfma_f32_16x16x32_bf16 a[76:79], v[164:167], v[32:35], a[76:79]
    v_cvt_pk_bf16_f32 v80, v16, v17
    v_cvt_f32_i32 v241, v241
    v_mfma_f32_16x16x32_bf16 a[76:79], v[180:183], v[36:39], a[76:79]
    v_exp_f32 v16, v112
    v_mfma_f32_16x16x32_bf16 a[124:127], v[168:171], v[32:35], a[124:127]
    ds_read_b128 v[28:31], v22 offset:13056
    v_add_f32 v4, v4, v18
    v_mfma_f32_16x16x32_bf16 a[124:127], v[184:187], v[36:39], a[124:127]
    v_add_f32 v4, v4, v19
    v_cvt_f32_i32 v244, v244
    v_mfma_f32_16x16x32_bf16 a[172:175], v[172:175], v[32:35], a[172:175]
    v_exp_f32 v17, v113
    v_mfma_f32_16x16x32_bf16 a[172:175], v[188:191], v[36:39], a[172:175]
    s_waitcnt lgkmcnt(2)
    v_cvt_pk_bf16_f32 v81, v18, v19
    v_add_u32 v2, s3, v2
    v_mfma_f32_16x16x32_bf16 a[32:35], v[160:163], v[40:43], a[32:35]
    ds_read_b128 v[32:35], v22 offset:1536
    v_mfma_f32_16x16x32_bf16 a[32:35], v[176:179], v[44:47], a[32:35]
    buffer_load_dwordx4 v8, s[4:7], s27 offen offset:2048 sc1 lds
    v_mfma_f32_16x16x32_bf16 a[80:83], v[164:167], v[40:43], a[80:83]
    v_exp_f32 v18, v114
    v_mfma_f32_16x16x32_bf16 a[80:83], v[180:183], v[44:47], a[80:83]
    v_add_f32 v4, v4, v16
    v_add_f32 v4, v4, v17
    v_mfma_f32_16x16x32_bf16 a[128:131], v[168:171], v[40:43], a[128:131]
    ds_read_b128 v[36:39], v22 offset:13824
    v_add_u32 v3, s3, v3
    v_mfma_f32_16x16x32_bf16 a[128:131], v[184:187], v[44:47], a[128:131]
    v_exp_f32 v19, v115
    v_mfma_f32_16x16x32_bf16 a[176:179], v[172:175], v[40:43], a[176:179]
    ds_read_b128 v[56:59], v23 offset:0
    v_cvt_pk_bf16_f32 v82, v16, v17
    v_mfma_f32_16x16x32_bf16 a[176:179], v[188:191], v[44:47], a[176:179]
    s_waitcnt lgkmcnt(3)
    v_exp_f32 v16, v84
    v_mfma_f32_16x16x32_bf16 a[36:39], v[160:163], v[24:27], a[36:39]
    ds_read_b128 v[40:43], v22 offset:2304
    v_add_f32 v4, v4, v18
    v_mfma_f32_16x16x32_bf16 a[36:39], v[176:179], v[28:31], a[36:39]
    v_add_f32 v4, v4, v19
    v_add_u32 v10, 1792, v10
    v_mfma_f32_16x16x32_bf16 a[84:87], v[164:167], v[24:27], a[84:87]
    v_exp_f32 v17, v85
    v_mfma_f32_16x16x32_bf16 a[84:87], v[180:183], v[28:31], a[84:87]
    s_add_u32 s27, s27, 24576
    v_cvt_pk_bf16_f32 v83, v18, v19
    v_cvt_f32_i32 v245, v245
    v_mfma_f32_16x16x32_bf16 a[132:135], v[168:171], v[24:27], a[132:135]
    s_add_u32 s56, s56, 36864
    ds_read_b128 v[44:47], v22 offset:14592
    v_mfma_f32_16x16x32_bf16 a[132:135], v[184:187], v[28:31], a[132:135]
    s_waitcnt lgkmcnt(3)
    v_exp_f32 v18, v86
    v_mfma_f32_16x16x32_bf16 a[180:183], v[172:175], v[24:27], a[180:183]
    s_waitcnt vmcnt(32)
    v_add_f32 v5, v5, v16
    v_add_f32 v5, v5, v17
    v_mfma_f32_16x16x32_bf16 a[180:183], v[188:191], v[28:31], a[180:183]
    s_barrier
    v_fma_f32 v240, v240, v60, v62
    v_mfma_f32_16x16x32_bf16 a[40:43], v[160:163], v[32:35], a[40:43]
    s_sub_u32 s58, s56, 147456
    ds_read_b128 v[24:27], v2 offset:0
    v_mfma_f32_16x16x32_bf16 a[40:43], v[176:179], v[36:39], a[40:43]
    v_exp_f32 v19, v87
    v_mfma_f32_16x16x32_bf16 a[88:91], v[164:167], v[32:35], a[88:91]
    s_min_u32 s56, s56, s58
    v_cvt_pk_bf16_f32 v84, v16, v17
    v_mfma_f32_16x16x32_bf16 a[88:91], v[180:183], v[36:39], a[88:91]
    v_exp_f32 v16, v116
    v_mfma_f32_16x16x32_bf16 a[136:139], v[168:171], v[32:35], a[136:139]
    ds_read_b128 v[28:31], v3 offset:0
    v_add_f32 v5, v5, v18
    v_mfma_f32_16x16x32_bf16 a[136:139], v[184:187], v[36:39], a[136:139]
    v_add_f32 v5, v5, v19
    v_fma_f32 v241, v241, v61, v63
    v_mfma_f32_16x16x32_bf16 a[184:187], v[172:175], v[32:35], a[184:187]
    v_exp_f32 v17, v117
    v_mfma_f32_16x16x32_bf16 a[184:187], v[188:191], v[36:39], a[184:187]
    s_waitcnt lgkmcnt(2)
    v_cvt_pk_bf16_f32 v85, v18, v19
    v_mfma_f32_16x16x32_bf16 a[44:47], v[160:163], v[40:43], a[44:47]
    ds_read_b128 v[32:35], v2 offset:6144
    v_fma_f32 v244, v244, v60, v62
    v_mfma_f32_16x16x32_bf16 a[44:47], v[176:179], v[44:47], a[44:47]
    v_exp_f32 v18, v118
    v_mfma_f32_16x16x32_bf16 a[92:95], v[164:167], v[40:43], a[92:95]
    v_add_f32 v5, v5, v16
    v_add_f32 v5, v5, v17
    v_mfma_f32_16x16x32_bf16 a[92:95], v[180:183], v[44:47], a[92:95]
    v_exp_f32 v19, v119
    v_mfma_f32_16x16x32_bf16 a[140:143], v[168:171], v[40:43], a[140:143]
    ds_read_b128 v[36:39], v3 offset:6144
    v_cvt_pk_bf16_f32 v86, v16, v17
    v_mfma_f32_16x16x32_bf16 a[140:143], v[184:187], v[44:47], a[140:143]
    v_add_f32 v5, v5, v18
    v_add_f32 v5, v5, v19
    v_mfma_f32_16x16x32_bf16 a[188:191], v[172:175], v[40:43], a[188:191]
    v_cvt_pk_bf16_f32 v87, v18, v19
    v_mfma_f32_16x16x32_bf16 a[188:191], v[188:191], v[44:47], a[188:191]
    s_waitcnt lgkmcnt(2)
    v_mfma_f32_16x16x32_bf16 v[160:163], v[24:27], a[192:195], v[128:131]
    s_mov_b32 m0, s26
    ds_read_b128 v[40:43], v2 offset:128
    v_fma_f32 v245, v245, v61, v63
    v_mfma_f32_16x16x32_bf16 v[160:163], v[28:31], a[196:199], v[160:163]
    v_exp_f32 v16, v88
    v_mfma_f32_16x16x32_bf16 v[164:167], v[24:27], a[216:219], v[132:135]
    v_exp_f32 v17, v89
    v_mfma_f32_16x16x32_bf16 v[164:167], v[28:31], a[220:223], v[164:167]
    v_bfe_u32 v53, v8, 4, 6
    v_cvt_pk_bf16_f32 v226, v240, v241
    v_mfma_f32_16x16x32_bf16 v[168:171], v[24:27], a[240:243], v[136:139]
    ds_read_b128 v[44:47], v3 offset:128
    v_lshlrev_b32 v53, 2, v53
    v_mfma_f32_16x16x32_bf16 v[168:171], v[28:31], a[244:247], v[168:171]
    buffer_load_dwordx4 v8, s[4:7], s32 offen offset:0 sc1 lds
    v_mfma_f32_16x16x32_bf16 v[172:175], v[24:27], v[200:203], v[140:143]
    v_exp_f32 v18, v90
    v_mfma_f32_16x16x32_bf16 v[172:175], v[28:31], v[204:207], v[172:175]
    s_waitcnt lgkmcnt(2)
    v_add_f32 v6, v6, v16
    v_add_f32 v6, v6, v17
    v_mfma_f32_16x16x32_bf16 v[96:99], v[32:35], a[192:195], v[128:131]
    ds_read_b128 v[24:27], v2 offset:6272
    v_cvt_pk_bf16_f32 v230, v244, v245
    v_mfma_f32_16x16x32_bf16 v[96:99], v[36:39], a[196:199], v[96:99]
    buffer_load_dword v52, v53, s[20:23], 0 offen sc1
    v_mfma_f32_16x16x32_bf16 v[100:103], v[32:35], a[216:219], v[132:135]
    v_exp_f32 v19, v91
    v_mfma_f32_16x16x32_bf16 v[100:103], v[36:39], a[220:223], v[100:103]
    v_cvt_pk_bf16_f32 v88, v16, v17
    v_mfma_f32_16x16x32_bf16 v[104:107], v[32:35], a[240:243], v[136:139]
    ds_read_b128 v[28:31], v3 offset:6272
    v_mfma_f32_16x16x32_bf16 v[104:107], v[36:39], a[244:247], v[104:107]
    v_exp_f32 v16, v120
    v_mfma_f32_16x16x32_bf16 v[108:111], v[32:35], v[200:203], v[140:143]
    v_add_f32 v6, v6, v18
    v_add_f32 v6, v6, v19
    v_mfma_f32_16x16x32_bf16 v[108:111], v[36:39], v[204:207], v[108:111]
    s_waitcnt lgkmcnt(2)
    buffer_load_dwordx4 v8, s[4:7], s32 offen offset:1024 sc1 lds
    v_mfma_f32_16x16x32_bf16 v[160:163], v[40:43], a[200:203], v[160:163]
    ds_read_b128 v[32:35], v2 offset:256
    v_cvt_f32_i32 v242, v242
    v_mfma_f32_16x16x32_bf16 v[160:163], v[44:47], a[204:207], v[160:163]
    v_exp_f32 v17, v121
    v_mfma_f32_16x16x32_bf16 v[164:167], v[40:43], a[224:227], v[164:167]
    v_cvt_pk_bf16_f32 v89, v18, v19
    v_cvt_f32_i32 v243, v243
    v_mfma_f32_16x16x32_bf16 v[164:167], v[44:47], a[228:231], v[164:167]
    v_exp_f32 v18, v122
    v_mfma_f32_16x16x32_bf16 v[168:171], v[40:43], a[248:251], v[168:171]
    ds_read_b128 v[36:39], v3 offset:256
    v_add_f32 v6, v6, v16
    v_mfma_f32_16x16x32_bf16 v[168:171], v[44:47], a[252:255], v[168:171]
    v_add_f32 v6, v6, v17
    v_mfma_f32_16x16x32_bf16 v[172:175], v[40:43], v[208:211], v[172:175]
    v_exp_f32 v19, v123
    v_mfma_f32_16x16x32_bf16 v[172:175], v[44:47], v[212:215], v[172:175]
    s_waitcnt lgkmcnt(2)
    buffer_load_dwordx4 v8, s[4:7], s32 offen offset:2048 sc1 lds
    v_mfma_f32_16x16x32_bf16 v[96:99], v[24:27], a[200:203], v[96:99]
    ds_read_b128 v[40:43], v2 offset:6400
    v_cvt_pk_bf16_f32 v90, v16, v17
    v_mfma_f32_16x16x32_bf16 v[96:99], v[28:31], a[204:207], v[96:99]
    v_exp_f32 v16, v92
    v_mfma_f32_16x16x32_bf16 v[100:103], v[24:27], a[224:227], v[100:103]
    v_add_f32 v6, v6, v18
    v_add_f32 v6, v6, v19
    v_mfma_f32_16x16x32_bf16 v[100:103], v[28:31], a[228:231], v[100:103]
    v_exp_f32 v17, v93
    v_mfma_f32_16x16x32_bf16 v[104:107], v[24:27], a[248:251], v[104:107]
    ds_read_b128 v[44:47], v3 offset:6400
    v_cvt_pk_bf16_f32 v91, v18, v19
    v_mfma_f32_16x16x32_bf16 v[104:107], v[28:31], a[252:255], v[104:107]
    v_exp_f32 v18, v94
    v_mfma_f32_16x16x32_bf16 v[108:111], v[24:27], v[208:211], v[108:111]
    s_add_u32 s29, s30, 49152
    v_cvt_f32_i32 v246, v246
    v_add_f32 v7, v7, v16
    v_mfma_f32_16x16x32_bf16 v[108:111], v[28:31], v[212:215], v[108:111]
    s_waitcnt lgkmcnt(2)
    v_add_f32 v7, v7, v17
    v_cvt_f32_i32 v247, v247
    v_mfma_f32_16x16x32_bf16 v[160:163], v[32:35], a[208:211], v[160:163]
    s_add_u32 s32, s32, 24576
    ds_read_b128 v[24:27], v2 offset:12288
    s_sub_u32 s3, s29, 147456
    v_mfma_f32_16x16x32_bf16 v[160:163], v[36:39], a[212:215], v[160:163]
    v_exp_f32 v19, v95
    v_mfma_f32_16x16x32_bf16 v[164:167], v[32:35], a[232:235], v[164:167]
    v_cvt_pk_bf16_f32 v92, v16, v17
    v_fma_f32 v242, v242, v48, v50
    v_mfma_f32_16x16x32_bf16 v[164:167], v[36:39], a[236:239], v[164:167]
    s_add_u32 s26, s26, 12288
    v_exp_f32 v16, v124
    v_mfma_f32_16x16x32_bf16 v[168:171], v[32:35], v[192:195], v[168:171]
    ds_read_b128 v[28:31], v3 offset:12288
    v_add_f32 v7, v7, v18
    v_mfma_f32_16x16x32_bf16 v[168:171], v[36:39], v[196:199], v[168:171]
    v_add_f32 v7, v7, v19
    v_mfma_f32_16x16x32_bf16 v[172:175], v[32:35], v[216:219], v[172:175]
    s_min_u32 s29, s29, s3
    v_mfma_f32_16x16x32_bf16 v[172:175], v[36:39], v[220:223], v[172:175]
    s_waitcnt lgkmcnt(2)
    v_exp_f32 v17, v125
    v_mfma_f32_16x16x32_bf16 v[96:99], v[40:43], a[208:211], v[96:99]
    s_mov_b32 m0, s26
    ds_read_b128 v[32:35], v2 offset:18432
    v_cvt_pk_bf16_f32 v93, v18, v19
    v_mfma_f32_16x16x32_bf16 v[96:99], v[44:47], a[212:215], v[96:99]
    v_exp_f32 v18, v126
    v_mfma_f32_16x16x32_bf16 v[100:103], v[40:43], a[232:235], v[100:103]
    v_fma_f32 v243, v243, v49, v51
    v_mfma_f32_16x16x32_bf16 v[100:103], v[44:47], a[236:239], v[100:103]
    v_add_f32 v7, v7, v16
    v_mfma_f32_16x16x32_bf16 v[104:107], v[40:43], v[192:195], v[104:107]
    s_sub_u32 s3, s29, s30
    ds_read_b128 v[36:39], v3 offset:18432
    v_add_f32 v7, v7, v17
    v_mfma_f32_16x16x32_bf16 v[104:107], v[44:47], v[196:199], v[104:107]
    v_exp_f32 v19, v127
    v_mfma_f32_16x16x32_bf16 v[108:111], v[40:43], v[216:219], v[108:111]
    v_fma_f32 v246, v246, v48, v50
    v_cvt_pk_bf16_f32 v94, v16, v17
    v_mfma_f32_16x16x32_bf16 v[108:111], v[44:47], v[220:223], v[108:111]
    s_waitcnt lgkmcnt(2)
    buffer_load_dwordx4 v8, s[4:7], s32 offen offset:0 sc1 lds
    v_mfma_f32_16x16x32_bf16 v[176:179], v[24:27], a[192:195], v[128:131]
    ds_read_b128 v[40:43], v2 offset:12416
    v_add_f32 v7, v7, v18
    v_mfma_f32_16x16x32_bf16 v[176:179], v[28:31], a[196:199], v[176:179]
    v_add_f32 v7, v7, v19
    v_cvt_pk_bf16_f32 v95, v18, v19
    v_mfma_f32_16x16x32_bf16 v[180:183], v[24:27], a[216:219], v[132:135]
    s_mov_b32 s30, s29
    v_fma_f32 v247, v247, v49, v51
    v_mfma_f32_16x16x32_bf16 v[180:183], v[28:31], a[220:223], v[180:183]
    v_mfma_f32_16x16x32_bf16 v[184:187], v[24:27], a[240:243], v[136:139]
    ds_read_b128 v[44:47], v3 offset:12416
    v_mfma_f32_16x16x32_bf16 v[184:187], v[28:31], a[244:247], v[184:187]
    v_exp_f32 v16, v160
    v_mfma_f32_16x16x32_bf16 v[188:191], v[24:27], v[200:203], v[140:143]
    v_exp_f32 v17, v161
    v_mfma_f32_16x16x32_bf16 v[188:191], v[28:31], v[204:207], v[188:191]
    s_waitcnt lgkmcnt(2)
    v_exp_f32 v18, v162
    v_mfma_f32_16x16x32_bf16 v[112:115], v[32:35], a[192:195], v[128:131]
    ds_read_b128 v[24:27], v2 offset:18560
    v_add_f32 v4, v4, v16
    v_mfma_f32_16x16x32_bf16 v[112:115], v[36:39], a[196:199], v[112:115]
    buffer_load_dwordx4 v8, s[4:7], s32 offen offset:1024 sc1 lds
    v_mfma_f32_16x16x32_bf16 v[116:119], v[32:35], a[216:219], v[132:135]
    v_add_f32 v4, v4, v17
    v_cvt_pk_bf16_f32 v227, v242, v243
    v_mfma_f32_16x16x32_bf16 v[116:119], v[36:39], a[220:223], v[116:119]
    v_exp_f32 v19, v163
    v_mfma_f32_16x16x32_bf16 v[120:123], v[32:35], a[240:243], v[136:139]
    ds_read_b128 v[28:31], v3 offset:18560
    v_cvt_pk_bf16_f32 v160, v16, v17
    v_mfma_f32_16x16x32_bf16 v[120:123], v[36:39], a[244:247], v[120:123]
    buffer_load_dword v0, v8, s[88:91], s93 offen
    v_mfma_f32_16x16x32_bf16 v[124:127], v[32:35], v[200:203], v[140:143]
    v_exp_f32 v16, v96
    v_mfma_f32_16x16x32_bf16 v[124:127], v[36:39], v[204:207], v[124:127]
    s_waitcnt lgkmcnt(2)
    v_add_f32 v4, v4, v18
    v_add_f32 v4, v4, v19
    v_mfma_f32_16x16x32_bf16 v[176:179], v[40:43], a[200:203], v[176:179]
    ds_read_b128 v[32:35], v2 offset:12544
    v_add_u32 v1, s3, v1
    v_mfma_f32_16x16x32_bf16 v[176:179], v[44:47], a[204:207], v[176:179]
    buffer_load_dwordx4 v8, s[4:7], s32 offen offset:2048 sc1 lds
    v_mfma_f32_16x16x32_bf16 v[180:183], v[40:43], a[224:227], v[180:183]
    v_exp_f32 v17, v97
    v_mfma_f32_16x16x32_bf16 v[180:183], v[44:47], a[228:231], v[180:183]
    v_cvt_pk_bf16_f32 v161, v18, v19
    v_add_u32 v21, s3, v21
    v_mfma_f32_16x16x32_bf16 v[184:187], v[40:43], a[248:251], v[184:187]
    ds_read_b128 v[36:39], v3 offset:12544
    v_cvt_pk_bf16_f32 v231, v246, v247
    v_mfma_f32_16x16x32_bf16 v[184:187], v[44:47], a[252:255], v[184:187]
    s_waitcnt vmcnt(25)
    v_exp_f32 v18, v98
    v_mfma_f32_16x16x32_bf16 v[188:191], v[40:43], v[208:211], v[188:191]
    v_add_f32 v4, v4, v16
    v_add_f32 v4, v4, v17
    v_mfma_f32_16x16x32_bf16 v[188:191], v[44:47], v[212:215], v[188:191]
    s_waitcnt lgkmcnt(2)
    v_exp_f32 v19, v99
    s_branch L_skip10
L_pad10:
    s_branch L_tb1_4
L_skip10:
    v_mfma_f32_16x16x32_bf16 v[112:115], v[24:27], a[200:203], v[112:115]
    ds_read_b128 v[40:43], v2 offset:18688
    v_cvt_pk_bf16_f32 v162, v16, v17
    v_mfma_f32_16x16x32_bf16 v[112:115], v[28:31], a[204:207], v[112:115]
    v_exp_f32 v16, v164
    v_mfma_f32_16x16x32_bf16 v[116:119], v[24:27], a[224:227], v[116:119]
    v_add_f32 v4, v4, v18
    v_add_u32 v22, s3, v22
    v_mfma_f32_16x16x32_bf16 v[116:119], v[28:31], a[228:231], v[116:119]
    s_add_u32 s32, s32, 24576
    v_add_f32 v4, v4, v19
    v_cvt_f32_i32 v248, v248
    v_mfma_f32_16x16x32_bf16 v[120:123], v[24:27], a[248:251], v[120:123]
    s_add_u32 s26, s26, 36864
    ds_read_b128 v[44:47], v3 offset:18688
    v_mfma_f32_16x16x32_bf16 v[120:123], v[28:31], a[252:255], v[120:123]
    s_waitcnt lgkmcnt(2)
    v_exp_f32 v17, v165
    v_mfma_f32_16x16x32_bf16 v[124:127], v[24:27], v[208:211], v[124:127]
    s_waitcnt vmcnt(27)
    v_cvt_pk_bf16_f32 v163, v18, v19
    v_cvt_f32_i32 v249, v249
    v_mfma_f32_16x16x32_bf16 v[124:127], v[28:31], v[212:215], v[124:127]
    s_barrier
    s_sub_u32 s57, s26, 147456
    v_mfma_f32_16x16x32_bf16 v[176:179], v[32:35], a[208:211], v[176:179]
    ds_read_b128 v[24:27], v1 offset:0
    v_mfma_f32_16x16x32_bf16 v[176:179], v[36:39], a[212:215], v[176:179]
    v_exp_f32 v18, v166
    v_mfma_f32_16x16x32_bf16 v[180:183], v[32:35], a[232:235], v[180:183]
    s_min_u32 s26, s26, s57
    v_add_f32 v5, v5, v16
    v_add_f32 v5, v5, v17
    v_mfma_f32_16x16x32_bf16 v[180:183], v[36:39], a[236:239], v[180:183]
    v_exp_f32 v19, v167
    v_mfma_f32_16x16x32_bf16 v[184:187], v[32:35], v[192:195], v[184:187]
    ds_read_b128 v[28:31], v1 offset:12288
    v_cvt_pk_bf16_f32 v164, v16, v17
    v_mfma_f32_16x16x32_bf16 v[184:187], v[36:39], v[196:199], v[184:187]
    v_exp_f32 v16, v100
    v_mfma_f32_16x16x32_bf16 v[188:191], v[32:35], v[216:219], v[188:191]
    v_add_f32 v5, v5, v18
    v_add_f32 v5, v5, v19
    v_mfma_f32_16x16x32_bf16 v[188:191], v[36:39], v[220:223], v[188:191]
    s_waitcnt lgkmcnt(2)
    v_exp_f32 v17, v101
    v_mfma_f32_16x16x32_bf16 v[112:115], v[40:43], a[208:211], v[112:115]
    ds_read_b128 v[32:35], v1 offset:768
    v_cvt_pk_bf16_f32 v165, v18, v19
    v_mfma_f32_16x16x32_bf16 v[112:115], v[44:47], a[212:215], v[112:115]
    v_exp_f32 v18, v102
    v_mfma_f32_16x16x32_bf16 v[116:119], v[40:43], a[232:235], v[116:119]
    v_add_f32 v5, v5, v16
    v_cvt_f32_i32 v252, v252
    v_mfma_f32_16x16x32_bf16 v[116:119], v[44:47], a[236:239], v[116:119]
    v_add_f32 v5, v5, v17
    v_cvt_f32_i32 v253, v253
    v_mfma_f32_16x16x32_bf16 v[120:123], v[40:43], v[192:195], v[120:123]
    ds_read_b128 v[36:39], v1 offset:13056
    v_mfma_f32_16x16x32_bf16 v[120:123], v[44:47], v[196:199], v[120:123]
    v_exp_f32 v19, v103
    v_mfma_f32_16x16x32_bf16 v[124:127], v[40:43], v[216:219], v[124:127]
    v_cvt_pk_bf16_f32 v166, v16, v17
    v_add_f32 v5, v5, v18
    v_mfma_f32_16x16x32_bf16 v[124:127], v[44:47], v[220:223], v[124:127]
    s_waitcnt lgkmcnt(2)
    v_add_f32 v5, v5, v19
    v_cvt_pk_bf16_f32 v167, v18, v19
    v_mfma_f32_16x16x32_bf16 a[0:3], v[64:67], v[24:27], a[0:3]
    ds_read_b128 v[40:43], v1 offset:1536
    v_fma_f32 v248, v248, v60, v62
    v_mfma_f32_16x16x32_bf16 a[0:3], v[80:83], v[28:31], a[0:3]
    v_exp_f32 v16, v168
    v_mfma_f32_16x16x32_bf16 a[48:51], v[68:71], v[24:27], a[48:51]
    v_exp_f32 v17, v169
    v_mfma_f32_16x16x32_bf16 a[48:51], v[84:87], v[28:31], a[48:51]
    v_exp_f32 v18, v170
    v_mfma_f32_16x16x32_bf16 a[96:99], v[72:75], v[24:27], a[96:99]
    ds_read_b128 v[44:47], v1 offset:13824
    v_fma_f32 v249, v249, v61, v63
    v_mfma_f32_16x16x32_bf16 a[96:99], v[88:91], v[28:31], a[96:99]
    v_add_f32 v6, v6, v16
    v_add_f32 v6, v6, v17
    v_mfma_f32_16x16x32_bf16 a[144:147], v[76:79], v[24:27], a[144:147]
    v_exp_f32 v19, v171
    v_mfma_f32_16x16x32_bf16 a[144:147], v[92:95], v[28:31], a[144:147]
    s_waitcnt lgkmcnt(2)
    v_mfma_f32_16x16x32_bf16 a[4:7], v[64:67], v[32:35], a[4:7]
    ds_read_b128 v[24:27], v1 offset:2304
    v_cvt_pk_bf16_f32 v168, v16, v17
    v_mfma_f32_16x16x32_bf16 a[4:7], v[80:83], v[36:39], a[4:7]
    v_exp_f32 v16, v104
    v_mfma_f32_16x16x32_bf16 a[52:55], v[68:71], v[32:35], a[52:55]
    v_add_f32 v6, v6, v18
    v_fma_f32 v252, v252, v60, v62
    v_mfma_f32_16x16x32_bf16 a[52:55], v[84:87], v[36:39], a[52:55]
    v_add_f32 v6, v6, v19
    v_mfma_f32_16x16x32_bf16 a[100:103], v[72:75], v[32:35], a[100:103]
    ds_read_b128 v[28:31], v1 offset:14592
    v_mfma_f32_16x16x32_bf16 a[100:103], v[88:91], v[36:39], a[100:103]
    v_exp_f32 v17, v105
    v_mfma_f32_16x16x32_bf16 a[148:151], v[76:79], v[32:35], a[148:151]
    v_cvt_pk_bf16_f32 v169, v18, v19
    v_fma_f32 v253, v253, v61, v63
    v_mfma_f32_16x16x32_bf16 a[148:151], v[92:95], v[36:39], a[148:151]
    s_waitcnt lgkmcnt(2)
    v_exp_f32 v18, v106
    v_mfma_f32_16x16x32_bf16 a[8:11], v[64:67], v[40:43], a[8:11]
    ds_read_b128 v[32:35], v21 offset:0
    v_add_f32 v6, v6, v16
    v_mfma_f32_16x16x32_bf16 a[8:11], v[80:83], v[44:47], a[8:11]
    v_add_f32 v6, v6, v17
    v_mfma_f32_16x16x32_bf16 a[56:59], v[68:71], v[40:43], a[56:59]
    v_exp_f32 v19, v107
    v_mfma_f32_16x16x32_bf16 a[56:59], v[84:87], v[44:47], a[56:59]
    v_mfma_f32_16x16x32_bf16 a[104:107], v[72:75], v[40:43], a[104:107]
    ds_read_b128 v[36:39], v21 offset:12288
    v_cvt_pk_bf16_f32 v170, v16, v17
    v_mfma_f32_16x16x32_bf16 a[104:107], v[88:91], v[44:47], a[104:107]
    v_exp_f32 v16, v172
    v_mfma_f32_16x16x32_bf16 a[152:155], v[76:79], v[40:43], a[152:155]
    v_cvt_pk_bf16_f32 v234, v248, v249
    v_add_f32 v6, v6, v18
    v_mfma_f32_16x16x32_bf16 a[152:155], v[92:95], v[44:47], a[152:155]
    s_waitcnt lgkmcnt(2)
    v_add_f32 v6, v6, v19
    v_mfma_f32_16x16x32_bf16 a[12:15], v[64:67], v[24:27], a[12:15]
    ds_read_b128 v[40:43], v21 offset:768
    v_mfma_f32_16x16x32_bf16 a[12:15], v[80:83], v[28:31], a[12:15]
    v_exp_f32 v17, v173
    v_mfma_f32_16x16x32_bf16 a[60:63], v[68:71], v[24:27], a[60:63]
    v_cvt_pk_bf16_f32 v171, v18, v19
    v_cvt_pk_bf16_f32 v238, v252, v253
    v_mfma_f32_16x16x32_bf16 a[60:63], v[84:87], v[28:31], a[60:63]
    v_exp_f32 v18, v174
    v_mfma_f32_16x16x32_bf16 a[108:111], v[72:75], v[24:27], a[108:111]
    ds_read_b128 v[44:47], v21 offset:13056
    v_add_f32 v7, v7, v16
    v_mfma_f32_16x16x32_bf16 a[108:111], v[88:91], v[28:31], a[108:111]
    s_waitcnt vmcnt(6)
    v_subrev_u32 v52, s92, v52
    v_cmp_lt_u32 vcc, 15, v52
    v_mfma_f32_16x16x32_bf16 a[156:159], v[76:79], v[24:27], a[156:159]
    s_add_u32 s29, s28, 49152
    v_add_f32 v7, v7, v17
    v_mfma_f32_16x16x32_bf16 a[156:159], v[92:95], v[28:31], a[156:159]
    s_waitcnt lgkmcnt(2)
    v_exp_f32 v19, v175
    v_mfma_f32_16x16x32_bf16 a[16:19], v[64:67], v[32:35], a[16:19]
    s_and_b32 s59, vcc_lo, 0xff
    ds_read_b128 v[24:27], v21 offset:1536
    v_cvt_pk_bf16_f32 v172, v16, v17
    v_mfma_f32_16x16x32_bf16 a[16:19], v[80:83], v[36:39], a[16:19]
    s_cbranch_scc1 L_pollslow5
L_pollok5:
    v_mfma_f32_16x16x32_bf16 a[64:67], v[68:71], v[32:35], a[64:67]
    s_add_u32 s92, s92, 1
    v_exp_f32 v16, v108
    v_mfma_f32_16x16x32_bf16 a[64:67], v[84:87], v[36:39], a[64:67]
    s_sub_u32 s3, s29, 147456
    v_add_f32 v7, v7, v18
    v_add_f32 v7, v7, v19
    v_mfma_f32_16x16x32_bf16 a[112:115], v[72:75], v[32:35], a[112:115]
    s_mov_b32 m0, s56
    ds_read_b128 v[28:31], v21 offset:13824
    v_cvt_f32_i32 v250, v250
    v_mfma_f32_16x16x32_bf16 a[112:115], v[88:91], v[36:39], a[112:115]
    v_exp_f32 v17, v109
    v_mfma_f32_16x16x32_bf16 a[160:163], v[76:79], v[32:35], a[160:163]
    v_cvt_pk_bf16_f32 v173, v18, v19
    v_cvt_f32_i32 v251, v251
    v_mfma_f32_16x16x32_bf16 a[160:163], v[92:95], v[36:39], a[160:163]
    s_waitcnt lgkmcnt(2)
    buffer_load_dwordx4 v8, s[4:7], s27 offen offset:0 sc1 lds
    v_mfma_f32_16x16x32_bf16 a[20:23], v[64:67], v[40:43], a[20:23]
    s_min_u32 s29, s29, s3
    ds_read_b128 v[32:35], v21 offset:2304
    v_mfma_f32_16x16x32_bf16 a[20:23], v[80:83], v[44:47], a[20:23]
    v_exp_f32 v18, v110
    v_mfma_f32_16x16x32_bf16 a[68:71], v[68:71], v[40:43], a[68:71]
    v_add_f32 v7, v7, v16
    v_add_f32 v7, v7, v17
    v_mfma_f32_16x16x32_bf16 a[68:71], v[84:87], v[44:47], a[68:71]
    buffer_load_dwordx4 v8, s[4:7], s27 offen offset:1024 sc1 lds
    v_mfma_f32_16x16x32_bf16 a[116:119], v[72:75], v[40:43], a[116:119]
    ds_read_b128 v[36:39], v21 offset:14592
    v_cvt_f32_i32 v254, v254
    v_mfma_f32_16x16x32_bf16 a[116:119], v[88:91], v[44:47], a[116:119]
    v_exp_f32 v19, v111
    v_mfma_f32_16x16x32_bf16 a[164:167], v[76:79], v[40:43], a[164:167]
    s_sub_u32 s3, s29, s28
    v_cvt_pk_bf16_f32 v174, v16, v17
    v_mfma_f32_16x16x32_bf16 a[164:167], v[92:95], v[44:47], a[164:167]
    s_waitcnt lgkmcnt(2)
    v_exp_f32 v16, v176
    v_mfma_f32_16x16x32_bf16 a[24:27], v[64:67], v[24:27], a[24:27]
    ds_read_b128 v[40:43], v22 offset:0
    v_add_f32 v7, v7, v18
    v_mfma_f32_16x16x32_bf16 a[24:27], v[80:83], v[28:31], a[24:27]
    buffer_load_dwordx4 v8, s[4:7], s27 offen offset:2048 sc1 lds
    v_mfma_f32_16x16x32_bf16 a[72:75], v[68:71], v[24:27], a[72:75]
    v_add_f32 v7, v7, v19
    v_cvt_f32_i32 v255, v255
    v_mfma_f32_16x16x32_bf16 a[72:75], v[84:87], v[28:31], a[72:75]
    v_exp_f32 v17, v177
    v_mfma_f32_16x16x32_bf16 a[120:123], v[72:75], v[24:27], a[120:123]
    s_add_u32 s27, s27, 24576
    ds_read_b128 v[44:47], v22 offset:12288
    v_cvt_pk_bf16_f32 v175, v18, v19
    v_mfma_f32_16x16x32_bf16 a[120:123], v[88:91], v[28:31], a[120:123]
    s_mov_b32 s28, s29
    v_exp_f32 v18, v178
    v_mfma_f32_16x16x32_bf16 a[168:171], v[76:79], v[24:27], a[168:171]
    v_add_f32 v4, v4, v16
    v_add_f32 v4, v4, v17
    v_mfma_f32_16x16x32_bf16 a[168:171], v[92:95], v[28:31], a[168:171]
    s_waitcnt lgkmcnt(2)
    v_exp_f32 v19, v179
    v_mfma_f32_16x16x32_bf16 a[28:31], v[64:67], v[32:35], a[28:31]
    s_add_u32 s56, s56, 12288
    ds_read_b128 v[24:27], v22 offset:768
    v_cvt_pk_bf16_f32 v176, v16, v17
    v_mfma_f32_16x16x32_bf16 a[28:31], v[80:83], v[36:39], a[28:31]
    s_mov_b32 m0, s56
    v_exp_f32 v16, v112
    v_mfma_f32_16x16x32_bf16 a[76:79], v[68:71], v[32:35], a[76:79]
    v_fma_f32 v250, v250, v48, v50
    v_add_f32 v4, v4, v18
    v_mfma_f32_16x16x32_bf16 a[76:79], v[84:87], v[36:39], a[76:79]
    v_add_f32 v4, v4, v19
    v_mfma_f32_16x16x32_bf16 a[124:127], v[72:75], v[32:35], a[124:127]
    ds_read_b128 v[28:31], v22 offset:13056
    v_add_u32 v2, s3, v2
    v_mfma_f32_16x16x32_bf16 a[124:127], v[88:91], v[36:39], a[124:127]
    buffer_load_dwordx4 v8, s[4:7], s27 offen offset:0 sc1 lds
    v_mfma_f32_16x16x32_bf16 a[172:175], v[76:79], v[32:35], a[172:175]
    v_exp_f32 v17, v113
    v_mfma_f32_16x16x32_bf16 a[172:175], v[92:95], v[36:39], a[172:175]
    s_waitcnt lgkmcnt(2)
    v_cvt_pk_bf16_f32 v177, v18, v19
    v_fma_f32 v251, v251, v49, v51
    v_mfma_f32_16x16x32_bf16 a[32:35], v[64:67], v[40:43], a[32:35]
    ds_read_b128 v[32:35], v22 offset:1536
    v_mfma_f32_16x16x32_bf16 a[32:35], v[80:83], v[44:47], a[32:35]
    v_exp_f32 v18, v114
    v_mfma_f32_16x16x32_bf16 a[80:83], v[68:71], v[40:43], a[80:83]
    v_add_f32 v4, v4, v16
    v_add_f32 v4, v4, v17
    v_mfma_f32_16x16x32_bf16 a[80:83], v[84:87], v[44:47], a[80:83]
    buffer_load_dwordx4 v8, s[4:7], s27 offen offset:1024 sc1 lds
    v_mfma_f32_16x16x32_bf16 a[128:131], v[72:75], v[40:43], a[128:131]
    ds_read_b128 v[36:39], v22 offset:13824
    v_add_u32 v3, s3, v3
    v_mfma_f32_16x16x32_bf16 a[128:131], v[88:91], v[44:47], a[128:131]
    v_exp_f32 v19, v115
    v_mfma_f32_16x16x32_bf16 a[176:179], v[76:79], v[40:43], a[176:179]
    v_cvt_pk_bf16_f32 v178, v16, v17
    v_fma_f32 v254, v254, v48, v50
    v_mfma_f32_16x16x32_bf16 a[176:179], v[92:95], v[44:47], a[176:179]
    s_waitcnt lgkmcnt(2)
    buffer_load_dwordx4 v8, s[4:7], s27 offen offset:2048 sc1 lds
    v_mfma_f32_16x16x32_bf16 a[36:39], v[64:67], v[24:27], a[36:39]
    ds_read_b128 v[40:43], v22 offset:2304
    v_mfma_f32_16x16x32_bf16 a[36:39], v[80:83], v[28:31], a[36:39]
    v_exp_f32 v16, v180
    v_mfma_f32_16x16x32_bf16 a[84:87], v[68:71], v[24:27], a[84:87]
    v_add_f32 v4, v4, v18
    v_add_f32 v4, v4, v19
    v_mfma_f32_16x16x32_bf16 a[84:87], v[84:87], v[28:31], a[84:87]
    v_exp_f32 v17, v181
    v_mfma_f32_16x16x32_bf16 a[132:135], v[72:75], v[24:27], a[132:135]
    ds_read_b128 v[44:47], v22 offset:14592
    v_cvt_pk_bf16_f32 v179, v18, v19
    v_mfma_f32_16x16x32_bf16 a[132:135], v[88:91], v[28:31], a[132:135]
    s_waitcnt lgkmcnt(2)
    v_exp_f32 v18, v182
    v_mfma_f32_16x16x32_bf16 a[180:183], v[76:79], v[24:27], a[180:183]
    s_waitcnt vmcnt(25)
    v_add_f32 v5, v5, v16
    v_add_f32 v5, v5, v17
    v_mfma_f32_16x16x32_bf16 a[180:183], v[92:95], v[28:31], a[180:183]
    s_barrier
    s_add_u32 s27, s27, 24576
    v_mfma_f32_16x16x32_bf16 a[40:43], v[64:67], v[32:35], a[40:43]
    ds_read_b128 v[24:27], v2 offset:0
    v_fma_f32 v255, v255, v49, v51
    v_mfma_f32_16x16x32_bf16 a[40:43], v[80:83], v[36:39], a[40:43]
    s_add_u32 s56, s56, 36864
    buffer_load_dwordx4 v[240:243], v12, s[68:71], s36 offen offset:0 nt
    v_mfma_f32_16x16x32_bf16 a[88:91], v[68:71], v[32:35], a[88:91]
    s_sub_u32 s58, s56, 147456
    v_exp_f32 v19, v183
    v_mfma_f32_16x16x32_bf16 a[88:91], v[84:87], v[36:39], a[88:91]
    v_cvt_pk_bf16_f32 v180, v16, v17
    v_cvt_pk_bf16_f32 v235, v250, v251
    v_mfma_f32_16x16x32_bf16 a[136:139], v[72:75], v[32:35], a[136:139]
    s_min_u32 s56, s56, s58
    ds_read_b128 v[28:31], v3 offset:0
    v_mfma_f32_16x16x32_bf16 a[136:139], v[88:91], v[36:39], a[136:139]
    v_exp_f32 v16, v116
    v_mfma_f32_16x16x32_bf16 a[184:187], v[76:79], v[32:35], a[184:187]
    v_add_f32 v5, v5, v18
    v_add_f32 v5, v5, v19
    v_mfma_f32_16x16x32_bf16 a[184:187], v[92:95], v[36:39], a[184:187]
    s_waitcnt lgkmcnt(2)
    buffer_load_dwordx4 v[244:247], v12, s[68:71], s36 offen offset:768 nt
    v_mfma_f32_16x16x32_bf16 a[44:47], v[64:67], v[40:43], a[44:47]
    ds_read_b128 v[32:35], v2 offset:6144
    v_cvt_pk_bf16_f32 v239, v254, v255
    v_mfma_f32_16x16x32_bf16 a[44:47], v[80:83], v[44:47], a[44:47]
    v_exp_f32 v17, v117
    v_mfma_f32_16x16x32_bf16 a[92:95], v[68:71], v[40:43], a[92:95]
    v_cvt_pk_bf16_f32 v181, v18, v19
    v_mfma_f32_16x16x32_bf16 a[92:95], v[84:87], v[44:47], a[92:95]
    v_exp_f32 v18, v118
    v_mfma_f32_16x16x32_bf16 a[140:143], v[72:75], v[40:43], a[140:143]
    ds_read_b128 v[36:39], v3 offset:6144
    v_add_f32 v5, v5, v16
    v_mfma_f32_16x16x32_bf16 a[140:143], v[88:91], v[44:47], a[140:143]
    v_add_f32 v5, v5, v17
    v_mfma_f32_16x16x32_bf16 a[188:191], v[76:79], v[40:43], a[188:191]
    v_exp_f32 v19, v119
    v_mfma_f32_16x16x32_bf16 a[188:191], v[92:95], v[44:47], a[188:191]
    s_waitcnt lgkmcnt(2)
    v_cvt_pk_bf16_f32 v182, v16, v17
    v_add_f32 v5, v5, v18
    v_add_f32 v5, v5, v19
    v_cvt_pk_bf16_f32 v183, v18, v19
L_join:
    v_mfma_f32_16x16x32_bf16 v[64:67], v[24:27], a[192:195], v[128:131]
    ds_read_b128 v[40:43], v2 offset:128
    v_mfma_f32_16x16x32_bf16 v[64:67], v[28:31], a[196:199], v[64:67]
    v_exp_f32 v16, v184
    v_mfma_f32_16x16x32_bf16 v[68:71], v[24:27], a[216:219], v[132:135]
    v_exp_f32 v17, v185
    v_mfma_f32_16x16x32_bf16 v[68:71], v[28:31], a[220:223], v[68:71]
    ds_read_b128 v[60:63], v23 offset:16
    s_waitcnt vmcnt(17)
    v_mfma_f32_16x16x32_bf16 v[72:75], v[24:27], a[240:243], v[136:139]
    ds_read_b128 v[44:47], v3 offset:128
    v_cvt_f32_i32 v144, v144
    v_mfma_f32_16x16x32_bf16 v[72:75], v[28:31], a[244:247], v[72:75]
    buffer_store_dwordx4 v[224:227], v11, s[4:7], s37 offen offset:0 sc1
    v_mfma_f32_16x16x32_bf16 v[76:79], v[24:27], v[200:203], v[140:143]
    v_exp_f32 v18, v186
    v_mfma_f32_16x16x32_bf16 v[76:79], v[28:31], v[204:207], v[76:79]
    s_waitcnt lgkmcnt(3)
    v_add_f32 v6, v6, v16
    v_add_f32 v6, v6, v17
    v_mfma_f32_16x16x32_bf16 v[96:99], v[32:35], a[192:195], v[128:131]
    ds_read_b128 v[24:27], v2 offset:6272
    v_cvt_f32_i32 v148, v148
    v_mfma_f32_16x16x32_bf16 v[96:99], v[36:39], a[196:199], v[96:99]
    v_exp_f32 v19, v187
    v_mfma_f32_16x16x32_bf16 v[100:103], v[32:35], a[216:219], v[132:135]
    s_mov_b32 m0, s26
    v_cvt_pk_bf16_f32 v184, v16, v17
    v_mfma_f32_16x16x32_bf16 v[100:103], v[36:39], a[220:223], v[100:103]
    v_exp_f32 v16, v120
    v_mfma_f32_16x16x32_bf16 v[104:107], v[32:35], a[240:243], v[136:139]
    ds_read_b128 v[28:31], v3 offset:6272
    v_add_f32 v6, v6, v18
    v_mfma_f32_16x16x32_bf16 v[104:107], v[36:39], a[244:247], v[104:107]
    v_add_f32 v6, v6, v19
    v_cvt_f32_i32 v145, v145
    v_mfma_f32_16x16x32_bf16 v[108:111], v[32:35], v[200:203], v[140:143]
    v_exp_f32 v17, v121
    v_mfma_f32_16x16x32_bf16 v[108:111], v[36:39], v[204:207], v[108:111]
    s_waitcnt lgkmcnt(2)
    buffer_load_dwordx4 v8, s[4:7], s32 offen offset:0 sc1 lds
    v_mfma_f32_16x16x32_bf16 v[64:67], v[40:43], a[200:203], v[64:67]
    ds_read_b128 v[32:35], v2 offset:256
    v_cvt_pk_bf16_f32 v185, v18, v19
    v_mfma_f32_16x16x32_bf16 v[64:67], v[44:47], a[204:207], v[64:67]
    v_exp_f32 v18, v122
    v_mfma_f32_16x16x32_bf16 v[68:71], v[40:43], a[224:227], v[68:71]
    ds_read_b128 v[48:51], v23 offset:32
    v_add_f32 v6, v6, v16
    v_mfma_f32_16x16x32_bf16 v[68:71], v[44:47], a[228:231], v[68:71]
    v_add_f32 v6, v6, v17
    v_cvt_f32_i32 v149, v149
    v_mfma_f32_16x16x32_bf16 v[72:75], v[40:43], a[248:251], v[72:75]
    ds_read_b128 v[36:39], v3 offset:256
    v_fma_f32 v144, v144, v56, v58
    v_mfma_f32_16x16x32_bf16 v[72:75], v[44:47], a[252:255], v[72:75]
    buffer_store_dwordx4 v[228:231], v54, s[4:7], s37 offen offset:768 sc1
    v_mfma_f32_16x16x32_bf16 v[76:79], v[40:43], v[208:211], v[76:79]
    v_exp_f32 v19, v123
    v_mfma_f32_16x16x32_bf16 v[76:79], v[44:47], v[212:215], v[76:79]
    s_waitcnt lgkmcnt(3)
    v_cvt_pk_bf16_f32 v186, v16, v17
    v_fma_f32 v148, v148, v57, v59
    v_mfma_f32_16x16x32_bf16 v[96:99], v[24:27], a[200:203], v[96:99]
    ds_read_b128 v[40:43], v2 offset:6400
    v_mfma_f32_16x16x32_bf16 v[96:99], v[28:31], a[204:207], v[96:99]
    buffer_load_dwordx4 v8, s[4:7], s32 offen offset:1024 sc1 lds
    v_mfma_f32_16x16x32_bf16 v[100:103], v[24:27], a[224:227], v[100:103]
    v_exp_f32 v16, v188
    v_mfma_f32_16x16x32_bf16 v[100:103], v[28:31], a[228:231], v[100:103]
    v_add_f32 v6, v6, v18
    v_add_f32 v6, v6, v19
    v_mfma_f32_16x16x32_bf16 v[104:107], v[24:27], a[248:251], v[104:107]
    ds_read_b128 v[44:47], v3 offset:6400
    v_fma_f32 v145, v145, v56, v58
    v_mfma_f32_16x16x32_bf16 v[104:107], v[28:31], a[252:255], v[104:107]
    v_exp_f32 v17, v189
    v_mfma_f32_16x16x32_bf16 v[108:111], v[24:27], v[208:211], v[108:111]
    s_add_u32 s29, s30, 49152
    v_cvt_pk_bf16_f32 v187, v18, v19
    v_fma_f32 v149, v149, v57, v59
    v_mfma_f32_16x16x32_bf16 v[108:111], v[28:31], v[212:215], v[108:111]
    s_waitcnt lgkmcnt(2)
    v_exp_f32 v18, v190
    v_mfma_f32_16x16x32_bf16 v[64:67], v[32:35], a[208:211], v[64:67]
    s_sub_u32 s3, s29, 147456
    ds_read_b128 v[24:27], v2 offset:12288
    v_add_f32 v7, v7, v16
    v_mfma_f32_16x16x32_bf16 v[64:67], v[36:39], a[212:215], v[64:67]
    v_add_f32 v7, v7, v17
    v_cvt_f32_i32 v146, v146
    v_mfma_f32_16x16x32_bf16 v[68:71], v[32:35], a[232:235], v[68:71]
    v_exp_f32 v19, v191
    v_mfma_f32_16x16x32_bf16 v[68:71], v[36:39], a[236:239], v[68:71]
    v_cvt_pk_bf16_f32 v188, v16, v17
    v_mfma_f32_16x16x32_bf16 v[72:75], v[32:35], v[192:195], v[72:75]
    ds_read_b128 v[28:31], v3 offset:12288
    v_cvt_f32_i32 v150, v150
    v_mfma_f32_16x16x32_bf16 v[72:75], v[36:39], v[196:199], v[72:75]
    buffer_store_dwordx4 v[232:235], v11, s[4:7], s80 offen offset:0 sc1
    v_mfma_f32_16x16x32_bf16 v[76:79], v[32:35], v[216:219], v[76:79]
    s_min_u32 s29, s29, s3
    v_exp_f32 v16, v124
    v_mfma_f32_16x16x32_bf16 v[76:79], v[36:39], v[220:223], v[76:79]
    s_waitcnt lgkmcnt(2)
    v_add_f32 v7, v7, v18
    v_add_f32 v7, v7, v19
    v_mfma_f32_16x16x32_bf16 v[96:99], v[40:43], a[208:211], v[96:99]
    ds_read_b128 v[32:35], v2 offset:18432
    v_cvt_f32_i32 v147, v147
    v_mfma_f32_16x16x32_bf16 v[96:99], v[44:47], a[212:215], v[96:99]
    buffer_load_dwordx4 v8, s[4:7], s32 offen offset:2048 sc1 lds
    v_mfma_f32_16x16x32_bf16 v[100:103], v[40:43], a[232:235], v[100:103]
    v_exp_f32 v17, v125
    v_mfma_f32_16x16x32_bf16 v[100:103], v[44:47], a[236:239], v[100:103]
    s_add_u32 s32, s32, 24576
    v_cvt_pk_bf16_f32 v189, v18, v19
    v_cvt_f32_i32 v151, v151
    v_mfma_f32_16x16x32_bf16 v[104:107], v[40:43], v[192:195], v[104:107]
    s_sub_u32 s3, s29, s30
    ds_read_b128 v[36:39], v3 offset:18432
    v_mfma_f32_16x16x32_bf16 v[104:107], v[44:47], v[196:199], v[104:107]
    v_exp_f32 v18, v126
    v_mfma_f32_16x16x32_bf16 v[108:111], v[40:43], v[216:219], v[108:111]
    v_add_f32 v7, v7, v16
    v_add_f32 v7, v7, v17
    v_mfma_f32_16x16x32_bf16 v[108:111], v[44:47], v[220:223], v[108:111]
    s_waitcnt lgkmcnt(2)
    v_exp_f32 v19, v127
    v_mfma_f32_16x16x32_bf16 v[80:83], v[24:27], a[192:195], v[128:131]
    s_add_u32 s26, s26, 12288
    ds_read_b128 v[40:43], v2 offset:12416
    v_cvt_pk_bf16_f32 v190, v16, v17
    v_mfma_f32_16x16x32_bf16 v[80:83], v[28:31], a[196:199], v[80:83]
    v_add_f32 v7, v7, v18
    v_add_f32 v7, v7, v19
    v_mfma_f32_16x16x32_bf16 v[84:87], v[24:27], a[216:219], v[132:135]
    s_mov_b32 s30, s29
    v_cvt_pk_bf16_f32 v191, v18, v19
    v_fma_f32 v146, v146, v56, v58
    v_mfma_f32_16x16x32_bf16 v[84:87], v[28:31], a[220:223], v[84:87]
    v_fma_f32 v150, v150, v57, v59
    v_mfma_f32_16x16x32_bf16 v[88:91], v[24:27], a[240:243], v[136:139]
    ds_read_b128 v[44:47], v3 offset:12416
    v_fma_f32 v147, v147, v56, v58
    v_mfma_f32_16x16x32_bf16 v[88:91], v[28:31], a[244:247], v[88:91]
    buffer_store_dwordx4 v[236:239], v54, s[4:7], s80 offen offset:768 sc1
    v_mfma_f32_16x16x32_bf16 v[92:95], v[24:27], v[200:203], v[140:143]
    s_mov_b32 m0, s26
    v_exp_f32 v16, v64
    v_mfma_f32_16x16x32_bf16 v[92:95], v[28:31], v[204:207], v[92:95]
    s_waitcnt lgkmcnt(2)
    v_exp_f32 v17, v65
    v_mfma_f32_16x16x32_bf16 v[112:115], v[32:35], a[192:195], v[128:131]
    ds_read_b128 v[24:27], v2 offset:18560
    v_fma_f32 v151, v151, v57, v59
    v_mfma_f32_16x16x32_bf16 v[112:115], v[36:39], a[196:199], v[112:115]
    v_exp_f32 v18, v66
    v_mfma_f32_16x16x32_bf16 v[116:119], v[32:35], a[216:219], v[132:135]
    v_add_f32 v4, v4, v16
    v_add_f32 v4, v4, v17
    v_mfma_f32_16x16x32_bf16 v[116:119], v[36:39], a[220:223], v[116:119]
    v_exp_f32 v19, v67
    v_mfma_f32_16x16x32_bf16 v[120:123], v[32:35], a[240:243], v[136:139]
    ds_read_b128 v[28:31], v3 offset:18560
    v_cvt_pk_bf16_f32 v64, v16, v17
    v_mfma_f32_16x16x32_bf16 v[120:123], v[36:39], a[244:247], v[120:123]
    buffer_load_dwordx4 v8, s[4:7], s32 offen offset:0 sc1 lds
    v_mfma_f32_16x16x32_bf16 v[124:127], v[32:35], v[200:203], v[140:143]
    v_exp_f32 v16, v96
    v_mfma_f32_16x16x32_bf16 v[124:127], v[36:39], v[204:207], v[124:127]
    s_waitcnt lgkmcnt(2)
    v_add_f32 v4, v4, v18
    v_add_f32 v4, v4, v19
    v_mfma_f32_16x16x32_bf16 v[80:83], v[40:43], a[200:203], v[80:83]
    ds_read_b128 v[32:35], v2 offset:12544
    v_add_u32 v1, s3, v1
    v_mfma_f32_16x16x32_bf16 v[80:83], v[44:47], a[204:207], v[80:83]
    v_exp_f32 v17, v97
    v_mfma_f32_16x16x32_bf16 v[84:87], v[40:43], a[224:227], v[84:87]
    ds_read_b128 v[56:59], v23 offset:48
    v_cvt_pk_bf16_f32 v65, v18, v19
    v_mfma_f32_16x16x32_bf16 v[84:87], v[44:47], a[228:231], v[84:87]
    s_waitcnt vmcnt(23)
    v_exp_f32 v18, v98
    v_mfma_f32_16x16x32_bf16 v[88:91], v[40:43], a[248:251], v[88:91]
    ds_read_b128 v[36:39], v3 offset:12544
    v_add_f32 v4, v4, v16
    v_mfma_f32_16x16x32_bf16 v[88:91], v[44:47], a[252:255], v[88:91]
    v_add_f32 v4, v4, v17
    v_add_u32 v21, s3, v21
    v_mfma_f32_16x16x32_bf16 v[92:95], v[40:43], v[208:211], v[92:95]
    v_exp_f32 v19, v99
    v_mfma_f32_16x16x32_bf16 v[92:95], v[44:47], v[212:215], v[92:95]
    s_waitcnt lgkmcnt(3)
    v_cvt_pk_bf16_f32 v66, v16, v17
    v_cvt_f32_i32 v152, v152
    v_mfma_f32_16x16x32_bf16 v[112:115], v[24:27], a[200:203], v[112:115]
    ds_read_b128 v[40:43], v2 offset:18688
    v_cvt_f32_i32 v156, v156
    v_mfma_f32_16x16x32_bf16 v[112:115], v[28:31], a[204:207], v[112:115]
    buffer_load_dwordx4 v8, s[4:7], s32 offen offset:1024 sc1 lds
    v_mfma_f32_16x16x32_bf16 v[116:119], v[24:27], a[224:227], v[116:119]
    v_exp_f32 v16, v68
    v_mfma_f32_16x16x32_bf16 v[116:119], v[28:31], a[228:231], v[116:119]
    v_add_f32 v4, v4, v18
    v_add_f32 v4, v4, v19
    v_mfma_f32_16x16x32_bf16 v[120:123], v[24:27], a[248:251], v[120:123]
    ds_read_b128 v[44:47], v3 offset:18688
    v_add_u32 v22, s3, v22
    v_mfma_f32_16x16x32_bf16 v[120:123], v[28:31], a[252:255], v[120:123]
    s_waitcnt lgkmcnt(2)
    v_exp_f32 v17, v69
    v_mfma_f32_16x16x32_bf16 v[124:127], v[24:27], v[208:211], v[124:127]
    s_waitcnt vmcnt(25)
    v_cvt_pk_bf16_f32 v67, v18, v19
    v_cvt_f32_i32 v153, v153
    v_mfma_f32_16x16x32_bf16 v[124:127], v[28:31], v[212:215], v[124:127]
    s_barrier
    v_add_u32 v23, 1792, v23
    v_mfma_f32_16x16x32_bf16 v[80:83], v[32:35], a[208:211], v[80:83]
    ds_read_b128 v[24:27], v1 offset:0
    v_cvt_f32_i32 v157, v157
    v_mfma_f32_16x16x32_bf16 v[80:83], v[36:39], a[212:215], v[80:83]
    v_exp_f32 v18, v70
    v_mfma_f32_16x16x32_bf16 v[84:87], v[32:35], a[232:235], v[84:87]
    v_add_f32 v5, v5, v16
    v_add_f32 v5, v5, v17
    v_mfma_f32_16x16x32_bf16 v[84:87], v[36:39], a[236:239], v[84:87]
    buffer_load_dwordx4 v8, s[4:7], s32 offen offset:2048 sc1 lds
    v_mfma_f32_16x16x32_bf16 v[88:91], v[32:35], v[192:195], v[88:91]
    ds_read_b128 v[28:31], v1 offset:12288
    v_fma_f32 v152, v152, v60, v62
    v_mfma_f32_16x16x32_bf16 v[88:91], v[36:39], v[196:199], v[88:91]
    v_exp_f32 v19, v71
    v_cvt_pk_bf16_f32 v68, v16, v17
    v_mfma_f32_16x16x32_bf16 v[92:95], v[32:35], v[216:219], v[92:95]
    v_exp_f32 v16, v100
    v_mfma_f32_16x16x32_bf16 v[92:95], v[36:39], v[220:223], v[92:95]
    s_waitcnt lgkmcnt(2)
    v_add_f32 v5, v5, v18
    v_add_f32 v5, v5, v19
    v_mfma_f32_16x16x32_bf16 v[112:115], v[40:43], a[208:211], v[112:115]
    ds_read_b128 v[32:35], v1 offset:768
    v_fma_f32 v156, v156, v61, v63
    v_mfma_f32_16x16x32_bf16 v[112:115], v[44:47], a[212:215], v[112:115]
    v_exp_f32 v17, v101
    v_mfma_f32_16x16x32_bf16 v[116:119], v[40:43], a[232:235], v[116:119]
    v_cvt_pk_bf16_f32 v69, v18, v19
    v_fma_f32 v153, v153, v60, v62
    v_mfma_f32_16x16x32_bf16 v[116:119], v[44:47], a[236:239], v[116:119]
    v_exp_f32 v18, v102
    v_mfma_f32_16x16x32_bf16 v[120:123], v[40:43], v[192:195], v[120:123]
    s_sub_u32 s31, s31, 1
    ds_read_b128 v[36:39], v1 offset:13056
    v_add_f32 v5, v5, v16
    v_mfma_f32_16x16x32_bf16 v[120:123], v[44:47], v[196:199], v[120:123]
    s_add_u32 s32, s32, 24576
    s_add_u32 s26, s26, 36864
    s_sub_u32 s57, s26, 147456
    s_min_u32 s26, s26, s57
    v_mfma_f32_16x16x32_bf16 v[124:127], v[40:43], v[216:219], v[124:127]
    s_waitcnt lgkmcnt(2)
    s_cmp_lg_u32 s31, 0
    v_add_f32 v5, v5, v17
    v_exp_f32 v19, v103
    v_cvt_pk_bf16_f32 v70, v16, v17
    v_add_f32 v5, v5, v18
    v_add_f32 v5, v5, v19
    v_cvt_pk_bf16_f32 v71, v18, v19
    v_fma_f32 v157, v157, v61, v63
    v_mfma_f32_16x16x32_bf16 v[124:127], v[44:47], v[220:223], v[124:127]
    s_cbranch_scc1 L_loop
    v_mfma_f32_16x16x32_bf16 a[0:3], v[160:163], v[24:27], a[0:3]
    ds_read_b128 v[40:43], v1 offset:1536
    v_cvt_f32_i32 v154, v154
    v_mfma_f32_16x16x32_bf16 a[0:3], v[176:179], v[28:31], a[0:3]
    buffer_load_dwordx4 v[248:251], v12, s[68:71], s36 offen offset:1536 nt
    v_mfma_f32_16x16x32_bf16 a[48:51], v[164:167], v[24:27], a[48:51]
    v_exp_f32 v16, v72
    v_mfma_f32_16x16x32_bf16 a[48:51], v[180:183], v[28:31], a[48:51]
    v_exp_f32 v17, v73
    v_mfma_f32_16x16x32_bf16 a[96:99], v[168:171], v[24:27], a[96:99]
    ds_read_b128 v[44:47], v1 offset:13824
    v_cvt_f32_i32 v158, v158
    v_mfma_f32_16x16x32_bf16 a[96:99], v[184:187], v[28:31], a[96:99]
    v_exp_f32 v18, v74
    v_mfma_f32_16x16x32_bf16 a[144:147], v[172:175], v[24:27], a[144:147]
    v_add_f32 v6, v6, v16
    v_add_f32 v6, v6, v17
    v_mfma_f32_16x16x32_bf16 a[144:147], v[188:191], v[28:31], a[144:147]
    s_waitcnt lgkmcnt(2)
    buffer_load_dwordx4 v[252:255], v12, s[68:71], s36 offen offset:2304 nt
    v_mfma_f32_16x16x32_bf16 a[4:7], v[160:163], v[32:35], a[4:7]
    ds_read_b128 v[24:27], v1 offset:2304
    v_cvt_f32_i32 v155, v155
    v_mfma_f32_16x16x32_bf16 a[4:7], v[176:179], v[36:39], a[4:7]
    v_exp_f32 v19, v75
    v_mfma_f32_16x16x32_bf16 a[52:55], v[164:167], v[32:35], a[52:55]
    v_cvt_pk_bf16_f32 v72, v16, v17
    v_cvt_f32_i32 v159, v159
    v_mfma_f32_16x16x32_bf16 a[52:55], v[180:183], v[36:39], a[52:55]
    v_exp_f32 v16, v104
    v_mfma_f32_16x16x32_bf16 a[100:103], v[168:171], v[32:35], a[100:103]
    ds_read_b128 v[28:31], v1 offset:14592
    v_add_f32 v6, v6, v18
    v_mfma_f32_16x16x32_bf16 a[100:103], v[184:187], v[36:39], a[100:103]
    v_add_f32 v6, v6, v19
    v_fma_f32 v154, v154, v60, v62
    s_branch L_skip11
L_pad11:
    s_branch L_tb1_3
L_skip11:
    v_mfma_f32_16x16x32_bf16 a[148:151], v[172:175], v[32:35], a[148:151]
    v_exp_f32 v17, v105
    v_mfma_f32_16x16x32_bf16 a[148:151], v[188:191], v[36:39], a[148:151]
    s_waitcnt lgkmcnt(2)
    v_cvt_pk_bf16_f32 v73, v18, v19
    v_fma_f32 v158, v158, v61, v63
    v_mfma_f32_16x16x32_bf16 a[8:11], v[160:163], v[40:43], a[8:11]
    ds_read_b128 v[32:35], v21 offset:0
    v_mfma_f32_16x16x32_bf16 a[8:11], v[176:179], v[44:47], a[8:11]
    v_exp_f32 v18, v106
    v_mfma_f32_16x16x32_bf16 a[56:59], v[164:167], v[40:43], a[56:59]
    v_add_f32 v6, v6, v16
    v_add_f32 v6, v6, v17
    v_mfma_f32_16x16x32_bf16 a[56:59], v[180:183], v[44:47], a[56:59]
    v_exp_f32 v19, v107
    v_mfma_f32_16x16x32_bf16 a[104:107], v[168:171], v[40:43], a[104:107]
    s_mov_b32 m0, s56
    ds_read_b128 v[36:39], v21 offset:12288
    v_cvt_pk_bf16_f32 v74, v16, v17
    v_mfma_f32_16x16x32_bf16 a[104:107], v[184:187], v[44:47], a[104:107]
    v_exp_f32 v16, v76
    v_mfma_f32_16x16x32_bf16 a[152:155], v[172:175], v[40:43], a[152:155]
    v_fma_f32 v155, v155, v60, v62
    v_fma_f32 v159, v159, v61, v63
    v_mfma_f32_16x16x32_bf16 a[152:155], v[188:191], v[44:47], a[152:155]
    s_waitcnt lgkmcnt(2)
    buffer_load_dwordx4 v8, s[4:7], s27 offen offset:0 sc1 lds
    v_mfma_f32_16x16x32_bf16 a[12:15], v[160:163], v[24:27], a[12:15]
    ds_read_b128 v[40:43], v21 offset:768
    v_add_f32 v6, v6, v18
    v_mfma_f32_16x16x32_bf16 a[12:15], v[176:179], v[28:31], a[12:15]
    v_add_f32 v6, v6, v19
    v_cvt_pk_bf16_f32 v144, v144, v148
    v_mfma_f32_16x16x32_bf16 a[60:63], v[164:167], v[24:27], a[60:63]
    v_exp_f32 v17, v77
    v_mfma_f32_16x16x32_bf16 a[60:63], v[180:183], v[28:31], a[60:63]
    v_cvt_pk_bf16_f32 v75, v18, v19
    v_mfma_f32_16x16x32_bf16 a[108:111], v[168:171], v[24:27], a[108:111]
    ds_read_b128 v[44:47], v21 offset:13056
    v_cvt_pk_bf16_f32 v148, v145, v149
    v_mfma_f32_16x16x32_bf16 a[108:111], v[184:187], v[28:31], a[108:111]
    v_exp_f32 v18, v78
    v_mfma_f32_16x16x32_bf16 a[156:159], v[172:175], v[24:27], a[156:159]
    s_add_u32 s29, s28, 49152
    v_add_f32 v7, v7, v16
    v_add_f32 v7, v7, v17
    v_mfma_f32_16x16x32_bf16 a[156:159], v[188:191], v[28:31], a[156:159]
    s_waitcnt lgkmcnt(2)
    buffer_load_dwordx4 v8, s[4:7], s27 offen offset:1024 sc1 lds
    v_mfma_f32_16x16x32_bf16 a[16:19], v[160:163], v[32:35], a[16:19]
    ds_read_b128 v[24:27], v21 offset:1536
    v_cvt_pk_bf16_f32 v145, v152, v156
    v_mfma_f32_16x16x32_bf16 a[16:19], v[176:179], v[36:39], a[16:19]
    s_sub_u32 s3, s29, 147456
    v_exp_f32 v19, v79
    v_mfma_f32_16x16x32_bf16 a[64:67], v[164:167], v[32:35], a[64:67]
    v_cvt_pk_bf16_f32 v76, v16, v17
    v_cvt_pk_bf16_f32 v149, v153, v157
    v_mfma_f32_16x16x32_bf16 a[64:67], v[180:183], v[36:39], a[64:67]
    v_exp_f32 v16, v108
    v_mfma_f32_16x16x32_bf16 a[112:115], v[168:171], v[32:35], a[112:115]
    ds_read_b128 v[28:31], v21 offset:13824
    v_add_f32 v7, v7, v18
    v_mfma_f32_16x16x32_bf16 a[112:115], v[184:187], v[36:39], a[112:115]
    buffer_load_dwordx4 v8, s[4:7], s27 offen offset:2048 sc1 lds
    v_mfma_f32_16x16x32_bf16 a[160:163], v[172:175], v[32:35], a[160:163]
    v_add_f32 v7, v7, v19
    v_cvt_pk_bf16_f32 v152, v146, v150
    v_mfma_f32_16x16x32_bf16 a[160:163], v[188:191], v[36:39], a[160:163]
    s_waitcnt lgkmcnt(2)
    v_exp_f32 v17, v109
    v_mfma_f32_16x16x32_bf16 a[20:23], v[160:163], v[40:43], a[20:23]
    s_min_u32 s29, s29, s3
    ds_read_b128 v[32:35], v21 offset:2304
    v_cvt_pk_bf16_f32 v77, v18, v19
    v_mfma_f32_16x16x32_bf16 a[20:23], v[176:179], v[44:47], a[20:23]
    v_exp_f32 v18, v110
    v_mfma_f32_16x16x32_bf16 a[68:71], v[164:167], v[40:43], a[68:71]
    s_add_u32 s27, s27, 24576
    v_add_f32 v7, v7, v16
    v_add_f32 v7, v7, v17
    v_mfma_f32_16x16x32_bf16 a[68:71], v[180:183], v[44:47], a[68:71]
    v_exp_f32 v19, v111
    v_mfma_f32_16x16x32_bf16 a[116:119], v[168:171], v[40:43], a[116:119]
    ds_read_b128 v[36:39], v21 offset:14592
    v_cvt_pk_bf16_f32 v153, v154, v158
    v_mfma_f32_16x16x32_bf16 a[116:119], v[184:187], v[44:47], a[116:119]
    s_add_u32 s56, s56, 12288
    v_cvt_pk_bf16_f32 v78, v16, v17
    v_cvt_pk_bf16_f32 v156, v147, v151
    v_mfma_f32_16x16x32_bf16 a[164:167], v[172:175], v[40:43], a[164:167]
    s_sub_u32 s3, s29, s28
    v_exp_f32 v16, v80
    v_mfma_f32_16x16x32_bf16 a[164:167], v[188:191], v[44:47], a[164:167]
    s_waitcnt lgkmcnt(2)
    v_add_f32 v7, v7, v18
    v_add_f32 v7, v7, v19
    v_mfma_f32_16x16x32_bf16 a[24:27], v[160:163], v[24:27], a[24:27]
    ds_read_b128 v[40:43], v22 offset:0
    v_cvt_pk_bf16_f32 v157, v155, v159
    v_mfma_f32_16x16x32_bf16 a[24:27], v[176:179], v[28:31], a[24:27]
    s_mov_b32 m0, s56
    v_exp_f32 v17, v81
    v_mfma_f32_16x16x32_bf16 a[72:75], v[164:167], v[24:27], a[72:75]
    v_cvt_pk_bf16_f32 v79, v18, v19
    v_mfma_f32_16x16x32_bf16 a[72:75], v[180:183], v[28:31], a[72:75]
    s_waitcnt vmcnt(15)
    v_exp_f32 v18, v82
    v_mfma_f32_16x16x32_bf16 a[120:123], v[168:171], v[24:27], a[120:123]
    ds_read_b128 v[44:47], v22 offset:12288
    v_add_f32 v4, v4, v16
    v_mfma_f32_16x16x32_bf16 a[120:123], v[184:187], v[28:31], a[120:123]
    s_mov_b32 s28, s29
    v_add_f32 v4, v4, v17
    v_mfma_f32_16x16x32_bf16 a[168:171], v[172:175], v[24:27], a[168:171]
    v_exp_f32 v19, v83
    v_mfma_f32_16x16x32_bf16 a[168:171], v[188:191], v[28:31], a[168:171]
    s_waitcnt lgkmcnt(2)
    buffer_load_dwordx4 v8, s[4:7], s27 offen offset:0 sc1 lds
    v_mfma_f32_16x16x32_bf16 a[28:31], v[160:163], v[32:35], a[28:31]
    ds_read_b128 v[24:27], v22 offset:768
    v_cvt_pk_bf16_f32 v80, v16, v17
    v_mfma_f32_16x16x32_bf16 a[28:31], v[176:179], v[36:39], a[28:31]
    v_exp_f32 v16, v112
    v_mfma_f32_16x16x32_bf16 a[76:79], v[164:167], v[32:35], a[76:79]
    v_cvt_f32_i32 v240, v240
    v_add_f32 v4, v4, v18
    v_mfma_f32_16x16x32_bf16 a[76:79], v[180:183], v[36:39], a[76:79]
    v_cvt_f32_i32 v244, v244
    v_add_f32 v4, v4, v19
    v_mfma_f32_16x16x32_bf16 a[124:127], v[168:171], v[32:35], a[124:127]
    ds_read_b128 v[28:31], v22 offset:13056
    v_add_u32 v2, s3, v2
    v_mfma_f32_16x16x32_bf16 a[124:127], v[184:187], v[36:39], a[124:127]
    buffer_load_dwordx4 v8, s[4:7], s27 offen offset:1024 sc1 lds
    v_mfma_f32_16x16x32_bf16 a[172:175], v[172:175], v[32:35], a[172:175]
    v_exp_f32 v17, v113
    v_mfma_f32_16x16x32_bf16 a[172:175], v[188:191], v[36:39], a[172:175]
    s_waitcnt lgkmcnt(2)
    v_cvt_pk_bf16_f32 v81, v18, v19
    v_cvt_f32_i32 v241, v241
    v_mfma_f32_16x16x32_bf16 a[32:35], v[160:163], v[40:43], a[32:35]
    ds_read_b128 v[32:35], v22 offset:1536
    v_cvt_f32_i32 v245, v245
    v_mfma_f32_16x16x32_bf16 a[32:35], v[176:179], v[44:47], a[32:35]
    v_exp_f32 v18, v114
    v_mfma_f32_16x16x32_bf16 a[80:83], v[164:167], v[40:43], a[80:83]
    v_add_f32 v4, v4, v16
    v_add_f32 v4, v4, v17
    v_mfma_f32_16x16x32_bf16 a[80:83], v[180:183], v[44:47], a[80:83]
    v_exp_f32 v19, v115
    v_mfma_f32_16x16x32_bf16 a[128:131], v[168:171], v[40:43], a[128:131]
    ds_read_b128 v[36:39], v22 offset:13824
    v_cvt_pk_bf16_f32 v82, v16, v17
    v_mfma_f32_16x16x32_bf16 a[128:131], v[184:187], v[44:47], a[128:131]
    buffer_load_dwordx4 v8, s[4:7], s27 offen offset:2048 sc1 lds
    v_mfma_f32_16x16x32_bf16 a[176:179], v[172:175], v[40:43], a[176:179]
    v_exp_f32 v16, v84
    v_mfma_f32_16x16x32_bf16 a[176:179], v[188:191], v[44:47], a[176:179]
    s_waitcnt lgkmcnt(2)
    v_add_f32 v4, v4, v18
    v_fma_f32 v240, v240, v48, v50
    v_mfma_f32_16x16x32_bf16 a[36:39], v[160:163], v[24:27], a[36:39]
    ds_read_b128 v[40:43], v22 offset:2304
    v_add_f32 v4, v4, v19
    v_mfma_f32_16x16x32_bf16 a[36:39], v[176:179], v[28:31], a[36:39]
    v_exp_f32 v17, v85
    v_mfma_f32_16x16x32_bf16 a[84:87], v[164:167], v[24:27], a[84:87]
    v_add_u32 v3, s3, v3
    v_fma_f32 v244, v244, v49, v51
    v_mfma_f32_16x16x32_bf16 a[84:87], v[180:183], v[28:31], a[84:87]
    s_add_u32 s27, s27, 24576
    v_cvt_pk_bf16_f32 v83, v18, v19
    v_fma_f32 v241, v241, v48, v50
    v_mfma_f32_16x16x32_bf16 a[132:135], v[168:171], v[24:27], a[132:135]
    s_add_u32 s56, s56, 36864
    ds_read_b128 v[44:47], v22 offset:14592
    v_mfma_f32_16x16x32_bf16 a[132:135], v[184:187], v[28:31], a[132:135]
    s_waitcnt lgkmcnt(2)
    v_exp_f32 v18, v86
    v_mfma_f32_16x16x32_bf16 a[180:183], v[172:175], v[24:27], a[180:183]
    s_waitcnt vmcnt(11)
    v_add_f32 v5, v5, v16
    v_add_f32 v5, v5, v17
    v_mfma_f32_16x16x32_bf16 a[180:183], v[188:191], v[28:31], a[180:183]
    s_barrier
    v_fma_f32 v245, v245, v49, v51
    v_mfma_f32_16x16x32_bf16 a[40:43], v[160:163], v[32:35], a[40:43]
    s_sub_u32 s58, s56, 147456
    ds_read_b128 v[24:27], v2 offset:0
    v_add_u32 v55, 1, v55
    v_mfma_f32_16x16x32_bf16 a[40:43], v[176:179], v[36:39], a[40:43]
    v_exp_f32 v19, v87
    v_mfma_f32_16x16x32_bf16 a[88:91], v[164:167], v[32:35], a[88:91]
    s_min_u32 s56, s56, s58
    v_cvt_pk_bf16_f32 v84, v16, v17
    v_cvt_f32_i32 v242, v242
    v_mfma_f32_16x16x32_bf16 a[88:91], v[180:183], v[36:39], a[88:91]
    v_exp_f32 v16, v116
    v_mfma_f32_16x16x32_bf16 a[136:139], v[168:171], v[32:35], a[136:139]
    ds_read_b128 v[28:31], v3 offset:0
    v_add_f32 v5, v5, v18
    v_mfma_f32_16x16x32_bf16 a[136:139], v[184:187], v[36:39], a[136:139]
    buffer_store_dword v55, v13, s[20:23], 0 offen sc1
    v_mfma_f32_16x16x32_bf16 a[184:187], v[172:175], v[32:35], a[184:187]
    v_add_f32 v5, v5, v19
    v_cvt_f32_i32 v246, v246
    v_mfma_f32_16x16x32_bf16 a[184:187], v[188:191], v[36:39], a[184:187]
    s_waitcnt lgkmcnt(2)
    v_exp_f32 v17, v117
    v_mfma_f32_16x16x32_bf16 a[44:47], v[160:163], v[40:43], a[44:47]
    ds_read_b128 v[32:35], v2 offset:6144
    v_cvt_pk_bf16_f32 v85, v18, v19
    v_mfma_f32_16x16x32_bf16 a[44:47], v[176:179], v[44:47], a[44:47]
    v_exp_f32 v18, v118
    v_mfma_f32_16x16x32_bf16 a[92:95], v[164:167], v[40:43], a[92:95]
    v_add_f32 v5, v5, v16
    v_add_f32 v5, v5, v17
    v_mfma_f32_16x16x32_bf16 a[92:95], v[180:183], v[44:47], a[92:95]
    v_exp_f32 v19, v119
    v_mfma_f32_16x16x32_bf16 a[140:143], v[168:171], v[40:43], a[140:143]
    ds_read_b128 v[36:39], v3 offset:6144
    v_cvt_f32_i32 v243, v243
    v_mfma_f32_16x16x32_bf16 a[140:143], v[184:187], v[44:47], a[140:143]
    v_cvt_pk_bf16_f32 v86, v16, v17
    v_add_f32 v5, v5, v18
    v_mfma_f32_16x16x32_bf16 a[188:191], v[172:175], v[40:43], a[188:191]
    v_add_f32 v5, v5, v19
    v_cvt_f32_i32 v247, v247
    v_mfma_f32_16x16x32_bf16 a[188:191], v[188:191], v[44:47], a[188:191]
    s_waitcnt lgkmcnt(2)
    v_cvt_pk_bf16_f32 v87, v18, v19
    v_mfma_f32_16x16x32_bf16 v[160:163], v[24:27], a[192:195], v[128:131]
    s_mov_b32 m0, s26
    ds_read_b128 v[40:43], v2 offset:128
    v_fma_f32 v242, v242, v48, v50
    v_mfma_f32_16x16x32_bf16 v[160:163], v[28:31], a[196:199], v[160:163]
    v_exp_f32 v16, v88
    v_mfma_f32_16x16x32_bf16 v[164:167], v[24:27], a[216:219], v[132:135]
    v_exp_f32 v17, v89
    v_mfma_f32_16x16x32_bf16 v[164:167], v[28:31], a[220:223], v[164:167]
    v_exp_f32 v18, v90
    v_mfma_f32_16x16x32_bf16 v[168:171], v[24:27], a[240:243], v[136:139]
    ds_read_b128 v[44:47], v3 offset:128
    v_fma_f32 v246, v246, v49, v51
    v_mfma_f32_16x16x32_bf16 v[168:171], v[28:31], a[244:247], v[168:171]
    buffer_load_dwordx4 v8, s[4:7], s32 offen offset:0 sc1 lds
    v_mfma_f32_16x16x32_bf16 v[172:175], v[24:27], v[200:203], v[140:143]
    v_add_f32 v6, v6, v16
    v_add_f32 v6, v6, v17
    v_mfma_f32_16x16x32_bf16 v[172:175], v[28:31], v[204:207], v[172:175]
    s_waitcnt lgkmcnt(2)
    v_exp_f32 v19, v91
    v_mfma_f32_16x16x32_bf16 v[96:99], v[32:35], a[192:195], v[128:131]
    ds_read_b128 v[24:27], v2 offset:6272
    v_fma_f32 v243, v243, v48, v50
    v_mfma_f32_16x16x32_bf16 v[96:99], v[36:39], a[196:199], v[96:99]
    v_cvt_pk_bf16_f32 v88, v16, v17
    v_fma_f32 v247, v247, v49, v51
    v_mfma_f32_16x16x32_bf16 v[100:103], v[32:35], a[216:219], v[132:135]
    v_exp_f32 v16, v120
    v_mfma_f32_16x16x32_bf16 v[100:103], v[36:39], a[220:223], v[100:103]
    v_add_f32 v6, v6, v18
    v_cvt_pk_bf16_f32 v146, v240, v244
    v_mfma_f32_16x16x32_bf16 v[104:107], v[32:35], a[240:243], v[136:139]
    ds_read_b128 v[28:31], v3 offset:6272
    v_add_f32 v6, v6, v19
    v_mfma_f32_16x16x32_bf16 v[104:107], v[36:39], a[244:247], v[104:107]
    buffer_load_dwordx4 v8, s[4:7], s32 offen offset:1024 sc1 lds
    v_mfma_f32_16x16x32_bf16 v[108:111], v[32:35], v[200:203], v[140:143]
    v_exp_f32 v17, v121
    v_mfma_f32_16x16x32_bf16 v[108:111], v[36:39], v[204:207], v[108:111]
    s_waitcnt lgkmcnt(2)
    v_cvt_pk_bf16_f32 v89, v18, v19
    v_cvt_pk_bf16_f32 v150, v241, v245
    v_mfma_f32_16x16x32_bf16 v[160:163], v[40:43], a[200:203], v[160:163]
    ds_read_b128 v[32:35], v2 offset:256
    v_mfma_f32_16x16x32_bf16 v[160:163], v[44:47], a[204:207], v[160:163]
    v_exp_f32 v18, v122
    v_mfma_f32_16x16x32_bf16 v[164:167], v[40:43], a[224:227], v[164:167]
    v_add_f32 v6, v6, v16
    v_add_f32 v6, v6, v17
    v_mfma_f32_16x16x32_bf16 v[164:167], v[44:47], a[228:231], v[164:167]
    v_cvt_pk_bf16_f32 v154, v242, v246
    v_mfma_f32_16x16x32_bf16 v[168:171], v[40:43], a[248:251], v[168:171]
    ds_read_b128 v[36:39], v3 offset:256
    v_mfma_f32_16x16x32_bf16 v[168:171], v[44:47], a[252:255], v[168:171]
    v_exp_f32 v19, v123
    v_mfma_f32_16x16x32_bf16 v[172:175], v[40:43], v[208:211], v[172:175]
    v_cvt_pk_bf16_f32 v90, v16, v17
    v_cvt_pk_bf16_f32 v158, v243, v247
    v_mfma_f32_16x16x32_bf16 v[172:175], v[44:47], v[212:215], v[172:175]
    s_waitcnt lgkmcnt(2)
    buffer_load_dwordx4 v8, s[4:7], s32 offen offset:2048 sc1 lds
    v_mfma_f32_16x16x32_bf16 v[96:99], v[24:27], a[200:203], v[96:99]
    s_waitcnt vmcnt(10)
    ds_read_b128 v[40:43], v2 offset:6400
    v_mfma_f32_16x16x32_bf16 v[96:99], v[28:31], a[204:207], v[96:99]
    v_exp_f32 v16, v92
    v_mfma_f32_16x16x32_bf16 v[100:103], v[24:27], a[224:227], v[100:103]
    v_add_f32 v6, v6, v18
    v_add_f32 v6, v6, v19
    v_mfma_f32_16x16x32_bf16 v[100:103], v[28:31], a[228:231], v[100:103]
    v_exp_f32 v17, v93
    v_mfma_f32_16x16x32_bf16 v[104:107], v[24:27], a[248:251], v[104:107]
    ds_read_b128 v[44:47], v3 offset:6400
    v_cvt_pk_bf16_f32 v91, v18, v19
    v_mfma_f32_16x16x32_bf16 v[104:107], v[28:31], a[252:255], v[104:107]
    s_add_u32 s32, s32, 24576
    v_exp_f32 v18, v94
    v_mfma_f32_16x16x32_bf16 v[108:111], v[24:27], v[208:211], v[108:111]
    s_add_u32 s29, s30, 49152
    v_cvt_f32_i32 v248, v248
    v_add_f32 v7, v7, v16
    v_mfma_f32_16x16x32_bf16 v[108:111], v[28:31], v[212:215], v[108:111]
    s_waitcnt lgkmcnt(2)
    v_add_f32 v7, v7, v17
    v_cvt_f32_i32 v252, v252
    v_mfma_f32_16x16x32_bf16 v[160:163], v[32:35], a[208:211], v[160:163]
    s_sub_u32 s3, s29, 147456
    ds_read_b128 v[24:27], v2 offset:12288
    v_mfma_f32_16x16x32_bf16 v[160:163], v[36:39], a[212:215], v[160:163]
    v_exp_f32 v19, v95
    v_mfma_f32_16x16x32_bf16 v[164:167], v[32:35], a[232:235], v[164:167]
    s_add_u32 s26, s26, 12288
    v_cvt_pk_bf16_f32 v92, v16, v17
    v_cvt_f32_i32 v249, v249
    v_mfma_f32_16x16x32_bf16 v[164:167], v[36:39], a[236:239], v[164:167]
    v_exp_f32 v16, v124
    v_mfma_f32_16x16x32_bf16 v[168:171], v[32:35], v[192:195], v[168:171]
    ds_read_b128 v[28:31], v3 offset:12288
    v_add_f32 v7, v7, v18
    v_mfma_f32_16x16x32_bf16 v[168:171], v[36:39], v[196:199], v[168:171]
    v_add_f32 v7, v7, v19
    v_mfma_f32_16x16x32_bf16 v[172:175], v[32:35], v[216:219], v[172:175]
    s_min_u32 s29, s29, s3
    v_cvt_f32_i32 v253, v253
    s_mov_b32 m0, s26
    v_mfma_f32_16x16x32_bf16 v[172:175], v[36:39], v[220:223], v[172:175]
    s_waitcnt lgkmcnt(2)
    v_exp_f32 v17, v125
    v_mfma_f32_16x16x32_bf16 v[96:99], v[40:43], a[208:211], v[96:99]
    ds_read_b128 v[32:35], v2 offset:18432
    v_cvt_pk_bf16_f32 v93, v18, v19
    v_mfma_f32_16x16x32_bf16 v[96:99], v[44:47], a[212:215], v[96:99]
    v_exp_f32 v18, v126
    v_mfma_f32_16x16x32_bf16 v[100:103], v[40:43], a[232:235], v[100:103]
    v_fma_f32 v248, v248, v56, v58
    v_mfma_f32_16x16x32_bf16 v[100:103], v[44:47], a[236:239], v[100:103]
    v_add_f32 v7, v7, v16
    v_mfma_f32_16x16x32_bf16 v[104:107], v[40:43], v[192:195], v[104:107]
    s_sub_u32 s3, s29, s30
    ds_read_b128 v[36:39], v3 offset:18432
    v_add_f32 v7, v7, v17
    v_mfma_f32_16x16x32_bf16 v[104:107], v[44:47], v[196:199], v[104:107]
    buffer_load_dwordx4 v8, s[4:7], s32 offen offset:0 sc1 lds
    v_mfma_f32_16x16x32_bf16 v[108:111], v[40:43], v[216:219], v[108:111]
    v_exp_f32 v19, v127
    v_mfma_f32_16x16x32_bf16 v[108:111], v[44:47], v[220:223], v[108:111]
    s_waitcnt lgkmcnt(2)
    v_cvt_pk_bf16_f32 v94, v16, v17
    v_fma_f32 v252, v252, v57, v59
    v_mfma_f32_16x16x32_bf16 v[176:179], v[24:27], a[192:195], v[128:131]
    ds_read_b128 v[40:43], v2 offset:12416
    v_add_f32 v7, v7, v18
    v_mfma_f32_16x16x32_bf16 v[176:179], v[28:31], a[196:199], v[176:179]
    v_add_f32 v7, v7, v19
    v_fma_f32 v249, v249, v56, v58
    v_mfma_f32_16x16x32_bf16 v[180:183], v[24:27], a[216:219], v[132:135]
    s_mov_b32 s30, s29
    v_cvt_pk_bf16_f32 v95, v18, v19
    v_mfma_f32_16x16x32_bf16 v[180:183], v[28:31], a[220:223], v[180:183]
    v_fma_f32 v253, v253, v57, v59
    v_mfma_f32_16x16x32_bf16 v[184:187], v[24:27], a[240:243], v[136:139]
    ds_read_b128 v[44:47], v3 offset:12416
    v_mfma_f32_16x16x32_bf16 v[184:187], v[28:31], a[244:247], v[184:187]
    v_exp_f32 v16, v160
    v_mfma_f32_16x16x32_bf16 v[188:191], v[24:27], v[200:203], v[140:143]
    v_exp_f32 v17, v161
    v_mfma_f32_16x16x32_bf16 v[188:191], v[28:31], v[204:207], v[188:191]
    s_waitcnt lgkmcnt(2)
    buffer_load_dwordx4 v8, s[4:7], s32 offen offset:1024 sc1 lds
    v_mfma_f32_16x16x32_bf16 v[112:115], v[32:35], a[192:195], v[128:131]
    ds_read_b128 v[24:27], v2 offset:18560
    v_cvt_f32_i32 v250, v250
    v_mfma_f32_16x16x32_bf16 v[112:115], v[36:39], a[196:199], v[112:115]
    v_exp_f32 v18, v162
    v_mfma_f32_16x16x32_bf16 v[116:119], v[32:35], a[216:219], v[132:135]
    v_add_f32 v4, v4, v16
    v_add_f32 v4, v4, v17
    v_mfma_f32_16x16x32_bf16 v[116:119], v[36:39], a[220:223], v[116:119]
    v_exp_f32 v19, v163
    v_mfma_f32_16x16x32_bf16 v[120:123], v[32:35], a[240:243], v[136:139]
    ds_read_b128 v[28:31], v3 offset:18560
    v_cvt_pk_bf16_f32 v160, v16, v17
    v_mfma_f32_16x16x32_bf16 v[120:123], v[36:39], a[244:247], v[120:123]
    v_exp_f32 v16, v96
    v_mfma_f32_16x16x32_bf16 v[124:127], v[32:35], v[200:203], v[140:143]
    v_cvt_f32_i32 v254, v254
    v_add_f32 v4, v4, v18
    v_mfma_f32_16x16x32_bf16 v[124:127], v[36:39], v[204:207], v[124:127]
    s_waitcnt lgkmcnt(2)
    buffer_load_dwordx4 v8, s[4:7], s32 offen offset:2048 sc1 lds
    v_mfma_f32_16x16x32_bf16 v[176:179], v[40:43], a[200:203], v[176:179]
    ds_read_b128 v[32:35], v2 offset:12544
    v_add_f32 v4, v4, v19
    v_mfma_f32_16x16x32_bf16 v[176:179], v[44:47], a[204:207], v[176:179]
    v_exp_f32 v17, v97
    v_mfma_f32_16x16x32_bf16 v[180:183], v[40:43], a[224:227], v[180:183]
    v_add_u32 v1, s3, v1
    v_cvt_pk_bf16_f32 v161, v18, v19
    v_mfma_f32_16x16x32_bf16 v[180:183], v[44:47], a[228:231], v[180:183]
    v_exp_f32 v18, v98
    v_mfma_f32_16x16x32_bf16 v[184:187], v[40:43], a[248:251], v[184:187]
    ds_read_b128 v[36:39], v3 offset:12544
    v_cvt_f32_i32 v251, v251
    v_mfma_f32_16x16x32_bf16 v[184:187], v[44:47], a[252:255], v[184:187]
    v_add_f32 v4, v4, v16
    v_add_f32 v4, v4, v17
    v_mfma_f32_16x16x32_bf16 v[188:191], v[40:43], v[208:211], v[188:191]
    v_exp_f32 v19, v99
    v_mfma_f32_16x16x32_bf16 v[188:191], v[44:47], v[212:215], v[188:191]
    s_waitcnt lgkmcnt(2)
    v_add_u32 v21, s3, v21
    v_cvt_f32_i32 v255, v255
    v_mfma_f32_16x16x32_bf16 v[112:115], v[24:27], a[200:203], v[112:115]
    ds_read_b128 v[40:43], v2 offset:18688
    v_cvt_pk_bf16_f32 v162, v16, v17
    v_mfma_f32_16x16x32_bf16 v[112:115], v[28:31], a[204:207], v[112:115]
    s_add_u32 s32, s32, 24576
    v_exp_f32 v16, v164
    v_mfma_f32_16x16x32_bf16 v[116:119], v[24:27], a[224:227], v[116:119]
    s_add_u32 s26, s26, 36864
    v_add_f32 v4, v4, v18
    v_add_u32 v22, s3, v22
    v_mfma_f32_16x16x32_bf16 v[116:119], v[28:31], a[228:231], v[116:119]
    v_add_f32 v4, v4, v19
    v_fma_f32 v250, v250, v56, v58
    v_mfma_f32_16x16x32_bf16 v[120:123], v[24:27], a[248:251], v[120:123]
    ds_read_b128 v[44:47], v3 offset:18688
    v_fma_f32 v254, v254, v57, v59
    v_mfma_f32_16x16x32_bf16 v[120:123], v[28:31], a[252:255], v[120:123]
    s_waitcnt lgkmcnt(2)
    v_exp_f32 v17, v165
    v_mfma_f32_16x16x32_bf16 v[124:127], v[24:27], v[208:211], v[124:127]
    s_waitcnt vmcnt(27)
    v_cvt_pk_bf16_f32 v163, v18, v19
    v_fma_f32 v251, v251, v56, v58
    v_mfma_f32_16x16x32_bf16 v[124:127], v[28:31], v[212:215], v[124:127]
    s_barrier
    s_sub_u32 s57, s26, 147456
    v_mfma_f32_16x16x32_bf16 v[176:179], v[32:35], a[208:211], v[176:179]
    s_min_u32 s26, s26, s57
    ds_read_b128 v[24:27], v1 offset:0
    v_fma_f32 v255, v255, v57, v59
    v_mfma_f32_16x16x32_bf16 v[176:179], v[36:39], a[212:215], v[176:179]
    v_exp_f32 v18, v166
    v_mfma_f32_16x16x32_bf16 v[180:183], v[32:35], a[232:235], v[180:183]
    v_add_f32 v5, v5, v16
    v_add_f32 v5, v5, v17
    v_mfma_f32_16x16x32_bf16 v[180:183], v[36:39], a[236:239], v[180:183]
    v_exp_f32 v19, v167
    v_mfma_f32_16x16x32_bf16 v[184:187], v[32:35], v[192:195], v[184:187]
    ds_read_b128 v[28:31], v1 offset:12288
    v_cvt_pk_bf16_f32 v164, v16, v17
    v_mfma_f32_16x16x32_bf16 v[184:187], v[36:39], v[196:199], v[184:187]
    v_exp_f32 v16, v100
    v_mfma_f32_16x16x32_bf16 v[188:191], v[32:35], v[216:219], v[188:191]
    v_add_f32 v5, v5, v18
    v_add_f32 v5, v5, v19
    v_mfma_f32_16x16x32_bf16 v[188:191], v[36:39], v[220:223], v[188:191]
    s_waitcnt lgkmcnt(2)
    v_exp_f32 v17, v101
    v_mfma_f32_16x16x32_bf16 v[112:115], v[40:43], a[208:211], v[112:115]
    ds_read_b128 v[32:35], v1 offset:768
    v_cvt_pk_bf16_f32 v165, v18, v19
    v_mfma_f32_16x16x32_bf16 v[112:115], v[44:47], a[212:215], v[112:115]
    v_exp_f32 v18, v102
    v_mfma_f32_16x16x32_bf16 v[116:119], v[40:43], a[232:235], v[116:119]
    v_cvt_pk_bf16_f32 v147, v248, v252
    v_add_f32 v5, v5, v16
    v_mfma_f32_16x16x32_bf16 v[116:119], v[44:47], a[236:239], v[116:119]
    v_add_f32 v5, v5, v17
    v_cvt_pk_bf16_f32 v151, v249, v253
    v_mfma_f32_16x16x32_bf16 v[120:123], v[40:43], v[192:195], v[120:123]
    ds_read_b128 v[36:39], v1 offset:13056
    v_cvt_pk_bf16_f32 v155, v250, v254
    v_mfma_f32_16x16x32_bf16 v[120:123], v[44:47], v[196:199], v[120:123]
    v_exp_f32 v19, v103
    v_mfma_f32_16x16x32_bf16 v[124:127], v[40:43], v[216:219], v[124:127]
    v_cvt_pk_bf16_f32 v166, v16, v17
    v_add_f32 v5, v5, v18
    v_mfma_f32_16x16x32_bf16 v[124:127], v[44:47], v[220:223], v[124:127]
    s_waitcnt lgkmcnt(2)
    v_add_f32 v5, v5, v19
    v_cvt_pk_bf16_f32 v167, v18, v19
    v_cvt_pk_bf16_f32 v159, v251, v255
    v_mfma_f32_16x16x32_bf16 a[0:3], v[64:67], v[24:27], a[0:3]
    ds_read_b128 v[40:43], v1 offset:1536
    v_bfe_u32 v53, v8, 4, 6
    v_mfma_f32_16x16x32_bf16 a[0:3], v[80:83], v[28:31], a[0:3]
    v_exp_f32 v16, v168
    v_mfma_f32_16x16x32_bf16 a[48:51], v[68:71], v[24:27], a[48:51]
    v_exp_f32 v17, v169
    v_mfma_f32_16x16x32_bf16 a[48:51], v[84:87], v[28:31], a[48:51]
    v_lshlrev_b32 v53, 2, v53
    v_mfma_f32_16x16x32_bf16 a[96:99], v[72:75], v[24:27], a[96:99]
    ds_read_b128 v[44:47], v1 offset:13824
    v_mfma_f32_16x16x32_bf16 a[96:99], v[88:91], v[28:31], a[96:99]
    buffer_store_dwordx4 v[144:147], v20, s[4:7], s81 offen offset:0 sc1
    v_mfma_f32_16x16x32_bf16 a[144:147], v[76:79], v[24:27], a[144:147]
    v_exp_f32 v18, v170
    v_mfma_f32_16x16x32_bf16 a[144:147], v[92:95], v[28:31], a[144:147]
    s_waitcnt lgkmcnt(2)
    v_add_f32 v6, v6, v16
    v_add_f32 v6, v6, v17
    v_mfma_f32_16x16x32_bf16 a[4:7], v[64:67], v[32:35], a[4:7]
    ds_read_b128 v[24:27], v1 offset:2304
    buffer_load_dword v52, v53, s[20:23], 0 offen sc1
    v_mfma_f32_16x16x32_bf16 a[4:7], v[80:83], v[36:39], a[4:7]
    v_exp_f32 v19, v171
    v_mfma_f32_16x16x32_bf16 a[52:55], v[68:71], v[32:35], a[52:55]
    s_mov_b32 m0, s56
    v_cvt_pk_bf16_f32 v168, v16, v17
    v_mfma_f32_16x16x32_bf16 a[52:55], v[84:87], v[36:39], a[52:55]
    v_exp_f32 v16, v104
    v_mfma_f32_16x16x32_bf16 a[100:103], v[72:75], v[32:35], a[100:103]
    ds_read_b128 v[28:31], v1 offset:14592
    v_add_f32 v6, v6, v18
    v_mfma_f32_16x16x32_bf16 a[100:103], v[88:91], v[36:39], a[100:103]
    v_add_f32 v6, v6, v19
    v_mfma_f32_16x16x32_bf16 a[148:151], v[76:79], v[32:35], a[148:151]
    v_exp_f32 v17, v105
    v_mfma_f32_16x16x32_bf16 a[148:151], v[92:95], v[36:39], a[148:151]
    s_waitcnt lgkmcnt(2)
    buffer_load_dwordx4 v8, s[4:7], s27 offen offset:0 sc1 lds
    v_mfma_f32_16x16x32_bf16 a[8:11], v[64:67], v[40:43], a[8:11]
    ds_read_b128 v[32:35], v21 offset:0
    v_cvt_pk_bf16_f32 v169, v18, v19
    v_mfma_f32_16x16x32_bf16 a[8:11], v[80:83], v[44:47], a[8:11]
    v_exp_f32 v18, v106
    v_mfma_f32_16x16x32_bf16 a[56:59], v[68:71], v[40:43], a[56:59]
    v_add_f32 v6, v6, v16
    v_add_f32 v6, v6, v17
    v_mfma_f32_16x16x32_bf16 a[56:59], v[84:87], v[44:47], a[56:59]
    v_exp_f32 v19, v107
    v_mfma_f32_16x16x32_bf16 a[104:107], v[72:75], v[40:43], a[104:107]
    ds_read_b128 v[36:39], v21 offset:12288
    v_cvt_pk_bf16_f32 v170, v16, v17
    v_mfma_f32_16x16x32_bf16 a[104:107], v[88:91], v[44:47], a[104:107]
    buffer_store_dwordx4 v[148:151], v20, s[4:7], s81 offen offset:768 sc1
    v_mfma_f32_16x16x32_bf16 a[152:155], v[76:79], v[40:43], a[152:155]
    v_exp_f32 v16, v172
    v_mfma_f32_16x16x32_bf16 a[152:155], v[92:95], v[44:47], a[152:155]
    s_waitcnt lgkmcnt(2)
    v_add_f32 v6, v6, v18
    v_add_f32 v6, v6, v19
    v_mfma_f32_16x16x32_bf16 a[12:15], v[64:67], v[24:27], a[12:15]
    ds_read_b128 v[40:43], v21 offset:768
    v_mfma_f32_16x16x32_bf16 a[12:15], v[80:83], v[28:31], a[12:15]
    buffer_load_dwordx4 v8, s[4:7], s27 offen offset:1024 sc1 lds
    v_mfma_f32_16x16x32_bf16 a[60:63], v[68:71], v[24:27], a[60:63]
    v_exp_f32 v17, v173
    v_mfma_f32_16x16x32_bf16 a[60:63], v[84:87], v[28:31], a[60:63]
    v_cvt_pk_bf16_f32 v171, v18, v19
    v_mfma_f32_16x16x32_bf16 a[108:111], v[72:75], v[24:27], a[108:111]
    ds_read_b128 v[44:47], v21 offset:13056
    v_mfma_f32_16x16x32_bf16 a[108:111], v[88:91], v[28:31], a[108:111]
    v_exp_f32 v18, v174
    v_mfma_f32_16x16x32_bf16 a[156:159], v[76:79], v[24:27], a[156:159]
    s_add_u32 s29, s28, 49152
    v_add_f32 v7, v7, v16
    v_add_f32 v7, v7, v17
    v_mfma_f32_16x16x32_bf16 a[156:159], v[92:95], v[28:31], a[156:159]
    s_waitcnt lgkmcnt(2)
    v_exp_f32 v19, v175
    v_mfma_f32_16x16x32_bf16 a[16:19], v[64:67], v[32:35], a[16:19]
    ds_read_b128 v[24:27], v21 offset:1536
    v_cvt_pk_bf16_f32 v172, v16, v17
    v_mfma_f32_16x16x32_bf16 a[16:19], v[80:83], v[36:39], a[16:19]
    s_sub_u32 s3, s29, 147456
    v_exp_f32 v16, v108
    v_mfma_f32_16x16x32_bf16 a[64:67], v[68:71], v[32:35], a[64:67]
    v_add_f32 v7, v7, v18
    v_mfma_f32_16x16x32_bf16 a[64:67], v[84:87], v[36:39], a[64:67]
    v_add_f32 v7, v7, v19
    v_mfma_f32_16x16x32_bf16 a[112:115], v[72:75], v[32:35], a[112:115]
    ds_read_b128 v[28:31], v21 offset:13824
    v_mfma_f32_16x16x32_bf16 a[112:115], v[88:91], v[36:39], a[112:115]
    buffer_store_dwordx4 v[152:155], v20, s[4:7], s81 offen offset:1536 sc1
    v_mfma_f32_16x16x32_bf16 a[160:163], v[76:79], v[32:35], a[160:163]
    v_exp_f32 v17, v109
    v_mfma_f32_16x16x32_bf16 a[160:163], v[92:95], v[36:39], a[160:163]
    s_waitcnt lgkmcnt(2)
    v_cvt_pk_bf16_f32 v173, v18, v19
    v_mfma_f32_16x16x32_bf16 a[20:23], v[64:67], v[40:43], a[20:23]
    s_min_u32 s29, s29, s3
    ds_read_b128 v[32:35], v21 offset:2304
    v_mfma_f32_16x16x32_bf16 a[20:23], v[80:83], v[44:47], a[20:23]
    buffer_load_dwordx4 v8, s[4:7], s27 offen offset:2048 sc1 lds
    v_mfma_f32_16x16x32_bf16 a[68:71], v[68:71], v[40:43], a[68:71]
    v_exp_f32 v18, v110
    v_mfma_f32_16x16x32_bf16 a[68:71], v[84:87], v[44:47], a[68:71]
    s_add_u32 s27, s27, 24576
    v_add_f32 v7, v7, v16
    v_add_f32 v7, v7, v17
    v_mfma_f32_16x16x32_bf16 a[116:119], v[72:75], v[40:43], a[116:119]
    ds_read_b128 v[36:39], v21 offset:14592
    v_mfma_f32_16x16x32_bf16 a[116:119], v[88:91], v[44:47], a[116:119]
    v_exp_f32 v19, v111
    v_mfma_f32_16x16x32_bf16 a[164:167], v[76:79], v[40:43], a[164:167]
    s_sub_u32 s3, s29, s28
    v_cvt_pk_bf16_f32 v174, v16, v17
    v_mfma_f32_16x16x32_bf16 a[164:167], v[92:95], v[44:47], a[164:167]
    s_waitcnt lgkmcnt(2)
    v_exp_f32 v16, v176
    v_mfma_f32_16x16x32_bf16 a[24:27], v[64:67], v[24:27], a[24:27]
    s_add_u32 s56, s56, 12288
    ds_read_b128 v[40:43], v22 offset:0
    v_add_f32 v7, v7, v18
    v_mfma_f32_16x16x32_bf16 a[24:27], v[80:83], v[28:31], a[24:27]
    v_add_f32 v7, v7, v19
    s_branch L_skip12
L_pad12:
    s_branch L_tb1_2
L_skip12:
    v_mfma_f32_16x16x32_bf16 a[72:75], v[68:71], v[24:27], a[72:75]
    v_exp_f32 v17, v177
    v_mfma_f32_16x16x32_bf16 a[72:75], v[84:87], v[28:31], a[72:75]
    v_cvt_pk_bf16_f32 v175, v18, v19
    v_mfma_f32_16x16x32_bf16 a[120:123], v[72:75], v[24:27], a[120:123]
    ds_read_b128 v[44:47], v22 offset:12288
    v_mfma_f32_16x16x32_bf16 a[120:123], v[88:91], v[28:31], a[120:123]
    buffer_store_dwordx4 v[156:159], v20, s[4:7], s81 offen offset:2304 sc1
    v_mfma_f32_16x16x32_bf16 a[168:171], v[76:79], v[24:27], a[168:171]
    s_mov_b32 m0, s56
    v_exp_f32 v18, v178
    v_mfma_f32_16x16x32_bf16 a[168:171], v[92:95], v[28:31], a[168:171]
    s_waitcnt lgkmcnt(2)
    v_add_f32 v4, v4, v16
    v_add_f32 v4, v4, v17
    v_mfma_f32_16x16x32_bf16 a[28:31], v[64:67], v[32:35], a[28:31]
    s_mov_b32 s28, s29
    ds_read_b128 v[24:27], v22 offset:768
    v_mfma_f32_16x16x32_bf16 a[28:31], v[80:83], v[36:39], a[28:31]
    v_exp_f32 v19, v179
    v_mfma_f32_16x16x32_bf16 a[76:79], v[68:71], v[32:35], a[76:79]
    v_cvt_pk_bf16_f32 v176, v16, v17
    v_mfma_f32_16x16x32_bf16 a[76:79], v[84:87], v[36:39], a[76:79]
    v_exp_f32 v16, v112
    v_mfma_f32_16x16x32_bf16 a[124:127], v[72:75], v[32:35], a[124:127]
    ds_read_b128 v[28:31], v22 offset:13056
    v_add_f32 v4, v4, v18
    v_mfma_f32_16x16x32_bf16 a[124:127], v[88:91], v[36:39], a[124:127]
    buffer_load_dwordx4 v8, s[4:7], s27 offen offset:0 sc1 lds
    v_mfma_f32_16x16x32_bf16 a[172:175], v[76:79], v[32:35], a[172:175]
    v_add_f32 v4, v4, v19
    v_add_u32 v2, s3, v2
    v_mfma_f32_16x16x32_bf16 a[172:175], v[92:95], v[36:39], a[172:175]
    s_waitcnt lgkmcnt(2)
    v_exp_f32 v17, v113
    v_mfma_f32_16x16x32_bf16 a[32:35], v[64:67], v[40:43], a[32:35]
    ds_read_b128 v[32:35], v22 offset:1536
    v_cvt_pk_bf16_f32 v177, v18, v19
    v_mfma_f32_16x16x32_bf16 a[32:35], v[80:83], v[44:47], a[32:35]
    v_exp_f32 v18, v114
    v_mfma_f32_16x16x32_bf16 a[80:83], v[68:71], v[40:43], a[80:83]
    v_add_f32 v4, v4, v16
    v_add_f32 v4, v4, v17
    v_mfma_f32_16x16x32_bf16 a[80:83], v[84:87], v[44:47], a[80:83]
    v_exp_f32 v19, v115
    v_mfma_f32_16x16x32_bf16 a[128:131], v[72:75], v[40:43], a[128:131]
    ds_read_b128 v[36:39], v22 offset:13824
    v_cvt_pk_bf16_f32 v178, v16, v17
    v_mfma_f32_16x16x32_bf16 a[128:131], v[88:91], v[44:47], a[128:131]
    v_exp_f32 v16, v180
    v_mfma_f32_16x16x32_bf16 a[176:179], v[76:79], v[40:43], a[176:179]
    v_add_u32 v3, s3, v3
    v_add_f32 v4, v4, v18
    v_mfma_f32_16x16x32_bf16 a[176:179], v[92:95], v[44:47], a[176:179]
    s_waitcnt lgkmcnt(2)
    v_add_f32 v4, v4, v19
    v_mfma_f32_16x16x32_bf16 a[36:39], v[64:67], v[24:27], a[36:39]
    ds_read_b128 v[40:43], v22 offset:2304
    v_mfma_f32_16x16x32_bf16 a[36:39], v[80:83], v[28:31], a[36:39]
    buffer_load_dwordx4 v8, s[4:7], s27 offen offset:1024 sc1 lds
    v_mfma_f32_16x16x32_bf16 a[84:87], v[68:71], v[24:27], a[84:87]
    v_exp_f32 v17, v181
    v_mfma_f32_16x16x32_bf16 a[84:87], v[84:87], v[28:31], a[84:87]
    v_cvt_pk_bf16_f32 v179, v18, v19
    v_mfma_f32_16x16x32_bf16 a[132:135], v[72:75], v[24:27], a[132:135]
    ds_read_b128 v[44:47], v22 offset:14592
    v_mfma_f32_16x16x32_bf16 a[132:135], v[88:91], v[28:31], a[132:135]
    s_waitcnt lgkmcnt(2)
    v_exp_f32 v18, v182
    v_mfma_f32_16x16x32_bf16 a[180:183], v[76:79], v[24:27], a[180:183]
    s_waitcnt vmcnt(25)
    v_add_f32 v5, v5, v16
    v_add_f32 v5, v5, v17
    v_mfma_f32_16x16x32_bf16 a[180:183], v[92:95], v[28:31], a[180:183]
    s_barrier
    v_mfma_f32_16x16x32_bf16 a[40:43], v[64:67], v[32:35], a[40:43]
    ds_read_b128 v[24:27], v2 offset:0
    v_mfma_f32_16x16x32_bf16 a[40:43], v[80:83], v[36:39], a[40:43]
    v_exp_f32 v19, v183
    v_mfma_f32_16x16x32_bf16 a[88:91], v[68:71], v[32:35], a[88:91]
    v_cvt_pk_bf16_f32 v180, v16, v17
    v_mfma_f32_16x16x32_bf16 a[88:91], v[84:87], v[36:39], a[88:91]
    buffer_load_dwordx4 v8, s[4:7], s27 offen offset:2048 sc1 lds
    v_mfma_f32_16x16x32_bf16 a[136:139], v[72:75], v[32:35], a[136:139]
    ds_read_b128 v[28:31], v3 offset:0
    v_mfma_f32_16x16x32_bf16 a[136:139], v[88:91], v[36:39], a[136:139]
    v_exp_f32 v16, v116
    v_mfma_f32_16x16x32_bf16 a[184:187], v[76:79], v[32:35], a[184:187]
    v_add_f32 v5, v5, v18
    v_add_f32 v5, v5, v19
    v_mfma_f32_16x16x32_bf16 a[184:187], v[92:95], v[36:39], a[184:187]
    s_waitcnt lgkmcnt(2)
    v_exp_f32 v17, v117
    v_mfma_f32_16x16x32_bf16 a[44:47], v[64:67], v[40:43], a[44:47]
    ds_read_b128 v[32:35], v2 offset:6144
    v_cvt_pk_bf16_f32 v181, v18, v19
    v_mfma_f32_16x16x32_bf16 a[44:47], v[80:83], v[44:47], a[44:47]
    v_exp_f32 v18, v118
    v_mfma_f32_16x16x32_bf16 a[92:95], v[68:71], v[40:43], a[92:95]
    v_add_f32 v5, v5, v16
    v_add_f32 v5, v5, v17
    v_mfma_f32_16x16x32_bf16 a[92:95], v[84:87], v[44:47], a[92:95]
    v_exp_f32 v19, v119
    v_mfma_f32_16x16x32_bf16 a[140:143], v[72:75], v[40:43], a[140:143]
    ds_read_b128 v[36:39], v3 offset:6144
    v_cvt_pk_bf16_f32 v182, v16, v17
    v_mfma_f32_16x16x32_bf16 a[140:143], v[88:91], v[44:47], a[140:143]
    s_add_u32 s27, s27, 24576
    v_add_f32 v5, v5, v18
    s_add_u32 s56, s56, 36864
    v_mfma_f32_16x16x32_bf16 a[188:191], v[76:79], v[40:43], a[188:191]
    s_sub_u32 s58, s56, 147456
    v_add_f32 v5, v5, v19
    v_cvt_pk_bf16_f32 v183, v18, v19
    v_mfma_f32_16x16x32_bf16 a[188:191], v[92:95], v[44:47], a[188:191]
    s_waitcnt lgkmcnt(2)
    s_min_u32 s56, s56, s58
    v_mfma_f32_16x16x32_bf16 v[64:67], v[24:27], a[192:195], v[128:131]
    ds_read_b128 v[40:43], v2 offset:128
    v_mfma_f32_16x16x32_bf16 v[64:67], v[28:31], a[196:199], v[64:67]
    v_exp_f32 v16, v184
    v_mfma_f32_16x16x32_bf16 v[68:71], v[24:27], a[216:219], v[132:135]
    v_exp_f32 v17, v185
    v_mfma_f32_16x16x32_bf16 v[68:71], v[28:31], a[220:223], v[68:71]
    v_exp_f32 v18, v186
    v_mfma_f32_16x16x32_bf16 v[72:75], v[24:27], a[240:243], v[136:139]
    ds_read_b128 v[44:47], v3 offset:128
    v_mfma_f32_16x16x32_bf16 v[72:75], v[28:31], a[244:247], v[72:75]
    v_add_f32 v6, v6, v16
    v_add_f32 v6, v6, v17
    v_mfma_f32_16x16x32_bf16 v[76:79], v[24:27], v[200:203], v[140:143]
    v_mfma_f32_16x16x32_bf16 v[76:79], v[28:31], v[204:207], v[76:79]
    s_waitcnt lgkmcnt(2)
    v_exp_f32 v19, v187
    v_mfma_f32_16x16x32_bf16 v[96:99], v[32:35], a[192:195], v[128:131]
    ds_read_b128 v[24:27], v2 offset:6272
    v_cvt_pk_bf16_f32 v184, v16, v17
    v_mfma_f32_16x16x32_bf16 v[96:99], v[36:39], a[196:199], v[96:99]
    v_mfma_f32_16x16x32_bf16 v[100:103], v[32:35], a[216:219], v[132:135]
    v_exp_f32 v16, v120
    v_mfma_f32_16x16x32_bf16 v[100:103], v[36:39], a[220:223], v[100:103]
    v_add_f32 v6, v6, v18
    v_mfma_f32_16x16x32_bf16 v[104:107], v[32:35], a[240:243], v[136:139]
    ds_read_b128 v[28:31], v3 offset:6272
    v_add_f32 v6, v6, v19
    v_mfma_f32_16x16x32_bf16 v[104:107], v[36:39], a[244:247], v[104:107]
    v_exp_f32 v17, v121
    v_mfma_f32_16x16x32_bf16 v[108:111], v[32:35], v[200:203], v[140:143]
    v_mfma_f32_16x16x32_bf16 v[108:111], v[36:39], v[204:207], v[108:111]
    s_waitcnt lgkmcnt(2)
    v_cvt_pk_bf16_f32 v185, v18, v19
    v_mfma_f32_16x16x32_bf16 v[64:67], v[40:43], a[200:203], v[64:67]
    ds_read_b128 v[32:35], v2 offset:256
    v_mfma_f32_16x16x32_bf16 v[64:67], v[44:47], a[204:207], v[64:67]
    v_exp_f32 v18, v122
    v_mfma_f32_16x16x32_bf16 v[68:71], v[40:43], a[224:227], v[68:71]
    v_add_f32 v6, v6, v16
    v_add_f32 v6, v6, v17
    v_mfma_f32_16x16x32_bf16 v[68:71], v[44:47], a[228:231], v[68:71]
    v_mfma_f32_16x16x32_bf16 v[72:75], v[40:43], a[248:251], v[72:75]
    ds_read_b128 v[36:39], v3 offset:256
    v_mfma_f32_16x16x32_bf16 v[72:75], v[44:47], a[252:255], v[72:75]
    v_exp_f32 v19, v123
    v_mfma_f32_16x16x32_bf16 v[76:79], v[40:43], v[208:211], v[76:79]
    v_cvt_pk_bf16_f32 v186, v16, v17
    v_mfma_f32_16x16x32_bf16 v[76:79], v[44:47], v[212:215], v[76:79]
    s_waitcnt lgkmcnt(2)
    v_exp_f32 v16, v188
    v_mfma_f32_16x16x32_bf16 v[96:99], v[24:27], a[200:203], v[96:99]
    ds_read_b128 v[40:43], v2 offset:6400
    v_add_f32 v6, v6, v18
    v_mfma_f32_16x16x32_bf16 v[96:99], v[28:31], a[204:207], v[96:99]
    v_add_f32 v6, v6, v19
    v_mfma_f32_16x16x32_bf16 v[100:103], v[24:27], a[224:227], v[100:103]
    v_exp_f32 v17, v189
    v_mfma_f32_16x16x32_bf16 v[100:103], v[28:31], a[228:231], v[100:103]
    v_cvt_pk_bf16_f32 v187, v18, v19
    v_mfma_f32_16x16x32_bf16 v[104:107], v[24:27], a[248:251], v[104:107]
    ds_read_b128 v[44:47], v3 offset:6400
    v_mfma_f32_16x16x32_bf16 v[104:107], v[28:31], a[252:255], v[104:107]
    s_waitcnt vmcnt(9)
    v_subrev_u32 v52, s92, v52
    v_cmp_lt_u32 vcc, 15, v52
    v_mfma_f32_16x16x32_bf16 v[108:111], v[24:27], v[208:211], v[108:111]
    s_add_u32 s29, s30, 49152
    v_exp_f32 v18, v190
    v_mfma_f32_16x16x32_bf16 v[108:111], v[28:31], v[212:215], v[108:111]
    s_waitcnt lgkmcnt(2)
    v_add_f32 v7, v7, v16
    v_add_f32 v7, v7, v17
    v_mfma_f32_16x16x32_bf16 v[64:67], v[32:35], a[208:211], v[64:67]
    s_and_b32 s59, vcc_lo, 0xff
    ds_read_b128 v[24:27], v2 offset:12288
    v_mfma_f32_16x16x32_bf16 v[64:67], v[36:39], a[212:215], v[64:67]
    s_cbranch_scc1 L_pollslow6
L_pollok6:
    v_mfma_f32_16x16x32_bf16 v[68:71], v[32:35], a[232:235], v[68:71]
    s_add_u32 s92, s92, 1
    v_exp_f32 v19, v191
    v_mfma_f32_16x16x32_bf16 v[68:71], v[36:39], a[236:239], v[68:71]
    s_sub_u32 s3, s29, 147456
    v_cvt_pk_bf16_f32 v188, v16, v17
    v_mfma_f32_16x16x32_bf16 v[72:75], v[32:35], v[192:195], v[72:75]
    s_mov_b32 m0, s26
    ds_read_b128 v[28:31], v3 offset:12288
    v_mfma_f32_16x16x32_bf16 v[72:75], v[36:39], v[196:199], v[72:75]
    v_exp_f32 v16, v124
    v_mfma_f32_16x16x32_bf16 v[76:79], v[32:35], v[216:219], v[76:79]
    s_min_u32 s29, s29, s3
    v_add_f32 v7, v7, v18
    v_add_f32 v7, v7, v19
    v_mfma_f32_16x16x32_bf16 v[76:79], v[36:39], v[220:223], v[76:79]
    s_waitcnt lgkmcnt(2)
    buffer_load_dwordx4 v8, s[4:7], s32 offen offset:0 sc1 lds
    v_mfma_f32_16x16x32_bf16 v[96:99], v[40:43], a[208:211], v[96:99]
    ds_read_b128 v[32:35], v2 offset:18432
    v_mfma_f32_16x16x32_bf16 v[96:99], v[44:47], a[212:215], v[96:99]
    v_exp_f32 v17, v125
    v_mfma_f32_16x16x32_bf16 v[100:103], v[40:43], a[232:235], v[100:103]
    v_cvt_pk_bf16_f32 v189, v18, v19
    v_mfma_f32_16x16x32_bf16 v[100:103], v[44:47], a[236:239], v[100:103]
    buffer_load_dwordx4 v8, s[4:7], s32 offen offset:1024 sc1 lds
    v_mfma_f32_16x16x32_bf16 v[104:107], v[40:43], v[192:195], v[104:107]
    s_sub_u32 s3, s29, s30
    ds_read_b128 v[36:39], v3 offset:18432
    v_mfma_f32_16x16x32_bf16 v[104:107], v[44:47], v[196:199], v[104:107]
    v_exp_f32 v18, v126
    v_mfma_f32_16x16x32_bf16 v[108:111], v[40:43], v[216:219], v[108:111]
    v_add_f32 v7, v7, v16
    v_add_f32 v7, v7, v17
    v_mfma_f32_16x16x32_bf16 v[108:111], v[44:47], v[220:223], v[108:111]
    s_waitcnt lgkmcnt(2)
    v_exp_f32 v19, v127
    v_mfma_f32_16x16x32_bf16 v[80:83], v[24:27], a[192:195], v[128:131]
    ds_read_b128 v[40:43], v2 offset:12416
    v_cvt_pk_bf16_f32 v190, v16, v17
    v_mfma_f32_16x16x32_bf16 v[80:83], v[28:31], a[196:199], v[80:83]
    buffer_load_dwordx4 v8, s[4:7], s32 offen offset:2048 sc1 lds
    v_mfma_f32_16x16x32_bf16 v[84:87], v[24:27], a[216:219], v[132:135]
    v_add_f32 v7, v7, v18
    v_add_f32 v7, v7, v19
    v_cvt_pk_bf16_f32 v191, v18, v19
    v_mfma_f32_16x16x32_bf16 v[84:87], v[28:31], a[220:223], v[84:87]
    s_mov_b32 s30, s29
    v_mfma_f32_16x16x32_bf16 v[88:91], v[24:27], a[240:243], v[136:139]
    s_add_u32 s32, s32, 24576
    ds_read_b128 v[44:47], v3 offset:12416
    v_mfma_f32_16x16x32_bf16 v[88:91], v[28:31], a[244:247], v[88:91]
    v_exp_f32 v16, v64
    v_mfma_f32_16x16x32_bf16 v[92:95], v[24:27], v[200:203], v[140:143]
    v_exp_f32 v17, v65
    v_mfma_f32_16x16x32_bf16 v[92:95], v[28:31], v[204:207], v[92:95]
    s_waitcnt lgkmcnt(2)
    v_exp_f32 v18, v66
    v_mfma_f32_16x16x32_bf16 v[112:115], v[32:35], a[192:195], v[128:131]
    s_add_u32 s26, s26, 12288
    ds_read_b128 v[24:27], v2 offset:18560
    v_add_f32 v4, v4, v16
    v_mfma_f32_16x16x32_bf16 v[112:115], v[36:39], a[196:199], v[112:115]
    s_mov_b32 m0, s26
    v_add_f32 v4, v4, v17
    v_add_u32 v1, s3, v1
    v_mfma_f32_16x16x32_bf16 v[116:119], v[32:35], a[216:219], v[132:135]
    v_exp_f32 v19, v67
    v_mfma_f32_16x16x32_bf16 v[116:119], v[36:39], a[220:223], v[116:119]
    v_cvt_pk_bf16_f32 v64, v16, v17
    v_mfma_f32_16x16x32_bf16 v[120:123], v[32:35], a[240:243], v[136:139]
    ds_read_b128 v[28:31], v3 offset:18560
    v_mfma_f32_16x16x32_bf16 v[120:123], v[36:39], a[244:247], v[120:123]
    buffer_load_dwordx4 v8, s[4:7], s32 offen offset:0 sc1 lds
    v_mfma_f32_16x16x32_bf16 v[124:127], v[32:35], v[200:203], v[140:143]
    v_exp_f32 v16, v96
    v_mfma_f32_16x16x32_bf16 v[124:127], v[36:39], v[204:207], v[124:127]
    s_waitcnt lgkmcnt(2)
    v_add_f32 v4, v4, v18
    v_add_f32 v4, v4, v19
    v_mfma_f32_16x16x32_bf16 v[80:83], v[40:43], a[200:203], v[80:83]
    ds_read_b128 v[32:35], v2 offset:12544
    v_add_u32 v21, s3, v21
    v_mfma_f32_16x16x32_bf16 v[80:83], v[44:47], a[204:207], v[80:83]
    v_exp_f32 v17, v97
    v_mfma_f32_16x16x32_bf16 v[84:87], v[40:43], a[224:227], v[84:87]
    v_cvt_pk_bf16_f32 v65, v18, v19
    v_mfma_f32_16x16x32_bf16 v[84:87], v[44:47], a[228:231], v[84:87]
    buffer_load_dwordx4 v8, s[4:7], s32 offen offset:1024 sc1 lds
    v_mfma_f32_16x16x32_bf16 v[88:91], v[40:43], a[248:251], v[88:91]
    ds_read_b128 v[36:39], v3 offset:12544
    v_add_u32 v22, s3, v22
    v_mfma_f32_16x16x32_bf16 v[88:91], v[44:47], a[252:255], v[88:91]
    v_exp_f32 v18, v98
    v_mfma_f32_16x16x32_bf16 v[92:95], v[40:43], v[208:211], v[92:95]
    v_add_f32 v4, v4, v16
    v_add_f32 v4, v4, v17
    v_mfma_f32_16x16x32_bf16 v[92:95], v[44:47], v[212:215], v[92:95]
    s_waitcnt lgkmcnt(2)
    buffer_load_dwordx4 v8, s[4:7], s32 offen offset:2048 sc1 lds
    v_mfma_f32_16x16x32_bf16 v[112:115], v[24:27], a[200:203], v[112:115]
    ds_read_b128 v[40:43], v2 offset:18688
    v_mfma_f32_16x16x32_bf16 v[112:115], v[28:31], a[204:207], v[112:115]
    v_exp_f32 v19, v99
    v_mfma_f32_16x16x32_bf16 v[116:119], v[24:27], a[224:227], v[116:119]
    v_cvt_pk_bf16_f32 v66, v16, v17
    v_mfma_f32_16x16x32_bf16 v[116:119], v[28:31], a[228:231], v[116:119]
    v_exp_f32 v16, v68
    v_mfma_f32_16x16x32_bf16 v[120:123], v[24:27], a[248:251], v[120:123]
    ds_read_b128 v[44:47], v3 offset:18688
    v_add_f32 v4, v4, v18
    v_mfma_f32_16x16x32_bf16 v[120:123], v[28:31], a[252:255], v[120:123]
    s_waitcnt lgkmcnt(2)
    v_add_f32 v4, v4, v19
    s_add_u32 s32, s32, 24576
    v_mfma_f32_16x16x32_bf16 v[124:127], v[24:27], v[208:211], v[124:127]
    s_waitcnt vmcnt(9)
    v_exp_f32 v17, v69
    v_mfma_f32_16x16x32_bf16 v[124:127], v[28:31], v[212:215], v[124:127]
    s_barrier
    v_cvt_pk_bf16_f32 v67, v18, v19
    v_mfma_f32_16x16x32_bf16 v[80:83], v[32:35], a[208:211], v[80:83]
    s_add_u32 s26, s26, 36864
    ds_read_b128 v[24:27], v1 offset:0
    v_add_u32 v55, 1, v55
    v_mfma_f32_16x16x32_bf16 v[80:83], v[36:39], a[212:215], v[80:83]
    s_sub_u32 s57, s26, 147456
    v_exp_f32 v18, v70
    v_mfma_f32_16x16x32_bf16 v[84:87], v[32:35], a[232:235], v[84:87]
    v_add_f32 v5, v5, v16
    v_add_f32 v5, v5, v17
    v_mfma_f32_16x16x32_bf16 v[84:87], v[36:39], a[236:239], v[84:87]
    v_exp_f32 v19, v71
    v_mfma_f32_16x16x32_bf16 v[88:91], v[32:35], v[192:195], v[88:91]
    s_min_u32 s26, s26, s57
    ds_read_b128 v[28:31], v1 offset:12288
    v_cvt_pk_bf16_f32 v68, v16, v17
    v_mfma_f32_16x16x32_bf16 v[88:91], v[36:39], v[196:199], v[88:91]
    buffer_store_dword v55, v13, s[20:23], 0 offen sc1
    v_mfma_f32_16x16x32_bf16 v[92:95], v[32:35], v[216:219], v[92:95]
    v_exp_f32 v16, v100
    v_mfma_f32_16x16x32_bf16 v[92:95], v[36:39], v[220:223], v[92:95]
    s_waitcnt lgkmcnt(2)
    v_add_f32 v5, v5, v18
    v_add_f32 v5, v5, v19
    v_mfma_f32_16x16x32_bf16 v[112:115], v[40:43], a[208:211], v[112:115]
    ds_read_b128 v[32:35], v1 offset:768
    v_mfma_f32_16x16x32_bf16 v[112:115], v[44:47], a[212:215], v[112:115]
    v_exp_f32 v17, v101
    v_mfma_f32_16x16x32_bf16 v[116:119], v[40:43], a[232:235], v[116:119]
    v_cvt_pk_bf16_f32 v69, v18, v19
    v_mfma_f32_16x16x32_bf16 v[116:119], v[44:47], a[236:239], v[116:119]
    v_exp_f32 v18, v102
    v_mfma_f32_16x16x32_bf16 v[120:123], v[40:43], v[192:195], v[120:123]
    ds_read_b128 v[36:39], v1 offset:13056
    v_add_f32 v5, v5, v16
    v_mfma_f32_16x16x32_bf16 v[120:123], v[44:47], v[196:199], v[120:123]
    v_add_f32 v5, v5, v17
    v_mfma_f32_16x16x32_bf16 v[124:127], v[40:43], v[216:219], v[124:127]
    v_exp_f32 v19, v103
    v_mfma_f32_16x16x32_bf16 v[124:127], v[44:47], v[220:223], v[124:127]
    s_waitcnt lgkmcnt(2)
    v_cvt_pk_bf16_f32 v70, v16, v17
    v_add_f32 v5, v5, v18
    v_add_f32 v5, v5, v19
    v_cvt_pk_bf16_f32 v71, v18, v19
    s_mov_b32 s31, 2
.p2align 6
L_loop2:
    v_mfma_f32_16x16x32_bf16 a[0:3], v[160:163], v[24:27], a[0:3]
    s_mov_b32 m0, s56
    ds_read_b128 v[40:43], v1 offset:1536
    v_mfma_f32_16x16x32_bf16 a[0:3], v[176:179], v[28:31], a[0:3]
    v_exp_f32 v16, v72
    v_mfma_f32_16x16x32_bf16 a[48:51], v[164:167], v[24:27], a[48:51]
    v_exp_f32 v17, v73
    v_mfma_f32_16x16x32_bf16 a[48:51], v[180:183], v[28:31], a[48:51]
    v_exp_f32 v18, v74
    v_mfma_f32_16x16x32_bf16 a[96:99], v[168:171], v[24:27], a[96:99]
    ds_read_b128 v[44:47], v1 offset:13824
    v_add_f32 v6, v6, v16
    v_mfma_f32_16x16x32_bf16 a[96:99], v[184:187], v[28:31], a[96:99]
    buffer_load_dwordx4 v8, s[4:7], s27 offen offset:0 sc1 lds
    v_mfma_f32_16x16x32_bf16 a[144:147], v[172:175], v[24:27], a[144:147]
    v_add_f32 v6, v6, v17
    v_mfma_f32_16x16x32_bf16 a[144:147], v[188:191], v[28:31], a[144:147]
    s_waitcnt lgkmcnt(2)
    v_exp_f32 v19, v75
    v_mfma_f32_16x16x32_bf16 a[4:7], v[160:163], v[32:35], a[4:7]
    ds_read_b128 v[24:27], v1 offset:2304
    v_cvt_pk_bf16_f32 v72, v16, v17
    v_mfma_f32_16x16x32_bf16 a[4:7], v[176:179], v[36:39], a[4:7]
    v_exp_f32 v16, v104
    v_mfma_f32_16x16x32_bf16 a[52:55], v[164:167], v[32:35], a[52:55]
    v_add_f32 v6, v6, v18
    v_mfma_f32_16x16x32_bf16 a[52:55], v[180:183], v[36:39], a[52:55]
    v_add_f32 v6, v6, v19
    v_mfma_f32_16x16x32_bf16 a[100:103], v[168:171], v[32:35], a[100:103]
    ds_read_b128 v[28:31], v1 offset:14592
    v_mfma_f32_16x16x32_bf16 a[100:103], v[184:187], v[36:39], a[100:103]
    v_exp_f32 v17, v105
    v_mfma_f32_16x16x32_bf16 a[148:151], v[172:175], v[32:35], a[148:151]
    v_cvt_pk_bf16_f32 v73, v18, v19
    v_mfma_f32_16x16x32_bf16 a[148:151], v[188:191], v[36:39], a[148:151]
    s_waitcnt lgkmcnt(2)
    buffer_load_dwordx4 v8, s[4:7], s27 offen offset:1024 sc1 lds
    v_mfma_f32_16x16x32_bf16 a[8:11], v[160:163], v[40:43], a[8:11]
    ds_read_b128 v[32:35], v21 offset:0
    v_mfma_f32_16x16x32_bf16 a[8:11], v[176:179], v[44:47], a[8:11]
    v_exp_f32 v18, v106
    v_mfma_f32_16x16x32_bf16 a[56:59], v[164:167], v[40:43], a[56:59]
    v_add_f32 v6, v6, v16
    v_add_f32 v6, v6, v17
    v_mfma_f32_16x16x32_bf16 a[56:59], v[180:183], v[44:47], a[56:59]
    v_exp_f32 v19, v107
    v_mfma_f32_16x16x32_bf16 a[104:107], v[168:171], v[40:43], a[104:107]
    ds_read_b128 v[36:39], v21 offset:12288
    v_cvt_pk_bf16_f32 v74, v16, v17
    v_mfma_f32_16x16x32_bf16 a[104:107], v[184:187], v[44:47], a[104:107]
    v_exp_f32 v16, v76
    v_mfma_f32_16x16x32_bf16 a[152:155], v[172:175], v[40:43], a[152:155]
    v_add_f32 v6, v6, v18
    v_mfma_f32_16x16x32_bf16 a[152:155], v[188:191], v[44:47], a[152:155]
    s_waitcnt lgkmcnt(2)
    buffer_load_dwordx4 v8, s[4:7], s27 offen offset:2048 sc1 lds
    v_mfma_f32_16x16x32_bf16 a[12:15], v[160:163], v[24:27], a[12:15]
    ds_read_b128 v[40:43], v21 offset:768
    v_add_f32 v6, v6, v19
    v_mfma_f32_16x16x32_bf16 a[12:15], v[176:179], v[28:31], a[12:15]
    v_exp_f32 v17, v77
    v_mfma_f32_16x16x32_bf16 a[60:63], v[164:167], v[24:27], a[60:63]
    v_cvt_pk_bf16_f32 v75, v18, v19
    v_mfma_f32_16x16x32_bf16 a[60:63], v[180:183], v[28:31], a[60:63]
    v_exp_f32 v18, v78
    v_mfma_f32_16x16x32_bf16 a[108:111], v[168:171], v[24:27], a[108:111]
    ds_read_b128 v[44:47], v21 offset:13056
    v_add_f32 v7, v7, v16
    v_mfma_f32_16x16x32_bf16 a[108:111], v[184:187], v[28:31], a[108:111]
    v_add_f32 v7, v7, v17
    v_mfma_f32_16x16x32_bf16 a[156:159], v[172:175], v[24:27], a[156:159]
    s_add_u32 s29, s28, 49152
    v_exp_f32 v19, v79
    v_mfma_f32_16x16x32_bf16 a[156:159], v[188:191], v[28:31], a[156:159]
    s_waitcnt lgkmcnt(2)
    s_add_u32 s27, s27, 24576
    v_mfma_f32_16x16x32_bf16 a[16:19], v[160:163], v[32:35], a[16:19]
    ds_read_b128 v[24:27], v21 offset:1536
    v_cvt_pk_bf16_f32 v76, v16, v17
    v_mfma_f32_16x16x32_bf16 a[16:19], v[176:179], v[36:39], a[16:19]
    s_sub_u32 s3, s29, 147456
    v_exp_f32 v16, v108
    v_mfma_f32_16x16x32_bf16 a[64:67], v[164:167], v[32:35], a[64:67]
    v_add_f32 v7, v7, v18
    v_mfma_f32_16x16x32_bf16 a[64:67], v[180:183], v[36:39], a[64:67]
    s_add_u32 s56, s56, 12288
    v_add_f32 v7, v7, v19
    v_mfma_f32_16x16x32_bf16 a[112:115], v[168:171], v[32:35], a[112:115]
    ds_read_b128 v[28:31], v21 offset:13824
    v_mfma_f32_16x16x32_bf16 a[112:115], v[184:187], v[36:39], a[112:115]
    v_exp_f32 v17, v109
    v_mfma_f32_16x16x32_bf16 a[160:163], v[172:175], v[32:35], a[160:163]
    v_cvt_pk_bf16_f32 v77, v18, v19
    v_mfma_f32_16x16x32_bf16 a[160:163], v[188:191], v[36:39], a[160:163]
    s_waitcnt lgkmcnt(2)
    v_exp_f32 v18, v110
    v_mfma_f32_16x16x32_bf16 a[20:23], v[160:163], v[40:43], a[20:23]
    s_mov_b32 m0, s56
    ds_read_b128 v[32:35], v21 offset:2304
    v_add_f32 v7, v7, v16
    v_mfma_f32_16x16x32_bf16 a[20:23], v[176:179], v[44:47], a[20:23]
    s_min_u32 s29, s29, s3
    v_add_f32 v7, v7, v17
    v_mfma_f32_16x16x32_bf16 a[68:71], v[164:167], v[40:43], a[68:71]
    v_exp_f32 v19, v111
    v_mfma_f32_16x16x32_bf16 a[68:71], v[180:183], v[44:47], a[68:71]
    v_mfma_f32_16x16x32_bf16 a[116:119], v[168:171], v[40:43], a[116:119]
    ds_read_b128 v[36:39], v21 offset:14592
    v_cvt_pk_bf16_f32 v78, v16, v17
    v_mfma_f32_16x16x32_bf16 a[116:119], v[184:187], v[44:47], a[116:119]
    v_exp_f32 v16, v80
    v_mfma_f32_16x16x32_bf16 a[164:167], v[172:175], v[40:43], a[164:167]
    s_sub_u32 s3, s29, s28
    v_add_f32 v7, v7, v18
    v_mfma_f32_16x16x32_bf16 a[164:167], v[188:191], v[44:47], a[164:167]
    s_waitcnt lgkmcnt(2)
    buffer_load_dwordx4 v8, s[4:7], s27 offen offset:0 sc1 lds
    v_mfma_f32_16x16x32_bf16 a[24:27], v[160:163], v[24:27], a[24:27]
    ds_read_b128 v[40:43], v22 offset:0
    v_add_f32 v7, v7, v19
    v_mfma_f32_16x16x32_bf16 a[24:27], v[176:179], v[28:31], a[24:27]
    v_exp_f32 v17, v81
    v_mfma_f32_16x16x32_bf16 a[72:75], v[164:167], v[24:27], a[72:75]
    v_cvt_pk_bf16_f32 v79, v18, v19
    v_mfma_f32_16x16x32_bf16 a[72:75], v[180:183], v[28:31], a[72:75]
    v_exp_f32 v18, v82
    v_mfma_f32_16x16x32_bf16 a[120:123], v[168:171], v[24:27], a[120:123]
    ds_read_b128 v[44:47], v22 offset:12288
    v_add_f32 v4, v4, v16
    v_mfma_f32_16x16x32_bf16 a[120:123], v[184:187], v[28:31], a[120:123]
    s_mov_b32 s28, s29
    v_add_f32 v4, v4, v17
    v_mfma_f32_16x16x32_bf16 a[168:171], v[172:175], v[24:27], a[168:171]
    v_exp_f32 v19, v83
    v_mfma_f32_16x16x32_bf16 a[168:171], v[188:191], v[28:31], a[168:171]
    s_waitcnt lgkmcnt(2)
    v_mfma_f32_16x16x32_bf16 a[28:31], v[160:163], v[32:35], a[28:31]
    ds_read_b128 v[24:27], v22 offset:768
    v_cvt_pk_bf16_f32 v80, v16, v17
    v_mfma_f32_16x16x32_bf16 a[28:31], v[176:179], v[36:39], a[28:31]
    buffer_load_dwordx4 v8, s[4:7], s27 offen offset:1024 sc1 lds
    v_mfma_f32_16x16x32_bf16 a[76:79], v[164:167], v[32:35], a[76:79]
    v_exp_f32 v16, v112
    v_mfma_f32_16x16x32_bf16 a[76:79], v[180:183], v[36:39], a[76:79]
    v_add_f32 v4, v4, v18
    v_add_f32 v4, v4, v19
    v_mfma_f32_16x16x32_bf16 a[124:127], v[168:171], v[32:35], a[124:127]
    ds_read_b128 v[28:31], v22 offset:13056
    v_add_u32 v2, s3, v2
    v_mfma_f32_16x16x32_bf16 a[124:127], v[184:187], v[36:39], a[124:127]
    v_exp_f32 v17, v113
    v_mfma_f32_16x16x32_bf16 a[172:175], v[172:175], v[32:35], a[172:175]
    v_cvt_pk_bf16_f32 v81, v18, v19
    v_mfma_f32_16x16x32_bf16 a[172:175], v[188:191], v[36:39], a[172:175]
    s_waitcnt lgkmcnt(2)
    v_exp_f32 v18, v114
    v_mfma_f32_16x16x32_bf16 a[32:35], v[160:163], v[40:43], a[32:35]
    ds_read_b128 v[32:35], v22 offset:1536
    v_add_f32 v4, v4, v16
    v_mfma_f32_16x16x32_bf16 a[32:35], v[176:179], v[44:47], a[32:35]
    buffer_load_dwordx4 v8, s[4:7], s27 offen offset:2048 sc1 lds
    v_mfma_f32_16x16x32_bf16 a[80:83], v[164:167], v[40:43], a[80:83]
    v_add_f32 v4, v4, v17
    v_add_u32 v3, s3, v3
    v_mfma_f32_16x16x32_bf16 a[80:83], v[180:183], v[44:47], a[80:83]
    v_exp_f32 v19, v115
    v_mfma_f32_16x16x32_bf16 a[128:131], v[168:171], v[40:43], a[128:131]
    ds_read_b128 v[36:39], v22 offset:13824
    v_cvt_pk_bf16_f32 v82, v16, v17
    v_mfma_f32_16x16x32_bf16 a[128:131], v[184:187], v[44:47], a[128:131]
    v_exp_f32 v16, v84
    v_mfma_f32_16x16x32_bf16 a[176:179], v[172:175], v[40:43], a[176:179]
    v_add_f32 v4, v4, v18
    v_mfma_f32_16x16x32_bf16 a[176:179], v[188:191], v[44:47], a[176:179]
    s_waitcnt lgkmcnt(2)
    v_add_f32 v4, v4, v19
    v_mfma_f32_16x16x32_bf16 a[36:39], v[160:163], v[24:27], a[36:39]
    ds_read_b128 v[40:43], v22 offset:2304
    v_mfma_f32_16x16x32_bf16 a[36:39], v[176:179], v[28:31], a[36:39]
    v_exp_f32 v17, v85
    v_mfma_f32_16x16x32_bf16 a[84:87], v[164:167], v[24:27], a[84:87]
    v_cvt_pk_bf16_f32 v83, v18, v19
    v_mfma_f32_16x16x32_bf16 a[84:87], v[180:183], v[28:31], a[84:87]
    s_add_u32 s27, s27, 24576
    v_exp_f32 v18, v86
    v_mfma_f32_16x16x32_bf16 a[132:135], v[168:171], v[24:27], a[132:135]
    s_add_u32 s56, s56, 36864
    ds_read_b128 v[44:47], v22 offset:14592
    v_add_f32 v5, v5, v16
    v_mfma_f32_16x16x32_bf16 a[132:135], v[184:187], v[28:31], a[132:135]
    s_waitcnt lgkmcnt(2)
    v_add_f32 v5, v5, v17
    v_mfma_f32_16x16x32_bf16 a[180:183], v[172:175], v[24:27], a[180:183]
    s_waitcnt vmcnt(24)
    v_exp_f32 v19, v87
    v_mfma_f32_16x16x32_bf16 a[180:183], v[188:191], v[28:31], a[180:183]
    s_barrier
    s_sub_u32 s58, s56, 147456
    v_mfma_f32_16x16x32_bf16 a[40:43], v[160:163], v[32:35], a[40:43]
    ds_read_b128 v[24:27], v2 offset:0
    v_cvt_pk_bf16_f32 v84, v16, v17
    v_mfma_f32_16x16x32_bf16 a[40:43], v[176:179], v[36:39], a[40:43]
    v_exp_f32 v16, v116
    v_mfma_f32_16x16x32_bf16 a[88:91], v[164:167], v[32:35], a[88:91]
    s_min_u32 s56, s56, s58
    v_add_f32 v5, v5, v18
    v_mfma_f32_16x16x32_bf16 a[88:91], v[180:183], v[36:39], a[88:91]
    v_add_f32 v5, v5, v19
    v_mfma_f32_16x16x32_bf16 a[136:139], v[168:171], v[32:35], a[136:139]
    ds_read_b128 v[28:31], v3 offset:0
    v_mfma_f32_16x16x32_bf16 a[136:139], v[184:187], v[36:39], a[136:139]
    v_exp_f32 v17, v117
    v_mfma_f32_16x16x32_bf16 a[184:187], v[172:175], v[32:35], a[184:187]
    v_cvt_pk_bf16_f32 v85, v18, v19
    v_mfma_f32_16x16x32_bf16 a[184:187], v[188:191], v[36:39], a[184:187]
    s_waitcnt lgkmcnt(2)
    v_exp_f32 v18, v118
    v_mfma_f32_16x16x32_bf16 a[44:47], v[160:163], v[40:43], a[44:47]
    ds_read_b128 v[32:35], v2 offset:6144
    v_add_f32 v5, v5, v16
    v_mfma_f32_16x16x32_bf16 a[44:47], v[176:179], v[44:47], a[44:47]
    v_add_f32 v5, v5, v17
    v_mfma_f32_16x16x32_bf16 a[92:95], v[164:167], v[40:43], a[92:95]
    v_exp_f32 v19, v119
    v_mfma_f32_16x16x32_bf16 a[92:95], v[180:183], v[44:47], a[92:95]
    v_mfma_f32_16x16x32_bf16 a[140:143], v[168:171], v[40:43], a[140:143]
    ds_read_b128 v[36:39], v3 offset:6144
    v_cvt_pk_bf16_f32 v86, v16, v17
    v_mfma_f32_16x16x32_bf16 a[140:143], v[184:187], v[44:47], a[140:143]
    v_add_f32 v5, v5, v18
    v_add_f32 v5, v5, v19
    v_mfma_f32_16x16x32_bf16 a[188:191], v[172:175], v[40:43], a[188:191]
    v_cvt_pk_bf16_f32 v87, v18, v19
    v_mfma_f32_16x16x32_bf16 a[188:191], v[188:191], v[44:47], a[188:191]
    s_waitcnt lgkmcnt(2)
    v_mfma_f32_16x16x32_bf16 v[160:163], v[24:27], a[192:195], v[128:131]
    s_mov_b32 m0, s26
    ds_read_b128 v[40:43], v2 offset:128
    v_mfma_f32_16x16x32_bf16 v[160:163], v[28:31], a[196:199], v[160:163]
    v_exp_f32 v16, v88
    v_mfma_f32_16x16x32_bf16 v[164:167], v[24:27], a[216:219], v[132:135]
    v_exp_f32 v17, v89
    v_mfma_f32_16x16x32_bf16 v[164:167], v[28:31], a[220:223], v[164:167]
    v_bfe_u32 v53, v8, 4, 6
    v_mfma_f32_16x16x32_bf16 v[168:171], v[24:27], a[240:243], v[136:139]
    ds_read_b128 v[44:47], v3 offset:128
    v_lshlrev_b32 v53, 2, v53
    v_mfma_f32_16x16x32_bf16 v[168:171], v[28:31], a[244:247], v[168:171]
    buffer_load_dwordx4 v8, s[4:7], s32 offen offset:0 sc1 lds
    v_mfma_f32_16x16x32_bf16 v[172:175], v[24:27], v[200:203], v[140:143]
    v_exp_f32 v18, v90
    v_mfma_f32_16x16x32_bf16 v[172:175], v[28:31], v[204:207], v[172:175]
    s_waitcnt lgkmcnt(2)
    v_add_f32 v6, v6, v16
    v_add_f32 v6, v6, v17
    s_branch L_skip13
L_pad13:
    s_branch L_tb1_1
L_skip13:
    v_mfma_f32_16x16x32_bf16 v[96:99], v[32:35], a[192:195], v[128:131]
    ds_read_b128 v[24:27], v2 offset:6272
    v_mfma_f32_16x16x32_bf16 v[96:99], v[36:39], a[196:199], v[96:99]
    buffer_load_dword v52, v53, s[20:23], 0 offen sc1
    v_mfma_f32_16x16x32_bf16 v[100:103], v[32:35], a[216:219], v[132:135]
    v_exp_f32 v19, v91
    v_mfma_f32_16x16x32_bf16 v[100:103], v[36:39], a[220:223], v[100:103]
    v_cvt_pk_bf16_f32 v88, v16, v17
    v_mfma_f32_16x16x32_bf16 v[104:107], v[32:35], a[240:243], v[136:139]
    ds_read_b128 v[28:31], v3 offset:6272
    v_mfma_f32_16x16x32_bf16 v[104:107], v[36:39], a[244:247], v[104:107]
    v_exp_f32 v16, v120
    v_mfma_f32_16x16x32_bf16 v[108:111], v[32:35], v[200:203], v[140:143]
    v_add_f32 v6, v6, v18
    v_add_f32 v6, v6, v19
    v_mfma_f32_16x16x32_bf16 v[108:111], v[36:39], v[204:207], v[108:111]
    s_waitcnt lgkmcnt(2)
    buffer_load_dwordx4 v8, s[4:7], s32 offen offset:1024 sc1 lds
    v_mfma_f32_16x16x32_bf16 v[160:163], v[40:43], a[200:203], v[160:163]
    ds_read_b128 v[32:35], v2 offset:256
    v_mfma_f32_16x16x32_bf16 v[160:163], v[44:47], a[204:207], v[160:163]
    v_exp_f32 v17, v121
    v_mfma_f32_16x16x32_bf16 v[164:167], v[40:43], a[224:227], v[164:167]
    v_cvt_pk_bf16_f32 v89, v18, v19
    v_mfma_f32_16x16x32_bf16 v[164:167], v[44:47], a[228:231], v[164:167]
    v_exp_f32 v18, v122
    v_mfma_f32_16x16x32_bf16 v[168:171], v[40:43], a[248:251], v[168:171]
    ds_read_b128 v[36:39], v3 offset:256
    v_add_f32 v6, v6, v16
    v_mfma_f32_16x16x32_bf16 v[168:171], v[44:47], a[252:255], v[168:171]
    v_add_f32 v6, v6, v17
    v_mfma_f32_16x16x32_bf16 v[172:175], v[40:43], v[208:211], v[172:175]
    v_exp_f32 v19, v123
    v_mfma_f32_16x16x32_bf16 v[172:175], v[44:47], v[212:215], v[172:175]
    s_waitcnt lgkmcnt(2)
    buffer_load_dwordx4 v8, s[4:7], s32 offen offset:2048 sc1 lds
    v_mfma_f32_16x16x32_bf16 v[96:99], v[24:27], a[200:203], v[96:99]
    ds_read_b128 v[40:43], v2 offset:6400
    v_cvt_pk_bf16_f32 v90, v16, v17
    v_mfma_f32_16x16x32_bf16 v[96:99], v[28:31], a[204:207], v[96:99]
    v_exp_f32 v16, v92
    v_mfma_f32_16x16x32_bf16 v[100:103], v[24:27], a[224:227], v[100:103]
    v_add_f32 v6, v6, v18
    v_add_f32 v6, v6, v19
    v_mfma_f32_16x16x32_bf16 v[100:103], v[28:31], a[228:231], v[100:103]
    v_exp_f32 v17, v93
    v_mfma_f32_16x16x32_bf16 v[104:107], v[24:27], a[248:251], v[104:107]
    ds_read_b128 v[44:47], v3 offset:6400
    v_cvt_pk_bf16_f32 v91, v18, v19
    v_mfma_f32_16x16x32_bf16 v[104:107], v[28:31], a[252:255], v[104:107]
    v_exp_f32 v18, v94
    v_mfma_f32_16x16x32_bf16 v[108:111], v[24:27], v[208:211], v[108:111]
    s_add_u32 s29, s30, 49152
    v_add_f32 v7, v7, v16
    s_add_u32 s32, s32, 24576
    v_mfma_f32_16x16x32_bf16 v[108:111], v[28:31], v[212:215], v[108:111]
    s_waitcnt lgkmcnt(2)
    v_add_f32 v7, v7, v17
    v_mfma_f32_16x16x32_bf16 v[160:163], v[32:35], a[208:211], v[160:163]
    s_sub_u32 s3, s29, 147456
    ds_read_b128 v[24:27], v2 offset:12288
    v_mfma_f32_16x16x32_bf16 v[160:163], v[36:39], a[212:215], v[160:163]
    v_exp_f32 v19, v95
    v_mfma_f32_16x16x32_bf16 v[164:167], v[32:35], a[232:235], v[164:167]
    v_cvt_pk_bf16_f32 v92, v16, v17
    v_mfma_f32_16x16x32_bf16 v[164:167], v[36:39], a[236:239], v[164:167]
    s_add_u32 s26, s26, 12288
    v_exp_f32 v16, v124
    v_mfma_f32_16x16x32_bf16 v[168:171], v[32:35], v[192:195], v[168:171]
    ds_read_b128 v[28:31], v3 offset:12288
    v_add_f32 v7, v7, v18
    v_mfma_f32_16x16x32_bf16 v[168:171], v[36:39], v[196:199], v[168:171]
    v_add_f32 v7, v7, v19
    v_mfma_f32_16x16x32_bf16 v[172:175], v[32:35], v[216:219], v[172:175]
    s_min_u32 s29, s29, s3
    v_mfma_f32_16x16x32_bf16 v[172:175], v[36:39], v[220:223], v[172:175]
    s_waitcnt lgkmcnt(2)
    v_exp_f32 v17, v125
    v_mfma_f32_16x16x32_bf16 v[96:99], v[40:43], a[208:211], v[96:99]
    s_mov_b32 m0, s26
    ds_read_b128 v[32:35], v2 offset:18432
    v_cvt_pk_bf16_f32 v93, v18, v19
    v_mfma_f32_16x16x32_bf16 v[96:99], v[44:47], a[212:215], v[96:99]
    v_exp_f32 v18, v126
    v_mfma_f32_16x16x32_bf16 v[100:103], v[40:43], a[232:235], v[100:103]
    v_mfma_f32_16x16x32_bf16 v[100:103], v[44:47], a[236:239], v[100:103]
    v_add_f32 v7, v7, v16
    v_mfma_f32_16x16x32_bf16 v[104:107], v[40:43], v[192:195], v[104:107]
    s_sub_u32 s3, s29, s30
    ds_read_b128 v[36:39], v3 offset:18432
    v_add_f32 v7, v7, v17
    v_mfma_f32_16x16x32_bf16 v[104:107], v[44:47], v[196:199], v[104:107]
    v_exp_f32 v19, v127
    v_mfma_f32_16x16x32_bf16 v[108:111], v[40:43], v[216:219], v[108:111]
    v_cvt_pk_bf16_f32 v94, v16, v17
    v_mfma_f32_16x16x32_bf16 v[108:111], v[44:47], v[220:223], v[108:111]
    s_waitcnt lgkmcnt(2)
    buffer_load_dwordx4 v8, s[4:7], s32 offen offset:0 sc1 lds
    v_mfma_f32_16x16x32_bf16 v[176:179], v[24:27], a[192:195], v[128:131]
    ds_read_b128 v[40:43], v2 offset:12416
    v_add_f32 v7, v7, v18
    v_mfma_f32_16x16x32_bf16 v[176:179], v[28:31], a[196:199], v[176:179]
    v_add_f32 v7, v7, v19
    v_cvt_pk_bf16_f32 v95, v18, v19
    v_mfma_f32_16x16x32_bf16 v[180:183], v[24:27], a[216:219], v[132:135]
    s_mov_b32 s30, s29
    v_mfma_f32_16x16x32_bf16 v[180:183], v[28:31], a[220:223], v[180:183]
    v_mfma_f32_16x16x32_bf16 v[184:187], v[24:27], a[240:243], v[136:139]
    ds_read_b128 v[44:47], v3 offset:12416
    v_mfma_f32_16x16x32_bf16 v[184:187], v[28:31], a[244:247], v[184:187]
    v_exp_f32 v16, v160
    v_mfma_f32_16x16x32_bf16 v[188:191], v[24:27], v[200:203], v[140:143]
    v_exp_f32 v17, v161
    v_mfma_f32_16x16x32_bf16 v[188:191], v[28:31], v[204:207], v[188:191]
    s_waitcnt lgkmcnt(2)
    v_exp_f32 v18, v162
    v_mfma_f32_16x16x32_bf16 v[112:115], v[32:35], a[192:195], v[128:131]
    ds_read_b128 v[24:27], v2 offset:18560
    v_add_f32 v4, v4, v16
    v_mfma_f32_16x16x32_bf16 v[112:115], v[36:39], a[196:199], v[112:115]
    buffer_load_dwordx4 v8, s[4:7], s32 offen offset:1024 sc1 lds
    v_mfma_f32_16x16x32_bf16 v[116:119], v[32:35], a[216:219], v[132:135]
    v_add_f32 v4, v4, v17
    v_add_u32 v1, s3, v1
    v_mfma_f32_16x16x32_bf16 v[116:119], v[36:39], a[220:223], v[116:119]
    v_exp_f32 v19, v163
    v_mfma_f32_16x16x32_bf16 v[120:123], v[32:35], a[240:243], v[136:139]
    ds_read_b128 v[28:31], v3 offset:18560
    v_cvt_pk_bf16_f32 v160, v16, v17
    v_mfma_f32_16x16x32_bf16 v[120:123], v[36:39], a[244:247], v[120:123]
    buffer_load_dword v0, v8, s[88:91], s93 offen
    v_mfma_f32_16x16x32_bf16 v[124:127], v[32:35], v[200:203], v[140:143]
    v_exp_f32 v16, v96
    v_mfma_f32_16x16x32_bf16 v[124:127], v[36:39], v[204:207], v[124:127]
    s_waitcnt lgkmcnt(2)
    v_add_f32 v4, v4, v18
    v_add_f32 v4, v4, v19
    v_mfma_f32_16x16x32_bf16 v[176:179], v[40:43], a[200:203], v[176:179]
    ds_read_b128 v[32:35], v2 offset:12544
    v_add_u32 v21, s3, v21
    v_mfma_f32_16x16x32_bf16 v[176:179], v[44:47], a[204:207], v[176:179]
    buffer_load_dwordx4 v8, s[4:7], s32 offen offset:2048 sc1 lds
    v_mfma_f32_16x16x32_bf16 v[180:183], v[40:43], a[224:227], v[180:183]
    v_exp_f32 v17, v97
    v_mfma_f32_16x16x32_bf16 v[180:183], v[44:47], a[228:231], v[180:183]
    v_cvt_pk_bf16_f32 v161, v18, v19
    v_mfma_f32_16x16x32_bf16 v[184:187], v[40:43], a[248:251], v[184:187]
    ds_read_b128 v[36:39], v3 offset:12544
    v_add_u32 v22, s3, v22
    v_mfma_f32_16x16x32_bf16 v[184:187], v[44:47], a[252:255], v[184:187]
    v_exp_f32 v18, v98
    v_mfma_f32_16x16x32_bf16 v[188:191], v[40:43], v[208:211], v[188:191]
    v_add_f32 v4, v4, v16
    v_add_f32 v4, v4, v17
    v_mfma_f32_16x16x32_bf16 v[188:191], v[44:47], v[212:215], v[188:191]
    s_waitcnt lgkmcnt(2)
    v_exp_f32 v19, v99
    v_mfma_f32_16x16x32_bf16 v[112:115], v[24:27], a[200:203], v[112:115]
    ds_read_b128 v[40:43], v2 offset:18688
    v_cvt_pk_bf16_f32 v162, v16, v17
    v_mfma_f32_16x16x32_bf16 v[112:115], v[28:31], a[204:207], v[112:115]
    v_exp_f32 v16, v164
    v_mfma_f32_16x16x32_bf16 v[116:119], v[24:27], a[224:227], v[116:119]
    v_add_f32 v4, v4, v18
    v_add_f32 v4, v4, v19
    v_mfma_f32_16x16x32_bf16 v[116:119], v[28:31], a[228:231], v[116:119]
    s_add_u32 s32, s32, 24576
    v_exp_f32 v17, v165
    v_mfma_f32_16x16x32_bf16 v[120:123], v[24:27], a[248:251], v[120:123]
    s_add_u32 s26, s26, 36864
    ds_read_b128 v[44:47], v3 offset:18688
    v_cvt_pk_bf16_f32 v163, v18, v19
    v_mfma_f32_16x16x32_bf16 v[120:123], v[28:31], a[252:255], v[120:123]
    s_waitcnt lgkmcnt(2)
    v_exp_f32 v18, v166
    v_mfma_f32_16x16x32_bf16 v[124:127], v[24:27], v[208:211], v[124:127]
    s_waitcnt vmcnt(21)
    v_add_f32 v5, v5, v16
    v_mfma_f32_16x16x32_bf16 v[124:127], v[28:31], v[212:215], v[124:127]
    s_barrier
    v_add_f32 v5, v5, v17
    v_mfma_f32_16x16x32_bf16 v[176:179], v[32:35], a[208:211], v[176:179]
    s_sub_u32 s57, s26, 147456
    ds_read_b128 v[24:27], v1 offset:0
    v_mfma_f32_16x16x32_bf16 v[176:179], v[36:39], a[212:215], v[176:179]
    v_exp_f32 v19, v167
    v_mfma_f32_16x16x32_bf16 v[180:183], v[32:35], a[232:235], v[180:183]
    s_min_u32 s26, s26, s57
    v_cvt_pk_bf16_f32 v164, v16, v17
    v_mfma_f32_16x16x32_bf16 v[180:183], v[36:39], a[236:239], v[180:183]
    v_exp_f32 v16, v100
    v_mfma_f32_16x16x32_bf16 v[184:187], v[32:35], v[192:195], v[184:187]
    ds_read_b128 v[28:31], v1 offset:12288
    v_add_f32 v5, v5, v18
    v_mfma_f32_16x16x32_bf16 v[184:187], v[36:39], v[196:199], v[184:187]
    v_add_f32 v5, v5, v19
    v_mfma_f32_16x16x32_bf16 v[188:191], v[32:35], v[216:219], v[188:191]
    v_exp_f32 v17, v101
    v_mfma_f32_16x16x32_bf16 v[188:191], v[36:39], v[220:223], v[188:191]
    s_waitcnt lgkmcnt(2)
    v_cvt_pk_bf16_f32 v165, v18, v19
    v_mfma_f32_16x16x32_bf16 v[112:115], v[40:43], a[208:211], v[112:115]
    ds_read_b128 v[32:35], v1 offset:768
    v_mfma_f32_16x16x32_bf16 v[112:115], v[44:47], a[212:215], v[112:115]
    v_exp_f32 v18, v102
    v_mfma_f32_16x16x32_bf16 v[116:119], v[40:43], a[232:235], v[116:119]
    v_add_f32 v5, v5, v16
    v_add_f32 v5, v5, v17
    v_mfma_f32_16x16x32_bf16 v[116:119], v[44:47], a[236:239], v[116:119]
    v_exp_f32 v19, v103
    v_mfma_f32_16x16x32_bf16 v[120:123], v[40:43], v[192:195], v[120:123]
    ds_read_b128 v[36:39], v1 offset:13056
    v_cvt_pk_bf16_f32 v166, v16, v17
    v_mfma_f32_16x16x32_bf16 v[120:123], v[44:47], v[196:199], v[120:123]
    v_add_f32 v5, v5, v18
    v_mfma_f32_16x16x32_bf16 v[124:127], v[40:43], v[216:219], v[124:127]
    v_add_f32 v5, v5, v19
    v_cvt_pk_bf16_f32 v167, v18, v19
    v_mfma_f32_16x16x32_bf16 v[124:127], v[44:47], v[220:223], v[124:127]
    s_waitcnt lgkmcnt(2)
    v_mfma_f32_16x16x32_bf16 a[0:3], v[64:67], v[24:27], a[0:3]
    ds_read_b128 v[40:43], v1 offset:1536
    v_mfma_f32_16x16x32_bf16 a[0:3], v[80:83], v[28:31], a[0:3]
    v_exp_f32 v16, v168
    v_mfma_f32_16x16x32_bf16 a[48:51], v[68:71], v[24:27], a[48:51]
    v_exp_f32 v17, v169
    v_mfma_f32_16x16x32_bf16 a[48:51], v[84:87], v[28:31], a[48:51]
    v_exp_f32 v18, v170
    v_mfma_f32_16x16x32_bf16 a[96:99], v[72:75], v[24:27], a[96:99]
    ds_read_b128 v[44:47], v1 offset:13824
    v_add_f32 v6, v6, v16
    v_mfma_f32_16x16x32_bf16 a[96:99], v[88:91], v[28:31], a[96:99]
    v_add_f32 v6, v6, v17
    v_mfma_f32_16x16x32_bf16 a[144:147], v[76:79], v[24:27], a[144:147]
    v_exp_f32 v19, v171
    v_mfma_f32_16x16x32_bf16 a[144:147], v[92:95], v[28:31], a[144:147]
    s_waitcnt lgkmcnt(2)
    v_mfma_f32_16x16x32_bf16 a[4:7], v[64:67], v[32:35], a[4:7]
    ds_read_b128 v[24:27], v1 offset:2304
    v_cvt_pk_bf16_f32 v168, v16, v17
    v_mfma_f32_16x16x32_bf16 a[4:7], v[80:83], v[36:39], a[4:7]
    v_exp_f32 v16, v104
    v_mfma_f32_16x16x32_bf16 a[52:55], v[68:71], v[32:35], a[52:55]
    v_add_f32 v6, v6, v18
    v_mfma_f32_16x16x32_bf16 a[52:55], v[84:87], v[36:39], a[52:55]
    v_add_f32 v6, v6, v19
    v_mfma_f32_16x16x32_bf16 a[100:103], v[72:75], v[32:35], a[100:103]
    ds_read_b128 v[28:31], v1 offset:14592
    v_mfma_f32_16x16x32_bf16 a[100:103], v[88:91], v[36:39], a[100:103]
    v_exp_f32 v17, v105
    v_mfma_f32_16x16x32_bf16 a[148:151], v[76:79], v[32:35], a[148:151]
    v_cvt_pk_bf16_f32 v169, v18, v19
    v_mfma_f32_16x16x32_bf16 a[148:151], v[92:95], v[36:39], a[148:151]
    s_waitcnt lgkmcnt(2)
    v_exp_f32 v18, v106
    v_mfma_f32_16x16x32_bf16 a[8:11], v[64:67], v[40:43], a[8:11]
    ds_read_b128 v[32:35], v21 offset:0
    v_add_f32 v6, v6, v16
    v_mfma_f32_16x16x32_bf16 a[8:11], v[80:83], v[44:47], a[8:11]
    v_add_f32 v6, v6, v17
    v_mfma_f32_16x16x32_bf16 a[56:59], v[68:71], v[40:43], a[56:59]
    v_exp_f32 v19, v107
    v_mfma_f32_16x16x32_bf16 a[56:59], v[84:87], v[44:47], a[56:59]
    v_mfma_f32_16x16x32_bf16 a[104:107], v[72:75], v[40:43], a[104:107]
    ds_read_b128 v[36:39], v21 offset:12288
    v_cvt_pk_bf16_f32 v170, v16, v17
    v_mfma_f32_16x16x32_bf16 a[104:107], v[88:91], v[44:47], a[104:107]
    v_exp_f32 v16, v172
    v_mfma_f32_16x16x32_bf16 a[152:155], v[76:79], v[40:43], a[152:155]
    v_add_f32 v6, v6, v18
    v_mfma_f32_16x16x32_bf16 a[152:155], v[92:95], v[44:47], a[152:155]
    s_waitcnt lgkmcnt(2)
    v_add_f32 v6, v6, v19
    v_mfma_f32_16x16x32_bf16 a[12:15], v[64:67], v[24:27], a[12:15]
    ds_read_b128 v[40:43], v21 offset:768
    v_mfma_f32_16x16x32_bf16 a[12:15], v[80:83], v[28:31], a[12:15]
    v_exp_f32 v17, v173
    v_mfma_f32_16x16x32_bf16 a[60:63], v[68:71], v[24:27], a[60:63]
    v_cvt_pk_bf16_f32 v171, v18, v19
    v_mfma_f32_16x16x32_bf16 a[60:63], v[84:87], v[28:31], a[60:63]
    v_exp_f32 v18, v174
    v_mfma_f32_16x16x32_bf16 a[108:111], v[72:75], v[24:27], a[108:111]
    ds_read_b128 v[44:47], v21 offset:13056
    v_add_f32 v7, v7, v16
    v_mfma_f32_16x16x32_bf16 a[108:111], v[88:91], v[28:31], a[108:111]
    s_waitcnt vmcnt(6)
    v_subrev_u32 v52, s92, v52
    v_cmp_lt_u32 vcc, 15, v52
    v_mfma_f32_16x16x32_bf16 a[156:159], v[76:79], v[24:27], a[156:159]
    s_add_u32 s29, s28, 49152
    v_add_f32 v7, v7, v17
    v_mfma_f32_16x16x32_bf16 a[156:159], v[92:95], v[28:31], a[156:159]
    s_waitcnt lgkmcnt(2)
    v_exp_f32 v19, v175
    v_mfma_f32_16x16x32_bf16 a[16:19], v[64:67], v[32:35], a[16:19]
    s_and_b32 s59, vcc_lo, 0xff
    ds_read_b128 v[24:27], v21 offset:1536
    v_cvt_pk_bf16_f32 v172, v16, v17
    v_mfma_f32_16x16x32_bf16 a[16:19], v[80:83], v[36:39], a[16:19]
    s_cbranch_scc1 L_pollslow7
L_pollok7:
    v_mfma_f32_16x16x32_bf16 a[64:67], v[68:71], v[32:35], a[64:67]
    s_sub_u32 s3, s29, 147456
    v_exp_f32 v16, v108
    v_mfma_f32_16x16x32_bf16 a[64:67], v[84:87], v[36:39], a[64:67]
    v_add_f32 v7, v7, v18
    v_add_f32 v7, v7, v19
    v_mfma_f32_16x16x32_bf16 a[112:115], v[72:75], v[32:35], a[112:115]
    s_mov_b32 m0, s56
    ds_read_b128 v[28:31], v21 offset:13824
    v_mfma_f32_16x16x32_bf16 a[112:115], v[88:91], v[36:39], a[112:115]
    v_exp_f32 v17, v109
    v_mfma_f32_16x16x32_bf16 a[160:163], v[76:79], v[32:35], a[160:163]
    v_cvt_pk_bf16_f32 v173, v18, v19
    v_mfma_f32_16x16x32_bf16 a[160:163], v[92:95], v[36:39], a[160:163]
    s_waitcnt lgkmcnt(2)
    buffer_load_dwordx4 v8, s[4:7], s27 offen offset:0 sc1 lds
    v_mfma_f32_16x16x32_bf16 a[20:23], v[64:67], v[40:43], a[20:23]
    s_min_u32 s29, s29, s3
    ds_read_b128 v[32:35], v21 offset:2304
    v_mfma_f32_16x16x32_bf16 a[20:23], v[80:83], v[44:47], a[20:23]
    v_exp_f32 v18, v110
    v_mfma_f32_16x16x32_bf16 a[68:71], v[68:71], v[40:43], a[68:71]
    v_add_f32 v7, v7, v16
    v_add_f32 v7, v7, v17
    v_mfma_f32_16x16x32_bf16 a[68:71], v[84:87], v[44:47], a[68:71]
    buffer_load_dwordx4 v8, s[4:7], s27 offen offset:1024 sc1 lds
    v_mfma_f32_16x16x32_bf16 a[116:119], v[72:75], v[40:43], a[116:119]
    ds_read_b128 v[36:39], v21 offset:14592
    v_mfma_f32_16x16x32_bf16 a[116:119], v[88:91], v[44:47], a[116:119]
    v_exp_f32 v19, v111
    v_mfma_f32_16x16x32_bf16 a[164:167], v[76:79], v[40:43], a[164:167]
    s_sub_u32 s3, s29, s28
    v_cvt_pk_bf16_f32 v174, v16, v17
    v_mfma_f32_16x16x32_bf16 a[164:167], v[92:95], v[44:47], a[164:167]
    s_waitcnt lgkmcnt(2)
    v_exp_f32 v16, v176
    v_mfma_f32_16x16x32_bf16 a[24:27], v[64:67], v[24:27], a[24:27]
    ds_read_b128 v[40:43], v22 offset:0
    v_add_f32 v7, v7, v18
    v_mfma_f32_16x16x32_bf16 a[24:27], v[80:83], v[28:31], a[24:27]
    buffer_load_dwordx4 v8, s[4:7], s27 offen offset:2048 sc1 lds
    v_mfma_f32_16x16x32_bf16 a[72:75], v[68:71], v[24:27], a[72:75]
    v_add_f32 v7, v7, v19
    v_mfma_f32_16x16x32_bf16 a[72:75], v[84:87], v[28:31], a[72:75]
    v_exp_f32 v17, v177
    v_mfma_f32_16x16x32_bf16 a[120:123], v[72:75], v[24:27], a[120:123]
    s_add_u32 s27, s27, 24576
    ds_read_b128 v[44:47], v22 offset:12288
    v_cvt_pk_bf16_f32 v175, v18, v19
    v_mfma_f32_16x16x32_bf16 a[120:123], v[88:91], v[28:31], a[120:123]
    s_mov_b32 s28, s29
    v_exp_f32 v18, v178
    v_mfma_f32_16x16x32_bf16 a[168:171], v[76:79], v[24:27], a[168:171]
    v_add_f32 v4, v4, v16
    v_add_f32 v4, v4, v17
    v_mfma_f32_16x16x32_bf16 a[168:171], v[92:95], v[28:31], a[168:171]
    s_waitcnt lgkmcnt(2)
    v_exp_f32 v19, v179
    v_mfma_f32_16x16x32_bf16 a[28:31], v[64:67], v[32:35], a[28:31]
    s_add_u32 s56, s56, 12288
    ds_read_b128 v[24:27], v22 offset:768
    v_cvt_pk_bf16_f32 v176, v16, v17
    v_mfma_f32_16x16x32_bf16 a[28:31], v[80:83], v[36:39], a[28:31]
    s_mov_b32 m0, s56
    v_exp_f32 v16, v112
    v_mfma_f32_16x16x32_bf16 a[76:79], v[68:71], v[32:35], a[76:79]
    v_add_f32 v4, v4, v18
    v_mfma_f32_16x16x32_bf16 a[76:79], v[84:87], v[36:39], a[76:79]
    v_add_f32 v4, v4, v19
    v_mfma_f32_16x16x32_bf16 a[124:127], v[72:75], v[32:35], a[124:127]
    ds_read_b128 v[28:31], v22 offset:13056
    v_add_u32 v2, s3, v2
    v_mfma_f32_16x16x32_bf16 a[124:127], v[88:91], v[36:39], a[124:127]
    buffer_load_dwordx4 v8, s[4:7], s27 offen offset:0 sc1 lds
    v_mfma_f32_16x16x32_bf16 a[172:175], v[76:79], v[32:35], a[172:175]
    v_exp_f32 v17, v113
    v_mfma_f32_16x16x32_bf16 a[172:175], v[92:95], v[36:39], a[172:175]
    s_waitcnt lgkmcnt(2)
    v_cvt_pk_bf16_f32 v177, v18, v19
    v_mfma_f32_16x16x32_bf16 a[32:35], v[64:67], v[40:43], a[32:35]
    ds_read_b128 v[32:35], v22 offset:1536
    v_mfma_f32_16x16x32_bf16 a[32:35], v[80:83], v[44:47], a[32:35]
    v_exp_f32 v18, v114
    v_mfma_f32_16x16x32_bf16 a[80:83], v[68:71], v[40:43], a[80:83]
    v_add_f32 v4, v4, v16
    v_add_f32 v4, v4, v17
    v_mfma_f32_16x16x32_bf16 a[80:83], v[84:87], v[44:47], a[80:83]
    buffer_load_dwordx4 v8, s[4:7], s27 offen offset:1024 sc1 lds
    v_mfma_f32_16x16x32_bf16 a[128:131], v[72:75], v[40:43], a[128:131]
    ds_read_b128 v[36:39], v22 offset:13824
    v_add_u32 v3, s3, v3
    v_mfma_f32_16x16x32_bf16 a[128:131], v[88:91], v[44:47], a[128:131]
    v_exp_f32 v19, v115
    v_mfma_f32_16x16x32_bf16 a[176:179], v[76:79], v[40:43], a[176:179]
    v_cvt_pk_bf16_f32 v178, v16, v17
    v_mfma_f32_16x16x32_bf16 a[176:179], v[92:95], v[44:47], a[176:179]
    s_waitcnt lgkmcnt(2)
    buffer_load_dwordx4 v8, s[4:7], s27 offen offset:2048 sc1 lds
    v_mfma_f32_16x16x32_bf16 a[36:39], v[64:67], v[24:27], a[36:39]
    ds_read_b128 v[40:43], v22 offset:2304
    v_mfma_f32_16x16x32_bf16 a[36:39], v[80:83], v[28:31], a[36:39]
    v_exp_f32 v16, v180
    v_mfma_f32_16x16x32_bf16 a[84:87], v[68:71], v[24:27], a[84:87]
    v_add_f32 v4, v4, v18
    v_add_f32 v4, v4, v19
    v_mfma_f32_16x16x32_bf16 a[84:87], v[84:87], v[28:31], a[84:87]
    v_exp_f32 v17, v181
    v_mfma_f32_16x16x32_bf16 a[132:135], v[72:75], v[24:27], a[132:135]
    ds_read_b128 v[44:47], v22 offset:14592
    v_cvt_pk_bf16_f32 v179, v18, v19
    v_mfma_f32_16x16x32_bf16 a[132:135], v[88:91], v[28:31], a[132:135]
    s_waitcnt lgkmcnt(2)
    v_exp_f32 v18, v182
    v_mfma_f32_16x16x32_bf16 a[180:183], v[76:79], v[24:27], a[180:183]
    s_waitcnt vmcnt(21)
    v_add_f32 v5, v5, v16
    v_add_f32 v5, v5, v17
    v_mfma_f32_16x16x32_bf16 a[180:183], v[92:95], v[28:31], a[180:183]
    s_barrier
    s_add_u32 s27, s27, 24576
    v_mfma_f32_16x16x32_bf16 a[40:43], v[64:67], v[32:35], a[40:43]
    s_add_u32 s56, s56, 36864
    ds_read_b128 v[24:27], v2 offset:0
    v_mfma_f32_16x16x32_bf16 a[40:43], v[80:83], v[36:39], a[40:43]
    s_sub_u32 s58, s56, 147456
    v_exp_f32 v19, v183
    v_mfma_f32_16x16x32_bf16 a[88:91], v[68:71], v[32:35], a[88:91]
    v_cvt_pk_bf16_f32 v180, v16, v17
    v_mfma_f32_16x16x32_bf16 a[88:91], v[84:87], v[36:39], a[88:91]
    v_exp_f32 v16, v116
    v_mfma_f32_16x16x32_bf16 a[136:139], v[72:75], v[32:35], a[136:139]
    s_min_u32 s56, s56, s58
    ds_read_b128 v[28:31], v3 offset:0
    v_add_f32 v5, v5, v18
    v_mfma_f32_16x16x32_bf16 a[136:139], v[88:91], v[36:39], a[136:139]
    v_add_f32 v5, v5, v19
    v_mfma_f32_16x16x32_bf16 a[184:187], v[76:79], v[32:35], a[184:187]
    v_exp_f32 v17, v117
    v_mfma_f32_16x16x32_bf16 a[184:187], v[92:95], v[36:39], a[184:187]
    s_waitcnt lgkmcnt(2)
    v_cvt_pk_bf16_f32 v181, v18, v19
    v_mfma_f32_16x16x32_bf16 a[44:47], v[64:67], v[40:43], a[44:47]
    ds_read_b128 v[32:35], v2 offset:6144
    v_mfma_f32_16x16x32_bf16 a[44:47], v[80:83], v[44:47], a[44:47]
    v_exp_f32 v18, v118
    v_mfma_f32_16x16x32_bf16 a[92:95], v[68:71], v[40:43], a[92:95]
    v_add_f32 v5, v5, v16
    v_add_f32 v5, v5, v17
    v_mfma_f32_16x16x32_bf16 a[92:95], v[84:87], v[44:47], a[92:95]
    v_exp_f32 v19, v119
    v_mfma_f32_16x16x32_bf16 a[140:143], v[72:75], v[40:43], a[140:143]
    ds_read_b128 v[36:39], v3 offset:6144
    v_cvt_pk_bf16_f32 v182, v16, v17
    v_mfma_f32_16x16x32_bf16 a[140:143], v[88:91], v[44:47], a[140:143]
    v_add_f32 v5, v5, v18
    v_add_f32 v5, v5, v19
    v_mfma_f32_16x16x32_bf16 a[188:191], v[76:79], v[40:43], a[188:191]
    v_cvt_pk_bf16_f32 v183, v18, v19
    v_mfma_f32_16x16x32_bf16 a[188:191], v[92:95], v[44:47], a[188:191]
    s_waitcnt lgkmcnt(2)
    v_mfma_f32_16x16x32_bf16 v[64:67], v[24:27], a[192:195], v[128:131]
    s_mov_b32 m0, s26
    ds_read_b128 v[40:43], v2 offset:128
    v_mfma_f32_16x16x32_bf16 v[64:67], v[28:31], a[196:199], v[64:67]
    v_exp_f32 v16, v184
    v_mfma_f32_16x16x32_bf16 v[68:71], v[24:27], a[216:219], v[132:135]
    v_exp_f32 v17, v185
    v_mfma_f32_16x16x32_bf16 v[68:71], v[28:31], a[220:223], v[68:71]
    v_exp_f32 v18, v186
    v_mfma_f32_16x16x32_bf16 v[72:75], v[24:27], a[240:243], v[136:139]
    ds_read_b128 v[44:47], v3 offset:128
    v_mfma_f32_16x16x32_bf16 v[72:75], v[28:31], a[244:247], v[72:75]
    buffer_load_dwordx4 v8, s[4:7], s32 offen offset:0 sc1 lds
    v_mfma_f32_16x16x32_bf16 v[76:79], v[24:27], v[200:203], v[140:143]
    v_add_f32 v6, v6, v16
    v_add_f32 v6, v6, v17
    v_mfma_f32_16x16x32_bf16 v[76:79], v[28:31], v[204:207], v[76:79]
    s_waitcnt lgkmcnt(2)
    v_exp_f32 v19, v187
    v_mfma_f32_16x16x32_bf16 v[96:99], v[32:35], a[192:195], v[128:131]
    ds_read_b128 v[24:27], v2 offset:6272
    v_cvt_pk_bf16_f32 v184, v16, v17
    v_mfma_f32_16x16x32_bf16 v[96:99], v[36:39], a[196:199], v[96:99]
    v_mfma_f32_16x16x32_bf16 v[100:103], v[32:35], a[216:219], v[132:135]
    v_exp_f32 v16, v120
    v_mfma_f32_16x16x32_bf16 v[100:103], v[36:39], a[220:223], v[100:103]
    v_add_f32 v6, v6, v18
    v_mfma_f32_16x16x32_bf16 v[104:107], v[32:35], a[240:243], v[136:139]
    ds_read_b128 v[28:31], v3 offset:6272
    v_add_f32 v6, v6, v19
    v_mfma_f32_16x16x32_bf16 v[104:107], v[36:39], a[244:247], v[104:107]
    v_exp_f32 v17, v121
    v_mfma_f32_16x16x32_bf16 v[108:111], v[32:35], v[200:203], v[140:143]
    v_mfma_f32_16x16x32_bf16 v[108:111], v[36:39], v[204:207], v[108:111]
    s_waitcnt lgkmcnt(2)
    buffer_load_dwordx4 v8, s[4:7], s32 offen offset:1024 sc1 lds
    v_mfma_f32_16x16x32_bf16 v[64:67], v[40:43], a[200:203], v[64:67]
    ds_read_b128 v[32:35], v2 offset:256
    v_cvt_pk_bf16_f32 v185, v18, v19
    v_mfma_f32_16x16x32_bf16 v[64:67], v[44:47], a[204:207], v[64:67]
    v_exp_f32 v18, v122
    v_mfma_f32_16x16x32_bf16 v[68:71], v[40:43], a[224:227], v[68:71]
    v_add_f32 v6, v6, v16
    v_add_f32 v6, v6, v17
    v_mfma_f32_16x16x32_bf16 v[68:71], v[44:47], a[228:231], v[68:71]
    v_mfma_f32_16x16x32_bf16 v[72:75], v[40:43], a[248:251], v[72:75]
    ds_read_b128 v[36:39], v3 offset:256
    v_mfma_f32_16x16x32_bf16 v[72:75], v[44:47], a[252:255], v[72:75]
    v_exp_f32 v19, v123
    v_mfma_f32_16x16x32_bf16 v[76:79], v[40:43], v[208:211], v[76:79]
    v_cvt_pk_bf16_f32 v186, v16, v17
    v_mfma_f32_16x16x32_bf16 v[76:79], v[44:47], v[212:215], v[76:79]
    s_waitcnt lgkmcnt(2)
    buffer_load_dwordx4 v8, s[4:7], s32 offen offset:2048 sc1 lds
    v_mfma_f32_16x16x32_bf16 v[96:99], v[24:27], a[200:203], v[96:99]
    ds_read_b128 v[40:43], v2 offset:6400
    v_mfma_f32_16x16x32_bf16 v[96:99], v[28:31], a[204:207], v[96:99]
    v_exp_f32 v16, v188
    v_mfma_f32_16x16x32_bf16 v[100:103], v[24:27], a[224:227], v[100:103]
    v_add_f32 v6, v6, v18
    v_add_f32 v6, v6, v19
    v_mfma_f32_16x16x32_bf16 v[100:103], v[28:31], a[228:231], v[100:103]
    v_exp_f32 v17, v189
    v_mfma_f32_16x16x32_bf16 v[104:107], v[24:27], a[248:251], v[104:107]
    ds_read_b128 v[44:47], v3 offset:6400
    v_cvt_pk_bf16_f32 v187, v18, v19
    v_mfma_f32_16x16x32_bf16 v[104:107], v[28:31], a[252:255], v[104:107]
    v_exp_f32 v18, v190
    v_mfma_f32_16x16x32_bf16 v[108:111], v[24:27], v[208:211], v[108:111]
    s_add_u32 s29, s30, 49152
    v_add_f32 v7, v7, v16
    s_add_u32 s32, s32, 24576
    v_mfma_f32_16x16x32_bf16 v[108:111], v[28:31], v[212:215], v[108:111]
    s_waitcnt lgkmcnt(2)
    v_add_f32 v7, v7, v17
    v_mfma_f32_16x16x32_bf16 v[64:67], v[32:35], a[208:211], v[64:67]
    s_sub_u32 s3, s29, 147456
    ds_read_b128 v[24:27], v2 offset:12288
    v_mfma_f32_16x16x32_bf16 v[64:67], v[36:39], a[212:215], v[64:67]
    v_exp_f32 v19, v191
    v_mfma_f32_16x16x32_bf16 v[68:71], v[32:35], a[232:235], v[68:71]
    v_cvt_pk_bf16_f32 v188, v16, v17
    v_mfma_f32_16x16x32_bf16 v[68:71], v[36:39], a[236:239], v[68:71]
    s_add_u32 s26, s26, 12288
    v_exp_f32 v16, v124
    v_mfma_f32_16x16x32_bf16 v[72:75], v[32:35], v[192:195], v[72:75]
    ds_read_b128 v[28:31], v3 offset:12288
    v_add_f32 v7, v7, v18
    v_mfma_f32_16x16x32_bf16 v[72:75], v[36:39], v[196:199], v[72:75]
    v_add_f32 v7, v7, v19
    v_mfma_f32_16x16x32_bf16 v[76:79], v[32:35], v[216:219], v[76:79]
    s_min_u32 s29, s29, s3
    v_mfma_f32_16x16x32_bf16 v[76:79], v[36:39], v[220:223], v[76:79]
    s_waitcnt lgkmcnt(2)
    v_exp_f32 v17, v125
    v_mfma_f32_16x16x32_bf16 v[96:99], v[40:43], a[208:211], v[96:99]
    s_mov_b32 m0, s26
    ds_read_b128 v[32:35], v2 offset:18432
    v_cvt_pk_bf16_f32 v189, v18, v19
    v_mfma_f32_16x16x32_bf16 v[96:99], v[44:47], a[212:215], v[96:99]
    v_exp_f32 v18, v126
    v_mfma_f32_16x16x32_bf16 v[100:103], v[40:43], a[232:235], v[100:103]
    v_mfma_f32_16x16x32_bf16 v[100:103], v[44:47], a[236:239], v[100:103]
    v_add_f32 v7, v7, v16
    v_mfma_f32_16x16x32_bf16 v[104:107], v[40:43], v[192:195], v[104:107]
    s_sub_u32 s3, s29, s30
    ds_read_b128 v[36:39], v3 offset:18432
    v_add_f32 v7, v7, v17
    v_mfma_f32_16x16x32_bf16 v[104:107], v[44:47], v[196:199], v[104:107]
    v_exp_f32 v19, v127
    v_mfma_f32_16x16x32_bf16 v[108:111], v[40:43], v[216:219], v[108:111]
    v_cvt_pk_bf16_f32 v190, v16, v17
    v_mfma_f32_16x16x32_bf16 v[108:111], v[44:47], v[220:223], v[108:111]
    s_waitcnt lgkmcnt(2)
    buffer_load_dwordx4 v8, s[4:7], s32 offen offset:0 sc1 lds
    v_mfma_f32_16x16x32_bf16 v[80:83], v[24:27], a[192:195], v[128:131]
    ds_read_b128 v[40:43], v2 offset:12416
    v_add_f32 v7, v7, v18
    v_mfma_f32_16x16x32_bf16 v[80:83], v[28:31], a[196:199], v[80:83]
    v_add_f32 v7, v7, v19
    v_cvt_pk_bf16_f32 v191, v18, v19
    v_mfma_f32_16x16x32_bf16 v[84:87], v[24:27], a[216:219], v[132:135]
    s_mov_b32 s30, s29
    v_mfma_f32_16x16x32_bf16 v[84:87], v[28:31], a[220:223], v[84:87]
    v_mfma_f32_16x16x32_bf16 v[88:91], v[24:27], a[240:243], v[136:139]
    ds_read_b128 v[44:47], v3 offset:12416
    v_mfma_f32_16x16x32_bf16 v[88:91], v[28:31], a[244:247], v[88:91]
    v_exp_f32 v16, v64
    v_mfma_f32_16x16x32_bf16 v[92:95], v[24:27], v[200:203], v[140:143]
    v_exp_f32 v17, v65
    v_mfma_f32_16x16x32_bf16 v[92:95], v[28:31], v[204:207], v[92:95]
    s_waitcnt lgkmcnt(2)
    v_exp_f32 v18, v66
    v_mfma_f32_16x16x32_bf16 v[112:115], v[32:35], a[192:195], v[128:131]
    ds_read_b128 v[24:27], v2 offset:18560
    v_add_f32 v4, v4, v16
    v_mfma_f32_16x16x32_bf16 v[112:115], v[36:39], a[196:199], v[112:115]
    buffer_load_dwordx4 v8, s[4:7], s32 offen offset:1024 sc1 lds
    v_mfma_f32_16x16x32_bf16 v[116:119], v[32:35], a[216:219], v[132:135]
    v_add_f32 v4, v4, v17
    v_add_u32 v1, s3, v1
    v_mfma_f32_16x16x32_bf16 v[116:119], v[36:39], a[220:223], v[116:119]
    v_exp_f32 v19, v67
    v_mfma_f32_16x16x32_bf16 v[120:123], v[32:35], a[240:243], v[136:139]
    ds_read_b128 v[28:31], v3 offset:18560
    v_cvt_pk_bf16_f32 v64, v16, v17
    v_mfma_f32_16x16x32_bf16 v[120:123], v[36:39], a[244:247], v[120:123]
    v_exp_f32 v16, v96
    v_mfma_f32_16x16x32_bf16 v[124:127], v[32:35], v[200:203], v[140:143]
    v_add_f32 v4, v4, v18
    v_add_f32 v4, v4, v19
    v_mfma_f32_16x16x32_bf16 v[124:127], v[36:39], v[204:207], v[124:127]
    s_waitcnt lgkmcnt(2)
    v_exp_f32 v17, v97
    v_mfma_f32_16x16x32_bf16 v[80:83], v[40:43], a[200:203], v[80:83]
    ds_read_b128 v[32:35], v2 offset:12544
    v_add_u32 v21, s3, v21
    v_mfma_f32_16x16x32_bf16 v[80:83], v[44:47], a[204:207], v[80:83]
    buffer_load_dwordx4 v8, s[4:7], s32 offen offset:2048 sc1 lds
    v_mfma_f32_16x16x32_bf16 v[84:87], v[40:43], a[224:227], v[84:87]
    v_cvt_pk_bf16_f32 v65, v18, v19
    v_mfma_f32_16x16x32_bf16 v[84:87], v[44:47], a[228:231], v[84:87]
    v_exp_f32 v18, v98
    v_mfma_f32_16x16x32_bf16 v[88:91], v[40:43], a[248:251], v[88:91]
    ds_read_b128 v[36:39], v3 offset:12544
    v_add_f32 v4, v4, v16
    v_mfma_f32_16x16x32_bf16 v[88:91], v[44:47], a[252:255], v[88:91]
    v_add_f32 v4, v4, v17
    v_add_u32 v22, s3, v22
    s_branch L_skip14
L_pad14:
    s_branch L_tb1_0
L_skip14:
    v_mfma_f32_16x16x32_bf16 v[92:95], v[40:43], v[208:211], v[92:95]
    v_exp_f32 v19, v99
    v_mfma_f32_16x16x32_bf16 v[92:95], v[44:47], v[212:215], v[92:95]
    s_waitcnt lgkmcnt(2)
    v_cvt_pk_bf16_f32 v66, v16, v17
    v_mfma_f32_16x16x32_bf16 v[112:115], v[24:27], a[200:203], v[112:115]
    ds_read_b128 v[40:43], v2 offset:18688
    v_mfma_f32_16x16x32_bf16 v[112:115], v[28:31], a[204:207], v[112:115]
    v_exp_f32 v16, v68
    v_mfma_f32_16x16x32_bf16 v[116:119], v[24:27], a[224:227], v[116:119]
    v_add_f32 v4, v4, v18
    v_add_f32 v4, v4, v19
    v_mfma_f32_16x16x32_bf16 v[116:119], v[28:31], a[228:231], v[116:119]
    s_add_u32 s32, s32, 24576
    v_exp_f32 v17, v69
    v_mfma_f32_16x16x32_bf16 v[120:123], v[24:27], a[248:251], v[120:123]
    s_add_u32 s26, s26, 36864
    ds_read_b128 v[44:47], v3 offset:18688
    v_cvt_pk_bf16_f32 v67, v18, v19
    v_mfma_f32_16x16x32_bf16 v[120:123], v[28:31], a[252:255], v[120:123]
    s_waitcnt lgkmcnt(2)
    v_exp_f32 v18, v70
    v_mfma_f32_16x16x32_bf16 v[124:127], v[24:27], v[208:211], v[124:127]
    s_waitcnt vmcnt(20)
    v_add_f32 v5, v5, v16
    v_add_f32 v5, v5, v17
    v_mfma_f32_16x16x32_bf16 v[124:127], v[28:31], v[212:215], v[124:127]
    s_barrier
    s_sub_u32 s57, s26, 147456
    v_mfma_f32_16x16x32_bf16 v[80:83], v[32:35], a[208:211], v[80:83]
    ds_read_b128 v[24:27], v1 offset:0
    v_mfma_f32_16x16x32_bf16 v[80:83], v[36:39], a[212:215], v[80:83]
    v_exp_f32 v19, v71
    v_mfma_f32_16x16x32_bf16 v[84:87], v[32:35], a[232:235], v[84:87]
    s_min_u32 s26, s26, s57
    v_cvt_pk_bf16_f32 v68, v16, v17
    v_mfma_f32_16x16x32_bf16 v[84:87], v[36:39], a[236:239], v[84:87]
    v_exp_f32 v16, v100
    v_mfma_f32_16x16x32_bf16 v[88:91], v[32:35], v[192:195], v[88:91]
    ds_read_b128 v[28:31], v1 offset:12288
    v_add_f32 v5, v5, v18
    v_mfma_f32_16x16x32_bf16 v[88:91], v[36:39], v[196:199], v[88:91]
    v_add_f32 v5, v5, v19
    v_mfma_f32_16x16x32_bf16 v[92:95], v[32:35], v[216:219], v[92:95]
    v_exp_f32 v17, v101
    v_mfma_f32_16x16x32_bf16 v[92:95], v[36:39], v[220:223], v[92:95]
    s_waitcnt lgkmcnt(2)
    v_cvt_pk_bf16_f32 v69, v18, v19
    v_mfma_f32_16x16x32_bf16 v[112:115], v[40:43], a[208:211], v[112:115]
    ds_read_b128 v[32:35], v1 offset:768
    v_mfma_f32_16x16x32_bf16 v[112:115], v[44:47], a[212:215], v[112:115]
    v_exp_f32 v18, v102
    v_mfma_f32_16x16x32_bf16 v[116:119], v[40:43], a[232:235], v[116:119]
    v_add_f32 v5, v5, v16
    v_add_f32 v5, v5, v17
    v_mfma_f32_16x16x32_bf16 v[116:119], v[44:47], a[236:239], v[116:119]
    v_exp_f32 v19, v103
    v_mfma_f32_16x16x32_bf16 v[120:123], v[40:43], v[192:195], v[120:123]
    s_sub_u32 s31, s31, 1
    ds_read_b128 v[36:39], v1 offset:13056
    v_cvt_pk_bf16_f32 v70, v16, v17
    v_mfma_f32_16x16x32_bf16 v[120:123], v[44:47], v[196:199], v[120:123]
    v_add_f32 v5, v5, v18
    v_add_f32 v5, v5, v19
    v_mfma_f32_16x16x32_bf16 v[124:127], v[40:43], v[216:219], v[124:127]
    s_waitcnt lgkmcnt(2)
    s_cmp_lg_u32 s31, 0
    v_cvt_pk_bf16_f32 v71, v18, v19
    v_mfma_f32_16x16x32_bf16 v[124:127], v[44:47], v[220:223], v[124:127]
    s_cbranch_scc1 L_loop2
    v_mfma_f32_16x16x32_bf16 a[0:3], v[160:163], v[24:27], a[0:3]
    ds_read_b128 v[40:43], v1 offset:1536
    ds_read_b128 v[44:47], v1 offset:13824
    v_mfma_f32_16x16x32_bf16 a[0:3], v[176:179], v[28:31], a[0:3]
    s_mov_b32 m0, s56
    s_add_u32 s29, s28, 49152
    s_sub_u32 s3, s29, 147456
    v_mfma_f32_16x16x32_bf16 a[48:51], v[164:167], v[24:27], a[48:51]
    ds_read_b128 v[240:243], v1 offset:2304
    s_min_u32 s29, s29, s3
    v_mfma_f32_16x16x32_bf16 a[48:51], v[180:183], v[28:31], a[48:51]
    s_waitcnt lgkmcnt(3)
    s_sub_u32 s3, s29, s28
    s_mov_b32 s28, s29
    v_mfma_f32_16x16x32_bf16 a[4:7], v[160:163], v[32:35], a[4:7]
    ds_read_b128 v[244:247], v1 offset:14592
    ds_read_b128 v[248:251], v21 offset:0
    v_mfma_f32_16x16x32_bf16 a[4:7], v[176:179], v[36:39], a[4:7]
    buffer_load_dwordx4 v8, s[4:7], s27 offen offset:0 sc1 lds
    v_mfma_f32_16x16x32_bf16 a[52:55], v[164:167], v[32:35], a[52:55]
    ds_read_b128 v[252:255], v21 offset:12288
    v_add_u32 v2, s3, v2
    v_mfma_f32_16x16x32_bf16 a[52:55], v[180:183], v[36:39], a[52:55]
    s_waitcnt lgkmcnt(4)
    v_add_u32 v3, s3, v3
    v_mfma_f32_16x16x32_bf16 a[8:11], v[160:163], v[40:43], a[8:11]
    ds_read_b128 v[24:27], v21 offset:768
    v_mfma_f32_16x16x32_bf16 a[8:11], v[176:179], v[44:47], a[8:11]
    buffer_load_dwordx4 v8, s[4:7], s27 offen offset:1024 sc1 lds
    v_mfma_f32_16x16x32_bf16 a[56:59], v[164:167], v[40:43], a[56:59]
    ds_read_b128 v[28:31], v21 offset:13056
    v_mfma_f32_16x16x32_bf16 a[56:59], v[180:183], v[44:47], a[56:59]
    s_waitcnt lgkmcnt(4)
    v_exp_f32 v16, v80
    v_mfma_f32_16x16x32_bf16 a[12:15], v[160:163], v[240:243], a[12:15]
    ds_read_b128 v[32:35], v21 offset:1536
    v_mfma_f32_16x16x32_bf16 a[12:15], v[176:179], v[244:247], a[12:15]
    buffer_load_dwordx4 v8, s[4:7], s27 offen offset:2048 sc1 lds
    v_mfma_f32_16x16x32_bf16 a[60:63], v[164:167], v[240:243], a[60:63]
    ds_read_b128 v[36:39], v21 offset:13824
    v_mfma_f32_16x16x32_bf16 a[60:63], v[180:183], v[244:247], a[60:63]
    s_waitcnt lgkmcnt(4)
    v_exp_f32 v17, v81
    v_mfma_f32_16x16x32_bf16 a[16:19], v[160:163], v[248:251], a[16:19]
    ds_read_b128 v[40:43], v21 offset:2304
    v_mfma_f32_16x16x32_bf16 a[16:19], v[176:179], v[252:255], a[16:19]
    s_add_u32 s27, s27, 24576
    s_add_u32 s56, s56, 12288
    s_mov_b32 m0, s56
    v_mfma_f32_16x16x32_bf16 a[64:67], v[164:167], v[248:251], a[64:67]
    ds_read_b128 v[44:47], v21 offset:14592
    v_mfma_f32_16x16x32_bf16 a[64:67], v[180:183], v[252:255], a[64:67]
    s_waitcnt lgkmcnt(4)
    v_exp_f32 v18, v82
    v_mfma_f32_16x16x32_bf16 a[20:23], v[160:163], v[24:27], a[20:23]
    ds_read_b128 v[240:243], v22 offset:0
    v_add_f32 v4, v4, v16
    v_mfma_f32_16x16x32_bf16 a[20:23], v[176:179], v[28:31], a[20:23]
    buffer_load_dwordx4 v8, s[4:7], s27 offen offset:0 sc1 lds
    v_mfma_f32_16x16x32_bf16 a[68:71], v[164:167], v[24:27], a[68:71]
    ds_read_b128 v[244:247], v22 offset:12288
    v_add_f32 v4, v4, v17
    v_mfma_f32_16x16x32_bf16 a[68:71], v[180:183], v[28:31], a[68:71]
    s_waitcnt lgkmcnt(4)
    v_exp_f32 v19, v83
    v_mfma_f32_16x16x32_bf16 a[24:27], v[160:163], v[32:35], a[24:27]
    ds_read_b128 v[248:251], v22 offset:768
    v_cvt_pk_bf16_f32 v80, v16, v17
    v_mfma_f32_16x16x32_bf16 a[24:27], v[176:179], v[36:39], a[24:27]
    buffer_load_dwordx4 v8, s[4:7], s27 offen offset:1024 sc1 lds
    v_mfma_f32_16x16x32_bf16 a[72:75], v[164:167], v[32:35], a[72:75]
    ds_read_b128 v[252:255], v22 offset:13056
    v_mfma_f32_16x16x32_bf16 a[72:75], v[180:183], v[36:39], a[72:75]
    s_waitcnt lgkmcnt(4)
    v_exp_f32 v16, v112
    v_mfma_f32_16x16x32_bf16 a[28:31], v[160:163], v[40:43], a[28:31]
    ds_read_b128 v[24:27], v22 offset:1536
    v_add_f32 v4, v4, v18
    v_mfma_f32_16x16x32_bf16 a[28:31], v[176:179], v[44:47], a[28:31]
    s_waitcnt vmcnt(63)
    s_barrier
    v_mfma_f32_16x16x32_bf16 a[76:79], v[164:167], v[40:43], a[76:79]
    ds_read_b128 v[28:31], v22 offset:13824
    v_add_f32 v4, v4, v19
    v_mfma_f32_16x16x32_bf16 a[76:79], v[180:183], v[44:47], a[76:79]
    s_waitcnt lgkmcnt(4)
    v_exp_f32 v17, v113
    v_mfma_f32_16x16x32_bf16 a[32:35], v[160:163], v[240:243], a[32:35]
    ds_read_b128 v[32:35], v22 offset:2304
    v_cvt_pk_bf16_f32 v81, v18, v19
    v_mfma_f32_16x16x32_bf16 a[32:35], v[176:179], v[244:247], a[32:35]
    buffer_load_dwordx4 v8, s[4:7], s27 offen offset:2048 sc1 lds
    v_mfma_f32_16x16x32_bf16 a[80:83], v[164:167], v[240:243], a[80:83]
    ds_read_b128 v[36:39], v22 offset:14592
    v_mfma_f32_16x16x32_bf16 a[80:83], v[180:183], v[244:247], a[80:83]
    s_waitcnt lgkmcnt(4)
    v_exp_f32 v18, v114
    v_mfma_f32_16x16x32_bf16 a[36:39], v[160:163], v[248:251], a[36:39]
    ds_read_b128 v[40:43], v2 offset:0
    v_add_f32 v4, v4, v16
    v_mfma_f32_16x16x32_bf16 a[36:39], v[176:179], v[252:255], a[36:39]
    v_add_f32 v4, v4, v17
    v_mfma_f32_16x16x32_bf16 a[84:87], v[164:167], v[248:251], a[84:87]
    ds_read_b128 v[44:47], v3 offset:0
    v_mfma_f32_16x16x32_bf16 a[84:87], v[180:183], v[252:255], a[84:87]
    s_waitcnt lgkmcnt(4)
    v_exp_f32 v19, v115
    v_mfma_f32_16x16x32_bf16 a[40:43], v[160:163], v[24:27], a[40:43]
    ds_read_b128 v[240:243], v2 offset:6144
    v_cvt_pk_bf16_f32 v82, v16, v17
    v_mfma_f32_16x16x32_bf16 a[40:43], v[176:179], v[28:31], a[40:43]
    v_exp_f32 v16, v84
    v_mfma_f32_16x16x32_bf16 a[88:91], v[164:167], v[24:27], a[88:91]
    ds_read_b128 v[244:247], v3 offset:6144
    v_add_f32 v4, v4, v18
    v_mfma_f32_16x16x32_bf16 a[88:91], v[180:183], v[28:31], a[88:91]
    s_waitcnt lgkmcnt(4)
    v_add_f32 v4, v4, v19
    v_mfma_f32_16x16x32_bf16 a[44:47], v[160:163], v[32:35], a[44:47]
    ds_read_b128 v[248:251], v2 offset:128
    v_mfma_f32_16x16x32_bf16 a[44:47], v[176:179], v[36:39], a[44:47]
    v_exp_f32 v17, v85
    v_mfma_f32_16x16x32_bf16 a[92:95], v[164:167], v[32:35], a[92:95]
    ds_read_b128 v[252:255], v3 offset:128
    v_cvt_pk_bf16_f32 v83, v18, v19
    v_mfma_f32_16x16x32_bf16 a[92:95], v[180:183], v[36:39], a[92:95]
    s_waitcnt lgkmcnt(4)
    v_exp_f32 v18, v86
    v_add_f32 v5, v5, v16
    v_add_f32 v5, v5, v17
    v_exp_f32 v19, v87
    v_cvt_pk_bf16_f32 v84, v16, v17
    v_exp_f32 v16, v116
    v_add_f32 v5, v5, v18
    v_add_f32 v5, v5, v19
    v_exp_f32 v17, v117
    v_cvt_pk_bf16_f32 v85, v18, v19
    v_exp_f32 v18, v118
    v_add_f32 v5, v5, v16
    v_add_f32 v5, v5, v17
    v_exp_f32 v19, v119
    v_cvt_pk_bf16_f32 v86, v16, v17
    v_add_f32 v5, v5, v18
    v_add_f32 v5, v5, v19
    v_cvt_pk_bf16_f32 v87, v18, v19
    v_mfma_f32_16x16x32_bf16 v[160:163], v[40:43], a[192:195], v[128:131]
    ds_read_b128 v[24:27], v2 offset:6272
    v_subrev_u32 v9, 98304, v1
    v_mfma_f32_16x16x32_bf16 v[160:163], v[44:47], a[196:199], v[160:163]
    v_subrev_u32 v10, 98304, v21
    v_subrev_u32 v11, 98304, v22
    v_mfma_f32_16x16x32_bf16 v[164:167], v[40:43], a[216:219], v[132:135]
    ds_read_b128 v[28:31], v3 offset:6272
    v_subrev_u32 v12, 49152, v1
    v_mfma_f32_16x16x32_bf16 v[164:167], v[44:47], a[220:223], v[164:167]
    s_waitcnt lgkmcnt(4)
    v_subrev_u32 v13, 49152, v21
    v_subrev_u32 v0, 49152, v22
    v_mfma_f32_16x16x32_bf16 v[96:99], v[240:243], a[192:195], v[128:131]
    ds_read_b128 v[32:35], v2 offset:256
    v_bfe_u32 v63, v8, 4, 6
    v_mfma_f32_16x16x32_bf16 v[96:99], v[244:247], a[196:199], v[96:99]
    v_and_b32 v62, 48, v63
    v_and_b32 v63, 15, v63
    v_mfma_f32_16x16x32_bf16 v[100:103], v[240:243], a[216:219], v[132:135]
    ds_read_b128 v[36:39], v3 offset:256
    v_mul_u32_u24 v61, 96, v62
    v_mfma_f32_16x16x32_bf16 v[100:103], v[244:247], a[220:223], v[100:103]
    s_waitcnt lgkmcnt(4)
    v_lshl_add_u32 v60, v63, 4, v61
    v_lshl_add_u32 v61, v63, 3, v61
    v_mfma_f32_16x16x32_bf16 v[160:163], v[248:251], a[200:203], v[160:163]
    ds_read_b128 v[40:43], v2 offset:6400
    s_lshl_b32 s24, s95, 2
    v_mfma_f32_16x16x32_bf16 v[160:163], v[252:255], a[204:207], v[160:163]
    s_add_u32 s24, s24, s25
    s_mul_i32 s24, s24, 24576
    v_mov_b32 v63, 1.0
    v_mfma_f32_16x16x32_bf16 v[164:167], v[248:251], a[224:227], v[164:167]
    ds_read_b128 v[44:47], v3 offset:6400
    s_add_u32 s33, s24, 0
    v_mfma_f32_16x16x32_bf16 v[164:167], v[252:255], a[228:231], v[164:167]
    s_waitcnt lgkmcnt(4)
    s_add_u32 s34, s24, 6144
    s_add_u32 s35, s24, 12288
    v_mfma_f32_16x16x32_bf16 v[96:99], v[24:27], a[200:203], v[96:99]
    ds_read_b128 v[240:243], v2 offset:12288
    s_add_u32 s36, s24, 18432
    v_mfma_f32_16x16x32_bf16 v[96:99], v[28:31], a[204:207], v[96:99]
    v_mfma_f32_16x16x32_bf16 v[100:103], v[24:27], a[224:227], v[100:103]
    ds_read_b128 v[244:247], v3 offset:12288
    v_mfma_f32_16x16x32_bf16 v[100:103], v[28:31], a[228:231], v[100:103]
    s_waitcnt lgkmcnt(4)
    v_mfma_f32_16x16x32_bf16 v[160:163], v[32:35], a[208:211], v[160:163]
    ds_read_b128 v[248:251], v2 offset:18432
    v_mfma_f32_16x16x32_bf16 v[160:163], v[36:39], a[212:215], v[160:163]
    v_mfma_f32_16x16x32_bf16 v[164:167], v[32:35], a[232:235], v[164:167]
    ds_read_b128 v[252:255], v3 offset:18432
    v_mfma_f32_16x16x32_bf16 v[164:167], v[36:39], a[236:239], v[164:167]
    s_waitcnt lgkmcnt(4)
    v_mfma_f32_16x16x32_bf16 v[96:99], v[40:43], a[208:211], v[96:99]
    ds_read_b128 v[24:27], v2 offset:12416
    v_mfma_f32_16x16x32_bf16 v[96:99], v[44:47], a[212:215], v[96:99]
    v_mfma_f32_16x16x32_bf16 v[100:103], v[40:43], a[232:235], v[100:103]
    ds_read_b128 v[28:31], v3 offset:12416
    v_mfma_f32_16x16x32_bf16 v[100:103], v[44:47], a[236:239], v[100:103]
    s_waitcnt lgkmcnt(4)
    v_mfma_f32_16x16x32_bf16 v[176:179], v[240:243], a[192:195], v[128:131]
    ds_read_b128 v[32:35], v2 offset:18560
    v_mfma_f32_16x16x32_bf16 v[176:179], v[244:247], a[196:199], v[176:179]
    v_mfma_f32_16x16x32_bf16 v[180:183], v[240:243], a[216:219], v[132:135]
    ds_read_b128 v[36:39], v3 offset:18560
    v_mfma_f32_16x16x32_bf16 v[180:183], v[244:247], a[220:223], v[180:183]
    s_waitcnt lgkmcnt(4)
    v_mfma_f32_16x16x32_bf16 v[112:115], v[248:251], a[192:195], v[128:131]
    ds_read_b128 v[40:43], v2 offset:12544
    v_mfma_f32_16x16x32_bf16 v[112:115], v[252:255], a[196:199], v[112:115]
    s_waitcnt vmcnt(63)
    s_barrier
    v_mfma_f32_16x16x32_bf16 v[116:119], v[248:251], a[216:219], v[132:135]
    ds_read_b128 v[44:47], v3 offset:12544
    v_mfma_f32_16x16x32_bf16 v[116:119], v[252:255], a[220:223], v[116:119]
    s_waitcnt lgkmcnt(4)
    v_exp_f32 v16, v160
    v_mfma_f32_16x16x32_bf16 v[176:179], v[24:27], a[200:203], v[176:179]
    ds_read_b128 v[240:243], v2 offset:18688
    v_mfma_f32_16x16x32_bf16 v[176:179], v[28:31], a[204:207], v[176:179]
    v_exp_f32 v17, v161
    v_mfma_f32_16x16x32_bf16 v[180:183], v[24:27], a[224:227], v[180:183]
    ds_read_b128 v[244:247], v3 offset:18688
    v_mfma_f32_16x16x32_bf16 v[180:183], v[28:31], a[228:231], v[180:183]
    s_waitcnt lgkmcnt(4)
    v_exp_f32 v18, v162
    v_mfma_f32_16x16x32_bf16 v[112:115], v[32:35], a[200:203], v[112:115]
    ds_read_b128 v[248:251], v9 offset:0
    v_add_f32 v4, v4, v16
    v_mfma_f32_16x16x32_bf16 v[112:115], v[36:39], a[204:207], v[112:115]
    v_add_f32 v4, v4, v17
    v_mfma_f32_16x16x32_bf16 v[116:119], v[32:35], a[224:227], v[116:119]
    ds_read_b128 v[252:255], v9 offset:12288
    v_mfma_f32_16x16x32_bf16 v[116:119], v[36:39], a[228:231], v[116:119]
    s_waitcnt lgkmcnt(4)
    v_exp_f32 v19, v163
    v_mfma_f32_16x16x32_bf16 v[176:179], v[40:43], a[208:211], v[176:179]
    ds_read_b128 v[24:27], v9 offset:768
    v_cvt_pk_bf16_f32 v160, v16, v17
    v_mfma_f32_16x16x32_bf16 v[176:179], v[44:47], a[212:215], v[176:179]
    v_exp_f32 v16, v96
    v_mfma_f32_16x16x32_bf16 v[180:183], v[40:43], a[232:235], v[180:183]
    ds_read_b128 v[28:31], v9 offset:13056
    v_add_f32 v4, v4, v18
    v_mfma_f32_16x16x32_bf16 v[180:183], v[44:47], a[236:239], v[180:183]
    s_waitcnt lgkmcnt(4)
    v_add_f32 v4, v4, v19
    v_mfma_f32_16x16x32_bf16 v[112:115], v[240:243], a[208:211], v[112:115]
    ds_read_b128 v[32:35], v9 offset:1536
    v_mfma_f32_16x16x32_bf16 v[112:115], v[244:247], a[212:215], v[112:115]
    v_exp_f32 v17, v97
    v_mfma_f32_16x16x32_bf16 v[116:119], v[240:243], a[232:235], v[116:119]
    ds_read_b128 v[36:39], v9 offset:13824
    v_cvt_pk_bf16_f32 v161, v18, v19
    v_mfma_f32_16x16x32_bf16 v[116:119], v[244:247], a[236:239], v[116:119]
    s_waitcnt lgkmcnt(4)
    v_exp_f32 v18, v98
    v_mfma_f32_16x16x32_bf16 a[0:3], v[64:67], v[248:251], a[0:3]
    ds_read_b128 v[40:43], v9 offset:2304
    s_mov_b32 s29, 0x5f800000
    v_mfma_f32_16x16x32_bf16 a[0:3], v[80:83], v[252:255], a[0:3]
    v_add_f32 v4, v4, v16
    v_add_f32 v4, v4, v17
    v_mfma_f32_16x16x32_bf16 a[48:51], v[68:71], v[248:251], a[48:51]
    ds_read_b128 v[44:47], v9 offset:14592
    v_mfma_f32_16x16x32_bf16 a[48:51], v[84:87], v[252:255], a[48:51]
    s_waitcnt lgkmcnt(4)
    v_exp_f32 v19, v99
    v_mfma_f32_16x16x32_bf16 a[4:7], v[64:67], v[24:27], a[4:7]
    ds_read_b128 v[240:243], v10 offset:0
    v_cvt_pk_bf16_f32 v162, v16, v17
    v_mfma_f32_16x16x32_bf16 a[4:7], v[80:83], v[28:31], a[4:7]
    v_exp_f32 v16, v164
    v_mfma_f32_16x16x32_bf16 a[52:55], v[68:71], v[24:27], a[52:55]
    ds_read_b128 v[244:247], v10 offset:12288
    v_add_f32 v4, v4, v18
    v_mfma_f32_16x16x32_bf16 a[52:55], v[84:87], v[28:31], a[52:55]
    s_waitcnt lgkmcnt(4)
    v_add_f32 v4, v4, v19
    v_mfma_f32_16x16x32_bf16 a[8:11], v[64:67], v[32:35], a[8:11]
    ds_read_b128 v[248:251], v10 offset:768
    v_mfma_f32_16x16x32_bf16 a[8:11], v[80:83], v[36:39], a[8:11]
    v_exp_f32 v17, v165
    v_mfma_f32_16x16x32_bf16 a[56:59], v[68:71], v[32:35], a[56:59]
    ds_read_b128 v[252:255], v10 offset:13056
    v_cvt_pk_bf16_f32 v163, v18, v19
    v_mfma_f32_16x16x32_bf16 a[56:59], v[84:87], v[36:39], a[56:59]
    s_waitcnt lgkmcnt(4)
    v_exp_f32 v18, v166
    v_mfma_f32_16x16x32_bf16 a[12:15], v[64:67], v[40:43], a[12:15]
    ds_read_b128 v[24:27], v10 offset:1536
    v_add_f32 v5, v5, v16
    v_mfma_f32_16x16x32_bf16 a[12:15], v[80:83], v[44:47], a[12:15]
    v_add_f32 v5, v5, v17
    v_mfma_f32_16x16x32_bf16 a[60:63], v[68:71], v[40:43], a[60:63]
    ds_read_b128 v[28:31], v10 offset:13824
    v_mfma_f32_16x16x32_bf16 a[60:63], v[84:87], v[44:47], a[60:63]
    s_waitcnt lgkmcnt(4)
    v_exp_f32 v19, v167
    v_mfma_f32_16x16x32_bf16 a[16:19], v[64:67], v[240:243], a[16:19]
    ds_read_b128 v[32:35], v10 offset:2304
    v_cvt_pk_bf16_f32 v164, v16, v17
    v_mfma_f32_16x16x32_bf16 a[16:19], v[80:83], v[244:247], a[16:19]
    v_exp_f32 v16, v100
    v_mfma_f32_16x16x32_bf16 a[64:67], v[68:71], v[240:243], a[64:67]
    ds_read_b128 v[36:39], v10 offset:14592
    v_add_f32 v5, v5, v18
    v_mfma_f32_16x16x32_bf16 a[64:67], v[84:87], v[244:247], a[64:67]
    s_waitcnt lgkmcnt(4)
    v_add_f32 v5, v5, v19
    v_mfma_f32_16x16x32_bf16 a[20:23], v[64:67], v[248:251], a[20:23]
    ds_read_b128 v[40:43], v11 offset:0
    v_mfma_f32_16x16x32_bf16 a[20:23], v[80:83], v[252:255], a[20:23]
    v_exp_f32 v17, v101
    v_mfma_f32_16x16x32_bf16 a[68:71], v[68:71], v[248:251], a[68:71]
    ds_read_b128 v[44:47], v11 offset:12288
    v_cvt_pk_bf16_f32 v165, v18, v19
    v_mfma_f32_16x16x32_bf16 a[68:71], v[84:87], v[252:255], a[68:71]
    s_waitcnt lgkmcnt(4)
    v_exp_f32 v18, v102
    v_mfma_f32_16x16x32_bf16 a[24:27], v[64:67], v[24:27], a[24:27]
    ds_read_b128 v[240:243], v11 offset:768
    v_add_f32 v5, v5, v16
    v_mfma_f32_16x16x32_bf16 a[24:27], v[80:83], v[28:31], a[24:27]
    v_add_f32 v5, v5, v17
    v_mfma_f32_16x16x32_bf16 a[72:75], v[68:71], v[24:27], a[72:75]
    ds_read_b128 v[244:247], v11 offset:13056
    v_mfma_f32_16x16x32_bf16 a[72:75], v[84:87], v[28:31], a[72:75]
    s_waitcnt lgkmcnt(4)
    v_exp_f32 v19, v103
    v_mfma_f32_16x16x32_bf16 a[28:31], v[64:67], v[32:35], a[28:31]
    ds_read_b128 v[248:251], v11 offset:1536
    v_cvt_pk_bf16_f32 v166, v16, v17
    v_mfma_f32_16x16x32_bf16 a[28:31], v[80:83], v[36:39], a[28:31]
    s_waitcnt vmcnt(0)
    s_barrier
    v_mfma_f32_16x16x32_bf16 a[76:79], v[68:71], v[32:35], a[76:79]
    ds_read_b128 v[252:255], v11 offset:13824
    v_add_f32 v5, v5, v18
    v_mfma_f32_16x16x32_bf16 a[76:79], v[84:87], v[36:39], a[76:79]
    s_waitcnt lgkmcnt(4)
    v_add_f32 v5, v5, v19
    v_cvt_pk_bf16_f32 v167, v18, v19
    v_mfma_f32_16x16x32_bf16 a[32:35], v[64:67], v[40:43], a[32:35]
    ds_read_b128 v[24:27], v11 offset:2304
    v_mfma_f32_16x16x32_bf16 a[32:35], v[80:83], v[44:47], a[32:35]
    v_exp_f32 v16, v176
    v_mfma_f32_16x16x32_bf16 a[80:83], v[68:71], v[40:43], a[80:83]
    ds_read_b128 v[28:31], v11 offset:14592
    v_mfma_f32_16x16x32_bf16 a[80:83], v[84:87], v[44:47], a[80:83]
    s_waitcnt lgkmcnt(4)
    v_exp_f32 v17, v177
    v_mfma_f32_16x16x32_bf16 a[36:39], v[64:67], v[240:243], a[36:39]
    ds_read_b128 v[32:35], v12 offset:0
    v_mfma_f32_16x16x32_bf16 a[36:39], v[80:83], v[244:247], a[36:39]
    v_exp_f32 v18, v178
    v_mfma_f32_16x16x32_bf16 a[84:87], v[68:71], v[240:243], a[84:87]
    ds_read_b128 v[36:39], v12 offset:12288
    v_add_f32 v4, v4, v16
    v_mfma_f32_16x16x32_bf16 a[84:87], v[84:87], v[244:247], a[84:87]
    s_waitcnt lgkmcnt(4)
    v_add_f32 v4, v4, v17
    v_mfma_f32_16x16x32_bf16 a[40:43], v[64:67], v[248:251], a[40:43]
    ds_read_b128 v[40:43], v12 offset:768
    v_mfma_f32_16x16x32_bf16 a[40:43], v[80:83], v[252:255], a[40:43]
    v_exp_f32 v19, v179
    v_mfma_f32_16x16x32_bf16 a[88:91], v[68:71], v[248:251], a[88:91]
    ds_read_b128 v[44:47], v12 offset:13056
    v_cvt_pk_bf16_f32 v176, v16, v17
    v_mfma_f32_16x16x32_bf16 a[88:91], v[84:87], v[252:255], a[88:91]
    s_waitcnt lgkmcnt(4)
    v_exp_f32 v16, v112
    v_mfma_f32_16x16x32_bf16 a[44:47], v[64:67], v[24:27], a[44:47]
    ds_read_b128 v[240:243], v12 offset:1536
    v_add_f32 v4, v4, v18
    v_mfma_f32_16x16x32_bf16 a[44:47], v[80:83], v[28:31], a[44:47]
    v_add_f32 v4, v4, v19
    v_mfma_f32_16x16x32_bf16 a[92:95], v[68:71], v[24:27], a[92:95]
    ds_read_b128 v[244:247], v12 offset:13824
    v_mfma_f32_16x16x32_bf16 a[92:95], v[84:87], v[28:31], a[92:95]
    s_waitcnt lgkmcnt(4)
    v_exp_f32 v17, v113
    v_cvt_pk_bf16_f32 v177, v18, v19
    v_exp_f32 v18, v114
    v_add_f32 v4, v4, v16
    v_add_f32 v4, v4, v17
    v_exp_f32 v19, v115
    v_cvt_pk_bf16_f32 v178, v16, v17
    v_exp_f32 v16, v180
    v_add_f32 v4, v4, v18
    v_add_f32 v4, v4, v19
    v_exp_f32 v17, v181
    v_cvt_pk_bf16_f32 v179, v18, v19
    v_exp_f32 v18, v182
    v_add_f32 v5, v5, v16
    v_add_f32 v5, v5, v17
    v_exp_f32 v19, v183
    v_cvt_pk_bf16_f32 v180, v16, v17
    v_exp_f32 v16, v116
    v_add_f32 v5, v5, v18
    v_add_f32 v5, v5, v19
    v_exp_f32 v17, v117
    v_cvt_pk_bf16_f32 v181, v18, v19
    v_exp_f32 v18, v118
    v_add_f32 v5, v5, v16
    v_add_f32 v5, v5, v17
    v_exp_f32 v19, v119
    v_cvt_pk_bf16_f32 v182, v16, v17
    v_add_f32 v5, v5, v18
    v_add_f32 v5, v5, v19
    v_cvt_pk_bf16_f32 v183, v18, v19
    s_nop 4
    v_cmp_nge_f32 vcc, s29, v4
    v_cmp_nge_f32_e64 s[56:57], s29, v5
    s_nop 0
    s_or_b64 vcc, vcc, s[56:57]
    v_mfma_f32_16x16x4_f32 v[48:51], v4, v63, 0
    v_mfma_f32_16x16x4_f32 v[52:55], v5, v63, 0
    s_cbranch_vccnz L_slow
    v_mfma_f32_16x16x32_bf16 a[0:3], v[160:163], v[32:35], a[0:3]
    ds_read_b128 v[248:251], v12 offset:2304
    v_mfma_f32_16x16x32_bf16 a[0:3], v[176:179], v[36:39], a[0:3]
    v_exp_f32 v16, v72
    v_mfma_f32_16x16x32_bf16 a[48:51], v[164:167], v[32:35], a[48:51]
    ds_read_b128 v[252:255], v12 offset:14592
    v_mfma_f32_16x16x32_bf16 a[48:51], v[180:183], v[36:39], a[48:51]
    s_waitcnt lgkmcnt(4)
    v_exp_f32 v17, v73
    v_mfma_f32_16x16x32_bf16 a[4:7], v[160:163], v[40:43], a[4:7]
    ds_read_b128 v[24:27], v13 offset:0
    v_mfma_f32_16x16x32_bf16 a[4:7], v[176:179], v[44:47], a[4:7]
    v_exp_f32 v18, v74
    v_mfma_f32_16x16x32_bf16 a[52:55], v[164:167], v[40:43], a[52:55]
    ds_read_b128 v[28:31], v13 offset:12288
    v_add_f32 v6, v6, v16
    v_mfma_f32_16x16x32_bf16 a[52:55], v[180:183], v[44:47], a[52:55]
    s_waitcnt lgkmcnt(4)
    v_add_f32 v6, v6, v17
    v_mfma_f32_16x16x32_bf16 a[8:11], v[160:163], v[240:243], a[8:11]
    ds_read_b128 v[32:35], v13 offset:768
    v_mfma_f32_16x16x32_bf16 a[8:11], v[176:179], v[244:247], a[8:11]
    v_exp_f32 v19, v75
    v_mfma_f32_16x16x32_bf16 a[56:59], v[164:167], v[240:243], a[56:59]
    ds_read_b128 v[36:39], v13 offset:13056
    v_cvt_pk_bf16_f32 v72, v16, v17
    v_mfma_f32_16x16x32_bf16 a[56:59], v[180:183], v[244:247], a[56:59]
    s_waitcnt lgkmcnt(4)
    v_exp_f32 v16, v104
    v_mfma_f32_16x16x32_bf16 a[12:15], v[160:163], v[248:251], a[12:15]
    ds_read_b128 v[40:43], v13 offset:1536
    v_add_f32 v6, v6, v18
    v_mfma_f32_16x16x32_bf16 a[12:15], v[176:179], v[252:255], a[12:15]
    v_add_f32 v6, v6, v19
    v_mfma_f32_16x16x32_bf16 a[60:63], v[164:167], v[248:251], a[60:63]
    ds_read_b128 v[44:47], v13 offset:13824
    v_mfma_f32_16x16x32_bf16 a[60:63], v[180:183], v[252:255], a[60:63]
    s_waitcnt lgkmcnt(4)
    v_exp_f32 v17, v105
    v_mfma_f32_16x16x32_bf16 a[16:19], v[160:163], v[24:27], a[16:19]
    ds_read_b128 v[240:243], v13 offset:2304
    v_cvt_pk_bf16_f32 v73, v18, v19
    v_mfma_f32_16x16x32_bf16 a[16:19], v[176:179], v[28:31], a[16:19]
    v_exp_f32 v18, v106
    v_mfma_f32_16x16x32_bf16 a[64:67], v[164:167], v[24:27], a[64:67]
    ds_read_b128 v[244:247], v13 offset:14592
    v_add_f32 v6, v6, v16
    v_mfma_f32_16x16x32_bf16 a[64:67], v[180:183], v[28:31], a[64:67]
    s_waitcnt lgkmcnt(4)
    v_add_f32 v6, v6, v17
    v_mfma_f32_16x16x32_bf16 a[20:23], v[160:163], v[32:35], a[20:23]
    ds_read_b128 v[248:251], v0 offset:0
    v_mfma_f32_16x16x32_bf16 a[20:23], v[176:179], v[36:39], a[20:23]
    v_exp_f32 v19, v107
    v_mfma_f32_16x16x32_bf16 a[68:71], v[164:167], v[32:35], a[68:71]
    ds_read_b128 v[252:255], v0 offset:12288
    v_cvt_pk_bf16_f32 v74, v16, v17
    v_mfma_f32_16x16x32_bf16 a[68:71], v[180:183], v[36:39], a[68:71]
    s_waitcnt lgkmcnt(4)
    v_exp_f32 v16, v76
    v_mfma_f32_16x16x32_bf16 a[24:27], v[160:163], v[40:43], a[24:27]
    ds_read_b128 v[24:27], v0 offset:768
    v_add_f32 v6, v6, v18
    v_mfma_f32_16x16x32_bf16 a[24:27], v[176:179], v[44:47], a[24:27]
    v_add_f32 v6, v6, v19
    v_mfma_f32_16x16x32_bf16 a[72:75], v[164:167], v[40:43], a[72:75]
    ds_read_b128 v[28:31], v0 offset:13056
    v_mfma_f32_16x16x32_bf16 a[72:75], v[180:183], v[44:47], a[72:75]
    s_waitcnt lgkmcnt(4)
    v_exp_f32 v17, v77
    v_mfma_f32_16x16x32_bf16 a[28:31], v[160:163], v[240:243], a[28:31]
    ds_read_b128 v[32:35], v0 offset:1536
    v_cvt_pk_bf16_f32 v75, v18, v19
    v_mfma_f32_16x16x32_bf16 a[28:31], v[176:179], v[244:247], a[28:31]
    v_exp_f32 v18, v78
    v_mfma_f32_16x16x32_bf16 a[76:79], v[164:167], v[240:243], a[76:79]
    ds_read_b128 v[36:39], v0 offset:13824
    v_add_f32 v7, v7, v16
    v_mfma_f32_16x16x32_bf16 a[76:79], v[180:183], v[244:247], a[76:79]
    s_waitcnt lgkmcnt(4)
    v_add_f32 v7, v7, v17
    v_mfma_f32_16x16x32_bf16 a[32:35], v[160:163], v[248:251], a[32:35]
    ds_read_b128 v[40:43], v0 offset:2304
    v_mfma_f32_16x16x32_bf16 a[32:35], v[176:179], v[252:255], a[32:35]
    v_exp_f32 v19, v79
    v_mfma_f32_16x16x32_bf16 a[80:83], v[164:167], v[248:251], a[80:83]
    ds_read_b128 v[44:47], v0 offset:14592
    v_cvt_pk_bf16_f32 v76, v16, v17
    v_mfma_f32_16x16x32_bf16 a[80:83], v[180:183], v[252:255], a[80:83]
    s_waitcnt lgkmcnt(4)
    v_exp_f32 v16, v108
    v_mfma_f32_16x16x32_bf16 a[36:39], v[160:163], v[24:27], a[36:39]
    ds_read_b128 v[240:243], v1 offset:0
    v_add_f32 v7, v7, v18
    v_mfma_f32_16x16x32_bf16 a[36:39], v[176:179], v[28:31], a[36:39]
    v_add_f32 v7, v7, v19
    v_mfma_f32_16x16x32_bf16 a[84:87], v[164:167], v[24:27], a[84:87]
    ds_read_b128 v[244:247], v1 offset:12288
    v_mfma_f32_16x16x32_bf16 a[84:87], v[180:183], v[28:31], a[84:87]
    s_waitcnt lgkmcnt(4)
    v_exp_f32 v17, v109
    v_mfma_f32_16x16x32_bf16 a[40:43], v[160:163], v[32:35], a[40:43]
    ds_read_b128 v[248:251], v1 offset:768
    v_cvt_pk_bf16_f32 v77, v18, v19
    v_mfma_f32_16x16x32_bf16 a[40:43], v[176:179], v[36:39], a[40:43]
    v_exp_f32 v18, v110
    v_mfma_f32_16x16x32_bf16 a[88:91], v[164:167], v[32:35], a[88:91]
    ds_read_b128 v[252:255], v1 offset:13056
    v_add_f32 v7, v7, v16
    v_mfma_f32_16x16x32_bf16 a[88:91], v[180:183], v[36:39], a[88:91]
    s_waitcnt lgkmcnt(4)
    v_add_f32 v7, v7, v17
    v_mfma_f32_16x16x32_bf16 a[44:47], v[160:163], v[40:43], a[44:47]
    ds_read_b128 v[24:27], v1 offset:1536
    v_mfma_f32_16x16x32_bf16 a[44:47], v[176:179], v[44:47], a[44:47]
    v_exp_f32 v19, v111
    v_mfma_f32_16x16x32_bf16 a[92:95], v[164:167], v[40:43], a[92:95]
    ds_read_b128 v[28:31], v1 offset:13824
    v_cvt_pk_bf16_f32 v78, v16, v17
    v_mfma_f32_16x16x32_bf16 a[92:95], v[180:183], v[44:47], a[92:95]
    s_waitcnt lgkmcnt(4)
    v_add_f32 v7, v7, v18
    v_add_f32 v7, v7, v19
    v_cvt_pk_bf16_f32 v79, v18, v19
    v_rcp_f32 v48, v48
    v_rcp_f32 v49, v49
    v_rcp_f32 v50, v50
    v_rcp_f32 v51, v51
    v_rcp_f32 v52, v52
    v_rcp_f32 v53, v53
    v_rcp_f32 v54, v54
    v_rcp_f32 v55, v55
    s_branch L_skip15
L_pad15:
    s_branch L_tb2_0
L_skip15:
    v_mfma_f32_16x16x32_bf16 a[96:99], v[168:171], v[240:243], a[96:99]
    ds_read_b128 v[32:35], v1 offset:2304
    v_accvgpr_read_b32 v224, a0
    v_mfma_f32_16x16x32_bf16 a[96:99], v[184:187], v[244:247], a[96:99]
    s_nop 3
    v_accvgpr_read_b32 v225, a4
    v_accvgpr_read_b32 v226, a8
    v_accvgpr_read_b32 v227, a12
    v_mfma_f32_16x16x32_bf16 a[144:147], v[172:175], v[240:243], a[144:147]
    ds_read_b128 v[36:39], v1 offset:14592
    v_accvgpr_read_b32 v228, a16
    v_mfma_f32_16x16x32_bf16 a[144:147], v[188:191], v[244:247], a[144:147]
    s_waitcnt lgkmcnt(4)
    v_accvgpr_read_b32 v229, a20
    v_accvgpr_read_b32 v230, a24
    v_accvgpr_read_b32 v231, a28
    v_accvgpr_read_b32 v232, a32
    v_accvgpr_read_b32 v233, a36
    v_accvgpr_read_b32 v234, a40
    v_mfma_f32_16x16x32_bf16 a[100:103], v[168:171], v[248:251], a[100:103]
    ds_read_b128 v[40:43], v21 offset:0
    v_accvgpr_read_b32 v235, a44
    v_mfma_f32_16x16x32_bf16 a[100:103], v[184:187], v[252:255], a[100:103]
    v_mul_f32 v224, v224, v48
    v_mul_f32 v225, v225, v48
    v_mul_f32 v226, v226, v48
    v_mul_f32 v227, v227, v48
    v_mul_f32 v228, v228, v48
    v_mul_f32 v229, v229, v48
    v_mfma_f32_16x16x32_bf16 a[148:151], v[172:175], v[248:251], a[148:151]
    ds_read_b128 v[44:47], v21 offset:12288
    v_mul_f32 v230, v230, v48
    v_mfma_f32_16x16x32_bf16 a[148:151], v[188:191], v[252:255], a[148:151]
    s_waitcnt lgkmcnt(4)
    v_mul_f32 v231, v231, v48
    v_mul_f32 v232, v232, v48
    v_mul_f32 v233, v233, v48
    v_mul_f32 v234, v234, v48
    v_mul_f32 v235, v235, v48
    v_cvt_pk_bf16_f32 v224, v224, v225
    v_mfma_f32_16x16x32_bf16 a[104:107], v[168:171], v[24:27], a[104:107]
    ds_read_b128 v[240:243], v21 offset:768
    v_cvt_pk_bf16_f32 v225, v226, v227
    v_mfma_f32_16x16x32_bf16 a[104:107], v[184:187], v[28:31], a[104:107]
    v_cvt_pk_bf16_f32 v226, v228, v229
    v_cvt_pk_bf16_f32 v227, v230, v231
    v_cvt_pk_bf16_f32 v228, v232, v233
    v_cvt_pk_bf16_f32 v229, v234, v235
    v_mfma_f32_16x16x32_bf16 a[152:155], v[172:175], v[24:27], a[152:155]
    ds_read_b128 v[244:247], v21 offset:13056
    v_mfma_f32_16x16x32_bf16 a[152:155], v[188:191], v[28:31], a[152:155]
    s_waitcnt lgkmcnt(4)
    buffer_store_dwordx4 v[224:227], v60, s[12:15], s33 offen offset:0 sc0 sc1
    buffer_store_dwordx2 v[228:229], v61, s[12:15], s33 offen offset:256 sc0 sc1
    v_mfma_f32_16x16x32_bf16 a[108:111], v[168:171], v[32:35], a[108:111]
    ds_read_b128 v[248:251], v21 offset:1536
    v_accvgpr_read_b32 v144, a1
    v_mfma_f32_16x16x32_bf16 a[108:111], v[184:187], v[36:39], a[108:111]
    v_accvgpr_read_b32 v145, a5
    v_accvgpr_read_b32 v146, a9
    v_accvgpr_read_b32 v147, a13
    v_accvgpr_read_b32 v148, a17
    v_accvgpr_read_b32 v149, a21
    v_accvgpr_read_b32 v150, a25
    v_mfma_f32_16x16x32_bf16 a[156:159], v[172:175], v[32:35], a[156:159]
    ds_read_b128 v[252:255], v21 offset:13824
    v_accvgpr_read_b32 v151, a29
    v_mfma_f32_16x16x32_bf16 a[156:159], v[188:191], v[36:39], a[156:159]
    s_waitcnt lgkmcnt(4)
    v_accvgpr_read_b32 v152, a33
    v_accvgpr_read_b32 v153, a37
    v_accvgpr_read_b32 v154, a41
    v_accvgpr_read_b32 v155, a45
    v_mul_f32 v144, v144, v49
    v_mul_f32 v145, v145, v49
    v_mfma_f32_16x16x32_bf16 a[112:115], v[168:171], v[40:43], a[112:115]
    ds_read_b128 v[24:27], v21 offset:2304
    v_mul_f32 v146, v146, v49
    v_mfma_f32_16x16x32_bf16 a[112:115], v[184:187], v[44:47], a[112:115]
    v_mul_f32 v147, v147, v49
    v_mul_f32 v148, v148, v49
    v_mul_f32 v149, v149, v49
    v_mul_f32 v150, v150, v49
    v_mul_f32 v151, v151, v49
    v_mul_f32 v152, v152, v49
    v_mfma_f32_16x16x32_bf16 a[160:163], v[172:175], v[40:43], a[160:163]
    ds_read_b128 v[28:31], v21 offset:14592
    v_mul_f32 v153, v153, v49
    v_mfma_f32_16x16x32_bf16 a[160:163], v[188:191], v[44:47], a[160:163]
    s_waitcnt lgkmcnt(4)
    v_mul_f32 v154, v154, v49
    v_mul_f32 v155, v155, v49
    v_cvt_pk_bf16_f32 v144, v144, v145
    v_cvt_pk_bf16_f32 v145, v146, v147
    v_cvt_pk_bf16_f32 v146, v148, v149
    v_cvt_pk_bf16_f32 v147, v150, v151
    v_mfma_f32_16x16x32_bf16 a[116:119], v[168:171], v[240:243], a[116:119]
    ds_read_b128 v[32:35], v22 offset:0
    v_cvt_pk_bf16_f32 v148, v152, v153
    v_mfma_f32_16x16x32_bf16 a[116:119], v[184:187], v[244:247], a[116:119]
    v_cvt_pk_bf16_f32 v149, v154, v155
    buffer_store_dwordx4 v[144:147], v60, s[12:15], s33 offen offset:384 sc0 sc1
    v_mfma_f32_16x16x32_bf16 a[164:167], v[172:175], v[240:243], a[164:167]
    ds_read_b128 v[36:39], v22 offset:12288
    v_mfma_f32_16x16x32_bf16 a[164:167], v[188:191], v[244:247], a[164:167]
    s_waitcnt lgkmcnt(4)
    buffer_store_dwordx2 v[148:149], v61, s[12:15], s33 offen offset:640 sc0 sc1
    v_accvgpr_read_b32 v224, a2
    v_accvgpr_read_b32 v225, a6
    v_accvgpr_read_b32 v226, a10
    v_mfma_f32_16x16x32_bf16 a[120:123], v[168:171], v[248:251], a[120:123]
    ds_read_b128 v[40:43], v22 offset:768
    v_accvgpr_read_b32 v227, a14
    v_mfma_f32_16x16x32_bf16 a[120:123], v[184:187], v[252:255], a[120:123]
    v_accvgpr_read_b32 v228, a18
    v_accvgpr_read_b32 v229, a22
    v_accvgpr_read_b32 v230, a26
    v_accvgpr_read_b32 v231, a30
    v_accvgpr_read_b32 v232, a34
    v_accvgpr_read_b32 v233, a38
    v_mfma_f32_16x16x32_bf16 a[168:171], v[172:175], v[248:251], a[168:171]
    ds_read_b128 v[44:47], v22 offset:13056
    v_accvgpr_read_b32 v234, a42
    v_mfma_f32_16x16x32_bf16 a[168:171], v[188:191], v[252:255], a[168:171]
    s_waitcnt lgkmcnt(4)
    v_accvgpr_read_b32 v235, a46
    v_mul_f32 v224, v224, v50
    v_mul_f32 v225, v225, v50
    v_mul_f32 v226, v226, v50
    v_mul_f32 v227, v227, v50
    v_mul_f32 v228, v228, v50
    v_mfma_f32_16x16x32_bf16 a[124:127], v[168:171], v[24:27], a[124:127]
    ds_read_b128 v[240:243], v22 offset:1536
    v_mul_f32 v229, v229, v50
    v_mfma_f32_16x16x32_bf16 a[124:127], v[184:187], v[28:31], a[124:127]
    v_exp_f32 v16, v88
    v_exp_f32 v17, v89
    v_exp_f32 v18, v90
    v_mfma_f32_16x16x32_bf16 a[172:175], v[172:175], v[24:27], a[172:175]
    ds_read_b128 v[244:247], v22 offset:13824
    v_add_f32 v6, v6, v16
    v_mfma_f32_16x16x32_bf16 a[172:175], v[188:191], v[28:31], a[172:175]
    s_waitcnt lgkmcnt(4)
    v_add_f32 v6, v6, v17
    v_exp_f32 v19, v91
    v_cvt_pk_bf16_f32 v88, v16, v17
    v_exp_f32 v16, v120
    v_mfma_f32_16x16x32_bf16 a[128:131], v[168:171], v[32:35], a[128:131]
    ds_read_b128 v[248:251], v22 offset:2304
    v_add_f32 v6, v6, v18
    v_mfma_f32_16x16x32_bf16 a[128:131], v[184:187], v[36:39], a[128:131]
    v_add_f32 v6, v6, v19
    v_exp_f32 v17, v121
    v_cvt_pk_bf16_f32 v89, v18, v19
    v_exp_f32 v18, v122
    v_mfma_f32_16x16x32_bf16 a[176:179], v[172:175], v[32:35], a[176:179]
    ds_read_b128 v[252:255], v22 offset:14592
    v_add_f32 v6, v6, v16
    v_mfma_f32_16x16x32_bf16 a[176:179], v[188:191], v[36:39], a[176:179]
    s_waitcnt lgkmcnt(4)
    v_add_f32 v6, v6, v17
    v_exp_f32 v19, v123
    v_cvt_pk_bf16_f32 v90, v16, v17
    v_add_f32 v6, v6, v18
    v_add_f32 v6, v6, v19
    v_mfma_f32_16x16x32_bf16 a[132:135], v[168:171], v[40:43], a[132:135]
    ds_read_b128 v[24:27], v2 offset:0
    v_cvt_pk_bf16_f32 v91, v18, v19
    v_mfma_f32_16x16x32_bf16 a[132:135], v[184:187], v[44:47], a[132:135]
    v_mul_f32 v230, v230, v50
    v_mul_f32 v231, v231, v50
    v_mul_f32 v232, v232, v50
    v_mul_f32 v233, v233, v50
    v_mul_f32 v234, v234, v50
    v_mul_f32 v235, v235, v50
    v_mfma_f32_16x16x32_bf16 a[180:183], v[172:175], v[40:43], a[180:183]
    ds_read_b128 v[28:31], v3 offset:0
    v_cvt_pk_bf16_f32 v224, v224, v225
    v_mfma_f32_16x16x32_bf16 a[180:183], v[188:191], v[44:47], a[180:183]
    s_waitcnt lgkmcnt(4)
    v_cvt_pk_bf16_f32 v225, v226, v227
    v_cvt_pk_bf16_f32 v226, v228, v229
    v_cvt_pk_bf16_f32 v227, v230, v231
    v_cvt_pk_bf16_f32 v228, v232, v233
    v_cvt_pk_bf16_f32 v229, v234, v235
    v_mfma_f32_16x16x32_bf16 a[136:139], v[168:171], v[240:243], a[136:139]
    ds_read_b128 v[32:35], v2 offset:6144
    v_mfma_f32_16x16x32_bf16 a[136:139], v[184:187], v[244:247], a[136:139]
    buffer_store_dwordx4 v[224:227], v60, s[12:15], s33 offen offset:768 sc0 sc1
    buffer_store_dwordx2 v[228:229], v61, s[12:15], s33 offen offset:1024 sc0 sc1
    v_mfma_f32_16x16x32_bf16 a[184:187], v[172:175], v[240:243], a[184:187]
    ds_read_b128 v[36:39], v3 offset:6144
    v_accvgpr_read_b32 v144, a3
    v_mfma_f32_16x16x32_bf16 a[184:187], v[188:191], v[244:247], a[184:187]
    s_waitcnt lgkmcnt(4)
    v_accvgpr_read_b32 v145, a7
    v_accvgpr_read_b32 v146, a11
    v_accvgpr_read_b32 v147, a15
    v_accvgpr_read_b32 v148, a19
    v_accvgpr_read_b32 v149, a23
    v_accvgpr_read_b32 v150, a27
    v_mfma_f32_16x16x32_bf16 a[140:143], v[168:171], v[248:251], a[140:143]
    ds_read_b128 v[40:43], v2 offset:128
    v_accvgpr_read_b32 v151, a31
    v_mfma_f32_16x16x32_bf16 a[140:143], v[184:187], v[252:255], a[140:143]
    v_accvgpr_read_b32 v152, a35
    v_accvgpr_read_b32 v153, a39
    v_accvgpr_read_b32 v154, a43
    v_accvgpr_read_b32 v155, a47
    v_mul_f32 v144, v144, v51
    v_mul_f32 v145, v145, v51
    v_mfma_f32_16x16x32_bf16 a[188:191], v[172:175], v[248:251], a[188:191]
    ds_read_b128 v[44:47], v3 offset:128
    v_mul_f32 v146, v146, v51
    v_mfma_f32_16x16x32_bf16 a[188:191], v[188:191], v[252:255], a[188:191]
    s_waitcnt lgkmcnt(4)
    v_mul_f32 v147, v147, v51
    v_mul_f32 v148, v148, v51
    v_mul_f32 v149, v149, v51
    v_mul_f32 v150, v150, v51
    v_mul_f32 v151, v151, v51
    v_mul_f32 v152, v152, v51
    v_mfma_f32_16x16x32_bf16 v[168:171], v[24:27], a[240:243], v[136:139]
    ds_read_b128 v[240:243], v2 offset:6272
    v_mul_f32 v153, v153, v51
    v_mfma_f32_16x16x32_bf16 v[168:171], v[28:31], a[244:247], v[168:171]
    v_exp_f32 v16, v92
    v_exp_f32 v17, v93
    v_exp_f32 v18, v94
    v_mfma_f32_16x16x32_bf16 v[172:175], v[24:27], v[200:203], v[140:143]
    ds_read_b128 v[244:247], v3 offset:6272
    v_add_f32 v7, v7, v16
    v_mfma_f32_16x16x32_bf16 v[172:175], v[28:31], v[204:207], v[172:175]
    s_waitcnt lgkmcnt(4)
    v_add_f32 v7, v7, v17
    v_exp_f32 v19, v95
    v_cvt_pk_bf16_f32 v92, v16, v17
    v_exp_f32 v16, v124
    v_mfma_f32_16x16x32_bf16 v[104:107], v[32:35], a[240:243], v[136:139]
    ds_read_b128 v[248:251], v2 offset:256
    v_add_f32 v7, v7, v18
    v_mfma_f32_16x16x32_bf16 v[104:107], v[36:39], a[244:247], v[104:107]
    v_add_f32 v7, v7, v19
    v_exp_f32 v17, v125
    v_cvt_pk_bf16_f32 v93, v18, v19
    v_exp_f32 v18, v126
    v_mfma_f32_16x16x32_bf16 v[108:111], v[32:35], v[200:203], v[140:143]
    ds_read_b128 v[252:255], v3 offset:256
    v_add_f32 v7, v7, v16
    v_mfma_f32_16x16x32_bf16 v[108:111], v[36:39], v[204:207], v[108:111]
    s_waitcnt lgkmcnt(4)
    v_add_f32 v7, v7, v17
    v_exp_f32 v19, v127
    v_cvt_pk_bf16_f32 v94, v16, v17
    v_add_f32 v7, v7, v18
    v_add_f32 v7, v7, v19
    v_mfma_f32_16x16x32_bf16 v[168:171], v[40:43], a[248:251], v[168:171]
    ds_read_b128 v[24:27], v2 offset:6400
    v_cvt_pk_bf16_f32 v95, v18, v19
    v_mfma_f32_16x16x32_bf16 v[168:171], v[44:47], a[252:255], v[168:171]
    v_mul_f32 v154, v154, v51
    v_mul_f32 v155, v155, v51
    v_cvt_pk_bf16_f32 v144, v144, v145
    v_cvt_pk_bf16_f32 v145, v146, v147
    v_cvt_pk_bf16_f32 v146, v148, v149
    v_cvt_pk_bf16_f32 v147, v150, v151
    v_mfma_f32_16x16x32_bf16 v[172:175], v[40:43], v[208:211], v[172:175]
    ds_read_b128 v[28:31], v3 offset:6400
    v_cvt_pk_bf16_f32 v148, v152, v153
    v_mfma_f32_16x16x32_bf16 v[172:175], v[44:47], v[212:215], v[172:175]
    s_waitcnt lgkmcnt(4)
    v_cvt_pk_bf16_f32 v149, v154, v155
    buffer_store_dwordx4 v[144:147], v60, s[12:15], s33 offen offset:1152 sc0 sc1
    v_mfma_f32_16x16x32_bf16 v[104:107], v[240:243], a[248:251], v[104:107]
    ds_read_b128 v[32:35], v2 offset:12288
    v_mfma_f32_16x16x32_bf16 v[104:107], v[244:247], a[252:255], v[104:107]
    buffer_store_dwordx2 v[148:149], v61, s[12:15], s33 offen offset:1408 sc0 sc1
    v_accvgpr_read_b32 v224, a48
    v_accvgpr_read_b32 v225, a52
    v_accvgpr_read_b32 v226, a56
    v_mfma_f32_16x16x32_bf16 v[108:111], v[240:243], v[208:211], v[108:111]
    ds_read_b128 v[36:39], v3 offset:12288
    v_accvgpr_read_b32 v227, a60
    v_mfma_f32_16x16x32_bf16 v[108:111], v[244:247], v[212:215], v[108:111]
    s_waitcnt lgkmcnt(4)
    v_accvgpr_read_b32 v228, a64
    v_accvgpr_read_b32 v229, a68
    v_accvgpr_read_b32 v230, a72
    v_accvgpr_read_b32 v231, a76
    v_accvgpr_read_b32 v232, a80
    v_accvgpr_read_b32 v233, a84
    v_mfma_f32_16x16x32_bf16 v[168:171], v[248:251], v[192:195], v[168:171]
    ds_read_b128 v[40:43], v2 offset:18432
    v_accvgpr_read_b32 v234, a88
    v_mfma_f32_16x16x32_bf16 v[168:171], v[252:255], v[196:199], v[168:171]
    v_accvgpr_read_b32 v235, a92
    v_mul_f32 v224, v224, v52
    v_mul_f32 v225, v225, v52
    v_mul_f32 v226, v226, v52
    v_mul_f32 v227, v227, v52
    v_mul_f32 v228, v228, v52
    v_mfma_f32_16x16x32_bf16 v[172:175], v[248:251], v[216:219], v[172:175]
    ds_read_b128 v[44:47], v3 offset:18432
    v_mul_f32 v229, v229, v52
    v_mfma_f32_16x16x32_bf16 v[172:175], v[252:255], v[220:223], v[172:175]
    s_waitcnt lgkmcnt(4)
    v_mul_f32 v230, v230, v52
    v_mul_f32 v231, v231, v52
    v_mul_f32 v232, v232, v52
    v_mul_f32 v233, v233, v52
    v_mul_f32 v234, v234, v52
    v_mul_f32 v235, v235, v52
    v_mfma_f32_16x16x32_bf16 v[104:107], v[24:27], v[192:195], v[104:107]
    ds_read_b128 v[240:243], v2 offset:12416
    v_cvt_pk_bf16_f32 v224, v224, v225
    v_mfma_f32_16x16x32_bf16 v[104:107], v[28:31], v[196:199], v[104:107]
    v_cvt_pk_bf16_f32 v225, v226, v227
    v_cvt_pk_bf16_f32 v226, v228, v229
    v_cvt_pk_bf16_f32 v227, v230, v231
    v_cvt_pk_bf16_f32 v228, v232, v233
    v_cvt_pk_bf16_f32 v229, v234, v235
    v_mfma_f32_16x16x32_bf16 v[108:111], v[24:27], v[216:219], v[108:111]
    ds_read_b128 v[244:247], v3 offset:12416
    v_mfma_f32_16x16x32_bf16 v[108:111], v[28:31], v[220:223], v[108:111]
    s_waitcnt lgkmcnt(4)
    buffer_store_dwordx4 v[224:227], v60, s[12:15], s34 offen offset:0 sc0 sc1
    buffer_store_dwordx2 v[228:229], v61, s[12:15], s34 offen offset:256 sc0 sc1
    v_mfma_f32_16x16x32_bf16 v[184:187], v[32:35], a[240:243], v[136:139]
    ds_read_b128 v[248:251], v2 offset:18560
    v_accvgpr_read_b32 v144, a49
    v_mfma_f32_16x16x32_bf16 v[184:187], v[36:39], a[244:247], v[184:187]
    v_accvgpr_read_b32 v145, a53
    v_accvgpr_read_b32 v146, a57
    v_accvgpr_read_b32 v147, a61
    v_accvgpr_read_b32 v148, a65
    v_accvgpr_read_b32 v149, a69
    v_accvgpr_read_b32 v150, a73
    v_mfma_f32_16x16x32_bf16 v[188:191], v[32:35], v[200:203], v[140:143]
    ds_read_b128 v[252:255], v3 offset:18560
    v_accvgpr_read_b32 v151, a77
    v_mfma_f32_16x16x32_bf16 v[188:191], v[36:39], v[204:207], v[188:191]
    s_waitcnt lgkmcnt(4)
    v_accvgpr_read_b32 v152, a81
    v_accvgpr_read_b32 v153, a85
    v_accvgpr_read_b32 v154, a89
    v_accvgpr_read_b32 v155, a93
    v_mul_f32 v144, v144, v53
    v_mul_f32 v145, v145, v53
    v_mfma_f32_16x16x32_bf16 v[120:123], v[40:43], a[240:243], v[136:139]
    ds_read_b128 v[24:27], v2 offset:12544
    v_mul_f32 v146, v146, v53
    v_mfma_f32_16x16x32_bf16 v[120:123], v[44:47], a[244:247], v[120:123]
    v_exp_f32 v16, v168
    v_exp_f32 v17, v169
    v_exp_f32 v18, v170
    v_mfma_f32_16x16x32_bf16 v[124:127], v[40:43], v[200:203], v[140:143]
    ds_read_b128 v[28:31], v3 offset:12544
    v_add_f32 v6, v6, v16
    v_mfma_f32_16x16x32_bf16 v[124:127], v[44:47], v[204:207], v[124:127]
    s_waitcnt lgkmcnt(4)
    v_add_f32 v6, v6, v17
    v_exp_f32 v19, v171
    v_cvt_pk_bf16_f32 v168, v16, v17
    v_exp_f32 v16, v104
    v_mfma_f32_16x16x32_bf16 v[184:187], v[240:243], a[248:251], v[184:187]
    ds_read_b128 v[32:35], v2 offset:18688
    v_add_f32 v6, v6, v18
    v_mfma_f32_16x16x32_bf16 v[184:187], v[244:247], a[252:255], v[184:187]
    v_add_f32 v6, v6, v19
    v_exp_f32 v17, v105
    v_cvt_pk_bf16_f32 v169, v18, v19
    v_exp_f32 v18, v106
    v_mfma_f32_16x16x32_bf16 v[188:191], v[240:243], v[208:211], v[188:191]
    ds_read_b128 v[36:39], v3 offset:18688
    v_add_f32 v6, v6, v16
    v_mfma_f32_16x16x32_bf16 v[188:191], v[244:247], v[212:215], v[188:191]
    s_waitcnt lgkmcnt(4)
    v_add_f32 v6, v6, v17
    v_exp_f32 v19, v107
    v_cvt_pk_bf16_f32 v170, v16, v17
    v_exp_f32 v16, v172
    v_mfma_f32_16x16x32_bf16 v[120:123], v[248:251], a[248:251], v[120:123]
    ds_read_b128 v[40:43], v9 offset:0
    v_add_f32 v6, v6, v18
    v_mfma_f32_16x16x32_bf16 v[120:123], v[252:255], a[252:255], v[120:123]
    v_add_f32 v6, v6, v19
    v_exp_f32 v17, v173
    v_cvt_pk_bf16_f32 v171, v18, v19
    v_exp_f32 v18, v174
    v_mfma_f32_16x16x32_bf16 v[124:127], v[248:251], v[208:211], v[124:127]
    ds_read_b128 v[44:47], v9 offset:12288
    v_add_f32 v7, v7, v16
    v_mfma_f32_16x16x32_bf16 v[124:127], v[252:255], v[212:215], v[124:127]
    s_waitcnt lgkmcnt(4)
    v_add_f32 v7, v7, v17
    v_exp_f32 v19, v175
    v_cvt_pk_bf16_f32 v172, v16, v17
    v_exp_f32 v16, v108
    v_mfma_f32_16x16x32_bf16 v[184:187], v[24:27], v[192:195], v[184:187]
    ds_read_b128 v[240:243], v9 offset:768
    v_add_f32 v7, v7, v18
    v_mfma_f32_16x16x32_bf16 v[184:187], v[28:31], v[196:199], v[184:187]
    v_add_f32 v7, v7, v19
    v_exp_f32 v17, v109
    v_cvt_pk_bf16_f32 v173, v18, v19
    v_exp_f32 v18, v110
    v_mfma_f32_16x16x32_bf16 v[188:191], v[24:27], v[216:219], v[188:191]
    ds_read_b128 v[244:247], v9 offset:13056
    v_add_f32 v7, v7, v16
    v_mfma_f32_16x16x32_bf16 v[188:191], v[28:31], v[220:223], v[188:191]
    s_waitcnt lgkmcnt(4)
    v_add_f32 v7, v7, v17
    v_exp_f32 v19, v111
    v_cvt_pk_bf16_f32 v174, v16, v17
    v_add_f32 v7, v7, v18
    v_add_f32 v7, v7, v19
    v_mfma_f32_16x16x32_bf16 v[120:123], v[32:35], v[192:195], v[120:123]
    ds_read_b128 v[248:251], v9 offset:1536
    v_cvt_pk_bf16_f32 v175, v18, v19
    v_mfma_f32_16x16x32_bf16 v[120:123], v[36:39], v[196:199], v[120:123]
    v_mul_f32 v147, v147, v53
    v_mul_f32 v148, v148, v53
    v_mul_f32 v149, v149, v53
    v_mul_f32 v150, v150, v53
    v_mul_f32 v151, v151, v53
    v_mul_f32 v152, v152, v53
    v_mfma_f32_16x16x32_bf16 v[124:127], v[32:35], v[216:219], v[124:127]
    ds_read_b128 v[252:255], v9 offset:13824
    v_mul_f32 v153, v153, v53
    v_mfma_f32_16x16x32_bf16 v[124:127], v[36:39], v[220:223], v[124:127]
    s_waitcnt lgkmcnt(4)
    v_mul_f32 v154, v154, v53
    v_mul_f32 v155, v155, v53
    v_cvt_pk_bf16_f32 v144, v144, v145
    v_cvt_pk_bf16_f32 v145, v146, v147
    v_cvt_pk_bf16_f32 v146, v148, v149
    v_cvt_pk_bf16_f32 v147, v150, v151
    v_mfma_f32_16x16x32_bf16 a[96:99], v[72:75], v[40:43], a[96:99]
    ds_read_b128 v[24:27], v9 offset:2304
    v_cvt_pk_bf16_f32 v148, v152, v153
    v_mfma_f32_16x16x32_bf16 a[96:99], v[88:91], v[44:47], a[96:99]
    v_exp_f32 v16, v184
    v_exp_f32 v17, v185
    v_exp_f32 v18, v186
    v_mfma_f32_16x16x32_bf16 a[144:147], v[76:79], v[40:43], a[144:147]
    ds_read_b128 v[28:31], v9 offset:14592
    v_add_f32 v6, v6, v16
    v_mfma_f32_16x16x32_bf16 a[144:147], v[92:95], v[44:47], a[144:147]
    s_waitcnt lgkmcnt(4)
    v_add_f32 v6, v6, v17
    v_exp_f32 v19, v187
    v_cvt_pk_bf16_f32 v184, v16, v17
    v_exp_f32 v16, v120
    v_mfma_f32_16x16x32_bf16 a[100:103], v[72:75], v[240:243], a[100:103]
    ds_read_b128 v[32:35], v10 offset:0
    v_add_f32 v6, v6, v18
    v_mfma_f32_16x16x32_bf16 a[100:103], v[88:91], v[244:247], a[100:103]
    v_add_f32 v6, v6, v19
    v_exp_f32 v17, v121
    v_cvt_pk_bf16_f32 v185, v18, v19
    v_exp_f32 v18, v122
    v_mfma_f32_16x16x32_bf16 a[148:151], v[76:79], v[240:243], a[148:151]
    ds_read_b128 v[36:39], v10 offset:12288
    v_add_f32 v6, v6, v16
    v_mfma_f32_16x16x32_bf16 a[148:151], v[92:95], v[244:247], a[148:151]
    s_waitcnt lgkmcnt(4)
    v_add_f32 v6, v6, v17
    v_exp_f32 v19, v123
    v_cvt_pk_bf16_f32 v186, v16, v17
    v_exp_f32 v16, v188
    v_mfma_f32_16x16x32_bf16 a[104:107], v[72:75], v[248:251], a[104:107]
    ds_read_b128 v[40:43], v10 offset:768
    v_add_f32 v6, v6, v18
    v_mfma_f32_16x16x32_bf16 a[104:107], v[88:91], v[252:255], a[104:107]
    v_add_f32 v6, v6, v19
    v_exp_f32 v17, v189
    v_cvt_pk_bf16_f32 v187, v18, v19
    v_exp_f32 v18, v190
    v_mfma_f32_16x16x32_bf16 a[152:155], v[76:79], v[248:251], a[152:155]
    ds_read_b128 v[44:47], v10 offset:13056
    v_add_f32 v7, v7, v16
    v_mfma_f32_16x16x32_bf16 a[152:155], v[92:95], v[252:255], a[152:155]
    s_waitcnt lgkmcnt(4)
    v_add_f32 v7, v7, v17
    v_exp_f32 v19, v191
    v_cvt_pk_bf16_f32 v188, v16, v17
    v_exp_f32 v16, v124
    v_mfma_f32_16x16x32_bf16 a[108:111], v[72:75], v[24:27], a[108:111]
    ds_read_b128 v[240:243], v10 offset:1536
    v_add_f32 v7, v7, v18
    v_mfma_f32_16x16x32_bf16 a[108:111], v[88:91], v[28:31], a[108:111]
    v_add_f32 v7, v7, v19
    v_exp_f32 v17, v125
    v_cvt_pk_bf16_f32 v189, v18, v19
    v_exp_f32 v18, v126
    v_mfma_f32_16x16x32_bf16 a[156:159], v[76:79], v[24:27], a[156:159]
    ds_read_b128 v[244:247], v10 offset:13824
    v_add_f32 v7, v7, v16
    v_mfma_f32_16x16x32_bf16 a[156:159], v[92:95], v[28:31], a[156:159]
    s_waitcnt lgkmcnt(4)
    v_add_f32 v7, v7, v17
    v_exp_f32 v19, v127
    v_cvt_pk_bf16_f32 v190, v16, v17
    v_add_f32 v7, v7, v18
    v_add_f32 v7, v7, v19
    v_mfma_f32_16x16x32_bf16 a[112:115], v[72:75], v[32:35], a[112:115]
    ds_read_b128 v[248:251], v10 offset:2304
    v_cvt_pk_bf16_f32 v191, v18, v19
    v_mfma_f32_16x16x32_bf16 a[112:115], v[88:91], v[36:39], a[112:115]
    v_cvt_pk_bf16_f32 v149, v154, v155
    buffer_store_dwordx4 v[144:147], v60, s[12:15], s34 offen offset:384 sc0 sc1
    v_mfma_f32_16x16x32_bf16 a[160:163], v[76:79], v[32:35], a[160:163]
    ds_read_b128 v[252:255], v10 offset:14592
    v_mfma_f32_16x16x32_bf16 a[160:163], v[92:95], v[36:39], a[160:163]
    s_waitcnt lgkmcnt(4)
    buffer_store_dwordx2 v[148:149], v61, s[12:15], s34 offen offset:640 sc0 sc1
    v_accvgpr_read_b32 v224, a50
    v_accvgpr_read_b32 v225, a54
    v_accvgpr_read_b32 v226, a58
    v_mfma_f32_16x16x32_bf16 a[116:119], v[72:75], v[40:43], a[116:119]
    ds_read_b128 v[24:27], v11 offset:0
    v_accvgpr_read_b32 v227, a62
    v_mfma_f32_16x16x32_bf16 a[116:119], v[88:91], v[44:47], a[116:119]
    v_accvgpr_read_b32 v228, a66
    v_accvgpr_read_b32 v229, a70
    v_accvgpr_read_b32 v230, a74
    v_accvgpr_read_b32 v231, a78
    v_accvgpr_read_b32 v232, a82
    v_accvgpr_read_b32 v233, a86
    v_mfma_f32_16x16x32_bf16 a[164:167], v[76:79], v[40:43], a[164:167]
    ds_read_b128 v[28:31], v11 offset:12288
    v_accvgpr_read_b32 v234, a90
    v_mfma_f32_16x16x32_bf16 a[164:167], v[92:95], v[44:47], a[164:167]
    s_waitcnt lgkmcnt(4)
    v_accvgpr_read_b32 v235, a94
    v_mul_f32 v224, v224, v54
    v_mul_f32 v225, v225, v54
    v_mul_f32 v226, v226, v54
    v_mul_f32 v227, v227, v54
    v_mul_f32 v228, v228, v54
    v_mfma_f32_16x16x32_bf16 a[120:123], v[72:75], v[240:243], a[120:123]
    ds_read_b128 v[32:35], v11 offset:768
    v_mul_f32 v229, v229, v54
    v_mfma_f32_16x16x32_bf16 a[120:123], v[88:91], v[244:247], a[120:123]
    v_mul_f32 v230, v230, v54
    v_mul_f32 v231, v231, v54
    v_mul_f32 v232, v232, v54
    v_mul_f32 v233, v233, v54
    v_mul_f32 v234, v234, v54
    v_mul_f32 v235, v235, v54
    v_mfma_f32_16x16x32_bf16 a[168:171], v[76:79], v[240:243], a[168:171]
    ds_read_b128 v[36:39], v11 offset:13056
    v_cvt_pk_bf16_f32 v224, v224, v225
    v_mfma_f32_16x16x32_bf16 a[168:171], v[92:95], v[244:247], a[168:171]
    s_waitcnt lgkmcnt(4)
    v_cvt_pk_bf16_f32 v225, v226, v227
    v_cvt_pk_bf16_f32 v226, v228, v229
    v_cvt_pk_bf16_f32 v227, v230, v231
    v_cvt_pk_bf16_f32 v228, v232, v233
    v_cvt_pk_bf16_f32 v229, v234, v235
    v_mfma_f32_16x16x32_bf16 a[124:127], v[72:75], v[248:251], a[124:127]
    ds_read_b128 v[40:43], v11 offset:1536
    v_mfma_f32_16x16x32_bf16 a[124:127], v[88:91], v[252:255], a[124:127]
    buffer_store_dwordx4 v[224:227], v60, s[12:15], s34 offen offset:768 sc0 sc1
    buffer_store_dwordx2 v[228:229], v61, s[12:15], s34 offen offset:1024 sc0 sc1
    v_mfma_f32_16x16x32_bf16 a[172:175], v[76:79], v[248:251], a[172:175]
    ds_read_b128 v[44:47], v11 offset:13824
    v_accvgpr_read_b32 v144, a51
    v_mfma_f32_16x16x32_bf16 a[172:175], v[92:95], v[252:255], a[172:175]
    s_waitcnt lgkmcnt(4)
    v_accvgpr_read_b32 v145, a55
    v_accvgpr_read_b32 v146, a59
    v_accvgpr_read_b32 v147, a63
    v_accvgpr_read_b32 v148, a67
    v_accvgpr_read_b32 v149, a71
    v_accvgpr_read_b32 v150, a75
    v_mfma_f32_16x16x32_bf16 a[128:131], v[72:75], v[24:27], a[128:131]
    ds_read_b128 v[240:243], v11 offset:2304
    v_accvgpr_read_b32 v151, a79
    v_mfma_f32_16x16x32_bf16 a[128:131], v[88:91], v[28:31], a[128:131]
    v_accvgpr_read_b32 v152, a83
    v_accvgpr_read_b32 v153, a87
    v_accvgpr_read_b32 v154, a91
    v_accvgpr_read_b32 v155, a95
    v_mul_f32 v144, v144, v55
    v_mul_f32 v145, v145, v55
    v_mfma_f32_16x16x32_bf16 a[176:179], v[76:79], v[24:27], a[176:179]
    ds_read_b128 v[244:247], v11 offset:14592
    v_mul_f32 v146, v146, v55
    v_mfma_f32_16x16x32_bf16 a[176:179], v[92:95], v[28:31], a[176:179]
    s_waitcnt lgkmcnt(4)
    v_mul_f32 v147, v147, v55
    v_mul_f32 v148, v148, v55
    v_mul_f32 v149, v149, v55
    v_mul_f32 v150, v150, v55
    v_mul_f32 v151, v151, v55
    v_mul_f32 v152, v152, v55
    v_mfma_f32_16x16x32_bf16 a[132:135], v[72:75], v[32:35], a[132:135]
    ds_read_b128 v[248:251], v12 offset:0
    v_mul_f32 v153, v153, v55
    v_mfma_f32_16x16x32_bf16 a[132:135], v[88:91], v[36:39], a[132:135]
    v_mul_f32 v154, v154, v55
    v_mul_f32 v155, v155, v55
    v_cvt_pk_bf16_f32 v144, v144, v145
    v_cvt_pk_bf16_f32 v145, v146, v147
    v_cvt_pk_bf16_f32 v146, v148, v149
    v_cvt_pk_bf16_f32 v147, v150, v151
    v_mfma_f32_16x16x32_bf16 a[180:183], v[76:79], v[32:35], a[180:183]
    ds_read_b128 v[252:255], v12 offset:12288
    v_cvt_pk_bf16_f32 v148, v152, v153
    v_mfma_f32_16x16x32_bf16 a[180:183], v[92:95], v[36:39], a[180:183]
    s_waitcnt lgkmcnt(4)
    v_cvt_pk_bf16_f32 v149, v154, v155
    buffer_store_dwordx4 v[144:147], v60, s[12:15], s34 offen offset:1152 sc0 sc1
    v_mfma_f32_16x16x32_bf16 a[136:139], v[72:75], v[40:43], a[136:139]
    ds_read_b128 v[24:27], v12 offset:768
    v_mfma_f32_16x16x32_bf16 a[136:139], v[88:91], v[44:47], a[136:139]
    buffer_store_dwordx2 v[148:149], v61, s[12:15], s34 offen offset:1408 sc0 sc1
    v_mfma_f32_16x16x32_bf16 a[184:187], v[76:79], v[40:43], a[184:187]
    ds_read_b128 v[28:31], v12 offset:13056
    v_mfma_f32_16x16x32_bf16 a[184:187], v[92:95], v[44:47], a[184:187]
    s_waitcnt lgkmcnt(4)
    v_mfma_f32_16x16x32_bf16 a[140:143], v[72:75], v[240:243], a[140:143]
    ds_read_b128 v[32:35], v12 offset:1536
    v_mfma_f32_16x16x32_bf16 a[140:143], v[88:91], v[244:247], a[140:143]
    s_branch L_skip16
L_pad16:
    s_branch L_tb2_1
L_skip16:
    v_mfma_f32_16x16x32_bf16 a[188:191], v[76:79], v[240:243], a[188:191]
    ds_read_b128 v[36:39], v12 offset:13824
    v_mfma_f32_16x16x32_bf16 a[188:191], v[92:95], v[244:247], a[188:191]
    s_waitcnt lgkmcnt(4)
    s_nop 4
    v_cmp_nge_f32 vcc, s29, v6
    v_cmp_nge_f32_e64 s[56:57], s29, v7
    s_nop 0
    s_or_b64 vcc, vcc, s[56:57]
    v_mfma_f32_16x16x4_f32 v[56:59], v6, v63, 0
    v_mfma_f32_16x16x4_f32 v[128:131], v7, v63, 0
    s_cbranch_vccnz L_slow
    v_mfma_f32_16x16x32_bf16 a[96:99], v[168:171], v[248:251], a[96:99]
    ds_read_b128 v[40:43], v12 offset:2304
    ds_read_b128 v[44:47], v12 offset:14592
    v_mfma_f32_16x16x32_bf16 a[96:99], v[184:187], v[252:255], a[96:99]
    s_waitcnt lgkmcnt(4)
    s_nop 3
    v_rcp_f32 v56, v56
    v_rcp_f32 v57, v57
    v_mfma_f32_16x16x32_bf16 a[100:103], v[168:171], v[24:27], a[100:103]
    ds_read_b128 v[240:243], v13 offset:0
    ds_read_b128 v[244:247], v13 offset:12288
    v_mfma_f32_16x16x32_bf16 a[100:103], v[184:187], v[28:31], a[100:103]
    s_waitcnt lgkmcnt(4)
    v_rcp_f32 v58, v58
    v_rcp_f32 v59, v59
    v_rcp_f32 v128, v128
    v_rcp_f32 v129, v129
    v_rcp_f32 v130, v130
    v_rcp_f32 v131, v131
    v_mfma_f32_16x16x32_bf16 a[104:107], v[168:171], v[32:35], a[104:107]
    ds_read_b128 v[248:251], v13 offset:768
    ds_read_b128 v[252:255], v13 offset:13056
    v_mfma_f32_16x16x32_bf16 a[104:107], v[184:187], v[36:39], a[104:107]
    s_waitcnt lgkmcnt(4)
    v_mfma_f32_16x16x32_bf16 a[108:111], v[168:171], v[40:43], a[108:111]
    ds_read_b128 v[24:27], v13 offset:1536
    ds_read_b128 v[28:31], v13 offset:13824
    v_mfma_f32_16x16x32_bf16 a[108:111], v[184:187], v[44:47], a[108:111]
    s_waitcnt lgkmcnt(4)
    v_mfma_f32_16x16x32_bf16 a[112:115], v[168:171], v[240:243], a[112:115]
    ds_read_b128 v[32:35], v13 offset:2304
    ds_read_b128 v[36:39], v13 offset:14592
    v_mfma_f32_16x16x32_bf16 a[112:115], v[184:187], v[244:247], a[112:115]
    s_waitcnt lgkmcnt(4)
    v_mfma_f32_16x16x32_bf16 a[116:119], v[168:171], v[248:251], a[116:119]
    ds_read_b128 v[40:43], v0 offset:0
    ds_read_b128 v[44:47], v0 offset:12288
    v_mfma_f32_16x16x32_bf16 a[116:119], v[184:187], v[252:255], a[116:119]
    s_waitcnt lgkmcnt(4)
    v_mfma_f32_16x16x32_bf16 a[120:123], v[168:171], v[24:27], a[120:123]
    ds_read_b128 v[240:243], v0 offset:768
    ds_read_b128 v[244:247], v0 offset:13056
    v_mfma_f32_16x16x32_bf16 a[120:123], v[184:187], v[28:31], a[120:123]
    s_waitcnt lgkmcnt(4)
    v_mfma_f32_16x16x32_bf16 a[124:127], v[168:171], v[32:35], a[124:127]
    ds_read_b128 v[248:251], v0 offset:1536
    ds_read_b128 v[252:255], v0 offset:13824
    v_mfma_f32_16x16x32_bf16 a[124:127], v[184:187], v[36:39], a[124:127]
    s_waitcnt lgkmcnt(4)
    v_mfma_f32_16x16x32_bf16 a[128:131], v[168:171], v[40:43], a[128:131]
    ds_read_b128 v[24:27], v0 offset:2304
    ds_read_b128 v[28:31], v0 offset:14592
    v_mfma_f32_16x16x32_bf16 a[128:131], v[184:187], v[44:47], a[128:131]
    s_waitcnt lgkmcnt(4)
    v_mfma_f32_16x16x32_bf16 a[132:135], v[168:171], v[240:243], a[132:135]
    ds_read_b128 v[32:35], v12 offset:0
    ds_read_b128 v[36:39], v12 offset:12288
    v_mfma_f32_16x16x32_bf16 a[132:135], v[184:187], v[244:247], a[132:135]
    s_waitcnt lgkmcnt(4)
    v_mfma_f32_16x16x32_bf16 a[136:139], v[168:171], v[248:251], a[136:139]
    ds_read_b128 v[40:43], v12 offset:768
    ds_read_b128 v[44:47], v12 offset:13056
    v_mfma_f32_16x16x32_bf16 a[136:139], v[184:187], v[252:255], a[136:139]
    s_waitcnt lgkmcnt(4)
    v_mfma_f32_16x16x32_bf16 a[140:143], v[168:171], v[24:27], a[140:143]
    ds_read_b128 v[240:243], v12 offset:1536
    ds_read_b128 v[244:247], v12 offset:13824
    v_mfma_f32_16x16x32_bf16 a[140:143], v[184:187], v[28:31], a[140:143]
    s_waitcnt lgkmcnt(4)
    v_mfma_f32_16x16x32_bf16 a[144:147], v[172:175], v[32:35], a[144:147]
    ds_read_b128 v[248:251], v12 offset:2304
    ds_read_b128 v[252:255], v12 offset:14592
    v_mfma_f32_16x16x32_bf16 a[144:147], v[188:191], v[36:39], a[144:147]
    s_waitcnt lgkmcnt(4)
    s_nop 3
    v_accvgpr_read_b32 v224, a96
    v_accvgpr_read_b32 v225, a100
    v_mfma_f32_16x16x32_bf16 a[148:151], v[172:175], v[40:43], a[148:151]
    ds_read_b128 v[24:27], v13 offset:0
    ds_read_b128 v[28:31], v13 offset:12288
    v_mfma_f32_16x16x32_bf16 a[148:151], v[188:191], v[44:47], a[148:151]
    s_waitcnt lgkmcnt(4)
    v_accvgpr_read_b32 v226, a104
    v_accvgpr_read_b32 v227, a108
    v_accvgpr_read_b32 v228, a112
    v_accvgpr_read_b32 v229, a116
    v_accvgpr_read_b32 v230, a120
    v_accvgpr_read_b32 v231, a124
    v_mfma_f32_16x16x32_bf16 a[152:155], v[172:175], v[240:243], a[152:155]
    ds_read_b128 v[32:35], v13 offset:768
    ds_read_b128 v[36:39], v13 offset:13056
    v_mfma_f32_16x16x32_bf16 a[152:155], v[188:191], v[244:247], a[152:155]
    s_waitcnt lgkmcnt(4)
    v_accvgpr_read_b32 v232, a128
    v_accvgpr_read_b32 v233, a132
    v_accvgpr_read_b32 v234, a136
    v_accvgpr_read_b32 v235, a140
    v_mul_f32 v224, v224, v56
    v_mul_f32 v225, v225, v56
    v_mfma_f32_16x16x32_bf16 a[156:159], v[172:175], v[248:251], a[156:159]
    ds_read_b128 v[40:43], v13 offset:1536
    ds_read_b128 v[44:47], v13 offset:13824
    v_mfma_f32_16x16x32_bf16 a[156:159], v[188:191], v[252:255], a[156:159]
    s_waitcnt lgkmcnt(4)
    v_mul_f32 v226, v226, v56
    v_mul_f32 v227, v227, v56
    v_mul_f32 v228, v228, v56
    v_mul_f32 v229, v229, v56
    v_mul_f32 v230, v230, v56
    v_mul_f32 v231, v231, v56
    v_mfma_f32_16x16x32_bf16 a[160:163], v[172:175], v[24:27], a[160:163]
    ds_read_b128 v[240:243], v13 offset:2304
    ds_read_b128 v[244:247], v13 offset:14592
    v_mfma_f32_16x16x32_bf16 a[160:163], v[188:191], v[28:31], a[160:163]
    s_waitcnt lgkmcnt(4)
    v_mul_f32 v232, v232, v56
    v_mul_f32 v233, v233, v56
    v_mul_f32 v234, v234, v56
    v_mul_f32 v235, v235, v56
    v_cvt_pk_bf16_f32 v224, v224, v225
    v_cvt_pk_bf16_f32 v225, v226, v227
    v_mfma_f32_16x16x32_bf16 a[164:167], v[172:175], v[32:35], a[164:167]
    ds_read_b128 v[248:251], v0 offset:0
    ds_read_b128 v[252:255], v0 offset:12288
    v_mfma_f32_16x16x32_bf16 a[164:167], v[188:191], v[36:39], a[164:167]
    s_waitcnt lgkmcnt(4)
    v_cvt_pk_bf16_f32 v226, v228, v229
    v_cvt_pk_bf16_f32 v227, v230, v231
    v_cvt_pk_bf16_f32 v228, v232, v233
    v_cvt_pk_bf16_f32 v229, v234, v235
    v_mfma_f32_16x16x32_bf16 a[168:171], v[172:175], v[40:43], a[168:171]
    ds_read_b128 v[24:27], v0 offset:768
    ds_read_b128 v[28:31], v0 offset:13056
    v_mfma_f32_16x16x32_bf16 a[168:171], v[188:191], v[44:47], a[168:171]
    s_waitcnt lgkmcnt(4)
    buffer_store_dwordx4 v[224:227], v60, s[12:15], s35 offen offset:0 sc0 sc1
    buffer_store_dwordx2 v[228:229], v61, s[12:15], s35 offen offset:256 sc0 sc1
    v_mfma_f32_16x16x32_bf16 a[172:175], v[172:175], v[240:243], a[172:175]
    ds_read_b128 v[32:35], v0 offset:1536
    ds_read_b128 v[36:39], v0 offset:13824
    v_mfma_f32_16x16x32_bf16 a[172:175], v[188:191], v[244:247], a[172:175]
    s_waitcnt lgkmcnt(4)
    v_accvgpr_read_b32 v144, a97
    v_accvgpr_read_b32 v145, a101
    v_accvgpr_read_b32 v146, a105
    v_accvgpr_read_b32 v147, a109
    v_accvgpr_read_b32 v148, a113
    v_accvgpr_read_b32 v149, a117
    v_mfma_f32_16x16x32_bf16 a[176:179], v[172:175], v[248:251], a[176:179]
    ds_read_b128 v[40:43], v0 offset:2304
    ds_read_b128 v[44:47], v0 offset:14592
    v_mfma_f32_16x16x32_bf16 a[176:179], v[188:191], v[252:255], a[176:179]
    s_waitcnt lgkmcnt(4)
    v_accvgpr_read_b32 v150, a121
    v_accvgpr_read_b32 v151, a125
    v_accvgpr_read_b32 v152, a129
    v_accvgpr_read_b32 v153, a133
    v_accvgpr_read_b32 v154, a137
    v_accvgpr_read_b32 v155, a141
    v_mfma_f32_16x16x32_bf16 a[180:183], v[172:175], v[24:27], a[180:183]
    v_mul_f32 v144, v144, v57
    v_mul_f32 v145, v145, v57
    v_mfma_f32_16x16x32_bf16 a[180:183], v[188:191], v[28:31], a[180:183]
    s_waitcnt lgkmcnt(2)
    v_mul_f32 v146, v146, v57
    v_mul_f32 v147, v147, v57
    v_mul_f32 v148, v148, v57
    v_mul_f32 v149, v149, v57
    v_mul_f32 v150, v150, v57
    v_mul_f32 v151, v151, v57
    v_mfma_f32_16x16x32_bf16 a[184:187], v[172:175], v[32:35], a[184:187]
    v_mul_f32 v152, v152, v57
    v_mul_f32 v153, v153, v57
    v_mfma_f32_16x16x32_bf16 a[184:187], v[188:191], v[36:39], a[184:187]
    s_waitcnt lgkmcnt(0)
    v_mul_f32 v154, v154, v57
    v_mul_f32 v155, v155, v57
    v_cvt_pk_bf16_f32 v144, v144, v145
    v_cvt_pk_bf16_f32 v145, v146, v147
    v_cvt_pk_bf16_f32 v146, v148, v149
    v_cvt_pk_bf16_f32 v147, v150, v151
    v_mfma_f32_16x16x32_bf16 a[188:191], v[172:175], v[40:43], a[188:191]
    v_cvt_pk_bf16_f32 v148, v152, v153
    v_cvt_pk_bf16_f32 v149, v154, v155
    v_mfma_f32_16x16x32_bf16 a[188:191], v[188:191], v[44:47], a[188:191]
    buffer_store_dwordx4 v[144:147], v60, s[12:15], s35 offen offset:384 sc0 sc1
    buffer_store_dwordx2 v[148:149], v61, s[12:15], s35 offen offset:640 sc0 sc1
    v_accvgpr_read_b32 v224, a98
    v_accvgpr_read_b32 v225, a102
    v_accvgpr_read_b32 v226, a106
    v_accvgpr_read_b32 v227, a110
    v_accvgpr_read_b32 v228, a114
    v_accvgpr_read_b32 v229, a118
    v_accvgpr_read_b32 v230, a122
    v_accvgpr_read_b32 v231, a126
    v_accvgpr_read_b32 v232, a130
    v_accvgpr_read_b32 v233, a134
    v_accvgpr_read_b32 v234, a138
    v_accvgpr_read_b32 v235, a142
    v_mul_f32 v224, v224, v58
    v_mul_f32 v225, v225, v58
    v_mul_f32 v226, v226, v58
    v_mul_f32 v227, v227, v58
    v_mul_f32 v228, v228, v58
    v_mul_f32 v229, v229, v58
    v_mul_f32 v230, v230, v58
    v_mul_f32 v231, v231, v58
    v_mul_f32 v232, v232, v58
    v_mul_f32 v233, v233, v58
    v_mul_f32 v234, v234, v58
    v_mul_f32 v235, v235, v58
    v_cvt_pk_bf16_f32 v224, v224, v225
    v_cvt_pk_bf16_f32 v225, v226, v227
    v_cvt_pk_bf16_f32 v226, v228, v229
    v_cvt_pk_bf16_f32 v227, v230, v231
    v_cvt_pk_bf16_f32 v228, v232, v233
    v_cvt_pk_bf16_f32 v229, v234, v235
    buffer_store_dwordx4 v[224:227], v60, s[12:15], s35 offen offset:768 sc0 sc1
    buffer_store_dwordx2 v[228:229], v61, s[12:15], s35 offen offset:1024 sc0 sc1
    v_accvgpr_read_b32 v144, a99
    v_accvgpr_read_b32 v145, a103
    v_accvgpr_read_b32 v146, a107
    v_accvgpr_read_b32 v147, a111
    v_accvgpr_read_b32 v148, a115
    v_accvgpr_read_b32 v149, a119
    v_accvgpr_read_b32 v150, a123
    v_accvgpr_read_b32 v151, a127
    v_accvgpr_read_b32 v152, a131
    v_accvgpr_read_b32 v153, a135
    v_accvgpr_read_b32 v154, a139
    v_accvgpr_read_b32 v155, a143
    v_mul_f32 v144, v144, v59
    v_mul_f32 v145, v145, v59
    v_mul_f32 v146, v146, v59
    v_mul_f32 v147, v147, v59
    v_mul_f32 v148, v148, v59
    v_mul_f32 v149, v149, v59
    v_mul_f32 v150, v150, v59
    v_mul_f32 v151, v151, v59
    v_mul_f32 v152, v152, v59
    v_mul_f32 v153, v153, v59
    v_mul_f32 v154, v154, v59
    v_mul_f32 v155, v155, v59
    v_cvt_pk_bf16_f32 v144, v144, v145
    v_cvt_pk_bf16_f32 v145, v146, v147
    v_cvt_pk_bf16_f32 v146, v148, v149
    v_cvt_pk_bf16_f32 v147, v150, v151
    v_cvt_pk_bf16_f32 v148, v152, v153
    v_cvt_pk_bf16_f32 v149, v154, v155
    buffer_store_dwordx4 v[144:147], v60, s[12:15], s35 offen offset:1152 sc0 sc1
    buffer_store_dwordx2 v[148:149], v61, s[12:15], s35 offen offset:1408 sc0 sc1
    s_nop 4
    v_accvgpr_read_b32 v88, a144
    v_accvgpr_read_b32 v89, a148
    v_accvgpr_read_b32 v90, a152
    v_accvgpr_read_b32 v91, a156
    v_accvgpr_read_b32 v92, a160
    v_accvgpr_read_b32 v93, a164
    v_accvgpr_read_b32 v94, a168
    v_accvgpr_read_b32 v95, a172
    v_accvgpr_read_b32 v96, a176
    v_accvgpr_read_b32 v97, a180
    v_accvgpr_read_b32 v98, a184
    v_accvgpr_read_b32 v99, a188
    v_pk_mul_f32 v[88:89], v[88:89], v[128:129] op_sel:[0,0] op_sel_hi:[1,0]
    v_pk_mul_f32 v[90:91], v[90:91], v[128:129] op_sel:[0,0] op_sel_hi:[1,0]
    v_pk_mul_f32 v[92:93], v[92:93], v[128:129] op_sel:[0,0] op_sel_hi:[1,0]
    v_pk_mul_f32 v[94:95], v[94:95], v[128:129] op_sel:[0,0] op_sel_hi:[1,0]
    v_pk_mul_f32 v[96:97], v[96:97], v[128:129] op_sel:[0,0] op_sel_hi:[1,0]
    v_pk_mul_f32 v[98:99], v[98:99], v[128:129] op_sel:[0,0] op_sel_hi:[1,0]
    v_cvt_pk_bf16_f32 v88, v88, v89
    v_cvt_pk_bf16_f32 v89, v90, v91
    v_cvt_pk_bf16_f32 v90, v92, v93
    v_cvt_pk_bf16_f32 v91, v94, v95
    v_cvt_pk_bf16_f32 v92, v96, v97
    v_cvt_pk_bf16_f32 v93, v98, v99
    buffer_store_dwordx4 v[88:91], v60, s[12:15], s36 offen offset:0 sc0 sc1
    buffer_store_dwordx2 v[92:93], v61, s[12:15], s36 offen offset:256 sc0 sc1
    v_accvgpr_read_b32 v100, a145
    v_accvgpr_read_b32 v101, a149
    v_accvgpr_read_b32 v102, a153
    v_accvgpr_read_b32 v103, a157
    v_accvgpr_read_b32 v104, a161
    v_accvgpr_read_b32 v105, a165
    v_accvgpr_read_b32 v106, a169
    v_accvgpr_read_b32 v107, a173
    v_accvgpr_read_b32 v108, a177
    v_accvgpr_read_b32 v109, a181
    v_accvgpr_read_b32 v110, a185
    v_accvgpr_read_b32 v111, a189
    v_pk_mul_f32 v[100:101], v[100:101], v[128:129] op_sel:[0,1] op_sel_hi:[1,1]
    v_pk_mul_f32 v[102:103], v[102:103], v[128:129] op_sel:[0,1] op_sel_hi:[1,1]
    v_pk_mul_f32 v[104:105], v[104:105], v[128:129] op_sel:[0,1] op_sel_hi:[1,1]
    v_pk_mul_f32 v[106:107], v[106:107], v[128:129] op_sel:[0,1] op_sel_hi:[1,1]
    v_pk_mul_f32 v[108:109], v[108:109], v[128:129] op_sel:[0,1] op_sel_hi:[1,1]
    v_pk_mul_f32 v[110:111], v[110:111], v[128:129] op_sel:[0,1] op_sel_hi:[1,1]
    v_cvt_pk_bf16_f32 v100, v100, v101
    v_cvt_pk_bf16_f32 v101, v102, v103
    v_cvt_pk_bf16_f32 v102, v104, v105
    v_cvt_pk_bf16_f32 v103, v106, v107
    v_cvt_pk_bf16_f32 v104, v108, v109
    v_cvt_pk_bf16_f32 v105, v110, v111
    buffer_store_dwordx4 v[100:103], v60, s[12:15], s36 offen offset:384 sc0 sc1
    buffer_store_dwordx2 v[104:105], v61, s[12:15], s36 offen offset:640 sc0 sc1
    v_accvgpr_read_b32 v112, a146
    v_accvgpr_read_b32 v113, a150
    v_accvgpr_read_b32 v114, a154
    v_accvgpr_read_b32 v115, a158
    v_accvgpr_read_b32 v116, a162
    v_accvgpr_read_b32 v117, a166
    v_accvgpr_read_b32 v118, a170
    v_accvgpr_read_b32 v119, a174
    v_accvgpr_read_b32 v120, a178
    v_accvgpr_read_b32 v121, a182
    v_accvgpr_read_b32 v122, a186
    v_accvgpr_read_b32 v123, a190
    v_pk_mul_f32 v[112:113], v[112:113], v[130:131] op_sel:[0,0] op_sel_hi:[1,0]
    v_pk_mul_f32 v[114:115], v[114:115], v[130:131] op_sel:[0,0] op_sel_hi:[1,0]
    v_pk_mul_f32 v[116:117], v[116:117], v[130:131] op_sel:[0,0] op_sel_hi:[1,0]
    v_pk_mul_f32 v[118:119], v[118:119], v[130:131] op_sel:[0,0] op_sel_hi:[1,0]
    v_pk_mul_f32 v[120:121], v[120:121], v[130:131] op_sel:[0,0] op_sel_hi:[1,0]
    v_pk_mul_f32 v[122:123], v[122:123], v[130:131] op_sel:[0,0] op_sel_hi:[1,0]
    v_cvt_pk_bf16_f32 v112, v112, v113
    v_cvt_pk_bf16_f32 v113, v114, v115
    v_cvt_pk_bf16_f32 v114, v116, v117
    v_cvt_pk_bf16_f32 v115, v118, v119
    v_cvt_pk_bf16_f32 v116, v120, v121
    v_cvt_pk_bf16_f32 v117, v122, v123
    buffer_store_dwordx4 v[112:115], v60, s[12:15], s36 offen offset:768 sc0 sc1
    buffer_store_dwordx2 v[116:117], v61, s[12:15], s36 offen offset:1024 sc0 sc1
    v_accvgpr_read_b32 v64, a147
    v_accvgpr_read_b32 v65, a151
    v_accvgpr_read_b32 v66, a155
    v_accvgpr_read_b32 v67, a159
    v_accvgpr_read_b32 v68, a163
    v_accvgpr_read_b32 v69, a167
    v_accvgpr_read_b32 v70, a171
    v_accvgpr_read_b32 v71, a175
    v_accvgpr_read_b32 v72, a179
    v_accvgpr_read_b32 v73, a183
    v_accvgpr_read_b32 v74, a187
    v_accvgpr_read_b32 v75, a191
    v_pk_mul_f32 v[64:65], v[64:65], v[130:131] op_sel:[0,1] op_sel_hi:[1,1]
    v_pk_mul_f32 v[66:67], v[66:67], v[130:131] op_sel:[0,1] op_sel_hi:[1,1]
    v_pk_mul_f32 v[68:69], v[68:69], v[130:131] op_sel:[0,1] op_sel_hi:[1,1]
    v_pk_mul_f32 v[70:71], v[70:71], v[130:131] op_sel:[0,1] op_sel_hi:[1,1]
    v_pk_mul_f32 v[72:73], v[72:73], v[130:131] op_sel:[0,1] op_sel_hi:[1,1]
    v_pk_mul_f32 v[74:75], v[74:75], v[130:131] op_sel:[0,1] op_sel_hi:[1,1]
    v_cvt_pk_bf16_f32 v64, v64, v65
    v_cvt_pk_bf16_f32 v65, v66, v67
    v_cvt_pk_bf16_f32 v66, v68, v69
    v_cvt_pk_bf16_f32 v67, v70, v71
    v_cvt_pk_bf16_f32 v68, v72, v73
    v_cvt_pk_bf16_f32 v69, v74, v75
    buffer_store_dwordx4 v[64:67], v60, s[12:15], s36 offen offset:1152 sc0 sc1
    buffer_store_dwordx2 v[68:69], v61, s[12:15], s36 offen offset:1408 sc0 sc1
L_fin:
L_done:
    s_endpgm
L_pollslow0:
    s_mov_b32 s59, 200
L_pollsm0:
    s_buffer_load_dwordx8 s[48:55], s[20:23], 0 glc
    s_waitcnt lgkmcnt(0)
    s_sub_u32 s48, s48, s92
    s_sub_u32 s49, s49, s92
    s_sub_u32 s50, s50, s92
    s_sub_u32 s51, s51, s92
    s_sub_u32 s52, s52, s92
    s_sub_u32 s53, s53, s92
    s_sub_u32 s54, s54, s92
    s_sub_u32 s55, s55, s92
    s_max_u32 s48, s48, s49
    s_max_u32 s48, s48, s50
    s_max_u32 s48, s48, s51
    s_max_u32 s48, s48, s52
    s_max_u32 s48, s48, s53
    s_max_u32 s48, s48, s54
    s_max_u32 s48, s48, s55
    s_cmp_lt_u32 s48, 16
    s_cbranch_scc1 L_pollok0
    s_sub_u32 s59, s59, 1
    s_cbranch_scc1 L_pollvec0
    s_sleep 1
    s_branch L_pollsm0
L_pollvec0:
    s_sub_u32 s96, s96, 1
    s_cbranch_scc1 L_pollgiveup0
    s_sleep 2
    buffer_load_dword v52, v53, s[20:23], 0 offen sc1
    s_waitcnt vmcnt(0)
    v_subrev_u32 v52, s92, v52
    v_cmp_lt_u32 vcc, 15, v52
    s_nop 0
    s_and_b32 s59, vcc_lo, 0xff
    s_cbranch_scc1 L_pollvec0
    s_branch L_pollok0
L_pollgiveup0:
    s_mov_b32 s96, 0
    s_branch L_pollok0
L_pollslow1:
    s_mov_b32 s59, 200
L_pollsm1:
    s_buffer_load_dwordx8 s[48:55], s[20:23], 0 glc
    s_waitcnt lgkmcnt(0)
    s_sub_u32 s48, s48, s92
    s_sub_u32 s49, s49, s92
    s_sub_u32 s50, s50, s92
    s_sub_u32 s51, s51, s92
    s_sub_u32 s52, s52, s92
    s_sub_u32 s53, s53, s92
    s_sub_u32 s54, s54, s92
    s_sub_u32 s55, s55, s92
    s_max_u32 s48, s48, s49
    s_max_u32 s48, s48, s50
    s_max_u32 s48, s48, s51
    s_max_u32 s48, s48, s52
    s_max_u32 s48, s48, s53
    s_max_u32 s48, s48, s54
    s_max_u32 s48, s48, s55
    s_cmp_lt_u32 s48, 16
    s_cbranch_scc1 L_pollok1
    s_sub_u32 s59, s59, 1
    s_cbranch_scc1 L_pollvec1
    s_sleep 1
    s_branch L_pollsm1
L_pollvec1:
    s_sub_u32 s96, s96, 1
    s_cbranch_scc1 L_pollgiveup1
    s_sleep 2
    buffer_load_dword v52, v53, s[20:23], 0 offen sc1
    s_waitcnt vmcnt(0)
    v_subrev_u32 v52, s92, v52
    v_cmp_lt_u32 vcc, 15, v52
    s_nop 0
    s_and_b32 s59, vcc_lo, 0xff
    s_cbranch_scc1 L_pollvec1
    s_branch L_pollok1
L_pollgiveup1:
    s_mov_b32 s96, 0
    s_branch L_pollok1
L_pollslow2:
    s_mov_b32 s59, 200
L_pollsm2:
    s_buffer_load_dwordx8 s[48:55], s[20:23], 0 glc
    s_waitcnt lgkmcnt(0)
    s_sub_u32 s48, s48, s92
    s_sub_u32 s49, s49, s92
    s_sub_u32 s50, s50, s92
    s_sub_u32 s51, s51, s92
    s_sub_u32 s52, s52, s92
    s_sub_u32 s53, s53, s92
    s_sub_u32 s54, s54, s92
    s_sub_u32 s55, s55, s92
    s_max_u32 s48, s48, s49
    s_max_u32 s48, s48, s50
    s_max_u32 s48, s48, s51
    s_max_u32 s48, s48, s52
    s_max_u32 s48, s48, s53
    s_max_u32 s48, s48, s54
    s_max_u32 s48, s48, s55
    s_cmp_lt_u32 s48, 16
    s_cbranch_scc1 L_pollok2
    s_sub_u32 s59, s59, 1
    s_cbranch_scc1 L_pollvec2
    s_sleep 1
    s_branch L_pollsm2
L_pollvec2:
    s_sub_u32 s96, s96, 1
    s_cbranch_scc1 L_pollgiveup2
    s_sleep 2
    buffer_load_dword v52, v53, s[20:23], 0 offen sc1
    s_waitcnt vmcnt(0)
    v_subrev_u32 v52, s92, v52
    v_cmp_lt_u32 vcc, 15, v52
    s_nop 0
    s_and_b32 s59, vcc_lo, 0xff
    s_cbranch_scc1 L_pollvec2
    s_branch L_pollok2
L_pollgiveup2:
    s_mov_b32 s96, 0
    s_branch L_pollok2
L_pollslow3:
    s_mov_b32 s59, 200
L_pollsm3:
    s_buffer_load_dwordx8 s[48:55], s[20:23], 0 glc
    s_waitcnt lgkmcnt(0)
    s_sub_u32 s48, s48, s92
    s_sub_u32 s49, s49, s92
    s_sub_u32 s50, s50, s92
    s_sub_u32 s51, s51, s92
    s_sub_u32 s52, s52, s92
    s_sub_u32 s53, s53, s92
    s_sub_u32 s54, s54, s92
    s_sub_u32 s55, s55, s92
    s_max_u32 s48, s48, s49
    s_max_u32 s48, s48, s50
    s_max_u32 s48, s48, s51
    s_max_u32 s48, s48, s52
    s_max_u32 s48, s48, s53
    s_max_u32 s48, s48, s54
    s_max_u32 s48, s48, s55
    s_cmp_lt_u32 s48, 16
    s_cbranch_scc1 L_pollok3
    s_sub_u32 s59, s59, 1
    s_cbranch_scc1 L_pollvec3
    s_sleep 1
    s_branch L_pollsm3
L_pollvec3:
    s_sub_u32 s96, s96, 1
    s_cbranch_scc1 L_pollgiveup3
    s_sleep 2
    buffer_load_dword v52, v53, s[20:23], 0 offen sc1
    s_waitcnt vmcnt(0)
    v_subrev_u32 v52, s92, v52
    v_cmp_lt_u32 vcc, 15, v52
    s_nop 0
    s_and_b32 s59, vcc_lo, 0xff
    s_cbranch_scc1 L_pollvec3
    s_branch L_pollok3
L_pollgiveup3:
    s_mov_b32 s96, 0
    s_branch L_pollok3
L_pollslow4:
    s_mov_b32 s59, 200
L_pollsm4:
    s_buffer_load_dwordx8 s[48:55], s[20:23], 0 glc
    s_waitcnt lgkmcnt(0)
    s_sub_u32 s48, s48, s92
    s_sub_u32 s49, s49, s92
    s_sub_u32 s50, s50, s92
    s_sub_u32 s51, s51, s92
    s_sub_u32 s52, s52, s92
    s_sub_u32 s53, s53, s92
    s_sub_u32 s54, s54, s92
    s_sub_u32 s55, s55, s92
    s_max_u32 s48, s48, s49
    s_max_u32 s48, s48, s50
    s_max_u32 s48, s48, s51
    s_max_u32 s48, s48, s52
    s_max_u32 s48, s48, s53
    s_max_u32 s48, s48, s54
    s_max_u32 s48, s48, s55
    s_cmp_lt_u32 s48, 16
    s_cbranch_scc1 L_pollok4
    s_sub_u32 s59, s59, 1
    s_cbranch_scc1 L_pollvec4
    s_sleep 1
    s_branch L_pollsm4
L_pollvec4:
    s_sub_u32 s96, s96, 1
    s_cbranch_scc1 L_pollgiveup4
    s_sleep 2
    buffer_load_dword v52, v53, s[20:23], 0 offen sc1
    s_waitcnt vmcnt(0)
    v_subrev_u32 v52, s92, v52
    v_cmp_lt_u32 vcc, 15, v52
    s_nop 0
    s_and_b32 s59, vcc_lo, 0xff
    s_cbranch_scc1 L_pollvec4
    s_branch L_pollok4
L_pollgiveup4:
    s_mov_b32 s96, 0
    s_branch L_pollok4
L_pollslow5:
    s_mov_b32 s59, 200
L_pollsm5:
    s_buffer_load_dwordx8 s[48:55], s[20:23], 0 glc
    s_waitcnt lgkmcnt(0)
    s_sub_u32 s48, s48, s92
    s_sub_u32 s49, s49, s92
    s_sub_u32 s50, s50, s92
    s_sub_u32 s51, s51, s92
    s_sub_u32 s52, s52, s92
    s_sub_u32 s53, s53, s92
    s_sub_u32 s54, s54, s92
    s_sub_u32 s55, s55, s92
    s_max_u32 s48, s48, s49
    s_max_u32 s48, s48, s50
    s_max_u32 s48, s48, s51
    s_max_u32 s48, s48, s52
    s_max_u32 s48, s48, s53
    s_max_u32 s48, s48, s54
    s_max_u32 s48, s48, s55
    s_cmp_lt_u32 s48, 16
    s_cbranch_scc1 L_pollok5
    s_sub_u32 s59, s59, 1
    s_cbranch_scc1 L_pollvec5
    s_sleep 1
    s_branch L_pollsm5
L_pollvec5:
    s_sub_u32 s96, s96, 1
    s_cbranch_scc1 L_pollgiveup5
    s_sleep 2
    buffer_load_dword v52, v53, s[20:23], 0 offen sc1
    s_waitcnt vmcnt(0)
    v_subrev_u32 v52, s92, v52
    v_cmp_lt_u32 vcc, 15, v52
    s_nop 0
    s_and_b32 s59, vcc_lo, 0xff
    s_cbranch_scc1 L_pollvec5
    s_branch L_pollok5
L_pollgiveup5:
    s_mov_b32 s96, 0
    s_branch L_pollok5
L_pollslow6:
    s_mov_b32 s59, 200
L_pollsm6:
    s_buffer_load_dwordx8 s[48:55], s[20:23], 0 glc
    s_waitcnt lgkmcnt(0)
    s_sub_u32 s48, s48, s92
    s_sub_u32 s49, s49, s92
    s_sub_u32 s50, s50, s92
    s_sub_u32 s51, s51, s92
    s_sub_u32 s52, s52, s92
    s_sub_u32 s53, s53, s92
    s_sub_u32 s54, s54, s92
    s_sub_u32 s55, s55, s92
    s_max_u32 s48, s48, s49
    s_max_u32 s48, s48, s50
    s_max_u32 s48, s48, s51
    s_max_u32 s48, s48, s52
    s_max_u32 s48, s48, s53
    s_max_u32 s48, s48, s54
    s_max_u32 s48, s48, s55
    s_cmp_lt_u32 s48, 16
    s_cbranch_scc1 L_pollok6
    s_sub_u32 s59, s59, 1
    s_cbranch_scc1 L_pollvec6
    s_sleep 1
    s_branch L_pollsm6
L_pollvec6:
    s_sub_u32 s96, s96, 1
    s_cbranch_scc1 L_pollgiveup6
    s_sleep 2
    buffer_load_dword v52, v53, s[20:23], 0 offen sc1
    s_waitcnt vmcnt(0)
    v_subrev_u32 v52, s92, v52
    v_cmp_lt_u32 vcc, 15, v52
    s_nop 0
    s_and_b32 s59, vcc_lo, 0xff
    s_cbranch_scc1 L_pollvec6
    s_branch L_pollok6
L_pollgiveup6:
    s_mov_b32 s96, 0
    s_branch L_pollok6
L_pollslow7:
    s_mov_b32 s59, 200
L_pollsm7:
    s_buffer_load_dwordx8 s[48:55], s[20:23], 0 glc
    s_waitcnt lgkmcnt(0)
    s_sub_u32 s48, s48, s92
    s_sub_u32 s49, s49, s92
    s_sub_u32 s50, s50, s92
    s_sub_u32 s51, s51, s92
    s_sub_u32 s52, s52, s92
    s_sub_u32 s53, s53, s92
    s_sub_u32 s54, s54, s92
    s_sub_u32 s55, s55, s92
    s_max_u32 s48, s48, s49
    s_max_u32 s48, s48, s50
    s_max_u32 s48, s48, s51
    s_max_u32 s48, s48, s52
    s_max_u32 s48, s48, s53
    s_max_u32 s48, s48, s54
    s_max_u32 s48, s48, s55
    s_cmp_lt_u32 s48, 16
    s_cbranch_scc1 L_pollok7
    s_sub_u32 s59, s59, 1
    s_cbranch_scc1 L_pollvec7
    s_sleep 1
    s_branch L_pollsm7
L_pollvec7:
    s_sub_u32 s96, s96, 1
    s_cbranch_scc1 L_pollgiveup7
    s_sleep 2
    buffer_load_dword v52, v53, s[20:23], 0 offen sc1
    s_waitcnt vmcnt(0)
    v_subrev_u32 v52, s92, v52
    v_cmp_lt_u32 vcc, 15, v52
    s_nop 0
    s_and_b32 s59, vcc_lo, 0xff
    s_cbranch_scc1 L_pollvec7
    s_branch L_pollok7
L_pollgiveup7:
    s_mov_b32 s96, 0
    s_branch L_pollok7
L_pollslowP:
L_pollvecP:
    s_sub_u32 s96, s96, 1
    s_cbranch_scc1 L_pollgiveupP
    s_sleep 2
    buffer_load_dword v52, v53, s[20:23], 0 offen sc1
    s_waitcnt vmcnt(0)
    v_subrev_u32 v52, s92, v52
    v_cmp_lt_u32 vcc, 15, v52
    s_nop 0
    s_and_b32 s59, vcc_lo, 0xff
    s_cbranch_scc1 L_pollvecP
    s_branch L_pollokP
L_pollgiveupP:
    s_mov_b32 s96, 0
    s_branch L_pollokP
L_tagslow:
    s_sub_u32 s96, s96, 1
    s_cbranch_scc1 L_taggiveup
    s_sleep 2
    buffer_load_dword v52, off, s[88:91], s93 sc1
    s_waitcnt vmcnt(0)
    v_readfirstlane_b32 s92, v52
    s_nop 0
    s_cmp_eq_u32 s92, 0
    s_cbranch_scc1 L_tagslow
    s_branch L_tagok
L_taggiveup:
    s_mov_b32 s96, 0
    s_branch L_tagok
L_slow:
    s_waitcnt vmcnt(0) lgkmcnt(0)
    s_nop 15
    v_accvgpr_write_b32 a0, 0
    v_accvgpr_write_b32 a1, 0
    v_accvgpr_write_b32 a2, 0
    v_accvgpr_write_b32 a3, 0
    v_accvgpr_write_b32 a4, 0
    v_accvgpr_write_b32 a5, 0
    v_accvgpr_write_b32 a6, 0
    v_accvgpr_write_b32 a7, 0
    v_accvgpr_write_b32 a8, 0
    v_accvgpr_write_b32 a9, 0
    v_accvgpr_write_b32 a10, 0
    v_accvgpr_write_b32 a11, 0
    v_accvgpr_write_b32 a12, 0
    v_accvgpr_write_b32 a13, 0
    v_accvgpr_write_b32 a14, 0
    v_accvgpr_write_b32 a15, 0
    v_accvgpr_write_b32 a16, 0
    v_accvgpr_write_b32 a17, 0
    v_accvgpr_write_b32 a18, 0
    v_accvgpr_write_b32 a19, 0
    v_accvgpr_write_b32 a20, 0
    v_accvgpr_write_b32 a21, 0
    v_accvgpr_write_b32 a22, 0
    v_accvgpr_write_b32 a23, 0
    v_accvgpr_write_b32 a24, 0
    v_accvgpr_write_b32 a25, 0
    v_accvgpr_write_b32 a26, 0
    v_accvgpr_write_b32 a27, 0
    v_accvgpr_write_b32 a28, 0
    v_accvgpr_write_b32 a29, 0
    v_accvgpr_write_b32 a30, 0
    v_accvgpr_write_b32 a31, 0
    v_accvgpr_write_b32 a32, 0
    v_accvgpr_write_b32 a33, 0
    v_accvgpr_write_b32 a34, 0
    v_accvgpr_write_b32 a35, 0
    v_accvgpr_write_b32 a36, 0
    v_accvgpr_write_b32 a37, 0
    v_accvgpr_write_b32 a38, 0
    v_accvgpr_write_b32 a39, 0
    v_accvgpr_write_b32 a40, 0
    v_accvgpr_write_b32 a41, 0
    v_accvgpr_write_b32 a42, 0
    v_accvgpr_write_b32 a43, 0
    v_accvgpr_write_b32 a44, 0
    v_accvgpr_write_b32 a45, 0
    v_accvgpr_write_b32 a46, 0
    v_accvgpr_write_b32 a47, 0
    v_accvgpr_write_b32 a48, 0
    v_accvgpr_write_b32 a49, 0
    v_accvgpr_write_b32 a50, 0
    v_accvgpr_write_b32 a51, 0
    v_accvgpr_write_b32 a52, 0
    v_accvgpr_write_b32 a53, 0
    v_accvgpr_write_b32 a54, 0
    v_accvgpr_write_b32 a55, 0
    v_accvgpr_write_b32 a56, 0
    v_accvgpr_write_b32 a57, 0
    v_accvgpr_write_b32 a58, 0
    v_accvgpr_write_b32 a59, 0
    v_accvgpr_write_b32 a60, 0
    v_accvgpr_write_b32 a61, 0
    v_accvgpr_write_b32 a62, 0
    v_accvgpr_write_b32 a63, 0
    v_accvgpr_write_b32 a64, 0
    v_accvgpr_write_b32 a65, 0
    v_accvgpr_write_b32 a66, 0
    v_accvgpr_write_b32 a67, 0
    v_accvgpr_write_b32 a68, 0
    v_accvgpr_write_b32 a69, 0
    v_accvgpr_write_b32 a70, 0
    v_accvgpr_write_b32 a71, 0
    v_accvgpr_write_b32 a72, 0
    v_accvgpr_write_b32 a73, 0
    v_accvgpr_write_b32 a74, 0
    v_accvgpr_write_b32 a75, 0
    v_accvgpr_write_b32 a76, 0
    v_accvgpr_write_b32 a77, 0
    v_accvgpr_write_b32 a78, 0
    v_accvgpr_write_b32 a79, 0
    v_accvgpr_write_b32 a80, 0
    v_accvgpr_write_b32 a81, 0
    v_accvgpr_write_b32 a82, 0
    v_accvgpr_write_b32 a83, 0
    v_accvgpr_write_b32 a84, 0
    v_accvgpr_write_b32 a85, 0
    v_accvgpr_write_b32 a86, 0
    v_accvgpr_write_b32 a87, 0
    v_accvgpr_write_b32 a88, 0
    v_accvgpr_write_b32 a89, 0
    v_accvgpr_write_b32 a90, 0
    v_accvgpr_write_b32 a91, 0
    v_accvgpr_write_b32 a92, 0
    v_accvgpr_write_b32 a93, 0
    v_accvgpr_write_b32 a94, 0
    v_accvgpr_write_b32 a95, 0
    v_accvgpr_write_b32 a96, 0
    v_accvgpr_write_b32 a97, 0
    v_accvgpr_write_b32 a98, 0
    v_accvgpr_write_b32 a99, 0
    v_accvgpr_write_b32 a100, 0
    v_accvgpr_write_b32 a101, 0
    v_accvgpr_write_b32 a102, 0
    v_accvgpr_write_b32 a103, 0
    v_accvgpr_write_b32 a104, 0
    v_accvgpr_write_b32 a105, 0
    v_accvgpr_write_b32 a106, 0
    v_accvgpr_write_b32 a107, 0
    v_accvgpr_write_b32 a108, 0
    v_accvgpr_write_b32 a109, 0
    v_accvgpr_write_b32 a110, 0
    v_accvgpr_write_b32 a111, 0
    v_accvgpr_write_b32 a112, 0
    v_accvgpr_write_b32 a113, 0
    v_accvgpr_write_b32 a114, 0
    v_accvgpr_write_b32 a115, 0
    v_accvgpr_write_b32 a116, 0
    v_accvgpr_write_b32 a117, 0
    v_accvgpr_write_b32 a118, 0
    v_accvgpr_write_b32 a119, 0
    v_accvgpr_write_b32 a120, 0
    v_accvgpr_write_b32 a121, 0
    v_accvgpr_write_b32 a122, 0
    v_accvgpr_write_b32 a123, 0
    v_accvgpr_write_b32 a124, 0
    v_accvgpr_write_b32 a125, 0
    v_accvgpr_write_b32 a126, 0
    v_accvgpr_write_b32 a127, 0
    v_accvgpr_write_b32 a128, 0
    v_accvgpr_write_b32 a129, 0
    v_accvgpr_write_b32 a130, 0
    v_accvgpr_write_b32 a131, 0
    v_accvgpr_write_b32 a132, 0
    v_accvgpr_write_b32 a133, 0
    v_accvgpr_write_b32 a134, 0
    v_accvgpr_write_b32 a135, 0
    v_accvgpr_write_b32 a136, 0
    v_accvgpr_write_b32 a137, 0
    v_accvgpr_write_b32 a138, 0
    v_accvgpr_write_b32 a139, 0
    v_accvgpr_write_b32 a140, 0
    v_accvgpr_write_b32 a141, 0
    v_accvgpr_write_b32 a142, 0
    v_accvgpr_write_b32 a143, 0
    v_accvgpr_write_b32 a144, 0
    v_accvgpr_write_b32 a145, 0
    v_accvgpr_write_b32 a146, 0
    v_accvgpr_write_b32 a147, 0
    v_accvgpr_write_b32 a148, 0
    v_accvgpr_write_b32 a149, 0
    v_accvgpr_write_b32 a150, 0
    v_accvgpr_write_b32 a151, 0
    v_accvgpr_write_b32 a152, 0
    v_accvgpr_write_b32 a153, 0
    v_accvgpr_write_b32 a154, 0
    v_accvgpr_write_b32 a155, 0
    v_accvgpr_write_b32 a156, 0
    v_accvgpr_write_b32 a157, 0
    v_accvgpr_write_b32 a158, 0
    v_accvgpr_write_b32 a159, 0
    v_accvgpr_write_b32 a160, 0
    v_accvgpr_write_b32 a161, 0
    v_accvgpr_write_b32 a162, 0
    v_accvgpr_write_b32 a163, 0
    v_accvgpr_write_b32 a164, 0
    v_accvgpr_write_b32 a165, 0
    v_accvgpr_write_b32 a166, 0
    v_accvgpr_write_b32 a167, 0
    v_accvgpr_write_b32 a168, 0
    v_accvgpr_write_b32 a169, 0
    v_accvgpr_write_b32 a170, 0
    v_accvgpr_write_b32 a171, 0
    v_accvgpr_write_b32 a172, 0
    v_accvgpr_write_b32 a173, 0
    v_accvgpr_write_b32 a174, 0
    v_accvgpr_write_b32 a175, 0
    v_accvgpr_write_b32 a176, 0
    v_accvgpr_write_b32 a177, 0
    v_accvgpr_write_b32 a178, 0
    v_accvgpr_write_b32 a179, 0
    v_accvgpr_write_b32 a180, 0
    v_accvgpr_write_b32 a181, 0
    v_accvgpr_write_b32 a182, 0
    v_accvgpr_write_b32 a183, 0
    v_accvgpr_write_b32 a184, 0
    v_accvgpr_write_b32 a185, 0
    v_accvgpr_write_b32 a186, 0
    v_accvgpr_write_b32 a187, 0
    v_accvgpr_write_b32 a188, 0
    v_accvgpr_write_b32 a189, 0
    v_accvgpr_write_b32 a190, 0
    v_accvgpr_write_b32 a191, 0
    v_mov_b32 v4, 0
    v_mov_b32 v240, 0xff7fffff
    v_mov_b32 v5, 0
    v_mov_b32 v241, 0xff7fffff
    v_mov_b32 v6, 0
    v_mov_b32 v242, 0xff7fffff
    v_mov_b32 v7, 0
    v_mov_b32 v243, 0xff7fffff
    v_subrev_u32 v244, s28, v2
    v_subrev_u32 v245, s28, v3
    v_subrev_u32 v246, s30, v1
    v_subrev_u32 v247, s30, v21
    v_subrev_u32 v248, s30, v22
    s_mov_b32 s48, 0
L_slowloop:
    s_add_u32 s49, s48, 6144
    s_add_u32 s50, s48, 12288
    buffer_load_dwordx4 v[64:67], v244, s[4:7], s48 offen offset:0 sc1
    buffer_load_dwordx4 v[68:71], v245, s[4:7], s48 offen offset:0 sc1
    buffer_load_dwordx4 v[72:75], v244, s[4:7], s49 offen offset:0 sc1
    buffer_load_dwordx4 v[76:79], v245, s[4:7], s49 offen offset:0 sc1
    buffer_load_dwordx4 v[80:83], v244, s[4:7], s48 offen offset:128 sc1
    buffer_load_dwordx4 v[84:87], v245, s[4:7], s48 offen offset:128 sc1
    buffer_load_dwordx4 v[88:91], v244, s[4:7], s49 offen offset:128 sc1
    buffer_load_dwordx4 v[92:95], v245, s[4:7], s49 offen offset:128 sc1
    buffer_load_dwordx4 v[96:99], v244, s[4:7], s48 offen offset:256 sc1
    buffer_load_dwordx4 v[100:103], v245, s[4:7], s48 offen offset:256 sc1
    buffer_load_dwordx4 v[104:107], v244, s[4:7], s49 offen offset:256 sc1
    buffer_load_dwordx4 v[108:111], v245, s[4:7], s49 offen offset:256 sc1
    buffer_load_dwordx4 v[112:115], v246, s[4:7], s50 offen offset:0 sc1
    buffer_load_dwordx4 v[116:119], v246, s[4:7], s50 offen offset:768 sc1
    buffer_load_dwordx4 v[120:123], v246, s[4:7], s50 offen offset:1536 sc1
    buffer_load_dwordx4 v[124:127], v246, s[4:7], s50 offen offset:2304 sc1
    buffer_load_dwordx4 v[128:131], v247, s[4:7], s50 offen offset:0 sc1
    buffer_load_dwordx4 v[132:135], v247, s[4:7], s50 offen offset:768 sc1
    buffer_load_dwordx4 v[136:139], v247, s[4:7], s50 offen offset:1536 sc1
    buffer_load_dwordx4 v[140:143], v247, s[4:7], s50 offen offset:2304 sc1
    buffer_load_dwordx4 v[144:147], v248, s[4:7], s50 offen offset:0 sc1
    buffer_load_dwordx4 v[148:151], v248, s[4:7], s50 offen offset:768 sc1
    buffer_load_dwordx4 v[152:155], v248, s[4:7], s50 offen offset:1536 sc1
    buffer_load_dwordx4 v[156:159], v248, s[4:7], s50 offen offset:2304 sc1
    s_waitcnt vmcnt(12)
    v_mfma_f32_16x16x32_bf16 v[160:163], v[64:67], a[192:195], 0
    v_mfma_f32_16x16x32_bf16 v[168:171], v[64:67], a[216:219], 0
    v_mfma_f32_16x16x32_bf16 v[176:179], v[64:67], a[240:243], 0
    v_mfma_f32_16x16x32_bf16 v[184:187], v[64:67], v[200:203], 0
    v_mfma_f32_16x16x32_bf16 v[160:163], v[68:71], a[196:199], v[160:163]
    v_mfma_f32_16x16x32_bf16 v[168:171], v[68:71], a[220:223], v[168:171]
    v_mfma_f32_16x16x32_bf16 v[176:179], v[68:71], a[244:247], v[176:179]
    v_mfma_f32_16x16x32_bf16 v[184:187], v[68:71], v[204:207], v[184:187]
    v_mfma_f32_16x16x32_bf16 v[164:167], v[72:75], a[192:195], 0
    v_mfma_f32_16x16x32_bf16 v[172:175], v[72:75], a[216:219], 0
    v_mfma_f32_16x16x32_bf16 v[180:183], v[72:75], a[240:243], 0
    v_mfma_f32_16x16x32_bf16 v[188:191], v[72:75], v[200:203], 0
    v_mfma_f32_16x16x32_bf16 v[164:167], v[76:79], a[196:199], v[164:167]
    v_mfma_f32_16x16x32_bf16 v[172:175], v[76:79], a[220:223], v[172:175]
    v_mfma_f32_16x16x32_bf16 v[180:183], v[76:79], a[244:247], v[180:183]
    v_mfma_f32_16x16x32_bf16 v[188:191], v[76:79], v[204:207], v[188:191]
    v_mfma_f32_16x16x32_bf16 v[160:163], v[80:83], a[200:203], v[160:163]
    v_mfma_f32_16x16x32_bf16 v[168:171], v[80:83], a[224:227], v[168:171]
    v_mfma_f32_16x16x32_bf16 v[176:179], v[80:83], a[248:251], v[176:179]
    v_mfma_f32_16x16x32_bf16 v[184:187], v[80:83], v[208:211], v[184:187]
    v_mfma_f32_16x16x32_bf16 v[160:163], v[84:87], a[204:207], v[160:163]
    v_mfma_f32_16x16x32_bf16 v[168:171], v[84:87], a[228:231], v[168:171]
    v_mfma_f32_16x16x32_bf16 v[176:179], v[84:87], a[252:255], v[176:179]
    v_mfma_f32_16x16x32_bf16 v[184:187], v[84:87], v[212:215], v[184:187]
    v_mfma_f32_16x16x32_bf16 v[164:167], v[88:91], a[200:203], v[164:167]
    v_mfma_f32_16x16x32_bf16 v[172:175], v[88:91], a[224:227], v[172:175]
    v_mfma_f32_16x16x32_bf16 v[180:183], v[88:91], a[248:251], v[180:183]
    v_mfma_f32_16x16x32_bf16 v[188:191], v[88:91], v[208:211], v[188:191]
    v_mfma_f32_16x16x32_bf16 v[164:167], v[92:95], a[204:207], v[164:167]
    v_mfma_f32_16x16x32_bf16 v[172:175], v[92:95], a[228:231], v[172:175]
    v_mfma_f32_16x16x32_bf16 v[180:183], v[92:95], a[252:255], v[180:183]
    v_mfma_f32_16x16x32_bf16 v[188:191], v[92:95], v[212:215], v[188:191]
    v_mfma_f32_16x16x32_bf16 v[160:163], v[96:99], a[208:211], v[160:163]
    v_mfma_f32_16x16x32_bf16 v[168:171], v[96:99], a[232:235], v[168:171]
    v_mfma_f32_16x16x32_bf16 v[176:179], v[96:99], v[192:195], v[176:179]
    v_mfma_f32_16x16x32_bf16 v[184:187], v[96:99], v[216:219], v[184:187]
    v_mfma_f32_16x16x32_bf16 v[160:163], v[100:103], a[212:215], v[160:163]
    v_mfma_f32_16x16x32_bf16 v[168:171], v[100:103], a[236:239], v[168:171]
    v_mfma_f32_16x16x32_bf16 v[176:179], v[100:103], v[196:199], v[176:179]
    v_mfma_f32_16x16x32_bf16 v[184:187], v[100:103], v[220:223], v[184:187]
    v_mfma_f32_16x16x32_bf16 v[164:167], v[104:107], a[208:211], v[164:167]
    v_mfma_f32_16x16x32_bf16 v[172:175], v[104:107], a[232:235], v[172:175]
    v_mfma_f32_16x16x32_bf16 v[180:183], v[104:107], v[192:195], v[180:183]
    v_mfma_f32_16x16x32_bf16 v[188:191], v[104:107], v[216:219], v[188:191]
    v_mfma_f32_16x16x32_bf16 v[164:167], v[108:111], a[212:215], v[164:167]
    v_mfma_f32_16x16x32_bf16 v[172:175], v[108:111], a[236:239], v[172:175]
    v_mfma_f32_16x16x32_bf16 v[180:183], v[108:111], v[196:199], v[180:183]
    v_mfma_f32_16x16x32_bf16 v[188:191], v[108:111], v[220:223], v[188:191]
    s_nop 9
    v_max3_f32 v16, v160, v161, v162
    v_max3_f32 v16, v16, v163, v164
    v_max3_f32 v16, v16, v165, v166
    v_max3_f32 v16, v16, v167, v240
    v_mov_b32 v17, v16
    s_nop 1
    v_permlane16_swap_b32 v16, v17
    s_nop 1
    v_max_f32 v16, v16, v17
    v_mov_b32 v17, v16
    s_nop 1
    v_permlane32_swap_b32 v16, v17
    s_nop 1
    v_max_f32 v16, v16, v17
    v_sub_f32 v17, v240, v16
    v_exp_f32 v17, v17
    v_mov_b32 v240, v16
    ds_bpermute_b32 v250, v62, v17 offset:0
    ds_bpermute_b32 v251, v62, v17 offset:4
    ds_bpermute_b32 v252, v62, v17 offset:8
    ds_bpermute_b32 v253, v62, v17 offset:12
    v_sub_f32 v160, v160, v16
    v_sub_f32 v161, v161, v16
    v_sub_f32 v162, v162, v16
    v_sub_f32 v163, v163, v16
    v_sub_f32 v164, v164, v16
    v_sub_f32 v165, v165, v16
    v_sub_f32 v166, v166, v16
    v_sub_f32 v167, v167, v16
    v_exp_f32 v160, v160
    v_exp_f32 v161, v161
    v_exp_f32 v162, v162
    v_exp_f32 v163, v163
    v_exp_f32 v164, v164
    v_exp_f32 v165, v165
    v_exp_f32 v166, v166
    v_exp_f32 v167, v167
    v_mul_f32 v4, v4, v17
    v_add_f32 v4, v4, v160
    v_add_f32 v4, v4, v161
    v_add_f32 v4, v4, v162
    v_add_f32 v4, v4, v163
    v_add_f32 v4, v4, v164
    v_add_f32 v4, v4, v165
    v_add_f32 v4, v4, v166
    v_add_f32 v4, v4, v167
    v_cvt_pk_bf16_f32 v224, v160, v161
    v_cvt_pk_bf16_f32 v225, v162, v163
    v_cvt_pk_bf16_f32 v226, v164, v165
    v_cvt_pk_bf16_f32 v227, v166, v167
    s_waitcnt lgkmcnt(0)
    v_accvgpr_read_b32 v18, a0
    v_mul_f32 v18, v18, v250
    v_accvgpr_write_b32 a0, v18
    v_accvgpr_read_b32 v19, a1
    v_mul_f32 v19, v19, v251
    v_accvgpr_write_b32 a1, v19
    v_accvgpr_read_b32 v18, a2
    v_mul_f32 v18, v18, v252
    v_accvgpr_write_b32 a2, v18
    v_accvgpr_read_b32 v19, a3
    v_mul_f32 v19, v19, v253
    v_accvgpr_write_b32 a3, v19
    v_accvgpr_read_b32 v18, a4
    v_mul_f32 v18, v18, v250
    v_accvgpr_write_b32 a4, v18
    v_accvgpr_read_b32 v19, a5
    v_mul_f32 v19, v19, v251
    v_accvgpr_write_b32 a5, v19
    v_accvgpr_read_b32 v18, a6
    v_mul_f32 v18, v18, v252
    v_accvgpr_write_b32 a6, v18
    v_accvgpr_read_b32 v19, a7
    v_mul_f32 v19, v19, v253
    v_accvgpr_write_b32 a7, v19
    v_accvgpr_read_b32 v18, a8
    v_mul_f32 v18, v18, v250
    v_accvgpr_write_b32 a8, v18
    v_accvgpr_read_b32 v19, a9
    v_mul_f32 v19, v19, v251
    v_accvgpr_write_b32 a9, v19
    v_accvgpr_read_b32 v18, a10
    v_mul_f32 v18, v18, v252
    v_accvgpr_write_b32 a10, v18
    v_accvgpr_read_b32 v19, a11
    v_mul_f32 v19, v19, v253
    v_accvgpr_write_b32 a11, v19
    v_accvgpr_read_b32 v18, a12
    v_mul_f32 v18, v18, v250
    v_accvgpr_write_b32 a12, v18
    v_accvgpr_read_b32 v19, a13
    v_mul_f32 v19, v19, v251
    v_accvgpr_write_b32 a13, v19
    v_accvgpr_read_b32 v18, a14
    v_mul_f32 v18, v18, v252
    v_accvgpr_write_b32 a14, v18
    v_accvgpr_read_b32 v19, a15
    v_mul_f32 v19, v19, v253
    v_accvgpr_write_b32 a15, v19
    v_accvgpr_read_b32 v18, a16
    v_mul_f32 v18, v18, v250
    v_accvgpr_write_b32 a16, v18
    v_accvgpr_read_b32 v19, a17
    v_mul_f32 v19, v19, v251
    v_accvgpr_write_b32 a17, v19
    v_accvgpr_read_b32 v18, a18
    v_mul_f32 v18, v18, v252
    v_accvgpr_write_b32 a18, v18
    v_accvgpr_read_b32 v19, a19
    v_mul_f32 v19, v19, v253
    v_accvgpr_write_b32 a19, v19
    v_accvgpr_read_b32 v18, a20
    v_mul_f32 v18, v18, v250
    v_accvgpr_write_b32 a20, v18
    v_accvgpr_read_b32 v19, a21
    v_mul_f32 v19, v19, v251
    v_accvgpr_write_b32 a21, v19
    v_accvgpr_read_b32 v18, a22
    v_mul_f32 v18, v18, v252
    v_accvgpr_write_b32 a22, v18
    v_accvgpr_read_b32 v19, a23
    v_mul_f32 v19, v19, v253
    v_accvgpr_write_b32 a23, v19
    v_accvgpr_read_b32 v18, a24
    v_mul_f32 v18, v18, v250
    v_accvgpr_write_b32 a24, v18
    v_accvgpr_read_b32 v19, a25
    v_mul_f32 v19, v19, v251
    v_accvgpr_write_b32 a25, v19
    v_accvgpr_read_b32 v18, a26
    v_mul_f32 v18, v18, v252
    v_accvgpr_write_b32 a26, v18
    v_accvgpr_read_b32 v19, a27
    v_mul_f32 v19, v19, v253
    v_accvgpr_write_b32 a27, v19
    v_accvgpr_read_b32 v18, a28
    v_mul_f32 v18, v18, v250
    v_accvgpr_write_b32 a28, v18
    v_accvgpr_read_b32 v19, a29
    v_mul_f32 v19, v19, v251
    v_accvgpr_write_b32 a29, v19
    v_accvgpr_read_b32 v18, a30
    v_mul_f32 v18, v18, v252
    v_accvgpr_write_b32 a30, v18
    v_accvgpr_read_b32 v19, a31
    v_mul_f32 v19, v19, v253
    v_accvgpr_write_b32 a31, v19
    v_accvgpr_read_b32 v18, a32
    v_mul_f32 v18, v18, v250
    v_accvgpr_write_b32 a32, v18
    v_accvgpr_read_b32 v19, a33
    v_mul_f32 v19, v19, v251
    v_accvgpr_write_b32 a33, v19
    v_accvgpr_read_b32 v18, a34
    v_mul_f32 v18, v18, v252
    v_accvgpr_write_b32 a34, v18
    v_accvgpr_read_b32 v19, a35
    v_mul_f32 v19, v19, v253
    v_accvgpr_write_b32 a35, v19
    v_accvgpr_read_b32 v18, a36
    v_mul_f32 v18, v18, v250
    v_accvgpr_write_b32 a36, v18
    v_accvgpr_read_b32 v19, a37
    v_mul_f32 v19, v19, v251
    v_accvgpr_write_b32 a37, v19
    v_accvgpr_read_b32 v18, a38
    v_mul_f32 v18, v18, v252
    v_accvgpr_write_b32 a38, v18
    v_accvgpr_read_b32 v19, a39
    v_mul_f32 v19, v19, v253
    v_accvgpr_write_b32 a39, v19
    v_accvgpr_read_b32 v18, a40
    v_mul_f32 v18, v18, v250
    v_accvgpr_write_b32 a40, v18
    v_accvgpr_read_b32 v19, a41
    v_mul_f32 v19, v19, v251
    v_accvgpr_write_b32 a41, v19
    v_accvgpr_read_b32 v18, a42
    v_mul_f32 v18, v18, v252
    v_accvgpr_write_b32 a42, v18
    v_accvgpr_read_b32 v19, a43
    v_mul_f32 v19, v19, v253
    v_accvgpr_write_b32 a43, v19
    v_accvgpr_read_b32 v18, a44
    v_mul_f32 v18, v18, v250
    v_accvgpr_write_b32 a44, v18
    v_accvgpr_read_b32 v19, a45
    v_mul_f32 v19, v19, v251
    v_accvgpr_write_b32 a45, v19
    v_accvgpr_read_b32 v18, a46
    v_mul_f32 v18, v18, v252
    v_accvgpr_write_b32 a46, v18
    v_accvgpr_read_b32 v19, a47
    v_mul_f32 v19, v19, v253
    v_accvgpr_write_b32 a47, v19
    v_max3_f32 v16, v168, v169, v170
    v_max3_f32 v16, v16, v171, v172
    v_max3_f32 v16, v16, v173, v174
    v_max3_f32 v16, v16, v175, v241
    v_mov_b32 v17, v16
    s_nop 1
    v_permlane16_swap_b32 v16, v17
    s_nop 1
    v_max_f32 v16, v16, v17
    v_mov_b32 v17, v16
    s_nop 1
    v_permlane32_swap_b32 v16, v17
    s_nop 1
    v_max_f32 v16, v16, v17
    v_sub_f32 v17, v241, v16
    v_exp_f32 v17, v17
    v_mov_b32 v241, v16
    ds_bpermute_b32 v250, v62, v17 offset:0
    ds_bpermute_b32 v251, v62, v17 offset:4
    ds_bpermute_b32 v252, v62, v17 offset:8
    ds_bpermute_b32 v253, v62, v17 offset:12
    v_sub_f32 v168, v168, v16
    v_sub_f32 v169, v169, v16
    v_sub_f32 v170, v170, v16
    v_sub_f32 v171, v171, v16
    v_sub_f32 v172, v172, v16
    v_sub_f32 v173, v173, v16
    v_sub_f32 v174, v174, v16
    v_sub_f32 v175, v175, v16
    v_exp_f32 v168, v168
    v_exp_f32 v169, v169
    v_exp_f32 v170, v170
    v_exp_f32 v171, v171
    v_exp_f32 v172, v172
    v_exp_f32 v173, v173
    v_exp_f32 v174, v174
    v_exp_f32 v175, v175
    v_mul_f32 v5, v5, v17
    v_add_f32 v5, v5, v168
    v_add_f32 v5, v5, v169
    v_add_f32 v5, v5, v170
    v_add_f32 v5, v5, v171
    v_add_f32 v5, v5, v172
    v_add_f32 v5, v5, v173
    v_add_f32 v5, v5, v174
    v_add_f32 v5, v5, v175
    v_cvt_pk_bf16_f32 v228, v168, v169
    v_cvt_pk_bf16_f32 v229, v170, v171
    v_cvt_pk_bf16_f32 v230, v172, v173
    v_cvt_pk_bf16_f32 v231, v174, v175
    s_waitcnt lgkmcnt(0)
    v_accvgpr_read_b32 v18, a48
    v_mul_f32 v18, v18, v250
    v_accvgpr_write_b32 a48, v18
    v_accvgpr_read_b32 v19, a49
    v_mul_f32 v19, v19, v251
    v_accvgpr_write_b32 a49, v19
    v_accvgpr_read_b32 v18, a50
    v_mul_f32 v18, v18, v252
    v_accvgpr_write_b32 a50, v18
    v_accvgpr_read_b32 v19, a51
    v_mul_f32 v19, v19, v253
    v_accvgpr_write_b32 a51, v19
    v_accvgpr_read_b32 v18, a52
    v_mul_f32 v18, v18, v250
    v_accvgpr_write_b32 a52, v18
    v_accvgpr_read_b32 v19, a53
    v_mul_f32 v19, v19, v251
    v_accvgpr_write_b32 a53, v19
    v_accvgpr_read_b32 v18, a54
    v_mul_f32 v18, v18, v252
    v_accvgpr_write_b32 a54, v18
    v_accvgpr_read_b32 v19, a55
    v_mul_f32 v19, v19, v253
    v_accvgpr_write_b32 a55, v19
    v_accvgpr_read_b32 v18, a56
    v_mul_f32 v18, v18, v250
    v_accvgpr_write_b32 a56, v18
    v_accvgpr_read_b32 v19, a57
    v_mul_f32 v19, v19, v251
    v_accvgpr_write_b32 a57, v19
    v_accvgpr_read_b32 v18, a58
    v_mul_f32 v18, v18, v252
    v_accvgpr_write_b32 a58, v18
    v_accvgpr_read_b32 v19, a59
    v_mul_f32 v19, v19, v253
    v_accvgpr_write_b32 a59, v19
    v_accvgpr_read_b32 v18, a60
    v_mul_f32 v18, v18, v250
    v_accvgpr_write_b32 a60, v18
    v_accvgpr_read_b32 v19, a61
    v_mul_f32 v19, v19, v251
    v_accvgpr_write_b32 a61, v19
    v_accvgpr_read_b32 v18, a62
    v_mul_f32 v18, v18, v252
    v_accvgpr_write_b32 a62, v18
    v_accvgpr_read_b32 v19, a63
    v_mul_f32 v19, v19, v253
    v_accvgpr_write_b32 a63, v19
    v_accvgpr_read_b32 v18, a64
    v_mul_f32 v18, v18, v250
    v_accvgpr_write_b32 a64, v18
    v_accvgpr_read_b32 v19, a65
    v_mul_f32 v19, v19, v251
    v_accvgpr_write_b32 a65, v19
    v_accvgpr_read_b32 v18, a66
    v_mul_f32 v18, v18, v252
    v_accvgpr_write_b32 a66, v18
    v_accvgpr_read_b32 v19, a67
    v_mul_f32 v19, v19, v253
    v_accvgpr_write_b32 a67, v19
    v_accvgpr_read_b32 v18, a68
    v_mul_f32 v18, v18, v250
    v_accvgpr_write_b32 a68, v18
    v_accvgpr_read_b32 v19, a69
    v_mul_f32 v19, v19, v251
    v_accvgpr_write_b32 a69, v19
    v_accvgpr_read_b32 v18, a70
    v_mul_f32 v18, v18, v252
    v_accvgpr_write_b32 a70, v18
    v_accvgpr_read_b32 v19, a71
    v_mul_f32 v19, v19, v253
    v_accvgpr_write_b32 a71, v19
    v_accvgpr_read_b32 v18, a72
    v_mul_f32 v18, v18, v250
    v_accvgpr_write_b32 a72, v18
    v_accvgpr_read_b32 v19, a73
    v_mul_f32 v19, v19, v251
    v_accvgpr_write_b32 a73, v19
    v_accvgpr_read_b32 v18, a74
    v_mul_f32 v18, v18, v252
    v_accvgpr_write_b32 a74, v18
    v_accvgpr_read_b32 v19, a75
    v_mul_f32 v19, v19, v253
    v_accvgpr_write_b32 a75, v19
    v_accvgpr_read_b32 v18, a76
    v_mul_f32 v18, v18, v250
    v_accvgpr_write_b32 a76, v18
    v_accvgpr_read_b32 v19, a77
    v_mul_f32 v19, v19, v251
    v_accvgpr_write_b32 a77, v19
    v_accvgpr_read_b32 v18, a78
    v_mul_f32 v18, v18, v252
    v_accvgpr_write_b32 a78, v18
    v_accvgpr_read_b32 v19, a79
    v_mul_f32 v19, v19, v253
    v_accvgpr_write_b32 a79, v19
    v_accvgpr_read_b32 v18, a80
    v_mul_f32 v18, v18, v250
    v_accvgpr_write_b32 a80, v18
    v_accvgpr_read_b32 v19, a81
    v_mul_f32 v19, v19, v251
    v_accvgpr_write_b32 a81, v19
    v_accvgpr_read_b32 v18, a82
    v_mul_f32 v18, v18, v252
    v_accvgpr_write_b32 a82, v18
    v_accvgpr_read_b32 v19, a83
    v_mul_f32 v19, v19, v253
    v_accvgpr_write_b32 a83, v19
    v_accvgpr_read_b32 v18, a84
    v_mul_f32 v18, v18, v250
    v_accvgpr_write_b32 a84, v18
    v_accvgpr_read_b32 v19, a85
    v_mul_f32 v19, v19, v251
    v_accvgpr_write_b32 a85, v19
    v_accvgpr_read_b32 v18, a86
    v_mul_f32 v18, v18, v252
    v_accvgpr_write_b32 a86, v18
    v_accvgpr_read_b32 v19, a87
    v_mul_f32 v19, v19, v253
    v_accvgpr_write_b32 a87, v19
    v_accvgpr_read_b32 v18, a88
    v_mul_f32 v18, v18, v250
    v_accvgpr_write_b32 a88, v18
    v_accvgpr_read_b32 v19, a89
    v_mul_f32 v19, v19, v251
    v_accvgpr_write_b32 a89, v19
    v_accvgpr_read_b32 v18, a90
    v_mul_f32 v18, v18, v252
    v_accvgpr_write_b32 a90, v18
    v_accvgpr_read_b32 v19, a91
    v_mul_f32 v19, v19, v253
    v_accvgpr_write_b32 a91, v19
    v_accvgpr_read_b32 v18, a92
    v_mul_f32 v18, v18, v250
    v_accvgpr_write_b32 a92, v18
    v_accvgpr_read_b32 v19, a93
    v_mul_f32 v19, v19, v251
    v_accvgpr_write_b32 a93, v19
    v_accvgpr_read_b32 v18, a94
    v_mul_f32 v18, v18, v252
    v_accvgpr_write_b32 a94, v18
    v_accvgpr_read_b32 v19, a95
    v_mul_f32 v19, v19, v253
    v_accvgpr_write_b32 a95, v19
    v_max3_f32 v16, v176, v177, v178
    v_max3_f32 v16, v16, v179, v180
    v_max3_f32 v16, v16, v181, v182
    v_max3_f32 v16, v16, v183, v242
    v_mov_b32 v17, v16
    s_nop 1
    v_permlane16_swap_b32 v16, v17
    s_nop 1
    v_max_f32 v16, v16, v17
    v_mov_b32 v17, v16
    s_nop 1
    v_permlane32_swap_b32 v16, v17
    s_nop 1
    v_max_f32 v16, v16, v17
    v_sub_f32 v17, v242, v16
    v_exp_f32 v17, v17
    v_mov_b32 v242, v16
    ds_bpermute_b32 v250, v62, v17 offset:0
    ds_bpermute_b32 v251, v62, v17 offset:4
    ds_bpermute_b32 v252, v62, v17 offset:8
    ds_bpermute_b32 v253, v62, v17 offset:12
    v_sub_f32 v176, v176, v16
    v_sub_f32 v177, v177, v16
    v_sub_f32 v178, v178, v16
    v_sub_f32 v179, v179, v16
    v_sub_f32 v180, v180, v16
    v_sub_f32 v181, v181, v16
    v_sub_f32 v182, v182, v16
    v_sub_f32 v183, v183, v16
    v_exp_f32 v176, v176
    v_exp_f32 v177, v177
    v_exp_f32 v178, v178
    v_exp_f32 v179, v179
    v_exp_f32 v180, v180
    v_exp_f32 v181, v181
    v_exp_f32 v182, v182
    v_exp_f32 v183, v183
    v_mul_f32 v6, v6, v17
    v_add_f32 v6, v6, v176
    v_add_f32 v6, v6, v177
    v_add_f32 v6, v6, v178
    v_add_f32 v6, v6, v179
    v_add_f32 v6, v6, v180
    v_add_f32 v6, v6, v181
    v_add_f32 v6, v6, v182
    v_add_f32 v6, v6, v183
    v_cvt_pk_bf16_f32 v232, v176, v177
    v_cvt_pk_bf16_f32 v233, v178, v179
    v_cvt_pk_bf16_f32 v234, v180, v181
    v_cvt_pk_bf16_f32 v235, v182, v183
    s_waitcnt lgkmcnt(0)
    v_accvgpr_read_b32 v18, a96
    v_mul_f32 v18, v18, v250
    v_accvgpr_write_b32 a96, v18
    v_accvgpr_read_b32 v19, a97
    v_mul_f32 v19, v19, v251
    v_accvgpr_write_b32 a97, v19
    v_accvgpr_read_b32 v18, a98
    v_mul_f32 v18, v18, v252
    v_accvgpr_write_b32 a98, v18
    v_accvgpr_read_b32 v19, a99
    v_mul_f32 v19, v19, v253
    v_accvgpr_write_b32 a99, v19
    v_accvgpr_read_b32 v18, a100
    v_mul_f32 v18, v18, v250
    v_accvgpr_write_b32 a100, v18
    v_accvgpr_read_b32 v19, a101
    v_mul_f32 v19, v19, v251
    v_accvgpr_write_b32 a101, v19
    v_accvgpr_read_b32 v18, a102
    v_mul_f32 v18, v18, v252
    v_accvgpr_write_b32 a102, v18
    v_accvgpr_read_b32 v19, a103
    v_mul_f32 v19, v19, v253
    v_accvgpr_write_b32 a103, v19
    v_accvgpr_read_b32 v18, a104
    v_mul_f32 v18, v18, v250
    v_accvgpr_write_b32 a104, v18
    v_accvgpr_read_b32 v19, a105
    v_mul_f32 v19, v19, v251
    v_accvgpr_write_b32 a105, v19
    v_accvgpr_read_b32 v18, a106
    v_mul_f32 v18, v18, v252
    v_accvgpr_write_b32 a106, v18
    v_accvgpr_read_b32 v19, a107
    v_mul_f32 v19, v19, v253
    v_accvgpr_write_b32 a107, v19
    v_accvgpr_read_b32 v18, a108
    v_mul_f32 v18, v18, v250
    v_accvgpr_write_b32 a108, v18
    v_accvgpr_read_b32 v19, a109
    v_mul_f32 v19, v19, v251
    v_accvgpr_write_b32 a109, v19
    v_accvgpr_read_b32 v18, a110
    v_mul_f32 v18, v18, v252
    v_accvgpr_write_b32 a110, v18
    v_accvgpr_read_b32 v19, a111
    v_mul_f32 v19, v19, v253
    v_accvgpr_write_b32 a111, v19
    v_accvgpr_read_b32 v18, a112
    v_mul_f32 v18, v18, v250
    v_accvgpr_write_b32 a112, v18
    v_accvgpr_read_b32 v19, a113
    v_mul_f32 v19, v19, v251
    v_accvgpr_write_b32 a113, v19
    v_accvgpr_read_b32 v18, a114
    v_mul_f32 v18, v18, v252
    v_accvgpr_write_b32 a114, v18
    v_accvgpr_read_b32 v19, a115
    v_mul_f32 v19, v19, v253
    v_accvgpr_write_b32 a115, v19
    v_accvgpr_read_b32 v18, a116
    v_mul_f32 v18, v18, v250
    v_accvgpr_write_b32 a116, v18
    v_accvgpr_read_b32 v19, a117
    v_mul_f32 v19, v19, v251
    v_accvgpr_write_b32 a117, v19
    v_accvgpr_read_b32 v18, a118
    v_mul_f32 v18, v18, v252
    v_accvgpr_write_b32 a118, v18
    v_accvgpr_read_b32 v19, a119
    v_mul_f32 v19, v19, v253
    v_accvgpr_write_b32 a119, v19
    v_accvgpr_read_b32 v18, a120
    v_mul_f32 v18, v18, v250
    v_accvgpr_write_b32 a120, v18
    v_accvgpr_read_b32 v19, a121
    v_mul_f32 v19, v19, v251
    v_accvgpr_write_b32 a121, v19
    v_accvgpr_read_b32 v18, a122
    v_mul_f32 v18, v18, v252
    v_accvgpr_write_b32 a122, v18
    v_accvgpr_read_b32 v19, a123
    v_mul_f32 v19, v19, v253
    v_accvgpr_write_b32 a123, v19
    v_accvgpr_read_b32 v18, a124
    v_mul_f32 v18, v18, v250
    v_accvgpr_write_b32 a124, v18
    v_accvgpr_read_b32 v19, a125
    v_mul_f32 v19, v19, v251
    v_accvgpr_write_b32 a125, v19
    v_accvgpr_read_b32 v18, a126
    v_mul_f32 v18, v18, v252
    v_accvgpr_write_b32 a126, v18
    v_accvgpr_read_b32 v19, a127
    v_mul_f32 v19, v19, v253
    v_accvgpr_write_b32 a127, v19
    v_accvgpr_read_b32 v18, a128
    v_mul_f32 v18, v18, v250
    v_accvgpr_write_b32 a128, v18
    v_accvgpr_read_b32 v19, a129
    v_mul_f32 v19, v19, v251
    v_accvgpr_write_b32 a129, v19
    v_accvgpr_read_b32 v18, a130
    v_mul_f32 v18, v18, v252
    v_accvgpr_write_b32 a130, v18
    v_accvgpr_read_b32 v19, a131
    v_mul_f32 v19, v19, v253
    v_accvgpr_write_b32 a131, v19
    v_accvgpr_read_b32 v18, a132
    v_mul_f32 v18, v18, v250
    v_accvgpr_write_b32 a132, v18
    v_accvgpr_read_b32 v19, a133
    v_mul_f32 v19, v19, v251
    v_accvgpr_write_b32 a133, v19
    v_accvgpr_read_b32 v18, a134
    v_mul_f32 v18, v18, v252
    v_accvgpr_write_b32 a134, v18
    v_accvgpr_read_b32 v19, a135
    v_mul_f32 v19, v19, v253
    v_accvgpr_write_b32 a135, v19
    v_accvgpr_read_b32 v18, a136
    v_mul_f32 v18, v18, v250
    v_accvgpr_write_b32 a136, v18
    v_accvgpr_read_b32 v19, a137
    v_mul_f32 v19, v19, v251
    v_accvgpr_write_b32 a137, v19
    v_accvgpr_read_b32 v18, a138
    v_mul_f32 v18, v18, v252
    v_accvgpr_write_b32 a138, v18
    v_accvgpr_read_b32 v19, a139
    v_mul_f32 v19, v19, v253
    v_accvgpr_write_b32 a139, v19
    v_accvgpr_read_b32 v18, a140
    v_mul_f32 v18, v18, v250
    v_accvgpr_write_b32 a140, v18
    v_accvgpr_read_b32 v19, a141
    v_mul_f32 v19, v19, v251
    v_accvgpr_write_b32 a141, v19
    v_accvgpr_read_b32 v18, a142
    v_mul_f32 v18, v18, v252
    v_accvgpr_write_b32 a142, v18
    v_accvgpr_read_b32 v19, a143
    v_mul_f32 v19, v19, v253
    v_accvgpr_write_b32 a143, v19
    v_max3_f32 v16, v184, v185, v186
    v_max3_f32 v16, v16, v187, v188
    v_max3_f32 v16, v16, v189, v190
    v_max3_f32 v16, v16, v191, v243
    v_mov_b32 v17, v16
    s_nop 1
    v_permlane16_swap_b32 v16, v17
    s_nop 1
    v_max_f32 v16, v16, v17
    v_mov_b32 v17, v16
    s_nop 1
    v_permlane32_swap_b32 v16, v17
    s_nop 1
    v_max_f32 v16, v16, v17
    v_sub_f32 v17, v243, v16
    v_exp_f32 v17, v17
    v_mov_b32 v243, v16
    ds_bpermute_b32 v250, v62, v17 offset:0
    ds_bpermute_b32 v251, v62, v17 offset:4
    ds_bpermute_b32 v252, v62, v17 offset:8
    ds_bpermute_b32 v253, v62, v17 offset:12
    v_sub_f32 v184, v184, v16
    v_sub_f32 v185, v185, v16
    v_sub_f32 v186, v186, v16
    v_sub_f32 v187, v187, v16
    v_sub_f32 v188, v188, v16
    v_sub_f32 v189, v189, v16
    v_sub_f32 v190, v190, v16
    v_sub_f32 v191, v191, v16
    v_exp_f32 v184, v184
    v_exp_f32 v185, v185
    v_exp_f32 v186, v186
    v_exp_f32 v187, v187
    v_exp_f32 v188, v188
    v_exp_f32 v189, v189
    v_exp_f32 v190, v190
    v_exp_f32 v191, v191
    v_mul_f32 v7, v7, v17
    v_add_f32 v7, v7, v184
    v_add_f32 v7, v7, v185
    v_add_f32 v7, v7, v186
    v_add_f32 v7, v7, v187
    v_add_f32 v7, v7, v188
    v_add_f32 v7, v7, v189
    v_add_f32 v7, v7, v190
    v_add_f32 v7, v7, v191
    v_cvt_pk_bf16_f32 v236, v184, v185
    v_cvt_pk_bf16_f32 v237, v186, v187
    v_cvt_pk_bf16_f32 v238, v188, v189
    v_cvt_pk_bf16_f32 v239, v190, v191
    s_waitcnt lgkmcnt(0)
    v_accvgpr_read_b32 v18, a144
    v_mul_f32 v18, v18, v250
    v_accvgpr_write_b32 a144, v18
    v_accvgpr_read_b32 v19, a145
    v_mul_f32 v19, v19, v251
    v_accvgpr_write_b32 a145, v19
    v_accvgpr_read_b32 v18, a146
    v_mul_f32 v18, v18, v252
    v_accvgpr_write_b32 a146, v18
    v_accvgpr_read_b32 v19, a147
    v_mul_f32 v19, v19, v253
    v_accvgpr_write_b32 a147, v19
    v_accvgpr_read_b32 v18, a148
    v_mul_f32 v18, v18, v250
    v_accvgpr_write_b32 a148, v18
    v_accvgpr_read_b32 v19, a149
    v_mul_f32 v19, v19, v251
    v_accvgpr_write_b32 a149, v19
    v_accvgpr_read_b32 v18, a150
    v_mul_f32 v18, v18, v252
    v_accvgpr_write_b32 a150, v18
    v_accvgpr_read_b32 v19, a151
    v_mul_f32 v19, v19, v253
    v_accvgpr_write_b32 a151, v19
    v_accvgpr_read_b32 v18, a152
    v_mul_f32 v18, v18, v250
    v_accvgpr_write_b32 a152, v18
    v_accvgpr_read_b32 v19, a153
    v_mul_f32 v19, v19, v251
    v_accvgpr_write_b32 a153, v19
    v_accvgpr_read_b32 v18, a154
    v_mul_f32 v18, v18, v252
    v_accvgpr_write_b32 a154, v18
    v_accvgpr_read_b32 v19, a155
    v_mul_f32 v19, v19, v253
    v_accvgpr_write_b32 a155, v19
    v_accvgpr_read_b32 v18, a156
    v_mul_f32 v18, v18, v250
    v_accvgpr_write_b32 a156, v18
    v_accvgpr_read_b32 v19, a157
    v_mul_f32 v19, v19, v251
    v_accvgpr_write_b32 a157, v19
    v_accvgpr_read_b32 v18, a158
    v_mul_f32 v18, v18, v252
    v_accvgpr_write_b32 a158, v18
    v_accvgpr_read_b32 v19, a159
    v_mul_f32 v19, v19, v253
    v_accvgpr_write_b32 a159, v19
    v_accvgpr_read_b32 v18, a160
    v_mul_f32 v18, v18, v250
    v_accvgpr_write_b32 a160, v18
    v_accvgpr_read_b32 v19, a161
    v_mul_f32 v19, v19, v251
    v_accvgpr_write_b32 a161, v19
    v_accvgpr_read_b32 v18, a162
    v_mul_f32 v18, v18, v252
    v_accvgpr_write_b32 a162, v18
    v_accvgpr_read_b32 v19, a163
    v_mul_f32 v19, v19, v253
    v_accvgpr_write_b32 a163, v19
    v_accvgpr_read_b32 v18, a164
    v_mul_f32 v18, v18, v250
    v_accvgpr_write_b32 a164, v18
    v_accvgpr_read_b32 v19, a165
    v_mul_f32 v19, v19, v251
    v_accvgpr_write_b32 a165, v19
    v_accvgpr_read_b32 v18, a166
    v_mul_f32 v18, v18, v252
    v_accvgpr_write_b32 a166, v18
    v_accvgpr_read_b32 v19, a167
    v_mul_f32 v19, v19, v253
    v_accvgpr_write_b32 a167, v19
    v_accvgpr_read_b32 v18, a168
    v_mul_f32 v18, v18, v250
    v_accvgpr_write_b32 a168, v18
    v_accvgpr_read_b32 v19, a169
    v_mul_f32 v19, v19, v251
    v_accvgpr_write_b32 a169, v19
    v_accvgpr_read_b32 v18, a170
    v_mul_f32 v18, v18, v252
    v_accvgpr_write_b32 a170, v18
    v_accvgpr_read_b32 v19, a171
    v_mul_f32 v19, v19, v253
    v_accvgpr_write_b32 a171, v19
    v_accvgpr_read_b32 v18, a172
    v_mul_f32 v18, v18, v250
    v_accvgpr_write_b32 a172, v18
    v_accvgpr_read_b32 v19, a173
    v_mul_f32 v19, v19, v251
    v_accvgpr_write_b32 a173, v19
    v_accvgpr_read_b32 v18, a174
    v_mul_f32 v18, v18, v252
    v_accvgpr_write_b32 a174, v18
    v_accvgpr_read_b32 v19, a175
    v_mul_f32 v19, v19, v253
    v_accvgpr_write_b32 a175, v19
    v_accvgpr_read_b32 v18, a176
    v_mul_f32 v18, v18, v250
    v_accvgpr_write_b32 a176, v18
    v_accvgpr_read_b32 v19, a177
    v_mul_f32 v19, v19, v251
    v_accvgpr_write_b32 a177, v19
    v_accvgpr_read_b32 v18, a178
    v_mul_f32 v18, v18, v252
    v_accvgpr_write_b32 a178, v18
    v_accvgpr_read_b32 v19, a179
    v_mul_f32 v19, v19, v253
    v_accvgpr_write_b32 a179, v19
    v_accvgpr_read_b32 v18, a180
    v_mul_f32 v18, v18, v250
    v_accvgpr_write_b32 a180, v18
    v_accvgpr_read_b32 v19, a181
    v_mul_f32 v19, v19, v251
    v_accvgpr_write_b32 a181, v19
    v_accvgpr_read_b32 v18, a182
    v_mul_f32 v18, v18, v252
    v_accvgpr_write_b32 a182, v18
    v_accvgpr_read_b32 v19, a183
    v_mul_f32 v19, v19, v253
    v_accvgpr_write_b32 a183, v19
    v_accvgpr_read_b32 v18, a184
    v_mul_f32 v18, v18, v250
    v_accvgpr_write_b32 a184, v18
    v_accvgpr_read_b32 v19, a185
    v_mul_f32 v19, v19, v251
    v_accvgpr_write_b32 a185, v19
    v_accvgpr_read_b32 v18, a186
    v_mul_f32 v18, v18, v252
    v_accvgpr_write_b32 a186, v18
    v_accvgpr_read_b32 v19, a187
    v_mul_f32 v19, v19, v253
    v_accvgpr_write_b32 a187, v19
    v_accvgpr_read_b32 v18, a188
    v_mul_f32 v18, v18, v250
    v_accvgpr_write_b32 a188, v18
    v_accvgpr_read_b32 v19, a189
    v_mul_f32 v19, v19, v251
    v_accvgpr_write_b32 a189, v19
    v_accvgpr_read_b32 v18, a190
    v_mul_f32 v18, v18, v252
    v_accvgpr_write_b32 a190, v18
    v_accvgpr_read_b32 v19, a191
    v_mul_f32 v19, v19, v253
    v_accvgpr_write_b32 a191, v19
    s_waitcnt vmcnt(0)
    s_nop 1
    v_mfma_f32_16x16x32_bf16 a[0:3], v[224:227], v[112:115], a[0:3]
    v_mfma_f32_16x16x32_bf16 a[48:51], v[228:231], v[112:115], a[48:51]
    v_mfma_f32_16x16x32_bf16 a[96:99], v[232:235], v[112:115], a[96:99]
    v_mfma_f32_16x16x32_bf16 a[144:147], v[236:239], v[112:115], a[144:147]
    v_mfma_f32_16x16x32_bf16 a[4:7], v[224:227], v[116:119], a[4:7]
    v_mfma_f32_16x16x32_bf16 a[52:55], v[228:231], v[116:119], a[52:55]
    v_mfma_f32_16x16x32_bf16 a[100:103], v[232:235], v[116:119], a[100:103]
    v_mfma_f32_16x16x32_bf16 a[148:151], v[236:239], v[116:119], a[148:151]
    v_mfma_f32_16x16x32_bf16 a[8:11], v[224:227], v[120:123], a[8:11]
    v_mfma_f32_16x16x32_bf16 a[56:59], v[228:231], v[120:123], a[56:59]
    v_mfma_f32_16x16x32_bf16 a[104:107], v[232:235], v[120:123], a[104:107]
    v_mfma_f32_16x16x32_bf16 a[152:155], v[236:239], v[120:123], a[152:155]
    v_mfma_f32_16x16x32_bf16 a[12:15], v[224:227], v[124:127], a[12:15]
    v_mfma_f32_16x16x32_bf16 a[60:63], v[228:231], v[124:127], a[60:63]
    v_mfma_f32_16x16x32_bf16 a[108:111], v[232:235], v[124:127], a[108:111]
    v_mfma_f32_16x16x32_bf16 a[156:159], v[236:239], v[124:127], a[156:159]
    v_mfma_f32_16x16x32_bf16 a[16:19], v[224:227], v[128:131], a[16:19]
    v_mfma_f32_16x16x32_bf16 a[64:67], v[228:231], v[128:131], a[64:67]
    v_mfma_f32_16x16x32_bf16 a[112:115], v[232:235], v[128:131], a[112:115]
    v_mfma_f32_16x16x32_bf16 a[160:163], v[236:239], v[128:131], a[160:163]
    v_mfma_f32_16x16x32_bf16 a[20:23], v[224:227], v[132:135], a[20:23]
    v_mfma_f32_16x16x32_bf16 a[68:71], v[228:231], v[132:135], a[68:71]
    v_mfma_f32_16x16x32_bf16 a[116:119], v[232:235], v[132:135], a[116:119]
    v_mfma_f32_16x16x32_bf16 a[164:167], v[236:239], v[132:135], a[164:167]
    v_mfma_f32_16x16x32_bf16 a[24:27], v[224:227], v[136:139], a[24:27]
    v_mfma_f32_16x16x32_bf16 a[72:75], v[228:231], v[136:139], a[72:75]
    v_mfma_f32_16x16x32_bf16 a[120:123], v[232:235], v[136:139], a[120:123]
    v_mfma_f32_16x16x32_bf16 a[168:171], v[236:239], v[136:139], a[168:171]
    v_mfma_f32_16x16x32_bf16 a[28:31], v[224:227], v[140:143], a[28:31]
    v_mfma_f32_16x16x32_bf16 a[76:79], v[228:231], v[140:143], a[76:79]
    v_mfma_f32_16x16x32_bf16 a[124:127], v[232:235], v[140:143], a[124:127]
    v_mfma_f32_16x16x32_bf16 a[172:175], v[236:239], v[140:143], a[172:175]
    v_mfma_f32_16x16x32_bf16 a[32:35], v[224:227], v[144:147], a[32:35]
    v_mfma_f32_16x16x32_bf16 a[80:83], v[228:231], v[144:147], a[80:83]
    v_mfma_f32_16x16x32_bf16 a[128:131], v[232:235], v[144:147], a[128:131]
    v_mfma_f32_16x16x32_bf16 a[176:179], v[236:239], v[144:147], a[176:179]
    v_mfma_f32_16x16x32_bf16 a[36:39], v[224:227], v[148:151], a[36:39]
    v_mfma_f32_16x16x32_bf16 a[84:87], v[228:231], v[148:151], a[84:87]
    v_mfma_f32_16x16x32_bf16 a[132:135], v[232:235], v[148:151], a[132:135]
    v_mfma_f32_16x16x32_bf16 a[180:183], v[236:239], v[148:151], a[180:183]
    v_mfma_f32_16x16x32_bf16 a[40:43], v[224:227], v[152:155], a[40:43]
    v_mfma_f32_16x16x32_bf16 a[88:91], v[228:231], v[152:155], a[88:91]
    v_mfma_f32_16x16x32_bf16 a[136:139], v[232:235], v[152:155], a[136:139]
    v_mfma_f32_16x16x32_bf16 a[184:187], v[236:239], v[152:155], a[184:187]
    v_mfma_f32_16x16x32_bf16 a[44:47], v[224:227], v[156:159], a[44:47]
    v_mfma_f32_16x16x32_bf16 a[92:95], v[228:231], v[156:159], a[92:95]
    v_mfma_f32_16x16x32_bf16 a[140:143], v[232:235], v[156:159], a[140:143]
    v_mfma_f32_16x16x32_bf16 a[188:191], v[236:239], v[156:159], a[188:191]
    s_add_u32 s48, s48, 24576
    s_cmp_lt_u32 s48, 1572864
    s_nop 7
    s_cbranch_scc1 L_slowloop
    s_nop 1
    v_mfma_f32_16x16x4_f32 v[48:51], v4, v63, 0
    v_mfma_f32_16x16x4_f32 v[52:55], v5, v63, 0
    v_mfma_f32_16x16x4_f32 v[56:59], v6, v63, 0
    v_mfma_f32_16x16x4_f32 v[128:131], v7, v63, 0
    s_nop 10
    v_rcp_f32 v48, v48
    v_rcp_f32 v49, v49
    v_rcp_f32 v50, v50
    v_rcp_f32 v51, v51
    v_rcp_f32 v52, v52
    v_rcp_f32 v53, v53
    v_rcp_f32 v54, v54
    v_rcp_f32 v55, v55
    v_rcp_f32 v56, v56
    v_rcp_f32 v57, v57
    v_rcp_f32 v58, v58
    v_rcp_f32 v59, v59
    v_rcp_f32 v128, v128
    v_rcp_f32 v129, v129
    v_rcp_f32 v130, v130
    v_rcp_f32 v131, v131
    s_nop 0
    v_accvgpr_read_b32 v64, a0
    v_accvgpr_read_b32 v65, a4
    v_accvgpr_read_b32 v66, a8
    v_accvgpr_read_b32 v67, a12
    v_accvgpr_read_b32 v68, a16
    v_accvgpr_read_b32 v69, a20
    v_accvgpr_read_b32 v70, a24
    v_accvgpr_read_b32 v71, a28
    v_accvgpr_read_b32 v72, a32
    v_accvgpr_read_b32 v73, a36
    v_accvgpr_read_b32 v74, a40
    v_accvgpr_read_b32 v75, a44
    v_pk_mul_f32 v[64:65], v[64:65], v[48:49] op_sel:[0,0] op_sel_hi:[1,0]
    v_pk_mul_f32 v[66:67], v[66:67], v[48:49] op_sel:[0,0] op_sel_hi:[1,0]
    v_pk_mul_f32 v[68:69], v[68:69], v[48:49] op_sel:[0,0] op_sel_hi:[1,0]
    v_pk_mul_f32 v[70:71], v[70:71], v[48:49] op_sel:[0,0] op_sel_hi:[1,0]
    v_pk_mul_f32 v[72:73], v[72:73], v[48:49] op_sel:[0,0] op_sel_hi:[1,0]
    v_pk_mul_f32 v[74:75], v[74:75], v[48:49] op_sel:[0,0] op_sel_hi:[1,0]
    v_cvt_pk_bf16_f32 v64, v64, v65
    v_cvt_pk_bf16_f32 v65, v66, v67
    v_cvt_pk_bf16_f32 v66, v68, v69
    v_cvt_pk_bf16_f32 v67, v70, v71
    v_cvt_pk_bf16_f32 v68, v72, v73
    v_cvt_pk_bf16_f32 v69, v74, v75
    buffer_store_dwordx4 v[64:67], v60, s[12:15], s33 offen offset:0 sc0 sc1
    buffer_store_dwordx2 v[68:69], v61, s[12:15], s33 offen offset:256 sc0 sc1
    v_accvgpr_read_b32 v76, a1
    v_accvgpr_read_b32 v77, a5
    v_accvgpr_read_b32 v78, a9
    v_accvgpr_read_b32 v79, a13
    v_accvgpr_read_b32 v80, a17
    v_accvgpr_read_b32 v81, a21
    v_accvgpr_read_b32 v82, a25
    v_accvgpr_read_b32 v83, a29
    v_accvgpr_read_b32 v84, a33
    v_accvgpr_read_b32 v85, a37
    v_accvgpr_read_b32 v86, a41
    v_accvgpr_read_b32 v87, a45
    v_pk_mul_f32 v[76:77], v[76:77], v[48:49] op_sel:[0,1] op_sel_hi:[1,1]
    v_pk_mul_f32 v[78:79], v[78:79], v[48:49] op_sel:[0,1] op_sel_hi:[1,1]
    v_pk_mul_f32 v[80:81], v[80:81], v[48:49] op_sel:[0,1] op_sel_hi:[1,1]
    v_pk_mul_f32 v[82:83], v[82:83], v[48:49] op_sel:[0,1] op_sel_hi:[1,1]
    v_pk_mul_f32 v[84:85], v[84:85], v[48:49] op_sel:[0,1] op_sel_hi:[1,1]
    v_pk_mul_f32 v[86:87], v[86:87], v[48:49] op_sel:[0,1] op_sel_hi:[1,1]
    v_cvt_pk_bf16_f32 v76, v76, v77
    v_cvt_pk_bf16_f32 v77, v78, v79
    v_cvt_pk_bf16_f32 v78, v80, v81
    v_cvt_pk_bf16_f32 v79, v82, v83
    v_cvt_pk_bf16_f32 v80, v84, v85
    v_cvt_pk_bf16_f32 v81, v86, v87
    buffer_store_dwordx4 v[76:79], v60, s[12:15], s33 offen offset:384 sc0 sc1
    buffer_store_dwordx2 v[80:81], v61, s[12:15], s33 offen offset:640 sc0 sc1
    v_accvgpr_read_b32 v88, a2
    v_accvgpr_read_b32 v89, a6
    v_accvgpr_read_b32 v90, a10
    v_accvgpr_read_b32 v91, a14
    v_accvgpr_read_b32 v92, a18
    v_accvgpr_read_b32 v93, a22
    v_accvgpr_read_b32 v94, a26
    v_accvgpr_read_b32 v95, a30
    v_accvgpr_read_b32 v96, a34
    v_accvgpr_read_b32 v97, a38
    v_accvgpr_read_b32 v98, a42
    v_accvgpr_read_b32 v99, a46
    v_pk_mul_f32 v[88:89], v[88:89], v[50:51] op_sel:[0,0] op_sel_hi:[1,0]
    v_pk_mul_f32 v[90:91], v[90:91], v[50:51] op_sel:[0,0] op_sel_hi:[1,0]
    v_pk_mul_f32 v[92:93], v[92:93], v[50:51] op_sel:[0,0] op_sel_hi:[1,0]
    v_pk_mul_f32 v[94:95], v[94:95], v[50:51] op_sel:[0,0] op_sel_hi:[1,0]
    v_pk_mul_f32 v[96:97], v[96:97], v[50:51] op_sel:[0,0] op_sel_hi:[1,0]
    v_pk_mul_f32 v[98:99], v[98:99], v[50:51] op_sel:[0,0] op_sel_hi:[1,0]
    v_cvt_pk_bf16_f32 v88, v88, v89
    v_cvt_pk_bf16_f32 v89, v90, v91
    v_cvt_pk_bf16_f32 v90, v92, v93
    v_cvt_pk_bf16_f32 v91, v94, v95
    v_cvt_pk_bf16_f32 v92, v96, v97
    v_cvt_pk_bf16_f32 v93, v98, v99
    buffer_store_dwordx4 v[88:91], v60, s[12:15], s33 offen offset:768 sc0 sc1
    buffer_store_dwordx2 v[92:93], v61, s[12:15], s33 offen offset:1024 sc0 sc1
    v_accvgpr_read_b32 v100, a3
    v_accvgpr_read_b32 v101, a7
    v_accvgpr_read_b32 v102, a11
    v_accvgpr_read_b32 v103, a15
    v_accvgpr_read_b32 v104, a19
    v_accvgpr_read_b32 v105, a23
    v_accvgpr_read_b32 v106, a27
    v_accvgpr_read_b32 v107, a31
    v_accvgpr_read_b32 v108, a35
    v_accvgpr_read_b32 v109, a39
    v_accvgpr_read_b32 v110, a43
    v_accvgpr_read_b32 v111, a47
    v_pk_mul_f32 v[100:101], v[100:101], v[50:51] op_sel:[0,1] op_sel_hi:[1,1]
    v_pk_mul_f32 v[102:103], v[102:103], v[50:51] op_sel:[0,1] op_sel_hi:[1,1]
    v_pk_mul_f32 v[104:105], v[104:105], v[50:51] op_sel:[0,1] op_sel_hi:[1,1]
    v_pk_mul_f32 v[106:107], v[106:107], v[50:51] op_sel:[0,1] op_sel_hi:[1,1]
    v_pk_mul_f32 v[108:109], v[108:109], v[50:51] op_sel:[0,1] op_sel_hi:[1,1]
    v_pk_mul_f32 v[110:111], v[110:111], v[50:51] op_sel:[0,1] op_sel_hi:[1,1]
    v_cvt_pk_bf16_f32 v100, v100, v101
    v_cvt_pk_bf16_f32 v101, v102, v103
    v_cvt_pk_bf16_f32 v102, v104, v105
    v_cvt_pk_bf16_f32 v103, v106, v107
    v_cvt_pk_bf16_f32 v104, v108, v109
    v_cvt_pk_bf16_f32 v105, v110, v111
    buffer_store_dwordx4 v[100:103], v60, s[12:15], s33 offen offset:1152 sc0 sc1
    buffer_store_dwordx2 v[104:105], v61, s[12:15], s33 offen offset:1408 sc0 sc1
    v_accvgpr_read_b32 v112, a48
    v_accvgpr_read_b32 v113, a52
    v_accvgpr_read_b32 v114, a56
    v_accvgpr_read_b32 v115, a60
    v_accvgpr_read_b32 v116, a64
    v_accvgpr_read_b32 v117, a68
    v_accvgpr_read_b32 v118, a72
    v_accvgpr_read_b32 v119, a76
    v_accvgpr_read_b32 v120, a80
    v_accvgpr_read_b32 v121, a84
    v_accvgpr_read_b32 v122, a88
    v_accvgpr_read_b32 v123, a92
    v_pk_mul_f32 v[112:113], v[112:113], v[52:53] op_sel:[0,0] op_sel_hi:[1,0]
    v_pk_mul_f32 v[114:115], v[114:115], v[52:53] op_sel:[0,0] op_sel_hi:[1,0]
    v_pk_mul_f32 v[116:117], v[116:117], v[52:53] op_sel:[0,0] op_sel_hi:[1,0]
    v_pk_mul_f32 v[118:119], v[118:119], v[52:53] op_sel:[0,0] op_sel_hi:[1,0]
    v_pk_mul_f32 v[120:121], v[120:121], v[52:53] op_sel:[0,0] op_sel_hi:[1,0]
    v_pk_mul_f32 v[122:123], v[122:123], v[52:53] op_sel:[0,0] op_sel_hi:[1,0]
    v_cvt_pk_bf16_f32 v112, v112, v113
    v_cvt_pk_bf16_f32 v113, v114, v115
    v_cvt_pk_bf16_f32 v114, v116, v117
    v_cvt_pk_bf16_f32 v115, v118, v119
    v_cvt_pk_bf16_f32 v116, v120, v121
    v_cvt_pk_bf16_f32 v117, v122, v123
    buffer_store_dwordx4 v[112:115], v60, s[12:15], s34 offen offset:0 sc0 sc1
    buffer_store_dwordx2 v[116:117], v61, s[12:15], s34 offen offset:256 sc0 sc1
    v_accvgpr_read_b32 v64, a49
    v_accvgpr_read_b32 v65, a53
    v_accvgpr_read_b32 v66, a57
    v_accvgpr_read_b32 v67, a61
    v_accvgpr_read_b32 v68, a65
    v_accvgpr_read_b32 v69, a69
    v_accvgpr_read_b32 v70, a73
    v_accvgpr_read_b32 v71, a77
    v_accvgpr_read_b32 v72, a81
    v_accvgpr_read_b32 v73, a85
    v_accvgpr_read_b32 v74, a89
    v_accvgpr_read_b32 v75, a93
    v_pk_mul_f32 v[64:65], v[64:65], v[52:53] op_sel:[0,1] op_sel_hi:[1,1]
    v_pk_mul_f32 v[66:67], v[66:67], v[52:53] op_sel:[0,1] op_sel_hi:[1,1]
    v_pk_mul_f32 v[68:69], v[68:69], v[52:53] op_sel:[0,1] op_sel_hi:[1,1]
    v_pk_mul_f32 v[70:71], v[70:71], v[52:53] op_sel:[0,1] op_sel_hi:[1,1]
    v_pk_mul_f32 v[72:73], v[72:73], v[52:53] op_sel:[0,1] op_sel_hi:[1,1]
    v_pk_mul_f32 v[74:75], v[74:75], v[52:53] op_sel:[0,1] op_sel_hi:[1,1]
    v_cvt_pk_bf16_f32 v64, v64, v65
    v_cvt_pk_bf16_f32 v65, v66, v67
    v_cvt_pk_bf16_f32 v66, v68, v69
    v_cvt_pk_bf16_f32 v67, v70, v71
    v_cvt_pk_bf16_f32 v68, v72, v73
    v_cvt_pk_bf16_f32 v69, v74, v75
    buffer_store_dwordx4 v[64:67], v60, s[12:15], s34 offen offset:384 sc0 sc1
    buffer_store_dwordx2 v[68:69], v61, s[12:15], s34 offen offset:640 sc0 sc1
    v_accvgpr_read_b32 v76, a50
    v_accvgpr_read_b32 v77, a54
    v_accvgpr_read_b32 v78, a58
    v_accvgpr_read_b32 v79, a62
    v_accvgpr_read_b32 v80, a66
    v_accvgpr_read_b32 v81, a70
    v_accvgpr_read_b32 v82, a74
    v_accvgpr_read_b32 v83, a78
    v_accvgpr_read_b32 v84, a82
    v_accvgpr_read_b32 v85, a86
    v_accvgpr_read_b32 v86, a90
    v_accvgpr_read_b32 v87, a94
    v_pk_mul_f32 v[76:77], v[76:77], v[54:55] op_sel:[0,0] op_sel_hi:[1,0]
    v_pk_mul_f32 v[78:79], v[78:79], v[54:55] op_sel:[0,0] op_sel_hi:[1,0]
    v_pk_mul_f32 v[80:81], v[80:81], v[54:55] op_sel:[0,0] op_sel_hi:[1,0]
    v_pk_mul_f32 v[82:83], v[82:83], v[54:55] op_sel:[0,0] op_sel_hi:[1,0]
    v_pk_mul_f32 v[84:85], v[84:85], v[54:55] op_sel:[0,0] op_sel_hi:[1,0]
    v_pk_mul_f32 v[86:87], v[86:87], v[54:55] op_sel:[0,0] op_sel_hi:[1,0]
    v_cvt_pk_bf16_f32 v76, v76, v77
    v_cvt_pk_bf16_f32 v77, v78, v79
    v_cvt_pk_bf16_f32 v78, v80, v81
    v_cvt_pk_bf16_f32 v79, v82, v83
    v_cvt_pk_bf16_f32 v80, v84, v85
    v_cvt_pk_bf16_f32 v81, v86, v87
    buffer_store_dwordx4 v[76:79], v60, s[12:15], s34 offen offset:768 sc0 sc1
    buffer_store_dwordx2 v[80:81], v61, s[12:15], s34 offen offset:1024 sc0 sc1
    v_accvgpr_read_b32 v88, a51
    v_accvgpr_read_b32 v89, a55
    v_accvgpr_read_b32 v90, a59
    v_accvgpr_read_b32 v91, a63
    v_accvgpr_read_b32 v92, a67
    v_accvgpr_read_b32 v93, a71
    v_accvgpr_read_b32 v94, a75
    v_accvgpr_read_b32 v95, a79
    v_accvgpr_read_b32 v96, a83
    v_accvgpr_read_b32 v97, a87
    v_accvgpr_read_b32 v98, a91
    v_accvgpr_read_b32 v99, a95
    v_pk_mul_f32 v[88:89], v[88:89], v[54:55] op_sel:[0,1] op_sel_hi:[1,1]
    v_pk_mul_f32 v[90:91], v[90:91], v[54:55] op_sel:[0,1] op_sel_hi:[1,1]
    v_pk_mul_f32 v[92:93], v[92:93], v[54:55] op_sel:[0,1] op_sel_hi:[1,1]
    v_pk_mul_f32 v[94:95], v[94:95], v[54:55] op_sel:[0,1] op_sel_hi:[1,1]
    v_pk_mul_f32 v[96:97], v[96:97], v[54:55] op_sel:[0,1] op_sel_hi:[1,1]
    v_pk_mul_f32 v[98:99], v[98:99], v[54:55] op_sel:[0,1] op_sel_hi:[1,1]
    v_cvt_pk_bf16_f32 v88, v88, v89
    v_cvt_pk_bf16_f32 v89, v90, v91
    v_cvt_pk_bf16_f32 v90, v92, v93
    v_cvt_pk_bf16_f32 v91, v94, v95
    v_cvt_pk_bf16_f32 v92, v96, v97
    v_cvt_pk_bf16_f32 v93, v98, v99
    buffer_store_dwordx4 v[88:91], v60, s[12:15], s34 offen offset:1152 sc0 sc1
    buffer_store_dwordx2 v[92:93], v61, s[12:15], s34 offen offset:1408 sc0 sc1
    v_accvgpr_read_b32 v100, a96
    v_accvgpr_read_b32 v101, a100
    v_accvgpr_read_b32 v102, a104
    v_accvgpr_read_b32 v103, a108
    v_accvgpr_read_b32 v104, a112
    v_accvgpr_read_b32 v105, a116
    v_accvgpr_read_b32 v106, a120
    v_accvgpr_read_b32 v107, a124
    v_accvgpr_read_b32 v108, a128
    v_accvgpr_read_b32 v109, a132
    v_accvgpr_read_b32 v110, a136
    v_accvgpr_read_b32 v111, a140
    v_pk_mul_f32 v[100:101], v[100:101], v[56:57] op_sel:[0,0] op_sel_hi:[1,0]
    v_pk_mul_f32 v[102:103], v[102:103], v[56:57] op_sel:[0,0] op_sel_hi:[1,0]
    v_pk_mul_f32 v[104:105], v[104:105], v[56:57] op_sel:[0,0] op_sel_hi:[1,0]
    v_pk_mul_f32 v[106:107], v[106:107], v[56:57] op_sel:[0,0] op_sel_hi:[1,0]
    v_pk_mul_f32 v[108:109], v[108:109], v[56:57] op_sel:[0,0] op_sel_hi:[1,0]
    v_pk_mul_f32 v[110:111], v[110:111], v[56:57] op_sel:[0,0] op_sel_hi:[1,0]
    v_cvt_pk_bf16_f32 v100, v100, v101
    v_cvt_pk_bf16_f32 v101, v102, v103
    v_cvt_pk_bf16_f32 v102, v104, v105
    v_cvt_pk_bf16_f32 v103, v106, v107
    v_cvt_pk_bf16_f32 v104, v108, v109
    v_cvt_pk_bf16_f32 v105, v110, v111
    buffer_store_dwordx4 v[100:103], v60, s[12:15], s35 offen offset:0 sc0 sc1
    buffer_store_dwordx2 v[104:105], v61, s[12:15], s35 offen offset:256 sc0 sc1
    v_accvgpr_read_b32 v112, a97
    v_accvgpr_read_b32 v113, a101
    v_accvgpr_read_b32 v114, a105
    v_accvgpr_read_b32 v115, a109
    v_accvgpr_read_b32 v116, a113
    v_accvgpr_read_b32 v117, a117
    v_accvgpr_read_b32 v118, a121
    v_accvgpr_read_b32 v119, a125
    v_accvgpr_read_b32 v120, a129
    v_accvgpr_read_b32 v121, a133
    v_accvgpr_read_b32 v122, a137
    v_accvgpr_read_b32 v123, a141
    v_pk_mul_f32 v[112:113], v[112:113], v[56:57] op_sel:[0,1] op_sel_hi:[1,1]
    v_pk_mul_f32 v[114:115], v[114:115], v[56:57] op_sel:[0,1] op_sel_hi:[1,1]
    v_pk_mul_f32 v[116:117], v[116:117], v[56:57] op_sel:[0,1] op_sel_hi:[1,1]
    v_pk_mul_f32 v[118:119], v[118:119], v[56:57] op_sel:[0,1] op_sel_hi:[1,1]
    v_pk_mul_f32 v[120:121], v[120:121], v[56:57] op_sel:[0,1] op_sel_hi:[1,1]
    v_pk_mul_f32 v[122:123], v[122:123], v[56:57] op_sel:[0,1] op_sel_hi:[1,1]
    v_cvt_pk_bf16_f32 v112, v112, v113
    v_cvt_pk_bf16_f32 v113, v114, v115
    v_cvt_pk_bf16_f32 v114, v116, v117
    v_cvt_pk_bf16_f32 v115, v118, v119
    v_cvt_pk_bf16_f32 v116, v120, v121
    v_cvt_pk_bf16_f32 v117, v122, v123
    buffer_store_dwordx4 v[112:115], v60, s[12:15], s35 offen offset:384 sc0 sc1
    buffer_store_dwordx2 v[116:117], v61, s[12:15], s35 offen offset:640 sc0 sc1
    v_accvgpr_read_b32 v64, a98
    v_accvgpr_read_b32 v65, a102
    v_accvgpr_read_b32 v66, a106
    v_accvgpr_read_b32 v67, a110
    v_accvgpr_read_b32 v68, a114
    v_accvgpr_read_b32 v69, a118
    v_accvgpr_read_b32 v70, a122
    v_accvgpr_read_b32 v71, a126
    v_accvgpr_read_b32 v72, a130
    v_accvgpr_read_b32 v73, a134
    v_accvgpr_read_b32 v74, a138
    v_accvgpr_read_b32 v75, a142
    v_pk_mul_f32 v[64:65], v[64:65], v[58:59] op_sel:[0,0] op_sel_hi:[1,0]
    v_pk_mul_f32 v[66:67], v[66:67], v[58:59] op_sel:[0,0] op_sel_hi:[1,0]
    v_pk_mul_f32 v[68:69], v[68:69], v[58:59] op_sel:[0,0] op_sel_hi:[1,0]
    v_pk_mul_f32 v[70:71], v[70:71], v[58:59] op_sel:[0,0] op_sel_hi:[1,0]
    v_pk_mul_f32 v[72:73], v[72:73], v[58:59] op_sel:[0,0] op_sel_hi:[1,0]
    v_pk_mul_f32 v[74:75], v[74:75], v[58:59] op_sel:[0,0] op_sel_hi:[1,0]
    v_cvt_pk_bf16_f32 v64, v64, v65
    v_cvt_pk_bf16_f32 v65, v66, v67
    v_cvt_pk_bf16_f32 v66, v68, v69
    v_cvt_pk_bf16_f32 v67, v70, v71
    v_cvt_pk_bf16_f32 v68, v72, v73
    v_cvt_pk_bf16_f32 v69, v74, v75
    buffer_store_dwordx4 v[64:67], v60, s[12:15], s35 offen offset:768 sc0 sc1
    buffer_store_dwordx2 v[68:69], v61, s[12:15], s35 offen offset:1024 sc0 sc1
    v_accvgpr_read_b32 v76, a99
    v_accvgpr_read_b32 v77, a103
    v_accvgpr_read_b32 v78, a107
    v_accvgpr_read_b32 v79, a111
    v_accvgpr_read_b32 v80, a115
    v_accvgpr_read_b32 v81, a119
    v_accvgpr_read_b32 v82, a123
    v_accvgpr_read_b32 v83, a127
    v_accvgpr_read_b32 v84, a131
    v_accvgpr_read_b32 v85, a135
    v_accvgpr_read_b32 v86, a139
    v_accvgpr_read_b32 v87, a143
    v_pk_mul_f32 v[76:77], v[76:77], v[58:59] op_sel:[0,1] op_sel_hi:[1,1]
    v_pk_mul_f32 v[78:79], v[78:79], v[58:59] op_sel:[0,1] op_sel_hi:[1,1]
    v_pk_mul_f32 v[80:81], v[80:81], v[58:59] op_sel:[0,1] op_sel_hi:[1,1]
    v_pk_mul_f32 v[82:83], v[82:83], v[58:59] op_sel:[0,1] op_sel_hi:[1,1]
    v_pk_mul_f32 v[84:85], v[84:85], v[58:59] op_sel:[0,1] op_sel_hi:[1,1]
    v_pk_mul_f32 v[86:87], v[86:87], v[58:59] op_sel:[0,1] op_sel_hi:[1,1]
    v_cvt_pk_bf16_f32 v76, v76, v77
    v_cvt_pk_bf16_f32 v77, v78, v79
    v_cvt_pk_bf16_f32 v78, v80, v81
    v_cvt_pk_bf16_f32 v79, v82, v83
    v_cvt_pk_bf16_f32 v80, v84, v85
    v_cvt_pk_bf16_f32 v81, v86, v87
    buffer_store_dwordx4 v[76:79], v60, s[12:15], s35 offen offset:1152 sc0 sc1
    buffer_store_dwordx2 v[80:81], v61, s[12:15], s35 offen offset:1408 sc0 sc1
    v_accvgpr_read_b32 v88, a144
    v_accvgpr_read_b32 v89, a148
    v_accvgpr_read_b32 v90, a152
    v_accvgpr_read_b32 v91, a156
    v_accvgpr_read_b32 v92, a160
    v_accvgpr_read_b32 v93, a164
    v_accvgpr_read_b32 v94, a168
    v_accvgpr_read_b32 v95, a172
    v_accvgpr_read_b32 v96, a176
    v_accvgpr_read_b32 v97, a180
    v_accvgpr_read_b32 v98, a184
    v_accvgpr_read_b32 v99, a188
    v_pk_mul_f32 v[88:89], v[88:89], v[128:129] op_sel:[0,0] op_sel_hi:[1,0]
    v_pk_mul_f32 v[90:91], v[90:91], v[128:129] op_sel:[0,0] op_sel_hi:[1,0]
    v_pk_mul_f32 v[92:93], v[92:93], v[128:129] op_sel:[0,0] op_sel_hi:[1,0]
    v_pk_mul_f32 v[94:95], v[94:95], v[128:129] op_sel:[0,0] op_sel_hi:[1,0]
    v_pk_mul_f32 v[96:97], v[96:97], v[128:129] op_sel:[0,0] op_sel_hi:[1,0]
    v_pk_mul_f32 v[98:99], v[98:99], v[128:129] op_sel:[0,0] op_sel_hi:[1,0]
    v_cvt_pk_bf16_f32 v88, v88, v89
    v_cvt_pk_bf16_f32 v89, v90, v91
    v_cvt_pk_bf16_f32 v90, v92, v93
    v_cvt_pk_bf16_f32 v91, v94, v95
    v_cvt_pk_bf16_f32 v92, v96, v97
    v_cvt_pk_bf16_f32 v93, v98, v99
    buffer_store_dwordx4 v[88:91], v60, s[12:15], s36 offen offset:0 sc0 sc1
    buffer_store_dwordx2 v[92:93], v61, s[12:15], s36 offen offset:256 sc0 sc1
    v_accvgpr_read_b32 v100, a145
    v_accvgpr_read_b32 v101, a149
    v_accvgpr_read_b32 v102, a153
    v_accvgpr_read_b32 v103, a157
    v_accvgpr_read_b32 v104, a161
    v_accvgpr_read_b32 v105, a165
    v_accvgpr_read_b32 v106, a169
    v_accvgpr_read_b32 v107, a173
    v_accvgpr_read_b32 v108, a177
    v_accvgpr_read_b32 v109, a181
    v_accvgpr_read_b32 v110, a185
    v_accvgpr_read_b32 v111, a189
    v_pk_mul_f32 v[100:101], v[100:101], v[128:129] op_sel:[0,1] op_sel_hi:[1,1]
    v_pk_mul_f32 v[102:103], v[102:103], v[128:129] op_sel:[0,1] op_sel_hi:[1,1]
    v_pk_mul_f32 v[104:105], v[104:105], v[128:129] op_sel:[0,1] op_sel_hi:[1,1]
    v_pk_mul_f32 v[106:107], v[106:107], v[128:129] op_sel:[0,1] op_sel_hi:[1,1]
    v_pk_mul_f32 v[108:109], v[108:109], v[128:129] op_sel:[0,1] op_sel_hi:[1,1]
    v_pk_mul_f32 v[110:111], v[110:111], v[128:129] op_sel:[0,1] op_sel_hi:[1,1]
    v_cvt_pk_bf16_f32 v100, v100, v101
    v_cvt_pk_bf16_f32 v101, v102, v103
    v_cvt_pk_bf16_f32 v102, v104, v105
    v_cvt_pk_bf16_f32 v103, v106, v107
    v_cvt_pk_bf16_f32 v104, v108, v109
    v_cvt_pk_bf16_f32 v105, v110, v111
    buffer_store_dwordx4 v[100:103], v60, s[12:15], s36 offen offset:384 sc0 sc1
    buffer_store_dwordx2 v[104:105], v61, s[12:15], s36 offen offset:640 sc0 sc1
    v_accvgpr_read_b32 v112, a146
    v_accvgpr_read_b32 v113, a150
    v_accvgpr_read_b32 v114, a154
    v_accvgpr_read_b32 v115, a158
    v_accvgpr_read_b32 v116, a162
    v_accvgpr_read_b32 v117, a166
    v_accvgpr_read_b32 v118, a170
    v_accvgpr_read_b32 v119, a174
    v_accvgpr_read_b32 v120, a178
    v_accvgpr_read_b32 v121, a182
    v_accvgpr_read_b32 v122, a186
    v_accvgpr_read_b32 v123, a190
    v_pk_mul_f32 v[112:113], v[112:113], v[130:131] op_sel:[0,0] op_sel_hi:[1,0]
    v_pk_mul_f32 v[114:115], v[114:115], v[130:131] op_sel:[0,0] op_sel_hi:[1,0]
    v_pk_mul_f32 v[116:117], v[116:117], v[130:131] op_sel:[0,0] op_sel_hi:[1,0]
    v_pk_mul_f32 v[118:119], v[118:119], v[130:131] op_sel:[0,0] op_sel_hi:[1,0]
    v_pk_mul_f32 v[120:121], v[120:121], v[130:131] op_sel:[0,0] op_sel_hi:[1,0]
    v_pk_mul_f32 v[122:123], v[122:123], v[130:131] op_sel:[0,0] op_sel_hi:[1,0]
    v_cvt_pk_bf16_f32 v112, v112, v113
    v_cvt_pk_bf16_f32 v113, v114, v115
    v_cvt_pk_bf16_f32 v114, v116, v117
    v_cvt_pk_bf16_f32 v115, v118, v119
    v_cvt_pk_bf16_f32 v116, v120, v121
    v_cvt_pk_bf16_f32 v117, v122, v123
    buffer_store_dwordx4 v[112:115], v60, s[12:15], s36 offen offset:768 sc0 sc1
    buffer_store_dwordx2 v[116:117], v61, s[12:15], s36 offen offset:1024 sc0 sc1
    v_accvgpr_read_b32 v64, a147
    v_accvgpr_read_b32 v65, a151
    v_accvgpr_read_b32 v66, a155
    v_accvgpr_read_b32 v67, a159
    v_accvgpr_read_b32 v68, a163
    v_accvgpr_read_b32 v69, a167
    v_accvgpr_read_b32 v70, a171
    v_accvgpr_read_b32 v71, a175
    v_accvgpr_read_b32 v72, a179
    v_accvgpr_read_b32 v73, a183
    v_accvgpr_read_b32 v74, a187
    v_accvgpr_read_b32 v75, a191
    v_pk_mul_f32 v[64:65], v[64:65], v[130:131] op_sel:[0,1] op_sel_hi:[1,1]
    v_pk_mul_f32 v[66:67], v[66:67], v[130:131] op_sel:[0,1] op_sel_hi:[1,1]
    v_pk_mul_f32 v[68:69], v[68:69], v[130:131] op_sel:[0,1] op_sel_hi:[1,1]
    v_pk_mul_f32 v[70:71], v[70:71], v[130:131] op_sel:[0,1] op_sel_hi:[1,1]
    v_pk_mul_f32 v[72:73], v[72:73], v[130:131] op_sel:[0,1] op_sel_hi:[1,1]
    v_pk_mul_f32 v[74:75], v[74:75], v[130:131] op_sel:[0,1] op_sel_hi:[1,1]
    v_cvt_pk_bf16_f32 v64, v64, v65
    v_cvt_pk_bf16_f32 v65, v66, v67
    v_cvt_pk_bf16_f32 v66, v68, v69
    v_cvt_pk_bf16_f32 v67, v70, v71
    v_cvt_pk_bf16_f32 v68, v72, v73
    v_cvt_pk_bf16_f32 v69, v74, v75
    buffer_store_dwordx4 v[64:67], v60, s[12:15], s36 offen offset:1152 sc0 sc1
    buffer_store_dwordx2 v[68:69], v61, s[12:15], s36 offen offset:1408 sc0 sc1
    s_branch L_fin
.section .rodata,"a"
.p2align 6
.amdhsa_kernel standalone__kv_cache_quant_int4_int2_kv_with_per_channel_or_per_token_scales__prompt_kernel
  .amdhsa_next_free_vgpr 512
  .amdhsa_next_free_sgpr 102
  .amdhsa_accum_offset 256
  .amdhsa_group_segment_fixed_size 0
  .amdhsa_kernarg_size 80
  .amdhsa_user_sgpr_count 2
  .amdhsa_user_sgpr_kernarg_segment_ptr 1
  .amdhsa_system_sgpr_workgroup_id_x 1
.end_amdhsa_kernel
```

```asm
; @launch grid=(256,1,1) block=(256,1,1) lds=161920
.amdgcn_target "amdgcn-amd-amdhsa--gfx950"
.text
.globl standalone__kv_cache_quant_int4_int2_kv_with_per_channel_or_per_token_scales__prompt_kernel
.p2align 8
.type standalone__kv_cache_quant_int4_int2_kv_with_per_channel_or_per_token_scales__prompt_kernel,@function
standalone__kv_cache_quant_int4_int2_kv_with_per_channel_or_per_token_scales__prompt_kernel:
    s_load_dwordx16 s[40:55], s[0:1], 0
    s_getpc_b64 s[60:61]
L_pc:
    s_movk_i32 s62, 0x4000
    s_lshl_b32 s63, 1, 17
    v_lshlrev_b32 v31, 6, v0
    buffer_load_dword v15, v31, s[60:63], 0 offen
    s_lshr_b32 s24, s2, 8
    s_cbranch_scc1 L_done
    s_load_dwordx4 s[16:19], s[0:1], 64
    v_lshlrev_b32 v30, 4, v0
    v_and_b32 v25, 63, v0
    v_lshrrev_b32 v24, 6, v0
    s_movk_i32 s24, 5120
    v_mul_u32_u24 v26, 43, v25
    v_mad_u32_u24 v12, v24, s24, v30
    s_movk_i32 s24, 384
    v_lshrrev_b32 v26, 10, v26
    s_and_b32 s22, s2, 7
    s_mul_i32 s29, s22, 264
    v_mad_u32_u24 v9, v26, s24, v12
    s_andn2_b32 s23, s2, 63
    s_bfe_u32 s95, s2, 0x30003
    s_add_u32 s29, s29, s23
    s_add_u32 s29, s29, s95
    s_lshr_b32 s23, s29, 1
    s_mulk_i32 s23, 384
    s_mul_i32 s24, s29, 24576
    v_lshl_add_u32 v27, v25, 3, s23
    s_addk_i32 s24, 2048
    s_mov_b32 exec_hi, 0xffff
    s_waitcnt lgkmcnt(0)
    global_load_dwordx2 v[32:33], v27, s[46:47]
    global_load_dwordx2 v[34:35], v27, s[48:49]
    s_add_u32 s56, s42, s24
    s_addc_u32 s57, s43, 0
    global_load_dwordx4 v[64:67], v9, s[56:57] offset:-2048 nt
    global_load_dwordx4 v[68:71], v9, s[56:57] offset:-512 nt
    global_load_dwordx4 v[72:75], v9, s[56:57] offset:1024 nt
    global_load_dwordx4 v[76:79], v9, s[56:57] offset:2560 nt
    global_load_dwordx4 v[80:83], v9, s[56:57] offset:-1664 nt
    global_load_dwordx4 v[84:87], v9, s[56:57] offset:-128 nt
    global_load_dwordx4 v[88:91], v9, s[56:57] offset:1408 nt
    global_load_dwordx4 v[92:95], v9, s[56:57] offset:2944 nt
    s_add_u32 s58, s44, s24
    s_addc_u32 s59, s45, 0
    global_load_dwordx4 v[96:99], v12, s[58:59] offset:-2048 nt
    global_load_dwordx4 v[100:103], v12, s[58:59] offset:-1280 nt
    global_load_dwordx4 v[104:107], v12, s[58:59] offset:-512 nt
    global_load_dwordx4 v[108:111], v12, s[58:59] offset:256 nt
    v_readfirstlane_b32 s25, v24
    s_lshl_b32 s23, s29, 6
    s_lshr_b32 s94, s29, 6
    s_lshl4_add_u32 s23, s25, s23
    s_load_dwordx4 s[64:67], s[50:51], s23
    s_load_dwordx4 s[68:71], s[52:53], s23
    s_lshl_b32 s22, s94, 10
    s_add_u32 s22, s22, 67108864
    s_or_b32 s83, s95, s25
    s_cbranch_scc1 L_notleader0
    s_load_dwordx8 s[72:79], s[18:19], s22 glc
L_notleader0:
    s_mov_b32 exec_hi, -1
    s_mov_b32 exec_hi, 0xffff
    global_load_dwordx4 v[112:115], v12, s[58:59] offset:1024 nt
    s_mov_b32 exec_hi, -1
    s_mul_i32 s24, s94, 786432
    s_add_u32 s8, s40, s24
    s_addc_u32 s9, s41, 0
    s_mov_b32 s10, 786432
    s_mov_b32 s11, 0x20000
    s_add_u32 s12, s54, s24
    s_addc_u32 s13, s55, 0
    s_mov_b32 s14, 786432
    s_mov_b32 s15, 0x20000
    s_lshl2_add_u32 s24, s95, s25
    s_mul_i32 s24, s24, 24576
    s_mul_i32 s82, s25, 6144
    s_add_u32 s82, s82, 73728
    v_add_u32 v208, 0, v25
    v_add_u32 v209, 64, v25
    v_add_u32 v210, 128, v25
    v_add_u32 v211, 192, v25
    v_add_u32 v212, 256, v25
    v_add_u32 v213, 320, v25
    v_mul_u32_u24 v216, 2731, v208
    v_mul_u32_u24 v217, 2731, v209
    v_mul_u32_u24 v218, 2731, v210
    v_mul_u32_u24 v219, 2731, v211
    v_mul_u32_u24 v220, 2731, v212
    s_mov_b32 exec_hi, 0xffff
    global_load_dwordx4 v[116:119], v12, s[58:59] offset:1792 nt
    s_mov_b32 exec_hi, -1
    v_mul_u32_u24 v221, 2731, v213
    v_bfe_u32 v216, v216, 17, 3
    v_bfe_u32 v217, v217, 17, 3
    v_bfe_u32 v218, v218, 17, 3
    v_bfe_u32 v219, v219, 17, 3
    v_bfe_u32 v220, v220, 17, 3
    v_bfe_u32 v221, v221, 17, 3
    v_xor_b32 v208, v208, v216
    v_xor_b32 v209, v209, v217
    v_xor_b32 v210, v210, v218
    v_xor_b32 v211, v211, v219
    v_xor_b32 v212, v212, v220
    v_xor_b32 v213, v213, v221
    v_lshl_add_u32 v208, v208, 4, s24
    v_lshl_add_u32 v209, v209, 4, s24
    v_lshl_add_u32 v210, v210, 4, s24
    v_lshl_add_u32 v211, v211, 4, s24
    v_lshl_add_u32 v212, v212, 4, s24
    v_lshl_add_u32 v213, v213, 4, s24
    v_mov_b32 v16, 0
    v_mov_b32 v17, 147456
    ds_write_b32 v17, v16
    s_mov_b32 s97, 0xffff0000
    s_mov_b32 s38, 0x3dd53b95
    v_mul_u32_u24 v27, 24, v26
    s_mov_b32 exec_hi, 0xffff
    global_load_dwordx4 v[120:123], v12, s[58:59] offset:2560 nt
    s_mov_b32 exec_hi, -1
    v_sub_u32 v27, v25, v27
    v_lshlrev_b32 v10, 4, v27
    v_add_u32 v10, 147584, v10
    v_mul_u32_u24 v36, 768, v26
    v_add_u32 v36, v36, v10
    s_waitcnt vmcnt(15)
    v_lshlrev_b32 v128, 16, v32
    v_and_b32 v129, s97, v32
    v_lshlrev_b32 v130, 16, v34
    v_and_b32 v131, s97, v34
    v_lshlrev_b32 v132, 16, v33
    v_and_b32 v133, s97, v33
    v_lshlrev_b32 v134, 16, v35
    v_and_b32 v135, s97, v35
    v_mul_f32 v128, s38, v128
    v_mul_f32 v129, s38, v129
    v_mul_f32 v132, s38, v132
    v_mul_f32 v133, s38, v133
    v_mul_f32_e64 v130, -v130, v128
    v_mul_f32_e64 v131, -v131, v129
    v_mul_f32_e64 v134, -v134, v132
    v_mul_f32_e64 v135, -v135, v133
    s_mov_b32 exec_hi, 0xffff
    ds_write_b128 v36, v[128:131] offset:0
    ds_write_b128 v36, v[132:135] offset:384
    s_mov_b32 exec_hi, -1
    ds_read_b128 v[128:131], v10 offset:0
    ds_read_b128 v[132:135], v10 offset:384
    s_mov_b32 exec_hi, 0xffff
    global_load_dwordx4 v[124:127], v12, s[58:59] offset:3328 nt
    s_mov_b32 exec_hi, -1
    ds_read_b128 v[136:139], v10 offset:768
    ds_read_b128 v[140:143], v10 offset:1152
    v_lshrrev_b32 v48, 1, v26
    v_lshlrev_b32 v48, 30, v48
    v_lshlrev_b32 v31, 4, v25
    v_mul_u32_u24 v30, 3072, v24
    v_add_u32 v8, v30, v31
    v_lshl_add_u32 v49, v24, 2, v26
    v_mul_u32_u24 v49, 384, v49
    v_lshlrev_b32 v50, 1, v24
    v_xor_b32 v50, v27, v50
    v_lshl_add_u32 v49, v50, 4, v49
    v_or_b32 v11, v49, v48
    v_xor_b32 v54, 16, v11
    v_lshrrev_b32 v49, 5, v25
    v_sub_u32 v49, 1, v49
    v_and_b32 v49, v49, v24
    v_lshlrev_b32 v49, 4, v49
    v_xor_b32 v49, v49, v8
    v_add_u32 v49, 12288, v49
    v_or_b32 v20, v49, v48
    s_mul_i32 s37, s95, 24576
    s_add_u32 s80, s37, 6144
    s_mov_b32 s81, s37
    s_mul_i32 s39, s94, 1769472
    s_mov_b32 s62, L_slow-L_pc
    s_bfe_u32 s24, s2, 0x20003
    s_add_u32 s24, s24, 1
    s_lshl_b32 s24, s24, 14
    v_lshlrev_b32 v15, 6, v0
    buffer_load_dword v15, v15, s[60:63], s24 offen
    v_or_b32 v9, v9, v48
    v_or_b32 v12, v12, v48
    s_waitcnt lgkmcnt(0)
    s_barrier
    s_add_u32 s4, s18, s39
    s_addc_u32 s5, s19, 0
    s_mov_b32 s6, 1572864
    s_mov_b32 s7, 0x20000
    s_add_u32 s20, s18, s22
    s_addc_u32 s21, s19, 0
    s_mov_b32 s22, 32
    s_mov_b32 s23, 0x20000
    s_mov_b32 s88, s16
    s_mov_b32 s89, s17
    s_movk_i32 s90, 256
    s_mov_b32 s91, s63
    s_lshl_b32 s93, s94, 3
    s_cmp_lg_u32 s83, 0
    s_cbranch_scc1 L_notleader
    s_mov_b32 s24, 1
    s_lshr_b32 s72, s72, 8
    s_min_u32 s72, s72, 31
    s_bitset1_b32 s24, s72
    s_lshr_b32 s73, s73, 8
    s_min_u32 s73, s73, 31
    s_bitset1_b32 s24, s73
    s_lshr_b32 s74, s74, 8
    s_min_u32 s74, s74, 31
    s_bitset1_b32 s24, s74
    s_lshr_b32 s75, s75, 8
    s_min_u32 s75, s75, 31
    s_bitset1_b32 s24, s75
    s_lshr_b32 s76, s76, 8
    s_min_u32 s76, s76, 31
    s_bitset1_b32 s24, s76
    s_lshr_b32 s77, s77, 8
    s_min_u32 s77, s77, 31
    s_bitset1_b32 s24, s77
    s_lshr_b32 s78, s78, 8
    s_min_u32 s78, s78, 31
    s_bitset1_b32 s24, s78
    s_lshr_b32 s79, s79, 8
    s_min_u32 s79, s79, 31
    s_bitset1_b32 s24, s79
    s_ff0_i32_b32 s24, s24
    s_lshl_b32 s24, s24, 8
    v_mov_b32 v52, s24
    s_mov_b64 exec, 1
    buffer_store_dword v52, off, s[88:91], s93 sc1
    s_mov_b64 exec, -1
L_notleader:
    s_add_u32 m0, s82, 0
    s_movk_i32 s24, 0
    buffer_load_dwordx4 v208, s[8:11], s24 offen nt lds
    s_waitcnt vmcnt(16)
    v_cvt_f32_i32 v64, v64
    v_cvt_f32_i32 v65, v65
    v_cvt_f32_i32 v68, v68
    v_cvt_f32_i32 v69, v69
    v_fma_f32 v64, v64, v128, v130
    v_fma_f32 v65, v65, v129, v131
    v_fma_f32 v68, v68, v128, v130
    v_fma_f32 v69, v69, v129, v131
    v_cvt_pk_bf16_f32 v64, v64, v65
    v_cvt_pk_bf16_f32 v68, v68, v69
    v_cvt_f32_i32 v66, v66
    v_cvt_f32_i32 v67, v67
    v_cvt_f32_i32 v70, v70
    v_cvt_f32_i32 v71, v71
    v_fma_f32 v66, v66, v132, v134
    v_fma_f32 v67, v67, v133, v135
    v_fma_f32 v70, v70, v132, v134
    v_fma_f32 v71, v71, v133, v135
    v_cvt_pk_bf16_f32 v65, v66, v67
    v_cvt_pk_bf16_f32 v69, v70, v71
    s_waitcnt vmcnt(14)
    v_cvt_f32_i32 v72, v72
    v_cvt_f32_i32 v73, v73
    v_cvt_f32_i32 v76, v76
    v_cvt_f32_i32 v77, v77
    v_fma_f32 v72, v72, v128, v130
    v_fma_f32 v73, v73, v129, v131
    s_add_u32 m0, s82, 1024
    s_movk_i32 s24, 0
    buffer_load_dwordx4 v209, s[8:11], s24 offen nt lds
    v_fma_f32 v76, v76, v128, v130
    v_fma_f32 v77, v77, v129, v131
    v_cvt_pk_bf16_f32 v72, v72, v73
    v_cvt_pk_bf16_f32 v76, v76, v77
    v_cvt_f32_i32 v74, v74
    v_cvt_f32_i32 v75, v75
    v_cvt_f32_i32 v78, v78
    v_cvt_f32_i32 v79, v79
    v_fma_f32 v74, v74, v132, v134
    v_fma_f32 v75, v75, v133, v135
    v_fma_f32 v78, v78, v132, v134
    v_fma_f32 v79, v79, v133, v135
    v_cvt_pk_bf16_f32 v73, v74, v75
    v_cvt_pk_bf16_f32 v77, v78, v79
    s_waitcnt vmcnt(13)
    v_cvt_f32_i32 v80, v80
    v_cvt_f32_i32 v81, v81
    v_cvt_f32_i32 v84, v84
    v_cvt_f32_i32 v85, v85
    v_fma_f32 v80, v80, v136, v138
    v_fma_f32 v81, v81, v137, v139
    v_fma_f32 v84, v84, v136, v138
    v_fma_f32 v85, v85, v137, v139
    v_cvt_pk_bf16_f32 v66, v80, v81
    v_cvt_pk_bf16_f32 v70, v84, v85
    v_cvt_f32_i32 v82, v82
    v_cvt_f32_i32 v83, v83
    v_cvt_f32_i32 v86, v86
    s_add_u32 m0, s82, 2048
    s_movk_i32 s24, 0
    buffer_load_dwordx4 v210, s[8:11], s24 offen nt lds
    v_cvt_f32_i32 v87, v87
    v_fma_f32 v82, v82, v140, v142
    v_fma_f32 v83, v83, v141, v143
    v_fma_f32 v86, v86, v140, v142
    v_fma_f32 v87, v87, v141, v143
    v_cvt_pk_bf16_f32 v67, v82, v83
    v_cvt_pk_bf16_f32 v71, v86, v87
    s_waitcnt vmcnt(12)
    v_cvt_f32_i32 v88, v88
    v_cvt_f32_i32 v89, v89
    v_cvt_f32_i32 v92, v92
    v_cvt_f32_i32 v93, v93
    v_fma_f32 v88, v88, v136, v138
    v_fma_f32 v89, v89, v137, v139
    v_fma_f32 v92, v92, v136, v138
    v_fma_f32 v93, v93, v137, v139
    v_cvt_pk_bf16_f32 v74, v88, v89
    v_cvt_pk_bf16_f32 v78, v92, v93
    v_cvt_f32_i32 v90, v90
    v_cvt_f32_i32 v91, v91
    v_cvt_f32_i32 v94, v94
    v_cvt_f32_i32 v95, v95
    v_fma_f32 v90, v90, v140, v142
    v_fma_f32 v91, v91, v141, v143
    v_fma_f32 v94, v94, v140, v142
    v_fma_f32 v95, v95, v141, v143
    v_cvt_pk_bf16_f32 v75, v90, v91
    v_cvt_pk_bf16_f32 v79, v94, v95
    buffer_store_dwordx4 v[64:67], v11, s[4:7], s37 offen offset:0 sc1
    buffer_store_dwordx4 v[68:71], v54, s[4:7], s37 offen offset:768 sc1
    buffer_store_dwordx4 v[72:75], v11, s[4:7], s80 offen offset:0 sc1
    buffer_store_dwordx4 v[76:79], v54, s[4:7], s80 offen offset:768 sc1
    s_mov_b32 exec_hi, 0xffff
    ds_write_b128 v11, v[64:67] offset:0
    ds_write_b128 v54, v[68:71] offset:768
    ds_write_b128 v11, v[72:75] offset:6144
    ds_write_b128 v54, v[76:79] offset:6912
    s_mov_b32 exec_hi, -1
    s_add_u32 m0, s82, 3072
    s_movk_i32 s24, 0
    buffer_load_dwordx4 v211, s[8:11], s24 offen nt lds
    s_lshl_b32 s57, s64, 16
    s_and_b32 s58, s64, s97
    v_mov_b32 v128, s57
    v_mov_b32 v129, s58
    s_lshl_b32 s57, s68, 16
    s_and_b32 s58, s68, s97
    v_mul_f32_e64 v130, -s57, v128
    v_mul_f32_e64 v131, -s58, v129
    s_lshl_b32 s57, s65, 16
    s_and_b32 s58, s65, s97
    v_mov_b32 v132, s57
    v_mov_b32 v133, s58
    s_lshl_b32 s57, s69, 16
    s_and_b32 s58, s69, s97
    v_mul_f32_e64 v134, -s57, v132
    v_mul_f32_e64 v135, -s58, v133
    s_lshl_b32 s57, s66, 16
    s_and_b32 s58, s66, s97
    v_mov_b32 v136, s57
    v_mov_b32 v137, s58
    s_lshl_b32 s57, s70, 16
    s_and_b32 s58, s70, s97
    v_mul_f32_e64 v138, -s57, v136
    v_mul_f32_e64 v139, -s58, v137
    s_lshl_b32 s57, s67, 16
    s_and_b32 s58, s67, s97
    v_mov_b32 v140, s57
    v_mov_b32 v141, s58
    s_lshl_b32 s57, s71, 16
    s_and_b32 s58, s71, s97
    v_mul_f32_e64 v142, -s57, v140
    v_mul_f32_e64 v143, -s58, v141
    s_waitcnt vmcnt(15)
    v_cvt_f32_i32 v96, v96
    v_cvt_f32_i32 v100, v100
    v_cvt_f32_i32 v97, v97
    v_cvt_f32_i32 v101, v101
    v_fma_f32 v96, v96, v128, v130
    s_add_u32 m0, s82, 4096
    s_movk_i32 s24, 0
    buffer_load_dwordx4 v212, s[8:11], s24 offen nt lds
    v_fma_f32 v100, v100, v129, v131
    v_fma_f32 v97, v97, v128, v130
    v_fma_f32 v101, v101, v129, v131
    v_cvt_f32_i32 v98, v98
    v_cvt_f32_i32 v102, v102
    v_cvt_f32_i32 v99, v99
    v_cvt_f32_i32 v103, v103
    v_fma_f32 v98, v98, v128, v130
    v_fma_f32 v102, v102, v129, v131
    v_fma_f32 v99, v99, v128, v130
    v_fma_f32 v103, v103, v129, v131
    s_waitcnt vmcnt(14)
    v_cvt_f32_i32 v104, v104
    v_cvt_f32_i32 v108, v108
    v_cvt_f32_i32 v105, v105
    v_cvt_f32_i32 v109, v109
    v_fma_f32 v104, v104, v132, v134
    v_fma_f32 v108, v108, v133, v135
    v_fma_f32 v105, v105, v132, v134
    v_fma_f32 v109, v109, v133, v135
    v_cvt_f32_i32 v106, v106
    v_cvt_f32_i32 v110, v110
    v_cvt_f32_i32 v107, v107
    v_cvt_f32_i32 v111, v111
    v_fma_f32 v106, v106, v132, v134
    v_fma_f32 v110, v110, v133, v135
    v_fma_f32 v107, v107, v132, v134
    v_fma_f32 v111, v111, v133, v135
    v_cvt_pk_bf16_f32 v96, v96, v100
    v_cvt_pk_bf16_f32 v100, v97, v101
    v_cvt_pk_bf16_f32 v97, v104, v108
    v_cvt_pk_bf16_f32 v101, v105, v109
    v_cvt_pk_bf16_f32 v104, v98, v102
    v_cvt_pk_bf16_f32 v105, v106, v110
    v_cvt_pk_bf16_f32 v108, v99, v103
    v_cvt_pk_bf16_f32 v109, v107, v111
    s_waitcnt vmcnt(12)
    v_cvt_f32_i32 v112, v112
    v_cvt_f32_i32 v116, v116
    s_add_u32 m0, s82, 5120
    s_movk_i32 s24, 0
    buffer_load_dwordx4 v213, s[8:11], s24 offen nt lds
    v_cvt_f32_i32 v113, v113
    v_cvt_f32_i32 v117, v117
    v_fma_f32 v112, v112, v136, v138
    v_fma_f32 v116, v116, v137, v139
    v_fma_f32 v113, v113, v136, v138
    v_fma_f32 v117, v117, v137, v139
    v_cvt_f32_i32 v114, v114
    v_cvt_f32_i32 v118, v118
    v_cvt_f32_i32 v115, v115
    v_cvt_f32_i32 v119, v119
    v_fma_f32 v114, v114, v136, v138
    v_fma_f32 v118, v118, v137, v139
    v_fma_f32 v115, v115, v136, v138
    v_fma_f32 v119, v119, v137, v139
    s_waitcnt vmcnt(11)
    v_cvt_f32_i32 v120, v120
    v_cvt_f32_i32 v124, v124
    v_cvt_f32_i32 v121, v121
    v_cvt_f32_i32 v125, v125
    v_fma_f32 v120, v120, v140, v142
    v_fma_f32 v124, v124, v141, v143
    v_fma_f32 v121, v121, v140, v142
    v_fma_f32 v125, v125, v141, v143
    v_cvt_f32_i32 v122, v122
    v_cvt_f32_i32 v126, v126
    v_cvt_f32_i32 v123, v123
    v_cvt_f32_i32 v127, v127
    v_fma_f32 v122, v122, v140, v142
    v_fma_f32 v126, v126, v141, v143
    v_fma_f32 v123, v123, v140, v142
    v_fma_f32 v127, v127, v141, v143
    v_cvt_pk_bf16_f32 v98, v112, v116
    v_cvt_pk_bf16_f32 v102, v113, v117
    v_cvt_pk_bf16_f32 v99, v120, v124
    v_cvt_pk_bf16_f32 v103, v121, v125
    v_cvt_pk_bf16_f32 v106, v114, v118
    v_cvt_pk_bf16_f32 v107, v122, v126
    v_cvt_pk_bf16_f32 v110, v115, v119
    v_cvt_pk_bf16_f32 v111, v123, v127
    buffer_store_dwordx4 v[96:99], v20, s[4:7], s81 offen offset:0 sc1
    buffer_store_dwordx4 v[100:103], v20, s[4:7], s81 offen offset:768 sc1
    buffer_store_dwordx4 v[104:107], v20, s[4:7], s81 offen offset:1536 sc1
    buffer_store_dwordx4 v[108:111], v20, s[4:7], s81 offen offset:2304 sc1
    s_mov_b32 exec_hi, 0xffff
    ds_write_b128 v20, v[96:99] offset:12288
    ds_write_b128 v20, v[100:103] offset:13056
    ds_write_b128 v20, v[104:107] offset:13824
    ds_write_b128 v20, v[108:111] offset:14592
    s_mov_b32 exec_hi, -1
    v_mov_b32 v52, 0
    buffer_load_dword v52, off, s[88:91], s93 sc1
    s_lshl_b32 s39, s95, 2
    v_lshl_add_u32 v13, v0, 2, s39
    v_cmp_lt_u32 vcc, 0, v0
    v_mov_b32 v30, 0x40000000
    s_mov_b32 s96, 100000
    v_cndmask_b32 v13, v13, v30, vcc
    s_mul_i32 s39, s94, 1572864
    s_add_u32 s64, s42, s39
    s_addc_u32 s65, s43, 0
    s_mov_b32 s66, 1572864
    s_mov_b32 s67, 0x20000
    s_add_u32 s68, s44, s39
    s_addc_u32 s69, s45, 0
    s_mov_b32 s70, 1572864
    s_mov_b32 s71, 0x20000
    s_waitcnt vmcnt(11)
    s_add_u32 m0, s82, 24576
    s_movk_i32 s24, 6144
    buffer_load_dwordx4 v208, s[8:11], s24 offen nt lds
    s_and_b32 s33, s29, 63
    s_mul_i32 s33, s33, 24576
    s_mov_b32 s35, s33
    s_mul_i32 s26, s25, 3072
    s_add_u32 s26, s26, 12288
    s_add_u32 s56, s26, 24576
    s_add_u32 s39, s95, 1
    s_and_b32 s39, s39, 7
    s_mul_i32 s32, s39, 24576
    s_waitcnt vmcnt(11)
    s_add_u32 m0, s82, 25600
    s_movk_i32 s24, 6144
    buffer_load_dwordx4 v209, s[8:11], s24 offen nt lds
    s_add_u32 s27, s32, 12288
    s_mov_b32 s28, 0
    s_mov_b32 s30, 24576
    v_and_b32 v26, 15, v25
    v_lshrrev_b32 v49, 4, v25
    v_bfe_u32 v28, v25, 1, 3
    v_xor_b32 v29, v49, v28
    v_mul_u32_u24 v30, 384, v26
    v_lshl_add_u32 v2, v29, 4, v30
    s_waitcnt vmcnt(11)
    s_add_u32 m0, s82, 26624
    s_movk_i32 s24, 6144
    buffer_load_dwordx4 v210, s[8:11], s24 offen nt lds
    v_xor_b32 v3, 64, v2
    v_mul_u32_u24 v50, 3072, v49
    v_add_u32 v50, 24576, v50
    v_and_b32 v51, 1, v49
    v_lshl_add_u32 v51, v26, 1, v51
    v_lshl_add_u32 v1, v51, 4, v50
    v_xor_b32 v21, 16, v1
    v_lshl_add_u32 v22, v26, 4, v50
    v_add_u32 v22, 512, v22
    s_waitcnt vmcnt(11)
    s_add_u32 m0, s82, 27648
    s_movk_i32 s24, 6144
    buffer_load_dwordx4 v211, s[8:11], s24 offen nt lds
    v_lshrrev_b32 v29, 1, v49
    v_xor_b32 v29, v29, v28
    v_lshl_add_u32 v31, v29, 4, v30
    v_and_b32 v29, 1, v49
    v_lshl_add_u32 v31, v29, 3, v31
    v_add_u32 v0, s82, v31
    v_mov_b32 v4, 0
    v_mov_b32 v5, 0
    v_mov_b32 v6, 0
    v_mov_b32 v7, 0
    s_branch L_anchor
.p2align 12
L_anchor:
    s_cmp_eq_u32 s25, 1
    s_cbranch_scc1 L_t1_1
    s_cmp_eq_u32 s25, 2
    s_cbranch_scc1 L_t1_2
    s_cmp_eq_u32 s25, 3
    s_cbranch_scc1 L_t1_3
L_t1_0:
    s_branch L_pad14
L_tb1_0:
    s_branch L_pad10
L_tb1_4:
    s_branch L_pad6
L_tb1_8:
    s_branch L_pad2
L_tb1_12:
    s_branch L_t1_end
L_t1_1:
    s_branch L_pad13
L_tb1_1:
    s_branch L_pad9
L_tb1_5:
    s_branch L_pad5
L_tb1_9:
    s_branch L_pad1
L_tb1_13:
    s_branch L_t1_end
L_t1_2:
    s_branch L_pad12
L_tb1_2:
    s_branch L_pad8
L_tb1_6:
    s_branch L_pad4
L_tb1_10:
    s_branch L_t1_end
L_t1_3:
    s_branch L_pad11
L_tb1_3:
    s_branch L_pad7
L_tb1_7:
    s_branch L_pad3
L_tb1_11:
L_t1_end:
    s_waitcnt vmcnt(4)
    v_readfirstlane_b32 s92, v52
    s_mov_b32 s39, 100
L_tagretry:
    s_cmp_lg_u32 s92, 0
    s_cbranch_scc1 L_tagok
    s_sub_u32 s39, s39, 1
    s_cbranch_scc1 L_tagslow
    s_sleep 8
    s_buffer_load_dword s92, s[88:91], s93 glc
    s_waitcnt lgkmcnt(0)
    s_branch L_tagretry
L_tagok:
    s_add_u32 s92, s92, 1
    v_mov_b32 v55, s92
    s_mov_b64 exec, 1
    v_mov_b32 v16, 1
    v_mov_b32 v17, 147456
    ds_add_rtn_u32 v16, v17, v16
    s_waitcnt lgkmcnt(0)
    v_readfirstlane_b32 s24, v16
    s_nop 0
    s_cmp_lg_u32 s24, 3
    s_cbranch_scc1 L_nopost
    s_lshl_b32 s39, s95, 2
    buffer_store_dword v55, off, s[20:23], s39 sc1
L_nopost:
    s_mov_b64 exec, -1
    s_waitcnt vmcnt(11)
    s_add_u32 m0, s82, 28672
    s_movk_i32 s24, 6144
    buffer_load_dwordx4 v212, s[8:11], s24 offen nt lds
    s_waitcnt vmcnt(11)
    s_add_u32 m0, s82, 29696
    s_movk_i32 s24, 6144
    buffer_load_dwordx4 v213, s[8:11], s24 offen nt lds
    s_lshl_b32 s24, s25, 4
    s_add_u32 s24, s24, s29
    s_and_b32 s58, s24, 63
    s_add_u32 s24, s24, 8
    s_and_b32 s57, s24, 63
    s_andn2_b32 s24, s29, 63
    s_or_b32 s58, s58, s24
    s_or_b32 s57, s57, s24
    v_mov_b32 v37, s58
    v_mov_b32 v38, s57
    v_cmp_lt_u32 vcc, 15, v25
    s_lshr_b32 s58, s58, 1
    s_lshr_b32 s57, s57, 1
    s_mulk_i32 s58, 384
    s_mulk_i32 s57, 384
    v_cndmask_b32 v37, v37, v38, vcc
    v_lshl_add_u32 v38, v25, 3, s58
    v_lshl_add_u32 v39, v25, 3, s57
    v_lshlrev_b32 v37, 6, v37
    v_lshl_add_u32 v37, v26, 2, v37
    s_mov_b32 exec_hi, 0xffff
    global_load_dwordx2 v[80:81], v38, s[46:47]
    global_load_dwordx2 v[82:83], v38, s[48:49]
    global_load_dwordx2 v[84:85], v39, s[46:47]
    global_load_dwordx2 v[86:87], v39, s[48:49]
    s_mov_b32 exec_hi, 0
    global_load_dword v88, v37, s[50:51]
    global_load_dword v89, v37, s[52:53]
    s_mov_b32 exec_hi, -1
    v_xor_b32 v17, 32, v0
    v_xor_b32 v18, 64, v0
    v_xor_b32 v19, 96, v0
    s_waitcnt vmcnt(17)
    ds_read_b64 a[192:193], v0 offset:0
    ds_read_b64 a[194:195], v18 offset:128
    ds_read_b64 a[196:197], v17 offset:0
    ds_read_b64 a[198:199], v19 offset:128
    ds_read_b64 a[200:201], v18 offset:0
    ds_read_b64 a[202:203], v0 offset:256
    ds_read_b64 a[204:205], v19 offset:0
    ds_read_b64 a[206:207], v17 offset:256
    ds_read_b64 a[208:209], v0 offset:128
    ds_read_b64 a[210:211], v18 offset:256
    ds_read_b64 a[212:213], v17 offset:128
    ds_read_b64 a[214:215], v19 offset:256
    s_waitcnt lgkmcnt(0)
    s_barrier
    ds_read_b128 v[144:147], v2 offset:0
    ds_read_b128 v[148:151], v3 offset:0
    ds_read_b128 v[152:155], v2 offset:6144
    ds_read_b128 v[156:159], v3 offset:6144
    ds_read_b128 v[160:163], v2 offset:128
    ds_read_b128 v[164:167], v3 offset:128
    ds_read_b128 v[168:171], v2 offset:6272
    ds_read_b128 v[172:175], v3 offset:6272
    ds_read_b128 v[176:179], v2 offset:256
    ds_read_b128 v[180:183], v3 offset:256
    ds_read_b128 v[184:187], v2 offset:6400
    ds_read_b128 v[188:191], v3 offset:6400
    s_waitcnt lgkmcnt(0)
    v_mfma_f32_16x16x32_bf16 v[64:67], v[144:147], a[192:195], 0
    v_mfma_f32_16x16x32_bf16 v[64:67], v[148:151], a[196:199], v[64:67]
    v_mfma_f32_16x16x32_bf16 v[64:67], v[160:163], a[200:203], v[64:67]
    v_mfma_f32_16x16x32_bf16 v[64:67], v[164:167], a[204:207], v[64:67]
    v_mfma_f32_16x16x32_bf16 v[64:67], v[176:179], a[208:211], v[64:67]
    v_mfma_f32_16x16x32_bf16 v[64:67], v[180:183], a[212:215], v[64:67]
    v_mfma_f32_16x16x32_bf16 v[96:99], v[152:155], a[192:195], 0
    v_mfma_f32_16x16x32_bf16 v[96:99], v[156:159], a[196:199], v[96:99]
    v_mfma_f32_16x16x32_bf16 v[96:99], v[168:171], a[200:203], v[96:99]
    v_mfma_f32_16x16x32_bf16 v[96:99], v[172:175], a[204:207], v[96:99]
    v_mfma_f32_16x16x32_bf16 v[96:99], v[184:187], a[208:211], v[96:99]
    v_mfma_f32_16x16x32_bf16 v[96:99], v[188:191], a[212:215], v[96:99]
    s_nop 7
    s_waitcnt vmcnt(11)
    s_add_u32 m0, s82, 49152
    s_movk_i32 s24, 12288
    buffer_load_dwordx4 v208, s[8:11], s24 offen nt lds
    v_max3_f32 v48, v64, v65, v66
    v_max3_f32 v48, v48, v67, v96
    v_max3_f32 v48, v48, v97, v98
    v_max_f32 v48, v48, v99
    v_mov_b32 v49, v48
    s_nop 1
    v_permlane16_swap_b32 v48, v49
    s_nop 1
    v_max_f32 v48, v48, v49
    v_mov_b32 v49, v48
    s_nop 1
    v_permlane32_swap_b32 v48, v49
    s_nop 1
    v_max_f32 v48, v48, v49
    v_sub_f32 v128, 0, v48
    v_sub_f32 v129, 0, v48
    v_sub_f32 v130, 0, v48
    v_sub_f32 v131, 0, v48
    v_sub_f32 v64, v64, v48
    v_sub_f32 v65, v65, v48
    v_sub_f32 v66, v66, v48
    v_sub_f32 v67, v67, v48
    v_sub_f32 v96, v96, v48
    s_waitcnt vmcnt(11)
    s_add_u32 m0, s82, 50176
    s_movk_i32 s24, 12288
    buffer_load_dwordx4 v209, s[8:11], s24 offen nt lds
    v_sub_f32 v97, v97, v48
    v_sub_f32 v98, v98, v48
    v_sub_f32 v99, v99, v48
    v_exp_f32 v64, v64
    v_exp_f32 v65, v65
    v_exp_f32 v66, v66
    v_exp_f32 v67, v67
    v_exp_f32 v96, v96
    v_exp_f32 v97, v97
    v_exp_f32 v98, v98
    v_exp_f32 v99, v99
    v_add_f32 v4, v4, v64
    v_add_f32 v4, v4, v65
    v_add_f32 v4, v4, v66
    v_add_f32 v4, v4, v67
    v_add_f32 v4, v4, v96
    v_add_f32 v4, v4, v97
    v_add_f32 v4, v4, v98
    v_add_f32 v4, v4, v99
    v_cvt_pk_bf16_f32 v64, v64, v65
    v_cvt_pk_bf16_f32 v65, v66, v67
    v_cvt_pk_bf16_f32 v66, v96, v97
    v_cvt_pk_bf16_f32 v67, v98, v99
    s_buffer_load_dwordx8 s[72:79], s[20:23], 0 glc
    s_waitcnt vmcnt(8)
    s_add_u32 m0, s82, 51200
    s_movk_i32 s24, 12288
    buffer_load_dwordx4 v210, s[8:11], s24 offen nt lds
    s_add_u32 s33, s33, 196608
    s_sub_u32 s34, s33, 1572864
    s_min_u32 s33, s33, s34
    s_add_u32 s34, s33, 3072
    s_add_u32 s37, s37, 196608
    s_add_u32 s80, s80, 196608
    s_add_u32 s35, s35, 196608
    s_sub_u32 s36, s35, 1572864
    s_min_u32 s35, s35, s36
    s_add_u32 s36, s35, 3072
    s_add_u32 s81, s81, 196608
    s_mov_b32 s88, s60
    s_mov_b32 s89, s61
    s_mov_b32 s90, L_slow-L_pc
    s_lshr_b32 s59, s2, 3
    s_mul_i32 s93, s59, 43
    s_lshr_b32 s93, s93, 7
    s_mul_i32 s39, s93, 3
    s_sub_u32 s59, s59, s39
    s_lshl_b32 s59, s59, 10
    s_mul_i32 s93, s93, 12288
    s_add_u32 s93, s93, s59
    s_waitcnt vmcnt(3)
    v_lshlrev_b32 v112, 16, v80
    v_and_b32 v113, s97, v80
    v_lshlrev_b32 v114, 16, v82
    v_and_b32 v115, s97, v82
    v_lshlrev_b32 v116, 16, v81
    v_and_b32 v117, s97, v81
    v_lshlrev_b32 v118, 16, v83
    v_and_b32 v119, s97, v83
    v_lshlrev_b32 v120, 16, v84
    v_and_b32 v121, s97, v84
    v_lshlrev_b32 v122, 16, v86
    v_and_b32 v123, s97, v86
    v_lshlrev_b32 v124, 16, v85
    v_and_b32 v125, s97, v85
    v_lshlrev_b32 v126, 16, v87
    v_and_b32 v127, s97, v87
    v_lshlrev_b32 v92, 16, v88
    v_and_b32 v93, s97, v88
    s_waitcnt vmcnt(8)
    s_add_u32 m0, s82, 52224
    s_movk_i32 s24, 12288
    buffer_load_dwordx4 v211, s[8:11], s24 offen nt lds
    v_lshlrev_b32 v94, 16, v89
    v_and_b32 v95, s97, v89
    v_mul_f32 v112, s38, v112
    v_mul_f32 v113, s38, v113
    v_mul_f32 v116, s38, v116
    v_mul_f32 v117, s38, v117
    v_mul_f32 v120, s38, v120
    v_mul_f32 v121, s38, v121
    v_mul_f32 v124, s38, v124
    v_mul_f32 v125, s38, v125
    v_mul_f32_e64 v114, -v114, v112
    v_mul_f32_e64 v115, -v115, v113
    v_mul_f32_e64 v118, -v118, v116
    v_mul_f32_e64 v119, -v119, v117
    v_mul_f32_e64 v122, -v122, v120
    v_mul_f32_e64 v123, -v123, v121
    v_mul_f32_e64 v126, -v126, v124
    v_mul_f32_e64 v127, -v127, v125
    v_mul_f32_e64 v94, -v94, v92
    v_mul_f32_e64 v95, -v95, v93
    s_mul_i32 s57, s25, 3584
    v_add_u32 v36, s57, v36
    s_add_u32 s57, s57, 147584
    v_lshrrev_b32 v37, 4, v25
    v_mul_u32_u24 v37, 1792, v37
    v_lshl_add_u32 v37, v26, 4, v37
    v_add_u32 v37, s57, v37
    s_mov_b32 exec_hi, 0xffff
    ds_write_b128 v36, v[112:115] offset:0
    ds_write_b128 v36, v[116:119] offset:384
    ds_write_b128 v36, v[120:123] offset:1792
    ds_write_b128 v36, v[124:127] offset:2176
    s_mov_b32 exec_hi, 0
    ds_write_b128 v37, v[92:95] offset:1536
    s_mov_b32 exec_hi, -1
    v_add_u32 v10, 1792, v10
    s_lshl_b32 s57, s25, 6
    s_add_u32 s57, s57, 150912
    v_mov_b32 v23, s57
    v_bfe_u32 v53, v8, 4, 6
    v_lshlrev_b32 v53, 2, v53
    s_mov_b32 s39, 200
    s_waitcnt lgkmcnt(0)
    s_sub_u32 s72, s72, s92
    s_sub_u32 s73, s73, s92
    s_sub_u32 s74, s74, s92
    s_sub_u32 s75, s75, s92
    s_sub_u32 s76, s76, s92
    s_sub_u32 s77, s77, s92
    s_sub_u32 s78, s78, s92
    s_sub_u32 s79, s79, s92
    s_max_u32 s72, s72, s73
    s_max_u32 s72, s72, s74
    s_max_u32 s72, s72, s75
    s_max_u32 s72, s72, s76
    s_max_u32 s72, s72, s77
    s_max_u32 s72, s72, s78
    s_max_u32 s72, s72, s79
    s_cmp_lt_u32 s72, 16
    s_cbranch_scc1 L_pollokP
L_pollretry:
    s_buffer_load_dwordx8 s[48:55], s[20:23], 0 glc
    s_waitcnt lgkmcnt(0)
    s_sub_u32 s48, s48, s92
    s_sub_u32 s49, s49, s92
    s_sub_u32 s50, s50, s92
    s_sub_u32 s51, s51, s92
    s_sub_u32 s52, s52, s92
    s_sub_u32 s53, s53, s92
    s_sub_u32 s54, s54, s92
    s_sub_u32 s55, s55, s92
    s_max_u32 s48, s48, s49
    s_max_u32 s48, s48, s50
    s_max_u32 s48, s48, s51
    s_max_u32 s48, s48, s52
    s_max_u32 s48, s48, s53
    s_max_u32 s48, s48, s54
    s_max_u32 s48, s48, s55
    s_cmp_lt_u32 s48, 16
    s_cbranch_scc1 L_pollokP
    s_sub_u32 s39, s39, 1
    s_cbranch_scc1 L_pollslowP
    s_sleep 1
    s_branch L_pollretry
L_pollokP:
    s_add_u32 s92, s92, 1
    s_mov_b32 m0, s26
    s_nop 0
    buffer_load_dwordx4 v8, s[4:7], s32 offen offset:0 sc1 lds
    buffer_load_dwordx4 v8, s[4:7], s32 offen offset:1024 sc1 lds
    buffer_load_dwordx4 v8, s[4:7], s32 offen offset:2048 sc1 lds
    s_add_u32 s32, s32, 24576
    s_sub_u32 s57, s32, 196608
    s_min_u32 s32, s32, s57
    s_add_u32 s26, s26, 36864
    s_sub_u32 s57, s26, 147456
    s_min_u32 s26, s26, s57
    v_xor_b32 v17, 32, v0
    v_xor_b32 v18, 64, v0
    v_xor_b32 v19, 96, v0
    s_waitcnt vmcnt(13)
    ds_read_b64 a[216:217], v0 offset:24576
    ds_read_b64 a[218:219], v18 offset:24704
    ds_read_b64 a[220:221], v17 offset:24576
    ds_read_b64 a[222:223], v19 offset:24704
    ds_read_b64 a[224:225], v18 offset:24576
    ds_read_b64 a[226:227], v0 offset:24832
    ds_read_b64 a[228:229], v19 offset:24576
    ds_read_b64 a[230:231], v17 offset:24832
    ds_read_b64 a[232:233], v0 offset:24704
    ds_read_b64 a[234:235], v18 offset:24832
    ds_read_b64 a[236:237], v17 offset:24704
    ds_read_b64 a[238:239], v19 offset:24832
    s_waitcnt lgkmcnt(0)
    v_mfma_f32_16x16x32_bf16 v[68:71], v[144:147], a[216:219], 0
    v_mfma_f32_16x16x32_bf16 v[68:71], v[148:151], a[220:223], v[68:71]
    v_mfma_f32_16x16x32_bf16 v[68:71], v[160:163], a[224:227], v[68:71]
    v_mfma_f32_16x16x32_bf16 v[68:71], v[164:167], a[228:231], v[68:71]
    v_mfma_f32_16x16x32_bf16 v[68:71], v[176:179], a[232:235], v[68:71]
    v_mfma_f32_16x16x32_bf16 v[68:71], v[180:183], a[236:239], v[68:71]
    v_mfma_f32_16x16x32_bf16 v[100:103], v[152:155], a[216:219], 0
    v_mfma_f32_16x16x32_bf16 v[100:103], v[156:159], a[220:223], v[100:103]
    v_mfma_f32_16x16x32_bf16 v[100:103], v[168:171], a[224:227], v[100:103]
    v_mfma_f32_16x16x32_bf16 v[100:103], v[172:175], a[228:231], v[100:103]
    v_mfma_f32_16x16x32_bf16 v[100:103], v[184:187], a[232:235], v[100:103]
    v_mfma_f32_16x16x32_bf16 v[100:103], v[188:191], a[236:239], v[100:103]
    s_nop 7
    s_mov_b32 m0, s26
    s_nop 0
    buffer_load_dwordx4 v8, s[4:7], s32 offen offset:0 sc1 lds
    buffer_load_dwordx4 v8, s[4:7], s32 offen offset:1024 sc1 lds
    buffer_load_dwordx4 v8, s[4:7], s32 offen offset:2048 sc1 lds
    s_add_u32 s32, s32, 24576
    s_sub_u32 s57, s32, 196608
    s_min_u32 s32, s32, s57
    s_add_u32 s26, s26, 12288
    v_max3_f32 v48, v68, v69, v70
    v_max3_f32 v48, v48, v71, v100
    v_max3_f32 v48, v48, v101, v102
    v_max_f32 v48, v48, v103
    v_mov_b32 v49, v48
    s_nop 1
    v_permlane16_swap_b32 v48, v49
    s_nop 1
    v_max_f32 v48, v48, v49
    v_mov_b32 v49, v48
    s_nop 1
    v_permlane32_swap_b32 v48, v49
    s_nop 1
    v_max_f32 v48, v48, v49
    v_sub_f32 v132, 0, v48
    s_mov_b32 m0, s26
    s_nop 0
    buffer_load_dwordx4 v8, s[4:7], s32 offen offset:0 sc1 lds
    buffer_load_dwordx4 v8, s[4:7], s32 offen offset:1024 sc1 lds
    buffer_load_dwordx4 v8, s[4:7], s32 offen offset:2048 sc1 lds
    s_add_u32 s32, s32, 24576
    s_sub_u32 s57, s32, 196608
    s_min_u32 s32, s32, s57
    s_add_u32 s26, s26, 36864
    s_sub_u32 s57, s26, 147456
    s_min_u32 s26, s26, s57
    v_sub_f32 v133, 0, v48
    v_sub_f32 v134, 0, v48
    v_sub_f32 v135, 0, v48
    v_sub_f32 v68, v68, v48
    v_sub_f32 v69, v69, v48
    v_sub_f32 v70, v70, v48
    v_sub_f32 v71, v71, v48
    v_sub_f32 v100, v100, v48
    v_sub_f32 v101, v101, v48
    v_sub_f32 v102, v102, v48
    v_sub_f32 v103, v103, v48
    v_exp_f32 v68, v68
    v_exp_f32 v69, v69
    v_exp_f32 v70, v70
    v_exp_f32 v71, v71
    s_mov_b32 m0, s56
    s_nop 0
    buffer_load_dwordx4 v8, s[4:7], s27 offen offset:0 sc1 lds
    buffer_load_dwordx4 v8, s[4:7], s27 offen offset:1024 sc1 lds
    buffer_load_dwordx4 v8, s[4:7], s27 offen offset:2048 sc1 lds
    s_add_u32 s27, s27, 24576
    s_sub_u32 s58, s27, 196608
    s_min_u32 s27, s27, s58
    s_add_u32 s56, s56, 36864
    s_sub_u32 s58, s56, 147456
    s_min_u32 s56, s56, s58
    v_exp_f32 v100, v100
    v_exp_f32 v101, v101
    v_exp_f32 v102, v102
    v_exp_f32 v103, v103
    v_add_f32 v5, v5, v68
    v_add_f32 v5, v5, v69
    v_add_f32 v5, v5, v70
    v_add_f32 v5, v5, v71
    v_add_f32 v5, v5, v100
    v_add_f32 v5, v5, v101
    v_add_f32 v5, v5, v102
    v_add_f32 v5, v5, v103
    v_cvt_pk_bf16_f32 v68, v68, v69
    v_cvt_pk_bf16_f32 v69, v70, v71
    v_cvt_pk_bf16_f32 v70, v100, v101
    v_cvt_pk_bf16_f32 v71, v102, v103
    s_waitcnt vmcnt(9)
    s_waitcnt lgkmcnt(0)
    s_barrier
    ds_read_b128 v[24:27], v2 offset:12288
    ds_read_b128 v[28:31], v3 offset:12288
    ds_read_b128 v[32:35], v2 offset:18432
    ds_read_b128 v[36:39], v3 offset:18432
    s_waitcnt lgkmcnt(2)
    v_mfma_f32_16x16x32_bf16 v[80:83], v[24:27], a[192:195], v[128:131]
    ds_read_b128 v[40:43], v2 offset:12416
    v_mfma_f32_16x16x32_bf16 v[80:83], v[28:31], a[196:199], v[80:83]
    s_add_u32 m0, s82, 53248
    s_movk_i32 s24, 12288
    buffer_load_dwordx4 v212, s[8:11], s24 offen nt lds
    v_mfma_f32_16x16x32_bf16 v[84:87], v[24:27], a[216:219], v[132:135]
    ds_read_b128 v[44:47], v3 offset:12416
    v_mfma_f32_16x16x32_bf16 v[84:87], v[28:31], a[220:223], v[84:87]
    s_waitcnt lgkmcnt(2)
    v_mfma_f32_16x16x32_bf16 v[112:115], v[32:35], a[192:195], v[128:131]
    ds_read_b128 v[24:27], v2 offset:18560
    v_mfma_f32_16x16x32_bf16 v[112:115], v[36:39], a[196:199], v[112:115]
    s_add_u32 m0, s82, 54272
    s_movk_i32 s24, 12288
    buffer_load_dwordx4 v213, s[8:11], s24 offen nt lds
    v_mfma_f32_16x16x32_bf16 v[116:119], v[32:35], a[216:219], v[132:135]
    ds_read_b128 v[28:31], v3 offset:18560
    v_mfma_f32_16x16x32_bf16 v[116:119], v[36:39], a[220:223], v[116:119]
    s_waitcnt lgkmcnt(2)
    v_mfma_f32_16x16x32_bf16 v[80:83], v[40:43], a[200:203], v[80:83]
    ds_read_b128 v[32:35], v2 offset:12544
    v_mfma_f32_16x16x32_bf16 v[80:83], v[44:47], a[204:207], v[80:83]
    s_add_u32 m0, s82, 24576
    s_movk_i32 s24, 18432
    buffer_load_dwordx4 v208, s[8:11], s24 offen nt lds
    v_mfma_f32_16x16x32_bf16 v[84:87], v[40:43], a[224:227], v[84:87]
    ds_read_b128 v[36:39], v3 offset:12544
    v_mfma_f32_16x16x32_bf16 v[84:87], v[44:47], a[228:231], v[84:87]
    s_waitcnt lgkmcnt(2)
    v_mfma_f32_16x16x32_bf16 v[112:115], v[24:27], a[200:203], v[112:115]
    ds_read_b128 v[40:43], v2 offset:18688
    v_mfma_f32_16x16x32_bf16 v[112:115], v[28:31], a[204:207], v[112:115]
    s_waitcnt vmcnt(6)
    s_barrier
    v_mfma_f32_16x16x32_bf16 v[116:119], v[24:27], a[224:227], v[116:119]
    ds_read_b128 v[44:47], v3 offset:18688
    v_mfma_f32_16x16x32_bf16 v[116:119], v[28:31], a[228:231], v[116:119]
    s_waitcnt lgkmcnt(2)
    v_mfma_f32_16x16x32_bf16 v[80:83], v[32:35], a[208:211], v[80:83]
    v_add_u32 v2, 49152, v2
    v_add_u32 v3, 49152, v3
    ds_read_b128 v[24:27], v2 offset:0
    v_mfma_f32_16x16x32_bf16 v[80:83], v[36:39], a[212:215], v[80:83]
    s_add_u32 m0, s82, 25600
    s_movk_i32 s24, 18432
    buffer_load_dwordx4 v209, s[8:11], s24 offen nt lds
    v_mfma_f32_16x16x32_bf16 v[84:87], v[32:35], a[232:235], v[84:87]
    ds_read_b128 v[28:31], v3 offset:0
    v_mfma_f32_16x16x32_bf16 v[84:87], v[36:39], a[236:239], v[84:87]
    s_waitcnt lgkmcnt(2)
    v_mfma_f32_16x16x32_bf16 v[112:115], v[40:43], a[208:211], v[112:115]
    ds_read_b128 v[32:35], v2 offset:6144
    v_mfma_f32_16x16x32_bf16 v[112:115], v[44:47], a[212:215], v[112:115]
    s_add_u32 m0, s82, 26624
    s_movk_i32 s24, 18432
    buffer_load_dwordx4 v210, s[8:11], s24 offen nt lds
    v_mfma_f32_16x16x32_bf16 v[116:119], v[40:43], a[232:235], v[116:119]
    ds_read_b128 v[36:39], v3 offset:6144
    v_mfma_f32_16x16x32_bf16 v[116:119], v[44:47], a[236:239], v[116:119]
    s_waitcnt lgkmcnt(2)
    v_mfma_f32_16x16x32_bf16 v[160:163], v[24:27], a[192:195], v[128:131]
    ds_read_b128 v[40:43], v2 offset:128
    v_mfma_f32_16x16x32_bf16 v[160:163], v[28:31], a[196:199], v[160:163]
    s_add_u32 m0, s82, 27648
    s_movk_i32 s24, 18432
    buffer_load_dwordx4 v211, s[8:11], s24 offen nt lds
    v_exp_f32 v16, v80
    v_mfma_f32_16x16x32_bf16 v[164:167], v[24:27], a[216:219], v[132:135]
    ds_read_b128 v[44:47], v3 offset:128
    v_mfma_f32_16x16x32_bf16 v[164:167], v[28:31], a[220:223], v[164:167]
    s_waitcnt lgkmcnt(2)
    v_exp_f32 v17, v81
    v_exp_f32 v18, v82
    v_add_f32 v4, v4, v16
    v_mfma_f32_16x16x32_bf16 v[96:99], v[32:35], a[192:195], v[128:131]
    ds_read_b128 v[24:27], v2 offset:6272
    v_add_f32 v4, v4, v17
    v_mfma_f32_16x16x32_bf16 v[96:99], v[36:39], a[196:199], v[96:99]
    s_add_u32 m0, s82, 28672
    s_movk_i32 s24, 18432
    buffer_load_dwordx4 v212, s[8:11], s24 offen nt lds
    v_exp_f32 v19, v83
    v_mfma_f32_16x16x32_bf16 v[100:103], v[32:35], a[216:219], v[132:135]
    ds_read_b128 v[28:31], v3 offset:6272
    v_cvt_pk_bf16_f32 v80, v16, v17
    v_mfma_f32_16x16x32_bf16 v[100:103], v[36:39], a[220:223], v[100:103]
    s_waitcnt lgkmcnt(2)
    v_exp_f32 v16, v112
    v_add_f32 v4, v4, v18
    v_add_f32 v4, v4, v19
    v_mfma_f32_16x16x32_bf16 v[160:163], v[40:43], a[200:203], v[160:163]
    ds_read_b128 v[32:35], v2 offset:256
    v_mfma_f32_16x16x32_bf16 v[160:163], v[44:47], a[204:207], v[160:163]
    s_add_u32 m0, s82, 29696
    s_movk_i32 s24, 18432
    buffer_load_dwordx4 v213, s[8:11], s24 offen nt lds
    v_exp_f32 v17, v113
    v_mfma_f32_16x16x32_bf16 v[164:167], v[40:43], a[224:227], v[164:167]
    ds_read_b128 v[36:39], v3 offset:256
    v_cvt_pk_bf16_f32 v81, v18, v19
    v_mfma_f32_16x16x32_bf16 v[164:167], v[44:47], a[228:231], v[164:167]
    s_waitcnt lgkmcnt(2)
    v_exp_f32 v18, v114
    v_add_f32 v4, v4, v16
    v_add_f32 v4, v4, v17
    v_mfma_f32_16x16x32_bf16 v[96:99], v[24:27], a[200:203], v[96:99]
    ds_read_b128 v[40:43], v2 offset:6400
    v_mfma_f32_16x16x32_bf16 v[96:99], v[28:31], a[204:207], v[96:99]
    s_mov_b32 m0, s56
    v_exp_f32 v19, v115
    v_cvt_pk_bf16_f32 v82, v16, v17
    v_exp_f32 v16, v84
    v_mfma_f32_16x16x32_bf16 v[100:103], v[24:27], a[224:227], v[100:103]
    ds_read_b128 v[44:47], v3 offset:6400
    v_add_f32 v4, v4, v18
    v_mfma_f32_16x16x32_bf16 v[100:103], v[28:31], a[228:231], v[100:103]
    s_waitcnt lgkmcnt(2)
    v_add_f32 v4, v4, v19
    v_exp_f32 v17, v85
    v_cvt_pk_bf16_f32 v83, v18, v19
    v_mfma_f32_16x16x32_bf16 v[160:163], v[32:35], a[208:211], v[160:163]
    ds_read_b128 v[24:27], v2 offset:12288
    v_mfma_f32_16x16x32_bf16 v[160:163], v[36:39], a[212:215], v[160:163]
    buffer_load_dwordx4 v8, s[4:7], s27 offen offset:0 sc1 lds
    v_exp_f32 v18, v86
    v_add_f32 v5, v5, v16
    v_mfma_f32_16x16x32_bf16 v[164:167], v[32:35], a[232:235], v[164:167]
    ds_read_b128 v[28:31], v3 offset:12288
    v_add_f32 v5, v5, v17
    v_mfma_f32_16x16x32_bf16 v[164:167], v[36:39], a[236:239], v[164:167]
    s_waitcnt lgkmcnt(2)
    v_exp_f32 v19, v87
    v_cvt_pk_bf16_f32 v84, v16, v17
    v_exp_f32 v16, v116
    v_mfma_f32_16x16x32_bf16 v[96:99], v[40:43], a[208:211], v[96:99]
    ds_read_b128 v[32:35], v2 offset:18432
    v_add_f32 v5, v5, v18
    v_mfma_f32_16x16x32_bf16 v[96:99], v[44:47], a[212:215], v[96:99]
    buffer_load_dwordx4 v8, s[4:7], s27 offen offset:1024 sc1 lds
    v_add_f32 v5, v5, v19
    v_exp_f32 v17, v117
    v_mfma_f32_16x16x32_bf16 v[100:103], v[40:43], a[232:235], v[100:103]
    ds_read_b128 v[36:39], v3 offset:18432
    v_cvt_pk_bf16_f32 v85, v18, v19
    v_mfma_f32_16x16x32_bf16 v[100:103], v[44:47], a[236:239], v[100:103]
    s_waitcnt lgkmcnt(2)
    v_exp_f32 v18, v118
    v_add_f32 v5, v5, v16
    v_add_f32 v5, v5, v17
    v_mfma_f32_16x16x32_bf16 v[176:179], v[24:27], a[192:195], v[128:131]
    ds_read_b128 v[40:43], v2 offset:12416
    v_mfma_f32_16x16x32_bf16 v[176:179], v[28:31], a[196:199], v[176:179]
    buffer_load_dwordx4 v8, s[4:7], s27 offen offset:2048 sc1 lds
    v_exp_f32 v19, v119
    v_cvt_pk_bf16_f32 v86, v16, v17
    v_mfma_f32_16x16x32_bf16 v[180:183], v[24:27], a[216:219], v[132:135]
    ds_read_b128 v[44:47], v3 offset:12416
    v_add_f32 v5, v5, v18
    v_mfma_f32_16x16x32_bf16 v[180:183], v[28:31], a[220:223], v[180:183]
    s_waitcnt lgkmcnt(2)
    v_add_f32 v5, v5, v19
    v_cvt_pk_bf16_f32 v87, v18, v19
    v_mfma_f32_16x16x32_bf16 v[120:123], v[32:35], a[192:195], v[128:131]
    ds_read_b128 v[24:27], v2 offset:18560
    v_mfma_f32_16x16x32_bf16 v[120:123], v[36:39], a[196:199], v[120:123]
    s_add_u32 s27, s27, 24576
    s_sub_u32 s58, s27, 196608
    s_min_u32 s27, s27, s58
    v_exp_f32 v16, v160
    v_mfma_f32_16x16x32_bf16 v[124:127], v[32:35], a[216:219], v[132:135]
    ds_read_b128 v[28:31], v3 offset:18560
    v_mfma_f32_16x16x32_bf16 v[124:127], v[36:39], a[220:223], v[124:127]
    s_waitcnt lgkmcnt(2)
    v_exp_f32 v17, v161
    v_exp_f32 v18, v162
    v_add_f32 v4, v4, v16
    v_mfma_f32_16x16x32_bf16 v[176:179], v[40:43], a[200:203], v[176:179]
    ds_read_b128 v[32:35], v2 offset:12544
    v_add_f32 v4, v4, v17
    v_mfma_f32_16x16x32_bf16 v[176:179], v[44:47], a[204:207], v[176:179]
    s_add_u32 s56, s56, 12288
    v_exp_f32 v19, v163
    v_cvt_pk_bf16_f32 v160, v16, v17
    v_exp_f32 v16, v96
    v_mfma_f32_16x16x32_bf16 v[180:183], v[40:43], a[224:227], v[180:183]
    ds_read_b128 v[36:39], v3 offset:12544
    v_add_f32 v4, v4, v18
    v_mfma_f32_16x16x32_bf16 v[180:183], v[44:47], a[228:231], v[180:183]
    s_waitcnt lgkmcnt(2)
    v_add_f32 v4, v4, v19
    v_exp_f32 v17, v97
    v_cvt_pk_bf16_f32 v161, v18, v19
    v_mfma_f32_16x16x32_bf16 v[120:123], v[24:27], a[200:203], v[120:123]
    ds_read_b128 v[40:43], v2 offset:18688
    v_mfma_f32_16x16x32_bf16 v[120:123], v[28:31], a[204:207], v[120:123]
    s_waitcnt vmcnt(11)
    s_barrier
    v_exp_f32 v18, v98
    v_add_f32 v4, v4, v16
    v_mfma_f32_16x16x32_bf16 v[124:127], v[24:27], a[224:227], v[124:127]
    ds_read_b128 v[44:47], v3 offset:18688
    v_add_f32 v4, v4, v17
    v_mfma_f32_16x16x32_bf16 v[124:127], v[28:31], a[228:231], v[124:127]
    s_waitcnt lgkmcnt(2)
    v_exp_f32 v19, v99
    v_cvt_pk_bf16_f32 v162, v16, v17
    v_exp_f32 v16, v164
    v_mfma_f32_16x16x32_bf16 v[176:179], v[32:35], a[208:211], v[176:179]
    ds_read_b128 v[24:27], v1 offset:0
    v_add_f32 v4, v4, v18
    v_mfma_f32_16x16x32_bf16 v[176:179], v[36:39], a[212:215], v[176:179]
    s_mov_b32 m0, s56
    v_add_f32 v4, v4, v19
    v_exp_f32 v17, v165
    v_cvt_pk_bf16_f32 v163, v18, v19
    v_mfma_f32_16x16x32_bf16 v[180:183], v[32:35], a[232:235], v[180:183]
    ds_read_b128 v[28:31], v1 offset:12288
    v_mfma_f32_16x16x32_bf16 v[180:183], v[36:39], a[236:239], v[180:183]
    s_waitcnt lgkmcnt(2)
    v_exp_f32 v18, v166
    v_add_f32 v5, v5, v16
    v_add_f32 v5, v5, v17
    v_mfma_f32_16x16x32_bf16 v[120:123], v[40:43], a[208:211], v[120:123]
    ds_read_b128 v[32:35], v1 offset:768
    v_mfma_f32_16x16x32_bf16 v[120:123], v[44:47], a[212:215], v[120:123]
    buffer_load_dwordx4 v8, s[4:7], s27 offen offset:0 sc1 lds
    v_exp_f32 v19, v167
    v_cvt_pk_bf16_f32 v164, v16, v17
    v_mfma_f32_16x16x32_bf16 v[124:127], v[40:43], a[232:235], v[124:127]
    ds_read_b128 v[36:39], v1 offset:13056
    v_mfma_f32_16x16x32_bf16 v[124:127], v[44:47], a[236:239], v[124:127]
    s_waitcnt lgkmcnt(2)
    v_exp_f32 v16, v100
    v_add_f32 v5, v5, v18
    v_add_f32 v5, v5, v19
    v_mfma_f32_16x16x32_bf16 a[0:3], v[64:67], v[24:27], 0
    ds_read_b128 v[40:43], v1 offset:1536
    v_mfma_f32_16x16x32_bf16 a[0:3], v[80:83], v[28:31], a[0:3]
    buffer_load_dwordx4 v8, s[4:7], s27 offen offset:1024 sc1 lds
    v_exp_f32 v17, v101
    v_cvt_pk_bf16_f32 v165, v18, v19
    v_mfma_f32_16x16x32_bf16 a[48:51], v[68:71], v[24:27], 0
    ds_read_b128 v[44:47], v1 offset:13824
    v_mfma_f32_16x16x32_bf16 a[48:51], v[84:87], v[28:31], a[48:51]
    s_waitcnt lgkmcnt(2)
    v_exp_f32 v18, v102
    v_add_f32 v5, v5, v16
    v_add_f32 v5, v5, v17
    v_mfma_f32_16x16x32_bf16 a[4:7], v[64:67], v[32:35], 0
    ds_read_b128 v[24:27], v1 offset:2304
    v_mfma_f32_16x16x32_bf16 a[4:7], v[80:83], v[36:39], a[4:7]
    buffer_load_dwordx4 v8, s[4:7], s27 offen offset:2048 sc1 lds
    v_exp_f32 v19, v103
    v_cvt_pk_bf16_f32 v166, v16, v17
    s_branch L_skip1
L_pad1:
    s_branch L_tb1_13
L_skip1:
    v_mfma_f32_16x16x32_bf16 a[52:55], v[68:71], v[32:35], 0
    ds_read_b128 v[28:31], v1 offset:14592
    v_add_f32 v5, v5, v18
    v_mfma_f32_16x16x32_bf16 a[52:55], v[84:87], v[36:39], a[52:55]
    s_waitcnt lgkmcnt(2)
    v_add_f32 v5, v5, v19
    v_cvt_pk_bf16_f32 v167, v18, v19
    v_exp_f32 v16, v176
    v_mfma_f32_16x16x32_bf16 a[8:11], v[64:67], v[40:43], 0
    ds_read_b128 v[32:35], v21 offset:0
    v_mfma_f32_16x16x32_bf16 a[8:11], v[80:83], v[44:47], a[8:11]
    s_add_u32 s27, s27, 24576
    s_sub_u32 s58, s27, 196608
    s_min_u32 s27, s27, s58
    v_exp_f32 v17, v177
    v_mfma_f32_16x16x32_bf16 a[56:59], v[68:71], v[40:43], 0
    ds_read_b128 v[36:39], v21 offset:12288
    v_mfma_f32_16x16x32_bf16 a[56:59], v[84:87], v[44:47], a[56:59]
    s_waitcnt lgkmcnt(2)
    v_exp_f32 v18, v178
    v_add_f32 v4, v4, v16
    v_add_f32 v4, v4, v17
    v_mfma_f32_16x16x32_bf16 a[12:15], v[64:67], v[24:27], 0
    ds_read_b128 v[40:43], v21 offset:768
    v_mfma_f32_16x16x32_bf16 a[12:15], v[80:83], v[28:31], a[12:15]
    s_add_u32 s56, s56, 36864
    s_sub_u32 s58, s56, 147456
    s_min_u32 s56, s56, s58
    v_exp_f32 v19, v179
    v_cvt_pk_bf16_f32 v176, v16, v17
    v_mfma_f32_16x16x32_bf16 a[60:63], v[68:71], v[24:27], 0
    ds_read_b128 v[44:47], v21 offset:13056
    v_mfma_f32_16x16x32_bf16 a[60:63], v[84:87], v[28:31], a[60:63]
    s_waitcnt lgkmcnt(2)
    v_exp_f32 v16, v120
    v_add_f32 v4, v4, v18
    v_add_f32 v4, v4, v19
    v_mfma_f32_16x16x32_bf16 a[16:19], v[64:67], v[32:35], 0
    ds_read_b128 v[24:27], v21 offset:1536
    v_mfma_f32_16x16x32_bf16 a[16:19], v[80:83], v[36:39], a[16:19]
    buffer_load_dwordx4 v[224:227], v9, s[64:67], s33 offen offset:0 nt
    v_exp_f32 v17, v121
    v_cvt_pk_bf16_f32 v177, v18, v19
    v_mfma_f32_16x16x32_bf16 a[64:67], v[68:71], v[32:35], 0
    ds_read_b128 v[28:31], v21 offset:13824
    v_mfma_f32_16x16x32_bf16 a[64:67], v[84:87], v[36:39], a[64:67]
    s_waitcnt lgkmcnt(2)
    v_exp_f32 v18, v122
    v_add_f32 v4, v4, v16
    v_add_f32 v4, v4, v17
    v_mfma_f32_16x16x32_bf16 a[20:23], v[64:67], v[40:43], 0
    ds_read_b128 v[32:35], v21 offset:2304
    v_mfma_f32_16x16x32_bf16 a[20:23], v[80:83], v[44:47], a[20:23]
    buffer_load_dwordx4 v[228:231], v9, s[64:67], s33 offen offset:1536 nt
    v_exp_f32 v19, v123
    v_cvt_pk_bf16_f32 v178, v16, v17
    v_mfma_f32_16x16x32_bf16 a[68:71], v[68:71], v[40:43], 0
    ds_read_b128 v[36:39], v21 offset:14592
    v_mfma_f32_16x16x32_bf16 a[68:71], v[84:87], v[44:47], a[68:71]
    s_waitcnt lgkmcnt(2)
    v_exp_f32 v16, v180
    v_add_f32 v4, v4, v18
    v_add_f32 v4, v4, v19
    v_mfma_f32_16x16x32_bf16 a[24:27], v[64:67], v[24:27], 0
    ds_read_b128 v[40:43], v22 offset:0
    v_mfma_f32_16x16x32_bf16 a[24:27], v[80:83], v[28:31], a[24:27]
    buffer_load_dwordx4 v[232:235], v9, s[64:67], s34 offen offset:0 nt
    v_exp_f32 v17, v181
    v_cvt_pk_bf16_f32 v179, v18, v19
    v_mfma_f32_16x16x32_bf16 a[72:75], v[68:71], v[24:27], 0
    ds_read_b128 v[44:47], v22 offset:12288
    v_mfma_f32_16x16x32_bf16 a[72:75], v[84:87], v[28:31], a[72:75]
    s_waitcnt lgkmcnt(2)
    v_exp_f32 v18, v182
    v_add_f32 v5, v5, v16
    v_add_f32 v5, v5, v17
    v_mfma_f32_16x16x32_bf16 a[28:31], v[64:67], v[32:35], 0
    ds_read_b128 v[24:27], v22 offset:768
    v_mfma_f32_16x16x32_bf16 a[28:31], v[80:83], v[36:39], a[28:31]
    buffer_load_dwordx4 v[236:239], v9, s[64:67], s34 offen offset:1536 nt
    v_exp_f32 v19, v183
    v_cvt_pk_bf16_f32 v180, v16, v17
    v_mfma_f32_16x16x32_bf16 a[76:79], v[68:71], v[32:35], 0
    ds_read_b128 v[28:31], v22 offset:13056
    v_mfma_f32_16x16x32_bf16 a[76:79], v[84:87], v[36:39], a[76:79]
    s_waitcnt lgkmcnt(2)
    v_exp_f32 v16, v124
    v_add_f32 v5, v5, v18
    v_add_f32 v5, v5, v19
    v_mfma_f32_16x16x32_bf16 a[32:35], v[64:67], v[40:43], 0
    ds_read_b128 v[32:35], v22 offset:1536
    v_mfma_f32_16x16x32_bf16 a[32:35], v[80:83], v[44:47], a[32:35]
    v_exp_f32 v17, v125
    v_cvt_pk_bf16_f32 v181, v18, v19
    v_exp_f32 v18, v126
    v_mfma_f32_16x16x32_bf16 a[80:83], v[68:71], v[40:43], 0
    ds_read_b128 v[36:39], v22 offset:13824
    v_add_f32 v5, v5, v16
    v_mfma_f32_16x16x32_bf16 a[80:83], v[84:87], v[44:47], a[80:83]
    s_waitcnt lgkmcnt(2)
    v_add_f32 v5, v5, v17
    v_exp_f32 v19, v127
    v_cvt_pk_bf16_f32 v182, v16, v17
    v_add_f32 v5, v5, v18
    v_mfma_f32_16x16x32_bf16 a[36:39], v[64:67], v[24:27], 0
    ds_read_b128 v[40:43], v22 offset:2304
    v_add_f32 v5, v5, v19
    v_mfma_f32_16x16x32_bf16 a[36:39], v[80:83], v[28:31], a[36:39]
    v_cvt_pk_bf16_f32 v183, v18, v19
    v_mfma_f32_16x16x32_bf16 a[84:87], v[68:71], v[24:27], 0
    ds_read_b128 v[44:47], v22 offset:14592
    v_mfma_f32_16x16x32_bf16 a[84:87], v[84:87], v[28:31], a[84:87]
    s_waitcnt lgkmcnt(2)
    v_mfma_f32_16x16x32_bf16 a[40:43], v[64:67], v[32:35], 0
    v_add_u32 v2, 4294918144, v2
    v_add_u32 v3, 4294918144, v3
    ds_read_b128 v[24:27], v2 offset:0
    v_mfma_f32_16x16x32_bf16 a[40:43], v[80:83], v[36:39], a[40:43]
    v_mfma_f32_16x16x32_bf16 a[88:91], v[68:71], v[32:35], 0
    ds_read_b128 v[28:31], v3 offset:0
    v_mfma_f32_16x16x32_bf16 a[88:91], v[84:87], v[36:39], a[88:91]
    s_waitcnt lgkmcnt(2)
    v_mfma_f32_16x16x32_bf16 a[44:47], v[64:67], v[40:43], 0
    ds_read_b128 v[32:35], v2 offset:6144
    v_mfma_f32_16x16x32_bf16 a[44:47], v[80:83], v[44:47], a[44:47]
    v_mfma_f32_16x16x32_bf16 a[92:95], v[68:71], v[40:43], 0
    ds_read_b128 v[36:39], v3 offset:6144
    v_mfma_f32_16x16x32_bf16 a[92:95], v[84:87], v[44:47], a[92:95]
    s_waitcnt lgkmcnt(2)
    ds_read_b128 v[48:51], v10 offset:0
    v_xor_b32 v17, 32, v0
    v_xor_b32 v18, 64, v0
    v_xor_b32 v19, 96, v0
    s_waitcnt vmcnt(16)
    ds_read_b64 a[240:241], v0 offset:49152
    ds_read_b64 a[242:243], v18 offset:49280
    ds_read_b64 a[244:245], v17 offset:49152
    ds_read_b64 a[246:247], v19 offset:49280
    ds_read_b64 a[248:249], v18 offset:49152
    ds_read_b64 a[250:251], v0 offset:49408
    ds_read_b64 a[252:253], v19 offset:49152
    ds_read_b64 a[254:255], v17 offset:49408
    ds_read_b64 v[192:193], v0 offset:49280
    ds_read_b64 v[194:195], v18 offset:49408
    ds_read_b64 v[196:197], v17 offset:49280
    ds_read_b64 v[198:199], v19 offset:49408
    s_cmp_eq_u32 s25, 1
    s_cbranch_scc1 L_t2_1
    s_cmp_eq_u32 s25, 2
    s_cbranch_scc1 L_t2_2
    s_cmp_eq_u32 s25, 3
    s_cbranch_scc1 L_t2_3
L_t2_0:
    s_branch L_pad15
L_tb2_0:
    s_branch L_t2_end
L_t2_1:
    s_branch L_pad16
L_tb2_1:
    s_branch L_t2_end
L_t2_2:
    s_branch L_t2_end
L_t2_3:
L_t2_end:
    v_xor_b32 v17, 32, v0
    v_xor_b32 v18, 64, v0
    v_xor_b32 v19, 96, v0
    s_waitcnt vmcnt(10)
    ds_read_b64 v[200:201], v0 offset:24576
    ds_read_b64 v[202:203], v18 offset:24704
    ds_read_b64 v[204:205], v17 offset:24576
    ds_read_b64 v[206:207], v19 offset:24704
    ds_read_b64 v[208:209], v18 offset:24576
    ds_read_b64 v[210:211], v0 offset:24832
    ds_read_b64 v[212:213], v19 offset:24576
    ds_read_b64 v[214:215], v17 offset:24832
    ds_read_b64 v[216:217], v0 offset:24704
    ds_read_b64 v[218:219], v18 offset:24832
    ds_read_b64 v[220:221], v17 offset:24704
    ds_read_b64 v[222:223], v19 offset:24832
    s_waitcnt lgkmcnt(0)
    s_barrier
    v_mfma_f32_16x16x32_bf16 v[72:75], v[24:27], a[240:243], 0
    ds_read_b128 v[40:43], v2 offset:128
    v_mfma_f32_16x16x32_bf16 v[72:75], v[28:31], a[244:247], v[72:75]
    buffer_load_dwordx4 v[240:243], v9, s[64:67], s33 offen offset:384 nt
    v_mfma_f32_16x16x32_bf16 v[76:79], v[24:27], v[200:203], 0
    ds_read_b128 v[44:47], v3 offset:128
    v_mfma_f32_16x16x32_bf16 v[76:79], v[28:31], v[204:207], v[76:79]
    s_nop 0
    v_mfma_f32_16x16x32_bf16 v[104:107], v[32:35], a[240:243], 0
    ds_read_b128 v[24:27], v2 offset:6272
    v_mfma_f32_16x16x32_bf16 v[104:107], v[36:39], a[244:247], v[104:107]
    buffer_load_dwordx4 v[244:247], v9, s[64:67], s33 offen offset:1920 nt
    v_mfma_f32_16x16x32_bf16 v[108:111], v[32:35], v[200:203], 0
    ds_read_b128 v[28:31], v3 offset:6272
    v_mfma_f32_16x16x32_bf16 v[108:111], v[36:39], v[204:207], v[108:111]
    s_waitcnt lgkmcnt(2)
    v_mfma_f32_16x16x32_bf16 v[72:75], v[40:43], a[248:251], v[72:75]
    ds_read_b128 v[32:35], v2 offset:256
    v_mfma_f32_16x16x32_bf16 v[72:75], v[44:47], a[252:255], v[72:75]
    buffer_load_dwordx4 v[248:251], v9, s[64:67], s34 offen offset:384 nt
    v_mfma_f32_16x16x32_bf16 v[76:79], v[40:43], v[208:211], v[76:79]
    ds_read_b128 v[36:39], v3 offset:256
    v_mfma_f32_16x16x32_bf16 v[76:79], v[44:47], v[212:215], v[76:79]
    s_waitcnt lgkmcnt(2)
    v_mfma_f32_16x16x32_bf16 v[104:107], v[24:27], a[248:251], v[104:107]
    ds_read_b128 v[40:43], v2 offset:6400
    v_mfma_f32_16x16x32_bf16 v[104:107], v[28:31], a[252:255], v[104:107]
    s_waitcnt vmcnt(7)
    s_barrier
    v_mfma_f32_16x16x32_bf16 v[108:111], v[24:27], v[208:211], v[108:111]
    ds_read_b128 v[44:47], v3 offset:6400
    v_mfma_f32_16x16x32_bf16 v[108:111], v[28:31], v[212:215], v[108:111]
    s_waitcnt lgkmcnt(2)
    v_mfma_f32_16x16x32_bf16 v[72:75], v[32:35], v[192:195], v[72:75]
    v_add_u32 v1, 49152, v1
    v_add_u32 v21, 49152, v21
    v_add_u32 v22, 49152, v22
    ds_read_b128 v[24:27], v1 offset:0
    v_mfma_f32_16x16x32_bf16 v[72:75], v[36:39], v[196:199], v[72:75]
    buffer_load_dwordx4 v[252:255], v9, s[64:67], s34 offen offset:1920 nt
    v_mfma_f32_16x16x32_bf16 v[76:79], v[32:35], v[216:219], v[76:79]
    ds_read_b128 v[28:31], v1 offset:12288
    v_mfma_f32_16x16x32_bf16 v[76:79], v[36:39], v[220:223], v[76:79]
    s_waitcnt lgkmcnt(2)
    v_mfma_f32_16x16x32_bf16 v[104:107], v[40:43], v[192:195], v[104:107]
    ds_read_b128 v[32:35], v1 offset:768
    v_mfma_f32_16x16x32_bf16 v[104:107], v[44:47], v[196:199], v[104:107]
    buffer_load_dwordx4 v[144:147], v12, s[68:71], s35 offen offset:0 nt
    v_mfma_f32_16x16x32_bf16 v[108:111], v[40:43], v[216:219], v[108:111]
    ds_read_b128 v[36:39], v1 offset:13056
    v_mfma_f32_16x16x32_bf16 v[108:111], v[44:47], v[220:223], v[108:111]
    s_waitcnt lgkmcnt(2)
    v_mfma_f32_16x16x32_bf16 a[0:3], v[160:163], v[24:27], a[0:3]
    ds_read_b128 v[40:43], v1 offset:1536
    v_max3_f32 v16, v72, v73, v74
    v_mfma_f32_16x16x32_bf16 a[0:3], v[176:179], v[28:31], a[0:3]
    buffer_load_dwordx4 v[148:151], v12, s[68:71], s35 offen offset:768 nt
    v_max3_f32 v18, v76, v77, v78
    v_max3_f32 v16, v16, v75, v104
    v_max3_f32 v18, v18, v79, v108
    v_mfma_f32_16x16x32_bf16 a[48:51], v[164:167], v[24:27], a[48:51]
    ds_read_b128 v[44:47], v1 offset:13824
    v_max3_f32 v16, v16, v105, v106
    v_mfma_f32_16x16x32_bf16 a[48:51], v[180:183], v[28:31], a[48:51]
    s_waitcnt lgkmcnt(2)
    v_max3_f32 v18, v18, v109, v110
    v_max_f32 v16, v16, v107
    v_max_f32 v18, v18, v111
    v_mov_b32 v17, v16
    v_mov_b32 v19, v18
    v_mfma_f32_16x16x32_bf16 a[4:7], v[160:163], v[32:35], a[4:7]
    ds_read_b128 v[24:27], v1 offset:2304
    s_nop 0
    v_mfma_f32_16x16x32_bf16 a[4:7], v[176:179], v[36:39], a[4:7]
    buffer_load_dwordx4 v[152:155], v12, s[68:71], s35 offen offset:1536 nt
    v_permlane16_swap_b32 v16, v17
    v_permlane16_swap_b32 v18, v19
    s_nop 0
    v_mfma_f32_16x16x32_bf16 a[52:55], v[164:167], v[32:35], a[52:55]
    ds_read_b128 v[28:31], v1 offset:14592
    v_max_f32 v16, v16, v17
    v_mfma_f32_16x16x32_bf16 a[52:55], v[180:183], v[36:39], a[52:55]
    s_waitcnt lgkmcnt(2)
    v_max_f32 v18, v18, v19
    v_mov_b32 v17, v16
    v_mov_b32 v19, v18
    s_nop 0
    v_permlane32_swap_b32 v16, v17
    v_mfma_f32_16x16x32_bf16 a[8:11], v[160:163], v[40:43], a[8:11]
    ds_read_b128 v[32:35], v21 offset:0
    v_permlane32_swap_b32 v18, v19
    v_mfma_f32_16x16x32_bf16 a[8:11], v[176:179], v[44:47], a[8:11]
    buffer_load_dwordx4 v[156:159], v12, s[68:71], s35 offen offset:2304 nt
    s_nop 0
    v_max_f32 v16, v16, v17
    v_max_f32 v18, v18, v19
    v_mfma_f32_16x16x32_bf16 a[56:59], v[164:167], v[40:43], a[56:59]
    ds_read_b128 v[36:39], v21 offset:12288
    v_sub_f32 v136, 0, v16
    v_mfma_f32_16x16x32_bf16 a[56:59], v[180:183], v[44:47], a[56:59]
    s_waitcnt lgkmcnt(2)
    v_sub_f32 v137, 0, v16
    v_sub_f32 v138, 0, v16
    v_sub_f32 v139, 0, v16
    v_sub_f32 v140, 0, v18
    v_sub_f32 v141, 0, v18
    v_mfma_f32_16x16x32_bf16 a[12:15], v[160:163], v[24:27], a[12:15]
    ds_read_b128 v[40:43], v21 offset:768
    v_sub_f32 v142, 0, v18
    v_mfma_f32_16x16x32_bf16 a[12:15], v[176:179], v[28:31], a[12:15]
    s_mov_b32 m0, s26
    v_sub_f32 v143, 0, v18
    v_add_f32 v72, v72, v136
    v_add_f32 v73, v73, v136
    v_add_f32 v74, v74, v136
    v_add_f32 v75, v75, v136
    v_mfma_f32_16x16x32_bf16 a[60:63], v[164:167], v[24:27], a[60:63]
    ds_read_b128 v[44:47], v21 offset:13056
    v_add_f32 v104, v104, v136
    v_mfma_f32_16x16x32_bf16 a[60:63], v[180:183], v[28:31], a[60:63]
    s_waitcnt lgkmcnt(2)
    v_add_f32 v105, v105, v136
    v_add_f32 v106, v106, v136
    v_add_f32 v107, v107, v136
    v_add_f32 v76, v76, v140
    v_add_f32 v77, v77, v140
    v_mfma_f32_16x16x32_bf16 a[16:19], v[160:163], v[32:35], a[16:19]
    ds_read_b128 v[24:27], v21 offset:1536
    v_add_f32 v78, v78, v140
    v_mfma_f32_16x16x32_bf16 a[16:19], v[176:179], v[36:39], a[16:19]
    buffer_load_dwordx4 v8, s[4:7], s32 offen offset:0 sc1 lds
    v_add_f32 v79, v79, v140
    v_add_f32 v108, v108, v140
    v_add_f32 v109, v109, v140
    v_mfma_f32_16x16x32_bf16 a[64:67], v[164:167], v[32:35], a[64:67]
    ds_read_b128 v[28:31], v21 offset:13824
    v_add_f32 v110, v110, v140
    v_mfma_f32_16x16x32_bf16 a[64:67], v[180:183], v[36:39], a[64:67]
    s_waitcnt lgkmcnt(2)
    v_add_f32 v111, v111, v140
    v_exp_f32 v16, v72
    v_exp_f32 v17, v73
    v_mfma_f32_16x16x32_bf16 a[20:23], v[160:163], v[40:43], a[20:23]
    ds_read_b128 v[32:35], v21 offset:2304
    ds_read_b128 v[56:59], v10 offset:384
    v_mfma_f32_16x16x32_bf16 a[20:23], v[176:179], v[44:47], a[20:23]
    buffer_load_dwordx4 v8, s[4:7], s32 offen offset:1024 sc1 lds
    v_exp_f32 v18, v74
    v_add_f32 v6, v6, v16
    v_mfma_f32_16x16x32_bf16 a[68:71], v[164:167], v[40:43], a[68:71]
    ds_read_b128 v[36:39], v21 offset:14592
    v_add_f32 v6, v6, v17
    v_mfma_f32_16x16x32_bf16 a[68:71], v[180:183], v[44:47], a[68:71]
    s_waitcnt lgkmcnt(3)
    v_exp_f32 v19, v75
    v_cvt_pk_bf16_f32 v72, v16, v17
    v_exp_f32 v16, v104
    v_mfma_f32_16x16x32_bf16 a[24:27], v[160:163], v[24:27], a[24:27]
    ds_read_b128 v[40:43], v22 offset:0
    v_add_f32 v6, v6, v18
    v_mfma_f32_16x16x32_bf16 a[24:27], v[176:179], v[28:31], a[24:27]
    buffer_load_dwordx4 v8, s[4:7], s32 offen offset:2048 sc1 lds
    v_add_f32 v6, v6, v19
    v_exp_f32 v17, v105
    v_mfma_f32_16x16x32_bf16 a[72:75], v[164:167], v[24:27], a[72:75]
    ds_read_b128 v[44:47], v22 offset:12288
    v_cvt_pk_bf16_f32 v73, v18, v19
    v_mfma_f32_16x16x32_bf16 a[72:75], v[180:183], v[28:31], a[72:75]
    s_waitcnt lgkmcnt(2)
    v_exp_f32 v18, v106
    v_add_f32 v6, v6, v16
    v_add_f32 v6, v6, v17
    s_waitcnt vmcnt(13)
    v_mfma_f32_16x16x32_bf16 a[28:31], v[160:163], v[32:35], a[28:31]
    ds_read_b128 v[24:27], v22 offset:768
    v_cvt_f32_i32 v224, v224
    v_mfma_f32_16x16x32_bf16 a[28:31], v[176:179], v[36:39], a[28:31]
    s_add_u32 s32, s32, 24576
    s_sub_u32 s57, s32, 196608
    s_min_u32 s32, s32, s57
    v_exp_f32 v19, v107
    v_cvt_pk_bf16_f32 v74, v16, v17
    v_mfma_f32_16x16x32_bf16 a[76:79], v[164:167], v[32:35], a[76:79]
    ds_read_b128 v[28:31], v22 offset:13056
    v_cvt_f32_i32 v225, v225
    v_mfma_f32_16x16x32_bf16 a[76:79], v[180:183], v[36:39], a[76:79]
    s_waitcnt lgkmcnt(2)
    v_exp_f32 v16, v76
    v_add_f32 v6, v6, v18
    v_add_f32 v6, v6, v19
    v_cvt_f32_i32 v228, v228
    v_mfma_f32_16x16x32_bf16 a[32:35], v[160:163], v[40:43], a[32:35]
    ds_read_b128 v[32:35], v22 offset:1536
    ds_read_b128 v[60:63], v10 offset:768
    v_mfma_f32_16x16x32_bf16 a[32:35], v[176:179], v[44:47], a[32:35]
    s_add_u32 s26, s26, 12288
    v_exp_f32 v17, v77
    v_cvt_pk_bf16_f32 v75, v18, v19
    v_exp_f32 v18, v78
    v_mfma_f32_16x16x32_bf16 a[80:83], v[164:167], v[40:43], a[80:83]
    ds_read_b128 v[36:39], v22 offset:13824
    v_add_f32 v7, v7, v16
    v_mfma_f32_16x16x32_bf16 a[80:83], v[180:183], v[44:47], a[80:83]
    s_waitcnt lgkmcnt(3)
    v_add_f32 v7, v7, v17
    v_exp_f32 v19, v79
    v_cvt_pk_bf16_f32 v76, v16, v17
    v_cvt_f32_i32 v229, v229
    v_mfma_f32_16x16x32_bf16 a[36:39], v[160:163], v[24:27], a[36:39]
    ds_read_b128 v[40:43], v22 offset:2304
    v_fma_f32 v224, v224, v48, v50
    v_mfma_f32_16x16x32_bf16 a[36:39], v[176:179], v[28:31], a[36:39]
    s_mov_b32 m0, s26
    v_exp_f32 v16, v108
    v_add_f32 v7, v7, v18
    v_add_f32 v7, v7, v19
    v_fma_f32 v225, v225, v49, v51
    v_mfma_f32_16x16x32_bf16 a[84:87], v[164:167], v[24:27], a[84:87]
    ds_read_b128 v[44:47], v22 offset:14592
    v_fma_f32 v228, v228, v48, v50
    v_mfma_f32_16x16x32_bf16 a[84:87], v[180:183], v[28:31], a[84:87]
    s_waitcnt lgkmcnt(2)
    v_exp_f32 v17, v109
    v_cvt_pk_bf16_f32 v77, v18, v19
    v_exp_f32 v18, v110
    v_mfma_f32_16x16x32_bf16 a[40:43], v[160:163], v[32:35], a[40:43]
    ds_read_b128 v[24:27], v2 offset:12288
    v_add_f32 v7, v7, v16
    v_mfma_f32_16x16x32_bf16 a[40:43], v[176:179], v[36:39], a[40:43]
    buffer_load_dwordx4 v8, s[4:7], s32 offen offset:0 sc1 lds
    v_add_f32 v7, v7, v17
    v_exp_f32 v19, v111
    v_mfma_f32_16x16x32_bf16 a[88:91], v[164:167], v[32:35], a[88:91]
    ds_read_b128 v[28:31], v3 offset:12288
    v_cvt_pk_bf16_f32 v78, v16, v17
    v_mfma_f32_16x16x32_bf16 a[88:91], v[180:183], v[36:39], a[88:91]
    s_waitcnt lgkmcnt(2)
    v_add_f32 v7, v7, v18
    v_add_f32 v7, v7, v19
    v_cvt_pk_bf16_f32 v79, v18, v19
    v_fma_f32 v229, v229, v49, v51
    v_cvt_pk_bf16_f32 v224, v224, v225
    v_mfma_f32_16x16x32_bf16 a[44:47], v[160:163], v[40:43], a[44:47]
    ds_read_b128 v[32:35], v2 offset:18432
    v_cvt_pk_bf16_f32 v228, v228, v229
    v_mfma_f32_16x16x32_bf16 a[44:47], v[176:179], v[44:47], a[44:47]
    buffer_load_dwordx4 v8, s[4:7], s32 offen offset:1024 sc1 lds
    v_cvt_f32_i32 v226, v226
    v_cvt_f32_i32 v227, v227
    v_cvt_f32_i32 v230, v230
    v_mfma_f32_16x16x32_bf16 a[92:95], v[164:167], v[40:43], a[92:95]
    ds_read_b128 v[36:39], v3 offset:18432
    v_cvt_f32_i32 v231, v231
    v_mfma_f32_16x16x32_bf16 a[92:95], v[180:183], v[44:47], a[92:95]
    s_waitcnt lgkmcnt(2)
    v_fma_f32 v226, v226, v56, v58
    v_fma_f32 v227, v227, v57, v59
    v_fma_f32 v230, v230, v56, v58
    v_fma_f32 v231, v231, v57, v59
    v_cvt_pk_bf16_f32 v225, v226, v227
    v_mfma_f32_16x16x32_bf16 v[88:91], v[24:27], a[240:243], v[136:139]
    ds_read_b128 v[40:43], v2 offset:12416
    v_cvt_pk_bf16_f32 v229, v230, v231
    v_mfma_f32_16x16x32_bf16 v[88:91], v[28:31], a[244:247], v[88:91]
    buffer_load_dwordx4 v8, s[4:7], s32 offen offset:2048 sc1 lds
    s_waitcnt vmcnt(14)
    v_cvt_f32_i32 v232, v232
    v_cvt_f32_i32 v233, v233
    v_mfma_f32_16x16x32_bf16 v[92:95], v[24:27], v[200:203], v[140:143]
    ds_read_b128 v[44:47], v3 offset:12416
    v_cvt_f32_i32 v236, v236
    v_mfma_f32_16x16x32_bf16 v[92:95], v[28:31], v[204:207], v[92:95]
    s_waitcnt lgkmcnt(2)
    v_cvt_f32_i32 v237, v237
    v_fma_f32 v232, v232, v48, v50
    v_fma_f32 v233, v233, v49, v51
    v_fma_f32 v236, v236, v48, v50
    v_fma_f32 v237, v237, v49, v51
    v_mfma_f32_16x16x32_bf16 v[120:123], v[32:35], a[240:243], v[136:139]
    ds_read_b128 v[24:27], v2 offset:18560
    v_cvt_pk_bf16_f32 v232, v232, v233
    v_mfma_f32_16x16x32_bf16 v[120:123], v[36:39], a[244:247], v[120:123]
    s_add_u32 s32, s32, 24576
    s_sub_u32 s57, s32, 196608
    s_min_u32 s32, s32, s57
    v_cvt_pk_bf16_f32 v236, v236, v237
    v_cvt_f32_i32 v234, v234
    v_cvt_f32_i32 v235, v235
    v_mfma_f32_16x16x32_bf16 v[124:127], v[32:35], v[200:203], v[140:143]
    ds_read_b128 v[28:31], v3 offset:18560
    v_cvt_f32_i32 v238, v238
    v_mfma_f32_16x16x32_bf16 v[124:127], v[36:39], v[204:207], v[124:127]
    s_waitcnt lgkmcnt(2)
    v_cvt_f32_i32 v239, v239
    v_fma_f32 v234, v234, v56, v58
    v_fma_f32 v235, v235, v57, v59
    v_fma_f32 v238, v238, v56, v58
    v_fma_f32 v239, v239, v57, v59
    v_mfma_f32_16x16x32_bf16 v[88:91], v[40:43], a[248:251], v[88:91]
    ds_read_b128 v[32:35], v2 offset:12544
    v_cvt_pk_bf16_f32 v233, v234, v235
    v_mfma_f32_16x16x32_bf16 v[88:91], v[44:47], a[252:255], v[88:91]
    s_add_u32 s26, s26, 36864
    s_sub_u32 s57, s26, 147456
    s_min_u32 s26, s26, s57
    v_cvt_pk_bf16_f32 v237, v238, v239
    v_mfma_f32_16x16x32_bf16 v[92:95], v[40:43], v[208:211], v[92:95]
    ds_read_b128 v[36:39], v3 offset:12544
    ds_read_b128 v[48:51], v10 offset:1152
    v_mfma_f32_16x16x32_bf16 v[92:95], v[44:47], v[212:215], v[92:95]
    s_waitcnt lgkmcnt(3)
    s_waitcnt vmcnt(12)
    v_cvt_f32_i32 v240, v240
    v_cvt_f32_i32 v241, v241
    v_cvt_f32_i32 v244, v244
    v_mfma_f32_16x16x32_bf16 v[120:123], v[24:27], a[248:251], v[120:123]
    ds_read_b128 v[40:43], v2 offset:18688
    ds_read_b128 v[56:59], v23 offset:0
    v_mfma_f32_16x16x32_bf16 v[120:123], v[28:31], a[252:255], v[120:123]
    v_add_u32 v10, 1792, v10
    v_cvt_f32_i32 v245, v245
    v_fma_f32 v240, v240, v60, v62
    v_fma_f32 v241, v241, v61, v63
    v_fma_f32 v244, v244, v60, v62
    v_mfma_f32_16x16x32_bf16 v[124:127], v[24:27], v[208:211], v[124:127]
    ds_read_b128 v[44:47], v3 offset:18688
    v_fma_f32 v245, v245, v61, v63
    v_mfma_f32_16x16x32_bf16 v[124:127], v[28:31], v[212:215], v[124:127]
    s_waitcnt lgkmcnt(4)
    v_cvt_pk_bf16_f32 v226, v240, v241
    v_cvt_pk_bf16_f32 v230, v244, v245
    s_waitcnt lgkmcnt(3)
    v_cvt_f32_i32 v242, v242
    v_cvt_f32_i32 v243, v243
    v_cvt_f32_i32 v246, v246
    v_mfma_f32_16x16x32_bf16 v[88:91], v[32:35], v[192:195], v[88:91]
    v_add_u32 v2, 49152, v2
    v_add_u32 v3, 49152, v3
    ds_read_b128 v[24:27], v2 offset:0
    v_mfma_f32_16x16x32_bf16 v[88:91], v[36:39], v[196:199], v[88:91]
    v_cvt_f32_i32 v247, v247
    v_fma_f32 v242, v242, v48, v50
    v_fma_f32 v243, v243, v49, v51
    v_fma_f32 v246, v246, v48, v50
    v_fma_f32 v247, v247, v49, v51
    v_mfma_f32_16x16x32_bf16 v[92:95], v[32:35], v[216:219], v[92:95]
    ds_read_b128 v[28:31], v3 offset:0
    v_cvt_pk_bf16_f32 v227, v242, v243
    v_mfma_f32_16x16x32_bf16 v[92:95], v[36:39], v[220:223], v[92:95]
    s_waitcnt lgkmcnt(2)
    v_cvt_pk_bf16_f32 v231, v246, v247
    s_waitcnt vmcnt(10)
    v_cvt_f32_i32 v248, v248
    v_cvt_f32_i32 v249, v249
    v_cvt_f32_i32 v252, v252
    v_mfma_f32_16x16x32_bf16 v[120:123], v[40:43], v[192:195], v[120:123]
    ds_read_b128 v[32:35], v2 offset:6144
    v_cvt_f32_i32 v253, v253
    v_mfma_f32_16x16x32_bf16 v[120:123], v[44:47], v[196:199], v[120:123]
    v_fma_f32 v248, v248, v60, v62
    v_fma_f32 v249, v249, v61, v63
    v_fma_f32 v252, v252, v60, v62
    v_fma_f32 v253, v253, v61, v63
    v_cvt_pk_bf16_f32 v234, v248, v249
    v_mfma_f32_16x16x32_bf16 v[124:127], v[40:43], v[216:219], v[124:127]
    ds_read_b128 v[36:39], v3 offset:6144
    v_cvt_pk_bf16_f32 v238, v252, v253
    v_mfma_f32_16x16x32_bf16 v[124:127], v[44:47], v[220:223], v[124:127]
    s_waitcnt lgkmcnt(2)
    v_cvt_f32_i32 v250, v250
    v_cvt_f32_i32 v251, v251
    v_cvt_f32_i32 v254, v254
    v_cvt_f32_i32 v255, v255
    v_fma_f32 v250, v250, v48, v50
    v_fma_f32 v251, v251, v49, v51
    v_fma_f32 v254, v254, v48, v50
    v_fma_f32 v255, v255, v49, v51
    v_cvt_pk_bf16_f32 v235, v250, v251
    v_cvt_pk_bf16_f32 v239, v254, v255
    v_mfma_f32_16x16x32_bf16 v[168:171], v[24:27], a[240:243], v[136:139]
    ds_read_b128 v[40:43], v2 offset:128
    v_mfma_f32_16x16x32_bf16 v[168:171], v[28:31], a[244:247], v[168:171]
    buffer_store_dwordx4 v[224:227], v11, s[4:7], s37 offen offset:0 sc1
    v_mfma_f32_16x16x32_bf16 v[172:175], v[24:27], v[200:203], v[140:143]
    ds_read_b128 v[44:47], v3 offset:128
    v_mfma_f32_16x16x32_bf16 v[172:175], v[28:31], v[204:207], v[172:175]
    s_waitcnt lgkmcnt(2)
    v_exp_f32 v16, v88
    v_exp_f32 v17, v89
    v_mfma_f32_16x16x32_bf16 v[96:99], v[32:35], a[240:243], v[136:139]
    ds_read_b128 v[24:27], v2 offset:6272
    v_mfma_f32_16x16x32_bf16 v[96:99], v[36:39], a[244:247], v[96:99]
    v_exp_f32 v18, v90
    v_add_f32 v6, v6, v16
    v_add_f32 v6, v6, v17
    v_mfma_f32_16x16x32_bf16 v[100:103], v[32:35], v[200:203], v[140:143]
    ds_read_b128 v[28:31], v3 offset:6272
    v_mfma_f32_16x16x32_bf16 v[100:103], v[36:39], v[204:207], v[100:103]
    s_waitcnt lgkmcnt(2)
    v_exp_f32 v19, v91
    v_cvt_pk_bf16_f32 v88, v16, v17
    v_mfma_f32_16x16x32_bf16 v[168:171], v[40:43], a[248:251], v[168:171]
    ds_read_b128 v[32:35], v2 offset:256
    v_mfma_f32_16x16x32_bf16 v[168:171], v[44:47], a[252:255], v[168:171]
    buffer_store_dwordx4 v[228:231], v54, s[4:7], s37 offen offset:768 sc1
    v_mfma_f32_16x16x32_bf16 v[172:175], v[40:43], v[208:211], v[172:175]
    ds_read_b128 v[36:39], v3 offset:256
    v_mfma_f32_16x16x32_bf16 v[172:175], v[44:47], v[212:215], v[172:175]
    s_waitcnt lgkmcnt(2)
    v_exp_f32 v16, v120
    v_add_f32 v6, v6, v18
    v_add_f32 v6, v6, v19
    v_mfma_f32_16x16x32_bf16 v[96:99], v[24:27], a[248:251], v[96:99]
    ds_read_b128 v[40:43], v2 offset:6400
    v_mfma_f32_16x16x32_bf16 v[96:99], v[28:31], a[252:255], v[96:99]
    v_exp_f32 v17, v121
    v_cvt_pk_bf16_f32 v89, v18, v19
    v_mfma_f32_16x16x32_bf16 v[100:103], v[24:27], v[208:211], v[100:103]
    ds_read_b128 v[44:47], v3 offset:6400
    v_mfma_f32_16x16x32_bf16 v[100:103], v[28:31], v[212:215], v[100:103]
    s_waitcnt lgkmcnt(2)
    v_exp_f32 v18, v122
    v_add_f32 v6, v6, v16
    v_add_f32 v6, v6, v17
    v_mfma_f32_16x16x32_bf16 v[168:171], v[32:35], v[192:195], v[168:171]
    ds_read_b128 v[24:27], v2 offset:12288
    v_mfma_f32_16x16x32_bf16 v[168:171], v[36:39], v[196:199], v[168:171]
    buffer_store_dwordx4 v[232:235], v11, s[4:7], s80 offen offset:0 sc1
    v_mfma_f32_16x16x32_bf16 v[172:175], v[32:35], v[216:219], v[172:175]
    ds_read_b128 v[28:31], v3 offset:12288
    v_mfma_f32_16x16x32_bf16 v[172:175], v[36:39], v[220:223], v[172:175]
    s_waitcnt lgkmcnt(2)
    v_exp_f32 v19, v123
    v_cvt_pk_bf16_f32 v90, v16, v17
    v_mfma_f32_16x16x32_bf16 v[96:99], v[40:43], v[192:195], v[96:99]
    ds_read_b128 v[32:35], v2 offset:18432
    v_mfma_f32_16x16x32_bf16 v[96:99], v[44:47], v[196:199], v[96:99]
    v_exp_f32 v16, v92
    v_add_f32 v6, v6, v18
    v_add_f32 v6, v6, v19
    v_mfma_f32_16x16x32_bf16 v[100:103], v[40:43], v[216:219], v[100:103]
    ds_read_b128 v[36:39], v3 offset:18432
    v_mfma_f32_16x16x32_bf16 v[100:103], v[44:47], v[220:223], v[100:103]
    s_waitcnt lgkmcnt(2)
    v_exp_f32 v17, v93
    v_cvt_pk_bf16_f32 v91, v18, v19
    v_mfma_f32_16x16x32_bf16 v[184:187], v[24:27], a[240:243], v[136:139]
    ds_read_b128 v[40:43], v2 offset:12416
    v_mfma_f32_16x16x32_bf16 v[184:187], v[28:31], a[244:247], v[184:187]
    buffer_store_dwordx4 v[236:239], v54, s[4:7], s80 offen offset:768 sc1
    s_branch L_skip2
L_pad2:
    s_branch L_tb1_12
L_skip2:
    v_mfma_f32_16x16x32_bf16 v[188:191], v[24:27], v[200:203], v[140:143]
    ds_read_b128 v[44:47], v3 offset:12416
    v_mfma_f32_16x16x32_bf16 v[188:191], v[28:31], v[204:207], v[188:191]
    s_waitcnt lgkmcnt(2)
    v_exp_f32 v18, v94
    v_add_f32 v7, v7, v16
    v_add_f32 v7, v7, v17
    v_mfma_f32_16x16x32_bf16 v[112:115], v[32:35], a[240:243], v[136:139]
    ds_read_b128 v[24:27], v2 offset:18560
    v_mfma_f32_16x16x32_bf16 v[112:115], v[36:39], a[244:247], v[112:115]
    v_exp_f32 v19, v95
    v_cvt_pk_bf16_f32 v92, v16, v17
    v_mfma_f32_16x16x32_bf16 v[116:119], v[32:35], v[200:203], v[140:143]
    ds_read_b128 v[28:31], v3 offset:18560
    v_mfma_f32_16x16x32_bf16 v[116:119], v[36:39], v[204:207], v[116:119]
    s_waitcnt lgkmcnt(2)
    v_exp_f32 v16, v124
    v_add_f32 v7, v7, v18
    v_add_f32 v7, v7, v19
    v_mfma_f32_16x16x32_bf16 v[184:187], v[40:43], a[248:251], v[184:187]
    ds_read_b128 v[32:35], v2 offset:12544
    v_mfma_f32_16x16x32_bf16 v[184:187], v[44:47], a[252:255], v[184:187]
    buffer_load_dwordx4 v[240:243], v12, s[68:71], s36 offen offset:0 nt
    v_exp_f32 v17, v125
    v_mfma_f32_16x16x32_bf16 v[188:191], v[40:43], v[208:211], v[188:191]
    ds_read_b128 v[36:39], v3 offset:12544
    v_cvt_pk_bf16_f32 v93, v18, v19
    v_mfma_f32_16x16x32_bf16 v[188:191], v[44:47], v[212:215], v[188:191]
    s_waitcnt lgkmcnt(2)
    v_exp_f32 v18, v126
    v_add_f32 v7, v7, v16
    v_add_f32 v7, v7, v17
    v_mfma_f32_16x16x32_bf16 v[112:115], v[24:27], a[248:251], v[112:115]
    ds_read_b128 v[40:43], v2 offset:18688
    v_mfma_f32_16x16x32_bf16 v[112:115], v[28:31], a[252:255], v[112:115]
    buffer_load_dwordx4 v[244:247], v12, s[68:71], s36 offen offset:768 nt
    v_exp_f32 v19, v127
    v_mfma_f32_16x16x32_bf16 v[116:119], v[24:27], v[208:211], v[116:119]
    ds_read_b128 v[44:47], v3 offset:18688
    v_cvt_pk_bf16_f32 v94, v16, v17
    v_mfma_f32_16x16x32_bf16 v[116:119], v[28:31], v[212:215], v[116:119]
    s_waitcnt lgkmcnt(2)
    v_add_f32 v7, v7, v18
    v_add_f32 v7, v7, v19
    v_cvt_pk_bf16_f32 v95, v18, v19
    v_mfma_f32_16x16x32_bf16 v[184:187], v[32:35], v[192:195], v[184:187]
    v_add_u32 v1, 4294918144, v1
    v_add_u32 v21, 4294918144, v21
    v_add_u32 v22, 4294918144, v22
    ds_read_b128 v[24:27], v1 offset:0
    v_mfma_f32_16x16x32_bf16 v[184:187], v[36:39], v[196:199], v[184:187]
    buffer_load_dwordx4 v[248:251], v12, s[68:71], s36 offen offset:1536 nt
    v_exp_f32 v16, v168
    v_mfma_f32_16x16x32_bf16 v[188:191], v[32:35], v[216:219], v[188:191]
    ds_read_b128 v[28:31], v1 offset:12288
    v_mfma_f32_16x16x32_bf16 v[188:191], v[36:39], v[220:223], v[188:191]
    s_waitcnt lgkmcnt(2)
    v_exp_f32 v17, v169
    v_exp_f32 v18, v170
    v_mfma_f32_16x16x32_bf16 v[112:115], v[40:43], v[192:195], v[112:115]
    ds_read_b128 v[32:35], v1 offset:768
    v_add_f32 v6, v6, v16
    v_mfma_f32_16x16x32_bf16 v[112:115], v[44:47], v[196:199], v[112:115]
    buffer_load_dwordx4 v[252:255], v12, s[68:71], s36 offen offset:2304 nt
    v_add_f32 v6, v6, v17
    v_mfma_f32_16x16x32_bf16 v[116:119], v[40:43], v[216:219], v[116:119]
    ds_read_b128 v[36:39], v1 offset:13056
    v_mfma_f32_16x16x32_bf16 v[116:119], v[44:47], v[220:223], v[116:119]
    s_waitcnt lgkmcnt(2)
    v_exp_f32 v19, v171
    v_cvt_pk_bf16_f32 v168, v16, v17
    v_mfma_f32_16x16x32_bf16 a[96:99], v[72:75], v[24:27], 0
    ds_read_b128 v[40:43], v1 offset:1536
    ds_read_b128 v[60:63], v23 offset:16
    v_mfma_f32_16x16x32_bf16 a[96:99], v[88:91], v[28:31], a[96:99]
    s_mov_b32 m0, s56
    v_exp_f32 v16, v96
    v_add_f32 v6, v6, v18
    v_add_f32 v6, v6, v19
    v_mfma_f32_16x16x32_bf16 a[144:147], v[76:79], v[24:27], 0
    ds_read_b128 v[44:47], v1 offset:13824
    s_waitcnt vmcnt(16)
    v_mfma_f32_16x16x32_bf16 a[144:147], v[92:95], v[28:31], a[144:147]
    s_waitcnt lgkmcnt(3)
    v_exp_f32 v17, v97
    v_cvt_pk_bf16_f32 v169, v18, v19
    v_cvt_f32_i32 v144, v144
    v_mfma_f32_16x16x32_bf16 a[100:103], v[72:75], v[32:35], 0
    ds_read_b128 v[24:27], v1 offset:2304
    v_cvt_f32_i32 v148, v148
    v_mfma_f32_16x16x32_bf16 a[100:103], v[88:91], v[36:39], a[100:103]
    buffer_load_dwordx4 v8, s[4:7], s27 offen offset:0 sc1 lds
    v_exp_f32 v18, v98
    v_mfma_f32_16x16x32_bf16 a[148:151], v[76:79], v[32:35], 0
    ds_read_b128 v[28:31], v1 offset:14592
    v_add_f32 v6, v6, v16
    v_mfma_f32_16x16x32_bf16 a[148:151], v[92:95], v[36:39], a[148:151]
    s_waitcnt lgkmcnt(2)
    v_add_f32 v6, v6, v17
    v_exp_f32 v19, v99
    v_cvt_pk_bf16_f32 v170, v16, v17
    v_mfma_f32_16x16x32_bf16 a[104:107], v[72:75], v[40:43], 0
    ds_read_b128 v[32:35], v21 offset:0
    v_cvt_f32_i32 v145, v145
    v_mfma_f32_16x16x32_bf16 a[104:107], v[88:91], v[44:47], a[104:107]
    buffer_load_dwordx4 v8, s[4:7], s27 offen offset:1024 sc1 lds
    v_exp_f32 v16, v172
    v_mfma_f32_16x16x32_bf16 a[152:155], v[76:79], v[40:43], 0
    ds_read_b128 v[36:39], v21 offset:12288
    v_add_f32 v6, v6, v18
    v_mfma_f32_16x16x32_bf16 a[152:155], v[92:95], v[44:47], a[152:155]
    s_waitcnt lgkmcnt(2)
    v_add_f32 v6, v6, v19
    v_exp_f32 v17, v173
    v_cvt_pk_bf16_f32 v171, v18, v19
    v_mfma_f32_16x16x32_bf16 a[108:111], v[72:75], v[24:27], 0
    ds_read_b128 v[40:43], v21 offset:768
    ds_read_b128 v[48:51], v23 offset:32
    v_mfma_f32_16x16x32_bf16 a[108:111], v[88:91], v[28:31], a[108:111]
    buffer_load_dwordx4 v8, s[4:7], s27 offen offset:2048 sc1 lds
    v_exp_f32 v18, v174
    v_mfma_f32_16x16x32_bf16 a[156:159], v[76:79], v[24:27], 0
    ds_read_b128 v[44:47], v21 offset:13056
    v_add_f32 v7, v7, v16
    v_mfma_f32_16x16x32_bf16 a[156:159], v[92:95], v[28:31], a[156:159]
    s_waitcnt lgkmcnt(3)
    v_add_f32 v7, v7, v17
    v_exp_f32 v19, v175
    v_cvt_pk_bf16_f32 v172, v16, v17
    v_mfma_f32_16x16x32_bf16 a[112:115], v[72:75], v[32:35], 0
    ds_read_b128 v[24:27], v21 offset:1536
    v_cvt_f32_i32 v149, v149
    v_mfma_f32_16x16x32_bf16 a[112:115], v[88:91], v[36:39], a[112:115]
    s_add_u32 s27, s27, 24576
    s_sub_u32 s58, s27, 196608
    s_min_u32 s27, s27, s58
    v_exp_f32 v16, v100
    v_mfma_f32_16x16x32_bf16 a[160:163], v[76:79], v[32:35], 0
    ds_read_b128 v[28:31], v21 offset:13824
    v_add_f32 v7, v7, v18
    v_mfma_f32_16x16x32_bf16 a[160:163], v[92:95], v[36:39], a[160:163]
    s_waitcnt lgkmcnt(2)
    v_add_f32 v7, v7, v19
    v_exp_f32 v17, v101
    v_cvt_pk_bf16_f32 v173, v18, v19
    v_mfma_f32_16x16x32_bf16 a[116:119], v[72:75], v[40:43], 0
    ds_read_b128 v[32:35], v21 offset:2304
    v_fma_f32 v144, v144, v56, v58
    v_mfma_f32_16x16x32_bf16 a[116:119], v[88:91], v[44:47], a[116:119]
    s_add_u32 s56, s56, 12288
    v_exp_f32 v18, v102
    v_add_f32 v7, v7, v16
    v_add_f32 v7, v7, v17
    v_mfma_f32_16x16x32_bf16 a[164:167], v[76:79], v[40:43], 0
    ds_read_b128 v[36:39], v21 offset:14592
    v_fma_f32 v148, v148, v57, v59
    v_mfma_f32_16x16x32_bf16 a[164:167], v[92:95], v[44:47], a[164:167]
    s_waitcnt lgkmcnt(2)
    v_exp_f32 v19, v103
    v_cvt_pk_bf16_f32 v174, v16, v17
    v_add_f32 v7, v7, v18
    v_mfma_f32_16x16x32_bf16 a[120:123], v[72:75], v[24:27], 0
    ds_read_b128 v[40:43], v22 offset:0
    v_add_f32 v7, v7, v19
    v_mfma_f32_16x16x32_bf16 a[120:123], v[88:91], v[28:31], a[120:123]
    v_cvt_pk_bf16_f32 v175, v18, v19
    v_fma_f32 v145, v145, v56, v58
    v_fma_f32 v149, v149, v57, v59
    v_cvt_f32_i32 v146, v146
    v_mfma_f32_16x16x32_bf16 a[168:171], v[76:79], v[24:27], 0
    ds_read_b128 v[44:47], v22 offset:12288
    v_cvt_f32_i32 v150, v150
    v_mfma_f32_16x16x32_bf16 a[168:171], v[92:95], v[28:31], a[168:171]
    s_waitcnt lgkmcnt(2)
    v_cvt_f32_i32 v147, v147
    v_cvt_f32_i32 v151, v151
    v_fma_f32 v146, v146, v56, v58
    v_fma_f32 v150, v150, v57, v59
    v_mfma_f32_16x16x32_bf16 a[124:127], v[72:75], v[32:35], 0
    ds_read_b128 v[24:27], v22 offset:768
    v_fma_f32 v147, v147, v56, v58
    v_mfma_f32_16x16x32_bf16 a[124:127], v[88:91], v[36:39], a[124:127]
    v_fma_f32 v151, v151, v57, v59
    v_mfma_f32_16x16x32_bf16 a[172:175], v[76:79], v[32:35], 0
    ds_read_b128 v[28:31], v22 offset:13056
    v_mfma_f32_16x16x32_bf16 a[172:175], v[92:95], v[36:39], a[172:175]
    s_waitcnt lgkmcnt(2)
    v_mfma_f32_16x16x32_bf16 a[128:131], v[72:75], v[40:43], 0
    ds_read_b128 v[32:35], v22 offset:1536
    v_mfma_f32_16x16x32_bf16 a[128:131], v[88:91], v[44:47], a[128:131]
    v_mfma_f32_16x16x32_bf16 a[176:179], v[76:79], v[40:43], 0
    ds_read_b128 v[36:39], v22 offset:13824
    v_mfma_f32_16x16x32_bf16 a[176:179], v[92:95], v[44:47], a[176:179]
    s_waitcnt lgkmcnt(2)
    v_mfma_f32_16x16x32_bf16 a[132:135], v[72:75], v[24:27], 0
    ds_read_b128 v[40:43], v22 offset:2304
    v_mfma_f32_16x16x32_bf16 a[132:135], v[88:91], v[28:31], a[132:135]
    s_waitcnt vmcnt(7)
    s_barrier
    v_mfma_f32_16x16x32_bf16 a[180:183], v[76:79], v[24:27], 0
    ds_read_b128 v[44:47], v22 offset:14592
    v_mfma_f32_16x16x32_bf16 a[180:183], v[92:95], v[28:31], a[180:183]
    s_waitcnt lgkmcnt(2)
    v_mfma_f32_16x16x32_bf16 a[136:139], v[72:75], v[32:35], 0
    v_add_u32 v2, 49152, v2
    v_add_u32 v3, 49152, v3
    s_mov_b32 s28, 98304
    ds_read_b128 v[24:27], v2 offset:0
    v_mfma_f32_16x16x32_bf16 a[136:139], v[88:91], v[36:39], a[136:139]
    v_add_u32 v55, 1, v55
    buffer_store_dword v55, v13, s[20:23], 0 offen sc1
    v_mfma_f32_16x16x32_bf16 a[184:187], v[76:79], v[32:35], 0
    ds_read_b128 v[28:31], v3 offset:0
    v_mfma_f32_16x16x32_bf16 a[184:187], v[92:95], v[36:39], a[184:187]
    s_waitcnt lgkmcnt(2)
    v_mfma_f32_16x16x32_bf16 a[140:143], v[72:75], v[40:43], 0
    ds_read_b128 v[32:35], v2 offset:6144
    v_mfma_f32_16x16x32_bf16 a[140:143], v[88:91], v[44:47], a[140:143]
    v_mfma_f32_16x16x32_bf16 a[188:191], v[76:79], v[40:43], 0
    ds_read_b128 v[36:39], v3 offset:6144
    v_mfma_f32_16x16x32_bf16 a[188:191], v[92:95], v[44:47], a[188:191]
    s_waitcnt lgkmcnt(2)
    s_mov_b32 s31, 5
    v_mfma_f32_16x16x32_bf16 v[64:67], v[24:27], a[192:195], v[128:131]
    s_mov_b32 m0, s56
    ds_read_b128 v[40:43], v2 offset:128
    v_mfma_f32_16x16x32_bf16 v[64:67], v[28:31], a[196:199], v[64:67]
    v_exp_f32 v16, v184
    v_mfma_f32_16x16x32_bf16 v[68:71], v[24:27], a[216:219], v[132:135]
    v_exp_f32 v17, v185
    v_mfma_f32_16x16x32_bf16 v[68:71], v[28:31], a[220:223], v[68:71]
    buffer_load_dwordx4 v8, s[4:7], s27 offen offset:0 sc1 lds
    v_mfma_f32_16x16x32_bf16 v[72:75], v[24:27], a[240:243], v[136:139]
    ds_read_b128 v[44:47], v3 offset:128
    v_mfma_f32_16x16x32_bf16 v[72:75], v[28:31], a[244:247], v[72:75]
    v_exp_f32 v18, v186
    v_mfma_f32_16x16x32_bf16 v[76:79], v[24:27], v[200:203], v[140:143]
    ds_read_b128 v[56:59], v23 offset:48
    v_add_f32 v6, v6, v16
    v_mfma_f32_16x16x32_bf16 v[76:79], v[28:31], v[204:207], v[76:79]
    s_waitcnt lgkmcnt(3)
    buffer_load_dwordx4 v8, s[4:7], s27 offen offset:1024 sc1 lds
    v_mfma_f32_16x16x32_bf16 v[96:99], v[32:35], a[192:195], v[128:131]
    s_waitcnt vmcnt(20)
    ds_read_b128 v[24:27], v2 offset:6272
    v_add_f32 v6, v6, v17
    v_mfma_f32_16x16x32_bf16 v[96:99], v[36:39], a[196:199], v[96:99]
    v_exp_f32 v19, v187
    v_mfma_f32_16x16x32_bf16 v[100:103], v[32:35], a[216:219], v[132:135]
    v_cvt_pk_bf16_f32 v184, v16, v17
    v_cvt_f32_i32 v152, v152
    v_mfma_f32_16x16x32_bf16 v[100:103], v[36:39], a[220:223], v[100:103]
    v_exp_f32 v16, v112
    v_mfma_f32_16x16x32_bf16 v[104:107], v[32:35], a[240:243], v[136:139]
    ds_read_b128 v[28:31], v3 offset:6272
    v_add_f32 v6, v6, v18
    v_mfma_f32_16x16x32_bf16 v[104:107], v[36:39], a[244:247], v[104:107]
    buffer_load_dwordx4 v8, s[4:7], s27 offen offset:2048 sc1 lds
    v_mfma_f32_16x16x32_bf16 v[108:111], v[32:35], v[200:203], v[140:143]
    v_add_f32 v6, v6, v19
    v_cvt_f32_i32 v156, v156
    v_mfma_f32_16x16x32_bf16 v[108:111], v[36:39], v[204:207], v[108:111]
    s_waitcnt lgkmcnt(3)
    v_exp_f32 v17, v113
    v_mfma_f32_16x16x32_bf16 v[64:67], v[40:43], a[200:203], v[64:67]
    s_add_u32 s27, s27, 24576
    ds_read_b128 v[32:35], v2 offset:256
    v_cvt_pk_bf16_f32 v185, v18, v19
    v_mfma_f32_16x16x32_bf16 v[64:67], v[44:47], a[204:207], v[64:67]
    v_exp_f32 v18, v114
    v_mfma_f32_16x16x32_bf16 v[68:71], v[40:43], a[224:227], v[68:71]
    s_sub_u32 s58, s27, 196608
    v_add_f32 v6, v6, v16
    v_add_f32 v6, v6, v17
    v_mfma_f32_16x16x32_bf16 v[68:71], v[44:47], a[228:231], v[68:71]
    v_mfma_f32_16x16x32_bf16 v[72:75], v[40:43], a[248:251], v[72:75]
    ds_read_b128 v[36:39], v3 offset:256
    v_cvt_f32_i32 v153, v153
    v_mfma_f32_16x16x32_bf16 v[72:75], v[44:47], a[252:255], v[72:75]
    s_min_u32 s27, s27, s58
    v_exp_f32 v19, v115
    v_mfma_f32_16x16x32_bf16 v[76:79], v[40:43], v[208:211], v[76:79]
    v_cvt_pk_bf16_f32 v186, v16, v17
    v_mfma_f32_16x16x32_bf16 v[76:79], v[44:47], v[212:215], v[76:79]
    s_waitcnt lgkmcnt(2)
    v_exp_f32 v16, v188
    v_mfma_f32_16x16x32_bf16 v[96:99], v[24:27], a[200:203], v[96:99]
    s_add_u32 s56, s56, 36864
    ds_read_b128 v[40:43], v2 offset:6400
    v_add_f32 v6, v6, v18
    v_mfma_f32_16x16x32_bf16 v[96:99], v[28:31], a[204:207], v[96:99]
    v_add_f32 v6, v6, v19
    v_mfma_f32_16x16x32_bf16 v[100:103], v[24:27], a[224:227], v[100:103]
    s_sub_u32 s58, s56, 147456
    v_exp_f32 v17, v189
    v_mfma_f32_16x16x32_bf16 v[100:103], v[28:31], a[228:231], v[100:103]
    v_add_u32 v23, 1792, v23
    v_cvt_pk_bf16_f32 v187, v18, v19
    v_mfma_f32_16x16x32_bf16 v[104:107], v[24:27], a[248:251], v[104:107]
    s_min_u32 s56, s56, s58
    ds_read_b128 v[44:47], v3 offset:6400
    v_mfma_f32_16x16x32_bf16 v[104:107], v[28:31], a[252:255], v[104:107]
    v_exp_f32 v18, v190
    v_mfma_f32_16x16x32_bf16 v[108:111], v[24:27], v[208:211], v[108:111]
    s_add_u32 s29, s30, 49152
    v_add_f32 v7, v7, v16
    v_mfma_f32_16x16x32_bf16 v[108:111], v[28:31], v[212:215], v[108:111]
    s_waitcnt lgkmcnt(2)
    v_add_f32 v7, v7, v17
    s_mov_b32 m0, s26
    v_mfma_f32_16x16x32_bf16 v[64:67], v[32:35], a[208:211], v[64:67]
    s_sub_u32 s3, s29, 147456
    ds_read_b128 v[24:27], v2 offset:12288
    v_cvt_f32_i32 v157, v157
    v_mfma_f32_16x16x32_bf16 v[64:67], v[36:39], a[212:215], v[64:67]
    v_exp_f32 v19, v191
    v_mfma_f32_16x16x32_bf16 v[68:71], v[32:35], a[232:235], v[68:71]
    v_cvt_pk_bf16_f32 v188, v16, v17
    v_mfma_f32_16x16x32_bf16 v[68:71], v[36:39], a[236:239], v[68:71]
    buffer_load_dwordx4 v8, s[4:7], s32 offen offset:0 sc1 lds
    v_mfma_f32_16x16x32_bf16 v[72:75], v[32:35], v[192:195], v[72:75]
    ds_read_b128 v[28:31], v3 offset:12288
    v_mfma_f32_16x16x32_bf16 v[72:75], v[36:39], v[196:199], v[72:75]
    v_exp_f32 v16, v116
    v_mfma_f32_16x16x32_bf16 v[76:79], v[32:35], v[216:219], v[76:79]
    s_min_u32 s29, s29, s3
    v_add_f32 v7, v7, v18
    v_add_f32 v7, v7, v19
    v_mfma_f32_16x16x32_bf16 v[76:79], v[36:39], v[220:223], v[76:79]
    s_waitcnt lgkmcnt(2)
    buffer_load_dwordx4 v8, s[4:7], s32 offen offset:1024 sc1 lds
    v_mfma_f32_16x16x32_bf16 v[96:99], v[40:43], a[208:211], v[96:99]
    ds_read_b128 v[32:35], v2 offset:18432
    v_fma_f32 v152, v152, v60, v62
    v_mfma_f32_16x16x32_bf16 v[96:99], v[44:47], a[212:215], v[96:99]
    v_exp_f32 v17, v117
    v_mfma_f32_16x16x32_bf16 v[100:103], v[40:43], a[232:235], v[100:103]
    v_cvt_pk_bf16_f32 v189, v18, v19
    v_mfma_f32_16x16x32_bf16 v[100:103], v[44:47], a[236:239], v[100:103]
    v_exp_f32 v18, v118
    v_mfma_f32_16x16x32_bf16 v[104:107], v[40:43], v[192:195], v[104:107]
    s_sub_u32 s3, s29, s30
    ds_read_b128 v[36:39], v3 offset:18432
    v_add_f32 v7, v7, v16
    v_mfma_f32_16x16x32_bf16 v[104:107], v[44:47], v[196:199], v[104:107]
    buffer_load_dwordx4 v8, s[4:7], s32 offen offset:2048 sc1 lds
    v_mfma_f32_16x16x32_bf16 v[108:111], v[40:43], v[216:219], v[108:111]
    v_add_f32 v7, v7, v17
    v_fma_f32 v156, v156, v61, v63
    v_mfma_f32_16x16x32_bf16 v[108:111], v[44:47], v[220:223], v[108:111]
    s_waitcnt lgkmcnt(2)
    v_exp_f32 v19, v119
    v_mfma_f32_16x16x32_bf16 v[80:83], v[24:27], a[192:195], v[128:131]
    s_add_u32 s32, s32, 24576
    ds_read_b128 v[40:43], v2 offset:12416
    v_cvt_pk_bf16_f32 v190, v16, v17
    v_mfma_f32_16x16x32_bf16 v[80:83], v[28:31], a[196:199], v[80:83]
    v_add_f32 v7, v7, v18
    v_add_f32 v7, v7, v19
    v_mfma_f32_16x16x32_bf16 v[84:87], v[24:27], a[216:219], v[132:135]
    s_mov_b32 s30, s29
    v_cvt_pk_bf16_f32 v191, v18, v19
    v_fma_f32 v153, v153, v60, v62
    v_mfma_f32_16x16x32_bf16 v[84:87], v[28:31], a[220:223], v[84:87]
    s_sub_u32 s57, s32, 196608
    v_mfma_f32_16x16x32_bf16 v[88:91], v[24:27], a[240:243], v[136:139]
    ds_read_b128 v[44:47], v3 offset:12416
    v_mfma_f32_16x16x32_bf16 v[88:91], v[28:31], a[244:247], v[88:91]
    s_min_u32 s32, s32, s57
    v_exp_f32 v16, v64
    v_mfma_f32_16x16x32_bf16 v[92:95], v[24:27], v[200:203], v[140:143]
    v_exp_f32 v17, v65
    v_mfma_f32_16x16x32_bf16 v[92:95], v[28:31], v[204:207], v[92:95]
    s_waitcnt lgkmcnt(2)
    v_exp_f32 v18, v66
    v_mfma_f32_16x16x32_bf16 v[112:115], v[32:35], a[192:195], v[128:131]
    s_add_u32 s26, s26, 12288
    ds_read_b128 v[24:27], v2 offset:18560
    v_add_f32 v4, v4, v16
    v_mfma_f32_16x16x32_bf16 v[112:115], v[36:39], a[196:199], v[112:115]
    v_add_f32 v4, v4, v17
    v_add_u32 v1, s3, v1
    v_mfma_f32_16x16x32_bf16 v[116:119], v[32:35], a[216:219], v[132:135]
    s_mov_b32 m0, s26
    v_exp_f32 v19, v67
    v_mfma_f32_16x16x32_bf16 v[116:119], v[36:39], a[220:223], v[116:119]
    v_cvt_pk_bf16_f32 v64, v16, v17
    v_fma_f32 v157, v157, v61, v63
    v_mfma_f32_16x16x32_bf16 v[120:123], v[32:35], a[240:243], v[136:139]
    ds_read_b128 v[28:31], v3 offset:18560
    v_mfma_f32_16x16x32_bf16 v[120:123], v[36:39], a[244:247], v[120:123]
    v_exp_f32 v16, v96
    v_mfma_f32_16x16x32_bf16 v[124:127], v[32:35], v[200:203], v[140:143]
    v_add_f32 v4, v4, v18
    v_add_f32 v4, v4, v19
    v_mfma_f32_16x16x32_bf16 v[124:127], v[36:39], v[204:207], v[124:127]
    s_waitcnt lgkmcnt(2)
    buffer_load_dwordx4 v8, s[4:7], s32 offen offset:0 sc1 lds
    v_mfma_f32_16x16x32_bf16 v[80:83], v[40:43], a[200:203], v[80:83]
    ds_read_b128 v[32:35], v2 offset:12544
    v_add_u32 v21, s3, v21
    v_mfma_f32_16x16x32_bf16 v[80:83], v[44:47], a[204:207], v[80:83]
    v_exp_f32 v17, v97
    v_mfma_f32_16x16x32_bf16 v[84:87], v[40:43], a[224:227], v[84:87]
    v_cvt_pk_bf16_f32 v65, v18, v19
    v_cvt_f32_i32 v154, v154
    v_mfma_f32_16x16x32_bf16 v[84:87], v[44:47], a[228:231], v[84:87]
    buffer_load_dwordx4 v8, s[4:7], s32 offen offset:1024 sc1 lds
    v_mfma_f32_16x16x32_bf16 v[88:91], v[40:43], a[248:251], v[88:91]
    ds_read_b128 v[36:39], v3 offset:12544
    v_cvt_f32_i32 v158, v158
    v_mfma_f32_16x16x32_bf16 v[88:91], v[44:47], a[252:255], v[88:91]
    v_exp_f32 v18, v98
    v_mfma_f32_16x16x32_bf16 v[92:95], v[40:43], v[208:211], v[92:95]
    v_add_f32 v4, v4, v16
    v_add_f32 v4, v4, v17
    v_mfma_f32_16x16x32_bf16 v[92:95], v[44:47], v[212:215], v[92:95]
    s_waitcnt lgkmcnt(2)
    v_exp_f32 v19, v99
    v_mfma_f32_16x16x32_bf16 v[112:115], v[24:27], a[200:203], v[112:115]
    ds_read_b128 v[40:43], v2 offset:18688
    v_cvt_pk_bf16_f32 v66, v16, v17
    v_mfma_f32_16x16x32_bf16 v[112:115], v[28:31], a[204:207], v[112:115]
    buffer_load_dwordx4 v8, s[4:7], s32 offen offset:2048 sc1 lds
    v_mfma_f32_16x16x32_bf16 v[116:119], v[24:27], a[224:227], v[116:119]
    v_exp_f32 v16, v68
    v_mfma_f32_16x16x32_bf16 v[116:119], v[28:31], a[228:231], v[116:119]
    v_add_f32 v4, v4, v18
    v_add_u32 v22, s3, v22
    v_mfma_f32_16x16x32_bf16 v[120:123], v[24:27], a[248:251], v[120:123]
    ds_read_b128 v[44:47], v3 offset:18688
    v_add_f32 v4, v4, v19
    v_mfma_f32_16x16x32_bf16 v[120:123], v[28:31], a[252:255], v[120:123]
    s_waitcnt lgkmcnt(2)
    v_exp_f32 v17, v69
    v_mfma_f32_16x16x32_bf16 v[124:127], v[24:27], v[208:211], v[124:127]
    s_waitcnt vmcnt(39)
    v_cvt_pk_bf16_f32 v67, v18, v19
    s_mov_b32 s32, 196608
    v_mfma_f32_16x16x32_bf16 v[124:127], v[28:31], v[212:215], v[124:127]
    s_barrier
    v_cvt_f32_i32 v155, v155
    v_mfma_f32_16x16x32_bf16 v[80:83], v[32:35], a[208:211], v[80:83]
    s_add_u32 s26, s26, 36864
    ds_read_b128 v[24:27], v1 offset:0
    v_cvt_f32_i32 v159, v159
    v_mfma_f32_16x16x32_bf16 v[80:83], v[36:39], a[212:215], v[80:83]
    s_sub_u32 s57, s26, 147456
    v_exp_f32 v18, v70
    v_mfma_f32_16x16x32_bf16 v[84:87], v[32:35], a[232:235], v[84:87]
    v_add_f32 v5, v5, v16
    v_add_f32 v5, v5, v17
    v_mfma_f32_16x16x32_bf16 v[84:87], v[36:39], a[236:239], v[84:87]
    v_exp_f32 v19, v71
    v_mfma_f32_16x16x32_bf16 v[88:91], v[32:35], v[192:195], v[88:91]
    s_min_u32 s26, s26, s57
    ds_read_b128 v[28:31], v1 offset:12288
    v_cvt_pk_bf16_f32 v68, v16, v17
    v_mfma_f32_16x16x32_bf16 v[88:91], v[36:39], v[196:199], v[88:91]
    v_exp_f32 v16, v100
    v_mfma_f32_16x16x32_bf16 v[92:95], v[32:35], v[216:219], v[92:95]
    v_add_f32 v5, v5, v18
    v_add_f32 v5, v5, v19
    v_mfma_f32_16x16x32_bf16 v[92:95], v[36:39], v[220:223], v[92:95]
    s_waitcnt lgkmcnt(2)
    v_exp_f32 v17, v101
    v_mfma_f32_16x16x32_bf16 v[112:115], v[40:43], a[208:211], v[112:115]
    ds_read_b128 v[32:35], v1 offset:768
    v_cvt_pk_bf16_f32 v69, v18, v19
    v_mfma_f32_16x16x32_bf16 v[112:115], v[44:47], a[212:215], v[112:115]
    v_exp_f32 v18, v102
    v_mfma_f32_16x16x32_bf16 v[116:119], v[40:43], a[232:235], v[116:119]
    v_add_f32 v5, v5, v16
    v_add_f32 v5, v5, v17
    v_mfma_f32_16x16x32_bf16 v[116:119], v[44:47], a[236:239], v[116:119]
    v_exp_f32 v19, v103
    v_mfma_f32_16x16x32_bf16 v[120:123], v[40:43], v[192:195], v[120:123]
    ds_read_b128 v[36:39], v1 offset:13056
    v_fma_f32 v154, v154, v60, v62
    v_mfma_f32_16x16x32_bf16 v[120:123], v[44:47], v[196:199], v[120:123]
    v_cvt_pk_bf16_f32 v70, v16, v17
    v_add_f32 v5, v5, v18
    v_mfma_f32_16x16x32_bf16 v[124:127], v[40:43], v[216:219], v[124:127]
    v_add_f32 v5, v5, v19
    v_cvt_pk_bf16_f32 v71, v18, v19
    v_mfma_f32_16x16x32_bf16 v[124:127], v[44:47], v[220:223], v[124:127]
    s_waitcnt lgkmcnt(2)
    v_mfma_f32_16x16x32_bf16 a[96:99], v[168:171], v[24:27], a[96:99]
    ds_read_b128 v[40:43], v1 offset:1536
    s_add_u32 s29, s28, 49152
    v_mfma_f32_16x16x32_bf16 a[96:99], v[184:187], v[28:31], a[96:99]
    s_mov_b32 m0, s56
    s_sub_u32 s3, s29, 147456
    s_min_u32 s29, s29, s3
    s_sub_u32 s3, s29, s28
    s_mov_b32 s28, s29
    v_mfma_f32_16x16x32_bf16 a[144:147], v[172:175], v[24:27], a[144:147]
    ds_read_b128 v[44:47], v1 offset:13824
    v_add_u32 v2, s3, v2
    v_mfma_f32_16x16x32_bf16 a[144:147], v[188:191], v[28:31], a[144:147]
    s_waitcnt lgkmcnt(2)
    v_add_u32 v3, s3, v3
    v_exp_f32 v16, v72
    v_fma_f32 v158, v158, v61, v63
    v_mfma_f32_16x16x32_bf16 a[100:103], v[168:171], v[32:35], a[100:103]
    ds_read_b128 v[24:27], v1 offset:2304
    v_fma_f32 v155, v155, v60, v62
    v_mfma_f32_16x16x32_bf16 a[100:103], v[184:187], v[36:39], a[100:103]
    buffer_load_dwordx4 v8, s[4:7], s27 offen offset:0 sc1 lds
    v_exp_f32 v17, v73
    v_mfma_f32_16x16x32_bf16 a[148:151], v[172:175], v[32:35], a[148:151]
    ds_read_b128 v[28:31], v1 offset:14592
    v_fma_f32 v159, v159, v61, v63
    v_mfma_f32_16x16x32_bf16 a[148:151], v[188:191], v[36:39], a[148:151]
    s_waitcnt lgkmcnt(2)
    v_exp_f32 v18, v74
    v_add_f32 v6, v6, v16
    v_add_f32 v6, v6, v17
    v_mfma_f32_16x16x32_bf16 a[104:107], v[168:171], v[40:43], a[104:107]
    ds_read_b128 v[32:35], v21 offset:0
    v_cvt_pk_bf16_f32 v144, v144, v148
    v_mfma_f32_16x16x32_bf16 a[104:107], v[184:187], v[44:47], a[104:107]
    buffer_load_dwordx4 v8, s[4:7], s27 offen offset:1024 sc1 lds
    v_exp_f32 v19, v75
    v_mfma_f32_16x16x32_bf16 a[152:155], v[172:175], v[40:43], a[152:155]
    ds_read_b128 v[36:39], v21 offset:12288
    v_cvt_pk_bf16_f32 v72, v16, v17
    v_mfma_f32_16x16x32_bf16 a[152:155], v[188:191], v[44:47], a[152:155]
    s_waitcnt lgkmcnt(2)
    v_exp_f32 v16, v104
    v_add_f32 v6, v6, v18
    v_add_f32 v6, v6, v19
    v_mfma_f32_16x16x32_bf16 a[108:111], v[168:171], v[24:27], a[108:111]
    ds_read_b128 v[40:43], v21 offset:768
    v_cvt_pk_bf16_f32 v148, v145, v149
    v_mfma_f32_16x16x32_bf16 a[108:111], v[184:187], v[28:31], a[108:111]
    buffer_load_dwordx4 v8, s[4:7], s27 offen offset:2048 sc1 lds
    v_exp_f32 v17, v105
    v_mfma_f32_16x16x32_bf16 a[156:159], v[172:175], v[24:27], a[156:159]
    ds_read_b128 v[44:47], v21 offset:13056
    v_cvt_pk_bf16_f32 v73, v18, v19
    v_mfma_f32_16x16x32_bf16 a[156:159], v[188:191], v[28:31], a[156:159]
    s_waitcnt lgkmcnt(2)
    v_exp_f32 v18, v106
    v_add_f32 v6, v6, v16
    v_add_f32 v6, v6, v17
    v_mfma_f32_16x16x32_bf16 a[112:115], v[168:171], v[32:35], a[112:115]
    ds_read_b128 v[24:27], v21 offset:1536
    v_cvt_pk_bf16_f32 v145, v152, v156
    v_mfma_f32_16x16x32_bf16 a[112:115], v[184:187], v[36:39], a[112:115]
    s_add_u32 s27, s27, 24576
    s_sub_u32 s58, s27, 196608
    s_min_u32 s27, s27, s58
    s_add_u32 s56, s56, 12288
    v_cvt_pk_bf16_f32 v149, v153, v157
    v_mfma_f32_16x16x32_bf16 a[160:163], v[172:175], v[32:35], a[160:163]
    ds_read_b128 v[28:31], v21 offset:13824
    v_cvt_pk_bf16_f32 v152, v146, v150
    v_mfma_f32_16x16x32_bf16 a[160:163], v[188:191], v[36:39], a[160:163]
    s_waitcnt lgkmcnt(2)
    v_exp_f32 v19, v107
    v_cvt_pk_bf16_f32 v74, v16, v17
    v_cvt_pk_bf16_f32 v153, v154, v158
    v_mfma_f32_16x16x32_bf16 a[116:119], v[168:171], v[40:43], a[116:119]
    ds_read_b128 v[32:35], v21 offset:2304
    v_cvt_pk_bf16_f32 v156, v147, v151
    v_mfma_f32_16x16x32_bf16 a[116:119], v[184:187], v[44:47], a[116:119]
    s_mov_b32 m0, s56
    v_exp_f32 v16, v76
    v_add_f32 v6, v6, v18
    v_add_f32 v6, v6, v19
    v_mfma_f32_16x16x32_bf16 a[164:167], v[172:175], v[40:43], a[164:167]
    ds_read_b128 v[36:39], v21 offset:14592
    v_cvt_pk_bf16_f32 v157, v155, v159
    v_mfma_f32_16x16x32_bf16 a[164:167], v[188:191], v[44:47], a[164:167]
    s_waitcnt lgkmcnt(2)
    v_exp_f32 v17, v77
    v_cvt_pk_bf16_f32 v75, v18, v19
    s_waitcnt vmcnt(18)
    v_mfma_f32_16x16x32_bf16 a[120:123], v[168:171], v[24:27], a[120:123]
    ds_read_b128 v[40:43], v22 offset:0
    v_cvt_f32_i32 v240, v240
    v_mfma_f32_16x16x32_bf16 a[120:123], v[184:187], v[28:31], a[120:123]
    buffer_load_dwordx4 v8, s[4:7], s27 offen offset:0 sc1 lds
    v_exp_f32 v18, v78
    v_mfma_f32_16x16x32_bf16 a[168:171], v[172:175], v[24:27], a[168:171]
    ds_read_b128 v[44:47], v22 offset:12288
    v_add_f32 v7, v7, v16
    v_mfma_f32_16x16x32_bf16 a[168:171], v[188:191], v[28:31], a[168:171]
    s_waitcnt lgkmcnt(2)
    v_add_f32 v7, v7, v17
    v_exp_f32 v19, v79
    v_cvt_pk_bf16_f32 v76, v16, v17
    v_mfma_f32_16x16x32_bf16 a[124:127], v[168:171], v[32:35], a[124:127]
    ds_read_b128 v[24:27], v22 offset:768
    v_cvt_f32_i32 v244, v244
    v_mfma_f32_16x16x32_bf16 a[124:127], v[184:187], v[36:39], a[124:127]
    buffer_load_dwordx4 v8, s[4:7], s27 offen offset:1024 sc1 lds
    v_exp_f32 v16, v108
    v_mfma_f32_16x16x32_bf16 a[172:175], v[172:175], v[32:35], a[172:175]
    ds_read_b128 v[28:31], v22 offset:13056
    v_add_f32 v7, v7, v18
    v_mfma_f32_16x16x32_bf16 a[172:175], v[188:191], v[36:39], a[172:175]
    s_waitcnt lgkmcnt(2)
    v_add_f32 v7, v7, v19
    v_exp_f32 v17, v109
    v_cvt_pk_bf16_f32 v77, v18, v19
    v_mfma_f32_16x16x32_bf16 a[128:131], v[168:171], v[40:43], a[128:131]
    ds_read_b128 v[32:35], v22 offset:1536
    v_cvt_f32_i32 v241, v241
    v_mfma_f32_16x16x32_bf16 a[128:131], v[184:187], v[44:47], a[128:131]
    buffer_load_dwordx4 v8, s[4:7], s27 offen offset:2048 sc1 lds
    v_exp_f32 v18, v110
    v_mfma_f32_16x16x32_bf16 a[176:179], v[172:175], v[40:43], a[176:179]
    ds_read_b128 v[36:39], v22 offset:13824
    v_add_f32 v7, v7, v16
    v_mfma_f32_16x16x32_bf16 a[176:179], v[188:191], v[44:47], a[176:179]
    s_waitcnt lgkmcnt(2)
    v_add_f32 v7, v7, v17
    v_exp_f32 v19, v111
    v_cvt_pk_bf16_f32 v78, v16, v17
    v_mfma_f32_16x16x32_bf16 a[132:135], v[168:171], v[24:27], a[132:135]
    ds_read_b128 v[40:43], v22 offset:2304
    v_mfma_f32_16x16x32_bf16 a[132:135], v[184:187], v[28:31], a[132:135]
    s_waitcnt vmcnt(6)
    s_barrier
    v_exp_f32 v16, v80
    s_branch L_skip3
L_pad3:
    s_branch L_tb1_11
L_skip3:
    v_mfma_f32_16x16x32_bf16 a[180:183], v[172:175], v[24:27], a[180:183]
    ds_read_b128 v[44:47], v22 offset:14592
    v_add_f32 v7, v7, v18
    v_mfma_f32_16x16x32_bf16 a[180:183], v[188:191], v[28:31], a[180:183]
    s_waitcnt lgkmcnt(2)
    v_add_f32 v7, v7, v19
    v_exp_f32 v17, v81
    v_cvt_pk_bf16_f32 v79, v18, v19
    v_mfma_f32_16x16x32_bf16 a[136:139], v[168:171], v[32:35], a[136:139]
    ds_read_b128 v[24:27], v2 offset:0
    v_mfma_f32_16x16x32_bf16 a[136:139], v[184:187], v[36:39], a[136:139]
    s_mov_b32 s27, 208896
    s_add_u32 s56, s56, 36864
    s_sub_u32 s58, s56, 147456
    s_min_u32 s56, s56, s58
    v_mfma_f32_16x16x32_bf16 a[184:187], v[172:175], v[32:35], a[184:187]
    ds_read_b128 v[28:31], v3 offset:0
    v_mfma_f32_16x16x32_bf16 a[184:187], v[188:191], v[36:39], a[184:187]
    s_waitcnt lgkmcnt(2)
    v_exp_f32 v18, v82
    v_add_f32 v4, v4, v16
    v_add_f32 v4, v4, v17
    v_mfma_f32_16x16x32_bf16 a[140:143], v[168:171], v[40:43], a[140:143]
    ds_read_b128 v[32:35], v2 offset:6144
    v_mfma_f32_16x16x32_bf16 a[140:143], v[184:187], v[44:47], a[140:143]
    v_exp_f32 v19, v83
    v_cvt_pk_bf16_f32 v80, v16, v17
    v_mfma_f32_16x16x32_bf16 a[188:191], v[172:175], v[40:43], a[188:191]
    ds_read_b128 v[36:39], v3 offset:6144
    v_mfma_f32_16x16x32_bf16 a[188:191], v[188:191], v[44:47], a[188:191]
    s_waitcnt lgkmcnt(2)
    v_exp_f32 v16, v112
    v_add_f32 v4, v4, v18
    v_add_f32 v4, v4, v19
    v_exp_f32 v17, v113
    v_cvt_pk_bf16_f32 v81, v18, v19
    v_exp_f32 v18, v114
    v_add_f32 v4, v4, v16
    v_add_f32 v4, v4, v17
    v_exp_f32 v19, v115
    v_cvt_pk_bf16_f32 v82, v16, v17
    v_exp_f32 v16, v84
    v_add_f32 v4, v4, v18
    v_add_f32 v4, v4, v19
    v_exp_f32 v17, v85
    v_cvt_pk_bf16_f32 v83, v18, v19
    v_exp_f32 v18, v86
    v_add_f32 v5, v5, v16
    v_add_f32 v5, v5, v17
    v_exp_f32 v19, v87
    v_cvt_pk_bf16_f32 v84, v16, v17
    v_exp_f32 v16, v116
    v_add_f32 v5, v5, v18
    v_add_f32 v5, v5, v19
    v_exp_f32 v17, v117
    v_cvt_pk_bf16_f32 v85, v18, v19
    v_exp_f32 v18, v118
    v_add_f32 v5, v5, v16
    v_add_f32 v5, v5, v17
    v_exp_f32 v19, v119
    v_cvt_pk_bf16_f32 v86, v16, v17
    v_add_f32 v5, v5, v18
    v_add_f32 v5, v5, v19
    v_cvt_pk_bf16_f32 v87, v18, v19
    v_mfma_f32_16x16x32_bf16 v[160:163], v[24:27], a[192:195], v[128:131]
    ds_read_b128 v[40:43], v2 offset:128
    v_bfe_u32 v53, v8, 4, 6
    v_mfma_f32_16x16x32_bf16 v[160:163], v[28:31], a[196:199], v[160:163]
    v_exp_f32 v16, v88
    v_mfma_f32_16x16x32_bf16 v[164:167], v[24:27], a[216:219], v[132:135]
    v_lshlrev_b32 v53, 2, v53
    v_cvt_f32_i32 v245, v245
    v_mfma_f32_16x16x32_bf16 v[164:167], v[28:31], a[220:223], v[164:167]
    buffer_load_dword v52, v53, s[20:23], 0 offen sc1
    v_mfma_f32_16x16x32_bf16 v[168:171], v[24:27], a[240:243], v[136:139]
    ds_read_b128 v[44:47], v3 offset:128
    v_fma_f32 v240, v240, v48, v50
    v_mfma_f32_16x16x32_bf16 v[168:171], v[28:31], a[244:247], v[168:171]
    v_exp_f32 v17, v89
    v_mfma_f32_16x16x32_bf16 v[172:175], v[24:27], v[200:203], v[140:143]
    v_exp_f32 v18, v90
    v_mfma_f32_16x16x32_bf16 v[172:175], v[28:31], v[204:207], v[172:175]
    s_waitcnt lgkmcnt(2)
    v_add_f32 v6, v6, v16
    v_add_f32 v6, v6, v17
    v_mfma_f32_16x16x32_bf16 v[96:99], v[32:35], a[192:195], v[128:131]
    ds_read_b128 v[24:27], v2 offset:6272
    v_fma_f32 v244, v244, v49, v51
    v_mfma_f32_16x16x32_bf16 v[96:99], v[36:39], a[196:199], v[96:99]
    s_add_u32 s33, s33, 196608
    v_exp_f32 v19, v91
    v_mfma_f32_16x16x32_bf16 v[100:103], v[32:35], a[216:219], v[132:135]
    s_sub_u32 s34, s33, 1572864
    v_cvt_pk_bf16_f32 v88, v16, v17
    v_fma_f32 v241, v241, v48, v50
    v_mfma_f32_16x16x32_bf16 v[100:103], v[36:39], a[220:223], v[100:103]
    s_min_u32 s33, s33, s34
    v_exp_f32 v16, v120
    v_mfma_f32_16x16x32_bf16 v[104:107], v[32:35], a[240:243], v[136:139]
    ds_read_b128 v[28:31], v3 offset:6272
    v_add_f32 v6, v6, v18
    v_mfma_f32_16x16x32_bf16 v[104:107], v[36:39], a[244:247], v[104:107]
    s_add_u32 s34, s33, 3072
    v_add_f32 v6, v6, v19
    v_fma_f32 v245, v245, v49, v51
    v_mfma_f32_16x16x32_bf16 v[108:111], v[32:35], v[200:203], v[140:143]
    v_exp_f32 v17, v121
    v_mfma_f32_16x16x32_bf16 v[108:111], v[36:39], v[204:207], v[108:111]
    s_waitcnt lgkmcnt(2)
    v_cvt_f32_i32 v242, v242
    v_cvt_pk_bf16_f32 v89, v18, v19
    v_mfma_f32_16x16x32_bf16 v[160:163], v[40:43], a[200:203], v[160:163]
    s_add_u32 s37, s37, 196608
    ds_read_b128 v[32:35], v2 offset:256
    v_cvt_f32_i32 v246, v246
    v_mfma_f32_16x16x32_bf16 v[160:163], v[44:47], a[204:207], v[160:163]
    v_exp_f32 v18, v122
    v_mfma_f32_16x16x32_bf16 v[164:167], v[40:43], a[224:227], v[164:167]
    s_add_u32 s80, s80, 196608
    v_add_f32 v6, v6, v16
    v_cvt_f32_i32 v243, v243
    v_mfma_f32_16x16x32_bf16 v[164:167], v[44:47], a[228:231], v[164:167]
    v_add_f32 v6, v6, v17
    v_cvt_f32_i32 v247, v247
    v_mfma_f32_16x16x32_bf16 v[168:171], v[40:43], a[248:251], v[168:171]
    ds_read_b128 v[36:39], v3 offset:256
    v_fma_f32 v242, v242, v48, v50
    v_mfma_f32_16x16x32_bf16 v[168:171], v[44:47], a[252:255], v[168:171]
    v_exp_f32 v19, v123
    v_mfma_f32_16x16x32_bf16 v[172:175], v[40:43], v[208:211], v[172:175]
    v_cvt_pk_bf16_f32 v90, v16, v17
    v_mfma_f32_16x16x32_bf16 v[172:175], v[44:47], v[212:215], v[172:175]
    s_waitcnt lgkmcnt(2)
    buffer_load_dwordx4 v[224:227], v9, s[64:67], s33 offen offset:0 nt
    v_mfma_f32_16x16x32_bf16 v[96:99], v[24:27], a[200:203], v[96:99]
    ds_read_b128 v[40:43], v2 offset:6400
    v_fma_f32 v246, v246, v49, v51
    v_mfma_f32_16x16x32_bf16 v[96:99], v[28:31], a[204:207], v[96:99]
    v_exp_f32 v16, v92
    v_mfma_f32_16x16x32_bf16 v[100:103], v[24:27], a[224:227], v[100:103]
    v_add_f32 v6, v6, v18
    v_add_f32 v6, v6, v19
    v_mfma_f32_16x16x32_bf16 v[100:103], v[28:31], a[228:231], v[100:103]
    buffer_load_dwordx4 v[228:231], v9, s[64:67], s33 offen offset:1536 nt
    v_mfma_f32_16x16x32_bf16 v[104:107], v[24:27], a[248:251], v[104:107]
    ds_read_b128 v[44:47], v3 offset:6400
    v_fma_f32 v243, v243, v48, v50
    v_mfma_f32_16x16x32_bf16 v[104:107], v[28:31], a[252:255], v[104:107]
    v_exp_f32 v17, v93
    v_mfma_f32_16x16x32_bf16 v[108:111], v[24:27], v[208:211], v[108:111]
    s_add_u32 s29, s30, 49152
    v_cvt_pk_bf16_f32 v91, v18, v19
    v_fma_f32 v247, v247, v49, v51
    v_mfma_f32_16x16x32_bf16 v[108:111], v[28:31], v[212:215], v[108:111]
    s_waitcnt lgkmcnt(2)
    buffer_load_dwordx4 v[232:235], v9, s[64:67], s34 offen offset:0 nt
    v_mfma_f32_16x16x32_bf16 v[160:163], v[32:35], a[208:211], v[160:163]
    s_sub_u32 s3, s29, 147456
    ds_read_b128 v[24:27], v2 offset:12288
    v_mfma_f32_16x16x32_bf16 v[160:163], v[36:39], a[212:215], v[160:163]
    v_exp_f32 v18, v94
    v_mfma_f32_16x16x32_bf16 v[164:167], v[32:35], a[232:235], v[164:167]
    v_add_f32 v7, v7, v16
    v_add_f32 v7, v7, v17
    v_mfma_f32_16x16x32_bf16 v[164:167], v[36:39], a[236:239], v[164:167]
    v_exp_f32 v19, v95
    v_mfma_f32_16x16x32_bf16 v[168:171], v[32:35], v[192:195], v[168:171]
    ds_read_b128 v[28:31], v3 offset:12288
    v_cvt_pk_bf16_f32 v92, v16, v17
    v_mfma_f32_16x16x32_bf16 v[168:171], v[36:39], v[196:199], v[168:171]
    buffer_load_dwordx4 v[236:239], v9, s[64:67], s34 offen offset:1536 nt
    v_mfma_f32_16x16x32_bf16 v[172:175], v[32:35], v[216:219], v[172:175]
    s_min_u32 s29, s29, s3
    v_exp_f32 v16, v124
    v_mfma_f32_16x16x32_bf16 v[172:175], v[36:39], v[220:223], v[172:175]
    s_waitcnt lgkmcnt(2)
    v_add_f32 v7, v7, v18
    v_add_f32 v7, v7, v19
    v_mfma_f32_16x16x32_bf16 v[96:99], v[40:43], a[208:211], v[96:99]
    ds_read_b128 v[32:35], v2 offset:18432
    v_mfma_f32_16x16x32_bf16 v[96:99], v[44:47], a[212:215], v[96:99]
    v_exp_f32 v17, v125
    v_mfma_f32_16x16x32_bf16 v[100:103], v[40:43], a[232:235], v[100:103]
    ds_read_b128 v[48:51], v10 offset:0
    v_cvt_pk_bf16_f32 v93, v18, v19
    v_mfma_f32_16x16x32_bf16 v[100:103], v[44:47], a[236:239], v[100:103]
    v_exp_f32 v18, v126
    v_mfma_f32_16x16x32_bf16 v[104:107], v[40:43], v[192:195], v[104:107]
    s_sub_u32 s3, s29, s30
    ds_read_b128 v[36:39], v3 offset:18432
    v_cvt_pk_bf16_f32 v146, v240, v244
    v_mfma_f32_16x16x32_bf16 v[104:107], v[44:47], v[196:199], v[104:107]
    v_add_f32 v7, v7, v16
    v_add_f32 v7, v7, v17
    v_mfma_f32_16x16x32_bf16 v[108:111], v[40:43], v[216:219], v[108:111]
    v_exp_f32 v19, v127
    v_mfma_f32_16x16x32_bf16 v[108:111], v[44:47], v[220:223], v[108:111]
    s_waitcnt lgkmcnt(3)
    v_cvt_pk_bf16_f32 v150, v241, v245
    v_cvt_pk_bf16_f32 v154, v242, v246
    v_mfma_f32_16x16x32_bf16 v[176:179], v[24:27], a[192:195], v[128:131]
    ds_read_b128 v[40:43], v2 offset:12416
    v_cvt_pk_bf16_f32 v94, v16, v17
    v_mfma_f32_16x16x32_bf16 v[176:179], v[28:31], a[196:199], v[176:179]
    v_add_f32 v7, v7, v18
    v_add_f32 v7, v7, v19
    v_mfma_f32_16x16x32_bf16 v[180:183], v[24:27], a[216:219], v[132:135]
    s_mov_b32 s30, s29
    v_cvt_pk_bf16_f32 v95, v18, v19
    v_cvt_pk_bf16_f32 v158, v243, v247
    v_mfma_f32_16x16x32_bf16 v[180:183], v[28:31], a[220:223], v[180:183]
    s_waitcnt vmcnt(24)
    v_cvt_f32_i32 v248, v248
    v_cvt_f32_i32 v252, v252
    v_mfma_f32_16x16x32_bf16 v[184:187], v[24:27], a[240:243], v[136:139]
    ds_read_b128 v[44:47], v3 offset:12416
    v_cvt_f32_i32 v249, v249
    v_mfma_f32_16x16x32_bf16 v[184:187], v[28:31], a[244:247], v[184:187]
    s_waitcnt vmcnt(4)
    v_subrev_u32 v52, s92, v52
    v_cmp_lt_u32 vcc, 15, v52
    v_mfma_f32_16x16x32_bf16 v[188:191], v[24:27], v[200:203], v[140:143]
    v_exp_f32 v16, v160
    v_mfma_f32_16x16x32_bf16 v[188:191], v[28:31], v[204:207], v[188:191]
    s_waitcnt lgkmcnt(2)
    v_exp_f32 v17, v161
    v_mfma_f32_16x16x32_bf16 v[112:115], v[32:35], a[192:195], v[128:131]
    s_and_b32 s59, vcc_lo, 0xff
    ds_read_b128 v[24:27], v2 offset:18560
    v_cvt_f32_i32 v253, v253
    v_mfma_f32_16x16x32_bf16 v[112:115], v[36:39], a[196:199], v[112:115]
    s_cbranch_scc1 L_pollslow0
L_pollok0:
    v_mfma_f32_16x16x32_bf16 v[116:119], v[32:35], a[216:219], v[132:135]
    s_add_u32 s92, s92, 1
    v_exp_f32 v18, v162
    v_mfma_f32_16x16x32_bf16 v[116:119], v[36:39], a[220:223], v[116:119]
    s_mov_b32 m0, s26
    v_add_f32 v4, v4, v16
    v_add_f32 v4, v4, v17
    v_mfma_f32_16x16x32_bf16 v[120:123], v[32:35], a[240:243], v[136:139]
    ds_read_b128 v[28:31], v3 offset:18560
    v_fma_f32 v248, v248, v56, v58
    v_mfma_f32_16x16x32_bf16 v[120:123], v[36:39], a[244:247], v[120:123]
    buffer_load_dwordx4 v8, s[4:7], s32 offen offset:0 sc1 lds
    v_mfma_f32_16x16x32_bf16 v[124:127], v[32:35], v[200:203], v[140:143]
    v_exp_f32 v19, v163
    v_mfma_f32_16x16x32_bf16 v[124:127], v[36:39], v[204:207], v[124:127]
    s_waitcnt lgkmcnt(2)
    v_cvt_pk_bf16_f32 v160, v16, v17
    v_fma_f32 v252, v252, v57, v59
    v_mfma_f32_16x16x32_bf16 v[176:179], v[40:43], a[200:203], v[176:179]
    ds_read_b128 v[32:35], v2 offset:12544
    v_add_u32 v1, s3, v1
    v_mfma_f32_16x16x32_bf16 v[176:179], v[44:47], a[204:207], v[176:179]
    buffer_load_dwordx4 v8, s[4:7], s32 offen offset:1024 sc1 lds
    v_mfma_f32_16x16x32_bf16 v[180:183], v[40:43], a[224:227], v[180:183]
    v_exp_f32 v16, v96
    v_mfma_f32_16x16x32_bf16 v[180:183], v[44:47], a[228:231], v[180:183]
    v_add_f32 v4, v4, v18
    v_add_f32 v4, v4, v19
    v_mfma_f32_16x16x32_bf16 v[184:187], v[40:43], a[248:251], v[184:187]
    ds_read_b128 v[36:39], v3 offset:12544
    v_fma_f32 v249, v249, v56, v58
    v_mfma_f32_16x16x32_bf16 v[184:187], v[44:47], a[252:255], v[184:187]
    buffer_load_dwordx4 v8, s[4:7], s32 offen offset:2048 sc1 lds
    v_mfma_f32_16x16x32_bf16 v[188:191], v[40:43], v[208:211], v[188:191]
    v_exp_f32 v17, v97
    v_mfma_f32_16x16x32_bf16 v[188:191], v[44:47], v[212:215], v[188:191]
    s_waitcnt lgkmcnt(2)
    v_cvt_pk_bf16_f32 v161, v18, v19
    v_exp_f32 v18, v98
    v_mfma_f32_16x16x32_bf16 v[112:115], v[24:27], a[200:203], v[112:115]
    s_add_u32 s32, s32, 24576
    ds_read_b128 v[40:43], v2 offset:18688
    v_add_f32 v4, v4, v16
    v_mfma_f32_16x16x32_bf16 v[112:115], v[28:31], a[204:207], v[112:115]
    v_add_f32 v4, v4, v17
    v_fma_f32 v253, v253, v57, v59
    v_mfma_f32_16x16x32_bf16 v[116:119], v[24:27], a[224:227], v[116:119]
    s_add_u32 s26, s26, 12288
    v_exp_f32 v19, v99
    v_mfma_f32_16x16x32_bf16 v[116:119], v[28:31], a[228:231], v[116:119]
    v_cvt_pk_bf16_f32 v162, v16, v17
    v_add_u32 v21, s3, v21
    v_mfma_f32_16x16x32_bf16 v[120:123], v[24:27], a[248:251], v[120:123]
    ds_read_b128 v[44:47], v3 offset:18688
    v_add_u32 v22, s3, v22
    v_mfma_f32_16x16x32_bf16 v[120:123], v[28:31], a[252:255], v[120:123]
    s_waitcnt lgkmcnt(2)
    v_exp_f32 v16, v164
    v_add_f32 v4, v4, v18
    v_mfma_f32_16x16x32_bf16 v[124:127], v[24:27], v[208:211], v[124:127]
    s_waitcnt vmcnt(20)
    v_add_f32 v4, v4, v19
    v_cvt_f32_i32 v250, v250
    v_mfma_f32_16x16x32_bf16 v[124:127], v[28:31], v[212:215], v[124:127]
    s_barrier
    v_exp_f32 v17, v165
    v_mfma_f32_16x16x32_bf16 v[176:179], v[32:35], a[208:211], v[176:179]
    s_mov_b32 m0, s26
    ds_read_b128 v[24:27], v1 offset:0
    v_cvt_pk_bf16_f32 v163, v18, v19
    v_mfma_f32_16x16x32_bf16 v[176:179], v[36:39], a[212:215], v[176:179]
    buffer_load_dwordx4 v8, s[4:7], s32 offen offset:0 sc1 lds
    v_mfma_f32_16x16x32_bf16 v[180:183], v[32:35], a[232:235], v[180:183]
    v_exp_f32 v18, v166
    v_mfma_f32_16x16x32_bf16 v[180:183], v[36:39], a[236:239], v[180:183]
    v_add_f32 v5, v5, v16
    v_cvt_f32_i32 v254, v254
    v_mfma_f32_16x16x32_bf16 v[184:187], v[32:35], v[192:195], v[184:187]
    ds_read_b128 v[28:31], v1 offset:12288
    v_add_f32 v5, v5, v17
    v_mfma_f32_16x16x32_bf16 v[184:187], v[36:39], v[196:199], v[184:187]
    buffer_load_dwordx4 v8, s[4:7], s32 offen offset:1024 sc1 lds
    v_mfma_f32_16x16x32_bf16 v[188:191], v[32:35], v[216:219], v[188:191]
    v_exp_f32 v19, v167
    v_mfma_f32_16x16x32_bf16 v[188:191], v[36:39], v[220:223], v[188:191]
    s_waitcnt lgkmcnt(2)
    v_cvt_pk_bf16_f32 v164, v16, v17
    v_exp_f32 v16, v100
    v_mfma_f32_16x16x32_bf16 v[112:115], v[40:43], a[208:211], v[112:115]
    ds_read_b128 v[32:35], v1 offset:768
    v_cvt_f32_i32 v251, v251
    v_mfma_f32_16x16x32_bf16 v[112:115], v[44:47], a[212:215], v[112:115]
    buffer_load_dwordx4 v8, s[4:7], s32 offen offset:2048 sc1 lds
    v_add_f32 v5, v5, v18
    v_mfma_f32_16x16x32_bf16 v[116:119], v[40:43], a[232:235], v[116:119]
    v_add_f32 v5, v5, v19
    v_cvt_f32_i32 v255, v255
    v_mfma_f32_16x16x32_bf16 v[116:119], v[44:47], a[236:239], v[116:119]
    v_exp_f32 v17, v101
    v_fma_f32 v250, v250, v56, v58
    v_mfma_f32_16x16x32_bf16 v[120:123], v[40:43], v[192:195], v[120:123]
    ds_read_b128 v[36:39], v1 offset:13056
    v_cvt_pk_bf16_f32 v165, v18, v19
    v_mfma_f32_16x16x32_bf16 v[120:123], v[44:47], v[196:199], v[120:123]
    v_exp_f32 v18, v102
    v_fma_f32 v254, v254, v57, v59
    v_mfma_f32_16x16x32_bf16 v[124:127], v[40:43], v[216:219], v[124:127]
    s_add_u32 s32, s32, 24576
    v_add_f32 v5, v5, v16
    v_add_f32 v5, v5, v17
    v_mfma_f32_16x16x32_bf16 v[124:127], v[44:47], v[220:223], v[124:127]
    s_waitcnt lgkmcnt(2)
    v_exp_f32 v19, v103
    v_fma_f32 v251, v251, v56, v58
    v_fma_f32 v255, v255, v57, v59
    v_cvt_pk_bf16_f32 v166, v16, v17
    v_cvt_pk_bf16_f32 v147, v248, v252
    v_add_f32 v5, v5, v18
    s_add_u32 s26, s26, 36864
    v_cvt_pk_bf16_f32 v151, v249, v253
    v_add_f32 v5, v5, v19
    s_sub_u32 s57, s26, 147456
    v_cvt_pk_bf16_f32 v155, v250, v254
    v_cvt_pk_bf16_f32 v167, v18, v19
    s_min_u32 s26, s26, s57
    v_cvt_pk_bf16_f32 v159, v251, v255
    v_mfma_f32_16x16x32_bf16 a[0:3], v[64:67], v[24:27], a[0:3]
    ds_read_b128 v[40:43], v1 offset:1536
    v_mfma_f32_16x16x32_bf16 a[0:3], v[80:83], v[28:31], a[0:3]
    buffer_store_dwordx4 v[144:147], v20, s[4:7], s81 offen offset:0 sc1
    v_mfma_f32_16x16x32_bf16 a[48:51], v[68:71], v[24:27], a[48:51]
    v_exp_f32 v16, v168
    v_mfma_f32_16x16x32_bf16 a[48:51], v[84:87], v[28:31], a[48:51]
    v_exp_f32 v17, v169
    v_mfma_f32_16x16x32_bf16 a[96:99], v[72:75], v[24:27], a[96:99]
    ds_read_b128 v[44:47], v1 offset:13824
    v_mfma_f32_16x16x32_bf16 a[96:99], v[88:91], v[28:31], a[96:99]
    v_exp_f32 v18, v170
    v_mfma_f32_16x16x32_bf16 a[144:147], v[76:79], v[24:27], a[144:147]
    v_add_f32 v6, v6, v16
    v_add_f32 v6, v6, v17
    v_mfma_f32_16x16x32_bf16 a[144:147], v[92:95], v[28:31], a[144:147]
    s_waitcnt lgkmcnt(2)
    v_exp_f32 v19, v171
    v_mfma_f32_16x16x32_bf16 a[4:7], v[64:67], v[32:35], a[4:7]
    ds_read_b128 v[24:27], v1 offset:2304
    v_cvt_pk_bf16_f32 v168, v16, v17
    v_mfma_f32_16x16x32_bf16 a[4:7], v[80:83], v[36:39], a[4:7]
    buffer_store_dwordx4 v[148:151], v20, s[4:7], s81 offen offset:768 sc1
    v_mfma_f32_16x16x32_bf16 a[52:55], v[68:71], v[32:35], a[52:55]
    v_exp_f32 v16, v104
    v_mfma_f32_16x16x32_bf16 a[52:55], v[84:87], v[36:39], a[52:55]
    v_add_f32 v6, v6, v18
    v_add_f32 v6, v6, v19
    v_mfma_f32_16x16x32_bf16 a[100:103], v[72:75], v[32:35], a[100:103]
    ds_read_b128 v[28:31], v1 offset:14592
    v_mfma_f32_16x16x32_bf16 a[100:103], v[88:91], v[36:39], a[100:103]
    v_exp_f32 v17, v105
    v_mfma_f32_16x16x32_bf16 a[148:151], v[76:79], v[32:35], a[148:151]
    v_cvt_pk_bf16_f32 v169, v18, v19
    v_mfma_f32_16x16x32_bf16 a[148:151], v[92:95], v[36:39], a[148:151]
    s_waitcnt lgkmcnt(2)
    v_exp_f32 v18, v106
    v_mfma_f32_16x16x32_bf16 a[8:11], v[64:67], v[40:43], a[8:11]
    ds_read_b128 v[32:35], v21 offset:0
    v_add_f32 v6, v6, v16
    v_mfma_f32_16x16x32_bf16 a[8:11], v[80:83], v[44:47], a[8:11]
    buffer_store_dwordx4 v[152:155], v20, s[4:7], s81 offen offset:1536 sc1
    v_mfma_f32_16x16x32_bf16 a[56:59], v[68:71], v[40:43], a[56:59]
    v_add_f32 v6, v6, v17
    v_mfma_f32_16x16x32_bf16 a[56:59], v[84:87], v[44:47], a[56:59]
    v_exp_f32 v19, v107
    v_mfma_f32_16x16x32_bf16 a[104:107], v[72:75], v[40:43], a[104:107]
    ds_read_b128 v[36:39], v21 offset:12288
    v_cvt_pk_bf16_f32 v170, v16, v17
    v_mfma_f32_16x16x32_bf16 a[104:107], v[88:91], v[44:47], a[104:107]
    v_exp_f32 v16, v172
    v_mfma_f32_16x16x32_bf16 a[152:155], v[76:79], v[40:43], a[152:155]
    v_add_f32 v6, v6, v18
    v_mfma_f32_16x16x32_bf16 a[152:155], v[92:95], v[44:47], a[152:155]
    s_waitcnt lgkmcnt(2)
    v_add_f32 v6, v6, v19
    v_mfma_f32_16x16x32_bf16 a[12:15], v[64:67], v[24:27], a[12:15]
    ds_read_b128 v[40:43], v21 offset:768
    v_mfma_f32_16x16x32_bf16 a[12:15], v[80:83], v[28:31], a[12:15]
    buffer_store_dwordx4 v[156:159], v20, s[4:7], s81 offen offset:2304 sc1
    v_mfma_f32_16x16x32_bf16 a[60:63], v[68:71], v[24:27], a[60:63]
    v_exp_f32 v17, v173
    v_mfma_f32_16x16x32_bf16 a[60:63], v[84:87], v[28:31], a[60:63]
    v_cvt_pk_bf16_f32 v171, v18, v19
    v_mfma_f32_16x16x32_bf16 a[108:111], v[72:75], v[24:27], a[108:111]
    ds_read_b128 v[44:47], v21 offset:13056
    v_mfma_f32_16x16x32_bf16 a[108:111], v[88:91], v[28:31], a[108:111]
    v_exp_f32 v18, v174
    v_mfma_f32_16x16x32_bf16 a[156:159], v[76:79], v[24:27], a[156:159]
    s_add_u32 s29, s28, 49152
    v_add_f32 v7, v7, v16
    v_add_f32 v7, v7, v17
    v_mfma_f32_16x16x32_bf16 a[156:159], v[92:95], v[28:31], a[156:159]
    s_waitcnt lgkmcnt(2)
    v_exp_f32 v19, v175
    v_mfma_f32_16x16x32_bf16 a[16:19], v[64:67], v[32:35], a[16:19]
    ds_read_b128 v[24:27], v21 offset:1536
    v_cvt_pk_bf16_f32 v172, v16, v17
    v_mfma_f32_16x16x32_bf16 a[16:19], v[80:83], v[36:39], a[16:19]
    s_sub_u32 s3, s29, 147456
    buffer_load_dwordx4 v[240:243], v9, s[64:67], s33 offen offset:384 nt
    v_mfma_f32_16x16x32_bf16 a[64:67], v[68:71], v[32:35], a[64:67]
    ds_read_b128 v[56:59], v10 offset:384
    s_waitcnt vmcnt(13)
    v_mfma_f32_16x16x32_bf16 a[64:67], v[84:87], v[36:39], a[64:67]
    v_exp_f32 v16, v108
    v_mfma_f32_16x16x32_bf16 a[112:115], v[72:75], v[32:35], a[112:115]
    ds_read_b128 v[28:31], v21 offset:13824
    v_add_f32 v7, v7, v18
    v_mfma_f32_16x16x32_bf16 a[112:115], v[88:91], v[36:39], a[112:115]
    v_add_f32 v7, v7, v19
    v_cvt_f32_i32 v224, v224
    v_mfma_f32_16x16x32_bf16 a[160:163], v[76:79], v[32:35], a[160:163]
    v_exp_f32 v17, v109
    v_mfma_f32_16x16x32_bf16 a[160:163], v[92:95], v[36:39], a[160:163]
    s_waitcnt lgkmcnt(3)
    buffer_load_dwordx4 v[244:247], v9, s[64:67], s33 offen offset:1920 nt
    v_mfma_f32_16x16x32_bf16 a[20:23], v[64:67], v[40:43], a[20:23]
    s_min_u32 s29, s29, s3
    ds_read_b128 v[32:35], v21 offset:2304
    v_cvt_pk_bf16_f32 v173, v18, v19
    v_mfma_f32_16x16x32_bf16 a[20:23], v[80:83], v[44:47], a[20:23]
    v_exp_f32 v18, v110
    v_mfma_f32_16x16x32_bf16 a[68:71], v[68:71], v[40:43], a[68:71]
    v_cvt_f32_i32 v225, v225
    v_add_f32 v7, v7, v16
    v_mfma_f32_16x16x32_bf16 a[68:71], v[84:87], v[44:47], a[68:71]
    v_add_f32 v7, v7, v17
    v_cvt_f32_i32 v228, v228
    v_mfma_f32_16x16x32_bf16 a[116:119], v[72:75], v[40:43], a[116:119]
    ds_read_b128 v[36:39], v21 offset:14592
    v_mfma_f32_16x16x32_bf16 a[116:119], v[88:91], v[44:47], a[116:119]
    buffer_load_dwordx4 v[248:251], v9, s[64:67], s34 offen offset:384 nt
    v_mfma_f32_16x16x32_bf16 a[164:167], v[76:79], v[40:43], a[164:167]
    s_sub_u32 s3, s29, s28
    v_exp_f32 v19, v111
    v_mfma_f32_16x16x32_bf16 a[164:167], v[92:95], v[44:47], a[164:167]
    s_waitcnt lgkmcnt(2)
    ds_read_b128 v[60:63], v10 offset:768
    v_cvt_pk_bf16_f32 v174, v16, v17
    v_mfma_f32_16x16x32_bf16 a[24:27], v[64:67], v[24:27], a[24:27]
    ds_read_b128 v[40:43], v22 offset:0
    v_cvt_f32_i32 v229, v229
    v_mfma_f32_16x16x32_bf16 a[24:27], v[80:83], v[28:31], a[24:27]
    v_exp_f32 v16, v176
    v_mfma_f32_16x16x32_bf16 a[72:75], v[68:71], v[24:27], a[72:75]
    v_add_f32 v7, v7, v18
    v_add_f32 v7, v7, v19
    v_mfma_f32_16x16x32_bf16 a[72:75], v[84:87], v[28:31], a[72:75]
    buffer_load_dwordx4 v[252:255], v9, s[64:67], s34 offen offset:1920 nt
    v_mfma_f32_16x16x32_bf16 a[120:123], v[72:75], v[24:27], a[120:123]
    ds_read_b128 v[44:47], v22 offset:12288
    v_fma_f32 v224, v224, v48, v50
    v_mfma_f32_16x16x32_bf16 a[120:123], v[88:91], v[28:31], a[120:123]
    s_mov_b32 s28, s29
    v_exp_f32 v17, v177
    v_mfma_f32_16x16x32_bf16 a[168:171], v[76:79], v[24:27], a[168:171]
    v_cvt_pk_bf16_f32 v175, v18, v19
    v_fma_f32 v225, v225, v49, v51
    v_mfma_f32_16x16x32_bf16 a[168:171], v[92:95], v[28:31], a[168:171]
    s_waitcnt lgkmcnt(3)
    v_exp_f32 v18, v178
    v_mfma_f32_16x16x32_bf16 a[28:31], v[64:67], v[32:35], a[28:31]
    ds_read_b128 v[24:27], v22 offset:768
    v_add_f32 v4, v4, v16
    v_mfma_f32_16x16x32_bf16 a[28:31], v[80:83], v[36:39], a[28:31]
    v_add_f32 v4, v4, v17
    v_fma_f32 v228, v228, v48, v50
    v_mfma_f32_16x16x32_bf16 a[76:79], v[68:71], v[32:35], a[76:79]
    s_mov_b32 m0, s26
    v_exp_f32 v19, v179
    v_mfma_f32_16x16x32_bf16 a[76:79], v[84:87], v[36:39], a[76:79]
    v_cvt_pk_bf16_f32 v176, v16, v17
    v_fma_f32 v229, v229, v49, v51
    v_mfma_f32_16x16x32_bf16 a[124:127], v[72:75], v[32:35], a[124:127]
    ds_read_b128 v[28:31], v22 offset:13056
    v_cvt_pk_bf16_f32 v224, v224, v225
    v_mfma_f32_16x16x32_bf16 a[124:127], v[88:91], v[36:39], a[124:127]
    buffer_load_dwordx4 v8, s[4:7], s32 offen offset:0 sc1 lds
    v_mfma_f32_16x16x32_bf16 a[172:175], v[76:79], v[32:35], a[172:175]
    v_exp_f32 v16, v112
    v_mfma_f32_16x16x32_bf16 a[172:175], v[92:95], v[36:39], a[172:175]
    s_waitcnt lgkmcnt(2)
    v_add_f32 v4, v4, v18
    v_add_f32 v4, v4, v19
    v_mfma_f32_16x16x32_bf16 a[32:35], v[64:67], v[40:43], a[32:35]
    ds_read_b128 v[32:35], v22 offset:1536
    v_cvt_pk_bf16_f32 v228, v228, v229
    v_mfma_f32_16x16x32_bf16 a[32:35], v[80:83], v[44:47], a[32:35]
    buffer_load_dwordx4 v8, s[4:7], s32 offen offset:1024 sc1 lds
    v_mfma_f32_16x16x32_bf16 a[80:83], v[68:71], v[40:43], a[80:83]
    v_exp_f32 v17, v113
    v_mfma_f32_16x16x32_bf16 a[80:83], v[84:87], v[44:47], a[80:83]
    v_cvt_pk_bf16_f32 v177, v18, v19
    v_cvt_f32_i32 v226, v226
    v_mfma_f32_16x16x32_bf16 a[128:131], v[72:75], v[40:43], a[128:131]
    ds_read_b128 v[36:39], v22 offset:13824
    v_cvt_f32_i32 v227, v227
    v_mfma_f32_16x16x32_bf16 a[128:131], v[88:91], v[44:47], a[128:131]
    buffer_load_dwordx4 v8, s[4:7], s32 offen offset:2048 sc1 lds
    v_mfma_f32_16x16x32_bf16 a[176:179], v[76:79], v[40:43], a[176:179]
    v_exp_f32 v18, v114
    v_mfma_f32_16x16x32_bf16 a[176:179], v[92:95], v[44:47], a[176:179]
    s_waitcnt lgkmcnt(2)
    v_add_f32 v4, v4, v16
    v_add_f32 v4, v4, v17
    v_mfma_f32_16x16x32_bf16 a[36:39], v[64:67], v[24:27], a[36:39]
    s_add_u32 s32, s32, 24576
    ds_read_b128 v[40:43], v22 offset:2304
    v_cvt_f32_i32 v230, v230
    v_mfma_f32_16x16x32_bf16 a[36:39], v[80:83], v[28:31], a[36:39]
    v_exp_f32 v19, v115
    v_cvt_pk_bf16_f32 v178, v16, v17
    v_mfma_f32_16x16x32_bf16 a[84:87], v[68:71], v[24:27], a[84:87]
    s_add_u32 s26, s26, 12288
    v_exp_f32 v16, v180
    v_mfma_f32_16x16x32_bf16 a[84:87], v[84:87], v[28:31], a[84:87]
    v_add_u32 v2, s3, v2
    v_add_f32 v4, v4, v18
    v_mfma_f32_16x16x32_bf16 a[132:135], v[72:75], v[24:27], a[132:135]
    s_mov_b32 m0, s26
    ds_read_b128 v[44:47], v22 offset:14592
    v_add_u32 v3, s3, v3
    v_mfma_f32_16x16x32_bf16 a[132:135], v[88:91], v[28:31], a[132:135]
    s_waitcnt lgkmcnt(2)
    v_add_f32 v4, v4, v19
    v_cvt_f32_i32 v231, v231
    v_mfma_f32_16x16x32_bf16 a[180:183], v[76:79], v[24:27], a[180:183]
    s_waitcnt vmcnt(7)
    v_exp_f32 v17, v181
    v_mfma_f32_16x16x32_bf16 a[180:183], v[92:95], v[28:31], a[180:183]
    s_barrier
    v_cvt_pk_bf16_f32 v179, v18, v19
    v_mfma_f32_16x16x32_bf16 a[40:43], v[64:67], v[32:35], a[40:43]
    ds_read_b128 v[24:27], v2 offset:0
    v_fma_f32 v226, v226, v56, v58
    v_mfma_f32_16x16x32_bf16 a[40:43], v[80:83], v[36:39], a[40:43]
    buffer_load_dwordx4 v8, s[4:7], s32 offen offset:0 sc1 lds
    v_mfma_f32_16x16x32_bf16 a[88:91], v[68:71], v[32:35], a[88:91]
    v_exp_f32 v18, v182
    v_mfma_f32_16x16x32_bf16 a[88:91], v[84:87], v[36:39], a[88:91]
    v_add_f32 v5, v5, v16
    v_add_f32 v5, v5, v17
    v_mfma_f32_16x16x32_bf16 a[136:139], v[72:75], v[32:35], a[136:139]
    ds_read_b128 v[28:31], v3 offset:0
    v_fma_f32 v227, v227, v57, v59
    v_mfma_f32_16x16x32_bf16 a[136:139], v[88:91], v[36:39], a[136:139]
    buffer_load_dwordx4 v8, s[4:7], s32 offen offset:1024 sc1 lds
    v_mfma_f32_16x16x32_bf16 a[184:187], v[76:79], v[32:35], a[184:187]
    v_exp_f32 v19, v183
    v_mfma_f32_16x16x32_bf16 a[184:187], v[92:95], v[36:39], a[184:187]
    s_waitcnt lgkmcnt(2)
    v_cvt_pk_bf16_f32 v180, v16, v17
    v_exp_f32 v16, v116
    v_mfma_f32_16x16x32_bf16 a[44:47], v[64:67], v[40:43], a[44:47]
    ds_read_b128 v[32:35], v2 offset:6144
    v_add_f32 v5, v5, v18
    v_mfma_f32_16x16x32_bf16 a[44:47], v[80:83], v[44:47], a[44:47]
    buffer_load_dwordx4 v8, s[4:7], s32 offen offset:2048 sc1 lds
    v_add_f32 v5, v5, v19
    v_mfma_f32_16x16x32_bf16 a[92:95], v[68:71], v[40:43], a[92:95]
    v_exp_f32 v17, v117
    v_mfma_f32_16x16x32_bf16 a[92:95], v[84:87], v[44:47], a[92:95]
    v_fma_f32 v230, v230, v56, v58
    v_cvt_pk_bf16_f32 v181, v18, v19
    v_fma_f32 v231, v231, v57, v59
    v_mfma_f32_16x16x32_bf16 a[140:143], v[72:75], v[40:43], a[140:143]
    ds_read_b128 v[36:39], v3 offset:6144
    v_cvt_pk_bf16_f32 v225, v226, v227
    v_mfma_f32_16x16x32_bf16 a[140:143], v[88:91], v[44:47], a[140:143]
    v_add_u32 v55, 1, v55
    buffer_store_dword v55, v13, s[20:23], 0 offen sc1
    v_mfma_f32_16x16x32_bf16 a[188:191], v[76:79], v[40:43], a[188:191]
    s_add_u32 s32, s32, 24576
    v_exp_f32 v18, v118
    v_mfma_f32_16x16x32_bf16 a[188:191], v[92:95], v[44:47], a[188:191]
    s_waitcnt lgkmcnt(2)
    v_add_f32 v5, v5, v16
    v_add_f32 v5, v5, v17
    v_exp_f32 v19, v119
    v_cvt_pk_bf16_f32 v229, v230, v231
    s_waitcnt vmcnt(21)
    v_cvt_pk_bf16_f32 v182, v16, v17
    v_cvt_f32_i32 v232, v232
    v_add_f32 v5, v5, v18
    s_add_u32 s26, s26, 36864
    v_cvt_f32_i32 v233, v233
    v_add_f32 v5, v5, v19
    s_sub_u32 s57, s26, 147456
    v_cvt_f32_i32 v236, v236
    v_cvt_pk_bf16_f32 v183, v18, v19
    s_min_u32 s26, s26, s57
    v_cvt_f32_i32 v237, v237
    v_mfma_f32_16x16x32_bf16 v[64:67], v[24:27], a[192:195], v[128:131]
    ds_read_b128 v[40:43], v2 offset:128
    s_add_u32 s35, s35, 196608
    v_mfma_f32_16x16x32_bf16 v[64:67], v[28:31], a[196:199], v[64:67]
    s_sub_u32 s36, s35, 1572864
    v_exp_f32 v16, v184
    s_branch L_skip4
L_pad4:
    s_branch L_tb1_10
L_skip4:
    v_mfma_f32_16x16x32_bf16 v[68:71], v[24:27], a[216:219], v[132:135]
    v_exp_f32 v17, v185
    v_mfma_f32_16x16x32_bf16 v[68:71], v[28:31], a[220:223], v[68:71]
    s_min_u32 s35, s35, s36
    v_fma_f32 v232, v232, v48, v50
    v_fma_f32 v233, v233, v49, v51
    v_mfma_f32_16x16x32_bf16 v[72:75], v[24:27], a[240:243], v[136:139]
    ds_read_b128 v[44:47], v3 offset:128
    v_fma_f32 v236, v236, v48, v50
    v_mfma_f32_16x16x32_bf16 v[72:75], v[28:31], a[244:247], v[72:75]
    s_add_u32 s36, s35, 3072
    v_exp_f32 v18, v186
    v_mfma_f32_16x16x32_bf16 v[76:79], v[24:27], v[200:203], v[140:143]
    v_add_f32 v6, v6, v16
    v_add_f32 v6, v6, v17
    v_mfma_f32_16x16x32_bf16 v[76:79], v[28:31], v[204:207], v[76:79]
    s_waitcnt lgkmcnt(2)
    v_exp_f32 v19, v187
    v_mfma_f32_16x16x32_bf16 v[96:99], v[32:35], a[192:195], v[128:131]
    s_add_u32 s81, s81, 196608
    ds_read_b128 v[24:27], v2 offset:6272
    v_fma_f32 v237, v237, v49, v51
    v_mfma_f32_16x16x32_bf16 v[96:99], v[36:39], a[196:199], v[96:99]
    v_cvt_pk_bf16_f32 v184, v16, v17
    v_cvt_pk_bf16_f32 v232, v232, v233
    v_mfma_f32_16x16x32_bf16 v[100:103], v[32:35], a[216:219], v[132:135]
    v_exp_f32 v16, v120
    v_mfma_f32_16x16x32_bf16 v[100:103], v[36:39], a[220:223], v[100:103]
    buffer_load_dwordx4 v[144:147], v12, s[68:71], s35 offen offset:0 nt
    v_mfma_f32_16x16x32_bf16 v[104:107], v[32:35], a[240:243], v[136:139]
    ds_read_b128 v[28:31], v3 offset:6272
    v_add_f32 v6, v6, v18
    v_mfma_f32_16x16x32_bf16 v[104:107], v[36:39], a[244:247], v[104:107]
    v_add_f32 v6, v6, v19
    v_cvt_pk_bf16_f32 v236, v236, v237
    v_mfma_f32_16x16x32_bf16 v[108:111], v[32:35], v[200:203], v[140:143]
    v_exp_f32 v17, v121
    v_mfma_f32_16x16x32_bf16 v[108:111], v[36:39], v[204:207], v[108:111]
    s_waitcnt lgkmcnt(2)
    v_cvt_pk_bf16_f32 v185, v18, v19
    v_cvt_f32_i32 v234, v234
    v_mfma_f32_16x16x32_bf16 v[64:67], v[40:43], a[200:203], v[64:67]
    ds_read_b128 v[32:35], v2 offset:256
    v_mfma_f32_16x16x32_bf16 v[64:67], v[44:47], a[204:207], v[64:67]
    buffer_load_dwordx4 v[148:151], v12, s[68:71], s35 offen offset:768 nt
    v_mfma_f32_16x16x32_bf16 v[68:71], v[40:43], a[224:227], v[68:71]
    v_exp_f32 v18, v122
    v_mfma_f32_16x16x32_bf16 v[68:71], v[44:47], a[228:231], v[68:71]
    v_add_f32 v6, v6, v16
    v_add_f32 v6, v6, v17
    v_mfma_f32_16x16x32_bf16 v[72:75], v[40:43], a[248:251], v[72:75]
    ds_read_b128 v[36:39], v3 offset:256
    v_cvt_f32_i32 v235, v235
    v_mfma_f32_16x16x32_bf16 v[72:75], v[44:47], a[252:255], v[72:75]
    buffer_load_dwordx4 v[152:155], v12, s[68:71], s35 offen offset:1536 nt
    v_mfma_f32_16x16x32_bf16 v[76:79], v[40:43], v[208:211], v[76:79]
    v_exp_f32 v19, v123
    v_mfma_f32_16x16x32_bf16 v[76:79], v[44:47], v[212:215], v[76:79]
    s_waitcnt lgkmcnt(2)
    v_cvt_pk_bf16_f32 v186, v16, v17
    v_cvt_f32_i32 v238, v238
    v_mfma_f32_16x16x32_bf16 v[96:99], v[24:27], a[200:203], v[96:99]
    ds_read_b128 v[40:43], v2 offset:6400
    v_cvt_f32_i32 v239, v239
    v_mfma_f32_16x16x32_bf16 v[96:99], v[28:31], a[204:207], v[96:99]
    v_exp_f32 v16, v188
    v_mfma_f32_16x16x32_bf16 v[100:103], v[24:27], a[224:227], v[100:103]
    v_add_f32 v6, v6, v18
    v_add_f32 v6, v6, v19
    v_mfma_f32_16x16x32_bf16 v[100:103], v[28:31], a[228:231], v[100:103]
    buffer_load_dwordx4 v[156:159], v12, s[68:71], s35 offen offset:2304 nt
    v_mfma_f32_16x16x32_bf16 v[104:107], v[24:27], a[248:251], v[104:107]
    ds_read_b128 v[44:47], v3 offset:6400
    v_fma_f32 v234, v234, v56, v58
    v_mfma_f32_16x16x32_bf16 v[104:107], v[28:31], a[252:255], v[104:107]
    v_exp_f32 v17, v189
    v_mfma_f32_16x16x32_bf16 v[108:111], v[24:27], v[208:211], v[108:111]
    s_add_u32 s29, s30, 49152
    v_cvt_pk_bf16_f32 v187, v18, v19
    v_fma_f32 v235, v235, v57, v59
    v_mfma_f32_16x16x32_bf16 v[108:111], v[28:31], v[212:215], v[108:111]
    s_waitcnt lgkmcnt(2)
    v_exp_f32 v18, v190
    v_mfma_f32_16x16x32_bf16 v[64:67], v[32:35], a[208:211], v[64:67]
    s_mov_b32 m0, s26
    ds_read_b128 v[24:27], v2 offset:12288
    v_add_f32 v7, v7, v16
    v_mfma_f32_16x16x32_bf16 v[64:67], v[36:39], a[212:215], v[64:67]
    s_sub_u32 s3, s29, 147456
    buffer_load_dwordx4 v8, s[4:7], s32 offen offset:0 sc1 lds
    v_mfma_f32_16x16x32_bf16 v[68:71], v[32:35], a[232:235], v[68:71]
    v_add_f32 v7, v7, v17
    v_fma_f32 v238, v238, v56, v58
    v_mfma_f32_16x16x32_bf16 v[68:71], v[36:39], a[236:239], v[68:71]
    v_exp_f32 v19, v191
    v_mfma_f32_16x16x32_bf16 v[72:75], v[32:35], v[192:195], v[72:75]
    ds_read_b128 v[28:31], v3 offset:12288
    v_cvt_pk_bf16_f32 v188, v16, v17
    v_mfma_f32_16x16x32_bf16 v[72:75], v[36:39], v[196:199], v[72:75]
    buffer_load_dwordx4 v8, s[4:7], s32 offen offset:1024 sc1 lds
    v_mfma_f32_16x16x32_bf16 v[76:79], v[32:35], v[216:219], v[76:79]
    s_min_u32 s29, s29, s3
    v_exp_f32 v16, v124
    v_mfma_f32_16x16x32_bf16 v[76:79], v[36:39], v[220:223], v[76:79]
    s_waitcnt lgkmcnt(2)
    v_add_f32 v7, v7, v18
    v_add_f32 v7, v7, v19
    v_mfma_f32_16x16x32_bf16 v[96:99], v[40:43], a[208:211], v[96:99]
    ds_read_b128 v[32:35], v2 offset:18432
    v_fma_f32 v239, v239, v57, v59
    v_mfma_f32_16x16x32_bf16 v[96:99], v[44:47], a[212:215], v[96:99]
    buffer_load_dwordx4 v8, s[4:7], s32 offen offset:2048 sc1 lds
    v_mfma_f32_16x16x32_bf16 v[100:103], v[40:43], a[232:235], v[100:103]
    v_exp_f32 v17, v125
    v_mfma_f32_16x16x32_bf16 v[100:103], v[44:47], a[236:239], v[100:103]
    v_cvt_pk_bf16_f32 v189, v18, v19
    v_cvt_pk_bf16_f32 v233, v234, v235
    v_mfma_f32_16x16x32_bf16 v[104:107], v[40:43], v[192:195], v[104:107]
    s_add_u32 s32, s32, 24576
    ds_read_b128 v[36:39], v3 offset:18432
    v_cvt_pk_bf16_f32 v237, v238, v239
    v_mfma_f32_16x16x32_bf16 v[104:107], v[44:47], v[196:199], v[104:107]
    s_sub_u32 s3, s29, s30
    v_exp_f32 v18, v126
    v_mfma_f32_16x16x32_bf16 v[108:111], v[40:43], v[216:219], v[108:111]
    s_add_u32 s26, s26, 12288
    v_add_f32 v7, v7, v16
    v_add_f32 v7, v7, v17
    v_mfma_f32_16x16x32_bf16 v[108:111], v[44:47], v[220:223], v[108:111]
    s_waitcnt lgkmcnt(2)
    v_exp_f32 v19, v127
    v_mfma_f32_16x16x32_bf16 v[80:83], v[24:27], a[192:195], v[128:131]
    s_mov_b32 m0, s26
    ds_read_b128 v[40:43], v2 offset:12416
    v_cvt_pk_bf16_f32 v190, v16, v17
    v_mfma_f32_16x16x32_bf16 v[80:83], v[28:31], a[196:199], v[80:83]
    v_add_f32 v7, v7, v18
    v_add_f32 v7, v7, v19
    v_mfma_f32_16x16x32_bf16 v[84:87], v[24:27], a[216:219], v[132:135]
    s_mov_b32 s30, s29
    ds_read_b128 v[48:51], v10 offset:1152
    v_cvt_pk_bf16_f32 v191, v18, v19
    v_mfma_f32_16x16x32_bf16 v[84:87], v[28:31], a[220:223], v[84:87]
    s_waitcnt vmcnt(16)
    buffer_load_dwordx4 v8, s[4:7], s32 offen offset:0 sc1 lds
    v_mfma_f32_16x16x32_bf16 v[88:91], v[24:27], a[240:243], v[136:139]
    ds_read_b128 v[44:47], v3 offset:12416
    v_cvt_f32_i32 v240, v240
    v_mfma_f32_16x16x32_bf16 v[88:91], v[28:31], a[244:247], v[88:91]
    v_exp_f32 v16, v64
    v_mfma_f32_16x16x32_bf16 v[92:95], v[24:27], v[200:203], v[140:143]
    v_exp_f32 v17, v65
    v_mfma_f32_16x16x32_bf16 v[92:95], v[28:31], v[204:207], v[92:95]
    s_waitcnt lgkmcnt(3)
    buffer_load_dwordx4 v8, s[4:7], s32 offen offset:1024 sc1 lds
    v_mfma_f32_16x16x32_bf16 v[112:115], v[32:35], a[192:195], v[128:131]
    ds_read_b128 v[24:27], v2 offset:18560
    v_cvt_f32_i32 v241, v241
    v_mfma_f32_16x16x32_bf16 v[112:115], v[36:39], a[196:199], v[112:115]
    v_exp_f32 v18, v66
    v_mfma_f32_16x16x32_bf16 v[116:119], v[32:35], a[216:219], v[132:135]
    v_add_f32 v4, v4, v16
    v_add_f32 v4, v4, v17
    v_mfma_f32_16x16x32_bf16 v[116:119], v[36:39], a[220:223], v[116:119]
    buffer_load_dwordx4 v8, s[4:7], s32 offen offset:2048 sc1 lds
    v_mfma_f32_16x16x32_bf16 v[120:123], v[32:35], a[240:243], v[136:139]
    ds_read_b128 v[28:31], v3 offset:18560
    v_cvt_f32_i32 v244, v244
    v_mfma_f32_16x16x32_bf16 v[120:123], v[36:39], a[244:247], v[120:123]
    v_exp_f32 v19, v67
    v_mfma_f32_16x16x32_bf16 v[124:127], v[32:35], v[200:203], v[140:143]
    ds_read_b128 v[56:59], v23 offset:0
    v_cvt_pk_bf16_f32 v64, v16, v17
    v_mfma_f32_16x16x32_bf16 v[124:127], v[36:39], v[204:207], v[124:127]
    s_waitcnt lgkmcnt(3)
    v_exp_f32 v16, v96
    v_mfma_f32_16x16x32_bf16 v[80:83], v[40:43], a[200:203], v[80:83]
    s_add_u32 s32, s32, 24576
    ds_read_b128 v[32:35], v2 offset:12544
    v_add_f32 v4, v4, v18
    v_mfma_f32_16x16x32_bf16 v[80:83], v[44:47], a[204:207], v[80:83]
    s_add_u32 s26, s26, 36864
    v_add_f32 v4, v4, v19
    v_add_u32 v10, 1792, v10
    v_mfma_f32_16x16x32_bf16 v[84:87], v[40:43], a[224:227], v[84:87]
    v_exp_f32 v17, v97
    v_mfma_f32_16x16x32_bf16 v[84:87], v[44:47], a[228:231], v[84:87]
    s_sub_u32 s57, s26, 147456
    v_cvt_pk_bf16_f32 v65, v18, v19
    v_bfe_u32 v53, v8, 4, 6
    v_mfma_f32_16x16x32_bf16 v[88:91], v[40:43], a[248:251], v[88:91]
    ds_read_b128 v[36:39], v3 offset:12544
    v_add_u32 v1, s3, v1
    v_mfma_f32_16x16x32_bf16 v[88:91], v[44:47], a[252:255], v[88:91]
    v_exp_f32 v18, v98
    v_mfma_f32_16x16x32_bf16 v[92:95], v[40:43], v[208:211], v[92:95]
    s_min_u32 s26, s26, s57
    v_lshlrev_b32 v53, 2, v53
    v_add_f32 v4, v4, v16
    v_mfma_f32_16x16x32_bf16 v[92:95], v[44:47], v[212:215], v[92:95]
    s_waitcnt lgkmcnt(3)
    buffer_load_dword v52, v53, s[20:23], 0 offen sc1
    v_mfma_f32_16x16x32_bf16 v[112:115], v[24:27], a[200:203], v[112:115]
    ds_read_b128 v[40:43], v2 offset:18688
    v_add_f32 v4, v4, v17
    v_mfma_f32_16x16x32_bf16 v[112:115], v[28:31], a[204:207], v[112:115]
    v_exp_f32 v19, v99
    v_mfma_f32_16x16x32_bf16 v[116:119], v[24:27], a[224:227], v[116:119]
    v_cvt_pk_bf16_f32 v66, v16, v17
    v_add_u32 v21, s3, v21
    v_mfma_f32_16x16x32_bf16 v[116:119], v[28:31], a[228:231], v[116:119]
    v_exp_f32 v16, v68
    v_mfma_f32_16x16x32_bf16 v[120:123], v[24:27], a[248:251], v[120:123]
    ds_read_b128 v[44:47], v3 offset:18688
    v_add_u32 v22, s3, v22
    v_mfma_f32_16x16x32_bf16 v[120:123], v[28:31], a[252:255], v[120:123]
    s_waitcnt lgkmcnt(2)
    v_add_f32 v4, v4, v18
    v_cvt_f32_i32 v245, v245
    v_mfma_f32_16x16x32_bf16 v[124:127], v[24:27], v[208:211], v[124:127]
    s_waitcnt vmcnt(37)
    v_add_f32 v4, v4, v19
    v_fma_f32 v240, v240, v60, v62
    v_mfma_f32_16x16x32_bf16 v[124:127], v[28:31], v[212:215], v[124:127]
    s_barrier
    v_exp_f32 v17, v69
    v_mfma_f32_16x16x32_bf16 v[80:83], v[32:35], a[208:211], v[80:83]
    ds_read_b128 v[24:27], v1 offset:0
    v_cvt_pk_bf16_f32 v67, v18, v19
    v_mfma_f32_16x16x32_bf16 v[80:83], v[36:39], a[212:215], v[80:83]
    v_exp_f32 v18, v70
    v_mfma_f32_16x16x32_bf16 v[84:87], v[32:35], a[232:235], v[84:87]
    v_add_f32 v5, v5, v16
    v_fma_f32 v241, v241, v61, v63
    v_mfma_f32_16x16x32_bf16 v[84:87], v[36:39], a[236:239], v[84:87]
    v_add_f32 v5, v5, v17
    v_fma_f32 v244, v244, v60, v62
    v_mfma_f32_16x16x32_bf16 v[88:91], v[32:35], v[192:195], v[88:91]
    ds_read_b128 v[28:31], v1 offset:12288
    v_fma_f32 v245, v245, v61, v63
    v_mfma_f32_16x16x32_bf16 v[88:91], v[36:39], v[196:199], v[88:91]
    v_exp_f32 v19, v71
    v_mfma_f32_16x16x32_bf16 v[92:95], v[32:35], v[216:219], v[92:95]
    v_cvt_pk_bf16_f32 v68, v16, v17
    v_cvt_pk_bf16_f32 v226, v240, v241
    v_mfma_f32_16x16x32_bf16 v[92:95], v[36:39], v[220:223], v[92:95]
    s_waitcnt lgkmcnt(2)
    v_exp_f32 v16, v100
    v_mfma_f32_16x16x32_bf16 v[112:115], v[40:43], a[208:211], v[112:115]
    ds_read_b128 v[32:35], v1 offset:768
    v_add_f32 v5, v5, v18
    v_mfma_f32_16x16x32_bf16 v[112:115], v[44:47], a[212:215], v[112:115]
    v_add_f32 v5, v5, v19
    v_cvt_pk_bf16_f32 v230, v244, v245
    v_mfma_f32_16x16x32_bf16 v[116:119], v[40:43], a[232:235], v[116:119]
    v_exp_f32 v17, v101
    v_mfma_f32_16x16x32_bf16 v[116:119], v[44:47], a[236:239], v[116:119]
    v_cvt_pk_bf16_f32 v69, v18, v19
    v_cvt_f32_i32 v242, v242
    v_mfma_f32_16x16x32_bf16 v[120:123], v[40:43], v[192:195], v[120:123]
    ds_read_b128 v[36:39], v1 offset:13056
    v_cvt_f32_i32 v243, v243
    v_mfma_f32_16x16x32_bf16 v[120:123], v[44:47], v[196:199], v[120:123]
    v_exp_f32 v18, v102
    v_mfma_f32_16x16x32_bf16 v[124:127], v[40:43], v[216:219], v[124:127]
    v_add_f32 v5, v5, v16
    v_add_f32 v5, v5, v17
    v_mfma_f32_16x16x32_bf16 v[124:127], v[44:47], v[220:223], v[124:127]
    s_waitcnt lgkmcnt(2)
    v_exp_f32 v19, v103
    v_cvt_pk_bf16_f32 v70, v16, v17
    v_add_f32 v5, v5, v18
    v_cvt_f32_i32 v246, v246
    v_add_f32 v5, v5, v19
    v_cvt_f32_i32 v247, v247
    v_cvt_pk_bf16_f32 v71, v18, v19
    v_fma_f32 v242, v242, v48, v50
    v_mfma_f32_16x16x32_bf16 a[0:3], v[160:163], v[24:27], a[0:3]
    ds_read_b128 v[40:43], v1 offset:1536
    v_fma_f32 v243, v243, v49, v51
    v_mfma_f32_16x16x32_bf16 a[0:3], v[176:179], v[28:31], a[0:3]
    v_exp_f32 v16, v72
    v_mfma_f32_16x16x32_bf16 a[48:51], v[164:167], v[24:27], a[48:51]
    v_exp_f32 v17, v73
    v_mfma_f32_16x16x32_bf16 a[48:51], v[180:183], v[28:31], a[48:51]
    v_exp_f32 v18, v74
    v_mfma_f32_16x16x32_bf16 a[96:99], v[168:171], v[24:27], a[96:99]
    ds_read_b128 v[44:47], v1 offset:13824
    v_fma_f32 v246, v246, v48, v50
    v_mfma_f32_16x16x32_bf16 a[96:99], v[184:187], v[28:31], a[96:99]
    v_add_f32 v6, v6, v16
    v_add_f32 v6, v6, v17
    v_mfma_f32_16x16x32_bf16 a[144:147], v[172:175], v[24:27], a[144:147]
    v_exp_f32 v19, v75
    v_mfma_f32_16x16x32_bf16 a[144:147], v[188:191], v[28:31], a[144:147]
    s_waitcnt lgkmcnt(2)
    v_fma_f32 v247, v247, v49, v51
    v_mfma_f32_16x16x32_bf16 a[4:7], v[160:163], v[32:35], a[4:7]
    ds_read_b128 v[24:27], v1 offset:2304
    v_cvt_pk_bf16_f32 v72, v16, v17
    v_mfma_f32_16x16x32_bf16 a[4:7], v[176:179], v[36:39], a[4:7]
    v_exp_f32 v16, v104
    v_mfma_f32_16x16x32_bf16 a[52:55], v[164:167], v[32:35], a[52:55]
    v_cvt_pk_bf16_f32 v227, v242, v243
    v_add_f32 v6, v6, v18
    v_mfma_f32_16x16x32_bf16 a[52:55], v[180:183], v[36:39], a[52:55]
    v_add_f32 v6, v6, v19
    v_mfma_f32_16x16x32_bf16 a[100:103], v[168:171], v[32:35], a[100:103]
    ds_read_b128 v[28:31], v1 offset:14592
    v_cvt_pk_bf16_f32 v231, v246, v247
    v_mfma_f32_16x16x32_bf16 a[100:103], v[184:187], v[36:39], a[100:103]
    v_exp_f32 v17, v105
    v_mfma_f32_16x16x32_bf16 a[148:151], v[172:175], v[32:35], a[148:151]
    v_cvt_pk_bf16_f32 v73, v18, v19
    v_mfma_f32_16x16x32_bf16 a[148:151], v[188:191], v[36:39], a[148:151]
    s_waitcnt lgkmcnt(2)
    v_exp_f32 v18, v106
    v_mfma_f32_16x16x32_bf16 a[8:11], v[160:163], v[40:43], a[8:11]
    s_waitcnt vmcnt(18)
    ds_read_b128 v[32:35], v21 offset:0
    v_add_f32 v6, v6, v16
    v_mfma_f32_16x16x32_bf16 a[8:11], v[176:179], v[44:47], a[8:11]
    v_add_f32 v6, v6, v17
    v_mfma_f32_16x16x32_bf16 a[56:59], v[164:167], v[40:43], a[56:59]
    v_exp_f32 v19, v107
    v_mfma_f32_16x16x32_bf16 a[56:59], v[180:183], v[44:47], a[56:59]
    v_mfma_f32_16x16x32_bf16 a[104:107], v[168:171], v[40:43], a[104:107]
    ds_read_b128 v[36:39], v21 offset:12288
    v_cvt_pk_bf16_f32 v74, v16, v17
    v_mfma_f32_16x16x32_bf16 a[104:107], v[184:187], v[44:47], a[104:107]
    v_exp_f32 v16, v76
    v_mfma_f32_16x16x32_bf16 a[152:155], v[172:175], v[40:43], a[152:155]
    v_cvt_f32_i32 v248, v248
    v_add_f32 v6, v6, v18
    v_mfma_f32_16x16x32_bf16 a[152:155], v[188:191], v[44:47], a[152:155]
    s_waitcnt lgkmcnt(2)
    v_add_f32 v6, v6, v19
    v_cvt_f32_i32 v249, v249
    v_mfma_f32_16x16x32_bf16 a[12:15], v[160:163], v[24:27], a[12:15]
    ds_read_b128 v[40:43], v21 offset:768
    v_mfma_f32_16x16x32_bf16 a[12:15], v[176:179], v[28:31], a[12:15]
    buffer_load_dwordx4 v[240:243], v12, s[68:71], s36 offen offset:0 nt
    v_mfma_f32_16x16x32_bf16 a[60:63], v[164:167], v[24:27], a[60:63]
    v_exp_f32 v17, v77
    v_mfma_f32_16x16x32_bf16 a[60:63], v[180:183], v[28:31], a[60:63]
    v_cvt_pk_bf16_f32 v75, v18, v19
    v_cvt_f32_i32 v252, v252
    v_mfma_f32_16x16x32_bf16 a[108:111], v[168:171], v[24:27], a[108:111]
    ds_read_b128 v[44:47], v21 offset:13056
    v_mfma_f32_16x16x32_bf16 a[108:111], v[184:187], v[28:31], a[108:111]
    v_exp_f32 v18, v78
    v_mfma_f32_16x16x32_bf16 a[156:159], v[172:175], v[24:27], a[156:159]
    s_add_u32 s29, s28, 49152
    v_add_f32 v7, v7, v16
    v_add_f32 v7, v7, v17
    v_mfma_f32_16x16x32_bf16 a[156:159], v[188:191], v[28:31], a[156:159]
    s_waitcnt lgkmcnt(2)
    v_exp_f32 v19, v79
    v_mfma_f32_16x16x32_bf16 a[16:19], v[160:163], v[32:35], a[16:19]
    ds_read_b128 v[24:27], v21 offset:1536
    v_cvt_pk_bf16_f32 v76, v16, v17
    v_mfma_f32_16x16x32_bf16 a[16:19], v[176:179], v[36:39], a[16:19]
    s_sub_u32 s3, s29, 147456
    buffer_load_dwordx4 v[244:247], v12, s[68:71], s36 offen offset:768 nt
    v_mfma_f32_16x16x32_bf16 a[64:67], v[164:167], v[32:35], a[64:67]
    v_exp_f32 v16, v108
    v_mfma_f32_16x16x32_bf16 a[64:67], v[180:183], v[36:39], a[64:67]
    v_add_f32 v7, v7, v18
    v_cvt_f32_i32 v253, v253
    v_mfma_f32_16x16x32_bf16 a[112:115], v[168:171], v[32:35], a[112:115]
    ds_read_b128 v[28:31], v21 offset:13824
    v_add_f32 v7, v7, v19
    v_mfma_f32_16x16x32_bf16 a[112:115], v[184:187], v[36:39], a[112:115]
    v_exp_f32 v17, v109
    v_mfma_f32_16x16x32_bf16 a[160:163], v[172:175], v[32:35], a[160:163]
    v_fma_f32 v248, v248, v60, v62
    v_cvt_pk_bf16_f32 v77, v18, v19
    v_mfma_f32_16x16x32_bf16 a[160:163], v[188:191], v[36:39], a[160:163]
    s_waitcnt lgkmcnt(2)
    v_exp_f32 v18, v110
    v_mfma_f32_16x16x32_bf16 a[20:23], v[160:163], v[40:43], a[20:23]
    s_min_u32 s29, s29, s3
    ds_read_b128 v[32:35], v21 offset:2304
    v_fma_f32 v249, v249, v61, v63
    v_mfma_f32_16x16x32_bf16 a[20:23], v[176:179], v[44:47], a[20:23]
    v_add_f32 v7, v7, v16
    v_add_f32 v7, v7, v17
    v_mfma_f32_16x16x32_bf16 a[68:71], v[164:167], v[40:43], a[68:71]
    v_exp_f32 v19, v111
    v_mfma_f32_16x16x32_bf16 a[68:71], v[180:183], v[44:47], a[68:71]
    v_fma_f32 v252, v252, v60, v62
    v_mfma_f32_16x16x32_bf16 a[116:119], v[168:171], v[40:43], a[116:119]
    ds_read_b128 v[36:39], v21 offset:14592
    v_cvt_pk_bf16_f32 v78, v16, v17
    v_mfma_f32_16x16x32_bf16 a[116:119], v[184:187], v[44:47], a[116:119]
    s_waitcnt vmcnt(2)
    v_subrev_u32 v52, s92, v52
    v_cmp_lt_u32 vcc, 15, v52
    v_mfma_f32_16x16x32_bf16 a[164:167], v[172:175], v[40:43], a[164:167]
    s_sub_u32 s3, s29, s28
    v_exp_f32 v16, v80
    v_mfma_f32_16x16x32_bf16 a[164:167], v[188:191], v[44:47], a[164:167]
    s_waitcnt lgkmcnt(2)
    v_add_f32 v7, v7, v18
    v_add_f32 v7, v7, v19
    v_mfma_f32_16x16x32_bf16 a[24:27], v[160:163], v[24:27], a[24:27]
    s_and_b32 s59, vcc_lo, 0xff
    ds_read_b128 v[40:43], v22 offset:0
    v_fma_f32 v253, v253, v61, v63
    v_mfma_f32_16x16x32_bf16 a[24:27], v[176:179], v[28:31], a[24:27]
    s_cbranch_scc1 L_pollslow1
L_pollok1:
    v_mfma_f32_16x16x32_bf16 a[72:75], v[164:167], v[24:27], a[72:75]
    s_add_u32 s92, s92, 1
    v_exp_f32 v17, v81
    v_mfma_f32_16x16x32_bf16 a[72:75], v[180:183], v[28:31], a[72:75]
    s_mov_b32 m0, s56
    v_cvt_pk_bf16_f32 v79, v18, v19
    v_cvt_pk_bf16_f32 v234, v248, v249
    v_mfma_f32_16x16x32_bf16 a[120:123], v[168:171], v[24:27], a[120:123]
    ds_read_b128 v[44:47], v22 offset:12288
    v_mfma_f32_16x16x32_bf16 a[120:123], v[184:187], v[28:31], a[120:123]
    s_mov_b32 s28, s29
    buffer_load_dwordx4 v8, s[4:7], s27 offen offset:0 sc1 lds
    v_mfma_f32_16x16x32_bf16 a[168:171], v[172:175], v[24:27], a[168:171]
    v_exp_f32 v18, v82
    v_mfma_f32_16x16x32_bf16 a[168:171], v[188:191], v[28:31], a[168:171]
    s_waitcnt lgkmcnt(2)
    v_add_f32 v4, v4, v16
    v_add_f32 v4, v4, v17
    v_mfma_f32_16x16x32_bf16 a[28:31], v[160:163], v[32:35], a[28:31]
    ds_read_b128 v[24:27], v22 offset:768
    v_cvt_pk_bf16_f32 v238, v252, v253
    v_mfma_f32_16x16x32_bf16 a[28:31], v[176:179], v[36:39], a[28:31]
    buffer_load_dwordx4 v8, s[4:7], s27 offen offset:1024 sc1 lds
    v_mfma_f32_16x16x32_bf16 a[76:79], v[164:167], v[32:35], a[76:79]
    v_exp_f32 v19, v83
    v_mfma_f32_16x16x32_bf16 a[76:79], v[180:183], v[36:39], a[76:79]
    v_cvt_pk_bf16_f32 v80, v16, v17
    v_cvt_f32_i32 v250, v250
    v_mfma_f32_16x16x32_bf16 a[124:127], v[168:171], v[32:35], a[124:127]
    ds_read_b128 v[28:31], v22 offset:13056
    v_cvt_f32_i32 v251, v251
    v_mfma_f32_16x16x32_bf16 a[124:127], v[184:187], v[36:39], a[124:127]
    buffer_load_dwordx4 v8, s[4:7], s27 offen offset:2048 sc1 lds
    v_mfma_f32_16x16x32_bf16 a[172:175], v[172:175], v[32:35], a[172:175]
    v_exp_f32 v16, v112
    v_mfma_f32_16x16x32_bf16 a[172:175], v[188:191], v[36:39], a[172:175]
    s_waitcnt lgkmcnt(2)
    v_add_f32 v4, v4, v18
    v_add_f32 v4, v4, v19
    v_mfma_f32_16x16x32_bf16 a[32:35], v[160:163], v[40:43], a[32:35]
    s_add_u32 s27, s27, 24576
    ds_read_b128 v[32:35], v22 offset:1536
    v_add_u32 v2, s3, v2
    v_mfma_f32_16x16x32_bf16 a[32:35], v[176:179], v[44:47], a[32:35]
    v_exp_f32 v17, v113
    v_mfma_f32_16x16x32_bf16 a[80:83], v[164:167], v[40:43], a[80:83]
    s_add_u32 s56, s56, 12288
    v_cvt_pk_bf16_f32 v81, v18, v19
    v_cvt_f32_i32 v254, v254
    v_mfma_f32_16x16x32_bf16 a[80:83], v[180:183], v[44:47], a[80:83]
    v_exp_f32 v18, v114
    v_mfma_f32_16x16x32_bf16 a[128:131], v[168:171], v[40:43], a[128:131]
    ds_read_b128 v[36:39], v22 offset:13824
    v_add_f32 v4, v4, v16
    v_mfma_f32_16x16x32_bf16 a[128:131], v[184:187], v[44:47], a[128:131]
    s_mov_b32 m0, s56
    v_add_f32 v4, v4, v17
    v_cvt_f32_i32 v255, v255
    v_mfma_f32_16x16x32_bf16 a[176:179], v[172:175], v[40:43], a[176:179]
    v_exp_f32 v19, v115
    v_mfma_f32_16x16x32_bf16 a[176:179], v[188:191], v[44:47], a[176:179]
    s_waitcnt lgkmcnt(2)
    v_cvt_pk_bf16_f32 v82, v16, v17
    v_add_u32 v3, s3, v3
    v_mfma_f32_16x16x32_bf16 a[36:39], v[160:163], v[24:27], a[36:39]
    ds_read_b128 v[40:43], v22 offset:2304
    v_fma_f32 v250, v250, v48, v50
    v_mfma_f32_16x16x32_bf16 a[36:39], v[176:179], v[28:31], a[36:39]
    buffer_load_dwordx4 v8, s[4:7], s27 offen offset:0 sc1 lds
    v_mfma_f32_16x16x32_bf16 a[84:87], v[164:167], v[24:27], a[84:87]
    v_exp_f32 v16, v84
    v_mfma_f32_16x16x32_bf16 a[84:87], v[180:183], v[28:31], a[84:87]
    v_add_f32 v4, v4, v18
    v_add_f32 v4, v4, v19
    v_mfma_f32_16x16x32_bf16 a[132:135], v[168:171], v[24:27], a[132:135]
    ds_read_b128 v[44:47], v22 offset:14592
    v_fma_f32 v251, v251, v49, v51
    v_mfma_f32_16x16x32_bf16 a[132:135], v[184:187], v[28:31], a[132:135]
    s_waitcnt lgkmcnt(2)
    buffer_load_dwordx4 v8, s[4:7], s27 offen offset:1024 sc1 lds
    v_mfma_f32_16x16x32_bf16 a[180:183], v[172:175], v[24:27], a[180:183]
    s_waitcnt vmcnt(19)
    v_exp_f32 v17, v85
    v_mfma_f32_16x16x32_bf16 a[180:183], v[188:191], v[28:31], a[180:183]
    s_barrier
    v_cvt_pk_bf16_f32 v83, v18, v19
    v_mfma_f32_16x16x32_bf16 a[40:43], v[160:163], v[32:35], a[40:43]
    ds_read_b128 v[24:27], v2 offset:0
    v_fma_f32 v254, v254, v48, v50
    v_mfma_f32_16x16x32_bf16 a[40:43], v[176:179], v[36:39], a[40:43]
    buffer_load_dwordx4 v8, s[4:7], s27 offen offset:2048 sc1 lds
    v_mfma_f32_16x16x32_bf16 a[88:91], v[164:167], v[32:35], a[88:91]
    v_exp_f32 v18, v86
    v_mfma_f32_16x16x32_bf16 a[88:91], v[180:183], v[36:39], a[88:91]
    v_add_f32 v5, v5, v16
    v_add_f32 v5, v5, v17
    v_mfma_f32_16x16x32_bf16 a[136:139], v[168:171], v[32:35], a[136:139]
    ds_read_b128 v[28:31], v3 offset:0
    v_fma_f32 v255, v255, v49, v51
    v_mfma_f32_16x16x32_bf16 a[136:139], v[184:187], v[36:39], a[136:139]
    v_exp_f32 v19, v87
    v_cvt_pk_bf16_f32 v84, v16, v17
    v_mfma_f32_16x16x32_bf16 a[184:187], v[172:175], v[32:35], a[184:187]
    s_add_u32 s27, s27, 24576
    v_exp_f32 v16, v116
    v_mfma_f32_16x16x32_bf16 a[184:187], v[188:191], v[36:39], a[184:187]
    s_waitcnt lgkmcnt(2)
    v_add_f32 v5, v5, v18
    v_add_f32 v5, v5, v19
    v_mfma_f32_16x16x32_bf16 a[44:47], v[160:163], v[40:43], a[44:47]
    s_add_u32 s56, s56, 36864
    ds_read_b128 v[32:35], v2 offset:6144
    v_cvt_pk_bf16_f32 v235, v250, v251
    v_mfma_f32_16x16x32_bf16 a[44:47], v[176:179], v[44:47], a[44:47]
    s_sub_u32 s58, s56, 147456
    v_exp_f32 v17, v117
    v_mfma_f32_16x16x32_bf16 a[92:95], v[164:167], v[40:43], a[92:95]
    v_cvt_pk_bf16_f32 v85, v18, v19
    v_cvt_pk_bf16_f32 v239, v254, v255
    v_mfma_f32_16x16x32_bf16 a[92:95], v[180:183], v[44:47], a[92:95]
    s_min_u32 s56, s56, s58
    v_exp_f32 v18, v118
    v_mfma_f32_16x16x32_bf16 a[140:143], v[168:171], v[40:43], a[140:143]
    ds_read_b128 v[36:39], v3 offset:6144
    v_add_f32 v5, v5, v16
    v_mfma_f32_16x16x32_bf16 a[140:143], v[184:187], v[44:47], a[140:143]
    v_add_f32 v5, v5, v17
    v_mfma_f32_16x16x32_bf16 a[188:191], v[172:175], v[40:43], a[188:191]
    v_exp_f32 v19, v119
    v_mfma_f32_16x16x32_bf16 a[188:191], v[188:191], v[44:47], a[188:191]
    s_waitcnt lgkmcnt(2)
    v_cvt_pk_bf16_f32 v86, v16, v17
    v_add_f32 v5, v5, v18
    v_add_f32 v5, v5, v19
    v_cvt_pk_bf16_f32 v87, v18, v19
    v_mfma_f32_16x16x32_bf16 v[160:163], v[24:27], a[192:195], v[128:131]
    ds_read_b128 v[40:43], v2 offset:128
    v_mfma_f32_16x16x32_bf16 v[160:163], v[28:31], a[196:199], v[160:163]
    buffer_store_dwordx4 v[224:227], v11, s[4:7], s37 offen offset:0 sc1
    v_mfma_f32_16x16x32_bf16 v[164:167], v[24:27], a[216:219], v[132:135]
    v_exp_f32 v16, v88
    v_mfma_f32_16x16x32_bf16 v[164:167], v[28:31], a[220:223], v[164:167]
    v_exp_f32 v17, v89
    v_mfma_f32_16x16x32_bf16 v[168:171], v[24:27], a[240:243], v[136:139]
    ds_read_b128 v[44:47], v3 offset:128
    v_mfma_f32_16x16x32_bf16 v[168:171], v[28:31], a[244:247], v[168:171]
    v_exp_f32 v18, v90
    v_mfma_f32_16x16x32_bf16 v[172:175], v[24:27], v[200:203], v[140:143]
    v_add_f32 v6, v6, v16
    v_add_f32 v6, v6, v17
    v_mfma_f32_16x16x32_bf16 v[172:175], v[28:31], v[204:207], v[172:175]
    s_waitcnt lgkmcnt(2)
    v_exp_f32 v19, v91
    v_mfma_f32_16x16x32_bf16 v[96:99], v[32:35], a[192:195], v[128:131]
    ds_read_b128 v[24:27], v2 offset:6272
    v_cvt_pk_bf16_f32 v88, v16, v17
    v_mfma_f32_16x16x32_bf16 v[96:99], v[36:39], a[196:199], v[96:99]
    buffer_store_dwordx4 v[228:231], v54, s[4:7], s37 offen offset:768 sc1
    v_mfma_f32_16x16x32_bf16 v[100:103], v[32:35], a[216:219], v[132:135]
    v_exp_f32 v16, v120
    v_mfma_f32_16x16x32_bf16 v[100:103], v[36:39], a[220:223], v[100:103]
    v_add_f32 v6, v6, v18
    v_mfma_f32_16x16x32_bf16 v[104:107], v[32:35], a[240:243], v[136:139]
    ds_read_b128 v[28:31], v3 offset:6272
    v_add_f32 v6, v6, v19
    v_mfma_f32_16x16x32_bf16 v[104:107], v[36:39], a[244:247], v[104:107]
    v_exp_f32 v17, v121
    v_mfma_f32_16x16x32_bf16 v[108:111], v[32:35], v[200:203], v[140:143]
    v_mfma_f32_16x16x32_bf16 v[108:111], v[36:39], v[204:207], v[108:111]
    s_waitcnt lgkmcnt(2)
    v_cvt_pk_bf16_f32 v89, v18, v19
    v_mfma_f32_16x16x32_bf16 v[160:163], v[40:43], a[200:203], v[160:163]
    ds_read_b128 v[32:35], v2 offset:256
    v_mfma_f32_16x16x32_bf16 v[160:163], v[44:47], a[204:207], v[160:163]
    buffer_store_dwordx4 v[232:235], v11, s[4:7], s80 offen offset:0 sc1
    v_mfma_f32_16x16x32_bf16 v[164:167], v[40:43], a[224:227], v[164:167]
    v_exp_f32 v18, v122
    v_mfma_f32_16x16x32_bf16 v[164:167], v[44:47], a[228:231], v[164:167]
    v_add_f32 v6, v6, v16
    v_add_f32 v6, v6, v17
    v_mfma_f32_16x16x32_bf16 v[168:171], v[40:43], a[248:251], v[168:171]
    ds_read_b128 v[36:39], v3 offset:256
    v_mfma_f32_16x16x32_bf16 v[168:171], v[44:47], a[252:255], v[168:171]
    v_exp_f32 v19, v123
    v_mfma_f32_16x16x32_bf16 v[172:175], v[40:43], v[208:211], v[172:175]
    v_cvt_pk_bf16_f32 v90, v16, v17
    v_mfma_f32_16x16x32_bf16 v[172:175], v[44:47], v[212:215], v[172:175]
    s_waitcnt lgkmcnt(2)
    v_exp_f32 v16, v92
    v_mfma_f32_16x16x32_bf16 v[96:99], v[24:27], a[200:203], v[96:99]
    ds_read_b128 v[40:43], v2 offset:6400
    v_add_f32 v6, v6, v18
    v_mfma_f32_16x16x32_bf16 v[96:99], v[28:31], a[204:207], v[96:99]
    buffer_store_dwordx4 v[236:239], v54, s[4:7], s80 offen offset:768 sc1
    v_mfma_f32_16x16x32_bf16 v[100:103], v[24:27], a[224:227], v[100:103]
    v_add_f32 v6, v6, v19
    v_mfma_f32_16x16x32_bf16 v[100:103], v[28:31], a[228:231], v[100:103]
    v_exp_f32 v17, v93
    v_mfma_f32_16x16x32_bf16 v[104:107], v[24:27], a[248:251], v[104:107]
    ds_read_b128 v[44:47], v3 offset:6400
    v_cvt_pk_bf16_f32 v91, v18, v19
    v_mfma_f32_16x16x32_bf16 v[104:107], v[28:31], a[252:255], v[104:107]
    v_exp_f32 v18, v94
    v_mfma_f32_16x16x32_bf16 v[108:111], v[24:27], v[208:211], v[108:111]
    s_add_u32 s29, s30, 49152
    ds_read_b128 v[60:63], v23 offset:16
    v_add_f32 v7, v7, v16
    v_mfma_f32_16x16x32_bf16 v[108:111], v[28:31], v[212:215], v[108:111]
    s_waitcnt lgkmcnt(3)
    v_add_f32 v7, v7, v17
    s_waitcnt vmcnt(21)
    s_branch L_skip5
L_pad5:
    s_branch L_tb1_9
L_skip5:
    v_mfma_f32_16x16x32_bf16 v[160:163], v[32:35], a[208:211], v[160:163]
    ds_read_b128 v[24:27], v2 offset:12288
    s_sub_u32 s3, s29, 147456
    v_mfma_f32_16x16x32_bf16 v[160:163], v[36:39], a[212:215], v[160:163]
    buffer_load_dwordx4 v[248:251], v12, s[68:71], s36 offen offset:1536 nt
    v_mfma_f32_16x16x32_bf16 v[164:167], v[32:35], a[232:235], v[164:167]
    v_exp_f32 v19, v95
    v_mfma_f32_16x16x32_bf16 v[164:167], v[36:39], a[236:239], v[164:167]
    v_cvt_pk_bf16_f32 v92, v16, v17
    v_cvt_f32_i32 v144, v144
    v_mfma_f32_16x16x32_bf16 v[168:171], v[32:35], v[192:195], v[168:171]
    ds_read_b128 v[28:31], v3 offset:12288
    v_cvt_f32_i32 v148, v148
    v_mfma_f32_16x16x32_bf16 v[168:171], v[36:39], v[196:199], v[168:171]
    buffer_load_dwordx4 v[252:255], v12, s[68:71], s36 offen offset:2304 nt
    v_mfma_f32_16x16x32_bf16 v[172:175], v[32:35], v[216:219], v[172:175]
    s_min_u32 s29, s29, s3
    v_exp_f32 v16, v124
    v_mfma_f32_16x16x32_bf16 v[172:175], v[36:39], v[220:223], v[172:175]
    s_waitcnt lgkmcnt(3)
    v_add_f32 v7, v7, v18
    v_add_f32 v7, v7, v19
    v_mfma_f32_16x16x32_bf16 v[96:99], v[40:43], a[208:211], v[96:99]
    ds_read_b128 v[32:35], v2 offset:18432
    v_cvt_f32_i32 v145, v145
    v_mfma_f32_16x16x32_bf16 v[96:99], v[44:47], a[212:215], v[96:99]
    v_exp_f32 v17, v125
    v_mfma_f32_16x16x32_bf16 v[100:103], v[40:43], a[232:235], v[100:103]
    ds_read_b128 v[48:51], v23 offset:32
    v_cvt_pk_bf16_f32 v93, v18, v19
    v_mfma_f32_16x16x32_bf16 v[100:103], v[44:47], a[236:239], v[100:103]
    v_exp_f32 v18, v126
    v_mfma_f32_16x16x32_bf16 v[104:107], v[40:43], v[192:195], v[104:107]
    s_mov_b32 m0, s56
    ds_read_b128 v[36:39], v3 offset:18432
    v_add_f32 v7, v7, v16
    v_mfma_f32_16x16x32_bf16 v[104:107], v[44:47], v[196:199], v[104:107]
    s_sub_u32 s3, s29, s30
    v_add_f32 v7, v7, v17
    v_cvt_f32_i32 v149, v149
    v_mfma_f32_16x16x32_bf16 v[108:111], v[40:43], v[216:219], v[108:111]
    v_exp_f32 v19, v127
    v_mfma_f32_16x16x32_bf16 v[108:111], v[44:47], v[220:223], v[108:111]
    s_waitcnt lgkmcnt(3)
    buffer_load_dwordx4 v8, s[4:7], s27 offen offset:0 sc1 lds
    v_mfma_f32_16x16x32_bf16 v[176:179], v[24:27], a[192:195], v[128:131]
    ds_read_b128 v[40:43], v2 offset:12416
    v_cvt_pk_bf16_f32 v94, v16, v17
    v_mfma_f32_16x16x32_bf16 v[176:179], v[28:31], a[196:199], v[176:179]
    v_add_f32 v7, v7, v18
    v_add_f32 v7, v7, v19
    v_mfma_f32_16x16x32_bf16 v[180:183], v[24:27], a[216:219], v[132:135]
    s_mov_b32 s30, s29
    v_cvt_pk_bf16_f32 v95, v18, v19
    v_fma_f32 v144, v144, v56, v58
    v_mfma_f32_16x16x32_bf16 v[180:183], v[28:31], a[220:223], v[180:183]
    v_fma_f32 v148, v148, v57, v59
    v_fma_f32 v145, v145, v56, v58
    v_mfma_f32_16x16x32_bf16 v[184:187], v[24:27], a[240:243], v[136:139]
    ds_read_b128 v[44:47], v3 offset:12416
    v_fma_f32 v149, v149, v57, v59
    v_mfma_f32_16x16x32_bf16 v[184:187], v[28:31], a[244:247], v[184:187]
    buffer_load_dwordx4 v8, s[4:7], s27 offen offset:1024 sc1 lds
    v_mfma_f32_16x16x32_bf16 v[188:191], v[24:27], v[200:203], v[140:143]
    v_exp_f32 v16, v160
    v_mfma_f32_16x16x32_bf16 v[188:191], v[28:31], v[204:207], v[188:191]
    s_waitcnt lgkmcnt(2)
    v_exp_f32 v17, v161
    v_mfma_f32_16x16x32_bf16 v[112:115], v[32:35], a[192:195], v[128:131]
    ds_read_b128 v[24:27], v2 offset:18560
    v_cvt_f32_i32 v146, v146
    v_mfma_f32_16x16x32_bf16 v[112:115], v[36:39], a[196:199], v[112:115]
    v_exp_f32 v18, v162
    v_mfma_f32_16x16x32_bf16 v[116:119], v[32:35], a[216:219], v[132:135]
    v_add_f32 v4, v4, v16
    v_add_f32 v4, v4, v17
    v_mfma_f32_16x16x32_bf16 v[116:119], v[36:39], a[220:223], v[116:119]
    buffer_load_dwordx4 v8, s[4:7], s27 offen offset:2048 sc1 lds
    v_mfma_f32_16x16x32_bf16 v[120:123], v[32:35], a[240:243], v[136:139]
    ds_read_b128 v[28:31], v3 offset:18560
    v_cvt_f32_i32 v150, v150
    v_mfma_f32_16x16x32_bf16 v[120:123], v[36:39], a[244:247], v[120:123]
    v_exp_f32 v19, v163
    v_mfma_f32_16x16x32_bf16 v[124:127], v[32:35], v[200:203], v[140:143]
    v_cvt_pk_bf16_f32 v160, v16, v17
    v_cvt_f32_i32 v147, v147
    v_mfma_f32_16x16x32_bf16 v[124:127], v[36:39], v[204:207], v[124:127]
    s_waitcnt lgkmcnt(2)
    v_exp_f32 v16, v96
    v_mfma_f32_16x16x32_bf16 v[176:179], v[40:43], a[200:203], v[176:179]
    s_add_u32 s27, s27, 24576
    ds_read_b128 v[32:35], v2 offset:12544
    v_add_f32 v4, v4, v18
    v_mfma_f32_16x16x32_bf16 v[176:179], v[44:47], a[204:207], v[176:179]
    v_add_f32 v4, v4, v19
    v_cvt_f32_i32 v151, v151
    v_mfma_f32_16x16x32_bf16 v[180:183], v[40:43], a[224:227], v[180:183]
    s_add_u32 s56, s56, 12288
    v_exp_f32 v17, v97
    v_mfma_f32_16x16x32_bf16 v[180:183], v[44:47], a[228:231], v[180:183]
    v_cvt_pk_bf16_f32 v161, v18, v19
    v_add_u32 v1, s3, v1
    v_mfma_f32_16x16x32_bf16 v[184:187], v[40:43], a[248:251], v[184:187]
    ds_read_b128 v[36:39], v3 offset:12544
    v_fma_f32 v146, v146, v56, v58
    v_mfma_f32_16x16x32_bf16 v[184:187], v[44:47], a[252:255], v[184:187]
    v_exp_f32 v18, v98
    v_mfma_f32_16x16x32_bf16 v[188:191], v[40:43], v[208:211], v[188:191]
    s_mov_b32 m0, s56
    v_add_f32 v4, v4, v16
    v_add_f32 v4, v4, v17
    v_mfma_f32_16x16x32_bf16 v[188:191], v[44:47], v[212:215], v[188:191]
    s_waitcnt lgkmcnt(2)
    v_exp_f32 v19, v99
    v_mfma_f32_16x16x32_bf16 v[112:115], v[24:27], a[200:203], v[112:115]
    ds_read_b128 v[40:43], v2 offset:18688
    v_fma_f32 v150, v150, v57, v59
    v_mfma_f32_16x16x32_bf16 v[112:115], v[28:31], a[204:207], v[112:115]
    v_cvt_pk_bf16_f32 v162, v16, v17
    v_add_u32 v21, s3, v21
    v_mfma_f32_16x16x32_bf16 v[116:119], v[24:27], a[224:227], v[116:119]
    v_exp_f32 v16, v164
    v_mfma_f32_16x16x32_bf16 v[116:119], v[28:31], a[228:231], v[116:119]
    buffer_load_dwordx4 v8, s[4:7], s27 offen offset:0 sc1 lds
    v_mfma_f32_16x16x32_bf16 v[120:123], v[24:27], a[248:251], v[120:123]
    ds_read_b128 v[44:47], v3 offset:18688
    v_add_u32 v22, s3, v22
    v_mfma_f32_16x16x32_bf16 v[120:123], v[28:31], a[252:255], v[120:123]
    s_waitcnt lgkmcnt(2)
    v_add_f32 v4, v4, v18
    v_add_f32 v4, v4, v19
    v_mfma_f32_16x16x32_bf16 v[124:127], v[24:27], v[208:211], v[124:127]
    s_waitcnt vmcnt(6)
    v_exp_f32 v17, v165
    v_mfma_f32_16x16x32_bf16 v[124:127], v[28:31], v[212:215], v[124:127]
    s_barrier
    v_fma_f32 v147, v147, v56, v58
    v_mfma_f32_16x16x32_bf16 v[176:179], v[32:35], a[208:211], v[176:179]
    ds_read_b128 v[24:27], v1 offset:0
    v_cvt_pk_bf16_f32 v163, v18, v19
    v_mfma_f32_16x16x32_bf16 v[176:179], v[36:39], a[212:215], v[176:179]
    buffer_load_dwordx4 v8, s[4:7], s27 offen offset:1024 sc1 lds
    v_mfma_f32_16x16x32_bf16 v[180:183], v[32:35], a[232:235], v[180:183]
    v_exp_f32 v18, v166
    v_mfma_f32_16x16x32_bf16 v[180:183], v[36:39], a[236:239], v[180:183]
    v_add_f32 v5, v5, v16
    v_add_f32 v5, v5, v17
    v_mfma_f32_16x16x32_bf16 v[184:187], v[32:35], v[192:195], v[184:187]
    ds_read_b128 v[28:31], v1 offset:12288
    v_fma_f32 v151, v151, v57, v59
    v_mfma_f32_16x16x32_bf16 v[184:187], v[36:39], v[196:199], v[184:187]
    v_exp_f32 v19, v167
    v_mfma_f32_16x16x32_bf16 v[188:191], v[32:35], v[216:219], v[188:191]
    ds_read_b128 v[56:59], v23 offset:48
    v_cvt_pk_bf16_f32 v164, v16, v17
    v_mfma_f32_16x16x32_bf16 v[188:191], v[36:39], v[220:223], v[188:191]
    s_waitcnt lgkmcnt(3)
    buffer_load_dwordx4 v8, s[4:7], s27 offen offset:2048 sc1 lds
    v_mfma_f32_16x16x32_bf16 v[112:115], v[40:43], a[208:211], v[112:115]
    s_waitcnt vmcnt(27)
    ds_read_b128 v[32:35], v1 offset:768
    v_cvt_f32_i32 v152, v152
    v_mfma_f32_16x16x32_bf16 v[112:115], v[44:47], a[212:215], v[112:115]
    v_exp_f32 v16, v100
    v_add_f32 v5, v5, v18
    v_mfma_f32_16x16x32_bf16 v[116:119], v[40:43], a[232:235], v[116:119]
    v_add_f32 v5, v5, v19
    v_cvt_f32_i32 v156, v156
    v_mfma_f32_16x16x32_bf16 v[116:119], v[44:47], a[236:239], v[116:119]
    v_exp_f32 v17, v101
    v_mfma_f32_16x16x32_bf16 v[120:123], v[40:43], v[192:195], v[120:123]
    ds_read_b128 v[36:39], v1 offset:13056
    v_cvt_pk_bf16_f32 v165, v18, v19
    v_mfma_f32_16x16x32_bf16 v[120:123], v[44:47], v[196:199], v[120:123]
    v_add_u32 v55, 1, v55
    buffer_store_dword v55, v13, s[20:23], 0 offen sc1
    v_mfma_f32_16x16x32_bf16 v[124:127], v[40:43], v[216:219], v[124:127]
    s_add_u32 s27, s27, 24576
    v_exp_f32 v18, v102
    v_mfma_f32_16x16x32_bf16 v[124:127], v[44:47], v[220:223], v[124:127]
    s_waitcnt lgkmcnt(3)
    v_add_f32 v5, v5, v16
    v_add_f32 v5, v5, v17
    v_exp_f32 v19, v103
    v_cvt_f32_i32 v153, v153
    v_add_u32 v23, 1792, v23
    v_cvt_pk_bf16_f32 v166, v16, v17
    v_cvt_f32_i32 v157, v157
    v_add_f32 v5, v5, v18
    s_add_u32 s56, s56, 36864
    v_fma_f32 v152, v152, v60, v62
    v_add_f32 v5, v5, v19
    s_sub_u32 s58, s56, 147456
    v_fma_f32 v156, v156, v61, v63
    v_cvt_pk_bf16_f32 v167, v18, v19
    s_min_u32 s56, s56, s58
    v_fma_f32 v153, v153, v60, v62
    v_mfma_f32_16x16x32_bf16 a[0:3], v[64:67], v[24:27], a[0:3]
    s_mov_b32 m0, s26
    ds_read_b128 v[40:43], v1 offset:1536
    v_fma_f32 v157, v157, v61, v63
    v_mfma_f32_16x16x32_bf16 a[0:3], v[80:83], v[28:31], a[0:3]
    v_exp_f32 v16, v168
    v_mfma_f32_16x16x32_bf16 a[48:51], v[68:71], v[24:27], a[48:51]
    v_exp_f32 v17, v169
    v_mfma_f32_16x16x32_bf16 a[48:51], v[84:87], v[28:31], a[48:51]
    buffer_load_dwordx4 v8, s[4:7], s32 offen offset:0 sc1 lds
    v_mfma_f32_16x16x32_bf16 a[96:99], v[72:75], v[24:27], a[96:99]
    ds_read_b128 v[44:47], v1 offset:13824
    v_cvt_f32_i32 v154, v154
    v_mfma_f32_16x16x32_bf16 a[96:99], v[88:91], v[28:31], a[96:99]
    v_exp_f32 v18, v170
    v_mfma_f32_16x16x32_bf16 a[144:147], v[76:79], v[24:27], a[144:147]
    v_add_f32 v6, v6, v16
    v_add_f32 v6, v6, v17
    v_mfma_f32_16x16x32_bf16 a[144:147], v[92:95], v[28:31], a[144:147]
    s_waitcnt lgkmcnt(2)
    buffer_load_dwordx4 v8, s[4:7], s32 offen offset:1024 sc1 lds
    v_mfma_f32_16x16x32_bf16 a[4:7], v[64:67], v[32:35], a[4:7]
    ds_read_b128 v[24:27], v1 offset:2304
    v_cvt_f32_i32 v158, v158
    v_mfma_f32_16x16x32_bf16 a[4:7], v[80:83], v[36:39], a[4:7]
    v_exp_f32 v19, v171
    v_mfma_f32_16x16x32_bf16 a[52:55], v[68:71], v[32:35], a[52:55]
    v_cvt_pk_bf16_f32 v168, v16, v17
    v_cvt_f32_i32 v155, v155
    v_mfma_f32_16x16x32_bf16 a[52:55], v[84:87], v[36:39], a[52:55]
    v_exp_f32 v16, v104
    v_mfma_f32_16x16x32_bf16 a[100:103], v[72:75], v[32:35], a[100:103]
    ds_read_b128 v[28:31], v1 offset:14592
    v_add_f32 v6, v6, v18
    v_mfma_f32_16x16x32_bf16 a[100:103], v[88:91], v[36:39], a[100:103]
    buffer_load_dwordx4 v8, s[4:7], s32 offen offset:2048 sc1 lds
    v_mfma_f32_16x16x32_bf16 a[148:151], v[76:79], v[32:35], a[148:151]
    v_add_f32 v6, v6, v19
    v_cvt_f32_i32 v159, v159
    v_mfma_f32_16x16x32_bf16 a[148:151], v[92:95], v[36:39], a[148:151]
    s_waitcnt lgkmcnt(2)
    v_exp_f32 v17, v105
    v_mfma_f32_16x16x32_bf16 a[8:11], v[64:67], v[40:43], a[8:11]
    s_add_u32 s32, s32, 24576
    ds_read_b128 v[32:35], v21 offset:0
    v_cvt_pk_bf16_f32 v169, v18, v19
    v_mfma_f32_16x16x32_bf16 a[8:11], v[80:83], v[44:47], a[8:11]
    v_exp_f32 v18, v106
    v_mfma_f32_16x16x32_bf16 a[56:59], v[68:71], v[40:43], a[56:59]
    v_add_f32 v6, v6, v16
    v_add_f32 v6, v6, v17
    v_mfma_f32_16x16x32_bf16 a[56:59], v[84:87], v[44:47], a[56:59]
    s_add_u32 s26, s26, 12288
    v_fma_f32 v154, v154, v60, v62
    v_fma_f32 v158, v158, v61, v63
    v_mfma_f32_16x16x32_bf16 a[104:107], v[72:75], v[40:43], a[104:107]
    ds_read_b128 v[36:39], v21 offset:12288
    v_fma_f32 v155, v155, v60, v62
    v_mfma_f32_16x16x32_bf16 a[104:107], v[88:91], v[44:47], a[104:107]
    v_exp_f32 v19, v107
    v_mfma_f32_16x16x32_bf16 a[152:155], v[76:79], v[40:43], a[152:155]
    s_mov_b32 m0, s56
    v_cvt_pk_bf16_f32 v170, v16, v17
    v_mfma_f32_16x16x32_bf16 a[152:155], v[92:95], v[44:47], a[152:155]
    s_waitcnt lgkmcnt(2)
    v_exp_f32 v16, v172
    v_mfma_f32_16x16x32_bf16 a[12:15], v[64:67], v[24:27], a[12:15]
    ds_read_b128 v[40:43], v21 offset:768
    v_add_f32 v6, v6, v18
    v_mfma_f32_16x16x32_bf16 a[12:15], v[80:83], v[28:31], a[12:15]
    buffer_load_dwordx4 v8, s[4:7], s27 offen offset:0 sc1 lds
    v_mfma_f32_16x16x32_bf16 a[60:63], v[68:71], v[24:27], a[60:63]
    v_add_f32 v6, v6, v19
    v_fma_f32 v159, v159, v61, v63
    v_mfma_f32_16x16x32_bf16 a[60:63], v[84:87], v[28:31], a[60:63]
    v_exp_f32 v17, v173
    v_mfma_f32_16x16x32_bf16 a[108:111], v[72:75], v[24:27], a[108:111]
    ds_read_b128 v[44:47], v21 offset:13056
    v_cvt_pk_bf16_f32 v171, v18, v19
    v_mfma_f32_16x16x32_bf16 a[108:111], v[88:91], v[28:31], a[108:111]
    v_exp_f32 v18, v174
    v_mfma_f32_16x16x32_bf16 a[156:159], v[76:79], v[24:27], a[156:159]
    s_add_u32 s29, s28, 49152
    v_add_f32 v7, v7, v16
    v_add_f32 v7, v7, v17
    v_mfma_f32_16x16x32_bf16 a[156:159], v[92:95], v[28:31], a[156:159]
    s_waitcnt lgkmcnt(2)
    buffer_load_dwordx4 v8, s[4:7], s27 offen offset:1024 sc1 lds
    v_mfma_f32_16x16x32_bf16 a[16:19], v[64:67], v[32:35], a[16:19]
    ds_read_b128 v[24:27], v21 offset:1536
    v_cvt_pk_bf16_f32 v144, v144, v148
    v_mfma_f32_16x16x32_bf16 a[16:19], v[80:83], v[36:39], a[16:19]
    s_sub_u32 s3, s29, 147456
    v_exp_f32 v19, v175
    v_mfma_f32_16x16x32_bf16 a[64:67], v[68:71], v[32:35], a[64:67]
    v_cvt_pk_bf16_f32 v172, v16, v17
    v_cvt_pk_bf16_f32 v148, v145, v149
    v_mfma_f32_16x16x32_bf16 a[64:67], v[84:87], v[36:39], a[64:67]
    v_exp_f32 v16, v108
    v_mfma_f32_16x16x32_bf16 a[112:115], v[72:75], v[32:35], a[112:115]
    ds_read_b128 v[28:31], v21 offset:13824
    v_add_f32 v7, v7, v18
    v_mfma_f32_16x16x32_bf16 a[112:115], v[88:91], v[36:39], a[112:115]
    buffer_load_dwordx4 v8, s[4:7], s27 offen offset:2048 sc1 lds
    v_mfma_f32_16x16x32_bf16 a[160:163], v[76:79], v[32:35], a[160:163]
    v_add_f32 v7, v7, v19
    v_cvt_pk_bf16_f32 v145, v152, v156
    v_mfma_f32_16x16x32_bf16 a[160:163], v[92:95], v[36:39], a[160:163]
    s_waitcnt lgkmcnt(2)
    v_exp_f32 v17, v109
    v_mfma_f32_16x16x32_bf16 a[20:23], v[64:67], v[40:43], a[20:23]
    s_add_u32 s27, s27, 24576
    ds_read_b128 v[32:35], v21 offset:2304
    v_cvt_pk_bf16_f32 v173, v18, v19
    v_mfma_f32_16x16x32_bf16 a[20:23], v[80:83], v[44:47], a[20:23]
    s_min_u32 s29, s29, s3
    v_exp_f32 v18, v110
    v_mfma_f32_16x16x32_bf16 a[68:71], v[68:71], v[40:43], a[68:71]
    s_add_u32 s56, s56, 12288
    v_add_f32 v7, v7, v16
    v_cvt_pk_bf16_f32 v149, v153, v157
    v_mfma_f32_16x16x32_bf16 a[68:71], v[84:87], v[44:47], a[68:71]
    v_add_f32 v7, v7, v17
    v_cvt_pk_bf16_f32 v152, v146, v150
    v_mfma_f32_16x16x32_bf16 a[116:119], v[72:75], v[40:43], a[116:119]
    ds_read_b128 v[36:39], v21 offset:14592
    v_cvt_pk_bf16_f32 v153, v154, v158
    v_mfma_f32_16x16x32_bf16 a[116:119], v[88:91], v[44:47], a[116:119]
    s_mov_b32 m0, s56
    v_exp_f32 v19, v111
    v_mfma_f32_16x16x32_bf16 a[164:167], v[76:79], v[40:43], a[164:167]
    s_sub_u32 s3, s29, s28
    v_cvt_pk_bf16_f32 v174, v16, v17
    v_cvt_pk_bf16_f32 v156, v147, v151
    v_mfma_f32_16x16x32_bf16 a[164:167], v[92:95], v[44:47], a[164:167]
    s_waitcnt lgkmcnt(2)
    v_exp_f32 v16, v176
    v_mfma_f32_16x16x32_bf16 a[24:27], v[64:67], v[24:27], a[24:27]
    ds_read_b128 v[40:43], v22 offset:0
    v_add_f32 v7, v7, v18
    v_mfma_f32_16x16x32_bf16 a[24:27], v[80:83], v[28:31], a[24:27]
    buffer_load_dwordx4 v8, s[4:7], s27 offen offset:0 sc1 lds
    v_mfma_f32_16x16x32_bf16 a[72:75], v[68:71], v[24:27], a[72:75]
    v_add_f32 v7, v7, v19
    v_cvt_pk_bf16_f32 v157, v155, v159
    v_mfma_f32_16x16x32_bf16 a[72:75], v[84:87], v[28:31], a[72:75]
    s_waitcnt vmcnt(26)
    v_exp_f32 v17, v177
    v_mfma_f32_16x16x32_bf16 a[120:123], v[72:75], v[24:27], a[120:123]
    ds_read_b128 v[44:47], v22 offset:12288
    v_cvt_pk_bf16_f32 v175, v18, v19
    v_mfma_f32_16x16x32_bf16 a[120:123], v[88:91], v[28:31], a[120:123]
    s_mov_b32 s28, s29
    v_exp_f32 v18, v178
    v_mfma_f32_16x16x32_bf16 a[168:171], v[76:79], v[24:27], a[168:171]
    v_add_f32 v4, v4, v16
    v_add_f32 v4, v4, v17
    v_mfma_f32_16x16x32_bf16 a[168:171], v[92:95], v[28:31], a[168:171]
    s_waitcnt lgkmcnt(2)
    buffer_load_dwordx4 v8, s[4:7], s27 offen offset:1024 sc1 lds
    v_mfma_f32_16x16x32_bf16 a[28:31], v[64:67], v[32:35], a[28:31]
    ds_read_b128 v[24:27], v22 offset:768
    v_cvt_f32_i32 v240, v240
    v_mfma_f32_16x16x32_bf16 a[28:31], v[80:83], v[36:39], a[28:31]
    v_exp_f32 v19, v179
    v_mfma_f32_16x16x32_bf16 a[76:79], v[68:71], v[32:35], a[76:79]
    v_cvt_pk_bf16_f32 v176, v16, v17
    v_cvt_f32_i32 v244, v244
    v_mfma_f32_16x16x32_bf16 a[76:79], v[84:87], v[36:39], a[76:79]
    buffer_load_dwordx4 v8, s[4:7], s27 offen offset:2048 sc1 lds
    v_mfma_f32_16x16x32_bf16 a[124:127], v[72:75], v[32:35], a[124:127]
    ds_read_b128 v[28:31], v22 offset:13056
    v_cvt_f32_i32 v241, v241
    v_mfma_f32_16x16x32_bf16 a[124:127], v[88:91], v[36:39], a[124:127]
    v_exp_f32 v16, v112
    v_mfma_f32_16x16x32_bf16 a[172:175], v[76:79], v[32:35], a[172:175]
    v_add_f32 v4, v4, v18
    v_add_f32 v4, v4, v19
    v_mfma_f32_16x16x32_bf16 a[172:175], v[92:95], v[36:39], a[172:175]
    s_waitcnt lgkmcnt(2)
    v_exp_f32 v17, v113
    v_mfma_f32_16x16x32_bf16 a[32:35], v[64:67], v[40:43], a[32:35]
    ds_read_b128 v[32:35], v22 offset:1536
    v_cvt_pk_bf16_f32 v177, v18, v19
    v_mfma_f32_16x16x32_bf16 a[32:35], v[80:83], v[44:47], a[32:35]
    s_add_u32 s27, s27, 24576
    v_exp_f32 v18, v114
    v_mfma_f32_16x16x32_bf16 a[80:83], v[68:71], v[40:43], a[80:83]
    s_add_u32 s56, s56, 36864
    v_add_f32 v4, v4, v16
    v_add_f32 v4, v4, v17
    v_mfma_f32_16x16x32_bf16 a[80:83], v[84:87], v[44:47], a[80:83]
    v_exp_f32 v19, v115
    v_mfma_f32_16x16x32_bf16 a[128:131], v[72:75], v[40:43], a[128:131]
    ds_read_b128 v[36:39], v22 offset:13824
    v_add_u32 v2, s3, v2
    v_mfma_f32_16x16x32_bf16 a[128:131], v[88:91], v[44:47], a[128:131]
    s_sub_u32 s58, s56, 147456
    v_bfe_u32 v53, v8, 4, 6
    v_cvt_pk_bf16_f32 v178, v16, v17
    v_mfma_f32_16x16x32_bf16 a[176:179], v[76:79], v[40:43], a[176:179]
    v_cvt_f32_i32 v245, v245
    v_lshlrev_b32 v53, 2, v53
    v_mfma_f32_16x16x32_bf16 a[176:179], v[92:95], v[44:47], a[176:179]
    s_waitcnt lgkmcnt(2)
    buffer_load_dword v52, v53, s[20:23], 0 offen sc1
    v_mfma_f32_16x16x32_bf16 a[36:39], v[64:67], v[24:27], a[36:39]
    s_min_u32 s56, s56, s58
    ds_read_b128 v[40:43], v22 offset:2304
    v_fma_f32 v240, v240, v48, v50
    v_mfma_f32_16x16x32_bf16 a[36:39], v[80:83], v[28:31], a[36:39]
    v_exp_f32 v16, v180
    v_mfma_f32_16x16x32_bf16 a[84:87], v[68:71], v[24:27], a[84:87]
    v_add_f32 v4, v4, v18
    v_add_f32 v4, v4, v19
    v_mfma_f32_16x16x32_bf16 a[84:87], v[84:87], v[28:31], a[84:87]
    v_exp_f32 v17, v181
    v_mfma_f32_16x16x32_bf16 a[132:135], v[72:75], v[24:27], a[132:135]
    ds_read_b128 v[44:47], v22 offset:14592
    v_add_u32 v3, s3, v3
    v_mfma_f32_16x16x32_bf16 a[132:135], v[88:91], v[28:31], a[132:135]
    s_waitcnt lgkmcnt(2)
    v_cvt_pk_bf16_f32 v179, v18, v19
    v_fma_f32 v244, v244, v49, v51
    v_mfma_f32_16x16x32_bf16 a[180:183], v[76:79], v[24:27], a[180:183]
    s_waitcnt vmcnt(32)
    v_exp_f32 v18, v182
    v_mfma_f32_16x16x32_bf16 a[180:183], v[92:95], v[28:31], a[180:183]
    s_barrier
    v_add_f32 v5, v5, v16
    v_mfma_f32_16x16x32_bf16 a[40:43], v[64:67], v[32:35], a[40:43]
    s_add_u32 s33, s33, 196608
    ds_read_b128 v[24:27], v2 offset:0
    v_add_f32 v5, v5, v17
    v_mfma_f32_16x16x32_bf16 a[40:43], v[80:83], v[36:39], a[40:43]
    s_sub_u32 s34, s33, 1572864
    v_exp_f32 v19, v183
    v_mfma_f32_16x16x32_bf16 a[88:91], v[68:71], v[32:35], a[88:91]
    s_min_u32 s33, s33, s34
    v_cvt_pk_bf16_f32 v180, v16, v17
    v_fma_f32 v241, v241, v48, v50
    v_mfma_f32_16x16x32_bf16 a[88:91], v[84:87], v[36:39], a[88:91]
    s_add_u32 s34, s33, 3072
    v_exp_f32 v16, v116
    v_mfma_f32_16x16x32_bf16 a[136:139], v[72:75], v[32:35], a[136:139]
    s_add_u32 s37, s37, 196608
    ds_read_b128 v[28:31], v3 offset:0
    v_fma_f32 v245, v245, v49, v51
    v_mfma_f32_16x16x32_bf16 a[136:139], v[88:91], v[36:39], a[136:139]
    s_add_u32 s80, s80, 196608
    v_add_f32 v5, v5, v18
    v_add_f32 v5, v5, v19
    v_mfma_f32_16x16x32_bf16 a[184:187], v[76:79], v[32:35], a[184:187]
    v_exp_f32 v17, v117
    v_mfma_f32_16x16x32_bf16 a[184:187], v[92:95], v[36:39], a[184:187]
    s_waitcnt lgkmcnt(2)
    buffer_load_dwordx4 v[224:227], v9, s[64:67], s33 offen offset:0 nt
    v_mfma_f32_16x16x32_bf16 a[44:47], v[64:67], v[40:43], a[44:47]
    ds_read_b128 v[32:35], v2 offset:6144
    v_cvt_pk_bf16_f32 v181, v18, v19
    v_mfma_f32_16x16x32_bf16 a[44:47], v[80:83], v[44:47], a[44:47]
    v_cvt_f32_i32 v242, v242
    v_cvt_f32_i32 v246, v246
    v_mfma_f32_16x16x32_bf16 a[92:95], v[68:71], v[40:43], a[92:95]
    v_exp_f32 v18, v118
    v_mfma_f32_16x16x32_bf16 a[92:95], v[84:87], v[44:47], a[92:95]
    buffer_load_dwordx4 v[228:231], v9, s[64:67], s33 offen offset:1536 nt
    v_mfma_f32_16x16x32_bf16 a[140:143], v[72:75], v[40:43], a[140:143]
    ds_read_b128 v[36:39], v3 offset:6144
    v_add_f32 v5, v5, v16
    v_mfma_f32_16x16x32_bf16 a[140:143], v[88:91], v[44:47], a[140:143]
    v_add_f32 v5, v5, v17
    v_cvt_f32_i32 v243, v243
    v_mfma_f32_16x16x32_bf16 a[188:191], v[76:79], v[40:43], a[188:191]
    buffer_load_dwordx4 v[232:235], v9, s[64:67], s34 offen offset:0 nt
    buffer_load_dwordx4 v[236:239], v9, s[64:67], s34 offen offset:1536 nt
    v_mfma_f32_16x16x32_bf16 a[188:191], v[92:95], v[44:47], a[188:191]
    s_waitcnt lgkmcnt(2)
    v_exp_f32 v19, v119
    v_cvt_pk_bf16_f32 v182, v16, v17
    v_add_f32 v5, v5, v18
    v_add_f32 v5, v5, v19
    v_cvt_f32_i32 v247, v247
    v_cvt_pk_bf16_f32 v183, v18, v19
    v_fma_f32 v242, v242, v48, v50
    v_mfma_f32_16x16x32_bf16 v[64:67], v[24:27], a[192:195], v[128:131]
    s_mov_b32 m0, s26
    ds_read_b128 v[40:43], v2 offset:128
    v_fma_f32 v246, v246, v49, v51
    v_mfma_f32_16x16x32_bf16 v[64:67], v[28:31], a[196:199], v[64:67]
    v_exp_f32 v16, v184
    v_mfma_f32_16x16x32_bf16 v[68:71], v[24:27], a[216:219], v[132:135]
    v_exp_f32 v17, v185
    v_mfma_f32_16x16x32_bf16 v[68:71], v[28:31], a[220:223], v[68:71]
    buffer_load_dwordx4 v8, s[4:7], s32 offen offset:0 sc1 lds
    v_mfma_f32_16x16x32_bf16 v[72:75], v[24:27], a[240:243], v[136:139]
    ds_read_b128 v[44:47], v3 offset:128
    v_fma_f32 v243, v243, v48, v50
    v_mfma_f32_16x16x32_bf16 v[72:75], v[28:31], a[244:247], v[72:75]
    v_exp_f32 v18, v186
    v_mfma_f32_16x16x32_bf16 v[76:79], v[24:27], v[200:203], v[140:143]
    v_add_f32 v6, v6, v16
    v_add_f32 v6, v6, v17
    v_mfma_f32_16x16x32_bf16 v[76:79], v[28:31], v[204:207], v[76:79]
    s_waitcnt lgkmcnt(2)
    v_exp_f32 v19, v187
    v_mfma_f32_16x16x32_bf16 v[96:99], v[32:35], a[192:195], v[128:131]
    ds_read_b128 v[24:27], v2 offset:6272
    v_fma_f32 v247, v247, v49, v51
    v_mfma_f32_16x16x32_bf16 v[96:99], v[36:39], a[196:199], v[96:99]
    ds_read_b128 v[48:51], v10 offset:0
    v_cvt_pk_bf16_f32 v184, v16, v17
    v_mfma_f32_16x16x32_bf16 v[100:103], v[32:35], a[216:219], v[132:135]
    v_exp_f32 v16, v120
    v_mfma_f32_16x16x32_bf16 v[100:103], v[36:39], a[220:223], v[100:103]
    buffer_load_dwordx4 v8, s[4:7], s32 offen offset:1024 sc1 lds
    v_mfma_f32_16x16x32_bf16 v[104:107], v[32:35], a[240:243], v[136:139]
    ds_read_b128 v[28:31], v3 offset:6272
    v_add_f32 v6, v6, v18
    v_mfma_f32_16x16x32_bf16 v[104:107], v[36:39], a[244:247], v[104:107]
    v_add_f32 v6, v6, v19
    v_cvt_pk_bf16_f32 v146, v240, v244
    v_mfma_f32_16x16x32_bf16 v[108:111], v[32:35], v[200:203], v[140:143]
    v_exp_f32 v17, v121
    v_mfma_f32_16x16x32_bf16 v[108:111], v[36:39], v[204:207], v[108:111]
    s_waitcnt lgkmcnt(3)
    v_cvt_pk_bf16_f32 v185, v18, v19
    v_cvt_pk_bf16_f32 v150, v241, v245
    v_mfma_f32_16x16x32_bf16 v[64:67], v[40:43], a[200:203], v[64:67]
    ds_read_b128 v[32:35], v2 offset:256
    v_mfma_f32_16x16x32_bf16 v[64:67], v[44:47], a[204:207], v[64:67]
    buffer_load_dwordx4 v8, s[4:7], s32 offen offset:2048 sc1 lds
    v_mfma_f32_16x16x32_bf16 v[68:71], v[40:43], a[224:227], v[68:71]
    v_exp_f32 v18, v122
    v_mfma_f32_16x16x32_bf16 v[68:71], v[44:47], a[228:231], v[68:71]
    v_add_f32 v6, v6, v16
    v_add_f32 v6, v6, v17
    v_mfma_f32_16x16x32_bf16 v[72:75], v[40:43], a[248:251], v[72:75]
    ds_read_b128 v[36:39], v3 offset:256
    v_cvt_pk_bf16_f32 v154, v242, v246
    v_mfma_f32_16x16x32_bf16 v[72:75], v[44:47], a[252:255], v[72:75]
    v_exp_f32 v19, v123
    v_mfma_f32_16x16x32_bf16 v[76:79], v[40:43], v[208:211], v[76:79]
    v_cvt_pk_bf16_f32 v186, v16, v17
    v_cvt_pk_bf16_f32 v158, v243, v247
    v_mfma_f32_16x16x32_bf16 v[76:79], v[44:47], v[212:215], v[76:79]
    s_waitcnt lgkmcnt(2)
    v_exp_f32 v16, v188
    v_mfma_f32_16x16x32_bf16 v[96:99], v[24:27], a[200:203], v[96:99]
    s_waitcnt vmcnt(24)
    ds_read_b128 v[40:43], v2 offset:6400
    v_add_f32 v6, v6, v18
    v_mfma_f32_16x16x32_bf16 v[96:99], v[28:31], a[204:207], v[96:99]
    s_add_u32 s32, s32, 24576
    v_add_f32 v6, v6, v19
    v_mfma_f32_16x16x32_bf16 v[100:103], v[24:27], a[224:227], v[100:103]
    s_add_u32 s26, s26, 36864
    v_exp_f32 v17, v189
    v_mfma_f32_16x16x32_bf16 v[100:103], v[28:31], a[228:231], v[100:103]
    v_cvt_pk_bf16_f32 v187, v18, v19
    v_mfma_f32_16x16x32_bf16 v[104:107], v[24:27], a[248:251], v[104:107]
    ds_read_b128 v[44:47], v3 offset:6400
    v_cvt_f32_i32 v248, v248
    v_mfma_f32_16x16x32_bf16 v[104:107], v[28:31], a[252:255], v[104:107]
    s_sub_u32 s57, s26, 147456
    v_exp_f32 v18, v190
    v_mfma_f32_16x16x32_bf16 v[108:111], v[24:27], v[208:211], v[108:111]
    s_add_u32 s29, s30, 49152
    v_add_f32 v7, v7, v16
    v_mfma_f32_16x16x32_bf16 v[108:111], v[28:31], v[212:215], v[108:111]
    s_waitcnt lgkmcnt(2)
    buffer_load_dwordx4 v[240:243], v9, s[64:67], s33 offen offset:384 nt
    v_mfma_f32_16x16x32_bf16 v[64:67], v[32:35], a[208:211], v[64:67]
    s_sub_u32 s3, s29, 147456
    ds_read_b128 v[24:27], v2 offset:12288
    v_add_f32 v7, v7, v17
    v_mfma_f32_16x16x32_bf16 v[64:67], v[36:39], a[212:215], v[64:67]
    s_min_u32 s26, s26, s57
    v_exp_f32 v19, v191
    v_mfma_f32_16x16x32_bf16 v[68:71], v[32:35], a[232:235], v[68:71]
    v_cvt_pk_bf16_f32 v188, v16, v17
    v_cvt_f32_i32 v252, v252
    v_mfma_f32_16x16x32_bf16 v[68:71], v[36:39], a[236:239], v[68:71]
    buffer_load_dwordx4 v[244:247], v9, s[64:67], s33 offen offset:1920 nt
    v_mfma_f32_16x16x32_bf16 v[72:75], v[32:35], v[192:195], v[72:75]
    ds_read_b128 v[28:31], v3 offset:12288
    v_cvt_f32_i32 v249, v249
    v_mfma_f32_16x16x32_bf16 v[72:75], v[36:39], v[196:199], v[72:75]
    v_exp_f32 v16, v124
    v_mfma_f32_16x16x32_bf16 v[76:79], v[32:35], v[216:219], v[76:79]
    s_min_u32 s29, s29, s3
    v_add_f32 v7, v7, v18
    v_add_f32 v7, v7, v19
    v_mfma_f32_16x16x32_bf16 v[76:79], v[36:39], v[220:223], v[76:79]
    s_waitcnt lgkmcnt(2)
    v_exp_f32 v17, v125
    v_mfma_f32_16x16x32_bf16 v[96:99], v[40:43], a[208:211], v[96:99]
    ds_read_b128 v[32:35], v2 offset:18432
    v_cvt_f32_i32 v253, v253
    v_mfma_f32_16x16x32_bf16 v[96:99], v[44:47], a[212:215], v[96:99]
    v_cvt_pk_bf16_f32 v189, v18, v19
    v_fma_f32 v248, v248, v56, v58
    v_mfma_f32_16x16x32_bf16 v[100:103], v[40:43], a[232:235], v[100:103]
    v_exp_f32 v18, v126
    v_mfma_f32_16x16x32_bf16 v[100:103], v[44:47], a[236:239], v[100:103]
    v_add_f32 v7, v7, v16
    v_mfma_f32_16x16x32_bf16 v[104:107], v[40:43], v[192:195], v[104:107]
    s_sub_u32 s3, s29, s30
    ds_read_b128 v[36:39], v3 offset:18432
    v_add_f32 v7, v7, v17
    v_mfma_f32_16x16x32_bf16 v[104:107], v[44:47], v[196:199], v[104:107]
    s_waitcnt vmcnt(9)
    v_subrev_u32 v52, s92, v52
    v_cmp_lt_u32 vcc, 15, v52
    v_mfma_f32_16x16x32_bf16 v[108:111], v[40:43], v[216:219], v[108:111]
    v_exp_f32 v19, v127
    v_mfma_f32_16x16x32_bf16 v[108:111], v[44:47], v[220:223], v[108:111]
    s_waitcnt lgkmcnt(2)
    v_cvt_pk_bf16_f32 v190, v16, v17
    v_fma_f32 v252, v252, v57, v59
    v_mfma_f32_16x16x32_bf16 v[80:83], v[24:27], a[192:195], v[128:131]
    s_and_b32 s59, vcc_lo, 0xff
    ds_read_b128 v[40:43], v2 offset:12416
    v_add_f32 v7, v7, v18
    v_mfma_f32_16x16x32_bf16 v[80:83], v[28:31], a[196:199], v[80:83]
    s_cbranch_scc1 L_pollslow2
L_pollok2:
    v_mfma_f32_16x16x32_bf16 v[84:87], v[24:27], a[216:219], v[132:135]
    s_add_u32 s92, s92, 1
    v_add_f32 v7, v7, v19
    v_cvt_pk_bf16_f32 v191, v18, v19
    v_mfma_f32_16x16x32_bf16 v[84:87], v[28:31], a[220:223], v[84:87]
    s_mov_b32 m0, s26
    v_fma_f32 v249, v249, v56, v58
    v_fma_f32 v253, v253, v57, v59
    s_branch L_skip6
L_pad6:
    s_branch L_tb1_8
L_skip6:
    v_mfma_f32_16x16x32_bf16 v[88:91], v[24:27], a[240:243], v[136:139]
    s_mov_b32 s30, s29
    ds_read_b128 v[44:47], v3 offset:12416
    v_mfma_f32_16x16x32_bf16 v[88:91], v[28:31], a[244:247], v[88:91]
    buffer_load_dwordx4 v8, s[4:7], s32 offen offset:0 sc1 lds
    v_mfma_f32_16x16x32_bf16 v[92:95], v[24:27], v[200:203], v[140:143]
    v_exp_f32 v16, v64
    v_mfma_f32_16x16x32_bf16 v[92:95], v[28:31], v[204:207], v[92:95]
    s_waitcnt lgkmcnt(2)
    v_exp_f32 v17, v65
    v_mfma_f32_16x16x32_bf16 v[112:115], v[32:35], a[192:195], v[128:131]
    ds_read_b128 v[24:27], v2 offset:18560
    v_cvt_f32_i32 v250, v250
    v_mfma_f32_16x16x32_bf16 v[112:115], v[36:39], a[196:199], v[112:115]
    v_exp_f32 v18, v66
    v_mfma_f32_16x16x32_bf16 v[116:119], v[32:35], a[216:219], v[132:135]
    v_add_f32 v4, v4, v16
    v_add_f32 v4, v4, v17
    v_mfma_f32_16x16x32_bf16 v[116:119], v[36:39], a[220:223], v[116:119]
    buffer_load_dwordx4 v8, s[4:7], s32 offen offset:1024 sc1 lds
    v_mfma_f32_16x16x32_bf16 v[120:123], v[32:35], a[240:243], v[136:139]
    ds_read_b128 v[28:31], v3 offset:18560
    v_cvt_f32_i32 v254, v254
    v_mfma_f32_16x16x32_bf16 v[120:123], v[36:39], a[244:247], v[120:123]
    v_exp_f32 v19, v67
    v_mfma_f32_16x16x32_bf16 v[124:127], v[32:35], v[200:203], v[140:143]
    v_cvt_pk_bf16_f32 v64, v16, v17
    v_add_u32 v1, s3, v1
    v_mfma_f32_16x16x32_bf16 v[124:127], v[36:39], v[204:207], v[124:127]
    s_waitcnt lgkmcnt(2)
    v_exp_f32 v16, v96
    v_mfma_f32_16x16x32_bf16 v[80:83], v[40:43], a[200:203], v[80:83]
    ds_read_b128 v[32:35], v2 offset:12544
    v_add_f32 v4, v4, v18
    v_mfma_f32_16x16x32_bf16 v[80:83], v[44:47], a[204:207], v[80:83]
    buffer_load_dwordx4 v8, s[4:7], s32 offen offset:2048 sc1 lds
    v_mfma_f32_16x16x32_bf16 v[84:87], v[40:43], a[224:227], v[84:87]
    v_add_f32 v4, v4, v19
    v_cvt_f32_i32 v251, v251
    v_mfma_f32_16x16x32_bf16 v[84:87], v[44:47], a[228:231], v[84:87]
    v_exp_f32 v17, v97
    v_mfma_f32_16x16x32_bf16 v[88:91], v[40:43], a[248:251], v[88:91]
    s_add_u32 s32, s32, 24576
    ds_read_b128 v[36:39], v3 offset:12544
    v_cvt_pk_bf16_f32 v65, v18, v19
    v_mfma_f32_16x16x32_bf16 v[88:91], v[44:47], a[252:255], v[88:91]
    v_exp_f32 v18, v98
    v_mfma_f32_16x16x32_bf16 v[92:95], v[40:43], v[208:211], v[92:95]
    s_add_u32 s26, s26, 12288
    v_add_f32 v4, v4, v16
    v_add_f32 v4, v4, v17
    v_mfma_f32_16x16x32_bf16 v[92:95], v[44:47], v[212:215], v[92:95]
    s_waitcnt lgkmcnt(2)
    v_exp_f32 v19, v99
    v_mfma_f32_16x16x32_bf16 v[112:115], v[24:27], a[200:203], v[112:115]
    ds_read_b128 v[40:43], v2 offset:18688
    v_add_u32 v21, s3, v21
    v_mfma_f32_16x16x32_bf16 v[112:115], v[28:31], a[204:207], v[112:115]
    s_mov_b32 m0, s26
    v_cvt_pk_bf16_f32 v66, v16, v17
    v_cvt_f32_i32 v255, v255
    v_mfma_f32_16x16x32_bf16 v[116:119], v[24:27], a[224:227], v[116:119]
    v_exp_f32 v16, v68
    v_mfma_f32_16x16x32_bf16 v[116:119], v[28:31], a[228:231], v[116:119]
    v_add_f32 v4, v4, v18
    v_add_u32 v22, s3, v22
    v_mfma_f32_16x16x32_bf16 v[120:123], v[24:27], a[248:251], v[120:123]
    ds_read_b128 v[44:47], v3 offset:18688
    v_add_f32 v4, v4, v19
    v_mfma_f32_16x16x32_bf16 v[120:123], v[28:31], a[252:255], v[120:123]
    s_waitcnt lgkmcnt(2)
    buffer_load_dwordx4 v8, s[4:7], s32 offen offset:0 sc1 lds
    v_mfma_f32_16x16x32_bf16 v[124:127], v[24:27], v[208:211], v[124:127]
    s_waitcnt vmcnt(24)
    v_exp_f32 v17, v69
    v_mfma_f32_16x16x32_bf16 v[124:127], v[28:31], v[212:215], v[124:127]
    s_barrier
    v_cvt_pk_bf16_f32 v67, v18, v19
    v_mfma_f32_16x16x32_bf16 v[80:83], v[32:35], a[208:211], v[80:83]
    ds_read_b128 v[24:27], v1 offset:0
    v_fma_f32 v250, v250, v56, v58
    v_mfma_f32_16x16x32_bf16 v[80:83], v[36:39], a[212:215], v[80:83]
    v_exp_f32 v18, v70
    v_mfma_f32_16x16x32_bf16 v[84:87], v[32:35], a[232:235], v[84:87]
    v_add_f32 v5, v5, v16
    v_add_f32 v5, v5, v17
    v_mfma_f32_16x16x32_bf16 v[84:87], v[36:39], a[236:239], v[84:87]
    buffer_load_dwordx4 v8, s[4:7], s32 offen offset:1024 sc1 lds
    v_mfma_f32_16x16x32_bf16 v[88:91], v[32:35], v[192:195], v[88:91]
    ds_read_b128 v[28:31], v1 offset:12288
    v_fma_f32 v254, v254, v57, v59
    v_mfma_f32_16x16x32_bf16 v[88:91], v[36:39], v[196:199], v[88:91]
    v_exp_f32 v19, v71
    v_mfma_f32_16x16x32_bf16 v[92:95], v[32:35], v[216:219], v[92:95]
    v_cvt_pk_bf16_f32 v68, v16, v17
    v_fma_f32 v251, v251, v56, v58
    v_mfma_f32_16x16x32_bf16 v[92:95], v[36:39], v[220:223], v[92:95]
    s_waitcnt lgkmcnt(2)
    buffer_load_dwordx4 v8, s[4:7], s32 offen offset:2048 sc1 lds
    v_mfma_f32_16x16x32_bf16 v[112:115], v[40:43], a[208:211], v[112:115]
    ds_read_b128 v[32:35], v1 offset:768
    v_fma_f32 v255, v255, v57, v59
    v_mfma_f32_16x16x32_bf16 v[112:115], v[44:47], a[212:215], v[112:115]
    v_exp_f32 v16, v100
    v_add_f32 v5, v5, v18
    v_mfma_f32_16x16x32_bf16 v[116:119], v[40:43], a[232:235], v[116:119]
    v_add_f32 v5, v5, v19
    v_cvt_pk_bf16_f32 v147, v248, v252
    v_mfma_f32_16x16x32_bf16 v[116:119], v[44:47], a[236:239], v[116:119]
    v_exp_f32 v17, v101
    v_mfma_f32_16x16x32_bf16 v[120:123], v[40:43], v[192:195], v[120:123]
    ds_read_b128 v[36:39], v1 offset:13056
    v_cvt_pk_bf16_f32 v69, v18, v19
    v_mfma_f32_16x16x32_bf16 v[120:123], v[44:47], v[196:199], v[120:123]
    s_add_u32 s32, s32, 24576
    v_exp_f32 v18, v102
    v_mfma_f32_16x16x32_bf16 v[124:127], v[40:43], v[216:219], v[124:127]
    s_add_u32 s26, s26, 36864
    v_add_f32 v5, v5, v16
    v_add_f32 v5, v5, v17
    v_mfma_f32_16x16x32_bf16 v[124:127], v[44:47], v[220:223], v[124:127]
    s_waitcnt lgkmcnt(2)
    v_exp_f32 v19, v103
    v_cvt_pk_bf16_f32 v70, v16, v17
    v_add_f32 v5, v5, v18
    v_cvt_pk_bf16_f32 v151, v249, v253
    v_add_f32 v5, v5, v19
    s_sub_u32 s57, s26, 147456
    v_cvt_pk_bf16_f32 v155, v250, v254
    v_cvt_pk_bf16_f32 v71, v18, v19
    s_min_u32 s26, s26, s57
    v_cvt_pk_bf16_f32 v159, v251, v255
    v_mfma_f32_16x16x32_bf16 a[0:3], v[160:163], v[24:27], a[0:3]
    ds_read_b128 v[40:43], v1 offset:1536
    v_mfma_f32_16x16x32_bf16 a[0:3], v[176:179], v[28:31], a[0:3]
    buffer_store_dwordx4 v[144:147], v20, s[4:7], s81 offen offset:0 sc1
    v_mfma_f32_16x16x32_bf16 a[48:51], v[164:167], v[24:27], a[48:51]
    v_exp_f32 v16, v72
    v_mfma_f32_16x16x32_bf16 a[48:51], v[180:183], v[28:31], a[48:51]
    v_exp_f32 v17, v73
    v_mfma_f32_16x16x32_bf16 a[96:99], v[168:171], v[24:27], a[96:99]
    ds_read_b128 v[44:47], v1 offset:13824
    v_mfma_f32_16x16x32_bf16 a[96:99], v[184:187], v[28:31], a[96:99]
    v_exp_f32 v18, v74
    v_mfma_f32_16x16x32_bf16 a[144:147], v[172:175], v[24:27], a[144:147]
    v_add_f32 v6, v6, v16
    v_add_f32 v6, v6, v17
    v_mfma_f32_16x16x32_bf16 a[144:147], v[188:191], v[28:31], a[144:147]
    s_waitcnt lgkmcnt(2)
    v_exp_f32 v19, v75
    v_mfma_f32_16x16x32_bf16 a[4:7], v[160:163], v[32:35], a[4:7]
    ds_read_b128 v[24:27], v1 offset:2304
    v_cvt_pk_bf16_f32 v72, v16, v17
    v_mfma_f32_16x16x32_bf16 a[4:7], v[176:179], v[36:39], a[4:7]
    buffer_store_dwordx4 v[148:151], v20, s[4:7], s81 offen offset:768 sc1
    v_mfma_f32_16x16x32_bf16 a[52:55], v[164:167], v[32:35], a[52:55]
    v_exp_f32 v16, v104
    v_mfma_f32_16x16x32_bf16 a[52:55], v[180:183], v[36:39], a[52:55]
    v_add_f32 v6, v6, v18
    v_add_f32 v6, v6, v19
    v_mfma_f32_16x16x32_bf16 a[100:103], v[168:171], v[32:35], a[100:103]
    ds_read_b128 v[28:31], v1 offset:14592
    v_mfma_f32_16x16x32_bf16 a[100:103], v[184:187], v[36:39], a[100:103]
    v_exp_f32 v17, v105
    v_mfma_f32_16x16x32_bf16 a[148:151], v[172:175], v[32:35], a[148:151]
    v_cvt_pk_bf16_f32 v73, v18, v19
    v_mfma_f32_16x16x32_bf16 a[148:151], v[188:191], v[36:39], a[148:151]
    s_waitcnt lgkmcnt(2)
    v_exp_f32 v18, v106
    v_mfma_f32_16x16x32_bf16 a[8:11], v[160:163], v[40:43], a[8:11]
    ds_read_b128 v[32:35], v21 offset:0
    v_add_f32 v6, v6, v16
    v_mfma_f32_16x16x32_bf16 a[8:11], v[176:179], v[44:47], a[8:11]
    buffer_store_dwordx4 v[152:155], v20, s[4:7], s81 offen offset:1536 sc1
    v_mfma_f32_16x16x32_bf16 a[56:59], v[164:167], v[40:43], a[56:59]
    v_add_f32 v6, v6, v17
    v_mfma_f32_16x16x32_bf16 a[56:59], v[180:183], v[44:47], a[56:59]
    v_exp_f32 v19, v107
    v_mfma_f32_16x16x32_bf16 a[104:107], v[168:171], v[40:43], a[104:107]
    ds_read_b128 v[36:39], v21 offset:12288
    v_cvt_pk_bf16_f32 v74, v16, v17
    v_mfma_f32_16x16x32_bf16 a[104:107], v[184:187], v[44:47], a[104:107]
    v_exp_f32 v16, v76
    v_mfma_f32_16x16x32_bf16 a[152:155], v[172:175], v[40:43], a[152:155]
    v_add_f32 v6, v6, v18
    v_mfma_f32_16x16x32_bf16 a[152:155], v[188:191], v[44:47], a[152:155]
    s_waitcnt lgkmcnt(2)
    v_add_f32 v6, v6, v19
    v_mfma_f32_16x16x32_bf16 a[12:15], v[160:163], v[24:27], a[12:15]
    ds_read_b128 v[40:43], v21 offset:768
    v_mfma_f32_16x16x32_bf16 a[12:15], v[176:179], v[28:31], a[12:15]
    buffer_store_dwordx4 v[156:159], v20, s[4:7], s81 offen offset:2304 sc1
    v_mfma_f32_16x16x32_bf16 a[60:63], v[164:167], v[24:27], a[60:63]
    v_exp_f32 v17, v77
    v_mfma_f32_16x16x32_bf16 a[60:63], v[180:183], v[28:31], a[60:63]
    v_cvt_pk_bf16_f32 v75, v18, v19
    v_mfma_f32_16x16x32_bf16 a[108:111], v[168:171], v[24:27], a[108:111]
    ds_read_b128 v[44:47], v21 offset:13056
    v_mfma_f32_16x16x32_bf16 a[108:111], v[184:187], v[28:31], a[108:111]
    v_exp_f32 v18, v78
    v_mfma_f32_16x16x32_bf16 a[156:159], v[172:175], v[24:27], a[156:159]
    s_add_u32 s29, s28, 49152
    v_add_f32 v7, v7, v16
    v_add_f32 v7, v7, v17
    v_mfma_f32_16x16x32_bf16 a[156:159], v[188:191], v[28:31], a[156:159]
    s_waitcnt lgkmcnt(2)
    v_exp_f32 v19, v79
    v_mfma_f32_16x16x32_bf16 a[16:19], v[160:163], v[32:35], a[16:19]
    ds_read_b128 v[24:27], v21 offset:1536
    v_cvt_pk_bf16_f32 v76, v16, v17
    v_mfma_f32_16x16x32_bf16 a[16:19], v[176:179], v[36:39], a[16:19]
    s_sub_u32 s3, s29, 147456
    buffer_load_dwordx4 v[248:251], v9, s[64:67], s34 offen offset:384 nt
    v_mfma_f32_16x16x32_bf16 a[64:67], v[164:167], v[32:35], a[64:67]
    v_exp_f32 v16, v108
    v_mfma_f32_16x16x32_bf16 a[64:67], v[180:183], v[36:39], a[64:67]
    ds_read_b128 v[56:59], v10 offset:384
    s_waitcnt vmcnt(18)
    v_mfma_f32_16x16x32_bf16 a[112:115], v[168:171], v[32:35], a[112:115]
    ds_read_b128 v[28:31], v21 offset:13824
    v_add_f32 v7, v7, v18
    v_mfma_f32_16x16x32_bf16 a[112:115], v[184:187], v[36:39], a[112:115]
    buffer_load_dwordx4 v[252:255], v9, s[64:67], s34 offen offset:1920 nt
    v_mfma_f32_16x16x32_bf16 a[160:163], v[172:175], v[32:35], a[160:163]
    v_add_f32 v7, v7, v19
    v_cvt_f32_i32 v224, v224
    v_mfma_f32_16x16x32_bf16 a[160:163], v[188:191], v[36:39], a[160:163]
    s_waitcnt lgkmcnt(3)
    v_exp_f32 v17, v109
    v_mfma_f32_16x16x32_bf16 a[20:23], v[160:163], v[40:43], a[20:23]
    s_min_u32 s29, s29, s3
    ds_read_b128 v[32:35], v21 offset:2304
    v_cvt_pk_bf16_f32 v77, v18, v19
    v_mfma_f32_16x16x32_bf16 a[20:23], v[176:179], v[44:47], a[20:23]
    v_exp_f32 v18, v110
    v_mfma_f32_16x16x32_bf16 a[68:71], v[164:167], v[40:43], a[68:71]
    s_mov_b32 m0, s56
    v_add_f32 v7, v7, v16
    v_cvt_f32_i32 v225, v225
    v_mfma_f32_16x16x32_bf16 a[68:71], v[180:183], v[44:47], a[68:71]
    v_add_f32 v7, v7, v17
    v_cvt_f32_i32 v228, v228
    v_mfma_f32_16x16x32_bf16 a[116:119], v[168:171], v[40:43], a[116:119]
    ds_read_b128 v[36:39], v21 offset:14592
    v_mfma_f32_16x16x32_bf16 a[116:119], v[184:187], v[44:47], a[116:119]
    buffer_load_dwordx4 v8, s[4:7], s27 offen offset:0 sc1 lds
    v_mfma_f32_16x16x32_bf16 a[164:167], v[172:175], v[40:43], a[164:167]
    s_sub_u32 s3, s29, s28
    v_exp_f32 v19, v111
    v_mfma_f32_16x16x32_bf16 a[164:167], v[188:191], v[44:47], a[164:167]
    s_waitcnt lgkmcnt(2)
    ds_read_b128 v[60:63], v10 offset:768
    v_cvt_pk_bf16_f32 v78, v16, v17
    v_mfma_f32_16x16x32_bf16 a[24:27], v[160:163], v[24:27], a[24:27]
    ds_read_b128 v[40:43], v22 offset:0
    v_cvt_f32_i32 v229, v229
    v_mfma_f32_16x16x32_bf16 a[24:27], v[176:179], v[28:31], a[24:27]
    buffer_load_dwordx4 v8, s[4:7], s27 offen offset:1024 sc1 lds
    v_mfma_f32_16x16x32_bf16 a[72:75], v[164:167], v[24:27], a[72:75]
    v_exp_f32 v16, v80
    v_mfma_f32_16x16x32_bf16 a[72:75], v[180:183], v[28:31], a[72:75]
    v_add_f32 v7, v7, v18
    v_add_f32 v7, v7, v19
    v_mfma_f32_16x16x32_bf16 a[120:123], v[168:171], v[24:27], a[120:123]
    ds_read_b128 v[44:47], v22 offset:12288
    v_fma_f32 v224, v224, v48, v50
    v_mfma_f32_16x16x32_bf16 a[120:123], v[184:187], v[28:31], a[120:123]
    s_mov_b32 s28, s29
    buffer_load_dwordx4 v8, s[4:7], s27 offen offset:2048 sc1 lds
    v_mfma_f32_16x16x32_bf16 a[168:171], v[172:175], v[24:27], a[168:171]
    v_exp_f32 v17, v81
    v_mfma_f32_16x16x32_bf16 a[168:171], v[188:191], v[28:31], a[168:171]
    s_waitcnt lgkmcnt(3)
    v_cvt_pk_bf16_f32 v79, v18, v19
    v_fma_f32 v225, v225, v49, v51
    v_mfma_f32_16x16x32_bf16 a[28:31], v[160:163], v[32:35], a[28:31]
    s_add_u32 s27, s27, 24576
    ds_read_b128 v[24:27], v22 offset:768
    v_fma_f32 v228, v228, v48, v50
    v_mfma_f32_16x16x32_bf16 a[28:31], v[176:179], v[36:39], a[28:31]
    v_exp_f32 v18, v82
    v_mfma_f32_16x16x32_bf16 a[76:79], v[164:167], v[32:35], a[76:79]
    s_add_u32 s56, s56, 12288
    v_add_f32 v4, v4, v16
    v_add_f32 v4, v4, v17
    v_mfma_f32_16x16x32_bf16 a[76:79], v[180:183], v[36:39], a[76:79]
    v_exp_f32 v19, v83
    v_mfma_f32_16x16x32_bf16 a[124:127], v[168:171], v[32:35], a[124:127]
    s_mov_b32 m0, s56
    ds_read_b128 v[28:31], v22 offset:13056
    v_cvt_pk_bf16_f32 v80, v16, v17
    v_mfma_f32_16x16x32_bf16 a[124:127], v[184:187], v[36:39], a[124:127]
    v_exp_f32 v16, v112
    v_mfma_f32_16x16x32_bf16 a[172:175], v[172:175], v[32:35], a[172:175]
    v_add_f32 v4, v4, v18
    v_add_f32 v4, v4, v19
    v_mfma_f32_16x16x32_bf16 a[172:175], v[188:191], v[36:39], a[172:175]
    s_waitcnt lgkmcnt(2)
    buffer_load_dwordx4 v8, s[4:7], s27 offen offset:0 sc1 lds
    v_mfma_f32_16x16x32_bf16 a[32:35], v[160:163], v[40:43], a[32:35]
    ds_read_b128 v[32:35], v22 offset:1536
    v_fma_f32 v229, v229, v49, v51
    v_mfma_f32_16x16x32_bf16 a[32:35], v[176:179], v[44:47], a[32:35]
    v_exp_f32 v17, v113
    v_mfma_f32_16x16x32_bf16 a[80:83], v[164:167], v[40:43], a[80:83]
    v_cvt_pk_bf16_f32 v81, v18, v19
    v_cvt_pk_bf16_f32 v224, v224, v225
    v_mfma_f32_16x16x32_bf16 a[80:83], v[180:183], v[44:47], a[80:83]
    v_exp_f32 v18, v114
    v_mfma_f32_16x16x32_bf16 a[128:131], v[168:171], v[40:43], a[128:131]
    ds_read_b128 v[36:39], v22 offset:13824
    v_add_f32 v4, v4, v16
    v_mfma_f32_16x16x32_bf16 a[128:131], v[184:187], v[44:47], a[128:131]
    buffer_load_dwordx4 v8, s[4:7], s27 offen offset:1024 sc1 lds
    v_mfma_f32_16x16x32_bf16 a[176:179], v[172:175], v[40:43], a[176:179]
    v_add_f32 v4, v4, v17
    v_cvt_pk_bf16_f32 v228, v228, v229
    v_mfma_f32_16x16x32_bf16 a[176:179], v[188:191], v[44:47], a[176:179]
    s_waitcnt lgkmcnt(2)
    v_exp_f32 v19, v115
    v_mfma_f32_16x16x32_bf16 a[36:39], v[160:163], v[24:27], a[36:39]
    ds_read_b128 v[40:43], v22 offset:2304
    v_cvt_pk_bf16_f32 v82, v16, v17
    v_mfma_f32_16x16x32_bf16 a[36:39], v[176:179], v[28:31], a[36:39]
    buffer_load_dwordx4 v8, s[4:7], s27 offen offset:2048 sc1 lds
    v_mfma_f32_16x16x32_bf16 a[84:87], v[164:167], v[24:27], a[84:87]
    v_exp_f32 v16, v84
    v_mfma_f32_16x16x32_bf16 a[84:87], v[180:183], v[28:31], a[84:87]
    v_add_u32 v2, s3, v2
    v_add_f32 v4, v4, v18
    v_mfma_f32_16x16x32_bf16 a[132:135], v[168:171], v[24:27], a[132:135]
    ds_read_b128 v[44:47], v22 offset:14592
    v_add_u32 v3, s3, v3
    v_mfma_f32_16x16x32_bf16 a[132:135], v[184:187], v[28:31], a[132:135]
    s_waitcnt lgkmcnt(2)
    v_add_f32 v4, v4, v19
    v_cvt_f32_i32 v226, v226
    v_mfma_f32_16x16x32_bf16 a[180:183], v[172:175], v[24:27], a[180:183]
    s_waitcnt vmcnt(8)
    v_exp_f32 v17, v85
    v_mfma_f32_16x16x32_bf16 a[180:183], v[188:191], v[28:31], a[180:183]
    s_barrier
    v_cvt_pk_bf16_f32 v83, v18, v19
    v_mfma_f32_16x16x32_bf16 a[40:43], v[160:163], v[32:35], a[40:43]
    s_add_u32 s27, s27, 24576
    ds_read_b128 v[24:27], v2 offset:0
    v_cvt_f32_i32 v227, v227
    v_mfma_f32_16x16x32_bf16 a[40:43], v[176:179], v[36:39], a[40:43]
    s_add_u32 s56, s56, 36864
    v_exp_f32 v18, v86
    v_mfma_f32_16x16x32_bf16 a[88:91], v[164:167], v[32:35], a[88:91]
    s_sub_u32 s58, s56, 147456
    v_add_f32 v5, v5, v16
    v_add_f32 v5, v5, v17
    v_mfma_f32_16x16x32_bf16 a[88:91], v[180:183], v[36:39], a[88:91]
    v_exp_f32 v19, v87
    v_mfma_f32_16x16x32_bf16 a[136:139], v[168:171], v[32:35], a[136:139]
    s_min_u32 s56, s56, s58
    ds_read_b128 v[28:31], v3 offset:0
    v_cvt_pk_bf16_f32 v84, v16, v17
    v_mfma_f32_16x16x32_bf16 a[136:139], v[184:187], v[36:39], a[136:139]
    v_exp_f32 v16, v116
    v_mfma_f32_16x16x32_bf16 a[184:187], v[172:175], v[32:35], a[184:187]
    v_cvt_f32_i32 v230, v230
    v_add_f32 v5, v5, v18
    v_mfma_f32_16x16x32_bf16 a[184:187], v[188:191], v[36:39], a[184:187]
    s_waitcnt lgkmcnt(2)
    v_add_f32 v5, v5, v19
    v_cvt_f32_i32 v231, v231
    v_mfma_f32_16x16x32_bf16 a[44:47], v[160:163], v[40:43], a[44:47]
    ds_read_b128 v[32:35], v2 offset:6144
    v_fma_f32 v226, v226, v56, v58
    v_mfma_f32_16x16x32_bf16 a[44:47], v[176:179], v[44:47], a[44:47]
    v_exp_f32 v17, v117
    v_mfma_f32_16x16x32_bf16 a[92:95], v[164:167], v[40:43], a[92:95]
    v_cvt_pk_bf16_f32 v85, v18, v19
    v_fma_f32 v227, v227, v57, v59
    v_mfma_f32_16x16x32_bf16 a[92:95], v[180:183], v[44:47], a[92:95]
    v_exp_f32 v18, v118
    v_mfma_f32_16x16x32_bf16 a[140:143], v[168:171], v[40:43], a[140:143]
    ds_read_b128 v[36:39], v3 offset:6144
    v_add_f32 v5, v5, v16
    v_mfma_f32_16x16x32_bf16 a[140:143], v[184:187], v[44:47], a[140:143]
    v_add_u32 v55, 1, v55
    buffer_store_dword v55, v13, s[20:23], 0 offen sc1
    v_mfma_f32_16x16x32_bf16 a[188:191], v[172:175], v[40:43], a[188:191]
    v_add_f32 v5, v5, v17
    v_fma_f32 v230, v230, v56, v58
    v_mfma_f32_16x16x32_bf16 a[188:191], v[188:191], v[44:47], a[188:191]
    s_waitcnt lgkmcnt(2)
    v_exp_f32 v19, v119
    v_cvt_pk_bf16_f32 v86, v16, v17
    v_add_f32 v5, v5, v18
    v_fma_f32 v231, v231, v57, v59
    v_add_f32 v5, v5, v19
    v_cvt_pk_bf16_f32 v225, v226, v227
    v_cvt_pk_bf16_f32 v87, v18, v19
    v_cvt_pk_bf16_f32 v229, v230, v231
    v_mfma_f32_16x16x32_bf16 v[160:163], v[24:27], a[192:195], v[128:131]
    ds_read_b128 v[40:43], v2 offset:128
    s_add_u32 s35, s35, 196608
    v_mfma_f32_16x16x32_bf16 v[160:163], v[28:31], a[196:199], v[160:163]
    s_waitcnt vmcnt(24)
    v_exp_f32 v16, v88
    v_mfma_f32_16x16x32_bf16 v[164:167], v[24:27], a[216:219], v[132:135]
    s_sub_u32 s36, s35, 1572864
    v_exp_f32 v17, v89
    v_mfma_f32_16x16x32_bf16 v[164:167], v[28:31], a[220:223], v[164:167]
    s_min_u32 s35, s35, s36
    v_exp_f32 v18, v90
    v_mfma_f32_16x16x32_bf16 v[168:171], v[24:27], a[240:243], v[136:139]
    ds_read_b128 v[44:47], v3 offset:128
    v_cvt_f32_i32 v232, v232
    v_mfma_f32_16x16x32_bf16 v[168:171], v[28:31], a[244:247], v[168:171]
    s_add_u32 s36, s35, 3072
    v_add_f32 v6, v6, v16
    v_cvt_f32_i32 v233, v233
    v_mfma_f32_16x16x32_bf16 v[172:175], v[24:27], v[200:203], v[140:143]
    v_add_f32 v6, v6, v17
    v_mfma_f32_16x16x32_bf16 v[172:175], v[28:31], v[204:207], v[172:175]
    s_waitcnt lgkmcnt(2)
    v_exp_f32 v19, v91
    v_mfma_f32_16x16x32_bf16 v[96:99], v[32:35], a[192:195], v[128:131]
    s_add_u32 s81, s81, 196608
    ds_read_b128 v[24:27], v2 offset:6272
    v_cvt_f32_i32 v236, v236
    v_mfma_f32_16x16x32_bf16 v[96:99], v[36:39], a[196:199], v[96:99]
    v_cvt_pk_bf16_f32 v88, v16, v17
    v_mfma_f32_16x16x32_bf16 v[100:103], v[32:35], a[216:219], v[132:135]
    v_exp_f32 v16, v120
    v_mfma_f32_16x16x32_bf16 v[100:103], v[36:39], a[220:223], v[100:103]
    buffer_load_dwordx4 v[144:147], v12, s[68:71], s35 offen offset:0 nt
    v_mfma_f32_16x16x32_bf16 v[104:107], v[32:35], a[240:243], v[136:139]
    ds_read_b128 v[28:31], v3 offset:6272
    v_add_f32 v6, v6, v18
    v_mfma_f32_16x16x32_bf16 v[104:107], v[36:39], a[244:247], v[104:107]
    v_add_f32 v6, v6, v19
    v_cvt_f32_i32 v237, v237
    v_mfma_f32_16x16x32_bf16 v[108:111], v[32:35], v[200:203], v[140:143]
    v_exp_f32 v17, v121
    v_mfma_f32_16x16x32_bf16 v[108:111], v[36:39], v[204:207], v[108:111]
    s_waitcnt lgkmcnt(2)
    v_cvt_pk_bf16_f32 v89, v18, v19
    v_fma_f32 v232, v232, v48, v50
    v_mfma_f32_16x16x32_bf16 v[160:163], v[40:43], a[200:203], v[160:163]
    ds_read_b128 v[32:35], v2 offset:256
    v_fma_f32 v233, v233, v49, v51
    v_mfma_f32_16x16x32_bf16 v[160:163], v[44:47], a[204:207], v[160:163]
    buffer_load_dwordx4 v[148:151], v12, s[68:71], s35 offen offset:768 nt
    v_mfma_f32_16x16x32_bf16 v[164:167], v[40:43], a[224:227], v[164:167]
    v_exp_f32 v18, v122
    v_mfma_f32_16x16x32_bf16 v[164:167], v[44:47], a[228:231], v[164:167]
    v_add_f32 v6, v6, v16
    v_add_f32 v6, v6, v17
    v_mfma_f32_16x16x32_bf16 v[168:171], v[40:43], a[248:251], v[168:171]
    ds_read_b128 v[36:39], v3 offset:256
    v_fma_f32 v236, v236, v48, v50
    v_mfma_f32_16x16x32_bf16 v[168:171], v[44:47], a[252:255], v[168:171]
    buffer_load_dwordx4 v[152:155], v12, s[68:71], s35 offen offset:1536 nt
    v_mfma_f32_16x16x32_bf16 v[172:175], v[40:43], v[208:211], v[172:175]
    v_exp_f32 v19, v123
    v_mfma_f32_16x16x32_bf16 v[172:175], v[44:47], v[212:215], v[172:175]
    s_waitcnt lgkmcnt(2)
    v_cvt_pk_bf16_f32 v90, v16, v17
    v_fma_f32 v237, v237, v49, v51
    v_mfma_f32_16x16x32_bf16 v[96:99], v[24:27], a[200:203], v[96:99]
    ds_read_b128 v[40:43], v2 offset:6400
    v_mfma_f32_16x16x32_bf16 v[96:99], v[28:31], a[204:207], v[96:99]
    v_exp_f32 v16, v92
    v_mfma_f32_16x16x32_bf16 v[100:103], v[24:27], a[224:227], v[100:103]
    v_add_f32 v6, v6, v18
    v_add_f32 v6, v6, v19
    v_mfma_f32_16x16x32_bf16 v[100:103], v[28:31], a[228:231], v[100:103]
    buffer_load_dwordx4 v[156:159], v12, s[68:71], s35 offen offset:2304 nt
    v_mfma_f32_16x16x32_bf16 v[104:107], v[24:27], a[248:251], v[104:107]
    ds_read_b128 v[44:47], v3 offset:6400
    v_cvt_pk_bf16_f32 v232, v232, v233
    v_mfma_f32_16x16x32_bf16 v[104:107], v[28:31], a[252:255], v[104:107]
    v_exp_f32 v17, v93
    v_mfma_f32_16x16x32_bf16 v[108:111], v[24:27], v[208:211], v[108:111]
    s_add_u32 s29, s30, 49152
    v_cvt_pk_bf16_f32 v91, v18, v19
    v_cvt_pk_bf16_f32 v236, v236, v237
    v_mfma_f32_16x16x32_bf16 v[108:111], v[28:31], v[212:215], v[108:111]
    s_waitcnt lgkmcnt(2)
    v_exp_f32 v18, v94
    v_mfma_f32_16x16x32_bf16 v[160:163], v[32:35], a[208:211], v[160:163]
    s_mov_b32 m0, s26
    ds_read_b128 v[24:27], v2 offset:12288
    v_add_f32 v7, v7, v16
    v_mfma_f32_16x16x32_bf16 v[160:163], v[36:39], a[212:215], v[160:163]
    s_sub_u32 s3, s29, 147456
    buffer_load_dwordx4 v8, s[4:7], s32 offen offset:0 sc1 lds
    v_mfma_f32_16x16x32_bf16 v[164:167], v[32:35], a[232:235], v[164:167]
    v_add_f32 v7, v7, v17
    v_cvt_f32_i32 v234, v234
    v_mfma_f32_16x16x32_bf16 v[164:167], v[36:39], a[236:239], v[164:167]
    v_exp_f32 v19, v95
    v_mfma_f32_16x16x32_bf16 v[168:171], v[32:35], v[192:195], v[168:171]
    ds_read_b128 v[28:31], v3 offset:12288
    v_cvt_pk_bf16_f32 v92, v16, v17
    v_mfma_f32_16x16x32_bf16 v[168:171], v[36:39], v[196:199], v[168:171]
    buffer_load_dwordx4 v8, s[4:7], s32 offen offset:1024 sc1 lds
    v_mfma_f32_16x16x32_bf16 v[172:175], v[32:35], v[216:219], v[172:175]
    s_min_u32 s29, s29, s3
    v_exp_f32 v16, v124
    v_mfma_f32_16x16x32_bf16 v[172:175], v[36:39], v[220:223], v[172:175]
    s_waitcnt lgkmcnt(2)
    v_add_f32 v7, v7, v18
    v_add_f32 v7, v7, v19
    v_mfma_f32_16x16x32_bf16 v[96:99], v[40:43], a[208:211], v[96:99]
    ds_read_b128 v[32:35], v2 offset:18432
    v_cvt_f32_i32 v235, v235
    v_mfma_f32_16x16x32_bf16 v[96:99], v[44:47], a[212:215], v[96:99]
    buffer_load_dwordx4 v8, s[4:7], s32 offen offset:2048 sc1 lds
    v_mfma_f32_16x16x32_bf16 v[100:103], v[40:43], a[232:235], v[100:103]
    v_exp_f32 v17, v125
    v_mfma_f32_16x16x32_bf16 v[100:103], v[44:47], a[236:239], v[100:103]
    v_cvt_pk_bf16_f32 v93, v18, v19
    v_cvt_f32_i32 v238, v238
    v_mfma_f32_16x16x32_bf16 v[104:107], v[40:43], v[192:195], v[104:107]
    s_add_u32 s32, s32, 24576
    ds_read_b128 v[36:39], v3 offset:18432
    v_cvt_f32_i32 v239, v239
    v_mfma_f32_16x16x32_bf16 v[104:107], v[44:47], v[196:199], v[104:107]
    s_sub_u32 s3, s29, s30
    v_exp_f32 v18, v126
    v_mfma_f32_16x16x32_bf16 v[108:111], v[40:43], v[216:219], v[108:111]
    s_add_u32 s26, s26, 12288
    v_add_f32 v7, v7, v16
    v_add_f32 v7, v7, v17
    v_mfma_f32_16x16x32_bf16 v[108:111], v[44:47], v[220:223], v[108:111]
    s_waitcnt lgkmcnt(2)
    v_exp_f32 v19, v127
    v_mfma_f32_16x16x32_bf16 v[176:179], v[24:27], a[192:195], v[128:131]
    s_mov_b32 m0, s26
    ds_read_b128 v[40:43], v2 offset:12416
    v_cvt_pk_bf16_f32 v94, v16, v17
    v_mfma_f32_16x16x32_bf16 v[176:179], v[28:31], a[196:199], v[176:179]
    v_add_f32 v7, v7, v18
    v_add_f32 v7, v7, v19
    v_mfma_f32_16x16x32_bf16 v[180:183], v[24:27], a[216:219], v[132:135]
    s_mov_b32 s30, s29
    v_cvt_pk_bf16_f32 v95, v18, v19
    v_fma_f32 v234, v234, v56, v58
    v_mfma_f32_16x16x32_bf16 v[180:183], v[28:31], a[220:223], v[180:183]
    buffer_load_dwordx4 v8, s[4:7], s32 offen offset:0 sc1 lds
    v_mfma_f32_16x16x32_bf16 v[184:187], v[24:27], a[240:243], v[136:139]
    ds_read_b128 v[44:47], v3 offset:12416
    v_fma_f32 v235, v235, v57, v59
    v_mfma_f32_16x16x32_bf16 v[184:187], v[28:31], a[244:247], v[184:187]
    v_exp_f32 v16, v160
    v_mfma_f32_16x16x32_bf16 v[188:191], v[24:27], v[200:203], v[140:143]
    v_exp_f32 v17, v161
    v_mfma_f32_16x16x32_bf16 v[188:191], v[28:31], v[204:207], v[188:191]
    s_waitcnt lgkmcnt(2)
    buffer_load_dwordx4 v8, s[4:7], s32 offen offset:1024 sc1 lds
    v_mfma_f32_16x16x32_bf16 v[112:115], v[32:35], a[192:195], v[128:131]
    ds_read_b128 v[24:27], v2 offset:18560
    v_fma_f32 v238, v238, v56, v58
    v_mfma_f32_16x16x32_bf16 v[112:115], v[36:39], a[196:199], v[112:115]
    v_exp_f32 v18, v162
    v_mfma_f32_16x16x32_bf16 v[116:119], v[32:35], a[216:219], v[132:135]
    v_add_f32 v4, v4, v16
    v_add_f32 v4, v4, v17
    v_mfma_f32_16x16x32_bf16 v[116:119], v[36:39], a[220:223], v[116:119]
    buffer_load_dwordx4 v8, s[4:7], s32 offen offset:2048 sc1 lds
    v_mfma_f32_16x16x32_bf16 v[120:123], v[32:35], a[240:243], v[136:139]
    ds_read_b128 v[28:31], v3 offset:18560
    v_fma_f32 v239, v239, v57, v59
    v_mfma_f32_16x16x32_bf16 v[120:123], v[36:39], a[244:247], v[120:123]
    v_exp_f32 v19, v163
    v_mfma_f32_16x16x32_bf16 v[124:127], v[32:35], v[200:203], v[140:143]
    v_cvt_pk_bf16_f32 v160, v16, v17
    v_cvt_pk_bf16_f32 v233, v234, v235
    v_mfma_f32_16x16x32_bf16 v[124:127], v[36:39], v[204:207], v[124:127]
    s_waitcnt lgkmcnt(2)
    v_exp_f32 v16, v96
    v_mfma_f32_16x16x32_bf16 v[176:179], v[40:43], a[200:203], v[176:179]
    s_add_u32 s32, s32, 24576
    ds_read_b128 v[32:35], v2 offset:12544
    v_add_f32 v4, v4, v18
    v_mfma_f32_16x16x32_bf16 v[176:179], v[44:47], a[204:207], v[176:179]
    s_add_u32 s26, s26, 36864
    v_add_f32 v4, v4, v19
    v_cvt_pk_bf16_f32 v237, v238, v239
    v_mfma_f32_16x16x32_bf16 v[180:183], v[40:43], a[224:227], v[180:183]
    v_exp_f32 v17, v97
    v_mfma_f32_16x16x32_bf16 v[180:183], v[44:47], a[228:231], v[180:183]
    s_sub_u32 s57, s26, 147456
    v_cvt_pk_bf16_f32 v161, v18, v19
    v_bfe_u32 v53, v8, 4, 6
    v_mfma_f32_16x16x32_bf16 v[184:187], v[40:43], a[248:251], v[184:187]
    ds_read_b128 v[36:39], v3 offset:12544
    v_add_u32 v1, s3, v1
    v_mfma_f32_16x16x32_bf16 v[184:187], v[44:47], a[252:255], v[184:187]
    v_exp_f32 v18, v98
    v_mfma_f32_16x16x32_bf16 v[188:191], v[40:43], v[208:211], v[188:191]
    s_min_u32 s26, s26, s57
    v_lshlrev_b32 v53, 2, v53
    v_add_f32 v4, v4, v16
    v_mfma_f32_16x16x32_bf16 v[188:191], v[44:47], v[212:215], v[188:191]
    s_waitcnt lgkmcnt(2)
    buffer_load_dword v52, v53, s[20:23], 0 offen sc1
    v_mfma_f32_16x16x32_bf16 v[112:115], v[24:27], a[200:203], v[112:115]
    ds_read_b128 v[40:43], v2 offset:18688
    v_add_f32 v4, v4, v17
    v_mfma_f32_16x16x32_bf16 v[112:115], v[28:31], a[204:207], v[112:115]
    v_exp_f32 v19, v99
    v_mfma_f32_16x16x32_bf16 v[116:119], v[24:27], a[224:227], v[116:119]
    v_cvt_pk_bf16_f32 v162, v16, v17
    v_add_u32 v21, s3, v21
    v_mfma_f32_16x16x32_bf16 v[116:119], v[28:31], a[228:231], v[116:119]
    v_exp_f32 v16, v164
    v_mfma_f32_16x16x32_bf16 v[120:123], v[24:27], a[248:251], v[120:123]
    ds_read_b128 v[44:47], v3 offset:18688
    v_add_u32 v22, s3, v22
    v_mfma_f32_16x16x32_bf16 v[120:123], v[28:31], a[252:255], v[120:123]
    s_waitcnt lgkmcnt(2)
    v_add_f32 v4, v4, v18
    v_add_f32 v4, v4, v19
    s_branch L_skip7
L_pad7:
    s_branch L_tb1_7
L_skip7:
    v_mfma_f32_16x16x32_bf16 v[124:127], v[24:27], v[208:211], v[124:127]
    s_waitcnt vmcnt(40)
    v_exp_f32 v17, v165
    v_mfma_f32_16x16x32_bf16 v[124:127], v[28:31], v[212:215], v[124:127]
    s_barrier
    ds_read_b128 v[48:51], v10 offset:1152
    v_mfma_f32_16x16x32_bf16 v[176:179], v[32:35], a[208:211], v[176:179]
    s_waitcnt vmcnt(30)
    ds_read_b128 v[24:27], v1 offset:0
    v_cvt_pk_bf16_f32 v163, v18, v19
    v_mfma_f32_16x16x32_bf16 v[176:179], v[36:39], a[212:215], v[176:179]
    v_exp_f32 v18, v166
    v_mfma_f32_16x16x32_bf16 v[180:183], v[32:35], a[232:235], v[180:183]
    v_add_f32 v5, v5, v16
    v_cvt_f32_i32 v240, v240
    v_mfma_f32_16x16x32_bf16 v[180:183], v[36:39], a[236:239], v[180:183]
    v_add_f32 v5, v5, v17
    v_cvt_f32_i32 v241, v241
    v_mfma_f32_16x16x32_bf16 v[184:187], v[32:35], v[192:195], v[184:187]
    ds_read_b128 v[28:31], v1 offset:12288
    v_cvt_f32_i32 v244, v244
    v_mfma_f32_16x16x32_bf16 v[184:187], v[36:39], v[196:199], v[184:187]
    v_exp_f32 v19, v167
    v_mfma_f32_16x16x32_bf16 v[188:191], v[32:35], v[216:219], v[188:191]
    ds_read_b128 v[56:59], v23 offset:0
    v_cvt_pk_bf16_f32 v164, v16, v17
    v_mfma_f32_16x16x32_bf16 v[188:191], v[36:39], v[220:223], v[188:191]
    s_waitcnt lgkmcnt(4)
    v_exp_f32 v16, v100
    v_mfma_f32_16x16x32_bf16 v[112:115], v[40:43], a[208:211], v[112:115]
    ds_read_b128 v[32:35], v1 offset:768
    v_add_f32 v5, v5, v18
    v_mfma_f32_16x16x32_bf16 v[112:115], v[44:47], a[212:215], v[112:115]
    v_add_f32 v5, v5, v19
    v_add_u32 v10, 1792, v10
    v_mfma_f32_16x16x32_bf16 v[116:119], v[40:43], a[232:235], v[116:119]
    v_exp_f32 v17, v101
    v_mfma_f32_16x16x32_bf16 v[116:119], v[44:47], a[236:239], v[116:119]
    v_cvt_pk_bf16_f32 v165, v18, v19
    v_cvt_f32_i32 v245, v245
    v_mfma_f32_16x16x32_bf16 v[120:123], v[40:43], v[192:195], v[120:123]
    ds_read_b128 v[36:39], v1 offset:13056
    v_fma_f32 v240, v240, v60, v62
    v_mfma_f32_16x16x32_bf16 v[120:123], v[44:47], v[196:199], v[120:123]
    v_exp_f32 v18, v102
    v_mfma_f32_16x16x32_bf16 v[124:127], v[40:43], v[216:219], v[124:127]
    v_add_f32 v5, v5, v16
    v_add_f32 v5, v5, v17
    v_mfma_f32_16x16x32_bf16 v[124:127], v[44:47], v[220:223], v[124:127]
    s_waitcnt lgkmcnt(3)
    v_exp_f32 v19, v103
    v_cvt_pk_bf16_f32 v166, v16, v17
    v_add_f32 v5, v5, v18
    v_add_f32 v5, v5, v19
    v_fma_f32 v241, v241, v61, v63
    v_cvt_pk_bf16_f32 v167, v18, v19
    v_fma_f32 v244, v244, v60, v62
    v_mfma_f32_16x16x32_bf16 a[0:3], v[64:67], v[24:27], a[0:3]
    ds_read_b128 v[40:43], v1 offset:1536
    v_fma_f32 v245, v245, v61, v63
    v_mfma_f32_16x16x32_bf16 a[0:3], v[80:83], v[28:31], a[0:3]
    v_exp_f32 v16, v168
    v_mfma_f32_16x16x32_bf16 a[48:51], v[68:71], v[24:27], a[48:51]
    v_exp_f32 v17, v169
    v_mfma_f32_16x16x32_bf16 a[48:51], v[84:87], v[28:31], a[48:51]
    v_exp_f32 v18, v170
    v_mfma_f32_16x16x32_bf16 a[96:99], v[72:75], v[24:27], a[96:99]
    ds_read_b128 v[44:47], v1 offset:13824
    v_cvt_pk_bf16_f32 v226, v240, v241
    v_mfma_f32_16x16x32_bf16 a[96:99], v[88:91], v[28:31], a[96:99]
    v_add_f32 v6, v6, v16
    v_cvt_pk_bf16_f32 v230, v244, v245
    v_mfma_f32_16x16x32_bf16 a[144:147], v[76:79], v[24:27], a[144:147]
    v_add_f32 v6, v6, v17
    v_cvt_f32_i32 v242, v242
    v_mfma_f32_16x16x32_bf16 a[144:147], v[92:95], v[28:31], a[144:147]
    s_waitcnt lgkmcnt(2)
    v_exp_f32 v19, v171
    v_mfma_f32_16x16x32_bf16 a[4:7], v[64:67], v[32:35], a[4:7]
    ds_read_b128 v[24:27], v1 offset:2304
    v_cvt_pk_bf16_f32 v168, v16, v17
    v_mfma_f32_16x16x32_bf16 a[4:7], v[80:83], v[36:39], a[4:7]
    v_exp_f32 v16, v104
    v_mfma_f32_16x16x32_bf16 a[52:55], v[68:71], v[32:35], a[52:55]
    v_add_f32 v6, v6, v18
    v_cvt_f32_i32 v243, v243
    v_mfma_f32_16x16x32_bf16 a[52:55], v[84:87], v[36:39], a[52:55]
    v_add_f32 v6, v6, v19
    v_mfma_f32_16x16x32_bf16 a[100:103], v[72:75], v[32:35], a[100:103]
    ds_read_b128 v[28:31], v1 offset:14592
    v_cvt_f32_i32 v246, v246
    v_mfma_f32_16x16x32_bf16 a[100:103], v[88:91], v[36:39], a[100:103]
    v_exp_f32 v17, v105
    v_mfma_f32_16x16x32_bf16 a[148:151], v[76:79], v[32:35], a[148:151]
    v_cvt_pk_bf16_f32 v169, v18, v19
    v_mfma_f32_16x16x32_bf16 a[148:151], v[92:95], v[36:39], a[148:151]
    s_waitcnt lgkmcnt(2)
    v_exp_f32 v18, v106
    v_mfma_f32_16x16x32_bf16 a[8:11], v[64:67], v[40:43], a[8:11]
    ds_read_b128 v[32:35], v21 offset:0
    v_cvt_f32_i32 v247, v247
    v_mfma_f32_16x16x32_bf16 a[8:11], v[80:83], v[44:47], a[8:11]
    v_add_f32 v6, v6, v16
    v_add_f32 v6, v6, v17
    v_mfma_f32_16x16x32_bf16 a[56:59], v[68:71], v[40:43], a[56:59]
    v_exp_f32 v19, v107
    v_mfma_f32_16x16x32_bf16 a[56:59], v[84:87], v[44:47], a[56:59]
    v_fma_f32 v242, v242, v48, v50
    v_cvt_pk_bf16_f32 v170, v16, v17
    v_mfma_f32_16x16x32_bf16 a[104:107], v[72:75], v[40:43], a[104:107]
    ds_read_b128 v[36:39], v21 offset:12288
    v_fma_f32 v243, v243, v49, v51
    v_mfma_f32_16x16x32_bf16 a[104:107], v[88:91], v[44:47], a[104:107]
    v_exp_f32 v16, v172
    v_mfma_f32_16x16x32_bf16 a[152:155], v[76:79], v[40:43], a[152:155]
    v_add_f32 v6, v6, v18
    v_mfma_f32_16x16x32_bf16 a[152:155], v[92:95], v[44:47], a[152:155]
    s_waitcnt lgkmcnt(2)
    v_add_f32 v6, v6, v19
    v_fma_f32 v246, v246, v48, v50
    v_mfma_f32_16x16x32_bf16 a[12:15], v[64:67], v[24:27], a[12:15]
    ds_read_b128 v[40:43], v21 offset:768
    v_mfma_f32_16x16x32_bf16 a[12:15], v[80:83], v[28:31], a[12:15]
    v_exp_f32 v17, v173
    v_mfma_f32_16x16x32_bf16 a[60:63], v[68:71], v[24:27], a[60:63]
    v_cvt_pk_bf16_f32 v171, v18, v19
    v_fma_f32 v247, v247, v49, v51
    v_mfma_f32_16x16x32_bf16 a[60:63], v[84:87], v[28:31], a[60:63]
    v_exp_f32 v18, v174
    v_mfma_f32_16x16x32_bf16 a[108:111], v[72:75], v[24:27], a[108:111]
    ds_read_b128 v[44:47], v21 offset:13056
    v_add_f32 v7, v7, v16
    v_mfma_f32_16x16x32_bf16 a[108:111], v[88:91], v[28:31], a[108:111]
    v_add_f32 v7, v7, v17
    v_cvt_pk_bf16_f32 v227, v242, v243
    v_mfma_f32_16x16x32_bf16 a[156:159], v[76:79], v[24:27], a[156:159]
    s_add_u32 s29, s28, 49152
    v_exp_f32 v19, v175
    v_mfma_f32_16x16x32_bf16 a[156:159], v[92:95], v[28:31], a[156:159]
    s_waitcnt lgkmcnt(2)
    v_cvt_pk_bf16_f32 v172, v16, v17
    v_mfma_f32_16x16x32_bf16 a[16:19], v[64:67], v[32:35], a[16:19]
    ds_read_b128 v[24:27], v21 offset:1536
    v_cvt_pk_bf16_f32 v231, v246, v247
    v_mfma_f32_16x16x32_bf16 a[16:19], v[80:83], v[36:39], a[16:19]
    s_sub_u32 s3, s29, 147456
    v_exp_f32 v16, v108
    v_mfma_f32_16x16x32_bf16 a[64:67], v[68:71], v[32:35], a[64:67]
    s_waitcnt vmcnt(18)
    v_add_f32 v7, v7, v18
    v_mfma_f32_16x16x32_bf16 a[64:67], v[84:87], v[36:39], a[64:67]
    v_add_f32 v7, v7, v19
    v_mfma_f32_16x16x32_bf16 a[112:115], v[72:75], v[32:35], a[112:115]
    ds_read_b128 v[28:31], v21 offset:13824
    v_mfma_f32_16x16x32_bf16 a[112:115], v[88:91], v[36:39], a[112:115]
    v_exp_f32 v17, v109
    v_mfma_f32_16x16x32_bf16 a[160:163], v[76:79], v[32:35], a[160:163]
    v_cvt_pk_bf16_f32 v173, v18, v19
    v_cvt_f32_i32 v248, v248
    v_mfma_f32_16x16x32_bf16 a[160:163], v[92:95], v[36:39], a[160:163]
    s_waitcnt lgkmcnt(2)
    v_exp_f32 v18, v110
    v_mfma_f32_16x16x32_bf16 a[20:23], v[64:67], v[40:43], a[20:23]
    s_min_u32 s29, s29, s3
    ds_read_b128 v[32:35], v21 offset:2304
    v_add_f32 v7, v7, v16
    v_mfma_f32_16x16x32_bf16 a[20:23], v[80:83], v[44:47], a[20:23]
    v_add_f32 v7, v7, v17
    v_cvt_f32_i32 v249, v249
    v_mfma_f32_16x16x32_bf16 a[68:71], v[68:71], v[40:43], a[68:71]
    v_exp_f32 v19, v111
    v_mfma_f32_16x16x32_bf16 a[68:71], v[84:87], v[44:47], a[68:71]
    v_cvt_pk_bf16_f32 v174, v16, v17
    v_cvt_f32_i32 v252, v252
    v_mfma_f32_16x16x32_bf16 a[116:119], v[72:75], v[40:43], a[116:119]
    ds_read_b128 v[36:39], v21 offset:14592
    v_mfma_f32_16x16x32_bf16 a[116:119], v[88:91], v[44:47], a[116:119]
    s_waitcnt vmcnt(0)
    v_subrev_u32 v52, s92, v52
    v_cmp_lt_u32 vcc, 15, v52
    v_mfma_f32_16x16x32_bf16 a[164:167], v[76:79], v[40:43], a[164:167]
    s_sub_u32 s3, s29, s28
    v_exp_f32 v16, v176
    v_mfma_f32_16x16x32_bf16 a[164:167], v[92:95], v[44:47], a[164:167]
    s_waitcnt lgkmcnt(2)
    v_add_f32 v7, v7, v18
    v_add_f32 v7, v7, v19
    v_mfma_f32_16x16x32_bf16 a[24:27], v[64:67], v[24:27], a[24:27]
    s_and_b32 s59, vcc_lo, 0xff
    ds_read_b128 v[40:43], v22 offset:0
    v_cvt_f32_i32 v253, v253
    v_mfma_f32_16x16x32_bf16 a[24:27], v[80:83], v[28:31], a[24:27]
    s_cbranch_scc1 L_pollslow3
L_pollok3:
    v_mfma_f32_16x16x32_bf16 a[72:75], v[68:71], v[24:27], a[72:75]
    s_add_u32 s92, s92, 1
    v_exp_f32 v17, v177
    v_mfma_f32_16x16x32_bf16 a[72:75], v[84:87], v[28:31], a[72:75]
    s_mov_b32 m0, s56
    v_cvt_pk_bf16_f32 v175, v18, v19
    v_fma_f32 v248, v248, v60, v62
    v_mfma_f32_16x16x32_bf16 a[120:123], v[72:75], v[24:27], a[120:123]
    ds_read_b128 v[44:47], v22 offset:12288
    v_fma_f32 v249, v249, v61, v63
    v_mfma_f32_16x16x32_bf16 a[120:123], v[88:91], v[28:31], a[120:123]
    s_mov_b32 s28, s29
    buffer_load_dwordx4 v8, s[4:7], s27 offen offset:0 sc1 lds
    v_mfma_f32_16x16x32_bf16 a[168:171], v[76:79], v[24:27], a[168:171]
    v_exp_f32 v18, v178
    v_mfma_f32_16x16x32_bf16 a[168:171], v[92:95], v[28:31], a[168:171]
    s_waitcnt lgkmcnt(2)
    v_add_f32 v4, v4, v16
    v_add_f32 v4, v4, v17
    v_mfma_f32_16x16x32_bf16 a[28:31], v[64:67], v[32:35], a[28:31]
    ds_read_b128 v[24:27], v22 offset:768
    v_fma_f32 v252, v252, v60, v62
    v_mfma_f32_16x16x32_bf16 a[28:31], v[80:83], v[36:39], a[28:31]
    buffer_load_dwordx4 v8, s[4:7], s27 offen offset:1024 sc1 lds
    v_mfma_f32_16x16x32_bf16 a[76:79], v[68:71], v[32:35], a[76:79]
    v_exp_f32 v19, v179
    v_mfma_f32_16x16x32_bf16 a[76:79], v[84:87], v[36:39], a[76:79]
    v_cvt_pk_bf16_f32 v176, v16, v17
    v_fma_f32 v253, v253, v61, v63
    v_mfma_f32_16x16x32_bf16 a[124:127], v[72:75], v[32:35], a[124:127]
    ds_read_b128 v[28:31], v22 offset:13056
    v_cvt_pk_bf16_f32 v234, v248, v249
    v_mfma_f32_16x16x32_bf16 a[124:127], v[88:91], v[36:39], a[124:127]
    buffer_load_dwordx4 v8, s[4:7], s27 offen offset:2048 sc1 lds
    v_mfma_f32_16x16x32_bf16 a[172:175], v[76:79], v[32:35], a[172:175]
    s_add_u32 s27, s27, 24576
    v_exp_f32 v16, v112
    v_mfma_f32_16x16x32_bf16 a[172:175], v[92:95], v[36:39], a[172:175]
    s_waitcnt lgkmcnt(2)
    v_add_f32 v4, v4, v18
    v_add_f32 v4, v4, v19
    v_mfma_f32_16x16x32_bf16 a[32:35], v[64:67], v[40:43], a[32:35]
    s_add_u32 s56, s56, 12288
    ds_read_b128 v[32:35], v22 offset:1536
    v_add_u32 v2, s3, v2
    v_mfma_f32_16x16x32_bf16 a[32:35], v[80:83], v[44:47], a[32:35]
    s_mov_b32 m0, s56
    v_exp_f32 v17, v113
    v_mfma_f32_16x16x32_bf16 a[80:83], v[68:71], v[40:43], a[80:83]
    v_cvt_pk_bf16_f32 v177, v18, v19
    v_cvt_pk_bf16_f32 v238, v252, v253
    v_mfma_f32_16x16x32_bf16 a[80:83], v[84:87], v[44:47], a[80:83]
    v_exp_f32 v18, v114
    v_mfma_f32_16x16x32_bf16 a[128:131], v[72:75], v[40:43], a[128:131]
    ds_read_b128 v[36:39], v22 offset:13824
    v_add_f32 v4, v4, v16
    v_mfma_f32_16x16x32_bf16 a[128:131], v[88:91], v[44:47], a[128:131]
    buffer_load_dwordx4 v8, s[4:7], s27 offen offset:0 sc1 lds
    v_mfma_f32_16x16x32_bf16 a[176:179], v[76:79], v[40:43], a[176:179]
    v_add_f32 v4, v4, v17
    v_cvt_f32_i32 v250, v250
    v_mfma_f32_16x16x32_bf16 a[176:179], v[92:95], v[44:47], a[176:179]
    s_waitcnt lgkmcnt(2)
    v_exp_f32 v19, v115
    v_mfma_f32_16x16x32_bf16 a[36:39], v[64:67], v[24:27], a[36:39]
    ds_read_b128 v[40:43], v22 offset:2304
    v_cvt_pk_bf16_f32 v178, v16, v17
    v_mfma_f32_16x16x32_bf16 a[36:39], v[80:83], v[28:31], a[36:39]
    buffer_load_dwordx4 v8, s[4:7], s27 offen offset:1024 sc1 lds
    v_mfma_f32_16x16x32_bf16 a[84:87], v[68:71], v[24:27], a[84:87]
    v_exp_f32 v16, v180
    v_mfma_f32_16x16x32_bf16 a[84:87], v[84:87], v[28:31], a[84:87]
    v_add_f32 v4, v4, v18
    v_add_f32 v4, v4, v19
    v_mfma_f32_16x16x32_bf16 a[132:135], v[72:75], v[24:27], a[132:135]
    ds_read_b128 v[44:47], v22 offset:14592
    v_add_u32 v3, s3, v3
    v_mfma_f32_16x16x32_bf16 a[132:135], v[88:91], v[28:31], a[132:135]
    s_waitcnt lgkmcnt(2)
    buffer_load_dwordx4 v8, s[4:7], s27 offen offset:2048 sc1 lds
    v_mfma_f32_16x16x32_bf16 a[180:183], v[76:79], v[24:27], a[180:183]
    s_waitcnt vmcnt(30)
    v_exp_f32 v17, v181
    v_mfma_f32_16x16x32_bf16 a[180:183], v[92:95], v[28:31], a[180:183]
    s_barrier
    v_cvt_pk_bf16_f32 v179, v18, v19
    v_mfma_f32_16x16x32_bf16 a[40:43], v[64:67], v[32:35], a[40:43]
    s_add_u32 s27, s27, 24576
    ds_read_b128 v[24:27], v2 offset:0
    v_cvt_f32_i32 v251, v251
    v_mfma_f32_16x16x32_bf16 a[40:43], v[80:83], v[36:39], a[40:43]
    v_exp_f32 v18, v182
    v_add_f32 v5, v5, v16
    v_mfma_f32_16x16x32_bf16 a[88:91], v[68:71], v[32:35], a[88:91]
    s_add_u32 s56, s56, 36864
    v_add_f32 v5, v5, v17
    v_cvt_f32_i32 v254, v254
    v_mfma_f32_16x16x32_bf16 a[88:91], v[84:87], v[36:39], a[88:91]
    s_sub_u32 s58, s56, 147456
    v_exp_f32 v19, v183
    v_mfma_f32_16x16x32_bf16 a[136:139], v[72:75], v[32:35], a[136:139]
    ds_read_b128 v[28:31], v3 offset:0
    v_cvt_pk_bf16_f32 v180, v16, v17
    v_mfma_f32_16x16x32_bf16 a[136:139], v[88:91], v[36:39], a[136:139]
    buffer_load_dwordx4 v[240:243], v12, s[68:71], s36 offen offset:0 nt
    v_mfma_f32_16x16x32_bf16 a[184:187], v[76:79], v[32:35], a[184:187]
    s_min_u32 s56, s56, s58
    v_exp_f32 v16, v116
    v_mfma_f32_16x16x32_bf16 a[184:187], v[92:95], v[36:39], a[184:187]
    s_waitcnt lgkmcnt(2)
    v_add_f32 v5, v5, v18
    v_add_f32 v5, v5, v19
    v_mfma_f32_16x16x32_bf16 a[44:47], v[64:67], v[40:43], a[44:47]
    ds_read_b128 v[32:35], v2 offset:6144
    v_cvt_f32_i32 v255, v255
    v_mfma_f32_16x16x32_bf16 a[44:47], v[80:83], v[44:47], a[44:47]
    buffer_load_dwordx4 v[244:247], v12, s[68:71], s36 offen offset:768 nt
    v_mfma_f32_16x16x32_bf16 a[92:95], v[68:71], v[40:43], a[92:95]
    v_exp_f32 v17, v117
    v_mfma_f32_16x16x32_bf16 a[92:95], v[84:87], v[44:47], a[92:95]
    v_cvt_pk_bf16_f32 v181, v18, v19
    v_exp_f32 v18, v118
    v_mfma_f32_16x16x32_bf16 a[140:143], v[72:75], v[40:43], a[140:143]
    s_nop 0
    ds_read_b128 v[36:39], v3 offset:6144
    v_add_f32 v5, v5, v16
    v_mfma_f32_16x16x32_bf16 a[140:143], v[88:91], v[44:47], a[140:143]
    v_add_f32 v5, v5, v17
    v_fma_f32 v250, v250, v48, v50
    v_mfma_f32_16x16x32_bf16 a[188:191], v[76:79], v[40:43], a[188:191]
    s_waitcnt lgkmcnt(2)
    v_exp_f32 v19, v119
    v_fma_f32 v251, v251, v49, v51
    v_cvt_pk_bf16_f32 v182, v16, v17
    v_fma_f32 v254, v254, v48, v50
    v_add_f32 v5, v5, v18
    v_fma_f32 v255, v255, v49, v51
    v_add_f32 v5, v5, v19
    v_cvt_pk_bf16_f32 v235, v250, v251
    v_cvt_pk_bf16_f32 v183, v18, v19
    v_cvt_pk_bf16_f32 v239, v254, v255
    v_mfma_f32_16x16x32_bf16 a[188:191], v[92:95], v[44:47], a[188:191]
    s_branch L_join
.p2align 6
L_loop:
    v_mfma_f32_16x16x32_bf16 a[0:3], v[160:163], v[24:27], a[0:3]
    ds_read_b128 v[40:43], v1 offset:1536
    v_cvt_f32_i32 v154, v154
    v_mfma_f32_16x16x32_bf16 a[0:3], v[176:179], v[28:31], a[0:3]
    buffer_load_dwordx4 v[248:251], v12, s[68:71], s36 offen offset:1536 nt
    v_mfma_f32_16x16x32_bf16 a[48:51], v[164:167], v[24:27], a[48:51]
    v_exp_f32 v16, v72
    v_mfma_f32_16x16x32_bf16 a[48:51], v[180:183], v[28:31], a[48:51]
    v_exp_f32 v17, v73
    v_mfma_f32_16x16x32_bf16 a[96:99], v[168:171], v[24:27], a[96:99]
    ds_read_b128 v[44:47], v1 offset:13824
    v_cvt_f32_i32 v158, v158
    v_mfma_f32_16x16x32_bf16 a[96:99], v[184:187], v[28:31], a[96:99]
    v_exp_f32 v18, v74
    v_mfma_f32_16x16x32_bf16 a[144:147], v[172:175], v[24:27], a[144:147]
    v_add_f32 v6, v6, v16
    v_add_f32 v6, v6, v17
    v_mfma_f32_16x16x32_bf16 a[144:147], v[188:191], v[28:31], a[144:147]
    s_waitcnt lgkmcnt(2)
    buffer_load_dwordx4 v[252:255], v12, s[68:71], s36 offen offset:2304 nt
    v_mfma_f32_16x16x32_bf16 a[4:7], v[160:163], v[32:35], a[4:7]
    ds_read_b128 v[24:27], v1 offset:2304
    v_cvt_f32_i32 v155, v155
    v_mfma_f32_16x16x32_bf16 a[4:7], v[176:179], v[36:39], a[4:7]
    v_exp_f32 v19, v75
    v_mfma_f32_16x16x32_bf16 a[52:55], v[164:167], v[32:35], a[52:55]
    v_cvt_pk_bf16_f32 v72, v16, v17
    v_cvt_f32_i32 v159, v159
    v_mfma_f32_16x16x32_bf16 a[52:55], v[180:183], v[36:39], a[52:55]
    v_exp_f32 v16, v104
    v_mfma_f32_16x16x32_bf16 a[100:103], v[168:171], v[32:35], a[100:103]
    ds_read_b128 v[28:31], v1 offset:14592
    v_add_f32 v6, v6, v18
    v_mfma_f32_16x16x32_bf16 a[100:103], v[184:187], v[36:39], a[100:103]
    v_add_f32 v6, v6, v19
    v_fma_f32 v154, v154, v60, v62
    v_mfma_f32_16x16x32_bf16 a[148:151], v[172:175], v[32:35], a[148:151]
    v_exp_f32 v17, v105
    v_mfma_f32_16x16x32_bf16 a[148:151], v[188:191], v[36:39], a[148:151]
    s_waitcnt lgkmcnt(2)
    v_cvt_pk_bf16_f32 v73, v18, v19
    v_fma_f32 v158, v158, v61, v63
    v_mfma_f32_16x16x32_bf16 a[8:11], v[160:163], v[40:43], a[8:11]
    ds_read_b128 v[32:35], v21 offset:0
    s_add_u32 s33, s33, 196608
    v_mfma_f32_16x16x32_bf16 a[8:11], v[176:179], v[44:47], a[8:11]
    s_sub_u32 s34, s33, 1572864
    v_exp_f32 v18, v106
    v_mfma_f32_16x16x32_bf16 a[56:59], v[164:167], v[40:43], a[56:59]
    v_add_f32 v6, v6, v16
    v_add_f32 v6, v6, v17
    v_mfma_f32_16x16x32_bf16 a[56:59], v[180:183], v[44:47], a[56:59]
    s_min_u32 s33, s33, s34
    v_exp_f32 v19, v107
    v_mfma_f32_16x16x32_bf16 a[104:107], v[168:171], v[40:43], a[104:107]
    s_mov_b32 m0, s56
    ds_read_b128 v[36:39], v21 offset:12288
    v_cvt_pk_bf16_f32 v74, v16, v17
    v_mfma_f32_16x16x32_bf16 a[104:107], v[184:187], v[44:47], a[104:107]
    v_exp_f32 v16, v76
    v_mfma_f32_16x16x32_bf16 a[152:155], v[172:175], v[40:43], a[152:155]
    s_add_u32 s34, s33, 3072
    v_fma_f32 v155, v155, v60, v62
    v_fma_f32 v159, v159, v61, v63
    v_mfma_f32_16x16x32_bf16 a[152:155], v[188:191], v[44:47], a[152:155]
    s_waitcnt lgkmcnt(2)
    buffer_load_dwordx4 v8, s[4:7], s27 offen offset:0 sc1 lds
    v_mfma_f32_16x16x32_bf16 a[12:15], v[160:163], v[24:27], a[12:15]
    s_add_u32 s37, s37, 196608
    ds_read_b128 v[40:43], v21 offset:768
    v_add_f32 v6, v6, v18
    v_mfma_f32_16x16x32_bf16 a[12:15], v[176:179], v[28:31], a[12:15]
    v_add_f32 v6, v6, v19
    v_cvt_pk_bf16_f32 v144, v144, v148
    v_mfma_f32_16x16x32_bf16 a[60:63], v[164:167], v[24:27], a[60:63]
    v_exp_f32 v17, v77
    v_mfma_f32_16x16x32_bf16 a[60:63], v[180:183], v[28:31], a[60:63]
    s_add_u32 s80, s80, 196608
    v_cvt_pk_bf16_f32 v75, v18, v19
    v_mfma_f32_16x16x32_bf16 a[108:111], v[168:171], v[24:27], a[108:111]
    ds_read_b128 v[44:47], v21 offset:13056
    v_cvt_pk_bf16_f32 v148, v145, v149
    v_mfma_f32_16x16x32_bf16 a[108:111], v[184:187], v[28:31], a[108:111]
    v_exp_f32 v18, v78
    v_mfma_f32_16x16x32_bf16 a[156:159], v[172:175], v[24:27], a[156:159]
    s_add_u32 s29, s28, 49152
    v_add_f32 v7, v7, v16
    v_add_f32 v7, v7, v17
    v_mfma_f32_16x16x32_bf16 a[156:159], v[188:191], v[28:31], a[156:159]
    s_waitcnt lgkmcnt(2)
    buffer_load_dwordx4 v[224:227], v9, s[64:67], s33 offen offset:0 nt
    v_mfma_f32_16x16x32_bf16 a[16:19], v[160:163], v[32:35], a[16:19]
    ds_read_b128 v[24:27], v21 offset:1536
    v_cvt_pk_bf16_f32 v145, v152, v156
    v_mfma_f32_16x16x32_bf16 a[16:19], v[176:179], v[36:39], a[16:19]
    s_sub_u32 s3, s29, 147456
    v_exp_f32 v19, v79
    v_mfma_f32_16x16x32_bf16 a[64:67], v[164:167], v[32:35], a[64:67]
    v_cvt_pk_bf16_f32 v76, v16, v17
    v_cvt_pk_bf16_f32 v149, v153, v157
    v_mfma_f32_16x16x32_bf16 a[64:67], v[180:183], v[36:39], a[64:67]
    buffer_load_dwordx4 v8, s[4:7], s27 offen offset:1024 sc1 lds
    v_mfma_f32_16x16x32_bf16 a[112:115], v[168:171], v[32:35], a[112:115]
    ds_read_b128 v[28:31], v21 offset:13824
    v_mfma_f32_16x16x32_bf16 a[112:115], v[184:187], v[36:39], a[112:115]
    v_exp_f32 v16, v108
    v_mfma_f32_16x16x32_bf16 a[160:163], v[172:175], v[32:35], a[160:163]
    v_add_f32 v7, v7, v18
    v_add_f32 v7, v7, v19
    v_mfma_f32_16x16x32_bf16 a[160:163], v[188:191], v[36:39], a[160:163]
    s_waitcnt lgkmcnt(2)
    buffer_load_dwordx4 v[228:231], v9, s[64:67], s33 offen offset:1536 nt
    v_mfma_f32_16x16x32_bf16 a[20:23], v[160:163], v[40:43], a[20:23]
    s_min_u32 s29, s29, s3
    ds_read_b128 v[32:35], v21 offset:2304
    v_cvt_pk_bf16_f32 v152, v146, v150
    v_mfma_f32_16x16x32_bf16 a[20:23], v[176:179], v[44:47], a[20:23]
    v_exp_f32 v17, v109
    v_mfma_f32_16x16x32_bf16 a[68:71], v[164:167], v[40:43], a[68:71]
    v_cvt_pk_bf16_f32 v77, v18, v19
    v_cvt_pk_bf16_f32 v153, v154, v158
    v_mfma_f32_16x16x32_bf16 a[68:71], v[180:183], v[44:47], a[68:71]
    buffer_load_dwordx4 v[232:235], v9, s[64:67], s34 offen offset:0 nt
    v_mfma_f32_16x16x32_bf16 a[116:119], v[168:171], v[40:43], a[116:119]
    ds_read_b128 v[36:39], v21 offset:14592
    v_cvt_pk_bf16_f32 v156, v147, v151
    v_mfma_f32_16x16x32_bf16 a[116:119], v[184:187], v[44:47], a[116:119]
    v_exp_f32 v18, v110
    v_mfma_f32_16x16x32_bf16 a[164:167], v[172:175], v[40:43], a[164:167]
    s_sub_u32 s3, s29, s28
    v_add_f32 v7, v7, v16
    v_add_f32 v7, v7, v17
    v_mfma_f32_16x16x32_bf16 a[164:167], v[188:191], v[44:47], a[164:167]
    s_waitcnt lgkmcnt(2)
    buffer_load_dwordx4 v8, s[4:7], s27 offen offset:2048 sc1 lds
    v_mfma_f32_16x16x32_bf16 a[24:27], v[160:163], v[24:27], a[24:27]
    s_add_u32 s27, s27, 24576
    ds_read_b128 v[40:43], v22 offset:0
    s_add_u32 s56, s56, 12288
    v_mfma_f32_16x16x32_bf16 a[24:27], v[176:179], v[28:31], a[24:27]
    v_exp_f32 v19, v111
    v_cvt_pk_bf16_f32 v78, v16, v17
    v_mfma_f32_16x16x32_bf16 a[72:75], v[164:167], v[24:27], a[72:75]
    s_mov_b32 m0, s56
    s_nop 0
    buffer_load_dwordx4 v[236:239], v9, s[64:67], s34 offen offset:1536 nt
    v_mfma_f32_16x16x32_bf16 a[72:75], v[180:183], v[28:31], a[72:75]
    v_exp_f32 v16, v80
    v_mfma_f32_16x16x32_bf16 a[120:123], v[168:171], v[24:27], a[120:123]
    ds_read_b128 v[44:47], v22 offset:12288
    v_add_f32 v7, v7, v18
    v_mfma_f32_16x16x32_bf16 a[120:123], v[184:187], v[28:31], a[120:123]
    s_mov_b32 s28, s29
    v_add_f32 v7, v7, v19
    v_cvt_pk_bf16_f32 v157, v155, v159
    v_mfma_f32_16x16x32_bf16 a[168:171], v[172:175], v[24:27], a[168:171]
    s_waitcnt vmcnt(19)
    v_exp_f32 v17, v81
    v_mfma_f32_16x16x32_bf16 a[168:171], v[188:191], v[28:31], a[168:171]
    s_waitcnt lgkmcnt(2)
    buffer_load_dwordx4 v8, s[4:7], s27 offen offset:0 sc1 lds
    v_cvt_pk_bf16_f32 v79, v18, v19
    v_mfma_f32_16x16x32_bf16 a[28:31], v[160:163], v[32:35], a[28:31]
    ds_read_b128 v[24:27], v22 offset:768
    v_cvt_f32_i32 v240, v240
    v_mfma_f32_16x16x32_bf16 a[28:31], v[176:179], v[36:39], a[28:31]
    v_exp_f32 v18, v82
    v_mfma_f32_16x16x32_bf16 a[76:79], v[164:167], v[32:35], a[76:79]
    v_add_f32 v4, v4, v16
    v_add_f32 v4, v4, v17
    v_mfma_f32_16x16x32_bf16 a[76:79], v[180:183], v[36:39], a[76:79]
    v_exp_f32 v19, v83
    v_mfma_f32_16x16x32_bf16 a[124:127], v[168:171], v[32:35], a[124:127]
    ds_read_b128 v[28:31], v22 offset:13056
    v_cvt_pk_bf16_f32 v80, v16, v17
    v_mfma_f32_16x16x32_bf16 a[124:127], v[184:187], v[36:39], a[124:127]
    buffer_load_dwordx4 v8, s[4:7], s27 offen offset:1024 sc1 lds
    v_mfma_f32_16x16x32_bf16 a[172:175], v[172:175], v[32:35], a[172:175]
    v_exp_f32 v16, v112
    v_mfma_f32_16x16x32_bf16 a[172:175], v[188:191], v[36:39], a[172:175]
    s_waitcnt lgkmcnt(2)
    v_add_f32 v4, v4, v18
    v_add_f32 v4, v4, v19
    v_mfma_f32_16x16x32_bf16 a[32:35], v[160:163], v[40:43], a[32:35]
    ds_read_b128 v[32:35], v22 offset:1536
    v_cvt_f32_i32 v244, v244
    v_mfma_f32_16x16x32_bf16 a[32:35], v[176:179], v[44:47], a[32:35]
    v_exp_f32 v17, v113
    v_mfma_f32_16x16x32_bf16 a[80:83], v[164:167], v[40:43], a[80:83]
    v_cvt_pk_bf16_f32 v81, v18, v19
    v_cvt_f32_i32 v241, v241
    v_mfma_f32_16x16x32_bf16 a[80:83], v[180:183], v[44:47], a[80:83]
    v_exp_f32 v18, v114
    v_mfma_f32_16x16x32_bf16 a[128:131], v[168:171], v[40:43], a[128:131]
    ds_read_b128 v[36:39], v22 offset:13824
    v_add_f32 v4, v4, v16
    v_mfma_f32_16x16x32_bf16 a[128:131], v[184:187], v[44:47], a[128:131]
    buffer_load_dwordx4 v8, s[4:7], s27 offen offset:2048 sc1 lds
    v_mfma_f32_16x16x32_bf16 a[176:179], v[172:175], v[40:43], a[176:179]
    v_add_f32 v4, v4, v17
    v_add_u32 v2, s3, v2
    v_mfma_f32_16x16x32_bf16 a[176:179], v[188:191], v[44:47], a[176:179]
    s_waitcnt lgkmcnt(2)
    v_exp_f32 v19, v115
    v_mfma_f32_16x16x32_bf16 a[36:39], v[160:163], v[24:27], a[36:39]
    ds_read_b128 v[40:43], v22 offset:2304
    v_cvt_pk_bf16_f32 v82, v16, v17
    v_mfma_f32_16x16x32_bf16 a[36:39], v[176:179], v[28:31], a[36:39]
    v_exp_f32 v16, v84
    v_mfma_f32_16x16x32_bf16 a[84:87], v[164:167], v[24:27], a[84:87]
    v_add_f32 v4, v4, v18
    v_add_f32 v4, v4, v19
    v_mfma_f32_16x16x32_bf16 a[84:87], v[180:183], v[28:31], a[84:87]
    s_add_u32 s27, s27, 24576
    v_exp_f32 v17, v85
    v_mfma_f32_16x16x32_bf16 a[132:135], v[168:171], v[24:27], a[132:135]
    s_add_u32 s56, s56, 36864
    ds_read_b128 v[44:47], v22 offset:14592
    v_add_u32 v3, s3, v3
    v_mfma_f32_16x16x32_bf16 a[132:135], v[184:187], v[28:31], a[132:135]
    s_waitcnt lgkmcnt(2)
    v_cvt_pk_bf16_f32 v83, v18, v19
    v_cvt_f32_i32 v245, v245
    v_mfma_f32_16x16x32_bf16 a[180:183], v[172:175], v[24:27], a[180:183]
    s_waitcnt vmcnt(15)
    v_exp_f32 v18, v86
    v_mfma_f32_16x16x32_bf16 a[180:183], v[188:191], v[28:31], a[180:183]
    s_barrier
    v_add_f32 v5, v5, v16
    v_mfma_f32_16x16x32_bf16 a[40:43], v[160:163], v[32:35], a[40:43]
    s_sub_u32 s58, s56, 147456
    ds_read_b128 v[24:27], v2 offset:0
    v_add_f32 v5, v5, v17
    v_mfma_f32_16x16x32_bf16 a[40:43], v[176:179], v[36:39], a[40:43]
    v_fma_f32 v240, v240, v48, v50
    v_fma_f32 v244, v244, v49, v51
    v_mfma_f32_16x16x32_bf16 a[88:91], v[164:167], v[32:35], a[88:91]
    s_min_u32 s56, s56, s58
    v_exp_f32 v19, v87
    v_mfma_f32_16x16x32_bf16 a[88:91], v[180:183], v[36:39], a[88:91]
    v_cvt_pk_bf16_f32 v84, v16, v17
    v_fma_f32 v241, v241, v48, v50
    v_mfma_f32_16x16x32_bf16 a[136:139], v[168:171], v[32:35], a[136:139]
    ds_read_b128 v[28:31], v3 offset:0
    v_fma_f32 v245, v245, v49, v51
    v_mfma_f32_16x16x32_bf16 a[136:139], v[184:187], v[36:39], a[136:139]
    v_exp_f32 v16, v116
    v_mfma_f32_16x16x32_bf16 a[184:187], v[172:175], v[32:35], a[184:187]
    v_add_f32 v5, v5, v18
    v_add_f32 v5, v5, v19
    v_mfma_f32_16x16x32_bf16 a[184:187], v[188:191], v[36:39], a[184:187]
    s_waitcnt lgkmcnt(2)
    v_exp_f32 v17, v117
    v_mfma_f32_16x16x32_bf16 a[44:47], v[160:163], v[40:43], a[44:47]
    ds_read_b128 v[32:35], v2 offset:6144
    v_cvt_pk_bf16_f32 v85, v18, v19
    v_mfma_f32_16x16x32_bf16 a[44:47], v[176:179], v[44:47], a[44:47]
    v_exp_f32 v18, v118
    v_mfma_f32_16x16x32_bf16 a[92:95], v[164:167], v[40:43], a[92:95]
    v_add_u32 v55, 1, v55
    v_cvt_f32_i32 v242, v242
    v_mfma_f32_16x16x32_bf16 a[92:95], v[180:183], v[44:47], a[92:95]
    buffer_store_dword v55, v13, s[20:23], 0 offen sc1
    v_mfma_f32_16x16x32_bf16 a[140:143], v[168:171], v[40:43], a[140:143]
    ds_read_b128 v[36:39], v3 offset:6144
    v_add_f32 v5, v5, v16
    v_mfma_f32_16x16x32_bf16 a[140:143], v[184:187], v[44:47], a[140:143]
    v_add_f32 v5, v5, v17
    v_cvt_f32_i32 v246, v246
    v_mfma_f32_16x16x32_bf16 a[188:191], v[172:175], v[40:43], a[188:191]
    v_exp_f32 v19, v119
    v_mfma_f32_16x16x32_bf16 a[188:191], v[188:191], v[44:47], a[188:191]
    s_waitcnt lgkmcnt(2)
    v_cvt_pk_bf16_f32 v86, v16, v17
    v_add_f32 v5, v5, v18
    v_add_f32 v5, v5, v19
    v_cvt_f32_i32 v243, v243
    v_cvt_pk_bf16_f32 v87, v18, v19
    v_cvt_f32_i32 v247, v247
    v_mfma_f32_16x16x32_bf16 v[160:163], v[24:27], a[192:195], v[128:131]
    s_mov_b32 m0, s26
    ds_read_b128 v[40:43], v2 offset:128
    v_fma_f32 v242, v242, v48, v50
    v_mfma_f32_16x16x32_bf16 v[160:163], v[28:31], a[196:199], v[160:163]
    v_exp_f32 v16, v88
    s_branch L_skip8
L_pad8:
    s_branch L_tb1_6
L_skip8:
    v_mfma_f32_16x16x32_bf16 v[164:167], v[24:27], a[216:219], v[132:135]
    v_exp_f32 v17, v89
    v_mfma_f32_16x16x32_bf16 v[164:167], v[28:31], a[220:223], v[164:167]
    v_exp_f32 v18, v90
    v_mfma_f32_16x16x32_bf16 v[168:171], v[24:27], a[240:243], v[136:139]
    ds_read_b128 v[44:47], v3 offset:128
    v_fma_f32 v246, v246, v49, v51
    v_mfma_f32_16x16x32_bf16 v[168:171], v[28:31], a[244:247], v[168:171]
    buffer_load_dwordx4 v8, s[4:7], s32 offen offset:0 sc1 lds
    v_mfma_f32_16x16x32_bf16 v[172:175], v[24:27], v[200:203], v[140:143]
    v_add_f32 v6, v6, v16
    v_add_f32 v6, v6, v17
    v_mfma_f32_16x16x32_bf16 v[172:175], v[28:31], v[204:207], v[172:175]
    s_waitcnt lgkmcnt(2)
    v_exp_f32 v19, v91
    v_mfma_f32_16x16x32_bf16 v[96:99], v[32:35], a[192:195], v[128:131]
    ds_read_b128 v[24:27], v2 offset:6272
    v_fma_f32 v243, v243, v48, v50
    v_mfma_f32_16x16x32_bf16 v[96:99], v[36:39], a[196:199], v[96:99]
    v_cvt_pk_bf16_f32 v88, v16, v17
    v_fma_f32 v247, v247, v49, v51
    v_mfma_f32_16x16x32_bf16 v[100:103], v[32:35], a[216:219], v[132:135]
    v_exp_f32 v16, v120
    v_mfma_f32_16x16x32_bf16 v[100:103], v[36:39], a[220:223], v[100:103]
    ds_read_b128 v[48:51], v10 offset:0
    v_add_f32 v6, v6, v18
    v_mfma_f32_16x16x32_bf16 v[104:107], v[32:35], a[240:243], v[136:139]
    ds_read_b128 v[28:31], v3 offset:6272
    v_add_f32 v6, v6, v19
    v_mfma_f32_16x16x32_bf16 v[104:107], v[36:39], a[244:247], v[104:107]
    buffer_load_dwordx4 v8, s[4:7], s32 offen offset:1024 sc1 lds
    v_mfma_f32_16x16x32_bf16 v[108:111], v[32:35], v[200:203], v[140:143]
    v_exp_f32 v17, v121
    v_mfma_f32_16x16x32_bf16 v[108:111], v[36:39], v[204:207], v[108:111]
    s_waitcnt lgkmcnt(3)
    v_cvt_pk_bf16_f32 v89, v18, v19
    v_cvt_pk_bf16_f32 v146, v240, v244
    v_mfma_f32_16x16x32_bf16 v[160:163], v[40:43], a[200:203], v[160:163]
    ds_read_b128 v[32:35], v2 offset:256
    v_mfma_f32_16x16x32_bf16 v[160:163], v[44:47], a[204:207], v[160:163]
    v_exp_f32 v18, v122
    v_mfma_f32_16x16x32_bf16 v[164:167], v[40:43], a[224:227], v[164:167]
    v_add_f32 v6, v6, v16
    v_cvt_pk_bf16_f32 v150, v241, v245
    v_mfma_f32_16x16x32_bf16 v[164:167], v[44:47], a[228:231], v[164:167]
    v_add_f32 v6, v6, v17
    v_mfma_f32_16x16x32_bf16 v[168:171], v[40:43], a[248:251], v[168:171]
    ds_read_b128 v[36:39], v3 offset:256
    v_cvt_pk_bf16_f32 v154, v242, v246
    v_mfma_f32_16x16x32_bf16 v[168:171], v[44:47], a[252:255], v[168:171]
    v_exp_f32 v19, v123
    v_mfma_f32_16x16x32_bf16 v[172:175], v[40:43], v[208:211], v[172:175]
    v_cvt_pk_bf16_f32 v90, v16, v17
    v_mfma_f32_16x16x32_bf16 v[172:175], v[44:47], v[212:215], v[172:175]
    s_waitcnt lgkmcnt(2)
    buffer_load_dwordx4 v8, s[4:7], s32 offen offset:2048 sc1 lds
    v_mfma_f32_16x16x32_bf16 v[96:99], v[24:27], a[200:203], v[96:99]
    ds_read_b128 v[40:43], v2 offset:6400
    v_cvt_pk_bf16_f32 v158, v243, v247
    v_mfma_f32_16x16x32_bf16 v[96:99], v[28:31], a[204:207], v[96:99]
    v_exp_f32 v16, v92
    v_mfma_f32_16x16x32_bf16 v[100:103], v[24:27], a[224:227], v[100:103]
    v_add_f32 v6, v6, v18
    v_add_f32 v6, v6, v19
    v_mfma_f32_16x16x32_bf16 v[100:103], v[28:31], a[228:231], v[100:103]
    s_waitcnt vmcnt(14)
    v_exp_f32 v17, v93
    v_mfma_f32_16x16x32_bf16 v[104:107], v[24:27], a[248:251], v[104:107]
    ds_read_b128 v[44:47], v3 offset:6400
    v_cvt_pk_bf16_f32 v91, v18, v19
    v_mfma_f32_16x16x32_bf16 v[104:107], v[28:31], a[252:255], v[104:107]
    s_add_u32 s32, s32, 24576
    v_exp_f32 v18, v94
    v_mfma_f32_16x16x32_bf16 v[108:111], v[24:27], v[208:211], v[108:111]
    s_add_u32 s29, s30, 49152
    v_add_f32 v7, v7, v16
    v_cvt_f32_i32 v248, v248
    v_mfma_f32_16x16x32_bf16 v[108:111], v[28:31], v[212:215], v[108:111]
    s_waitcnt lgkmcnt(2)
    v_add_f32 v7, v7, v17
    v_mfma_f32_16x16x32_bf16 v[160:163], v[32:35], a[208:211], v[160:163]
    s_sub_u32 s3, s29, 147456
    ds_read_b128 v[24:27], v2 offset:12288
    v_mfma_f32_16x16x32_bf16 v[160:163], v[36:39], a[212:215], v[160:163]
    v_exp_f32 v19, v95
    v_mfma_f32_16x16x32_bf16 v[164:167], v[32:35], a[232:235], v[164:167]
    s_add_u32 s26, s26, 12288
    v_cvt_pk_bf16_f32 v92, v16, v17
    v_cvt_f32_i32 v252, v252
    v_mfma_f32_16x16x32_bf16 v[164:167], v[36:39], a[236:239], v[164:167]
    v_exp_f32 v16, v124
    v_mfma_f32_16x16x32_bf16 v[168:171], v[32:35], v[192:195], v[168:171]
    ds_read_b128 v[28:31], v3 offset:12288
    v_cvt_f32_i32 v249, v249
    v_mfma_f32_16x16x32_bf16 v[168:171], v[36:39], v[196:199], v[168:171]
    v_add_f32 v7, v7, v18
    v_add_f32 v7, v7, v19
    v_mfma_f32_16x16x32_bf16 v[172:175], v[32:35], v[216:219], v[172:175]
    s_min_u32 s29, s29, s3
    s_mov_b32 m0, s26
    v_mfma_f32_16x16x32_bf16 v[172:175], v[36:39], v[220:223], v[172:175]
    s_waitcnt lgkmcnt(2)
    v_exp_f32 v17, v125
    v_mfma_f32_16x16x32_bf16 v[96:99], v[40:43], a[208:211], v[96:99]
    ds_read_b128 v[32:35], v2 offset:18432
    v_cvt_pk_bf16_f32 v93, v18, v19
    v_mfma_f32_16x16x32_bf16 v[96:99], v[44:47], a[212:215], v[96:99]
    v_exp_f32 v18, v126
    v_mfma_f32_16x16x32_bf16 v[100:103], v[40:43], a[232:235], v[100:103]
    v_cvt_f32_i32 v253, v253
    v_mfma_f32_16x16x32_bf16 v[100:103], v[44:47], a[236:239], v[100:103]
    v_add_f32 v7, v7, v16
    v_fma_f32 v248, v248, v56, v58
    v_mfma_f32_16x16x32_bf16 v[104:107], v[40:43], v[192:195], v[104:107]
    s_sub_u32 s3, s29, s30
    ds_read_b128 v[36:39], v3 offset:18432
    v_add_f32 v7, v7, v17
    v_mfma_f32_16x16x32_bf16 v[104:107], v[44:47], v[196:199], v[104:107]
    buffer_load_dwordx4 v8, s[4:7], s32 offen offset:0 sc1 lds
    v_mfma_f32_16x16x32_bf16 v[108:111], v[40:43], v[216:219], v[108:111]
    v_exp_f32 v19, v127
    v_mfma_f32_16x16x32_bf16 v[108:111], v[44:47], v[220:223], v[108:111]
    s_waitcnt lgkmcnt(2)
    v_cvt_pk_bf16_f32 v94, v16, v17
    v_fma_f32 v252, v252, v57, v59
    v_mfma_f32_16x16x32_bf16 v[176:179], v[24:27], a[192:195], v[128:131]
    ds_read_b128 v[40:43], v2 offset:12416
    v_add_f32 v7, v7, v18
    v_mfma_f32_16x16x32_bf16 v[176:179], v[28:31], a[196:199], v[176:179]
    v_add_f32 v7, v7, v19
    v_fma_f32 v249, v249, v56, v58
    v_mfma_f32_16x16x32_bf16 v[180:183], v[24:27], a[216:219], v[132:135]
    s_mov_b32 s30, s29
    v_cvt_pk_bf16_f32 v95, v18, v19
    v_mfma_f32_16x16x32_bf16 v[180:183], v[28:31], a[220:223], v[180:183]
    v_mfma_f32_16x16x32_bf16 v[184:187], v[24:27], a[240:243], v[136:139]
    ds_read_b128 v[44:47], v3 offset:12416
    v_fma_f32 v253, v253, v57, v59
    v_mfma_f32_16x16x32_bf16 v[184:187], v[28:31], a[244:247], v[184:187]
    v_exp_f32 v16, v160
    v_mfma_f32_16x16x32_bf16 v[188:191], v[24:27], v[200:203], v[140:143]
    v_exp_f32 v17, v161
    v_mfma_f32_16x16x32_bf16 v[188:191], v[28:31], v[204:207], v[188:191]
    s_waitcnt lgkmcnt(2)
    buffer_load_dwordx4 v8, s[4:7], s32 offen offset:1024 sc1 lds
    v_mfma_f32_16x16x32_bf16 v[112:115], v[32:35], a[192:195], v[128:131]
    ds_read_b128 v[24:27], v2 offset:18560
    v_cvt_f32_i32 v250, v250
    v_mfma_f32_16x16x32_bf16 v[112:115], v[36:39], a[196:199], v[112:115]
    v_exp_f32 v18, v162
    v_mfma_f32_16x16x32_bf16 v[116:119], v[32:35], a[216:219], v[132:135]
    v_add_f32 v4, v4, v16
    v_add_f32 v4, v4, v17
    v_mfma_f32_16x16x32_bf16 v[116:119], v[36:39], a[220:223], v[116:119]
    v_exp_f32 v19, v163
    v_mfma_f32_16x16x32_bf16 v[120:123], v[32:35], a[240:243], v[136:139]
    ds_read_b128 v[28:31], v3 offset:18560
    v_cvt_pk_bf16_f32 v160, v16, v17
    v_mfma_f32_16x16x32_bf16 v[120:123], v[36:39], a[244:247], v[120:123]
    v_exp_f32 v16, v96
    v_mfma_f32_16x16x32_bf16 v[124:127], v[32:35], v[200:203], v[140:143]
    v_add_f32 v4, v4, v18
    v_add_u32 v1, s3, v1
    v_mfma_f32_16x16x32_bf16 v[124:127], v[36:39], v[204:207], v[124:127]
    s_waitcnt lgkmcnt(2)
    buffer_load_dwordx4 v8, s[4:7], s32 offen offset:2048 sc1 lds
    v_mfma_f32_16x16x32_bf16 v[176:179], v[40:43], a[200:203], v[176:179]
    ds_read_b128 v[32:35], v2 offset:12544
    v_add_f32 v4, v4, v19
    v_mfma_f32_16x16x32_bf16 v[176:179], v[44:47], a[204:207], v[176:179]
    v_exp_f32 v17, v97
    v_mfma_f32_16x16x32_bf16 v[180:183], v[40:43], a[224:227], v[180:183]
    v_cvt_pk_bf16_f32 v161, v18, v19
    v_cvt_f32_i32 v254, v254
    v_mfma_f32_16x16x32_bf16 v[180:183], v[44:47], a[228:231], v[180:183]
    v_exp_f32 v18, v98
    v_mfma_f32_16x16x32_bf16 v[184:187], v[40:43], a[248:251], v[184:187]
    ds_read_b128 v[36:39], v3 offset:12544
    v_add_f32 v4, v4, v16
    v_mfma_f32_16x16x32_bf16 v[184:187], v[44:47], a[252:255], v[184:187]
    v_add_f32 v4, v4, v17
    v_cvt_f32_i32 v251, v251
    v_mfma_f32_16x16x32_bf16 v[188:191], v[40:43], v[208:211], v[188:191]
    v_exp_f32 v19, v99
    v_mfma_f32_16x16x32_bf16 v[188:191], v[44:47], v[212:215], v[188:191]
    s_waitcnt lgkmcnt(2)
    v_add_u32 v21, s3, v21
    v_cvt_f32_i32 v255, v255
    v_mfma_f32_16x16x32_bf16 v[112:115], v[24:27], a[200:203], v[112:115]
    ds_read_b128 v[40:43], v2 offset:18688
    v_cvt_pk_bf16_f32 v162, v16, v17
    v_mfma_f32_16x16x32_bf16 v[112:115], v[28:31], a[204:207], v[112:115]
    s_add_u32 s32, s32, 24576
    v_exp_f32 v16, v164
    v_mfma_f32_16x16x32_bf16 v[116:119], v[24:27], a[224:227], v[116:119]
    s_add_u32 s26, s26, 36864
    v_add_f32 v4, v4, v18
    v_add_u32 v22, s3, v22
    v_mfma_f32_16x16x32_bf16 v[116:119], v[28:31], a[228:231], v[116:119]
    v_add_f32 v4, v4, v19
    v_fma_f32 v250, v250, v56, v58
    v_mfma_f32_16x16x32_bf16 v[120:123], v[24:27], a[248:251], v[120:123]
    ds_read_b128 v[44:47], v3 offset:18688
    v_fma_f32 v254, v254, v57, v59
    v_mfma_f32_16x16x32_bf16 v[120:123], v[28:31], a[252:255], v[120:123]
    s_waitcnt lgkmcnt(2)
    buffer_load_dwordx4 v[240:243], v9, s[64:67], s33 offen offset:384 nt
    v_mfma_f32_16x16x32_bf16 v[124:127], v[24:27], v[208:211], v[124:127]
    s_waitcnt vmcnt(32)
    v_exp_f32 v17, v165
    v_mfma_f32_16x16x32_bf16 v[124:127], v[28:31], v[212:215], v[124:127]
    s_barrier
    v_cvt_pk_bf16_f32 v163, v18, v19
    v_mfma_f32_16x16x32_bf16 v[176:179], v[32:35], a[208:211], v[176:179]
    s_sub_u32 s57, s26, 147456
    ds_read_b128 v[24:27], v1 offset:0
    v_fma_f32 v251, v251, v56, v58
    v_mfma_f32_16x16x32_bf16 v[176:179], v[36:39], a[212:215], v[176:179]
    s_min_u32 s26, s26, s57
    v_exp_f32 v18, v166
    v_mfma_f32_16x16x32_bf16 v[180:183], v[32:35], a[232:235], v[180:183]
    v_add_f32 v5, v5, v16
    v_add_f32 v5, v5, v17
    v_mfma_f32_16x16x32_bf16 v[180:183], v[36:39], a[236:239], v[180:183]
    v_exp_f32 v19, v167
    v_mfma_f32_16x16x32_bf16 v[184:187], v[32:35], v[192:195], v[184:187]
    ds_read_b128 v[28:31], v1 offset:12288
    v_cvt_pk_bf16_f32 v164, v16, v17
    v_mfma_f32_16x16x32_bf16 v[184:187], v[36:39], v[196:199], v[184:187]
    buffer_load_dwordx4 v[244:247], v9, s[64:67], s33 offen offset:1920 nt
    v_mfma_f32_16x16x32_bf16 v[188:191], v[32:35], v[216:219], v[188:191]
    v_exp_f32 v16, v100
    v_mfma_f32_16x16x32_bf16 v[188:191], v[36:39], v[220:223], v[188:191]
    s_waitcnt lgkmcnt(2)
    v_add_f32 v5, v5, v18
    v_add_f32 v5, v5, v19
    v_mfma_f32_16x16x32_bf16 v[112:115], v[40:43], a[208:211], v[112:115]
    ds_read_b128 v[32:35], v1 offset:768
    v_fma_f32 v255, v255, v57, v59
    v_mfma_f32_16x16x32_bf16 v[112:115], v[44:47], a[212:215], v[112:115]
    v_exp_f32 v17, v101
    v_mfma_f32_16x16x32_bf16 v[116:119], v[40:43], a[232:235], v[116:119]
    v_cvt_pk_bf16_f32 v165, v18, v19
    v_cvt_pk_bf16_f32 v147, v248, v252
    v_mfma_f32_16x16x32_bf16 v[116:119], v[44:47], a[236:239], v[116:119]
    v_exp_f32 v18, v102
    v_mfma_f32_16x16x32_bf16 v[120:123], v[40:43], v[192:195], v[120:123]
    ds_read_b128 v[36:39], v1 offset:13056
    v_add_f32 v5, v5, v16
    v_mfma_f32_16x16x32_bf16 v[120:123], v[44:47], v[196:199], v[120:123]
    v_add_f32 v5, v5, v17
    v_cvt_pk_bf16_f32 v151, v249, v253
    v_mfma_f32_16x16x32_bf16 v[124:127], v[40:43], v[216:219], v[124:127]
    v_exp_f32 v19, v103
    v_mfma_f32_16x16x32_bf16 v[124:127], v[44:47], v[220:223], v[124:127]
    s_waitcnt lgkmcnt(2)
    v_cvt_pk_bf16_f32 v166, v16, v17
    v_add_f32 v5, v5, v18
    v_add_f32 v5, v5, v19
    v_cvt_pk_bf16_f32 v155, v250, v254
    v_cvt_pk_bf16_f32 v167, v18, v19
    v_cvt_pk_bf16_f32 v159, v251, v255
    v_mfma_f32_16x16x32_bf16 a[0:3], v[64:67], v[24:27], a[0:3]
    ds_read_b128 v[40:43], v1 offset:1536
    v_bfe_u32 v53, v8, 4, 6
    v_mfma_f32_16x16x32_bf16 a[0:3], v[80:83], v[28:31], a[0:3]
    v_exp_f32 v16, v168
    v_mfma_f32_16x16x32_bf16 a[48:51], v[68:71], v[24:27], a[48:51]
    v_exp_f32 v17, v169
    v_mfma_f32_16x16x32_bf16 a[48:51], v[84:87], v[28:31], a[48:51]
    ds_read_b128 v[56:59], v10 offset:384
    v_lshlrev_b32 v53, 2, v53
    v_mfma_f32_16x16x32_bf16 a[96:99], v[72:75], v[24:27], a[96:99]
    s_waitcnt vmcnt(15)
    ds_read_b128 v[44:47], v1 offset:13824
    v_mfma_f32_16x16x32_bf16 a[96:99], v[88:91], v[28:31], a[96:99]
    buffer_store_dwordx4 v[144:147], v20, s[4:7], s81 offen offset:0 sc1
    v_mfma_f32_16x16x32_bf16 a[144:147], v[76:79], v[24:27], a[144:147]
    v_exp_f32 v18, v170
    v_mfma_f32_16x16x32_bf16 a[144:147], v[92:95], v[28:31], a[144:147]
    s_waitcnt lgkmcnt(3)
    v_add_f32 v6, v6, v16
    v_add_f32 v6, v6, v17
    v_mfma_f32_16x16x32_bf16 a[4:7], v[64:67], v[32:35], a[4:7]
    ds_read_b128 v[24:27], v1 offset:2304
    buffer_load_dword v52, v53, s[20:23], 0 offen sc1
    v_mfma_f32_16x16x32_bf16 a[4:7], v[80:83], v[36:39], a[4:7]
    v_exp_f32 v19, v171
    v_mfma_f32_16x16x32_bf16 a[52:55], v[68:71], v[32:35], a[52:55]
    s_mov_b32 m0, s56
    v_cvt_pk_bf16_f32 v168, v16, v17
    v_cvt_f32_i32 v224, v224
    v_mfma_f32_16x16x32_bf16 a[52:55], v[84:87], v[36:39], a[52:55]
    v_exp_f32 v16, v104
    v_mfma_f32_16x16x32_bf16 a[100:103], v[72:75], v[32:35], a[100:103]
    ds_read_b128 v[28:31], v1 offset:14592
    v_add_f32 v6, v6, v18
    v_mfma_f32_16x16x32_bf16 a[100:103], v[88:91], v[36:39], a[100:103]
    v_add_f32 v6, v6, v19
    v_mfma_f32_16x16x32_bf16 a[148:151], v[76:79], v[32:35], a[148:151]
    v_exp_f32 v17, v105
    v_mfma_f32_16x16x32_bf16 a[148:151], v[92:95], v[36:39], a[148:151]
    s_waitcnt lgkmcnt(2)
    buffer_load_dwordx4 v8, s[4:7], s27 offen offset:0 sc1 lds
    v_mfma_f32_16x16x32_bf16 a[8:11], v[64:67], v[40:43], a[8:11]
    ds_read_b128 v[32:35], v21 offset:0
    v_cvt_pk_bf16_f32 v169, v18, v19
    v_mfma_f32_16x16x32_bf16 a[8:11], v[80:83], v[44:47], a[8:11]
    v_exp_f32 v18, v106
    v_mfma_f32_16x16x32_bf16 a[56:59], v[68:71], v[40:43], a[56:59]
    v_add_f32 v6, v6, v16
    v_add_f32 v6, v6, v17
    v_mfma_f32_16x16x32_bf16 a[56:59], v[84:87], v[44:47], a[56:59]
    v_exp_f32 v19, v107
    v_mfma_f32_16x16x32_bf16 a[104:107], v[72:75], v[40:43], a[104:107]
    ds_read_b128 v[36:39], v21 offset:12288
    v_cvt_f32_i32 v225, v225
    v_mfma_f32_16x16x32_bf16 a[104:107], v[88:91], v[44:47], a[104:107]
    buffer_store_dwordx4 v[148:151], v20, s[4:7], s81 offen offset:768 sc1
    v_mfma_f32_16x16x32_bf16 a[152:155], v[76:79], v[40:43], a[152:155]
    v_cvt_pk_bf16_f32 v170, v16, v17
    v_cvt_f32_i32 v228, v228
    v_mfma_f32_16x16x32_bf16 a[152:155], v[92:95], v[44:47], a[152:155]
    s_waitcnt lgkmcnt(2)
    v_exp_f32 v16, v172
    v_mfma_f32_16x16x32_bf16 a[12:15], v[64:67], v[24:27], a[12:15]
    ds_read_b128 v[40:43], v21 offset:768
    v_add_f32 v6, v6, v18
    v_mfma_f32_16x16x32_bf16 a[12:15], v[80:83], v[28:31], a[12:15]
    buffer_load_dwordx4 v8, s[4:7], s27 offen offset:1024 sc1 lds
    v_mfma_f32_16x16x32_bf16 a[60:63], v[68:71], v[24:27], a[60:63]
    ds_read_b128 v[60:63], v10 offset:768
    v_add_f32 v6, v6, v19
    v_mfma_f32_16x16x32_bf16 a[60:63], v[84:87], v[28:31], a[60:63]
    v_exp_f32 v17, v173
    v_mfma_f32_16x16x32_bf16 a[108:111], v[72:75], v[24:27], a[108:111]
    ds_read_b128 v[44:47], v21 offset:13056
    v_cvt_pk_bf16_f32 v171, v18, v19
    v_mfma_f32_16x16x32_bf16 a[108:111], v[88:91], v[28:31], a[108:111]
    v_exp_f32 v18, v174
    v_mfma_f32_16x16x32_bf16 a[156:159], v[76:79], v[24:27], a[156:159]
    s_add_u32 s29, s28, 49152
    v_add_f32 v7, v7, v16
    v_add_f32 v7, v7, v17
    v_mfma_f32_16x16x32_bf16 a[156:159], v[92:95], v[28:31], a[156:159]
    s_waitcnt lgkmcnt(3)
    v_exp_f32 v19, v175
    v_mfma_f32_16x16x32_bf16 a[16:19], v[64:67], v[32:35], a[16:19]
    ds_read_b128 v[24:27], v21 offset:1536
    v_cvt_pk_bf16_f32 v172, v16, v17
    v_mfma_f32_16x16x32_bf16 a[16:19], v[80:83], v[36:39], a[16:19]
    s_sub_u32 s3, s29, 147456
    v_exp_f32 v16, v108
    v_mfma_f32_16x16x32_bf16 a[64:67], v[68:71], v[32:35], a[64:67]
    v_cvt_f32_i32 v229, v229
    v_add_f32 v7, v7, v18
    v_mfma_f32_16x16x32_bf16 a[64:67], v[84:87], v[36:39], a[64:67]
    v_add_f32 v7, v7, v19
    v_mfma_f32_16x16x32_bf16 a[112:115], v[72:75], v[32:35], a[112:115]
    ds_read_b128 v[28:31], v21 offset:13824
    v_fma_f32 v224, v224, v48, v50
    v_mfma_f32_16x16x32_bf16 a[112:115], v[88:91], v[36:39], a[112:115]
    buffer_store_dwordx4 v[152:155], v20, s[4:7], s81 offen offset:1536 sc1
    v_mfma_f32_16x16x32_bf16 a[160:163], v[76:79], v[32:35], a[160:163]
    v_exp_f32 v17, v109
    v_mfma_f32_16x16x32_bf16 a[160:163], v[92:95], v[36:39], a[160:163]
    s_waitcnt lgkmcnt(2)
    v_cvt_pk_bf16_f32 v173, v18, v19
    v_mfma_f32_16x16x32_bf16 a[20:23], v[64:67], v[40:43], a[20:23]
    s_min_u32 s29, s29, s3
    ds_read_b128 v[32:35], v21 offset:2304
    v_mfma_f32_16x16x32_bf16 a[20:23], v[80:83], v[44:47], a[20:23]
    buffer_load_dwordx4 v8, s[4:7], s27 offen offset:2048 sc1 lds
    v_mfma_f32_16x16x32_bf16 a[68:71], v[68:71], v[40:43], a[68:71]
    v_exp_f32 v18, v110
    v_mfma_f32_16x16x32_bf16 a[68:71], v[84:87], v[44:47], a[68:71]
    s_add_u32 s27, s27, 24576
    v_add_f32 v7, v7, v16
    v_add_f32 v7, v7, v17
    v_mfma_f32_16x16x32_bf16 a[116:119], v[72:75], v[40:43], a[116:119]
    ds_read_b128 v[36:39], v21 offset:14592
    v_fma_f32 v225, v225, v49, v51
    v_mfma_f32_16x16x32_bf16 a[116:119], v[88:91], v[44:47], a[116:119]
    v_exp_f32 v19, v111
    v_mfma_f32_16x16x32_bf16 a[164:167], v[76:79], v[40:43], a[164:167]
    s_sub_u32 s3, s29, s28
    v_cvt_pk_bf16_f32 v174, v16, v17
    v_mfma_f32_16x16x32_bf16 a[164:167], v[92:95], v[44:47], a[164:167]
    s_waitcnt lgkmcnt(2)
    v_exp_f32 v16, v176
    v_mfma_f32_16x16x32_bf16 a[24:27], v[64:67], v[24:27], a[24:27]
    s_add_u32 s56, s56, 12288
    ds_read_b128 v[40:43], v22 offset:0
    v_add_f32 v7, v7, v18
    v_mfma_f32_16x16x32_bf16 a[24:27], v[80:83], v[28:31], a[24:27]
    v_add_f32 v7, v7, v19
    v_fma_f32 v228, v228, v48, v50
    v_mfma_f32_16x16x32_bf16 a[72:75], v[68:71], v[24:27], a[72:75]
    v_exp_f32 v17, v177
    v_mfma_f32_16x16x32_bf16 a[72:75], v[84:87], v[28:31], a[72:75]
    v_cvt_pk_bf16_f32 v175, v18, v19
    v_mfma_f32_16x16x32_bf16 a[120:123], v[72:75], v[24:27], a[120:123]
    ds_read_b128 v[44:47], v22 offset:12288
    v_mfma_f32_16x16x32_bf16 a[120:123], v[88:91], v[28:31], a[120:123]
    buffer_store_dwordx4 v[156:159], v20, s[4:7], s81 offen offset:2304 sc1
    v_mfma_f32_16x16x32_bf16 a[168:171], v[76:79], v[24:27], a[168:171]
    s_mov_b32 m0, s56
    v_exp_f32 v18, v178
    v_mfma_f32_16x16x32_bf16 a[168:171], v[92:95], v[28:31], a[168:171]
    s_waitcnt lgkmcnt(2)
    v_add_f32 v4, v4, v16
    v_add_f32 v4, v4, v17
    v_mfma_f32_16x16x32_bf16 a[28:31], v[64:67], v[32:35], a[28:31]
    s_mov_b32 s28, s29
    ds_read_b128 v[24:27], v22 offset:768
    v_fma_f32 v229, v229, v49, v51
    v_mfma_f32_16x16x32_bf16 a[28:31], v[80:83], v[36:39], a[28:31]
    v_exp_f32 v19, v179
    v_mfma_f32_16x16x32_bf16 a[76:79], v[68:71], v[32:35], a[76:79]
    v_cvt_pk_bf16_f32 v176, v16, v17
    v_mfma_f32_16x16x32_bf16 a[76:79], v[84:87], v[36:39], a[76:79]
    v_exp_f32 v16, v112
    v_mfma_f32_16x16x32_bf16 a[124:127], v[72:75], v[32:35], a[124:127]
    ds_read_b128 v[28:31], v22 offset:13056
    v_add_f32 v4, v4, v18
    v_mfma_f32_16x16x32_bf16 a[124:127], v[88:91], v[36:39], a[124:127]
    buffer_load_dwordx4 v8, s[4:7], s27 offen offset:0 sc1 lds
    v_mfma_f32_16x16x32_bf16 a[172:175], v[76:79], v[32:35], a[172:175]
    v_add_f32 v4, v4, v19
    v_cvt_pk_bf16_f32 v224, v224, v225
    v_mfma_f32_16x16x32_bf16 a[172:175], v[92:95], v[36:39], a[172:175]
    s_waitcnt lgkmcnt(2)
    v_exp_f32 v17, v113
    v_mfma_f32_16x16x32_bf16 a[32:35], v[64:67], v[40:43], a[32:35]
    ds_read_b128 v[32:35], v22 offset:1536
    v_cvt_pk_bf16_f32 v177, v18, v19
    v_mfma_f32_16x16x32_bf16 a[32:35], v[80:83], v[44:47], a[32:35]
    v_exp_f32 v18, v114
    v_mfma_f32_16x16x32_bf16 a[80:83], v[68:71], v[40:43], a[80:83]
    v_add_f32 v4, v4, v16
    v_add_f32 v4, v4, v17
    v_mfma_f32_16x16x32_bf16 a[80:83], v[84:87], v[44:47], a[80:83]
    v_exp_f32 v19, v115
    v_mfma_f32_16x16x32_bf16 a[128:131], v[72:75], v[40:43], a[128:131]
    ds_read_b128 v[36:39], v22 offset:13824
    v_add_u32 v2, s3, v2
    v_mfma_f32_16x16x32_bf16 a[128:131], v[88:91], v[44:47], a[128:131]
    v_cvt_pk_bf16_f32 v178, v16, v17
    v_cvt_pk_bf16_f32 v228, v228, v229
    v_mfma_f32_16x16x32_bf16 a[176:179], v[76:79], v[40:43], a[176:179]
    v_exp_f32 v16, v180
    v_mfma_f32_16x16x32_bf16 a[176:179], v[92:95], v[44:47], a[176:179]
    s_waitcnt lgkmcnt(2)
    v_add_f32 v4, v4, v18
    v_add_u32 v3, s3, v3
    v_mfma_f32_16x16x32_bf16 a[36:39], v[64:67], v[24:27], a[36:39]
    ds_read_b128 v[40:43], v22 offset:2304
    v_add_f32 v4, v4, v19
    v_mfma_f32_16x16x32_bf16 a[36:39], v[80:83], v[28:31], a[36:39]
    buffer_load_dwordx4 v8, s[4:7], s27 offen offset:1024 sc1 lds
    v_mfma_f32_16x16x32_bf16 a[84:87], v[68:71], v[24:27], a[84:87]
    v_exp_f32 v17, v181
    v_mfma_f32_16x16x32_bf16 a[84:87], v[84:87], v[28:31], a[84:87]
    v_cvt_pk_bf16_f32 v179, v18, v19
    v_cvt_f32_i32 v226, v226
    v_mfma_f32_16x16x32_bf16 a[132:135], v[72:75], v[24:27], a[132:135]
    ds_read_b128 v[44:47], v22 offset:14592
    v_cvt_f32_i32 v227, v227
    v_mfma_f32_16x16x32_bf16 a[132:135], v[88:91], v[28:31], a[132:135]
    s_waitcnt lgkmcnt(2)
    v_exp_f32 v18, v182
    v_mfma_f32_16x16x32_bf16 a[180:183], v[76:79], v[24:27], a[180:183]
    s_waitcnt vmcnt(31)
    v_add_f32 v5, v5, v16
    v_add_f32 v5, v5, v17
    v_mfma_f32_16x16x32_bf16 a[180:183], v[92:95], v[28:31], a[180:183]
    s_barrier
    v_mfma_f32_16x16x32_bf16 a[40:43], v[64:67], v[32:35], a[40:43]
    ds_read_b128 v[24:27], v2 offset:0
    v_mfma_f32_16x16x32_bf16 a[40:43], v[80:83], v[36:39], a[40:43]
    v_exp_f32 v19, v183
    v_mfma_f32_16x16x32_bf16 a[88:91], v[68:71], v[32:35], a[88:91]
    v_cvt_pk_bf16_f32 v180, v16, v17
    v_cvt_f32_i32 v230, v230
    v_mfma_f32_16x16x32_bf16 a[88:91], v[84:87], v[36:39], a[88:91]
    buffer_load_dwordx4 v8, s[4:7], s27 offen offset:2048 sc1 lds
    v_mfma_f32_16x16x32_bf16 a[136:139], v[72:75], v[32:35], a[136:139]
    ds_read_b128 v[28:31], v3 offset:0
    v_mfma_f32_16x16x32_bf16 a[136:139], v[88:91], v[36:39], a[136:139]
    v_exp_f32 v16, v116
    v_mfma_f32_16x16x32_bf16 a[184:187], v[76:79], v[32:35], a[184:187]
    v_add_f32 v5, v5, v18
    v_add_f32 v5, v5, v19
    v_mfma_f32_16x16x32_bf16 a[184:187], v[92:95], v[36:39], a[184:187]
    s_waitcnt lgkmcnt(2)
    v_exp_f32 v17, v117
    v_mfma_f32_16x16x32_bf16 a[44:47], v[64:67], v[40:43], a[44:47]
    ds_read_b128 v[32:35], v2 offset:6144
    v_cvt_pk_bf16_f32 v181, v18, v19
    v_mfma_f32_16x16x32_bf16 a[44:47], v[80:83], v[44:47], a[44:47]
    v_exp_f32 v18, v118
    v_mfma_f32_16x16x32_bf16 a[92:95], v[68:71], v[40:43], a[92:95]
    v_add_f32 v5, v5, v16
    v_add_f32 v5, v5, v17
    v_mfma_f32_16x16x32_bf16 a[92:95], v[84:87], v[44:47], a[92:95]
    v_exp_f32 v19, v119
    v_mfma_f32_16x16x32_bf16 a[140:143], v[72:75], v[40:43], a[140:143]
    ds_read_b128 v[36:39], v3 offset:6144
    v_cvt_pk_bf16_f32 v182, v16, v17
    v_mfma_f32_16x16x32_bf16 a[140:143], v[88:91], v[44:47], a[140:143]
    s_add_u32 s27, s27, 24576
    v_add_f32 v5, v5, v18
    v_cvt_f32_i32 v231, v231
    v_mfma_f32_16x16x32_bf16 a[188:191], v[76:79], v[40:43], a[188:191]
    s_add_u32 s56, s56, 36864
    v_add_f32 v5, v5, v19
    s_sub_u32 s58, s56, 147456
    v_mfma_f32_16x16x32_bf16 a[188:191], v[92:95], v[44:47], a[188:191]
    s_waitcnt lgkmcnt(2)
    v_cvt_pk_bf16_f32 v183, v18, v19
    s_min_u32 s56, s56, s58
    v_mfma_f32_16x16x32_bf16 v[64:67], v[24:27], a[192:195], v[128:131]
    ds_read_b128 v[40:43], v2 offset:128
    v_fma_f32 v226, v226, v56, v58
    v_mfma_f32_16x16x32_bf16 v[64:67], v[28:31], a[196:199], v[64:67]
    buffer_load_dwordx4 v[248:251], v9, s[64:67], s34 offen offset:384 nt
    v_mfma_f32_16x16x32_bf16 v[68:71], v[24:27], a[216:219], v[132:135]
    v_exp_f32 v16, v184
    v_mfma_f32_16x16x32_bf16 v[68:71], v[28:31], a[220:223], v[68:71]
    v_exp_f32 v17, v185
    v_mfma_f32_16x16x32_bf16 v[72:75], v[24:27], a[240:243], v[136:139]
    ds_read_b128 v[44:47], v3 offset:128
    v_fma_f32 v227, v227, v57, v59
    v_mfma_f32_16x16x32_bf16 v[72:75], v[28:31], a[244:247], v[72:75]
    v_exp_f32 v18, v186
    v_mfma_f32_16x16x32_bf16 v[76:79], v[24:27], v[200:203], v[140:143]
    v_add_f32 v6, v6, v16
    v_add_f32 v6, v6, v17
    v_mfma_f32_16x16x32_bf16 v[76:79], v[28:31], v[204:207], v[76:79]
    s_waitcnt lgkmcnt(2)
    v_exp_f32 v19, v187
    v_mfma_f32_16x16x32_bf16 v[96:99], v[32:35], a[192:195], v[128:131]
    ds_read_b128 v[24:27], v2 offset:6272
    v_cvt_pk_bf16_f32 v184, v16, v17
    v_mfma_f32_16x16x32_bf16 v[96:99], v[36:39], a[196:199], v[96:99]
    v_fma_f32 v230, v230, v56, v58
    v_mfma_f32_16x16x32_bf16 v[100:103], v[32:35], a[216:219], v[132:135]
    v_exp_f32 v16, v120
    v_mfma_f32_16x16x32_bf16 v[100:103], v[36:39], a[220:223], v[100:103]
    buffer_load_dwordx4 v[252:255], v9, s[64:67], s34 offen offset:1920 nt
    v_mfma_f32_16x16x32_bf16 v[104:107], v[32:35], a[240:243], v[136:139]
    ds_read_b128 v[28:31], v3 offset:6272
    v_add_f32 v6, v6, v18
    v_mfma_f32_16x16x32_bf16 v[104:107], v[36:39], a[244:247], v[104:107]
    v_add_f32 v6, v6, v19
    v_fma_f32 v231, v231, v57, v59
    v_mfma_f32_16x16x32_bf16 v[108:111], v[32:35], v[200:203], v[140:143]
    v_exp_f32 v17, v121
    v_mfma_f32_16x16x32_bf16 v[108:111], v[36:39], v[204:207], v[108:111]
    s_waitcnt lgkmcnt(2)
    v_cvt_pk_bf16_f32 v185, v18, v19
    v_mfma_f32_16x16x32_bf16 v[64:67], v[40:43], a[200:203], v[64:67]
    ds_read_b128 v[32:35], v2 offset:256
    v_mfma_f32_16x16x32_bf16 v[64:67], v[44:47], a[204:207], v[64:67]
    v_exp_f32 v18, v122
    v_mfma_f32_16x16x32_bf16 v[68:71], v[40:43], a[224:227], v[68:71]
    v_add_f32 v6, v6, v16
    v_add_f32 v6, v6, v17
    v_mfma_f32_16x16x32_bf16 v[68:71], v[44:47], a[228:231], v[68:71]
    v_cvt_pk_bf16_f32 v225, v226, v227
    v_mfma_f32_16x16x32_bf16 v[72:75], v[40:43], a[248:251], v[72:75]
    ds_read_b128 v[36:39], v3 offset:256
    v_mfma_f32_16x16x32_bf16 v[72:75], v[44:47], a[252:255], v[72:75]
    v_exp_f32 v19, v123
    v_mfma_f32_16x16x32_bf16 v[76:79], v[40:43], v[208:211], v[76:79]
    v_cvt_pk_bf16_f32 v186, v16, v17
    v_mfma_f32_16x16x32_bf16 v[76:79], v[44:47], v[212:215], v[76:79]
    s_waitcnt lgkmcnt(2)
    v_exp_f32 v16, v188
    v_mfma_f32_16x16x32_bf16 v[96:99], v[24:27], a[200:203], v[96:99]
    ds_read_b128 v[40:43], v2 offset:6400
    v_add_f32 v6, v6, v18
    v_mfma_f32_16x16x32_bf16 v[96:99], v[28:31], a[204:207], v[96:99]
    v_add_f32 v6, v6, v19
    v_cvt_pk_bf16_f32 v229, v230, v231
    v_mfma_f32_16x16x32_bf16 v[100:103], v[24:27], a[224:227], v[100:103]
    v_exp_f32 v17, v189
    v_mfma_f32_16x16x32_bf16 v[100:103], v[28:31], a[228:231], v[100:103]
    v_cvt_pk_bf16_f32 v187, v18, v19
    v_mfma_f32_16x16x32_bf16 v[104:107], v[24:27], a[248:251], v[104:107]
    ds_read_b128 v[44:47], v3 offset:6400
    v_mfma_f32_16x16x32_bf16 v[104:107], v[28:31], a[252:255], v[104:107]
    s_waitcnt vmcnt(11)
    v_subrev_u32 v52, s92, v52
    v_cmp_lt_u32 vcc, 15, v52
    v_mfma_f32_16x16x32_bf16 v[108:111], v[24:27], v[208:211], v[108:111]
    s_add_u32 s29, s30, 49152
    v_exp_f32 v18, v190
    v_mfma_f32_16x16x32_bf16 v[108:111], v[28:31], v[212:215], v[108:111]
    s_waitcnt lgkmcnt(2)
    v_add_f32 v7, v7, v16
    v_add_f32 v7, v7, v17
    v_mfma_f32_16x16x32_bf16 v[64:67], v[32:35], a[208:211], v[64:67]
    s_and_b32 s59, vcc_lo, 0xff
    ds_read_b128 v[24:27], v2 offset:12288
    v_mfma_f32_16x16x32_bf16 v[64:67], v[36:39], a[212:215], v[64:67]
    s_cbranch_scc1 L_pollslow4
L_pollok4:
    v_mfma_f32_16x16x32_bf16 v[68:71], v[32:35], a[232:235], v[68:71]
    s_add_u32 s92, s92, 1
    v_exp_f32 v19, v191
    v_mfma_f32_16x16x32_bf16 v[68:71], v[36:39], a[236:239], v[68:71]
    s_waitcnt vmcnt(25)
    v_cvt_pk_bf16_f32 v188, v16, v17
    s_sub_u32 s3, s29, 147456
    v_mfma_f32_16x16x32_bf16 v[72:75], v[32:35], v[192:195], v[72:75]
    s_mov_b32 m0, s26
    ds_read_b128 v[28:31], v3 offset:12288
    v_cvt_f32_i32 v232, v232
    v_mfma_f32_16x16x32_bf16 v[72:75], v[36:39], v[196:199], v[72:75]
    v_exp_f32 v16, v124
    v_mfma_f32_16x16x32_bf16 v[76:79], v[32:35], v[216:219], v[76:79]
    s_min_u32 s29, s29, s3
    v_add_f32 v7, v7, v18
    v_add_f32 v7, v7, v19
    v_mfma_f32_16x16x32_bf16 v[76:79], v[36:39], v[220:223], v[76:79]
    s_waitcnt lgkmcnt(2)
    buffer_load_dwordx4 v8, s[4:7], s32 offen offset:0 sc1 lds
    s_branch L_skip9
L_pad9:
    s_branch L_tb1_5
L_skip9:
    v_mfma_f32_16x16x32_bf16 v[96:99], v[40:43], a[208:211], v[96:99]
    ds_read_b128 v[32:35], v2 offset:18432
    v_cvt_f32_i32 v233, v233
    v_mfma_f32_16x16x32_bf16 v[96:99], v[44:47], a[212:215], v[96:99]
    v_exp_f32 v17, v125
    v_mfma_f32_16x16x32_bf16 v[100:103], v[40:43], a[232:235], v[100:103]
    v_cvt_pk_bf16_f32 v189, v18, v19
    v_mfma_f32_16x16x32_bf16 v[100:103], v[44:47], a[236:239], v[100:103]
    buffer_load_dwordx4 v8, s[4:7], s32 offen offset:1024 sc1 lds
    v_mfma_f32_16x16x32_bf16 v[104:107], v[40:43], v[192:195], v[104:107]
    s_sub_u32 s3, s29, s30
    ds_read_b128 v[36:39], v3 offset:18432
    v_mfma_f32_16x16x32_bf16 v[104:107], v[44:47], v[196:199], v[104:107]
    v_exp_f32 v18, v126
    v_mfma_f32_16x16x32_bf16 v[108:111], v[40:43], v[216:219], v[108:111]
    v_add_f32 v7, v7, v16
    v_add_f32 v7, v7, v17
    v_mfma_f32_16x16x32_bf16 v[108:111], v[44:47], v[220:223], v[108:111]
    s_waitcnt lgkmcnt(2)
    v_exp_f32 v19, v127
    v_mfma_f32_16x16x32_bf16 v[80:83], v[24:27], a[192:195], v[128:131]
    ds_read_b128 v[40:43], v2 offset:12416
    v_cvt_pk_bf16_f32 v190, v16, v17
    v_mfma_f32_16x16x32_bf16 v[80:83], v[28:31], a[196:199], v[80:83]
    buffer_load_dwordx4 v8, s[4:7], s32 offen offset:2048 sc1 lds
    v_mfma_f32_16x16x32_bf16 v[84:87], v[24:27], a[216:219], v[132:135]
    v_add_f32 v7, v7, v18
    v_add_f32 v7, v7, v19
    v_cvt_pk_bf16_f32 v191, v18, v19
    v_mfma_f32_16x16x32_bf16 v[84:87], v[28:31], a[220:223], v[84:87]
    s_mov_b32 s30, s29
    v_cvt_f32_i32 v236, v236
    v_cvt_f32_i32 v237, v237
    v_mfma_f32_16x16x32_bf16 v[88:91], v[24:27], a[240:243], v[136:139]
    s_add_u32 s32, s32, 24576
    ds_read_b128 v[44:47], v3 offset:12416
    v_mfma_f32_16x16x32_bf16 v[88:91], v[28:31], a[244:247], v[88:91]
    v_exp_f32 v16, v64
    v_mfma_f32_16x16x32_bf16 v[92:95], v[24:27], v[200:203], v[140:143]
    v_exp_f32 v17, v65
    v_mfma_f32_16x16x32_bf16 v[92:95], v[28:31], v[204:207], v[92:95]
    s_waitcnt lgkmcnt(2)
    v_exp_f32 v18, v66
    v_mfma_f32_16x16x32_bf16 v[112:115], v[32:35], a[192:195], v[128:131]
    s_add_u32 s26, s26, 12288
    ds_read_b128 v[24:27], v2 offset:18560
    v_add_f32 v4, v4, v16
    v_mfma_f32_16x16x32_bf16 v[112:115], v[36:39], a[196:199], v[112:115]
    s_mov_b32 m0, s26
    v_add_f32 v4, v4, v17
    v_fma_f32 v232, v232, v48, v50
    v_mfma_f32_16x16x32_bf16 v[116:119], v[32:35], a[216:219], v[132:135]
    v_exp_f32 v19, v67
    v_mfma_f32_16x16x32_bf16 v[116:119], v[36:39], a[220:223], v[116:119]
    v_cvt_pk_bf16_f32 v64, v16, v17
    v_add_u32 v1, s3, v1
    v_mfma_f32_16x16x32_bf16 v[120:123], v[32:35], a[240:243], v[136:139]
    ds_read_b128 v[28:31], v3 offset:18560
    v_mfma_f32_16x16x32_bf16 v[120:123], v[36:39], a[244:247], v[120:123]
    buffer_load_dwordx4 v8, s[4:7], s32 offen offset:0 sc1 lds
    v_mfma_f32_16x16x32_bf16 v[124:127], v[32:35], v[200:203], v[140:143]
    v_exp_f32 v16, v96
    v_mfma_f32_16x16x32_bf16 v[124:127], v[36:39], v[204:207], v[124:127]
    s_waitcnt lgkmcnt(2)
    v_add_f32 v4, v4, v18
    v_add_f32 v4, v4, v19
    v_mfma_f32_16x16x32_bf16 v[80:83], v[40:43], a[200:203], v[80:83]
    ds_read_b128 v[32:35], v2 offset:12544
    v_fma_f32 v233, v233, v49, v51
    v_mfma_f32_16x16x32_bf16 v[80:83], v[44:47], a[204:207], v[80:83]
    v_exp_f32 v17, v97
    v_mfma_f32_16x16x32_bf16 v[84:87], v[40:43], a[224:227], v[84:87]
    v_cvt_pk_bf16_f32 v65, v18, v19
    v_add_u32 v21, s3, v21
    v_mfma_f32_16x16x32_bf16 v[84:87], v[44:47], a[228:231], v[84:87]
    buffer_load_dwordx4 v8, s[4:7], s32 offen offset:1024 sc1 lds
    v_mfma_f32_16x16x32_bf16 v[88:91], v[40:43], a[248:251], v[88:91]
    ds_read_b128 v[36:39], v3 offset:12544
    v_fma_f32 v236, v236, v48, v50
    v_mfma_f32_16x16x32_bf16 v[88:91], v[44:47], a[252:255], v[88:91]
    v_exp_f32 v18, v98
    v_mfma_f32_16x16x32_bf16 v[92:95], v[40:43], v[208:211], v[92:95]
    v_add_f32 v4, v4, v16
    v_add_f32 v4, v4, v17
    v_mfma_f32_16x16x32_bf16 v[92:95], v[44:47], v[212:215], v[92:95]
    s_waitcnt lgkmcnt(2)
    buffer_load_dwordx4 v8, s[4:7], s32 offen offset:2048 sc1 lds
    v_mfma_f32_16x16x32_bf16 v[112:115], v[24:27], a[200:203], v[112:115]
    ds_read_b128 v[40:43], v2 offset:18688
    v_add_u32 v22, s3, v22
    v_mfma_f32_16x16x32_bf16 v[112:115], v[28:31], a[204:207], v[112:115]
    v_exp_f32 v19, v99
    v_mfma_f32_16x16x32_bf16 v[116:119], v[24:27], a[224:227], v[116:119]
    v_cvt_pk_bf16_f32 v66, v16, v17
    v_fma_f32 v237, v237, v49, v51
    v_mfma_f32_16x16x32_bf16 v[116:119], v[28:31], a[228:231], v[116:119]
    v_exp_f32 v16, v68
    v_mfma_f32_16x16x32_bf16 v[120:123], v[24:27], a[248:251], v[120:123]
    ds_read_b128 v[44:47], v3 offset:18688
    v_add_f32 v4, v4, v18
    v_mfma_f32_16x16x32_bf16 v[120:123], v[28:31], a[252:255], v[120:123]
    s_waitcnt lgkmcnt(2)
    v_add_f32 v4, v4, v19
    s_add_u32 s32, s32, 24576
    v_mfma_f32_16x16x32_bf16 v[124:127], v[24:27], v[208:211], v[124:127]
    s_waitcnt vmcnt(11)
    v_exp_f32 v17, v69
    v_mfma_f32_16x16x32_bf16 v[124:127], v[28:31], v[212:215], v[124:127]
    s_barrier
    v_cvt_pk_bf16_f32 v67, v18, v19
    v_mfma_f32_16x16x32_bf16 v[80:83], v[32:35], a[208:211], v[80:83]
    s_add_u32 s26, s26, 36864
    ds_read_b128 v[24:27], v1 offset:0
    v_add_u32 v55, 1, v55
    v_mfma_f32_16x16x32_bf16 v[80:83], v[36:39], a[212:215], v[80:83]
    s_sub_u32 s57, s26, 147456
    v_exp_f32 v18, v70
    v_mfma_f32_16x16x32_bf16 v[84:87], v[32:35], a[232:235], v[84:87]
    v_add_f32 v5, v5, v16
    v_add_f32 v5, v5, v17
    v_mfma_f32_16x16x32_bf16 v[84:87], v[36:39], a[236:239], v[84:87]
    v_exp_f32 v19, v71
    v_mfma_f32_16x16x32_bf16 v[88:91], v[32:35], v[192:195], v[88:91]
    s_min_u32 s26, s26, s57
    ds_read_b128 v[28:31], v1 offset:12288
    v_cvt_pk_bf16_f32 v68, v16, v17
    v_mfma_f32_16x16x32_bf16 v[88:91], v[36:39], v[196:199], v[88:91]
    buffer_store_dword v55, v13, s[20:23], 0 offen sc1
    v_mfma_f32_16x16x32_bf16 v[92:95], v[32:35], v[216:219], v[92:95]
    v_exp_f32 v16, v100
    v_mfma_f32_16x16x32_bf16 v[92:95], v[36:39], v[220:223], v[92:95]
    s_waitcnt lgkmcnt(2)
    v_add_f32 v5, v5, v18
    v_add_f32 v5, v5, v19
    v_mfma_f32_16x16x32_bf16 v[112:115], v[40:43], a[208:211], v[112:115]
    ds_read_b128 v[32:35], v1 offset:768
    v_cvt_pk_bf16_f32 v232, v232, v233
    v_mfma_f32_16x16x32_bf16 v[112:115], v[44:47], a[212:215], v[112:115]
    v_exp_f32 v17, v101
    v_mfma_f32_16x16x32_bf16 v[116:119], v[40:43], a[232:235], v[116:119]
    v_cvt_pk_bf16_f32 v69, v18, v19
    v_cvt_pk_bf16_f32 v236, v236, v237
    v_mfma_f32_16x16x32_bf16 v[116:119], v[44:47], a[236:239], v[116:119]
    v_exp_f32 v18, v102
    v_mfma_f32_16x16x32_bf16 v[120:123], v[40:43], v[192:195], v[120:123]
    ds_read_b128 v[36:39], v1 offset:13056
    v_add_f32 v5, v5, v16
    v_mfma_f32_16x16x32_bf16 v[120:123], v[44:47], v[196:199], v[120:123]
    v_add_f32 v5, v5, v17
    v_cvt_f32_i32 v234, v234
    v_mfma_f32_16x16x32_bf16 v[124:127], v[40:43], v[216:219], v[124:127]
    v_exp_f32 v19, v103
    v_mfma_f32_16x16x32_bf16 v[124:127], v[44:47], v[220:223], v[124:127]
    s_waitcnt lgkmcnt(2)
    v_cvt_pk_bf16_f32 v70, v16, v17
    v_add_f32 v5, v5, v18
    v_add_f32 v5, v5, v19
    v_cvt_pk_bf16_f32 v71, v18, v19
    v_mfma_f32_16x16x32_bf16 a[0:3], v[160:163], v[24:27], a[0:3]
    ds_read_b128 v[40:43], v1 offset:1536
    s_add_u32 s35, s35, 196608
    v_mfma_f32_16x16x32_bf16 a[0:3], v[176:179], v[28:31], a[0:3]
    s_mov_b32 m0, s56
    v_exp_f32 v16, v72
    v_mfma_f32_16x16x32_bf16 a[48:51], v[164:167], v[24:27], a[48:51]
    s_sub_u32 s36, s35, 1572864
    v_exp_f32 v17, v73
    v_mfma_f32_16x16x32_bf16 a[48:51], v[180:183], v[28:31], a[48:51]
    v_cvt_f32_i32 v235, v235
    v_cvt_f32_i32 v238, v238
    v_mfma_f32_16x16x32_bf16 a[96:99], v[168:171], v[24:27], a[96:99]
    ds_read_b128 v[44:47], v1 offset:13824
    v_mfma_f32_16x16x32_bf16 a[96:99], v[184:187], v[28:31], a[96:99]
    s_min_u32 s35, s35, s36
    buffer_load_dwordx4 v8, s[4:7], s27 offen offset:0 sc1 lds
    v_mfma_f32_16x16x32_bf16 a[144:147], v[172:175], v[24:27], a[144:147]
    v_exp_f32 v18, v74
    v_mfma_f32_16x16x32_bf16 a[144:147], v[188:191], v[28:31], a[144:147]
    s_waitcnt lgkmcnt(2)
    v_add_f32 v6, v6, v16
    v_add_f32 v6, v6, v17
    v_mfma_f32_16x16x32_bf16 a[4:7], v[160:163], v[32:35], a[4:7]
    s_add_u32 s36, s35, 3072
    ds_read_b128 v[24:27], v1 offset:2304
    v_cvt_f32_i32 v239, v239
    v_mfma_f32_16x16x32_bf16 a[4:7], v[176:179], v[36:39], a[4:7]
    v_exp_f32 v19, v75
    v_mfma_f32_16x16x32_bf16 a[52:55], v[164:167], v[32:35], a[52:55]
    v_cvt_pk_bf16_f32 v72, v16, v17
    v_mfma_f32_16x16x32_bf16 a[52:55], v[180:183], v[36:39], a[52:55]
    v_exp_f32 v16, v104
    v_mfma_f32_16x16x32_bf16 a[100:103], v[168:171], v[32:35], a[100:103]
    s_add_u32 s81, s81, 196608
    ds_read_b128 v[28:31], v1 offset:14592
    v_add_f32 v6, v6, v18
    v_mfma_f32_16x16x32_bf16 a[100:103], v[184:187], v[36:39], a[100:103]
    v_add_f32 v6, v6, v19
    v_fma_f32 v234, v234, v56, v58
    v_mfma_f32_16x16x32_bf16 a[148:151], v[172:175], v[32:35], a[148:151]
    v_exp_f32 v17, v105
    v_mfma_f32_16x16x32_bf16 a[148:151], v[188:191], v[36:39], a[148:151]
    s_waitcnt lgkmcnt(2)
    buffer_load_dwordx4 v8, s[4:7], s27 offen offset:1024 sc1 lds
    v_mfma_f32_16x16x32_bf16 a[8:11], v[160:163], v[40:43], a[8:11]
    ds_read_b128 v[32:35], v21 offset:0
    v_cvt_pk_bf16_f32 v73, v18, v19
    v_mfma_f32_16x16x32_bf16 a[8:11], v[176:179], v[44:47], a[8:11]
    v_exp_f32 v18, v106
    v_mfma_f32_16x16x32_bf16 a[56:59], v[164:167], v[40:43], a[56:59]
    v_add_f32 v6, v6, v16
    v_add_f32 v6, v6, v17
    v_mfma_f32_16x16x32_bf16 a[56:59], v[180:183], v[44:47], a[56:59]
    buffer_load_dwordx4 v[144:147], v12, s[68:71], s35 offen offset:0 nt
    v_mfma_f32_16x16x32_bf16 a[104:107], v[168:171], v[40:43], a[104:107]
    ds_read_b128 v[36:39], v21 offset:12288
    v_fma_f32 v235, v235, v57, v59
    v_mfma_f32_16x16x32_bf16 a[104:107], v[184:187], v[44:47], a[104:107]
    v_exp_f32 v19, v107
    v_mfma_f32_16x16x32_bf16 a[152:155], v[172:175], v[40:43], a[152:155]
    v_cvt_pk_bf16_f32 v74, v16, v17
    v_fma_f32 v238, v238, v56, v58
    v_mfma_f32_16x16x32_bf16 a[152:155], v[188:191], v[44:47], a[152:155]
    s_waitcnt lgkmcnt(2)
    buffer_load_dwordx4 v8, s[4:7], s27 offen offset:2048 sc1 lds
    v_mfma_f32_16x16x32_bf16 a[12:15], v[160:163], v[24:27], a[12:15]
    ds_read_b128 v[40:43], v21 offset:768
    v_mfma_f32_16x16x32_bf16 a[12:15], v[176:179], v[28:31], a[12:15]
    v_exp_f32 v16, v76
    v_mfma_f32_16x16x32_bf16 a[60:63], v[164:167], v[24:27], a[60:63]
    v_add_f32 v6, v6, v18
    v_add_f32 v6, v6, v19
    v_mfma_f32_16x16x32_bf16 a[60:63], v[180:183], v[28:31], a[60:63]
    buffer_load_dwordx4 v[148:151], v12, s[68:71], s35 offen offset:768 nt
    v_mfma_f32_16x16x32_bf16 a[108:111], v[168:171], v[24:27], a[108:111]
    ds_read_b128 v[44:47], v21 offset:13056
    v_fma_f32 v239, v239, v57, v59
    v_mfma_f32_16x16x32_bf16 a[108:111], v[184:187], v[28:31], a[108:111]
    v_exp_f32 v17, v77
    v_mfma_f32_16x16x32_bf16 a[156:159], v[172:175], v[24:27], a[156:159]
    s_add_u32 s29, s28, 49152
    v_cvt_pk_bf16_f32 v75, v18, v19
    s_add_u32 s27, s27, 24576
    v_mfma_f32_16x16x32_bf16 a[156:159], v[188:191], v[28:31], a[156:159]
    s_waitcnt lgkmcnt(2)
    buffer_load_dwordx4 v[152:155], v12, s[68:71], s35 offen offset:1536 nt
    v_mfma_f32_16x16x32_bf16 a[16:19], v[160:163], v[32:35], a[16:19]
    ds_read_b128 v[24:27], v21 offset:1536
    v_cvt_pk_bf16_f32 v233, v234, v235
    v_mfma_f32_16x16x32_bf16 a[16:19], v[176:179], v[36:39], a[16:19]
    s_sub_u32 s3, s29, 147456
    v_exp_f32 v18, v78
    v_mfma_f32_16x16x32_bf16 a[64:67], v[164:167], v[32:35], a[64:67]
    v_add_f32 v7, v7, v16
    v_add_f32 v7, v7, v17
    v_mfma_f32_16x16x32_bf16 a[64:67], v[180:183], v[36:39], a[64:67]
    s_add_u32 s56, s56, 12288
    v_exp_f32 v19, v79
    v_mfma_f32_16x16x32_bf16 a[112:115], v[168:171], v[32:35], a[112:115]
    ds_read_b128 v[28:31], v21 offset:13824
    v_cvt_pk_bf16_f32 v76, v16, v17
    v_mfma_f32_16x16x32_bf16 a[112:115], v[184:187], v[36:39], a[112:115]
    v_exp_f32 v16, v108
    v_mfma_f32_16x16x32_bf16 a[160:163], v[172:175], v[32:35], a[160:163]
    v_add_f32 v7, v7, v18
    v_add_f32 v7, v7, v19
    v_mfma_f32_16x16x32_bf16 a[160:163], v[188:191], v[36:39], a[160:163]
    s_waitcnt lgkmcnt(2)
    buffer_load_dwordx4 v[156:159], v12, s[68:71], s35 offen offset:2304 nt
    v_mfma_f32_16x16x32_bf16 a[20:23], v[160:163], v[40:43], a[20:23]
    s_mov_b32 m0, s56
    ds_read_b128 v[32:35], v21 offset:2304
    v_cvt_pk_bf16_f32 v237, v238, v239
    v_mfma_f32_16x16x32_bf16 a[20:23], v[176:179], v[44:47], a[20:23]
    s_min_u32 s29, s29, s3
    v_exp_f32 v17, v109
    v_mfma_f32_16x16x32_bf16 a[68:71], v[164:167], v[40:43], a[68:71]
    ds_read_b128 v[48:51], v10 offset:1152
    v_cvt_pk_bf16_f32 v77, v18, v19
    v_mfma_f32_16x16x32_bf16 a[68:71], v[180:183], v[44:47], a[68:71]
    v_exp_f32 v18, v110
    v_mfma_f32_16x16x32_bf16 a[116:119], v[168:171], v[40:43], a[116:119]
    ds_read_b128 v[36:39], v21 offset:14592
    v_add_f32 v7, v7, v16
    v_mfma_f32_16x16x32_bf16 a[116:119], v[184:187], v[44:47], a[116:119]
    s_waitcnt vmcnt(27)
    v_add_f32 v7, v7, v17
    v_mfma_f32_16x16x32_bf16 a[164:167], v[172:175], v[40:43], a[164:167]
    s_sub_u32 s3, s29, s28
    v_exp_f32 v19, v111
    v_mfma_f32_16x16x32_bf16 a[164:167], v[188:191], v[44:47], a[164:167]
    s_waitcnt lgkmcnt(3)
    buffer_load_dwordx4 v8, s[4:7], s27 offen offset:0 sc1 lds
    v_mfma_f32_16x16x32_bf16 a[24:27], v[160:163], v[24:27], a[24:27]
    ds_read_b128 v[40:43], v22 offset:0
    v_cvt_pk_bf16_f32 v78, v16, v17
    v_mfma_f32_16x16x32_bf16 a[24:27], v[176:179], v[28:31], a[24:27]
    v_exp_f32 v16, v80
    v_mfma_f32_16x16x32_bf16 a[72:75], v[164:167], v[24:27], a[72:75]
    v_add_f32 v7, v7, v18
    v_add_f32 v7, v7, v19
    v_mfma_f32_16x16x32_bf16 a[72:75], v[180:183], v[28:31], a[72:75]
    v_exp_f32 v17, v81
    v_mfma_f32_16x16x32_bf16 a[120:123], v[168:171], v[24:27], a[120:123]
    ds_read_b128 v[44:47], v22 offset:12288
    v_cvt_pk_bf16_f32 v79, v18, v19
    v_mfma_f32_16x16x32_bf16 a[120:123], v[184:187], v[28:31], a[120:123]
    s_mov_b32 s28, s29
    v_exp_f32 v18, v82
    v_mfma_f32_16x16x32_bf16 a[168:171], v[172:175], v[24:27], a[168:171]
    v_add_f32 v4, v4, v16
    v_add_f32 v4, v4, v17
    v_mfma_f32_16x16x32_bf16 a[168:171], v[188:191], v[28:31], a[168:171]
    s_waitcnt lgkmcnt(2)
    v_exp_f32 v19, v83
    v_mfma_f32_16x16x32_bf16 a[28:31], v[160:163], v[32:35], a[28:31]
    ds_read_b128 v[24:27], v22 offset:768
    v_cvt_f32_i32 v240, v240
    v_mfma_f32_16x16x32_bf16 a[28:31], v[176:179], v[36:39], a[28:31]
    buffer_load_dwordx4 v8, s[4:7], s27 offen offset:1024 sc1 lds
    v_mfma_f32_16x16x32_bf16 a[76:79], v[164:167], v[32:35], a[76:79]
    v_cvt_pk_bf16_f32 v80, v16, v17
    v_cvt_f32_i32 v241, v241
    v_mfma_f32_16x16x32_bf16 a[76:79], v[180:183], v[36:39], a[76:79]
    v_exp_f32 v16, v112
    v_mfma_f32_16x16x32_bf16 a[124:127], v[168:171], v[32:35], a[124:127]
    ds_read_b128 v[28:31], v22 offset:13056
    v_add_f32 v4, v4, v18
    v_mfma_f32_16x16x32_bf16 a[124:127], v[184:187], v[36:39], a[124:127]
    v_add_f32 v4, v4, v19
    v_cvt_f32_i32 v244, v244
    v_mfma_f32_16x16x32_bf16 a[172:175], v[172:175], v[32:35], a[172:175]
    v_exp_f32 v17, v113
    v_mfma_f32_16x16x32_bf16 a[172:175], v[188:191], v[36:39], a[172:175]
    s_waitcnt lgkmcnt(2)
    v_cvt_pk_bf16_f32 v81, v18, v19
    v_add_u32 v2, s3, v2
    v_mfma_f32_16x16x32_bf16 a[32:35], v[160:163], v[40:43], a[32:35]
    ds_read_b128 v[32:35], v22 offset:1536
    v_mfma_f32_16x16x32_bf16 a[32:35], v[176:179], v[44:47], a[32:35]
    buffer_load_dwordx4 v8, s[4:7], s27 offen offset:2048 sc1 lds
    v_mfma_f32_16x16x32_bf16 a[80:83], v[164:167], v[40:43], a[80:83]
    v_exp_f32 v18, v114
    v_mfma_f32_16x16x32_bf16 a[80:83], v[180:183], v[44:47], a[80:83]
    v_add_f32 v4, v4, v16
    v_add_f32 v4, v4, v17
    v_mfma_f32_16x16x32_bf16 a[128:131], v[168:171], v[40:43], a[128:131]
    ds_read_b128 v[36:39], v22 offset:13824
    v_add_u32 v3, s3, v3
    v_mfma_f32_16x16x32_bf16 a[128:131], v[184:187], v[44:47], a[128:131]
    v_exp_f32 v19, v115
    v_mfma_f32_16x16x32_bf16 a[176:179], v[172:175], v[40:43], a[176:179]
    ds_read_b128 v[56:59], v23 offset:0
    v_cvt_pk_bf16_f32 v82, v16, v17
    v_mfma_f32_16x16x32_bf16 a[176:179], v[188:191], v[44:47], a[176:179]
    s_waitcnt lgkmcnt(3)
    v_exp_f32 v16, v84
    v_mfma_f32_16x16x32_bf16 a[36:39], v[160:163], v[24:27], a[36:39]
    ds_read_b128 v[40:43], v22 offset:2304
    v_add_f32 v4, v4, v18
    v_mfma_f32_16x16x32_bf16 a[36:39], v[176:179], v[28:31], a[36:39]
    v_add_f32 v4, v4, v19
    v_add_u32 v10, 1792, v10
    v_mfma_f32_16x16x32_bf16 a[84:87], v[164:167], v[24:27], a[84:87]
    v_exp_f32 v17, v85
    v_mfma_f32_16x16x32_bf16 a[84:87], v[180:183], v[28:31], a[84:87]
    s_add_u32 s27, s27, 24576
    v_cvt_pk_bf16_f32 v83, v18, v19
    v_cvt_f32_i32 v245, v245
    v_mfma_f32_16x16x32_bf16 a[132:135], v[168:171], v[24:27], a[132:135]
    s_add_u32 s56, s56, 36864
    ds_read_b128 v[44:47], v22 offset:14592
    v_mfma_f32_16x16x32_bf16 a[132:135], v[184:187], v[28:31], a[132:135]
    s_waitcnt lgkmcnt(3)
    v_exp_f32 v18, v86
    v_mfma_f32_16x16x32_bf16 a[180:183], v[172:175], v[24:27], a[180:183]
    s_waitcnt vmcnt(32)
    v_add_f32 v5, v5, v16
    v_add_f32 v5, v5, v17
    v_mfma_f32_16x16x32_bf16 a[180:183], v[188:191], v[28:31], a[180:183]
    s_barrier
    v_fma_f32 v240, v240, v60, v62
    v_mfma_f32_16x16x32_bf16 a[40:43], v[160:163], v[32:35], a[40:43]
    s_sub_u32 s58, s56, 147456
    ds_read_b128 v[24:27], v2 offset:0
    v_mfma_f32_16x16x32_bf16 a[40:43], v[176:179], v[36:39], a[40:43]
    v_exp_f32 v19, v87
    v_mfma_f32_16x16x32_bf16 a[88:91], v[164:167], v[32:35], a[88:91]
    s_min_u32 s56, s56, s58
    v_cvt_pk_bf16_f32 v84, v16, v17
    v_mfma_f32_16x16x32_bf16 a[88:91], v[180:183], v[36:39], a[88:91]
    v_exp_f32 v16, v116
    v_mfma_f32_16x16x32_bf16 a[136:139], v[168:171], v[32:35], a[136:139]
    ds_read_b128 v[28:31], v3 offset:0
    v_add_f32 v5, v5, v18
    v_mfma_f32_16x16x32_bf16 a[136:139], v[184:187], v[36:39], a[136:139]
    v_add_f32 v5, v5, v19
    v_fma_f32 v241, v241, v61, v63
    v_mfma_f32_16x16x32_bf16 a[184:187], v[172:175], v[32:35], a[184:187]
    v_exp_f32 v17, v117
    v_mfma_f32_16x16x32_bf16 a[184:187], v[188:191], v[36:39], a[184:187]
    s_waitcnt lgkmcnt(2)
    v_cvt_pk_bf16_f32 v85, v18, v19
    v_mfma_f32_16x16x32_bf16 a[44:47], v[160:163], v[40:43], a[44:47]
    ds_read_b128 v[32:35], v2 offset:6144
    v_fma_f32 v244, v244, v60, v62
    v_mfma_f32_16x16x32_bf16 a[44:47], v[176:179], v[44:47], a[44:47]
    v_exp_f32 v18, v118
    v_mfma_f32_16x16x32_bf16 a[92:95], v[164:167], v[40:43], a[92:95]
    v_add_f32 v5, v5, v16
    v_add_f32 v5, v5, v17
    v_mfma_f32_16x16x32_bf16 a[92:95], v[180:183], v[44:47], a[92:95]
    v_exp_f32 v19, v119
    v_mfma_f32_16x16x32_bf16 a[140:143], v[168:171], v[40:43], a[140:143]
    ds_read_b128 v[36:39], v3 offset:6144
    v_cvt_pk_bf16_f32 v86, v16, v17
    v_mfma_f32_16x16x32_bf16 a[140:143], v[184:187], v[44:47], a[140:143]
    v_add_f32 v5, v5, v18
    v_add_f32 v5, v5, v19
    v_mfma_f32_16x16x32_bf16 a[188:191], v[172:175], v[40:43], a[188:191]
    v_cvt_pk_bf16_f32 v87, v18, v19
    v_mfma_f32_16x16x32_bf16 a[188:191], v[188:191], v[44:47], a[188:191]
    s_waitcnt lgkmcnt(2)
    v_mfma_f32_16x16x32_bf16 v[160:163], v[24:27], a[192:195], v[128:131]
    s_mov_b32 m0, s26
    ds_read_b128 v[40:43], v2 offset:128
    v_fma_f32 v245, v245, v61, v63
    v_mfma_f32_16x16x32_bf16 v[160:163], v[28:31], a[196:199], v[160:163]
    v_exp_f32 v16, v88
    v_mfma_f32_16x16x32_bf16 v[164:167], v[24:27], a[216:219], v[132:135]
    v_exp_f32 v17, v89
    v_mfma_f32_16x16x32_bf16 v[164:167], v[28:31], a[220:223], v[164:167]
    v_bfe_u32 v53, v8, 4, 6
    v_cvt_pk_bf16_f32 v226, v240, v241
    v_mfma_f32_16x16x32_bf16 v[168:171], v[24:27], a[240:243], v[136:139]
    ds_read_b128 v[44:47], v3 offset:128
    v_lshlrev_b32 v53, 2, v53
    v_mfma_f32_16x16x32_bf16 v[168:171], v[28:31], a[244:247], v[168:171]
    buffer_load_dwordx4 v8, s[4:7], s32 offen offset:0 sc1 lds
    v_mfma_f32_16x16x32_bf16 v[172:175], v[24:27], v[200:203], v[140:143]
    v_exp_f32 v18, v90
    v_mfma_f32_16x16x32_bf16 v[172:175], v[28:31], v[204:207], v[172:175]
    s_waitcnt lgkmcnt(2)
    v_add_f32 v6, v6, v16
    v_add_f32 v6, v6, v17
    v_mfma_f32_16x16x32_bf16 v[96:99], v[32:35], a[192:195], v[128:131]
    ds_read_b128 v[24:27], v2 offset:6272
    v_cvt_pk_bf16_f32 v230, v244, v245
    v_mfma_f32_16x16x32_bf16 v[96:99], v[36:39], a[196:199], v[96:99]
    buffer_load_dword v52, v53, s[20:23], 0 offen sc1
    v_mfma_f32_16x16x32_bf16 v[100:103], v[32:35], a[216:219], v[132:135]
    v_exp_f32 v19, v91
    v_mfma_f32_16x16x32_bf16 v[100:103], v[36:39], a[220:223], v[100:103]
    v_cvt_pk_bf16_f32 v88, v16, v17
    v_mfma_f32_16x16x32_bf16 v[104:107], v[32:35], a[240:243], v[136:139]
    ds_read_b128 v[28:31], v3 offset:6272
    v_mfma_f32_16x16x32_bf16 v[104:107], v[36:39], a[244:247], v[104:107]
    v_exp_f32 v16, v120
    v_mfma_f32_16x16x32_bf16 v[108:111], v[32:35], v[200:203], v[140:143]
    v_add_f32 v6, v6, v18
    v_add_f32 v6, v6, v19
    v_mfma_f32_16x16x32_bf16 v[108:111], v[36:39], v[204:207], v[108:111]
    s_waitcnt lgkmcnt(2)
    buffer_load_dwordx4 v8, s[4:7], s32 offen offset:1024 sc1 lds
    v_mfma_f32_16x16x32_bf16 v[160:163], v[40:43], a[200:203], v[160:163]
    ds_read_b128 v[32:35], v2 offset:256
    v_cvt_f32_i32 v242, v242
    v_mfma_f32_16x16x32_bf16 v[160:163], v[44:47], a[204:207], v[160:163]
    v_exp_f32 v17, v121
    v_mfma_f32_16x16x32_bf16 v[164:167], v[40:43], a[224:227], v[164:167]
    v_cvt_pk_bf16_f32 v89, v18, v19
    v_cvt_f32_i32 v243, v243
    v_mfma_f32_16x16x32_bf16 v[164:167], v[44:47], a[228:231], v[164:167]
    v_exp_f32 v18, v122
    v_mfma_f32_16x16x32_bf16 v[168:171], v[40:43], a[248:251], v[168:171]
    ds_read_b128 v[36:39], v3 offset:256
    v_add_f32 v6, v6, v16
    v_mfma_f32_16x16x32_bf16 v[168:171], v[44:47], a[252:255], v[168:171]
    v_add_f32 v6, v6, v17
    v_mfma_f32_16x16x32_bf16 v[172:175], v[40:43], v[208:211], v[172:175]
    v_exp_f32 v19, v123
    v_mfma_f32_16x16x32_bf16 v[172:175], v[44:47], v[212:215], v[172:175]
    s_waitcnt lgkmcnt(2)
    buffer_load_dwordx4 v8, s[4:7], s32 offen offset:2048 sc1 lds
    v_mfma_f32_16x16x32_bf16 v[96:99], v[24:27], a[200:203], v[96:99]
    ds_read_b128 v[40:43], v2 offset:6400
    v_cvt_pk_bf16_f32 v90, v16, v17
    v_mfma_f32_16x16x32_bf16 v[96:99], v[28:31], a[204:207], v[96:99]
    v_exp_f32 v16, v92
    v_mfma_f32_16x16x32_bf16 v[100:103], v[24:27], a[224:227], v[100:103]
    v_add_f32 v6, v6, v18
    v_add_f32 v6, v6, v19
    v_mfma_f32_16x16x32_bf16 v[100:103], v[28:31], a[228:231], v[100:103]
    v_exp_f32 v17, v93
    v_mfma_f32_16x16x32_bf16 v[104:107], v[24:27], a[248:251], v[104:107]
    ds_read_b128 v[44:47], v3 offset:6400
    v_cvt_pk_bf16_f32 v91, v18, v19
    v_mfma_f32_16x16x32_bf16 v[104:107], v[28:31], a[252:255], v[104:107]
    v_exp_f32 v18, v94
    v_mfma_f32_16x16x32_bf16 v[108:111], v[24:27], v[208:211], v[108:111]
    s_add_u32 s29, s30, 49152
    v_cvt_f32_i32 v246, v246
    v_add_f32 v7, v7, v16
    v_mfma_f32_16x16x32_bf16 v[108:111], v[28:31], v[212:215], v[108:111]
    s_waitcnt lgkmcnt(2)
    v_add_f32 v7, v7, v17
    v_cvt_f32_i32 v247, v247
    v_mfma_f32_16x16x32_bf16 v[160:163], v[32:35], a[208:211], v[160:163]
    s_add_u32 s32, s32, 24576
    ds_read_b128 v[24:27], v2 offset:12288
    s_sub_u32 s3, s29, 147456
    v_mfma_f32_16x16x32_bf16 v[160:163], v[36:39], a[212:215], v[160:163]
    v_exp_f32 v19, v95
    v_mfma_f32_16x16x32_bf16 v[164:167], v[32:35], a[232:235], v[164:167]
    v_cvt_pk_bf16_f32 v92, v16, v17
    v_fma_f32 v242, v242, v48, v50
    v_mfma_f32_16x16x32_bf16 v[164:167], v[36:39], a[236:239], v[164:167]
    s_add_u32 s26, s26, 12288
    v_exp_f32 v16, v124
    v_mfma_f32_16x16x32_bf16 v[168:171], v[32:35], v[192:195], v[168:171]
    ds_read_b128 v[28:31], v3 offset:12288
    v_add_f32 v7, v7, v18
    v_mfma_f32_16x16x32_bf16 v[168:171], v[36:39], v[196:199], v[168:171]
    v_add_f32 v7, v7, v19
    v_mfma_f32_16x16x32_bf16 v[172:175], v[32:35], v[216:219], v[172:175]
    s_min_u32 s29, s29, s3
    v_mfma_f32_16x16x32_bf16 v[172:175], v[36:39], v[220:223], v[172:175]
    s_waitcnt lgkmcnt(2)
    v_exp_f32 v17, v125
    v_mfma_f32_16x16x32_bf16 v[96:99], v[40:43], a[208:211], v[96:99]
    s_mov_b32 m0, s26
    ds_read_b128 v[32:35], v2 offset:18432
    v_cvt_pk_bf16_f32 v93, v18, v19
    v_mfma_f32_16x16x32_bf16 v[96:99], v[44:47], a[212:215], v[96:99]
    v_exp_f32 v18, v126
    v_mfma_f32_16x16x32_bf16 v[100:103], v[40:43], a[232:235], v[100:103]
    v_fma_f32 v243, v243, v49, v51
    v_mfma_f32_16x16x32_bf16 v[100:103], v[44:47], a[236:239], v[100:103]
    v_add_f32 v7, v7, v16
    v_mfma_f32_16x16x32_bf16 v[104:107], v[40:43], v[192:195], v[104:107]
    s_sub_u32 s3, s29, s30
    ds_read_b128 v[36:39], v3 offset:18432
    v_add_f32 v7, v7, v17
    v_mfma_f32_16x16x32_bf16 v[104:107], v[44:47], v[196:199], v[104:107]
    v_exp_f32 v19, v127
    v_mfma_f32_16x16x32_bf16 v[108:111], v[40:43], v[216:219], v[108:111]
    v_fma_f32 v246, v246, v48, v50
    v_cvt_pk_bf16_f32 v94, v16, v17
    v_mfma_f32_16x16x32_bf16 v[108:111], v[44:47], v[220:223], v[108:111]
    s_waitcnt lgkmcnt(2)
    buffer_load_dwordx4 v8, s[4:7], s32 offen offset:0 sc1 lds
    v_mfma_f32_16x16x32_bf16 v[176:179], v[24:27], a[192:195], v[128:131]
    ds_read_b128 v[40:43], v2 offset:12416
    v_add_f32 v7, v7, v18
    v_mfma_f32_16x16x32_bf16 v[176:179], v[28:31], a[196:199], v[176:179]
    v_add_f32 v7, v7, v19
    v_cvt_pk_bf16_f32 v95, v18, v19
    v_mfma_f32_16x16x32_bf16 v[180:183], v[24:27], a[216:219], v[132:135]
    s_mov_b32 s30, s29
    v_fma_f32 v247, v247, v49, v51
    v_mfma_f32_16x16x32_bf16 v[180:183], v[28:31], a[220:223], v[180:183]
    v_mfma_f32_16x16x32_bf16 v[184:187], v[24:27], a[240:243], v[136:139]
    ds_read_b128 v[44:47], v3 offset:12416
    v_mfma_f32_16x16x32_bf16 v[184:187], v[28:31], a[244:247], v[184:187]
    v_exp_f32 v16, v160
    v_mfma_f32_16x16x32_bf16 v[188:191], v[24:27], v[200:203], v[140:143]
    v_exp_f32 v17, v161
    v_mfma_f32_16x16x32_bf16 v[188:191], v[28:31], v[204:207], v[188:191]
    s_waitcnt lgkmcnt(2)
    v_exp_f32 v18, v162
    v_mfma_f32_16x16x32_bf16 v[112:115], v[32:35], a[192:195], v[128:131]
    ds_read_b128 v[24:27], v2 offset:18560
    v_add_f32 v4, v4, v16
    v_mfma_f32_16x16x32_bf16 v[112:115], v[36:39], a[196:199], v[112:115]
    buffer_load_dwordx4 v8, s[4:7], s32 offen offset:1024 sc1 lds
    v_mfma_f32_16x16x32_bf16 v[116:119], v[32:35], a[216:219], v[132:135]
    v_add_f32 v4, v4, v17
    v_cvt_pk_bf16_f32 v227, v242, v243
    v_mfma_f32_16x16x32_bf16 v[116:119], v[36:39], a[220:223], v[116:119]
    v_exp_f32 v19, v163
    v_mfma_f32_16x16x32_bf16 v[120:123], v[32:35], a[240:243], v[136:139]
    ds_read_b128 v[28:31], v3 offset:18560
    v_cvt_pk_bf16_f32 v160, v16, v17
    v_mfma_f32_16x16x32_bf16 v[120:123], v[36:39], a[244:247], v[120:123]
    buffer_load_dword v0, v8, s[88:91], s93 offen
    v_mfma_f32_16x16x32_bf16 v[124:127], v[32:35], v[200:203], v[140:143]
    v_exp_f32 v16, v96
    v_mfma_f32_16x16x32_bf16 v[124:127], v[36:39], v[204:207], v[124:127]
    s_waitcnt lgkmcnt(2)
    v_add_f32 v4, v4, v18
    v_add_f32 v4, v4, v19
    v_mfma_f32_16x16x32_bf16 v[176:179], v[40:43], a[200:203], v[176:179]
    ds_read_b128 v[32:35], v2 offset:12544
    v_add_u32 v1, s3, v1
    v_mfma_f32_16x16x32_bf16 v[176:179], v[44:47], a[204:207], v[176:179]
    buffer_load_dwordx4 v8, s[4:7], s32 offen offset:2048 sc1 lds
    v_mfma_f32_16x16x32_bf16 v[180:183], v[40:43], a[224:227], v[180:183]
    v_exp_f32 v17, v97
    v_mfma_f32_16x16x32_bf16 v[180:183], v[44:47], a[228:231], v[180:183]
    v_cvt_pk_bf16_f32 v161, v18, v19
    v_add_u32 v21, s3, v21
    v_mfma_f32_16x16x32_bf16 v[184:187], v[40:43], a[248:251], v[184:187]
    ds_read_b128 v[36:39], v3 offset:12544
    v_cvt_pk_bf16_f32 v231, v246, v247
    v_mfma_f32_16x16x32_bf16 v[184:187], v[44:47], a[252:255], v[184:187]
    s_waitcnt vmcnt(25)
    v_exp_f32 v18, v98
    v_mfma_f32_16x16x32_bf16 v[188:191], v[40:43], v[208:211], v[188:191]
    v_add_f32 v4, v4, v16
    v_add_f32 v4, v4, v17
    v_mfma_f32_16x16x32_bf16 v[188:191], v[44:47], v[212:215], v[188:191]
    s_waitcnt lgkmcnt(2)
    v_exp_f32 v19, v99
    v_mfma_f32_16x16x32_bf16 v[112:115], v[24:27], a[200:203], v[112:115]
    ds_read_b128 v[40:43], v2 offset:18688
    v_cvt_pk_bf16_f32 v162, v16, v17
    v_mfma_f32_16x16x32_bf16 v[112:115], v[28:31], a[204:207], v[112:115]
    v_exp_f32 v16, v164
    v_mfma_f32_16x16x32_bf16 v[116:119], v[24:27], a[224:227], v[116:119]
    v_add_f32 v4, v4, v18
    v_add_u32 v22, s3, v22
    v_mfma_f32_16x16x32_bf16 v[116:119], v[28:31], a[228:231], v[116:119]
    s_add_u32 s32, s32, 24576
    v_add_f32 v4, v4, v19
    v_cvt_f32_i32 v248, v248
    s_branch L_skip10
L_pad10:
    s_branch L_tb1_4
L_skip10:
    v_mfma_f32_16x16x32_bf16 v[120:123], v[24:27], a[248:251], v[120:123]
    s_add_u32 s26, s26, 36864
    ds_read_b128 v[44:47], v3 offset:18688
    v_mfma_f32_16x16x32_bf16 v[120:123], v[28:31], a[252:255], v[120:123]
    s_waitcnt lgkmcnt(2)
    v_exp_f32 v17, v165
    v_mfma_f32_16x16x32_bf16 v[124:127], v[24:27], v[208:211], v[124:127]
    s_waitcnt vmcnt(27)
    v_cvt_pk_bf16_f32 v163, v18, v19
    v_cvt_f32_i32 v249, v249
    v_mfma_f32_16x16x32_bf16 v[124:127], v[28:31], v[212:215], v[124:127]
    s_barrier
    s_sub_u32 s57, s26, 147456
    v_mfma_f32_16x16x32_bf16 v[176:179], v[32:35], a[208:211], v[176:179]
    ds_read_b128 v[24:27], v1 offset:0
    v_mfma_f32_16x16x32_bf16 v[176:179], v[36:39], a[212:215], v[176:179]
    v_exp_f32 v18, v166
    v_mfma_f32_16x16x32_bf16 v[180:183], v[32:35], a[232:235], v[180:183]
    s_min_u32 s26, s26, s57
    v_add_f32 v5, v5, v16
    v_add_f32 v5, v5, v17
    v_mfma_f32_16x16x32_bf16 v[180:183], v[36:39], a[236:239], v[180:183]
    v_exp_f32 v19, v167
    v_mfma_f32_16x16x32_bf16 v[184:187], v[32:35], v[192:195], v[184:187]
    ds_read_b128 v[28:31], v1 offset:12288
    v_cvt_pk_bf16_f32 v164, v16, v17
    v_mfma_f32_16x16x32_bf16 v[184:187], v[36:39], v[196:199], v[184:187]
    v_exp_f32 v16, v100
    v_mfma_f32_16x16x32_bf16 v[188:191], v[32:35], v[216:219], v[188:191]
    v_add_f32 v5, v5, v18
    v_add_f32 v5, v5, v19
    v_mfma_f32_16x16x32_bf16 v[188:191], v[36:39], v[220:223], v[188:191]
    s_waitcnt lgkmcnt(2)
    v_exp_f32 v17, v101
    v_mfma_f32_16x16x32_bf16 v[112:115], v[40:43], a[208:211], v[112:115]
    ds_read_b128 v[32:35], v1 offset:768
    v_cvt_pk_bf16_f32 v165, v18, v19
    v_mfma_f32_16x16x32_bf16 v[112:115], v[44:47], a[212:215], v[112:115]
    v_exp_f32 v18, v102
    v_mfma_f32_16x16x32_bf16 v[116:119], v[40:43], a[232:235], v[116:119]
    v_add_f32 v5, v5, v16
    v_cvt_f32_i32 v252, v252
    v_mfma_f32_16x16x32_bf16 v[116:119], v[44:47], a[236:239], v[116:119]
    v_add_f32 v5, v5, v17
    v_cvt_f32_i32 v253, v253
    v_mfma_f32_16x16x32_bf16 v[120:123], v[40:43], v[192:195], v[120:123]
    ds_read_b128 v[36:39], v1 offset:13056
    v_mfma_f32_16x16x32_bf16 v[120:123], v[44:47], v[196:199], v[120:123]
    v_exp_f32 v19, v103
    v_mfma_f32_16x16x32_bf16 v[124:127], v[40:43], v[216:219], v[124:127]
    v_cvt_pk_bf16_f32 v166, v16, v17
    v_add_f32 v5, v5, v18
    v_mfma_f32_16x16x32_bf16 v[124:127], v[44:47], v[220:223], v[124:127]
    s_waitcnt lgkmcnt(2)
    v_add_f32 v5, v5, v19
    v_cvt_pk_bf16_f32 v167, v18, v19
    v_mfma_f32_16x16x32_bf16 a[0:3], v[64:67], v[24:27], a[0:3]
    ds_read_b128 v[40:43], v1 offset:1536
    v_fma_f32 v248, v248, v60, v62
    v_mfma_f32_16x16x32_bf16 a[0:3], v[80:83], v[28:31], a[0:3]
    v_exp_f32 v16, v168
    v_mfma_f32_16x16x32_bf16 a[48:51], v[68:71], v[24:27], a[48:51]
    v_exp_f32 v17, v169
    v_mfma_f32_16x16x32_bf16 a[48:51], v[84:87], v[28:31], a[48:51]
    v_exp_f32 v18, v170
    v_mfma_f32_16x16x32_bf16 a[96:99], v[72:75], v[24:27], a[96:99]
    ds_read_b128 v[44:47], v1 offset:13824
    v_fma_f32 v249, v249, v61, v63
    v_mfma_f32_16x16x32_bf16 a[96:99], v[88:91], v[28:31], a[96:99]
    v_add_f32 v6, v6, v16
    v_add_f32 v6, v6, v17
    v_mfma_f32_16x16x32_bf16 a[144:147], v[76:79], v[24:27], a[144:147]
    v_exp_f32 v19, v171
    v_mfma_f32_16x16x32_bf16 a[144:147], v[92:95], v[28:31], a[144:147]
    s_waitcnt lgkmcnt(2)
    v_mfma_f32_16x16x32_bf16 a[4:7], v[64:67], v[32:35], a[4:7]
    ds_read_b128 v[24:27], v1 offset:2304
    v_cvt_pk_bf16_f32 v168, v16, v17
    v_mfma_f32_16x16x32_bf16 a[4:7], v[80:83], v[36:39], a[4:7]
    v_exp_f32 v16, v104
    v_mfma_f32_16x16x32_bf16 a[52:55], v[68:71], v[32:35], a[52:55]
    v_add_f32 v6, v6, v18
    v_fma_f32 v252, v252, v60, v62
    v_mfma_f32_16x16x32_bf16 a[52:55], v[84:87], v[36:39], a[52:55]
    v_add_f32 v6, v6, v19
    v_mfma_f32_16x16x32_bf16 a[100:103], v[72:75], v[32:35], a[100:103]
    ds_read_b128 v[28:31], v1 offset:14592
    v_mfma_f32_16x16x32_bf16 a[100:103], v[88:91], v[36:39], a[100:103]
    v_exp_f32 v17, v105
    v_mfma_f32_16x16x32_bf16 a[148:151], v[76:79], v[32:35], a[148:151]
    v_cvt_pk_bf16_f32 v169, v18, v19
    v_fma_f32 v253, v253, v61, v63
    v_mfma_f32_16x16x32_bf16 a[148:151], v[92:95], v[36:39], a[148:151]
    s_waitcnt lgkmcnt(2)
    v_exp_f32 v18, v106
    v_mfma_f32_16x16x32_bf16 a[8:11], v[64:67], v[40:43], a[8:11]
    ds_read_b128 v[32:35], v21 offset:0
    v_add_f32 v6, v6, v16
    v_mfma_f32_16x16x32_bf16 a[8:11], v[80:83], v[44:47], a[8:11]
    v_add_f32 v6, v6, v17
    v_mfma_f32_16x16x32_bf16 a[56:59], v[68:71], v[40:43], a[56:59]
    v_exp_f32 v19, v107
    v_mfma_f32_16x16x32_bf16 a[56:59], v[84:87], v[44:47], a[56:59]
    v_mfma_f32_16x16x32_bf16 a[104:107], v[72:75], v[40:43], a[104:107]
    ds_read_b128 v[36:39], v21 offset:12288
    v_cvt_pk_bf16_f32 v170, v16, v17
    v_mfma_f32_16x16x32_bf16 a[104:107], v[88:91], v[44:47], a[104:107]
    v_exp_f32 v16, v172
    v_mfma_f32_16x16x32_bf16 a[152:155], v[76:79], v[40:43], a[152:155]
    v_cvt_pk_bf16_f32 v234, v248, v249
    v_add_f32 v6, v6, v18
    v_mfma_f32_16x16x32_bf16 a[152:155], v[92:95], v[44:47], a[152:155]
    s_waitcnt lgkmcnt(2)
    v_add_f32 v6, v6, v19
    v_mfma_f32_16x16x32_bf16 a[12:15], v[64:67], v[24:27], a[12:15]
    ds_read_b128 v[40:43], v21 offset:768
    v_mfma_f32_16x16x32_bf16 a[12:15], v[80:83], v[28:31], a[12:15]
    v_exp_f32 v17, v173
    v_mfma_f32_16x16x32_bf16 a[60:63], v[68:71], v[24:27], a[60:63]
    v_cvt_pk_bf16_f32 v171, v18, v19
    v_cvt_pk_bf16_f32 v238, v252, v253
    v_mfma_f32_16x16x32_bf16 a[60:63], v[84:87], v[28:31], a[60:63]
    v_exp_f32 v18, v174
    v_mfma_f32_16x16x32_bf16 a[108:111], v[72:75], v[24:27], a[108:111]
    ds_read_b128 v[44:47], v21 offset:13056
    v_add_f32 v7, v7, v16
    v_mfma_f32_16x16x32_bf16 a[108:111], v[88:91], v[28:31], a[108:111]
    s_waitcnt vmcnt(6)
    v_subrev_u32 v52, s92, v52
    v_cmp_lt_u32 vcc, 15, v52
    v_mfma_f32_16x16x32_bf16 a[156:159], v[76:79], v[24:27], a[156:159]
    s_add_u32 s29, s28, 49152
    v_add_f32 v7, v7, v17
    v_mfma_f32_16x16x32_bf16 a[156:159], v[92:95], v[28:31], a[156:159]
    s_waitcnt lgkmcnt(2)
    v_exp_f32 v19, v175
    v_mfma_f32_16x16x32_bf16 a[16:19], v[64:67], v[32:35], a[16:19]
    s_and_b32 s59, vcc_lo, 0xff
    ds_read_b128 v[24:27], v21 offset:1536
    v_cvt_pk_bf16_f32 v172, v16, v17
    v_mfma_f32_16x16x32_bf16 a[16:19], v[80:83], v[36:39], a[16:19]
    s_cbranch_scc1 L_pollslow5
L_pollok5:
    v_mfma_f32_16x16x32_bf16 a[64:67], v[68:71], v[32:35], a[64:67]
    s_add_u32 s92, s92, 1
    v_exp_f32 v16, v108
    v_mfma_f32_16x16x32_bf16 a[64:67], v[84:87], v[36:39], a[64:67]
    s_sub_u32 s3, s29, 147456
    v_add_f32 v7, v7, v18
    v_add_f32 v7, v7, v19
    v_mfma_f32_16x16x32_bf16 a[112:115], v[72:75], v[32:35], a[112:115]
    s_mov_b32 m0, s56
    ds_read_b128 v[28:31], v21 offset:13824
    v_cvt_f32_i32 v250, v250
    v_mfma_f32_16x16x32_bf16 a[112:115], v[88:91], v[36:39], a[112:115]
    v_exp_f32 v17, v109
    v_mfma_f32_16x16x32_bf16 a[160:163], v[76:79], v[32:35], a[160:163]
    v_cvt_pk_bf16_f32 v173, v18, v19
    v_cvt_f32_i32 v251, v251
    v_mfma_f32_16x16x32_bf16 a[160:163], v[92:95], v[36:39], a[160:163]
    s_waitcnt lgkmcnt(2)
    buffer_load_dwordx4 v8, s[4:7], s27 offen offset:0 sc1 lds
    v_mfma_f32_16x16x32_bf16 a[20:23], v[64:67], v[40:43], a[20:23]
    s_min_u32 s29, s29, s3
    ds_read_b128 v[32:35], v21 offset:2304
    v_mfma_f32_16x16x32_bf16 a[20:23], v[80:83], v[44:47], a[20:23]
    v_exp_f32 v18, v110
    v_mfma_f32_16x16x32_bf16 a[68:71], v[68:71], v[40:43], a[68:71]
    v_add_f32 v7, v7, v16
    v_add_f32 v7, v7, v17
    v_mfma_f32_16x16x32_bf16 a[68:71], v[84:87], v[44:47], a[68:71]
    buffer_load_dwordx4 v8, s[4:7], s27 offen offset:1024 sc1 lds
    v_mfma_f32_16x16x32_bf16 a[116:119], v[72:75], v[40:43], a[116:119]
    ds_read_b128 v[36:39], v21 offset:14592
    v_cvt_f32_i32 v254, v254
    v_mfma_f32_16x16x32_bf16 a[116:119], v[88:91], v[44:47], a[116:119]
    v_exp_f32 v19, v111
    v_mfma_f32_16x16x32_bf16 a[164:167], v[76:79], v[40:43], a[164:167]
    s_sub_u32 s3, s29, s28
    v_cvt_pk_bf16_f32 v174, v16, v17
    v_mfma_f32_16x16x32_bf16 a[164:167], v[92:95], v[44:47], a[164:167]
    s_waitcnt lgkmcnt(2)
    v_exp_f32 v16, v176
    v_mfma_f32_16x16x32_bf16 a[24:27], v[64:67], v[24:27], a[24:27]
    ds_read_b128 v[40:43], v22 offset:0
    v_add_f32 v7, v7, v18
    v_mfma_f32_16x16x32_bf16 a[24:27], v[80:83], v[28:31], a[24:27]
    buffer_load_dwordx4 v8, s[4:7], s27 offen offset:2048 sc1 lds
    v_mfma_f32_16x16x32_bf16 a[72:75], v[68:71], v[24:27], a[72:75]
    v_add_f32 v7, v7, v19
    v_cvt_f32_i32 v255, v255
    v_mfma_f32_16x16x32_bf16 a[72:75], v[84:87], v[28:31], a[72:75]
    v_exp_f32 v17, v177
    v_mfma_f32_16x16x32_bf16 a[120:123], v[72:75], v[24:27], a[120:123]
    s_add_u32 s27, s27, 24576
    ds_read_b128 v[44:47], v22 offset:12288
    v_cvt_pk_bf16_f32 v175, v18, v19
    v_mfma_f32_16x16x32_bf16 a[120:123], v[88:91], v[28:31], a[120:123]
    s_mov_b32 s28, s29
    v_exp_f32 v18, v178
    v_mfma_f32_16x16x32_bf16 a[168:171], v[76:79], v[24:27], a[168:171]
    v_add_f32 v4, v4, v16
    v_add_f32 v4, v4, v17
    v_mfma_f32_16x16x32_bf16 a[168:171], v[92:95], v[28:31], a[168:171]
    s_waitcnt lgkmcnt(2)
    v_exp_f32 v19, v179
    v_mfma_f32_16x16x32_bf16 a[28:31], v[64:67], v[32:35], a[28:31]
    s_add_u32 s56, s56, 12288
    ds_read_b128 v[24:27], v22 offset:768
    v_cvt_pk_bf16_f32 v176, v16, v17
    v_mfma_f32_16x16x32_bf16 a[28:31], v[80:83], v[36:39], a[28:31]
    s_mov_b32 m0, s56
    v_exp_f32 v16, v112
    v_mfma_f32_16x16x32_bf16 a[76:79], v[68:71], v[32:35], a[76:79]
    v_fma_f32 v250, v250, v48, v50
    v_add_f32 v4, v4, v18
    v_mfma_f32_16x16x32_bf16 a[76:79], v[84:87], v[36:39], a[76:79]
    v_add_f32 v4, v4, v19
    v_mfma_f32_16x16x32_bf16 a[124:127], v[72:75], v[32:35], a[124:127]
    ds_read_b128 v[28:31], v22 offset:13056
    v_add_u32 v2, s3, v2
    v_mfma_f32_16x16x32_bf16 a[124:127], v[88:91], v[36:39], a[124:127]
    buffer_load_dwordx4 v8, s[4:7], s27 offen offset:0 sc1 lds
    v_mfma_f32_16x16x32_bf16 a[172:175], v[76:79], v[32:35], a[172:175]
    v_exp_f32 v17, v113
    v_mfma_f32_16x16x32_bf16 a[172:175], v[92:95], v[36:39], a[172:175]
    s_waitcnt lgkmcnt(2)
    v_cvt_pk_bf16_f32 v177, v18, v19
    v_fma_f32 v251, v251, v49, v51
    v_mfma_f32_16x16x32_bf16 a[32:35], v[64:67], v[40:43], a[32:35]
    ds_read_b128 v[32:35], v22 offset:1536
    v_mfma_f32_16x16x32_bf16 a[32:35], v[80:83], v[44:47], a[32:35]
    v_exp_f32 v18, v114
    v_mfma_f32_16x16x32_bf16 a[80:83], v[68:71], v[40:43], a[80:83]
    v_add_f32 v4, v4, v16
    v_add_f32 v4, v4, v17
    v_mfma_f32_16x16x32_bf16 a[80:83], v[84:87], v[44:47], a[80:83]
    buffer_load_dwordx4 v8, s[4:7], s27 offen offset:1024 sc1 lds
    v_mfma_f32_16x16x32_bf16 a[128:131], v[72:75], v[40:43], a[128:131]
    ds_read_b128 v[36:39], v22 offset:13824
    v_add_u32 v3, s3, v3
    v_mfma_f32_16x16x32_bf16 a[128:131], v[88:91], v[44:47], a[128:131]
    v_exp_f32 v19, v115
    v_mfma_f32_16x16x32_bf16 a[176:179], v[76:79], v[40:43], a[176:179]
    v_cvt_pk_bf16_f32 v178, v16, v17
    v_fma_f32 v254, v254, v48, v50
    v_mfma_f32_16x16x32_bf16 a[176:179], v[92:95], v[44:47], a[176:179]
    s_waitcnt lgkmcnt(2)
    buffer_load_dwordx4 v8, s[4:7], s27 offen offset:2048 sc1 lds
    v_mfma_f32_16x16x32_bf16 a[36:39], v[64:67], v[24:27], a[36:39]
    ds_read_b128 v[40:43], v22 offset:2304
    v_mfma_f32_16x16x32_bf16 a[36:39], v[80:83], v[28:31], a[36:39]
    v_exp_f32 v16, v180
    v_mfma_f32_16x16x32_bf16 a[84:87], v[68:71], v[24:27], a[84:87]
    v_add_f32 v4, v4, v18
    v_add_f32 v4, v4, v19
    v_mfma_f32_16x16x32_bf16 a[84:87], v[84:87], v[28:31], a[84:87]
    v_exp_f32 v17, v181
    v_mfma_f32_16x16x32_bf16 a[132:135], v[72:75], v[24:27], a[132:135]
    ds_read_b128 v[44:47], v22 offset:14592
    v_cvt_pk_bf16_f32 v179, v18, v19
    v_mfma_f32_16x16x32_bf16 a[132:135], v[88:91], v[28:31], a[132:135]
    s_waitcnt lgkmcnt(2)
    v_exp_f32 v18, v182
    v_mfma_f32_16x16x32_bf16 a[180:183], v[76:79], v[24:27], a[180:183]
    s_waitcnt vmcnt(25)
    v_add_f32 v5, v5, v16
    v_add_f32 v5, v5, v17
    v_mfma_f32_16x16x32_bf16 a[180:183], v[92:95], v[28:31], a[180:183]
    s_barrier
    s_add_u32 s27, s27, 24576
    v_mfma_f32_16x16x32_bf16 a[40:43], v[64:67], v[32:35], a[40:43]
    ds_read_b128 v[24:27], v2 offset:0
    v_fma_f32 v255, v255, v49, v51
    v_mfma_f32_16x16x32_bf16 a[40:43], v[80:83], v[36:39], a[40:43]
    s_add_u32 s56, s56, 36864
    buffer_load_dwordx4 v[240:243], v12, s[68:71], s36 offen offset:0 nt
    v_mfma_f32_16x16x32_bf16 a[88:91], v[68:71], v[32:35], a[88:91]
    s_sub_u32 s58, s56, 147456
    v_exp_f32 v19, v183
    v_mfma_f32_16x16x32_bf16 a[88:91], v[84:87], v[36:39], a[88:91]
    v_cvt_pk_bf16_f32 v180, v16, v17
    v_cvt_pk_bf16_f32 v235, v250, v251
    v_mfma_f32_16x16x32_bf16 a[136:139], v[72:75], v[32:35], a[136:139]
    s_min_u32 s56, s56, s58
    ds_read_b128 v[28:31], v3 offset:0
    v_mfma_f32_16x16x32_bf16 a[136:139], v[88:91], v[36:39], a[136:139]
    v_exp_f32 v16, v116
    v_mfma_f32_16x16x32_bf16 a[184:187], v[76:79], v[32:35], a[184:187]
    v_add_f32 v5, v5, v18
    v_add_f32 v5, v5, v19
    v_mfma_f32_16x16x32_bf16 a[184:187], v[92:95], v[36:39], a[184:187]
    s_waitcnt lgkmcnt(2)
    buffer_load_dwordx4 v[244:247], v12, s[68:71], s36 offen offset:768 nt
    v_mfma_f32_16x16x32_bf16 a[44:47], v[64:67], v[40:43], a[44:47]
    ds_read_b128 v[32:35], v2 offset:6144
    v_cvt_pk_bf16_f32 v239, v254, v255
    v_mfma_f32_16x16x32_bf16 a[44:47], v[80:83], v[44:47], a[44:47]
    v_exp_f32 v17, v117
    v_mfma_f32_16x16x32_bf16 a[92:95], v[68:71], v[40:43], a[92:95]
    v_cvt_pk_bf16_f32 v181, v18, v19
    v_mfma_f32_16x16x32_bf16 a[92:95], v[84:87], v[44:47], a[92:95]
    v_exp_f32 v18, v118
    v_mfma_f32_16x16x32_bf16 a[140:143], v[72:75], v[40:43], a[140:143]
    ds_read_b128 v[36:39], v3 offset:6144
    v_add_f32 v5, v5, v16
    v_mfma_f32_16x16x32_bf16 a[140:143], v[88:91], v[44:47], a[140:143]
    v_add_f32 v5, v5, v17
    v_mfma_f32_16x16x32_bf16 a[188:191], v[76:79], v[40:43], a[188:191]
    v_exp_f32 v19, v119
    v_mfma_f32_16x16x32_bf16 a[188:191], v[92:95], v[44:47], a[188:191]
    s_waitcnt lgkmcnt(2)
    v_cvt_pk_bf16_f32 v182, v16, v17
    v_add_f32 v5, v5, v18
    v_add_f32 v5, v5, v19
    v_cvt_pk_bf16_f32 v183, v18, v19
L_join:
    v_mfma_f32_16x16x32_bf16 v[64:67], v[24:27], a[192:195], v[128:131]
    ds_read_b128 v[40:43], v2 offset:128
    v_mfma_f32_16x16x32_bf16 v[64:67], v[28:31], a[196:199], v[64:67]
    v_exp_f32 v16, v184
    v_mfma_f32_16x16x32_bf16 v[68:71], v[24:27], a[216:219], v[132:135]
    v_exp_f32 v17, v185
    v_mfma_f32_16x16x32_bf16 v[68:71], v[28:31], a[220:223], v[68:71]
    ds_read_b128 v[60:63], v23 offset:16
    s_waitcnt vmcnt(17)
    v_mfma_f32_16x16x32_bf16 v[72:75], v[24:27], a[240:243], v[136:139]
    ds_read_b128 v[44:47], v3 offset:128
    v_cvt_f32_i32 v144, v144
    v_mfma_f32_16x16x32_bf16 v[72:75], v[28:31], a[244:247], v[72:75]
    buffer_store_dwordx4 v[224:227], v11, s[4:7], s37 offen offset:0 sc1
    v_mfma_f32_16x16x32_bf16 v[76:79], v[24:27], v[200:203], v[140:143]
    v_exp_f32 v18, v186
    v_mfma_f32_16x16x32_bf16 v[76:79], v[28:31], v[204:207], v[76:79]
    s_waitcnt lgkmcnt(3)
    v_add_f32 v6, v6, v16
    v_add_f32 v6, v6, v17
    v_mfma_f32_16x16x32_bf16 v[96:99], v[32:35], a[192:195], v[128:131]
    ds_read_b128 v[24:27], v2 offset:6272
    v_cvt_f32_i32 v148, v148
    v_mfma_f32_16x16x32_bf16 v[96:99], v[36:39], a[196:199], v[96:99]
    v_exp_f32 v19, v187
    v_mfma_f32_16x16x32_bf16 v[100:103], v[32:35], a[216:219], v[132:135]
    s_mov_b32 m0, s26
    v_cvt_pk_bf16_f32 v184, v16, v17
    v_mfma_f32_16x16x32_bf16 v[100:103], v[36:39], a[220:223], v[100:103]
    v_exp_f32 v16, v120
    v_mfma_f32_16x16x32_bf16 v[104:107], v[32:35], a[240:243], v[136:139]
    ds_read_b128 v[28:31], v3 offset:6272
    v_add_f32 v6, v6, v18
    v_mfma_f32_16x16x32_bf16 v[104:107], v[36:39], a[244:247], v[104:107]
    v_add_f32 v6, v6, v19
    v_cvt_f32_i32 v145, v145
    v_mfma_f32_16x16x32_bf16 v[108:111], v[32:35], v[200:203], v[140:143]
    v_exp_f32 v17, v121
    v_mfma_f32_16x16x32_bf16 v[108:111], v[36:39], v[204:207], v[108:111]
    s_waitcnt lgkmcnt(2)
    buffer_load_dwordx4 v8, s[4:7], s32 offen offset:0 sc1 lds
    v_mfma_f32_16x16x32_bf16 v[64:67], v[40:43], a[200:203], v[64:67]
    ds_read_b128 v[32:35], v2 offset:256
    v_cvt_pk_bf16_f32 v185, v18, v19
    v_mfma_f32_16x16x32_bf16 v[64:67], v[44:47], a[204:207], v[64:67]
    v_exp_f32 v18, v122
    v_mfma_f32_16x16x32_bf16 v[68:71], v[40:43], a[224:227], v[68:71]
    ds_read_b128 v[48:51], v23 offset:32
    v_add_f32 v6, v6, v16
    v_mfma_f32_16x16x32_bf16 v[68:71], v[44:47], a[228:231], v[68:71]
    v_add_f32 v6, v6, v17
    v_cvt_f32_i32 v149, v149
    v_mfma_f32_16x16x32_bf16 v[72:75], v[40:43], a[248:251], v[72:75]
    ds_read_b128 v[36:39], v3 offset:256
    v_fma_f32 v144, v144, v56, v58
    v_mfma_f32_16x16x32_bf16 v[72:75], v[44:47], a[252:255], v[72:75]
    buffer_store_dwordx4 v[228:231], v54, s[4:7], s37 offen offset:768 sc1
    v_mfma_f32_16x16x32_bf16 v[76:79], v[40:43], v[208:211], v[76:79]
    v_exp_f32 v19, v123
    v_mfma_f32_16x16x32_bf16 v[76:79], v[44:47], v[212:215], v[76:79]
    s_waitcnt lgkmcnt(3)
    v_cvt_pk_bf16_f32 v186, v16, v17
    v_fma_f32 v148, v148, v57, v59
    v_mfma_f32_16x16x32_bf16 v[96:99], v[24:27], a[200:203], v[96:99]
    ds_read_b128 v[40:43], v2 offset:6400
    v_mfma_f32_16x16x32_bf16 v[96:99], v[28:31], a[204:207], v[96:99]
    buffer_load_dwordx4 v8, s[4:7], s32 offen offset:1024 sc1 lds
    v_mfma_f32_16x16x32_bf16 v[100:103], v[24:27], a[224:227], v[100:103]
    v_exp_f32 v16, v188
    v_mfma_f32_16x16x32_bf16 v[100:103], v[28:31], a[228:231], v[100:103]
    v_add_f32 v6, v6, v18
    v_add_f32 v6, v6, v19
    v_mfma_f32_16x16x32_bf16 v[104:107], v[24:27], a[248:251], v[104:107]
    ds_read_b128 v[44:47], v3 offset:6400
    v_fma_f32 v145, v145, v56, v58
    v_mfma_f32_16x16x32_bf16 v[104:107], v[28:31], a[252:255], v[104:107]
    v_exp_f32 v17, v189
    v_mfma_f32_16x16x32_bf16 v[108:111], v[24:27], v[208:211], v[108:111]
    s_add_u32 s29, s30, 49152
    v_cvt_pk_bf16_f32 v187, v18, v19
    v_fma_f32 v149, v149, v57, v59
    v_mfma_f32_16x16x32_bf16 v[108:111], v[28:31], v[212:215], v[108:111]
    s_waitcnt lgkmcnt(2)
    v_exp_f32 v18, v190
    v_mfma_f32_16x16x32_bf16 v[64:67], v[32:35], a[208:211], v[64:67]
    s_sub_u32 s3, s29, 147456
    ds_read_b128 v[24:27], v2 offset:12288
    v_add_f32 v7, v7, v16
    v_mfma_f32_16x16x32_bf16 v[64:67], v[36:39], a[212:215], v[64:67]
    v_add_f32 v7, v7, v17
    v_cvt_f32_i32 v146, v146
    v_mfma_f32_16x16x32_bf16 v[68:71], v[32:35], a[232:235], v[68:71]
    v_exp_f32 v19, v191
    v_mfma_f32_16x16x32_bf16 v[68:71], v[36:39], a[236:239], v[68:71]
    v_cvt_pk_bf16_f32 v188, v16, v17
    v_mfma_f32_16x16x32_bf16 v[72:75], v[32:35], v[192:195], v[72:75]
    ds_read_b128 v[28:31], v3 offset:12288
    v_cvt_f32_i32 v150, v150
    v_mfma_f32_16x16x32_bf16 v[72:75], v[36:39], v[196:199], v[72:75]
    buffer_store_dwordx4 v[232:235], v11, s[4:7], s80 offen offset:0 sc1
    v_mfma_f32_16x16x32_bf16 v[76:79], v[32:35], v[216:219], v[76:79]
    s_min_u32 s29, s29, s3
    v_exp_f32 v16, v124
    v_mfma_f32_16x16x32_bf16 v[76:79], v[36:39], v[220:223], v[76:79]
    s_waitcnt lgkmcnt(2)
    v_add_f32 v7, v7, v18
    v_add_f32 v7, v7, v19
    v_mfma_f32_16x16x32_bf16 v[96:99], v[40:43], a[208:211], v[96:99]
    ds_read_b128 v[32:35], v2 offset:18432
    v_cvt_f32_i32 v147, v147
    v_mfma_f32_16x16x32_bf16 v[96:99], v[44:47], a[212:215], v[96:99]
    buffer_load_dwordx4 v8, s[4:7], s32 offen offset:2048 sc1 lds
    v_mfma_f32_16x16x32_bf16 v[100:103], v[40:43], a[232:235], v[100:103]
    v_exp_f32 v17, v125
    v_mfma_f32_16x16x32_bf16 v[100:103], v[44:47], a[236:239], v[100:103]
    s_add_u32 s32, s32, 24576
    v_cvt_pk_bf16_f32 v189, v18, v19
    v_cvt_f32_i32 v151, v151
    v_mfma_f32_16x16x32_bf16 v[104:107], v[40:43], v[192:195], v[104:107]
    s_sub_u32 s3, s29, s30
    ds_read_b128 v[36:39], v3 offset:18432
    v_mfma_f32_16x16x32_bf16 v[104:107], v[44:47], v[196:199], v[104:107]
    v_exp_f32 v18, v126
    v_mfma_f32_16x16x32_bf16 v[108:111], v[40:43], v[216:219], v[108:111]
    v_add_f32 v7, v7, v16
    v_add_f32 v7, v7, v17
    v_mfma_f32_16x16x32_bf16 v[108:111], v[44:47], v[220:223], v[108:111]
    s_waitcnt lgkmcnt(2)
    v_exp_f32 v19, v127
    v_mfma_f32_16x16x32_bf16 v[80:83], v[24:27], a[192:195], v[128:131]
    s_add_u32 s26, s26, 12288
    ds_read_b128 v[40:43], v2 offset:12416
    v_cvt_pk_bf16_f32 v190, v16, v17
    v_mfma_f32_16x16x32_bf16 v[80:83], v[28:31], a[196:199], v[80:83]
    v_add_f32 v7, v7, v18
    v_add_f32 v7, v7, v19
    v_mfma_f32_16x16x32_bf16 v[84:87], v[24:27], a[216:219], v[132:135]
    s_mov_b32 s30, s29
    v_cvt_pk_bf16_f32 v191, v18, v19
    v_fma_f32 v146, v146, v56, v58
    v_mfma_f32_16x16x32_bf16 v[84:87], v[28:31], a[220:223], v[84:87]
    v_fma_f32 v150, v150, v57, v59
    v_mfma_f32_16x16x32_bf16 v[88:91], v[24:27], a[240:243], v[136:139]
    ds_read_b128 v[44:47], v3 offset:12416
    v_fma_f32 v147, v147, v56, v58
    v_mfma_f32_16x16x32_bf16 v[88:91], v[28:31], a[244:247], v[88:91]
    buffer_store_dwordx4 v[236:239], v54, s[4:7], s80 offen offset:768 sc1
    v_mfma_f32_16x16x32_bf16 v[92:95], v[24:27], v[200:203], v[140:143]
    s_mov_b32 m0, s26
    v_exp_f32 v16, v64
    v_mfma_f32_16x16x32_bf16 v[92:95], v[28:31], v[204:207], v[92:95]
    s_waitcnt lgkmcnt(2)
    v_exp_f32 v17, v65
    v_mfma_f32_16x16x32_bf16 v[112:115], v[32:35], a[192:195], v[128:131]
    ds_read_b128 v[24:27], v2 offset:18560
    v_fma_f32 v151, v151, v57, v59
    v_mfma_f32_16x16x32_bf16 v[112:115], v[36:39], a[196:199], v[112:115]
    v_exp_f32 v18, v66
    v_mfma_f32_16x16x32_bf16 v[116:119], v[32:35], a[216:219], v[132:135]
    v_add_f32 v4, v4, v16
    v_add_f32 v4, v4, v17
    v_mfma_f32_16x16x32_bf16 v[116:119], v[36:39], a[220:223], v[116:119]
    v_exp_f32 v19, v67
    v_mfma_f32_16x16x32_bf16 v[120:123], v[32:35], a[240:243], v[136:139]
    ds_read_b128 v[28:31], v3 offset:18560
    v_cvt_pk_bf16_f32 v64, v16, v17
    v_mfma_f32_16x16x32_bf16 v[120:123], v[36:39], a[244:247], v[120:123]
    buffer_load_dwordx4 v8, s[4:7], s32 offen offset:0 sc1 lds
    v_mfma_f32_16x16x32_bf16 v[124:127], v[32:35], v[200:203], v[140:143]
    v_exp_f32 v16, v96
    v_mfma_f32_16x16x32_bf16 v[124:127], v[36:39], v[204:207], v[124:127]
    s_waitcnt lgkmcnt(2)
    v_add_f32 v4, v4, v18
    v_add_f32 v4, v4, v19
    v_mfma_f32_16x16x32_bf16 v[80:83], v[40:43], a[200:203], v[80:83]
    ds_read_b128 v[32:35], v2 offset:12544
    v_add_u32 v1, s3, v1
    v_mfma_f32_16x16x32_bf16 v[80:83], v[44:47], a[204:207], v[80:83]
    v_exp_f32 v17, v97
    v_mfma_f32_16x16x32_bf16 v[84:87], v[40:43], a[224:227], v[84:87]
    ds_read_b128 v[56:59], v23 offset:48
    v_cvt_pk_bf16_f32 v65, v18, v19
    v_mfma_f32_16x16x32_bf16 v[84:87], v[44:47], a[228:231], v[84:87]
    s_waitcnt vmcnt(23)
    v_exp_f32 v18, v98
    v_mfma_f32_16x16x32_bf16 v[88:91], v[40:43], a[248:251], v[88:91]
    ds_read_b128 v[36:39], v3 offset:12544
    v_add_f32 v4, v4, v16
    v_mfma_f32_16x16x32_bf16 v[88:91], v[44:47], a[252:255], v[88:91]
    v_add_f32 v4, v4, v17
    v_add_u32 v21, s3, v21
    v_mfma_f32_16x16x32_bf16 v[92:95], v[40:43], v[208:211], v[92:95]
    v_exp_f32 v19, v99
    v_mfma_f32_16x16x32_bf16 v[92:95], v[44:47], v[212:215], v[92:95]
    s_waitcnt lgkmcnt(3)
    v_cvt_pk_bf16_f32 v66, v16, v17
    v_cvt_f32_i32 v152, v152
    v_mfma_f32_16x16x32_bf16 v[112:115], v[24:27], a[200:203], v[112:115]
    ds_read_b128 v[40:43], v2 offset:18688
    v_cvt_f32_i32 v156, v156
    v_mfma_f32_16x16x32_bf16 v[112:115], v[28:31], a[204:207], v[112:115]
    buffer_load_dwordx4 v8, s[4:7], s32 offen offset:1024 sc1 lds
    v_mfma_f32_16x16x32_bf16 v[116:119], v[24:27], a[224:227], v[116:119]
    v_exp_f32 v16, v68
    v_mfma_f32_16x16x32_bf16 v[116:119], v[28:31], a[228:231], v[116:119]
    v_add_f32 v4, v4, v18
    v_add_f32 v4, v4, v19
    v_mfma_f32_16x16x32_bf16 v[120:123], v[24:27], a[248:251], v[120:123]
    ds_read_b128 v[44:47], v3 offset:18688
    v_add_u32 v22, s3, v22
    v_mfma_f32_16x16x32_bf16 v[120:123], v[28:31], a[252:255], v[120:123]
    s_waitcnt lgkmcnt(2)
    v_exp_f32 v17, v69
    v_mfma_f32_16x16x32_bf16 v[124:127], v[24:27], v[208:211], v[124:127]
    s_waitcnt vmcnt(25)
    v_cvt_pk_bf16_f32 v67, v18, v19
    v_cvt_f32_i32 v153, v153
    v_mfma_f32_16x16x32_bf16 v[124:127], v[28:31], v[212:215], v[124:127]
    s_barrier
    v_add_u32 v23, 1792, v23
    v_mfma_f32_16x16x32_bf16 v[80:83], v[32:35], a[208:211], v[80:83]
    ds_read_b128 v[24:27], v1 offset:0
    v_cvt_f32_i32 v157, v157
    v_mfma_f32_16x16x32_bf16 v[80:83], v[36:39], a[212:215], v[80:83]
    v_exp_f32 v18, v70
    v_mfma_f32_16x16x32_bf16 v[84:87], v[32:35], a[232:235], v[84:87]
    v_add_f32 v5, v5, v16
    v_add_f32 v5, v5, v17
    v_mfma_f32_16x16x32_bf16 v[84:87], v[36:39], a[236:239], v[84:87]
    buffer_load_dwordx4 v8, s[4:7], s32 offen offset:2048 sc1 lds
    v_mfma_f32_16x16x32_bf16 v[88:91], v[32:35], v[192:195], v[88:91]
    ds_read_b128 v[28:31], v1 offset:12288
    v_fma_f32 v152, v152, v60, v62
    v_mfma_f32_16x16x32_bf16 v[88:91], v[36:39], v[196:199], v[88:91]
    v_exp_f32 v19, v71
    v_cvt_pk_bf16_f32 v68, v16, v17
    v_mfma_f32_16x16x32_bf16 v[92:95], v[32:35], v[216:219], v[92:95]
    v_exp_f32 v16, v100
    v_mfma_f32_16x16x32_bf16 v[92:95], v[36:39], v[220:223], v[92:95]
    s_waitcnt lgkmcnt(2)
    v_add_f32 v5, v5, v18
    v_add_f32 v5, v5, v19
    v_mfma_f32_16x16x32_bf16 v[112:115], v[40:43], a[208:211], v[112:115]
    ds_read_b128 v[32:35], v1 offset:768
    v_fma_f32 v156, v156, v61, v63
    v_mfma_f32_16x16x32_bf16 v[112:115], v[44:47], a[212:215], v[112:115]
    v_exp_f32 v17, v101
    v_mfma_f32_16x16x32_bf16 v[116:119], v[40:43], a[232:235], v[116:119]
    v_cvt_pk_bf16_f32 v69, v18, v19
    v_fma_f32 v153, v153, v60, v62
    v_mfma_f32_16x16x32_bf16 v[116:119], v[44:47], a[236:239], v[116:119]
    v_exp_f32 v18, v102
    v_mfma_f32_16x16x32_bf16 v[120:123], v[40:43], v[192:195], v[120:123]
    s_sub_u32 s31, s31, 1
    ds_read_b128 v[36:39], v1 offset:13056
    v_add_f32 v5, v5, v16
    v_mfma_f32_16x16x32_bf16 v[120:123], v[44:47], v[196:199], v[120:123]
    s_add_u32 s32, s32, 24576
    s_add_u32 s26, s26, 36864
    s_sub_u32 s57, s26, 147456
    s_min_u32 s26, s26, s57
    v_mfma_f32_16x16x32_bf16 v[124:127], v[40:43], v[216:219], v[124:127]
    s_waitcnt lgkmcnt(2)
    s_cmp_lg_u32 s31, 0
    v_add_f32 v5, v5, v17
    v_exp_f32 v19, v103
    v_cvt_pk_bf16_f32 v70, v16, v17
    v_add_f32 v5, v5, v18
    v_add_f32 v5, v5, v19
    v_cvt_pk_bf16_f32 v71, v18, v19
    v_fma_f32 v157, v157, v61, v63
    v_mfma_f32_16x16x32_bf16 v[124:127], v[44:47], v[220:223], v[124:127]
    s_cbranch_scc1 L_loop
    v_mfma_f32_16x16x32_bf16 a[0:3], v[160:163], v[24:27], a[0:3]
    ds_read_b128 v[40:43], v1 offset:1536
    v_cvt_f32_i32 v154, v154
    v_mfma_f32_16x16x32_bf16 a[0:3], v[176:179], v[28:31], a[0:3]
    buffer_load_dwordx4 v[248:251], v12, s[68:71], s36 offen offset:1536 nt
    v_mfma_f32_16x16x32_bf16 a[48:51], v[164:167], v[24:27], a[48:51]
    v_exp_f32 v16, v72
    v_mfma_f32_16x16x32_bf16 a[48:51], v[180:183], v[28:31], a[48:51]
    v_exp_f32 v17, v73
    v_mfma_f32_16x16x32_bf16 a[96:99], v[168:171], v[24:27], a[96:99]
    ds_read_b128 v[44:47], v1 offset:13824
    v_cvt_f32_i32 v158, v158
    v_mfma_f32_16x16x32_bf16 a[96:99], v[184:187], v[28:31], a[96:99]
    v_exp_f32 v18, v74
    v_mfma_f32_16x16x32_bf16 a[144:147], v[172:175], v[24:27], a[144:147]
    v_add_f32 v6, v6, v16
    v_add_f32 v6, v6, v17
    v_mfma_f32_16x16x32_bf16 a[144:147], v[188:191], v[28:31], a[144:147]
    s_waitcnt lgkmcnt(2)
    buffer_load_dwordx4 v[252:255], v12, s[68:71], s36 offen offset:2304 nt
    v_mfma_f32_16x16x32_bf16 a[4:7], v[160:163], v[32:35], a[4:7]
    ds_read_b128 v[24:27], v1 offset:2304
    v_cvt_f32_i32 v155, v155
    v_mfma_f32_16x16x32_bf16 a[4:7], v[176:179], v[36:39], a[4:7]
    v_exp_f32 v19, v75
    v_mfma_f32_16x16x32_bf16 a[52:55], v[164:167], v[32:35], a[52:55]
    v_cvt_pk_bf16_f32 v72, v16, v17
    v_cvt_f32_i32 v159, v159
    v_mfma_f32_16x16x32_bf16 a[52:55], v[180:183], v[36:39], a[52:55]
    v_exp_f32 v16, v104
    v_mfma_f32_16x16x32_bf16 a[100:103], v[168:171], v[32:35], a[100:103]
    ds_read_b128 v[28:31], v1 offset:14592
    v_add_f32 v6, v6, v18
    v_mfma_f32_16x16x32_bf16 a[100:103], v[184:187], v[36:39], a[100:103]
    v_add_f32 v6, v6, v19
    v_fma_f32 v154, v154, v60, v62
    v_mfma_f32_16x16x32_bf16 a[148:151], v[172:175], v[32:35], a[148:151]
    v_exp_f32 v17, v105
    v_mfma_f32_16x16x32_bf16 a[148:151], v[188:191], v[36:39], a[148:151]
    s_waitcnt lgkmcnt(2)
    v_cvt_pk_bf16_f32 v73, v18, v19
    v_fma_f32 v158, v158, v61, v63
    s_branch L_skip11
L_pad11:
    s_branch L_tb1_3
L_skip11:
    v_mfma_f32_16x16x32_bf16 a[8:11], v[160:163], v[40:43], a[8:11]
    ds_read_b128 v[32:35], v21 offset:0
    v_mfma_f32_16x16x32_bf16 a[8:11], v[176:179], v[44:47], a[8:11]
    v_exp_f32 v18, v106
    v_mfma_f32_16x16x32_bf16 a[56:59], v[164:167], v[40:43], a[56:59]
    v_add_f32 v6, v6, v16
    v_add_f32 v6, v6, v17
    v_mfma_f32_16x16x32_bf16 a[56:59], v[180:183], v[44:47], a[56:59]
    v_exp_f32 v19, v107
    v_mfma_f32_16x16x32_bf16 a[104:107], v[168:171], v[40:43], a[104:107]
    s_mov_b32 m0, s56
    ds_read_b128 v[36:39], v21 offset:12288
    v_cvt_pk_bf16_f32 v74, v16, v17
    v_mfma_f32_16x16x32_bf16 a[104:107], v[184:187], v[44:47], a[104:107]
    v_exp_f32 v16, v76
    v_mfma_f32_16x16x32_bf16 a[152:155], v[172:175], v[40:43], a[152:155]
    v_fma_f32 v155, v155, v60, v62
    v_fma_f32 v159, v159, v61, v63
    v_mfma_f32_16x16x32_bf16 a[152:155], v[188:191], v[44:47], a[152:155]
    s_waitcnt lgkmcnt(2)
    buffer_load_dwordx4 v8, s[4:7], s27 offen offset:0 sc1 lds
    v_mfma_f32_16x16x32_bf16 a[12:15], v[160:163], v[24:27], a[12:15]
    ds_read_b128 v[40:43], v21 offset:768
    v_add_f32 v6, v6, v18
    v_mfma_f32_16x16x32_bf16 a[12:15], v[176:179], v[28:31], a[12:15]
    v_add_f32 v6, v6, v19
    v_cvt_pk_bf16_f32 v144, v144, v148
    v_mfma_f32_16x16x32_bf16 a[60:63], v[164:167], v[24:27], a[60:63]
    v_exp_f32 v17, v77
    v_mfma_f32_16x16x32_bf16 a[60:63], v[180:183], v[28:31], a[60:63]
    v_cvt_pk_bf16_f32 v75, v18, v19
    v_mfma_f32_16x16x32_bf16 a[108:111], v[168:171], v[24:27], a[108:111]
    ds_read_b128 v[44:47], v21 offset:13056
    v_cvt_pk_bf16_f32 v148, v145, v149
    v_mfma_f32_16x16x32_bf16 a[108:111], v[184:187], v[28:31], a[108:111]
    v_exp_f32 v18, v78
    v_mfma_f32_16x16x32_bf16 a[156:159], v[172:175], v[24:27], a[156:159]
    s_add_u32 s29, s28, 49152
    v_add_f32 v7, v7, v16
    v_add_f32 v7, v7, v17
    v_mfma_f32_16x16x32_bf16 a[156:159], v[188:191], v[28:31], a[156:159]
    s_waitcnt lgkmcnt(2)
    buffer_load_dwordx4 v8, s[4:7], s27 offen offset:1024 sc1 lds
    v_mfma_f32_16x16x32_bf16 a[16:19], v[160:163], v[32:35], a[16:19]
    ds_read_b128 v[24:27], v21 offset:1536
    v_cvt_pk_bf16_f32 v145, v152, v156
    v_mfma_f32_16x16x32_bf16 a[16:19], v[176:179], v[36:39], a[16:19]
    s_sub_u32 s3, s29, 147456
    v_exp_f32 v19, v79
    v_mfma_f32_16x16x32_bf16 a[64:67], v[164:167], v[32:35], a[64:67]
    v_cvt_pk_bf16_f32 v76, v16, v17
    v_cvt_pk_bf16_f32 v149, v153, v157
    v_mfma_f32_16x16x32_bf16 a[64:67], v[180:183], v[36:39], a[64:67]
    v_exp_f32 v16, v108
    v_mfma_f32_16x16x32_bf16 a[112:115], v[168:171], v[32:35], a[112:115]
    ds_read_b128 v[28:31], v21 offset:13824
    v_add_f32 v7, v7, v18
    v_mfma_f32_16x16x32_bf16 a[112:115], v[184:187], v[36:39], a[112:115]
    buffer_load_dwordx4 v8, s[4:7], s27 offen offset:2048 sc1 lds
    v_mfma_f32_16x16x32_bf16 a[160:163], v[172:175], v[32:35], a[160:163]
    v_add_f32 v7, v7, v19
    v_cvt_pk_bf16_f32 v152, v146, v150
    v_mfma_f32_16x16x32_bf16 a[160:163], v[188:191], v[36:39], a[160:163]
    s_waitcnt lgkmcnt(2)
    v_exp_f32 v17, v109
    v_mfma_f32_16x16x32_bf16 a[20:23], v[160:163], v[40:43], a[20:23]
    s_min_u32 s29, s29, s3
    ds_read_b128 v[32:35], v21 offset:2304
    v_cvt_pk_bf16_f32 v77, v18, v19
    v_mfma_f32_16x16x32_bf16 a[20:23], v[176:179], v[44:47], a[20:23]
    v_exp_f32 v18, v110
    v_mfma_f32_16x16x32_bf16 a[68:71], v[164:167], v[40:43], a[68:71]
    s_add_u32 s27, s27, 24576
    v_add_f32 v7, v7, v16
    v_add_f32 v7, v7, v17
    v_mfma_f32_16x16x32_bf16 a[68:71], v[180:183], v[44:47], a[68:71]
    v_exp_f32 v19, v111
    v_mfma_f32_16x16x32_bf16 a[116:119], v[168:171], v[40:43], a[116:119]
    ds_read_b128 v[36:39], v21 offset:14592
    v_cvt_pk_bf16_f32 v153, v154, v158
    v_mfma_f32_16x16x32_bf16 a[116:119], v[184:187], v[44:47], a[116:119]
    s_add_u32 s56, s56, 12288
    v_cvt_pk_bf16_f32 v78, v16, v17
    v_cvt_pk_bf16_f32 v156, v147, v151
    v_mfma_f32_16x16x32_bf16 a[164:167], v[172:175], v[40:43], a[164:167]
    s_sub_u32 s3, s29, s28
    v_exp_f32 v16, v80
    v_mfma_f32_16x16x32_bf16 a[164:167], v[188:191], v[44:47], a[164:167]
    s_waitcnt lgkmcnt(2)
    v_add_f32 v7, v7, v18
    v_add_f32 v7, v7, v19
    v_mfma_f32_16x16x32_bf16 a[24:27], v[160:163], v[24:27], a[24:27]
    ds_read_b128 v[40:43], v22 offset:0
    v_cvt_pk_bf16_f32 v157, v155, v159
    v_mfma_f32_16x16x32_bf16 a[24:27], v[176:179], v[28:31], a[24:27]
    s_mov_b32 m0, s56
    v_exp_f32 v17, v81
    v_mfma_f32_16x16x32_bf16 a[72:75], v[164:167], v[24:27], a[72:75]
    v_cvt_pk_bf16_f32 v79, v18, v19
    v_mfma_f32_16x16x32_bf16 a[72:75], v[180:183], v[28:31], a[72:75]
    s_waitcnt vmcnt(15)
    v_exp_f32 v18, v82
    v_mfma_f32_16x16x32_bf16 a[120:123], v[168:171], v[24:27], a[120:123]
    ds_read_b128 v[44:47], v22 offset:12288
    v_add_f32 v4, v4, v16
    v_mfma_f32_16x16x32_bf16 a[120:123], v[184:187], v[28:31], a[120:123]
    s_mov_b32 s28, s29
    v_add_f32 v4, v4, v17
    v_mfma_f32_16x16x32_bf16 a[168:171], v[172:175], v[24:27], a[168:171]
    v_exp_f32 v19, v83
    v_mfma_f32_16x16x32_bf16 a[168:171], v[188:191], v[28:31], a[168:171]
    s_waitcnt lgkmcnt(2)
    buffer_load_dwordx4 v8, s[4:7], s27 offen offset:0 sc1 lds
    v_mfma_f32_16x16x32_bf16 a[28:31], v[160:163], v[32:35], a[28:31]
    ds_read_b128 v[24:27], v22 offset:768
    v_cvt_pk_bf16_f32 v80, v16, v17
    v_mfma_f32_16x16x32_bf16 a[28:31], v[176:179], v[36:39], a[28:31]
    v_exp_f32 v16, v112
    v_mfma_f32_16x16x32_bf16 a[76:79], v[164:167], v[32:35], a[76:79]
    v_cvt_f32_i32 v240, v240
    v_add_f32 v4, v4, v18
    v_mfma_f32_16x16x32_bf16 a[76:79], v[180:183], v[36:39], a[76:79]
    v_cvt_f32_i32 v244, v244
    v_add_f32 v4, v4, v19
    v_mfma_f32_16x16x32_bf16 a[124:127], v[168:171], v[32:35], a[124:127]
    ds_read_b128 v[28:31], v22 offset:13056
    v_add_u32 v2, s3, v2
    v_mfma_f32_16x16x32_bf16 a[124:127], v[184:187], v[36:39], a[124:127]
    buffer_load_dwordx4 v8, s[4:7], s27 offen offset:1024 sc1 lds
    v_mfma_f32_16x16x32_bf16 a[172:175], v[172:175], v[32:35], a[172:175]
    v_exp_f32 v17, v113
    v_mfma_f32_16x16x32_bf16 a[172:175], v[188:191], v[36:39], a[172:175]
    s_waitcnt lgkmcnt(2)
    v_cvt_pk_bf16_f32 v81, v18, v19
    v_cvt_f32_i32 v241, v241
    v_mfma_f32_16x16x32_bf16 a[32:35], v[160:163], v[40:43], a[32:35]
    ds_read_b128 v[32:35], v22 offset:1536
    v_cvt_f32_i32 v245, v245
    v_mfma_f32_16x16x32_bf16 a[32:35], v[176:179], v[44:47], a[32:35]
    v_exp_f32 v18, v114
    v_mfma_f32_16x16x32_bf16 a[80:83], v[164:167], v[40:43], a[80:83]
    v_add_f32 v4, v4, v16
    v_add_f32 v4, v4, v17
    v_mfma_f32_16x16x32_bf16 a[80:83], v[180:183], v[44:47], a[80:83]
    v_exp_f32 v19, v115
    v_mfma_f32_16x16x32_bf16 a[128:131], v[168:171], v[40:43], a[128:131]
    ds_read_b128 v[36:39], v22 offset:13824
    v_cvt_pk_bf16_f32 v82, v16, v17
    v_mfma_f32_16x16x32_bf16 a[128:131], v[184:187], v[44:47], a[128:131]
    buffer_load_dwordx4 v8, s[4:7], s27 offen offset:2048 sc1 lds
    v_mfma_f32_16x16x32_bf16 a[176:179], v[172:175], v[40:43], a[176:179]
    v_exp_f32 v16, v84
    v_mfma_f32_16x16x32_bf16 a[176:179], v[188:191], v[44:47], a[176:179]
    s_waitcnt lgkmcnt(2)
    v_add_f32 v4, v4, v18
    v_fma_f32 v240, v240, v48, v50
    v_mfma_f32_16x16x32_bf16 a[36:39], v[160:163], v[24:27], a[36:39]
    ds_read_b128 v[40:43], v22 offset:2304
    v_add_f32 v4, v4, v19
    v_mfma_f32_16x16x32_bf16 a[36:39], v[176:179], v[28:31], a[36:39]
    v_exp_f32 v17, v85
    v_mfma_f32_16x16x32_bf16 a[84:87], v[164:167], v[24:27], a[84:87]
    v_add_u32 v3, s3, v3
    v_fma_f32 v244, v244, v49, v51
    v_mfma_f32_16x16x32_bf16 a[84:87], v[180:183], v[28:31], a[84:87]
    s_add_u32 s27, s27, 24576
    v_cvt_pk_bf16_f32 v83, v18, v19
    v_fma_f32 v241, v241, v48, v50
    v_mfma_f32_16x16x32_bf16 a[132:135], v[168:171], v[24:27], a[132:135]
    s_add_u32 s56, s56, 36864
    ds_read_b128 v[44:47], v22 offset:14592
    v_mfma_f32_16x16x32_bf16 a[132:135], v[184:187], v[28:31], a[132:135]
    s_waitcnt lgkmcnt(2)
    v_exp_f32 v18, v86
    v_mfma_f32_16x16x32_bf16 a[180:183], v[172:175], v[24:27], a[180:183]
    s_waitcnt vmcnt(11)
    v_add_f32 v5, v5, v16
    v_add_f32 v5, v5, v17
    v_mfma_f32_16x16x32_bf16 a[180:183], v[188:191], v[28:31], a[180:183]
    s_barrier
    v_fma_f32 v245, v245, v49, v51
    v_mfma_f32_16x16x32_bf16 a[40:43], v[160:163], v[32:35], a[40:43]
    s_sub_u32 s58, s56, 147456
    ds_read_b128 v[24:27], v2 offset:0
    v_add_u32 v55, 1, v55
    v_mfma_f32_16x16x32_bf16 a[40:43], v[176:179], v[36:39], a[40:43]
    v_exp_f32 v19, v87
    v_mfma_f32_16x16x32_bf16 a[88:91], v[164:167], v[32:35], a[88:91]
    s_min_u32 s56, s56, s58
    v_cvt_pk_bf16_f32 v84, v16, v17
    v_cvt_f32_i32 v242, v242
    v_mfma_f32_16x16x32_bf16 a[88:91], v[180:183], v[36:39], a[88:91]
    v_exp_f32 v16, v116
    v_mfma_f32_16x16x32_bf16 a[136:139], v[168:171], v[32:35], a[136:139]
    ds_read_b128 v[28:31], v3 offset:0
    v_add_f32 v5, v5, v18
    v_mfma_f32_16x16x32_bf16 a[136:139], v[184:187], v[36:39], a[136:139]
    buffer_store_dword v55, v13, s[20:23], 0 offen sc1
    v_mfma_f32_16x16x32_bf16 a[184:187], v[172:175], v[32:35], a[184:187]
    v_add_f32 v5, v5, v19
    v_cvt_f32_i32 v246, v246
    v_mfma_f32_16x16x32_bf16 a[184:187], v[188:191], v[36:39], a[184:187]
    s_waitcnt lgkmcnt(2)
    v_exp_f32 v17, v117
    v_mfma_f32_16x16x32_bf16 a[44:47], v[160:163], v[40:43], a[44:47]
    ds_read_b128 v[32:35], v2 offset:6144
    v_cvt_pk_bf16_f32 v85, v18, v19
    v_mfma_f32_16x16x32_bf16 a[44:47], v[176:179], v[44:47], a[44:47]
    v_exp_f32 v18, v118
    v_mfma_f32_16x16x32_bf16 a[92:95], v[164:167], v[40:43], a[92:95]
    v_add_f32 v5, v5, v16
    v_add_f32 v5, v5, v17
    v_mfma_f32_16x16x32_bf16 a[92:95], v[180:183], v[44:47], a[92:95]
    v_exp_f32 v19, v119
    v_mfma_f32_16x16x32_bf16 a[140:143], v[168:171], v[40:43], a[140:143]
    ds_read_b128 v[36:39], v3 offset:6144
    v_cvt_f32_i32 v243, v243
    v_mfma_f32_16x16x32_bf16 a[140:143], v[184:187], v[44:47], a[140:143]
    v_cvt_pk_bf16_f32 v86, v16, v17
    v_add_f32 v5, v5, v18
    v_mfma_f32_16x16x32_bf16 a[188:191], v[172:175], v[40:43], a[188:191]
    v_add_f32 v5, v5, v19
    v_cvt_f32_i32 v247, v247
    v_mfma_f32_16x16x32_bf16 a[188:191], v[188:191], v[44:47], a[188:191]
    s_waitcnt lgkmcnt(2)
    v_cvt_pk_bf16_f32 v87, v18, v19
    v_mfma_f32_16x16x32_bf16 v[160:163], v[24:27], a[192:195], v[128:131]
    s_mov_b32 m0, s26
    ds_read_b128 v[40:43], v2 offset:128
    v_fma_f32 v242, v242, v48, v50
    v_mfma_f32_16x16x32_bf16 v[160:163], v[28:31], a[196:199], v[160:163]
    v_exp_f32 v16, v88
    v_mfma_f32_16x16x32_bf16 v[164:167], v[24:27], a[216:219], v[132:135]
    v_exp_f32 v17, v89
    v_mfma_f32_16x16x32_bf16 v[164:167], v[28:31], a[220:223], v[164:167]
    v_exp_f32 v18, v90
    v_mfma_f32_16x16x32_bf16 v[168:171], v[24:27], a[240:243], v[136:139]
    ds_read_b128 v[44:47], v3 offset:128
    v_fma_f32 v246, v246, v49, v51
    v_mfma_f32_16x16x32_bf16 v[168:171], v[28:31], a[244:247], v[168:171]
    buffer_load_dwordx4 v8, s[4:7], s32 offen offset:0 sc1 lds
    v_mfma_f32_16x16x32_bf16 v[172:175], v[24:27], v[200:203], v[140:143]
    v_add_f32 v6, v6, v16
    v_add_f32 v6, v6, v17
    v_mfma_f32_16x16x32_bf16 v[172:175], v[28:31], v[204:207], v[172:175]
    s_waitcnt lgkmcnt(2)
    v_exp_f32 v19, v91
    v_mfma_f32_16x16x32_bf16 v[96:99], v[32:35], a[192:195], v[128:131]
    ds_read_b128 v[24:27], v2 offset:6272
    v_fma_f32 v243, v243, v48, v50
    v_mfma_f32_16x16x32_bf16 v[96:99], v[36:39], a[196:199], v[96:99]
    v_cvt_pk_bf16_f32 v88, v16, v17
    v_fma_f32 v247, v247, v49, v51
    v_mfma_f32_16x16x32_bf16 v[100:103], v[32:35], a[216:219], v[132:135]
    v_exp_f32 v16, v120
    v_mfma_f32_16x16x32_bf16 v[100:103], v[36:39], a[220:223], v[100:103]
    v_add_f32 v6, v6, v18
    v_cvt_pk_bf16_f32 v146, v240, v244
    v_mfma_f32_16x16x32_bf16 v[104:107], v[32:35], a[240:243], v[136:139]
    ds_read_b128 v[28:31], v3 offset:6272
    v_add_f32 v6, v6, v19
    v_mfma_f32_16x16x32_bf16 v[104:107], v[36:39], a[244:247], v[104:107]
    buffer_load_dwordx4 v8, s[4:7], s32 offen offset:1024 sc1 lds
    v_mfma_f32_16x16x32_bf16 v[108:111], v[32:35], v[200:203], v[140:143]
    v_exp_f32 v17, v121
    v_mfma_f32_16x16x32_bf16 v[108:111], v[36:39], v[204:207], v[108:111]
    s_waitcnt lgkmcnt(2)
    v_cvt_pk_bf16_f32 v89, v18, v19
    v_cvt_pk_bf16_f32 v150, v241, v245
    v_mfma_f32_16x16x32_bf16 v[160:163], v[40:43], a[200:203], v[160:163]
    ds_read_b128 v[32:35], v2 offset:256
    v_mfma_f32_16x16x32_bf16 v[160:163], v[44:47], a[204:207], v[160:163]
    v_exp_f32 v18, v122
    v_mfma_f32_16x16x32_bf16 v[164:167], v[40:43], a[224:227], v[164:167]
    v_add_f32 v6, v6, v16
    v_add_f32 v6, v6, v17
    v_mfma_f32_16x16x32_bf16 v[164:167], v[44:47], a[228:231], v[164:167]
    v_cvt_pk_bf16_f32 v154, v242, v246
    v_mfma_f32_16x16x32_bf16 v[168:171], v[40:43], a[248:251], v[168:171]
    ds_read_b128 v[36:39], v3 offset:256
    v_mfma_f32_16x16x32_bf16 v[168:171], v[44:47], a[252:255], v[168:171]
    v_exp_f32 v19, v123
    v_mfma_f32_16x16x32_bf16 v[172:175], v[40:43], v[208:211], v[172:175]
    v_cvt_pk_bf16_f32 v90, v16, v17
    v_cvt_pk_bf16_f32 v158, v243, v247
    v_mfma_f32_16x16x32_bf16 v[172:175], v[44:47], v[212:215], v[172:175]
    s_waitcnt lgkmcnt(2)
    buffer_load_dwordx4 v8, s[4:7], s32 offen offset:2048 sc1 lds
    v_mfma_f32_16x16x32_bf16 v[96:99], v[24:27], a[200:203], v[96:99]
    s_waitcnt vmcnt(10)
    ds_read_b128 v[40:43], v2 offset:6400
    v_mfma_f32_16x16x32_bf16 v[96:99], v[28:31], a[204:207], v[96:99]
    v_exp_f32 v16, v92
    v_mfma_f32_16x16x32_bf16 v[100:103], v[24:27], a[224:227], v[100:103]
    v_add_f32 v6, v6, v18
    v_add_f32 v6, v6, v19
    v_mfma_f32_16x16x32_bf16 v[100:103], v[28:31], a[228:231], v[100:103]
    v_exp_f32 v17, v93
    v_mfma_f32_16x16x32_bf16 v[104:107], v[24:27], a[248:251], v[104:107]
    ds_read_b128 v[44:47], v3 offset:6400
    v_cvt_pk_bf16_f32 v91, v18, v19
    v_mfma_f32_16x16x32_bf16 v[104:107], v[28:31], a[252:255], v[104:107]
    s_add_u32 s32, s32, 24576
    v_exp_f32 v18, v94
    v_mfma_f32_16x16x32_bf16 v[108:111], v[24:27], v[208:211], v[108:111]
    s_add_u32 s29, s30, 49152
    v_cvt_f32_i32 v248, v248
    v_add_f32 v7, v7, v16
    v_mfma_f32_16x16x32_bf16 v[108:111], v[28:31], v[212:215], v[108:111]
    s_waitcnt lgkmcnt(2)
    v_add_f32 v7, v7, v17
    v_cvt_f32_i32 v252, v252
    v_mfma_f32_16x16x32_bf16 v[160:163], v[32:35], a[208:211], v[160:163]
    s_sub_u32 s3, s29, 147456
    ds_read_b128 v[24:27], v2 offset:12288
    v_mfma_f32_16x16x32_bf16 v[160:163], v[36:39], a[212:215], v[160:163]
    v_exp_f32 v19, v95
    v_mfma_f32_16x16x32_bf16 v[164:167], v[32:35], a[232:235], v[164:167]
    s_add_u32 s26, s26, 12288
    v_cvt_pk_bf16_f32 v92, v16, v17
    v_cvt_f32_i32 v249, v249
    v_mfma_f32_16x16x32_bf16 v[164:167], v[36:39], a[236:239], v[164:167]
    v_exp_f32 v16, v124
    v_mfma_f32_16x16x32_bf16 v[168:171], v[32:35], v[192:195], v[168:171]
    ds_read_b128 v[28:31], v3 offset:12288
    v_add_f32 v7, v7, v18
    v_mfma_f32_16x16x32_bf16 v[168:171], v[36:39], v[196:199], v[168:171]
    v_add_f32 v7, v7, v19
    v_mfma_f32_16x16x32_bf16 v[172:175], v[32:35], v[216:219], v[172:175]
    s_min_u32 s29, s29, s3
    v_cvt_f32_i32 v253, v253
    s_mov_b32 m0, s26
    v_mfma_f32_16x16x32_bf16 v[172:175], v[36:39], v[220:223], v[172:175]
    s_waitcnt lgkmcnt(2)
    v_exp_f32 v17, v125
    v_mfma_f32_16x16x32_bf16 v[96:99], v[40:43], a[208:211], v[96:99]
    ds_read_b128 v[32:35], v2 offset:18432
    v_cvt_pk_bf16_f32 v93, v18, v19
    v_mfma_f32_16x16x32_bf16 v[96:99], v[44:47], a[212:215], v[96:99]
    v_exp_f32 v18, v126
    v_mfma_f32_16x16x32_bf16 v[100:103], v[40:43], a[232:235], v[100:103]
    v_fma_f32 v248, v248, v56, v58
    v_mfma_f32_16x16x32_bf16 v[100:103], v[44:47], a[236:239], v[100:103]
    v_add_f32 v7, v7, v16
    v_mfma_f32_16x16x32_bf16 v[104:107], v[40:43], v[192:195], v[104:107]
    s_sub_u32 s3, s29, s30
    ds_read_b128 v[36:39], v3 offset:18432
    v_add_f32 v7, v7, v17
    v_mfma_f32_16x16x32_bf16 v[104:107], v[44:47], v[196:199], v[104:107]
    buffer_load_dwordx4 v8, s[4:7], s32 offen offset:0 sc1 lds
    v_mfma_f32_16x16x32_bf16 v[108:111], v[40:43], v[216:219], v[108:111]
    v_exp_f32 v19, v127
    v_mfma_f32_16x16x32_bf16 v[108:111], v[44:47], v[220:223], v[108:111]
    s_waitcnt lgkmcnt(2)
    v_cvt_pk_bf16_f32 v94, v16, v17
    v_fma_f32 v252, v252, v57, v59
    v_mfma_f32_16x16x32_bf16 v[176:179], v[24:27], a[192:195], v[128:131]
    ds_read_b128 v[40:43], v2 offset:12416
    v_add_f32 v7, v7, v18
    v_mfma_f32_16x16x32_bf16 v[176:179], v[28:31], a[196:199], v[176:179]
    v_add_f32 v7, v7, v19
    v_fma_f32 v249, v249, v56, v58
    v_mfma_f32_16x16x32_bf16 v[180:183], v[24:27], a[216:219], v[132:135]
    s_mov_b32 s30, s29
    v_cvt_pk_bf16_f32 v95, v18, v19
    v_mfma_f32_16x16x32_bf16 v[180:183], v[28:31], a[220:223], v[180:183]
    v_fma_f32 v253, v253, v57, v59
    v_mfma_f32_16x16x32_bf16 v[184:187], v[24:27], a[240:243], v[136:139]
    ds_read_b128 v[44:47], v3 offset:12416
    v_mfma_f32_16x16x32_bf16 v[184:187], v[28:31], a[244:247], v[184:187]
    v_exp_f32 v16, v160
    v_mfma_f32_16x16x32_bf16 v[188:191], v[24:27], v[200:203], v[140:143]
    v_exp_f32 v17, v161
    v_mfma_f32_16x16x32_bf16 v[188:191], v[28:31], v[204:207], v[188:191]
    s_waitcnt lgkmcnt(2)
    buffer_load_dwordx4 v8, s[4:7], s32 offen offset:1024 sc1 lds
    v_mfma_f32_16x16x32_bf16 v[112:115], v[32:35], a[192:195], v[128:131]
    ds_read_b128 v[24:27], v2 offset:18560
    v_cvt_f32_i32 v250, v250
    v_mfma_f32_16x16x32_bf16 v[112:115], v[36:39], a[196:199], v[112:115]
    v_exp_f32 v18, v162
    v_mfma_f32_16x16x32_bf16 v[116:119], v[32:35], a[216:219], v[132:135]
    v_add_f32 v4, v4, v16
    v_add_f32 v4, v4, v17
    v_mfma_f32_16x16x32_bf16 v[116:119], v[36:39], a[220:223], v[116:119]
    v_exp_f32 v19, v163
    v_mfma_f32_16x16x32_bf16 v[120:123], v[32:35], a[240:243], v[136:139]
    ds_read_b128 v[28:31], v3 offset:18560
    v_cvt_pk_bf16_f32 v160, v16, v17
    v_mfma_f32_16x16x32_bf16 v[120:123], v[36:39], a[244:247], v[120:123]
    v_exp_f32 v16, v96
    v_mfma_f32_16x16x32_bf16 v[124:127], v[32:35], v[200:203], v[140:143]
    v_cvt_f32_i32 v254, v254
    v_add_f32 v4, v4, v18
    v_mfma_f32_16x16x32_bf16 v[124:127], v[36:39], v[204:207], v[124:127]
    s_waitcnt lgkmcnt(2)
    buffer_load_dwordx4 v8, s[4:7], s32 offen offset:2048 sc1 lds
    v_mfma_f32_16x16x32_bf16 v[176:179], v[40:43], a[200:203], v[176:179]
    ds_read_b128 v[32:35], v2 offset:12544
    v_add_f32 v4, v4, v19
    v_mfma_f32_16x16x32_bf16 v[176:179], v[44:47], a[204:207], v[176:179]
    v_exp_f32 v17, v97
    v_mfma_f32_16x16x32_bf16 v[180:183], v[40:43], a[224:227], v[180:183]
    v_add_u32 v1, s3, v1
    v_cvt_pk_bf16_f32 v161, v18, v19
    v_mfma_f32_16x16x32_bf16 v[180:183], v[44:47], a[228:231], v[180:183]
    v_exp_f32 v18, v98
    v_mfma_f32_16x16x32_bf16 v[184:187], v[40:43], a[248:251], v[184:187]
    ds_read_b128 v[36:39], v3 offset:12544
    v_cvt_f32_i32 v251, v251
    v_mfma_f32_16x16x32_bf16 v[184:187], v[44:47], a[252:255], v[184:187]
    v_add_f32 v4, v4, v16
    v_add_f32 v4, v4, v17
    v_mfma_f32_16x16x32_bf16 v[188:191], v[40:43], v[208:211], v[188:191]
    v_exp_f32 v19, v99
    v_mfma_f32_16x16x32_bf16 v[188:191], v[44:47], v[212:215], v[188:191]
    s_waitcnt lgkmcnt(2)
    v_add_u32 v21, s3, v21
    v_cvt_f32_i32 v255, v255
    v_mfma_f32_16x16x32_bf16 v[112:115], v[24:27], a[200:203], v[112:115]
    ds_read_b128 v[40:43], v2 offset:18688
    v_cvt_pk_bf16_f32 v162, v16, v17
    v_mfma_f32_16x16x32_bf16 v[112:115], v[28:31], a[204:207], v[112:115]
    s_add_u32 s32, s32, 24576
    v_exp_f32 v16, v164
    v_mfma_f32_16x16x32_bf16 v[116:119], v[24:27], a[224:227], v[116:119]
    s_add_u32 s26, s26, 36864
    v_add_f32 v4, v4, v18
    v_add_u32 v22, s3, v22
    v_mfma_f32_16x16x32_bf16 v[116:119], v[28:31], a[228:231], v[116:119]
    v_add_f32 v4, v4, v19
    v_fma_f32 v250, v250, v56, v58
    v_mfma_f32_16x16x32_bf16 v[120:123], v[24:27], a[248:251], v[120:123]
    ds_read_b128 v[44:47], v3 offset:18688
    v_fma_f32 v254, v254, v57, v59
    v_mfma_f32_16x16x32_bf16 v[120:123], v[28:31], a[252:255], v[120:123]
    s_waitcnt lgkmcnt(2)
    v_exp_f32 v17, v165
    v_mfma_f32_16x16x32_bf16 v[124:127], v[24:27], v[208:211], v[124:127]
    s_waitcnt vmcnt(27)
    v_cvt_pk_bf16_f32 v163, v18, v19
    v_fma_f32 v251, v251, v56, v58
    v_mfma_f32_16x16x32_bf16 v[124:127], v[28:31], v[212:215], v[124:127]
    s_barrier
    s_sub_u32 s57, s26, 147456
    v_mfma_f32_16x16x32_bf16 v[176:179], v[32:35], a[208:211], v[176:179]
    s_min_u32 s26, s26, s57
    ds_read_b128 v[24:27], v1 offset:0
    v_fma_f32 v255, v255, v57, v59
    v_mfma_f32_16x16x32_bf16 v[176:179], v[36:39], a[212:215], v[176:179]
    v_exp_f32 v18, v166
    v_mfma_f32_16x16x32_bf16 v[180:183], v[32:35], a[232:235], v[180:183]
    v_add_f32 v5, v5, v16
    v_add_f32 v5, v5, v17
    v_mfma_f32_16x16x32_bf16 v[180:183], v[36:39], a[236:239], v[180:183]
    v_exp_f32 v19, v167
    v_mfma_f32_16x16x32_bf16 v[184:187], v[32:35], v[192:195], v[184:187]
    ds_read_b128 v[28:31], v1 offset:12288
    v_cvt_pk_bf16_f32 v164, v16, v17
    v_mfma_f32_16x16x32_bf16 v[184:187], v[36:39], v[196:199], v[184:187]
    v_exp_f32 v16, v100
    v_mfma_f32_16x16x32_bf16 v[188:191], v[32:35], v[216:219], v[188:191]
    v_add_f32 v5, v5, v18
    v_add_f32 v5, v5, v19
    v_mfma_f32_16x16x32_bf16 v[188:191], v[36:39], v[220:223], v[188:191]
    s_waitcnt lgkmcnt(2)
    v_exp_f32 v17, v101
    v_mfma_f32_16x16x32_bf16 v[112:115], v[40:43], a[208:211], v[112:115]
    ds_read_b128 v[32:35], v1 offset:768
    v_cvt_pk_bf16_f32 v165, v18, v19
    v_mfma_f32_16x16x32_bf16 v[112:115], v[44:47], a[212:215], v[112:115]
    v_exp_f32 v18, v102
    v_mfma_f32_16x16x32_bf16 v[116:119], v[40:43], a[232:235], v[116:119]
    v_cvt_pk_bf16_f32 v147, v248, v252
    v_add_f32 v5, v5, v16
    v_mfma_f32_16x16x32_bf16 v[116:119], v[44:47], a[236:239], v[116:119]
    v_add_f32 v5, v5, v17
    v_cvt_pk_bf16_f32 v151, v249, v253
    v_mfma_f32_16x16x32_bf16 v[120:123], v[40:43], v[192:195], v[120:123]
    ds_read_b128 v[36:39], v1 offset:13056
    v_cvt_pk_bf16_f32 v155, v250, v254
    v_mfma_f32_16x16x32_bf16 v[120:123], v[44:47], v[196:199], v[120:123]
    v_exp_f32 v19, v103
    v_mfma_f32_16x16x32_bf16 v[124:127], v[40:43], v[216:219], v[124:127]
    v_cvt_pk_bf16_f32 v166, v16, v17
    v_add_f32 v5, v5, v18
    v_mfma_f32_16x16x32_bf16 v[124:127], v[44:47], v[220:223], v[124:127]
    s_waitcnt lgkmcnt(2)
    v_add_f32 v5, v5, v19
    v_cvt_pk_bf16_f32 v167, v18, v19
    v_cvt_pk_bf16_f32 v159, v251, v255
    v_mfma_f32_16x16x32_bf16 a[0:3], v[64:67], v[24:27], a[0:3]
    ds_read_b128 v[40:43], v1 offset:1536
    v_bfe_u32 v53, v8, 4, 6
    v_mfma_f32_16x16x32_bf16 a[0:3], v[80:83], v[28:31], a[0:3]
    v_exp_f32 v16, v168
    v_mfma_f32_16x16x32_bf16 a[48:51], v[68:71], v[24:27], a[48:51]
    v_exp_f32 v17, v169
    v_mfma_f32_16x16x32_bf16 a[48:51], v[84:87], v[28:31], a[48:51]
    v_lshlrev_b32 v53, 2, v53
    v_mfma_f32_16x16x32_bf16 a[96:99], v[72:75], v[24:27], a[96:99]
    ds_read_b128 v[44:47], v1 offset:13824
    v_mfma_f32_16x16x32_bf16 a[96:99], v[88:91], v[28:31], a[96:99]
    buffer_store_dwordx4 v[144:147], v20, s[4:7], s81 offen offset:0 sc1
    v_mfma_f32_16x16x32_bf16 a[144:147], v[76:79], v[24:27], a[144:147]
    v_exp_f32 v18, v170
    v_mfma_f32_16x16x32_bf16 a[144:147], v[92:95], v[28:31], a[144:147]
    s_waitcnt lgkmcnt(2)
    v_add_f32 v6, v6, v16
    v_add_f32 v6, v6, v17
    v_mfma_f32_16x16x32_bf16 a[4:7], v[64:67], v[32:35], a[4:7]
    ds_read_b128 v[24:27], v1 offset:2304
    buffer_load_dword v52, v53, s[20:23], 0 offen sc1
    v_mfma_f32_16x16x32_bf16 a[4:7], v[80:83], v[36:39], a[4:7]
    v_exp_f32 v19, v171
    v_mfma_f32_16x16x32_bf16 a[52:55], v[68:71], v[32:35], a[52:55]
    s_mov_b32 m0, s56
    v_cvt_pk_bf16_f32 v168, v16, v17
    v_mfma_f32_16x16x32_bf16 a[52:55], v[84:87], v[36:39], a[52:55]
    v_exp_f32 v16, v104
    v_mfma_f32_16x16x32_bf16 a[100:103], v[72:75], v[32:35], a[100:103]
    ds_read_b128 v[28:31], v1 offset:14592
    v_add_f32 v6, v6, v18
    v_mfma_f32_16x16x32_bf16 a[100:103], v[88:91], v[36:39], a[100:103]
    v_add_f32 v6, v6, v19
    v_mfma_f32_16x16x32_bf16 a[148:151], v[76:79], v[32:35], a[148:151]
    v_exp_f32 v17, v105
    v_mfma_f32_16x16x32_bf16 a[148:151], v[92:95], v[36:39], a[148:151]
    s_waitcnt lgkmcnt(2)
    buffer_load_dwordx4 v8, s[4:7], s27 offen offset:0 sc1 lds
    v_mfma_f32_16x16x32_bf16 a[8:11], v[64:67], v[40:43], a[8:11]
    ds_read_b128 v[32:35], v21 offset:0
    v_cvt_pk_bf16_f32 v169, v18, v19
    v_mfma_f32_16x16x32_bf16 a[8:11], v[80:83], v[44:47], a[8:11]
    v_exp_f32 v18, v106
    v_mfma_f32_16x16x32_bf16 a[56:59], v[68:71], v[40:43], a[56:59]
    v_add_f32 v6, v6, v16
    v_add_f32 v6, v6, v17
    v_mfma_f32_16x16x32_bf16 a[56:59], v[84:87], v[44:47], a[56:59]
    v_exp_f32 v19, v107
    v_mfma_f32_16x16x32_bf16 a[104:107], v[72:75], v[40:43], a[104:107]
    ds_read_b128 v[36:39], v21 offset:12288
    v_cvt_pk_bf16_f32 v170, v16, v17
    v_mfma_f32_16x16x32_bf16 a[104:107], v[88:91], v[44:47], a[104:107]
    buffer_store_dwordx4 v[148:151], v20, s[4:7], s81 offen offset:768 sc1
    v_mfma_f32_16x16x32_bf16 a[152:155], v[76:79], v[40:43], a[152:155]
    v_exp_f32 v16, v172
    v_mfma_f32_16x16x32_bf16 a[152:155], v[92:95], v[44:47], a[152:155]
    s_waitcnt lgkmcnt(2)
    v_add_f32 v6, v6, v18
    v_add_f32 v6, v6, v19
    v_mfma_f32_16x16x32_bf16 a[12:15], v[64:67], v[24:27], a[12:15]
    ds_read_b128 v[40:43], v21 offset:768
    v_mfma_f32_16x16x32_bf16 a[12:15], v[80:83], v[28:31], a[12:15]
    buffer_load_dwordx4 v8, s[4:7], s27 offen offset:1024 sc1 lds
    v_mfma_f32_16x16x32_bf16 a[60:63], v[68:71], v[24:27], a[60:63]
    v_exp_f32 v17, v173
    v_mfma_f32_16x16x32_bf16 a[60:63], v[84:87], v[28:31], a[60:63]
    v_cvt_pk_bf16_f32 v171, v18, v19
    v_mfma_f32_16x16x32_bf16 a[108:111], v[72:75], v[24:27], a[108:111]
    ds_read_b128 v[44:47], v21 offset:13056
    v_mfma_f32_16x16x32_bf16 a[108:111], v[88:91], v[28:31], a[108:111]
    v_exp_f32 v18, v174
    v_mfma_f32_16x16x32_bf16 a[156:159], v[76:79], v[24:27], a[156:159]
    s_add_u32 s29, s28, 49152
    v_add_f32 v7, v7, v16
    v_add_f32 v7, v7, v17
    v_mfma_f32_16x16x32_bf16 a[156:159], v[92:95], v[28:31], a[156:159]
    s_waitcnt lgkmcnt(2)
    v_exp_f32 v19, v175
    v_mfma_f32_16x16x32_bf16 a[16:19], v[64:67], v[32:35], a[16:19]
    ds_read_b128 v[24:27], v21 offset:1536
    v_cvt_pk_bf16_f32 v172, v16, v17
    v_mfma_f32_16x16x32_bf16 a[16:19], v[80:83], v[36:39], a[16:19]
    s_sub_u32 s3, s29, 147456
    v_exp_f32 v16, v108
    v_mfma_f32_16x16x32_bf16 a[64:67], v[68:71], v[32:35], a[64:67]
    v_add_f32 v7, v7, v18
    v_mfma_f32_16x16x32_bf16 a[64:67], v[84:87], v[36:39], a[64:67]
    v_add_f32 v7, v7, v19
    v_mfma_f32_16x16x32_bf16 a[112:115], v[72:75], v[32:35], a[112:115]
    ds_read_b128 v[28:31], v21 offset:13824
    v_mfma_f32_16x16x32_bf16 a[112:115], v[88:91], v[36:39], a[112:115]
    buffer_store_dwordx4 v[152:155], v20, s[4:7], s81 offen offset:1536 sc1
    v_mfma_f32_16x16x32_bf16 a[160:163], v[76:79], v[32:35], a[160:163]
    v_exp_f32 v17, v109
    v_mfma_f32_16x16x32_bf16 a[160:163], v[92:95], v[36:39], a[160:163]
    s_waitcnt lgkmcnt(2)
    v_cvt_pk_bf16_f32 v173, v18, v19
    v_mfma_f32_16x16x32_bf16 a[20:23], v[64:67], v[40:43], a[20:23]
    s_min_u32 s29, s29, s3
    ds_read_b128 v[32:35], v21 offset:2304
    v_mfma_f32_16x16x32_bf16 a[20:23], v[80:83], v[44:47], a[20:23]
    buffer_load_dwordx4 v8, s[4:7], s27 offen offset:2048 sc1 lds
    v_mfma_f32_16x16x32_bf16 a[68:71], v[68:71], v[40:43], a[68:71]
    v_exp_f32 v18, v110
    v_mfma_f32_16x16x32_bf16 a[68:71], v[84:87], v[44:47], a[68:71]
    s_add_u32 s27, s27, 24576
    v_add_f32 v7, v7, v16
    v_add_f32 v7, v7, v17
    v_mfma_f32_16x16x32_bf16 a[116:119], v[72:75], v[40:43], a[116:119]
    ds_read_b128 v[36:39], v21 offset:14592
    v_mfma_f32_16x16x32_bf16 a[116:119], v[88:91], v[44:47], a[116:119]
    v_exp_f32 v19, v111
    v_mfma_f32_16x16x32_bf16 a[164:167], v[76:79], v[40:43], a[164:167]
    s_sub_u32 s3, s29, s28
    v_cvt_pk_bf16_f32 v174, v16, v17
    v_mfma_f32_16x16x32_bf16 a[164:167], v[92:95], v[44:47], a[164:167]
    s_waitcnt lgkmcnt(2)
    v_exp_f32 v16, v176
    v_mfma_f32_16x16x32_bf16 a[24:27], v[64:67], v[24:27], a[24:27]
    s_add_u32 s56, s56, 12288
    ds_read_b128 v[40:43], v22 offset:0
    v_add_f32 v7, v7, v18
    v_mfma_f32_16x16x32_bf16 a[24:27], v[80:83], v[28:31], a[24:27]
    v_add_f32 v7, v7, v19
    v_mfma_f32_16x16x32_bf16 a[72:75], v[68:71], v[24:27], a[72:75]
    v_exp_f32 v17, v177
    v_mfma_f32_16x16x32_bf16 a[72:75], v[84:87], v[28:31], a[72:75]
    v_cvt_pk_bf16_f32 v175, v18, v19
    v_mfma_f32_16x16x32_bf16 a[120:123], v[72:75], v[24:27], a[120:123]
    ds_read_b128 v[44:47], v22 offset:12288
    v_mfma_f32_16x16x32_bf16 a[120:123], v[88:91], v[28:31], a[120:123]
    buffer_store_dwordx4 v[156:159], v20, s[4:7], s81 offen offset:2304 sc1
    s_branch L_skip12
L_pad12:
    s_branch L_tb1_2
L_skip12:
    v_mfma_f32_16x16x32_bf16 a[168:171], v[76:79], v[24:27], a[168:171]
    s_mov_b32 m0, s56
    v_exp_f32 v18, v178
    v_mfma_f32_16x16x32_bf16 a[168:171], v[92:95], v[28:31], a[168:171]
    s_waitcnt lgkmcnt(2)
    v_add_f32 v4, v4, v16
    v_add_f32 v4, v4, v17
    v_mfma_f32_16x16x32_bf16 a[28:31], v[64:67], v[32:35], a[28:31]
    s_mov_b32 s28, s29
    ds_read_b128 v[24:27], v22 offset:768
    v_mfma_f32_16x16x32_bf16 a[28:31], v[80:83], v[36:39], a[28:31]
    v_exp_f32 v19, v179
    v_mfma_f32_16x16x32_bf16 a[76:79], v[68:71], v[32:35], a[76:79]
    v_cvt_pk_bf16_f32 v176, v16, v17
    v_mfma_f32_16x16x32_bf16 a[76:79], v[84:87], v[36:39], a[76:79]
    v_exp_f32 v16, v112
    v_mfma_f32_16x16x32_bf16 a[124:127], v[72:75], v[32:35], a[124:127]
    ds_read_b128 v[28:31], v22 offset:13056
    v_add_f32 v4, v4, v18
    v_mfma_f32_16x16x32_bf16 a[124:127], v[88:91], v[36:39], a[124:127]
    buffer_load_dwordx4 v8, s[4:7], s27 offen offset:0 sc1 lds
    v_mfma_f32_16x16x32_bf16 a[172:175], v[76:79], v[32:35], a[172:175]
    v_add_f32 v4, v4, v19
    v_add_u32 v2, s3, v2
    v_mfma_f32_16x16x32_bf16 a[172:175], v[92:95], v[36:39], a[172:175]
    s_waitcnt lgkmcnt(2)
    v_exp_f32 v17, v113
    v_mfma_f32_16x16x32_bf16 a[32:35], v[64:67], v[40:43], a[32:35]
    ds_read_b128 v[32:35], v22 offset:1536
    v_cvt_pk_bf16_f32 v177, v18, v19
    v_mfma_f32_16x16x32_bf16 a[32:35], v[80:83], v[44:47], a[32:35]
    v_exp_f32 v18, v114
    v_mfma_f32_16x16x32_bf16 a[80:83], v[68:71], v[40:43], a[80:83]
    v_add_f32 v4, v4, v16
    v_add_f32 v4, v4, v17
    v_mfma_f32_16x16x32_bf16 a[80:83], v[84:87], v[44:47], a[80:83]
    v_exp_f32 v19, v115
    v_mfma_f32_16x16x32_bf16 a[128:131], v[72:75], v[40:43], a[128:131]
    ds_read_b128 v[36:39], v22 offset:13824
    v_cvt_pk_bf16_f32 v178, v16, v17
    v_mfma_f32_16x16x32_bf16 a[128:131], v[88:91], v[44:47], a[128:131]
    v_exp_f32 v16, v180
    v_mfma_f32_16x16x32_bf16 a[176:179], v[76:79], v[40:43], a[176:179]
    v_add_u32 v3, s3, v3
    v_add_f32 v4, v4, v18
    v_mfma_f32_16x16x32_bf16 a[176:179], v[92:95], v[44:47], a[176:179]
    s_waitcnt lgkmcnt(2)
    v_add_f32 v4, v4, v19
    v_mfma_f32_16x16x32_bf16 a[36:39], v[64:67], v[24:27], a[36:39]
    ds_read_b128 v[40:43], v22 offset:2304
    v_mfma_f32_16x16x32_bf16 a[36:39], v[80:83], v[28:31], a[36:39]
    buffer_load_dwordx4 v8, s[4:7], s27 offen offset:1024 sc1 lds
    v_mfma_f32_16x16x32_bf16 a[84:87], v[68:71], v[24:27], a[84:87]
    v_exp_f32 v17, v181
    v_mfma_f32_16x16x32_bf16 a[84:87], v[84:87], v[28:31], a[84:87]
    v_cvt_pk_bf16_f32 v179, v18, v19
    v_mfma_f32_16x16x32_bf16 a[132:135], v[72:75], v[24:27], a[132:135]
    ds_read_b128 v[44:47], v22 offset:14592
    v_mfma_f32_16x16x32_bf16 a[132:135], v[88:91], v[28:31], a[132:135]
    s_waitcnt lgkmcnt(2)
    v_exp_f32 v18, v182
    v_mfma_f32_16x16x32_bf16 a[180:183], v[76:79], v[24:27], a[180:183]
    s_waitcnt vmcnt(25)
    v_add_f32 v5, v5, v16
    v_add_f32 v5, v5, v17
    v_mfma_f32_16x16x32_bf16 a[180:183], v[92:95], v[28:31], a[180:183]
    s_barrier
    v_mfma_f32_16x16x32_bf16 a[40:43], v[64:67], v[32:35], a[40:43]
    ds_read_b128 v[24:27], v2 offset:0
    v_mfma_f32_16x16x32_bf16 a[40:43], v[80:83], v[36:39], a[40:43]
    v_exp_f32 v19, v183
    v_mfma_f32_16x16x32_bf16 a[88:91], v[68:71], v[32:35], a[88:91]
    v_cvt_pk_bf16_f32 v180, v16, v17
    v_mfma_f32_16x16x32_bf16 a[88:91], v[84:87], v[36:39], a[88:91]
    buffer_load_dwordx4 v8, s[4:7], s27 offen offset:2048 sc1 lds
    v_mfma_f32_16x16x32_bf16 a[136:139], v[72:75], v[32:35], a[136:139]
    ds_read_b128 v[28:31], v3 offset:0
    v_mfma_f32_16x16x32_bf16 a[136:139], v[88:91], v[36:39], a[136:139]
    v_exp_f32 v16, v116
    v_mfma_f32_16x16x32_bf16 a[184:187], v[76:79], v[32:35], a[184:187]
    v_add_f32 v5, v5, v18
    v_add_f32 v5, v5, v19
    v_mfma_f32_16x16x32_bf16 a[184:187], v[92:95], v[36:39], a[184:187]
    s_waitcnt lgkmcnt(2)
    v_exp_f32 v17, v117
    v_mfma_f32_16x16x32_bf16 a[44:47], v[64:67], v[40:43], a[44:47]
    ds_read_b128 v[32:35], v2 offset:6144
    v_cvt_pk_bf16_f32 v181, v18, v19
    v_mfma_f32_16x16x32_bf16 a[44:47], v[80:83], v[44:47], a[44:47]
    v_exp_f32 v18, v118
    v_mfma_f32_16x16x32_bf16 a[92:95], v[68:71], v[40:43], a[92:95]
    v_add_f32 v5, v5, v16
    v_add_f32 v5, v5, v17
    v_mfma_f32_16x16x32_bf16 a[92:95], v[84:87], v[44:47], a[92:95]
    v_exp_f32 v19, v119
    v_mfma_f32_16x16x32_bf16 a[140:143], v[72:75], v[40:43], a[140:143]
    ds_read_b128 v[36:39], v3 offset:6144
    v_cvt_pk_bf16_f32 v182, v16, v17
    v_mfma_f32_16x16x32_bf16 a[140:143], v[88:91], v[44:47], a[140:143]
    s_add_u32 s27, s27, 24576
    v_add_f32 v5, v5, v18
    s_add_u32 s56, s56, 36864
    v_mfma_f32_16x16x32_bf16 a[188:191], v[76:79], v[40:43], a[188:191]
    s_sub_u32 s58, s56, 147456
    v_add_f32 v5, v5, v19
    v_cvt_pk_bf16_f32 v183, v18, v19
    v_mfma_f32_16x16x32_bf16 a[188:191], v[92:95], v[44:47], a[188:191]
    s_waitcnt lgkmcnt(2)
    s_min_u32 s56, s56, s58
    v_mfma_f32_16x16x32_bf16 v[64:67], v[24:27], a[192:195], v[128:131]
    ds_read_b128 v[40:43], v2 offset:128
    v_mfma_f32_16x16x32_bf16 v[64:67], v[28:31], a[196:199], v[64:67]
    v_exp_f32 v16, v184
    v_mfma_f32_16x16x32_bf16 v[68:71], v[24:27], a[216:219], v[132:135]
    v_exp_f32 v17, v185
    v_mfma_f32_16x16x32_bf16 v[68:71], v[28:31], a[220:223], v[68:71]
    v_exp_f32 v18, v186
    v_mfma_f32_16x16x32_bf16 v[72:75], v[24:27], a[240:243], v[136:139]
    ds_read_b128 v[44:47], v3 offset:128
    v_mfma_f32_16x16x32_bf16 v[72:75], v[28:31], a[244:247], v[72:75]
    v_add_f32 v6, v6, v16
    v_add_f32 v6, v6, v17
    v_mfma_f32_16x16x32_bf16 v[76:79], v[24:27], v[200:203], v[140:143]
    v_mfma_f32_16x16x32_bf16 v[76:79], v[28:31], v[204:207], v[76:79]
    s_waitcnt lgkmcnt(2)
    v_exp_f32 v19, v187
    v_mfma_f32_16x16x32_bf16 v[96:99], v[32:35], a[192:195], v[128:131]
    ds_read_b128 v[24:27], v2 offset:6272
    v_cvt_pk_bf16_f32 v184, v16, v17
    v_mfma_f32_16x16x32_bf16 v[96:99], v[36:39], a[196:199], v[96:99]
    v_mfma_f32_16x16x32_bf16 v[100:103], v[32:35], a[216:219], v[132:135]
    v_exp_f32 v16, v120
    v_mfma_f32_16x16x32_bf16 v[100:103], v[36:39], a[220:223], v[100:103]
    v_add_f32 v6, v6, v18
    v_mfma_f32_16x16x32_bf16 v[104:107], v[32:35], a[240:243], v[136:139]
    ds_read_b128 v[28:31], v3 offset:6272
    v_add_f32 v6, v6, v19
    v_mfma_f32_16x16x32_bf16 v[104:107], v[36:39], a[244:247], v[104:107]
    v_exp_f32 v17, v121
    v_mfma_f32_16x16x32_bf16 v[108:111], v[32:35], v[200:203], v[140:143]
    v_mfma_f32_16x16x32_bf16 v[108:111], v[36:39], v[204:207], v[108:111]
    s_waitcnt lgkmcnt(2)
    v_cvt_pk_bf16_f32 v185, v18, v19
    v_mfma_f32_16x16x32_bf16 v[64:67], v[40:43], a[200:203], v[64:67]
    ds_read_b128 v[32:35], v2 offset:256
    v_mfma_f32_16x16x32_bf16 v[64:67], v[44:47], a[204:207], v[64:67]
    v_exp_f32 v18, v122
    v_mfma_f32_16x16x32_bf16 v[68:71], v[40:43], a[224:227], v[68:71]
    v_add_f32 v6, v6, v16
    v_add_f32 v6, v6, v17
    v_mfma_f32_16x16x32_bf16 v[68:71], v[44:47], a[228:231], v[68:71]
    v_mfma_f32_16x16x32_bf16 v[72:75], v[40:43], a[248:251], v[72:75]
    ds_read_b128 v[36:39], v3 offset:256
    v_mfma_f32_16x16x32_bf16 v[72:75], v[44:47], a[252:255], v[72:75]
    v_exp_f32 v19, v123
    v_mfma_f32_16x16x32_bf16 v[76:79], v[40:43], v[208:211], v[76:79]
    v_cvt_pk_bf16_f32 v186, v16, v17
    v_mfma_f32_16x16x32_bf16 v[76:79], v[44:47], v[212:215], v[76:79]
    s_waitcnt lgkmcnt(2)
    v_exp_f32 v16, v188
    v_mfma_f32_16x16x32_bf16 v[96:99], v[24:27], a[200:203], v[96:99]
    ds_read_b128 v[40:43], v2 offset:6400
    v_add_f32 v6, v6, v18
    v_mfma_f32_16x16x32_bf16 v[96:99], v[28:31], a[204:207], v[96:99]
    v_add_f32 v6, v6, v19
    v_mfma_f32_16x16x32_bf16 v[100:103], v[24:27], a[224:227], v[100:103]
    v_exp_f32 v17, v189
    v_mfma_f32_16x16x32_bf16 v[100:103], v[28:31], a[228:231], v[100:103]
    v_cvt_pk_bf16_f32 v187, v18, v19
    v_mfma_f32_16x16x32_bf16 v[104:107], v[24:27], a[248:251], v[104:107]
    ds_read_b128 v[44:47], v3 offset:6400
    v_mfma_f32_16x16x32_bf16 v[104:107], v[28:31], a[252:255], v[104:107]
    s_waitcnt vmcnt(9)
    v_subrev_u32 v52, s92, v52
    v_cmp_lt_u32 vcc, 15, v52
    v_mfma_f32_16x16x32_bf16 v[108:111], v[24:27], v[208:211], v[108:111]
    s_add_u32 s29, s30, 49152
    v_exp_f32 v18, v190
    v_mfma_f32_16x16x32_bf16 v[108:111], v[28:31], v[212:215], v[108:111]
    s_waitcnt lgkmcnt(2)
    v_add_f32 v7, v7, v16
    v_add_f32 v7, v7, v17
    v_mfma_f32_16x16x32_bf16 v[64:67], v[32:35], a[208:211], v[64:67]
    s_and_b32 s59, vcc_lo, 0xff
    ds_read_b128 v[24:27], v2 offset:12288
    v_mfma_f32_16x16x32_bf16 v[64:67], v[36:39], a[212:215], v[64:67]
    s_cbranch_scc1 L_pollslow6
L_pollok6:
    v_mfma_f32_16x16x32_bf16 v[68:71], v[32:35], a[232:235], v[68:71]
    s_add_u32 s92, s92, 1
    v_exp_f32 v19, v191
    v_mfma_f32_16x16x32_bf16 v[68:71], v[36:39], a[236:239], v[68:71]
    s_sub_u32 s3, s29, 147456
    v_cvt_pk_bf16_f32 v188, v16, v17
    v_mfma_f32_16x16x32_bf16 v[72:75], v[32:35], v[192:195], v[72:75]
    s_mov_b32 m0, s26
    ds_read_b128 v[28:31], v3 offset:12288
    v_mfma_f32_16x16x32_bf16 v[72:75], v[36:39], v[196:199], v[72:75]
    v_exp_f32 v16, v124
    v_mfma_f32_16x16x32_bf16 v[76:79], v[32:35], v[216:219], v[76:79]
    s_min_u32 s29, s29, s3
    v_add_f32 v7, v7, v18
    v_add_f32 v7, v7, v19
    v_mfma_f32_16x16x32_bf16 v[76:79], v[36:39], v[220:223], v[76:79]
    s_waitcnt lgkmcnt(2)
    buffer_load_dwordx4 v8, s[4:7], s32 offen offset:0 sc1 lds
    v_mfma_f32_16x16x32_bf16 v[96:99], v[40:43], a[208:211], v[96:99]
    ds_read_b128 v[32:35], v2 offset:18432
    v_mfma_f32_16x16x32_bf16 v[96:99], v[44:47], a[212:215], v[96:99]
    v_exp_f32 v17, v125
    v_mfma_f32_16x16x32_bf16 v[100:103], v[40:43], a[232:235], v[100:103]
    v_cvt_pk_bf16_f32 v189, v18, v19
    v_mfma_f32_16x16x32_bf16 v[100:103], v[44:47], a[236:239], v[100:103]
    buffer_load_dwordx4 v8, s[4:7], s32 offen offset:1024 sc1 lds
    v_mfma_f32_16x16x32_bf16 v[104:107], v[40:43], v[192:195], v[104:107]
    s_sub_u32 s3, s29, s30
    ds_read_b128 v[36:39], v3 offset:18432
    v_mfma_f32_16x16x32_bf16 v[104:107], v[44:47], v[196:199], v[104:107]
    v_exp_f32 v18, v126
    v_mfma_f32_16x16x32_bf16 v[108:111], v[40:43], v[216:219], v[108:111]
    v_add_f32 v7, v7, v16
    v_add_f32 v7, v7, v17
    v_mfma_f32_16x16x32_bf16 v[108:111], v[44:47], v[220:223], v[108:111]
    s_waitcnt lgkmcnt(2)
    v_exp_f32 v19, v127
    v_mfma_f32_16x16x32_bf16 v[80:83], v[24:27], a[192:195], v[128:131]
    ds_read_b128 v[40:43], v2 offset:12416
    v_cvt_pk_bf16_f32 v190, v16, v17
    v_mfma_f32_16x16x32_bf16 v[80:83], v[28:31], a[196:199], v[80:83]
    buffer_load_dwordx4 v8, s[4:7], s32 offen offset:2048 sc1 lds
    v_mfma_f32_16x16x32_bf16 v[84:87], v[24:27], a[216:219], v[132:135]
    v_add_f32 v7, v7, v18
    v_add_f32 v7, v7, v19
    v_cvt_pk_bf16_f32 v191, v18, v19
    v_mfma_f32_16x16x32_bf16 v[84:87], v[28:31], a[220:223], v[84:87]
    s_mov_b32 s30, s29
    v_mfma_f32_16x16x32_bf16 v[88:91], v[24:27], a[240:243], v[136:139]
    s_add_u32 s32, s32, 24576
    ds_read_b128 v[44:47], v3 offset:12416
    v_mfma_f32_16x16x32_bf16 v[88:91], v[28:31], a[244:247], v[88:91]
    v_exp_f32 v16, v64
    v_mfma_f32_16x16x32_bf16 v[92:95], v[24:27], v[200:203], v[140:143]
    v_exp_f32 v17, v65
    v_mfma_f32_16x16x32_bf16 v[92:95], v[28:31], v[204:207], v[92:95]
    s_waitcnt lgkmcnt(2)
    v_exp_f32 v18, v66
    v_mfma_f32_16x16x32_bf16 v[112:115], v[32:35], a[192:195], v[128:131]
    s_add_u32 s26, s26, 12288
    ds_read_b128 v[24:27], v2 offset:18560
    v_add_f32 v4, v4, v16
    v_mfma_f32_16x16x32_bf16 v[112:115], v[36:39], a[196:199], v[112:115]
    s_mov_b32 m0, s26
    v_add_f32 v4, v4, v17
    v_add_u32 v1, s3, v1
    v_mfma_f32_16x16x32_bf16 v[116:119], v[32:35], a[216:219], v[132:135]
    v_exp_f32 v19, v67
    v_mfma_f32_16x16x32_bf16 v[116:119], v[36:39], a[220:223], v[116:119]
    v_cvt_pk_bf16_f32 v64, v16, v17
    v_mfma_f32_16x16x32_bf16 v[120:123], v[32:35], a[240:243], v[136:139]
    ds_read_b128 v[28:31], v3 offset:18560
    v_mfma_f32_16x16x32_bf16 v[120:123], v[36:39], a[244:247], v[120:123]
    buffer_load_dwordx4 v8, s[4:7], s32 offen offset:0 sc1 lds
    v_mfma_f32_16x16x32_bf16 v[124:127], v[32:35], v[200:203], v[140:143]
    v_exp_f32 v16, v96
    v_mfma_f32_16x16x32_bf16 v[124:127], v[36:39], v[204:207], v[124:127]
    s_waitcnt lgkmcnt(2)
    v_add_f32 v4, v4, v18
    v_add_f32 v4, v4, v19
    v_mfma_f32_16x16x32_bf16 v[80:83], v[40:43], a[200:203], v[80:83]
    ds_read_b128 v[32:35], v2 offset:12544
    v_add_u32 v21, s3, v21
    v_mfma_f32_16x16x32_bf16 v[80:83], v[44:47], a[204:207], v[80:83]
    v_exp_f32 v17, v97
    v_mfma_f32_16x16x32_bf16 v[84:87], v[40:43], a[224:227], v[84:87]
    v_cvt_pk_bf16_f32 v65, v18, v19
    v_mfma_f32_16x16x32_bf16 v[84:87], v[44:47], a[228:231], v[84:87]
    buffer_load_dwordx4 v8, s[4:7], s32 offen offset:1024 sc1 lds
    v_mfma_f32_16x16x32_bf16 v[88:91], v[40:43], a[248:251], v[88:91]
    ds_read_b128 v[36:39], v3 offset:12544
    v_add_u32 v22, s3, v22
    v_mfma_f32_16x16x32_bf16 v[88:91], v[44:47], a[252:255], v[88:91]
    v_exp_f32 v18, v98
    v_mfma_f32_16x16x32_bf16 v[92:95], v[40:43], v[208:211], v[92:95]
    v_add_f32 v4, v4, v16
    v_add_f32 v4, v4, v17
    v_mfma_f32_16x16x32_bf16 v[92:95], v[44:47], v[212:215], v[92:95]
    s_waitcnt lgkmcnt(2)
    buffer_load_dwordx4 v8, s[4:7], s32 offen offset:2048 sc1 lds
    v_mfma_f32_16x16x32_bf16 v[112:115], v[24:27], a[200:203], v[112:115]
    ds_read_b128 v[40:43], v2 offset:18688
    v_mfma_f32_16x16x32_bf16 v[112:115], v[28:31], a[204:207], v[112:115]
    v_exp_f32 v19, v99
    v_mfma_f32_16x16x32_bf16 v[116:119], v[24:27], a[224:227], v[116:119]
    v_cvt_pk_bf16_f32 v66, v16, v17
    v_mfma_f32_16x16x32_bf16 v[116:119], v[28:31], a[228:231], v[116:119]
    v_exp_f32 v16, v68
    v_mfma_f32_16x16x32_bf16 v[120:123], v[24:27], a[248:251], v[120:123]
    ds_read_b128 v[44:47], v3 offset:18688
    v_add_f32 v4, v4, v18
    v_mfma_f32_16x16x32_bf16 v[120:123], v[28:31], a[252:255], v[120:123]
    s_waitcnt lgkmcnt(2)
    v_add_f32 v4, v4, v19
    s_add_u32 s32, s32, 24576
    v_mfma_f32_16x16x32_bf16 v[124:127], v[24:27], v[208:211], v[124:127]
    s_waitcnt vmcnt(9)
    v_exp_f32 v17, v69
    v_mfma_f32_16x16x32_bf16 v[124:127], v[28:31], v[212:215], v[124:127]
    s_barrier
    v_cvt_pk_bf16_f32 v67, v18, v19
    v_mfma_f32_16x16x32_bf16 v[80:83], v[32:35], a[208:211], v[80:83]
    s_add_u32 s26, s26, 36864
    ds_read_b128 v[24:27], v1 offset:0
    v_add_u32 v55, 1, v55
    v_mfma_f32_16x16x32_bf16 v[80:83], v[36:39], a[212:215], v[80:83]
    s_sub_u32 s57, s26, 147456
    v_exp_f32 v18, v70
    v_mfma_f32_16x16x32_bf16 v[84:87], v[32:35], a[232:235], v[84:87]
    v_add_f32 v5, v5, v16
    v_add_f32 v5, v5, v17
    v_mfma_f32_16x16x32_bf16 v[84:87], v[36:39], a[236:239], v[84:87]
    v_exp_f32 v19, v71
    v_mfma_f32_16x16x32_bf16 v[88:91], v[32:35], v[192:195], v[88:91]
    s_min_u32 s26, s26, s57
    ds_read_b128 v[28:31], v1 offset:12288
    v_cvt_pk_bf16_f32 v68, v16, v17
    v_mfma_f32_16x16x32_bf16 v[88:91], v[36:39], v[196:199], v[88:91]
    buffer_store_dword v55, v13, s[20:23], 0 offen sc1
    v_mfma_f32_16x16x32_bf16 v[92:95], v[32:35], v[216:219], v[92:95]
    v_exp_f32 v16, v100
    v_mfma_f32_16x16x32_bf16 v[92:95], v[36:39], v[220:223], v[92:95]
    s_waitcnt lgkmcnt(2)
    v_add_f32 v5, v5, v18
    v_add_f32 v5, v5, v19
    v_mfma_f32_16x16x32_bf16 v[112:115], v[40:43], a[208:211], v[112:115]
    ds_read_b128 v[32:35], v1 offset:768
    v_mfma_f32_16x16x32_bf16 v[112:115], v[44:47], a[212:215], v[112:115]
    v_exp_f32 v17, v101
    v_mfma_f32_16x16x32_bf16 v[116:119], v[40:43], a[232:235], v[116:119]
    v_cvt_pk_bf16_f32 v69, v18, v19
    v_mfma_f32_16x16x32_bf16 v[116:119], v[44:47], a[236:239], v[116:119]
    v_exp_f32 v18, v102
    v_mfma_f32_16x16x32_bf16 v[120:123], v[40:43], v[192:195], v[120:123]
    ds_read_b128 v[36:39], v1 offset:13056
    v_add_f32 v5, v5, v16
    v_mfma_f32_16x16x32_bf16 v[120:123], v[44:47], v[196:199], v[120:123]
    v_add_f32 v5, v5, v17
    v_mfma_f32_16x16x32_bf16 v[124:127], v[40:43], v[216:219], v[124:127]
    v_exp_f32 v19, v103
    v_mfma_f32_16x16x32_bf16 v[124:127], v[44:47], v[220:223], v[124:127]
    s_waitcnt lgkmcnt(2)
    v_cvt_pk_bf16_f32 v70, v16, v17
    v_add_f32 v5, v5, v18
    v_add_f32 v5, v5, v19
    v_cvt_pk_bf16_f32 v71, v18, v19
    s_mov_b32 s31, 2
.p2align 6
L_loop2:
    v_mfma_f32_16x16x32_bf16 a[0:3], v[160:163], v[24:27], a[0:3]
    s_mov_b32 m0, s56
    ds_read_b128 v[40:43], v1 offset:1536
    v_mfma_f32_16x16x32_bf16 a[0:3], v[176:179], v[28:31], a[0:3]
    v_exp_f32 v16, v72
    v_mfma_f32_16x16x32_bf16 a[48:51], v[164:167], v[24:27], a[48:51]
    v_exp_f32 v17, v73
    v_mfma_f32_16x16x32_bf16 a[48:51], v[180:183], v[28:31], a[48:51]
    v_exp_f32 v18, v74
    v_mfma_f32_16x16x32_bf16 a[96:99], v[168:171], v[24:27], a[96:99]
    ds_read_b128 v[44:47], v1 offset:13824
    v_add_f32 v6, v6, v16
    v_mfma_f32_16x16x32_bf16 a[96:99], v[184:187], v[28:31], a[96:99]
    buffer_load_dwordx4 v8, s[4:7], s27 offen offset:0 sc1 lds
    v_mfma_f32_16x16x32_bf16 a[144:147], v[172:175], v[24:27], a[144:147]
    v_add_f32 v6, v6, v17
    v_mfma_f32_16x16x32_bf16 a[144:147], v[188:191], v[28:31], a[144:147]
    s_waitcnt lgkmcnt(2)
    v_exp_f32 v19, v75
    v_mfma_f32_16x16x32_bf16 a[4:7], v[160:163], v[32:35], a[4:7]
    ds_read_b128 v[24:27], v1 offset:2304
    v_cvt_pk_bf16_f32 v72, v16, v17
    v_mfma_f32_16x16x32_bf16 a[4:7], v[176:179], v[36:39], a[4:7]
    v_exp_f32 v16, v104
    v_mfma_f32_16x16x32_bf16 a[52:55], v[164:167], v[32:35], a[52:55]
    v_add_f32 v6, v6, v18
    v_mfma_f32_16x16x32_bf16 a[52:55], v[180:183], v[36:39], a[52:55]
    v_add_f32 v6, v6, v19
    v_mfma_f32_16x16x32_bf16 a[100:103], v[168:171], v[32:35], a[100:103]
    ds_read_b128 v[28:31], v1 offset:14592
    v_mfma_f32_16x16x32_bf16 a[100:103], v[184:187], v[36:39], a[100:103]
    v_exp_f32 v17, v105
    v_mfma_f32_16x16x32_bf16 a[148:151], v[172:175], v[32:35], a[148:151]
    v_cvt_pk_bf16_f32 v73, v18, v19
    v_mfma_f32_16x16x32_bf16 a[148:151], v[188:191], v[36:39], a[148:151]
    s_waitcnt lgkmcnt(2)
    buffer_load_dwordx4 v8, s[4:7], s27 offen offset:1024 sc1 lds
    v_mfma_f32_16x16x32_bf16 a[8:11], v[160:163], v[40:43], a[8:11]
    ds_read_b128 v[32:35], v21 offset:0
    v_mfma_f32_16x16x32_bf16 a[8:11], v[176:179], v[44:47], a[8:11]
    v_exp_f32 v18, v106
    v_mfma_f32_16x16x32_bf16 a[56:59], v[164:167], v[40:43], a[56:59]
    v_add_f32 v6, v6, v16
    v_add_f32 v6, v6, v17
    v_mfma_f32_16x16x32_bf16 a[56:59], v[180:183], v[44:47], a[56:59]
    v_exp_f32 v19, v107
    v_mfma_f32_16x16x32_bf16 a[104:107], v[168:171], v[40:43], a[104:107]
    ds_read_b128 v[36:39], v21 offset:12288
    v_cvt_pk_bf16_f32 v74, v16, v17
    v_mfma_f32_16x16x32_bf16 a[104:107], v[184:187], v[44:47], a[104:107]
    v_exp_f32 v16, v76
    v_mfma_f32_16x16x32_bf16 a[152:155], v[172:175], v[40:43], a[152:155]
    v_add_f32 v6, v6, v18
    v_mfma_f32_16x16x32_bf16 a[152:155], v[188:191], v[44:47], a[152:155]
    s_waitcnt lgkmcnt(2)
    buffer_load_dwordx4 v8, s[4:7], s27 offen offset:2048 sc1 lds
    v_mfma_f32_16x16x32_bf16 a[12:15], v[160:163], v[24:27], a[12:15]
    ds_read_b128 v[40:43], v21 offset:768
    v_add_f32 v6, v6, v19
    v_mfma_f32_16x16x32_bf16 a[12:15], v[176:179], v[28:31], a[12:15]
    v_exp_f32 v17, v77
    v_mfma_f32_16x16x32_bf16 a[60:63], v[164:167], v[24:27], a[60:63]
    v_cvt_pk_bf16_f32 v75, v18, v19
    v_mfma_f32_16x16x32_bf16 a[60:63], v[180:183], v[28:31], a[60:63]
    v_exp_f32 v18, v78
    v_mfma_f32_16x16x32_bf16 a[108:111], v[168:171], v[24:27], a[108:111]
    ds_read_b128 v[44:47], v21 offset:13056
    v_add_f32 v7, v7, v16
    v_mfma_f32_16x16x32_bf16 a[108:111], v[184:187], v[28:31], a[108:111]
    v_add_f32 v7, v7, v17
    v_mfma_f32_16x16x32_bf16 a[156:159], v[172:175], v[24:27], a[156:159]
    s_add_u32 s29, s28, 49152
    v_exp_f32 v19, v79
    v_mfma_f32_16x16x32_bf16 a[156:159], v[188:191], v[28:31], a[156:159]
    s_waitcnt lgkmcnt(2)
    s_add_u32 s27, s27, 24576
    v_mfma_f32_16x16x32_bf16 a[16:19], v[160:163], v[32:35], a[16:19]
    ds_read_b128 v[24:27], v21 offset:1536
    v_cvt_pk_bf16_f32 v76, v16, v17
    v_mfma_f32_16x16x32_bf16 a[16:19], v[176:179], v[36:39], a[16:19]
    s_sub_u32 s3, s29, 147456
    v_exp_f32 v16, v108
    v_mfma_f32_16x16x32_bf16 a[64:67], v[164:167], v[32:35], a[64:67]
    v_add_f32 v7, v7, v18
    v_mfma_f32_16x16x32_bf16 a[64:67], v[180:183], v[36:39], a[64:67]
    s_add_u32 s56, s56, 12288
    v_add_f32 v7, v7, v19
    v_mfma_f32_16x16x32_bf16 a[112:115], v[168:171], v[32:35], a[112:115]
    ds_read_b128 v[28:31], v21 offset:13824
    v_mfma_f32_16x16x32_bf16 a[112:115], v[184:187], v[36:39], a[112:115]
    v_exp_f32 v17, v109
    v_mfma_f32_16x16x32_bf16 a[160:163], v[172:175], v[32:35], a[160:163]
    v_cvt_pk_bf16_f32 v77, v18, v19
    v_mfma_f32_16x16x32_bf16 a[160:163], v[188:191], v[36:39], a[160:163]
    s_waitcnt lgkmcnt(2)
    v_exp_f32 v18, v110
    v_mfma_f32_16x16x32_bf16 a[20:23], v[160:163], v[40:43], a[20:23]
    s_mov_b32 m0, s56
    ds_read_b128 v[32:35], v21 offset:2304
    v_add_f32 v7, v7, v16
    v_mfma_f32_16x16x32_bf16 a[20:23], v[176:179], v[44:47], a[20:23]
    s_min_u32 s29, s29, s3
    v_add_f32 v7, v7, v17
    v_mfma_f32_16x16x32_bf16 a[68:71], v[164:167], v[40:43], a[68:71]
    v_exp_f32 v19, v111
    v_mfma_f32_16x16x32_bf16 a[68:71], v[180:183], v[44:47], a[68:71]
    v_mfma_f32_16x16x32_bf16 a[116:119], v[168:171], v[40:43], a[116:119]
    ds_read_b128 v[36:39], v21 offset:14592
    v_cvt_pk_bf16_f32 v78, v16, v17
    v_mfma_f32_16x16x32_bf16 a[116:119], v[184:187], v[44:47], a[116:119]
    v_exp_f32 v16, v80
    v_mfma_f32_16x16x32_bf16 a[164:167], v[172:175], v[40:43], a[164:167]
    s_sub_u32 s3, s29, s28
    v_add_f32 v7, v7, v18
    v_mfma_f32_16x16x32_bf16 a[164:167], v[188:191], v[44:47], a[164:167]
    s_waitcnt lgkmcnt(2)
    buffer_load_dwordx4 v8, s[4:7], s27 offen offset:0 sc1 lds
    v_mfma_f32_16x16x32_bf16 a[24:27], v[160:163], v[24:27], a[24:27]
    ds_read_b128 v[40:43], v22 offset:0
    v_add_f32 v7, v7, v19
    v_mfma_f32_16x16x32_bf16 a[24:27], v[176:179], v[28:31], a[24:27]
    v_exp_f32 v17, v81
    v_mfma_f32_16x16x32_bf16 a[72:75], v[164:167], v[24:27], a[72:75]
    v_cvt_pk_bf16_f32 v79, v18, v19
    v_mfma_f32_16x16x32_bf16 a[72:75], v[180:183], v[28:31], a[72:75]
    v_exp_f32 v18, v82
    v_mfma_f32_16x16x32_bf16 a[120:123], v[168:171], v[24:27], a[120:123]
    ds_read_b128 v[44:47], v22 offset:12288
    v_add_f32 v4, v4, v16
    v_mfma_f32_16x16x32_bf16 a[120:123], v[184:187], v[28:31], a[120:123]
    s_mov_b32 s28, s29
    v_add_f32 v4, v4, v17
    v_mfma_f32_16x16x32_bf16 a[168:171], v[172:175], v[24:27], a[168:171]
    v_exp_f32 v19, v83
    v_mfma_f32_16x16x32_bf16 a[168:171], v[188:191], v[28:31], a[168:171]
    s_waitcnt lgkmcnt(2)
    v_mfma_f32_16x16x32_bf16 a[28:31], v[160:163], v[32:35], a[28:31]
    ds_read_b128 v[24:27], v22 offset:768
    v_cvt_pk_bf16_f32 v80, v16, v17
    v_mfma_f32_16x16x32_bf16 a[28:31], v[176:179], v[36:39], a[28:31]
    buffer_load_dwordx4 v8, s[4:7], s27 offen offset:1024 sc1 lds
    v_mfma_f32_16x16x32_bf16 a[76:79], v[164:167], v[32:35], a[76:79]
    v_exp_f32 v16, v112
    v_mfma_f32_16x16x32_bf16 a[76:79], v[180:183], v[36:39], a[76:79]
    v_add_f32 v4, v4, v18
    v_add_f32 v4, v4, v19
    v_mfma_f32_16x16x32_bf16 a[124:127], v[168:171], v[32:35], a[124:127]
    ds_read_b128 v[28:31], v22 offset:13056
    v_add_u32 v2, s3, v2
    v_mfma_f32_16x16x32_bf16 a[124:127], v[184:187], v[36:39], a[124:127]
    v_exp_f32 v17, v113
    v_mfma_f32_16x16x32_bf16 a[172:175], v[172:175], v[32:35], a[172:175]
    v_cvt_pk_bf16_f32 v81, v18, v19
    v_mfma_f32_16x16x32_bf16 a[172:175], v[188:191], v[36:39], a[172:175]
    s_waitcnt lgkmcnt(2)
    v_exp_f32 v18, v114
    v_mfma_f32_16x16x32_bf16 a[32:35], v[160:163], v[40:43], a[32:35]
    ds_read_b128 v[32:35], v22 offset:1536
    v_add_f32 v4, v4, v16
    v_mfma_f32_16x16x32_bf16 a[32:35], v[176:179], v[44:47], a[32:35]
    buffer_load_dwordx4 v8, s[4:7], s27 offen offset:2048 sc1 lds
    v_mfma_f32_16x16x32_bf16 a[80:83], v[164:167], v[40:43], a[80:83]
    v_add_f32 v4, v4, v17
    v_add_u32 v3, s3, v3
    v_mfma_f32_16x16x32_bf16 a[80:83], v[180:183], v[44:47], a[80:83]
    v_exp_f32 v19, v115
    v_mfma_f32_16x16x32_bf16 a[128:131], v[168:171], v[40:43], a[128:131]
    ds_read_b128 v[36:39], v22 offset:13824
    v_cvt_pk_bf16_f32 v82, v16, v17
    v_mfma_f32_16x16x32_bf16 a[128:131], v[184:187], v[44:47], a[128:131]
    v_exp_f32 v16, v84
    v_mfma_f32_16x16x32_bf16 a[176:179], v[172:175], v[40:43], a[176:179]
    v_add_f32 v4, v4, v18
    v_mfma_f32_16x16x32_bf16 a[176:179], v[188:191], v[44:47], a[176:179]
    s_waitcnt lgkmcnt(2)
    v_add_f32 v4, v4, v19
    v_mfma_f32_16x16x32_bf16 a[36:39], v[160:163], v[24:27], a[36:39]
    ds_read_b128 v[40:43], v22 offset:2304
    v_mfma_f32_16x16x32_bf16 a[36:39], v[176:179], v[28:31], a[36:39]
    v_exp_f32 v17, v85
    v_mfma_f32_16x16x32_bf16 a[84:87], v[164:167], v[24:27], a[84:87]
    v_cvt_pk_bf16_f32 v83, v18, v19
    v_mfma_f32_16x16x32_bf16 a[84:87], v[180:183], v[28:31], a[84:87]
    s_add_u32 s27, s27, 24576
    v_exp_f32 v18, v86
    v_mfma_f32_16x16x32_bf16 a[132:135], v[168:171], v[24:27], a[132:135]
    s_add_u32 s56, s56, 36864
    ds_read_b128 v[44:47], v22 offset:14592
    v_add_f32 v5, v5, v16
    v_mfma_f32_16x16x32_bf16 a[132:135], v[184:187], v[28:31], a[132:135]
    s_waitcnt lgkmcnt(2)
    v_add_f32 v5, v5, v17
    v_mfma_f32_16x16x32_bf16 a[180:183], v[172:175], v[24:27], a[180:183]
    s_waitcnt vmcnt(24)
    v_exp_f32 v19, v87
    v_mfma_f32_16x16x32_bf16 a[180:183], v[188:191], v[28:31], a[180:183]
    s_barrier
    s_sub_u32 s58, s56, 147456
    v_mfma_f32_16x16x32_bf16 a[40:43], v[160:163], v[32:35], a[40:43]
    ds_read_b128 v[24:27], v2 offset:0
    v_cvt_pk_bf16_f32 v84, v16, v17
    v_mfma_f32_16x16x32_bf16 a[40:43], v[176:179], v[36:39], a[40:43]
    v_exp_f32 v16, v116
    v_mfma_f32_16x16x32_bf16 a[88:91], v[164:167], v[32:35], a[88:91]
    s_min_u32 s56, s56, s58
    v_add_f32 v5, v5, v18
    v_mfma_f32_16x16x32_bf16 a[88:91], v[180:183], v[36:39], a[88:91]
    v_add_f32 v5, v5, v19
    v_mfma_f32_16x16x32_bf16 a[136:139], v[168:171], v[32:35], a[136:139]
    ds_read_b128 v[28:31], v3 offset:0
    v_mfma_f32_16x16x32_bf16 a[136:139], v[184:187], v[36:39], a[136:139]
    v_exp_f32 v17, v117
    v_mfma_f32_16x16x32_bf16 a[184:187], v[172:175], v[32:35], a[184:187]
    v_cvt_pk_bf16_f32 v85, v18, v19
    v_mfma_f32_16x16x32_bf16 a[184:187], v[188:191], v[36:39], a[184:187]
    s_waitcnt lgkmcnt(2)
    v_exp_f32 v18, v118
    v_mfma_f32_16x16x32_bf16 a[44:47], v[160:163], v[40:43], a[44:47]
    ds_read_b128 v[32:35], v2 offset:6144
    v_add_f32 v5, v5, v16
    v_mfma_f32_16x16x32_bf16 a[44:47], v[176:179], v[44:47], a[44:47]
    v_add_f32 v5, v5, v17
    v_mfma_f32_16x16x32_bf16 a[92:95], v[164:167], v[40:43], a[92:95]
    v_exp_f32 v19, v119
    v_mfma_f32_16x16x32_bf16 a[92:95], v[180:183], v[44:47], a[92:95]
    v_mfma_f32_16x16x32_bf16 a[140:143], v[168:171], v[40:43], a[140:143]
    ds_read_b128 v[36:39], v3 offset:6144
    v_cvt_pk_bf16_f32 v86, v16, v17
    v_mfma_f32_16x16x32_bf16 a[140:143], v[184:187], v[44:47], a[140:143]
    v_add_f32 v5, v5, v18
    v_add_f32 v5, v5, v19
    v_mfma_f32_16x16x32_bf16 a[188:191], v[172:175], v[40:43], a[188:191]
    v_cvt_pk_bf16_f32 v87, v18, v19
    v_mfma_f32_16x16x32_bf16 a[188:191], v[188:191], v[44:47], a[188:191]
    s_waitcnt lgkmcnt(2)
    v_mfma_f32_16x16x32_bf16 v[160:163], v[24:27], a[192:195], v[128:131]
    s_mov_b32 m0, s26
    ds_read_b128 v[40:43], v2 offset:128
    v_mfma_f32_16x16x32_bf16 v[160:163], v[28:31], a[196:199], v[160:163]
    v_exp_f32 v16, v88
    v_mfma_f32_16x16x32_bf16 v[164:167], v[24:27], a[216:219], v[132:135]
    v_exp_f32 v17, v89
    v_mfma_f32_16x16x32_bf16 v[164:167], v[28:31], a[220:223], v[164:167]
    v_bfe_u32 v53, v8, 4, 6
    v_mfma_f32_16x16x32_bf16 v[168:171], v[24:27], a[240:243], v[136:139]
    ds_read_b128 v[44:47], v3 offset:128
    v_lshlrev_b32 v53, 2, v53
    v_mfma_f32_16x16x32_bf16 v[168:171], v[28:31], a[244:247], v[168:171]
    buffer_load_dwordx4 v8, s[4:7], s32 offen offset:0 sc1 lds
    v_mfma_f32_16x16x32_bf16 v[172:175], v[24:27], v[200:203], v[140:143]
    v_exp_f32 v18, v90
    v_mfma_f32_16x16x32_bf16 v[172:175], v[28:31], v[204:207], v[172:175]
    s_waitcnt lgkmcnt(2)
    v_add_f32 v6, v6, v16
    v_add_f32 v6, v6, v17
    v_mfma_f32_16x16x32_bf16 v[96:99], v[32:35], a[192:195], v[128:131]
    ds_read_b128 v[24:27], v2 offset:6272
    v_mfma_f32_16x16x32_bf16 v[96:99], v[36:39], a[196:199], v[96:99]
    buffer_load_dword v52, v53, s[20:23], 0 offen sc1
    v_mfma_f32_16x16x32_bf16 v[100:103], v[32:35], a[216:219], v[132:135]
    v_exp_f32 v19, v91
    v_mfma_f32_16x16x32_bf16 v[100:103], v[36:39], a[220:223], v[100:103]
    v_cvt_pk_bf16_f32 v88, v16, v17
    s_branch L_skip13
L_pad13:
    s_branch L_tb1_1
L_skip13:
    v_mfma_f32_16x16x32_bf16 v[104:107], v[32:35], a[240:243], v[136:139]
    ds_read_b128 v[28:31], v3 offset:6272
    v_mfma_f32_16x16x32_bf16 v[104:107], v[36:39], a[244:247], v[104:107]
    v_exp_f32 v16, v120
    v_mfma_f32_16x16x32_bf16 v[108:111], v[32:35], v[200:203], v[140:143]
    v_add_f32 v6, v6, v18
    v_add_f32 v6, v6, v19
    v_mfma_f32_16x16x32_bf16 v[108:111], v[36:39], v[204:207], v[108:111]
    s_waitcnt lgkmcnt(2)
    buffer_load_dwordx4 v8, s[4:7], s32 offen offset:1024 sc1 lds
    v_mfma_f32_16x16x32_bf16 v[160:163], v[40:43], a[200:203], v[160:163]
    ds_read_b128 v[32:35], v2 offset:256
    v_mfma_f32_16x16x32_bf16 v[160:163], v[44:47], a[204:207], v[160:163]
    v_exp_f32 v17, v121
    v_mfma_f32_16x16x32_bf16 v[164:167], v[40:43], a[224:227], v[164:167]
    v_cvt_pk_bf16_f32 v89, v18, v19
    v_mfma_f32_16x16x32_bf16 v[164:167], v[44:47], a[228:231], v[164:167]
    v_exp_f32 v18, v122
    v_mfma_f32_16x16x32_bf16 v[168:171], v[40:43], a[248:251], v[168:171]
    ds_read_b128 v[36:39], v3 offset:256
    v_add_f32 v6, v6, v16
    v_mfma_f32_16x16x32_bf16 v[168:171], v[44:47], a[252:255], v[168:171]
    v_add_f32 v6, v6, v17
    v_mfma_f32_16x16x32_bf16 v[172:175], v[40:43], v[208:211], v[172:175]
    v_exp_f32 v19, v123
    v_mfma_f32_16x16x32_bf16 v[172:175], v[44:47], v[212:215], v[172:175]
    s_waitcnt lgkmcnt(2)
    buffer_load_dwordx4 v8, s[4:7], s32 offen offset:2048 sc1 lds
    v_mfma_f32_16x16x32_bf16 v[96:99], v[24:27], a[200:203], v[96:99]
    ds_read_b128 v[40:43], v2 offset:6400
    v_cvt_pk_bf16_f32 v90, v16, v17
    v_mfma_f32_16x16x32_bf16 v[96:99], v[28:31], a[204:207], v[96:99]
    v_exp_f32 v16, v92
    v_mfma_f32_16x16x32_bf16 v[100:103], v[24:27], a[224:227], v[100:103]
    v_add_f32 v6, v6, v18
    v_add_f32 v6, v6, v19
    v_mfma_f32_16x16x32_bf16 v[100:103], v[28:31], a[228:231], v[100:103]
    v_exp_f32 v17, v93
    v_mfma_f32_16x16x32_bf16 v[104:107], v[24:27], a[248:251], v[104:107]
    ds_read_b128 v[44:47], v3 offset:6400
    v_cvt_pk_bf16_f32 v91, v18, v19
    v_mfma_f32_16x16x32_bf16 v[104:107], v[28:31], a[252:255], v[104:107]
    v_exp_f32 v18, v94
    v_mfma_f32_16x16x32_bf16 v[108:111], v[24:27], v[208:211], v[108:111]
    s_add_u32 s29, s30, 49152
    v_add_f32 v7, v7, v16
    s_add_u32 s32, s32, 24576
    v_mfma_f32_16x16x32_bf16 v[108:111], v[28:31], v[212:215], v[108:111]
    s_waitcnt lgkmcnt(2)
    v_add_f32 v7, v7, v17
    v_mfma_f32_16x16x32_bf16 v[160:163], v[32:35], a[208:211], v[160:163]
    s_sub_u32 s3, s29, 147456
    ds_read_b128 v[24:27], v2 offset:12288
    v_mfma_f32_16x16x32_bf16 v[160:163], v[36:39], a[212:215], v[160:163]
    v_exp_f32 v19, v95
    v_mfma_f32_16x16x32_bf16 v[164:167], v[32:35], a[232:235], v[164:167]
    v_cvt_pk_bf16_f32 v92, v16, v17
    v_mfma_f32_16x16x32_bf16 v[164:167], v[36:39], a[236:239], v[164:167]
    s_add_u32 s26, s26, 12288
    v_exp_f32 v16, v124
    v_mfma_f32_16x16x32_bf16 v[168:171], v[32:35], v[192:195], v[168:171]
    ds_read_b128 v[28:31], v3 offset:12288
    v_add_f32 v7, v7, v18
    v_mfma_f32_16x16x32_bf16 v[168:171], v[36:39], v[196:199], v[168:171]
    v_add_f32 v7, v7, v19
    v_mfma_f32_16x16x32_bf16 v[172:175], v[32:35], v[216:219], v[172:175]
    s_min_u32 s29, s29, s3
    v_mfma_f32_16x16x32_bf16 v[172:175], v[36:39], v[220:223], v[172:175]
    s_waitcnt lgkmcnt(2)
    v_exp_f32 v17, v125
    v_mfma_f32_16x16x32_bf16 v[96:99], v[40:43], a[208:211], v[96:99]
    s_mov_b32 m0, s26
    ds_read_b128 v[32:35], v2 offset:18432
    v_cvt_pk_bf16_f32 v93, v18, v19
    v_mfma_f32_16x16x32_bf16 v[96:99], v[44:47], a[212:215], v[96:99]
    v_exp_f32 v18, v126
    v_mfma_f32_16x16x32_bf16 v[100:103], v[40:43], a[232:235], v[100:103]
    v_mfma_f32_16x16x32_bf16 v[100:103], v[44:47], a[236:239], v[100:103]
    v_add_f32 v7, v7, v16
    v_mfma_f32_16x16x32_bf16 v[104:107], v[40:43], v[192:195], v[104:107]
    s_sub_u32 s3, s29, s30
    ds_read_b128 v[36:39], v3 offset:18432
    v_add_f32 v7, v7, v17
    v_mfma_f32_16x16x32_bf16 v[104:107], v[44:47], v[196:199], v[104:107]
    v_exp_f32 v19, v127
    v_mfma_f32_16x16x32_bf16 v[108:111], v[40:43], v[216:219], v[108:111]
    v_cvt_pk_bf16_f32 v94, v16, v17
    v_mfma_f32_16x16x32_bf16 v[108:111], v[44:47], v[220:223], v[108:111]
    s_waitcnt lgkmcnt(2)
    buffer_load_dwordx4 v8, s[4:7], s32 offen offset:0 sc1 lds
    v_mfma_f32_16x16x32_bf16 v[176:179], v[24:27], a[192:195], v[128:131]
    ds_read_b128 v[40:43], v2 offset:12416
    v_add_f32 v7, v7, v18
    v_mfma_f32_16x16x32_bf16 v[176:179], v[28:31], a[196:199], v[176:179]
    v_add_f32 v7, v7, v19
    v_cvt_pk_bf16_f32 v95, v18, v19
    v_mfma_f32_16x16x32_bf16 v[180:183], v[24:27], a[216:219], v[132:135]
    s_mov_b32 s30, s29
    v_mfma_f32_16x16x32_bf16 v[180:183], v[28:31], a[220:223], v[180:183]
    v_mfma_f32_16x16x32_bf16 v[184:187], v[24:27], a[240:243], v[136:139]
    ds_read_b128 v[44:47], v3 offset:12416
    v_mfma_f32_16x16x32_bf16 v[184:187], v[28:31], a[244:247], v[184:187]
    v_exp_f32 v16, v160
    v_mfma_f32_16x16x32_bf16 v[188:191], v[24:27], v[200:203], v[140:143]
    v_exp_f32 v17, v161
    v_mfma_f32_16x16x32_bf16 v[188:191], v[28:31], v[204:207], v[188:191]
    s_waitcnt lgkmcnt(2)
    v_exp_f32 v18, v162
    v_mfma_f32_16x16x32_bf16 v[112:115], v[32:35], a[192:195], v[128:131]
    ds_read_b128 v[24:27], v2 offset:18560
    v_add_f32 v4, v4, v16
    v_mfma_f32_16x16x32_bf16 v[112:115], v[36:39], a[196:199], v[112:115]
    buffer_load_dwordx4 v8, s[4:7], s32 offen offset:1024 sc1 lds
    v_mfma_f32_16x16x32_bf16 v[116:119], v[32:35], a[216:219], v[132:135]
    v_add_f32 v4, v4, v17
    v_add_u32 v1, s3, v1
    v_mfma_f32_16x16x32_bf16 v[116:119], v[36:39], a[220:223], v[116:119]
    v_exp_f32 v19, v163
    v_mfma_f32_16x16x32_bf16 v[120:123], v[32:35], a[240:243], v[136:139]
    ds_read_b128 v[28:31], v3 offset:18560
    v_cvt_pk_bf16_f32 v160, v16, v17
    v_mfma_f32_16x16x32_bf16 v[120:123], v[36:39], a[244:247], v[120:123]
    buffer_load_dword v0, v8, s[88:91], s93 offen
    v_mfma_f32_16x16x32_bf16 v[124:127], v[32:35], v[200:203], v[140:143]
    v_exp_f32 v16, v96
    v_mfma_f32_16x16x32_bf16 v[124:127], v[36:39], v[204:207], v[124:127]
    s_waitcnt lgkmcnt(2)
    v_add_f32 v4, v4, v18
    v_add_f32 v4, v4, v19
    v_mfma_f32_16x16x32_bf16 v[176:179], v[40:43], a[200:203], v[176:179]
    ds_read_b128 v[32:35], v2 offset:12544
    v_add_u32 v21, s3, v21
    v_mfma_f32_16x16x32_bf16 v[176:179], v[44:47], a[204:207], v[176:179]
    buffer_load_dwordx4 v8, s[4:7], s32 offen offset:2048 sc1 lds
    v_mfma_f32_16x16x32_bf16 v[180:183], v[40:43], a[224:227], v[180:183]
    v_exp_f32 v17, v97
    v_mfma_f32_16x16x32_bf16 v[180:183], v[44:47], a[228:231], v[180:183]
    v_cvt_pk_bf16_f32 v161, v18, v19
    v_mfma_f32_16x16x32_bf16 v[184:187], v[40:43], a[248:251], v[184:187]
    ds_read_b128 v[36:39], v3 offset:12544
    v_add_u32 v22, s3, v22
    v_mfma_f32_16x16x32_bf16 v[184:187], v[44:47], a[252:255], v[184:187]
    v_exp_f32 v18, v98
    v_mfma_f32_16x16x32_bf16 v[188:191], v[40:43], v[208:211], v[188:191]
    v_add_f32 v4, v4, v16
    v_add_f32 v4, v4, v17
    v_mfma_f32_16x16x32_bf16 v[188:191], v[44:47], v[212:215], v[188:191]
    s_waitcnt lgkmcnt(2)
    v_exp_f32 v19, v99
    v_mfma_f32_16x16x32_bf16 v[112:115], v[24:27], a[200:203], v[112:115]
    ds_read_b128 v[40:43], v2 offset:18688
    v_cvt_pk_bf16_f32 v162, v16, v17
    v_mfma_f32_16x16x32_bf16 v[112:115], v[28:31], a[204:207], v[112:115]
    v_exp_f32 v16, v164
    v_mfma_f32_16x16x32_bf16 v[116:119], v[24:27], a[224:227], v[116:119]
    v_add_f32 v4, v4, v18
    v_add_f32 v4, v4, v19
    v_mfma_f32_16x16x32_bf16 v[116:119], v[28:31], a[228:231], v[116:119]
    s_add_u32 s32, s32, 24576
    v_exp_f32 v17, v165
    v_mfma_f32_16x16x32_bf16 v[120:123], v[24:27], a[248:251], v[120:123]
    s_add_u32 s26, s26, 36864
    ds_read_b128 v[44:47], v3 offset:18688
    v_cvt_pk_bf16_f32 v163, v18, v19
    v_mfma_f32_16x16x32_bf16 v[120:123], v[28:31], a[252:255], v[120:123]
    s_waitcnt lgkmcnt(2)
    v_exp_f32 v18, v166
    v_mfma_f32_16x16x32_bf16 v[124:127], v[24:27], v[208:211], v[124:127]
    s_waitcnt vmcnt(21)
    v_add_f32 v5, v5, v16
    v_mfma_f32_16x16x32_bf16 v[124:127], v[28:31], v[212:215], v[124:127]
    s_barrier
    v_add_f32 v5, v5, v17
    v_mfma_f32_16x16x32_bf16 v[176:179], v[32:35], a[208:211], v[176:179]
    s_sub_u32 s57, s26, 147456
    ds_read_b128 v[24:27], v1 offset:0
    v_mfma_f32_16x16x32_bf16 v[176:179], v[36:39], a[212:215], v[176:179]
    v_exp_f32 v19, v167
    v_mfma_f32_16x16x32_bf16 v[180:183], v[32:35], a[232:235], v[180:183]
    s_min_u32 s26, s26, s57
    v_cvt_pk_bf16_f32 v164, v16, v17
    v_mfma_f32_16x16x32_bf16 v[180:183], v[36:39], a[236:239], v[180:183]
    v_exp_f32 v16, v100
    v_mfma_f32_16x16x32_bf16 v[184:187], v[32:35], v[192:195], v[184:187]
    ds_read_b128 v[28:31], v1 offset:12288
    v_add_f32 v5, v5, v18
    v_mfma_f32_16x16x32_bf16 v[184:187], v[36:39], v[196:199], v[184:187]
    v_add_f32 v5, v5, v19
    v_mfma_f32_16x16x32_bf16 v[188:191], v[32:35], v[216:219], v[188:191]
    v_exp_f32 v17, v101
    v_mfma_f32_16x16x32_bf16 v[188:191], v[36:39], v[220:223], v[188:191]
    s_waitcnt lgkmcnt(2)
    v_cvt_pk_bf16_f32 v165, v18, v19
    v_mfma_f32_16x16x32_bf16 v[112:115], v[40:43], a[208:211], v[112:115]
    ds_read_b128 v[32:35], v1 offset:768
    v_mfma_f32_16x16x32_bf16 v[112:115], v[44:47], a[212:215], v[112:115]
    v_exp_f32 v18, v102
    v_mfma_f32_16x16x32_bf16 v[116:119], v[40:43], a[232:235], v[116:119]
    v_add_f32 v5, v5, v16
    v_add_f32 v5, v5, v17
    v_mfma_f32_16x16x32_bf16 v[116:119], v[44:47], a[236:239], v[116:119]
    v_exp_f32 v19, v103
    v_mfma_f32_16x16x32_bf16 v[120:123], v[40:43], v[192:195], v[120:123]
    ds_read_b128 v[36:39], v1 offset:13056
    v_cvt_pk_bf16_f32 v166, v16, v17
    v_mfma_f32_16x16x32_bf16 v[120:123], v[44:47], v[196:199], v[120:123]
    v_add_f32 v5, v5, v18
    v_mfma_f32_16x16x32_bf16 v[124:127], v[40:43], v[216:219], v[124:127]
    v_add_f32 v5, v5, v19
    v_cvt_pk_bf16_f32 v167, v18, v19
    v_mfma_f32_16x16x32_bf16 v[124:127], v[44:47], v[220:223], v[124:127]
    s_waitcnt lgkmcnt(2)
    v_mfma_f32_16x16x32_bf16 a[0:3], v[64:67], v[24:27], a[0:3]
    ds_read_b128 v[40:43], v1 offset:1536
    v_mfma_f32_16x16x32_bf16 a[0:3], v[80:83], v[28:31], a[0:3]
    v_exp_f32 v16, v168
    v_mfma_f32_16x16x32_bf16 a[48:51], v[68:71], v[24:27], a[48:51]
    v_exp_f32 v17, v169
    v_mfma_f32_16x16x32_bf16 a[48:51], v[84:87], v[28:31], a[48:51]
    v_exp_f32 v18, v170
    v_mfma_f32_16x16x32_bf16 a[96:99], v[72:75], v[24:27], a[96:99]
    ds_read_b128 v[44:47], v1 offset:13824
    v_add_f32 v6, v6, v16
    v_mfma_f32_16x16x32_bf16 a[96:99], v[88:91], v[28:31], a[96:99]
    v_add_f32 v6, v6, v17
    v_mfma_f32_16x16x32_bf16 a[144:147], v[76:79], v[24:27], a[144:147]
    v_exp_f32 v19, v171
    v_mfma_f32_16x16x32_bf16 a[144:147], v[92:95], v[28:31], a[144:147]
    s_waitcnt lgkmcnt(2)
    v_mfma_f32_16x16x32_bf16 a[4:7], v[64:67], v[32:35], a[4:7]
    ds_read_b128 v[24:27], v1 offset:2304
    v_cvt_pk_bf16_f32 v168, v16, v17
    v_mfma_f32_16x16x32_bf16 a[4:7], v[80:83], v[36:39], a[4:7]
    v_exp_f32 v16, v104
    v_mfma_f32_16x16x32_bf16 a[52:55], v[68:71], v[32:35], a[52:55]
    v_add_f32 v6, v6, v18
    v_mfma_f32_16x16x32_bf16 a[52:55], v[84:87], v[36:39], a[52:55]
    v_add_f32 v6, v6, v19
    v_mfma_f32_16x16x32_bf16 a[100:103], v[72:75], v[32:35], a[100:103]
    ds_read_b128 v[28:31], v1 offset:14592
    v_mfma_f32_16x16x32_bf16 a[100:103], v[88:91], v[36:39], a[100:103]
    v_exp_f32 v17, v105
    v_mfma_f32_16x16x32_bf16 a[148:151], v[76:79], v[32:35], a[148:151]
    v_cvt_pk_bf16_f32 v169, v18, v19
    v_mfma_f32_16x16x32_bf16 a[148:151], v[92:95], v[36:39], a[148:151]
    s_waitcnt lgkmcnt(2)
    v_exp_f32 v18, v106
    v_mfma_f32_16x16x32_bf16 a[8:11], v[64:67], v[40:43], a[8:11]
    ds_read_b128 v[32:35], v21 offset:0
    v_add_f32 v6, v6, v16
    v_mfma_f32_16x16x32_bf16 a[8:11], v[80:83], v[44:47], a[8:11]
    v_add_f32 v6, v6, v17
    v_mfma_f32_16x16x32_bf16 a[56:59], v[68:71], v[40:43], a[56:59]
    v_exp_f32 v19, v107
    v_mfma_f32_16x16x32_bf16 a[56:59], v[84:87], v[44:47], a[56:59]
    v_mfma_f32_16x16x32_bf16 a[104:107], v[72:75], v[40:43], a[104:107]
    ds_read_b128 v[36:39], v21 offset:12288
    v_cvt_pk_bf16_f32 v170, v16, v17
    v_mfma_f32_16x16x32_bf16 a[104:107], v[88:91], v[44:47], a[104:107]
    v_exp_f32 v16, v172
    v_mfma_f32_16x16x32_bf16 a[152:155], v[76:79], v[40:43], a[152:155]
    v_add_f32 v6, v6, v18
    v_mfma_f32_16x16x32_bf16 a[152:155], v[92:95], v[44:47], a[152:155]
    s_waitcnt lgkmcnt(2)
    v_add_f32 v6, v6, v19
    v_mfma_f32_16x16x32_bf16 a[12:15], v[64:67], v[24:27], a[12:15]
    ds_read_b128 v[40:43], v21 offset:768
    v_mfma_f32_16x16x32_bf16 a[12:15], v[80:83], v[28:31], a[12:15]
    v_exp_f32 v17, v173
    v_mfma_f32_16x16x32_bf16 a[60:63], v[68:71], v[24:27], a[60:63]
    v_cvt_pk_bf16_f32 v171, v18, v19
    v_mfma_f32_16x16x32_bf16 a[60:63], v[84:87], v[28:31], a[60:63]
    v_exp_f32 v18, v174
    v_mfma_f32_16x16x32_bf16 a[108:111], v[72:75], v[24:27], a[108:111]
    ds_read_b128 v[44:47], v21 offset:13056
    v_add_f32 v7, v7, v16
    v_mfma_f32_16x16x32_bf16 a[108:111], v[88:91], v[28:31], a[108:111]
    s_waitcnt vmcnt(6)
    v_subrev_u32 v52, s92, v52
    v_cmp_lt_u32 vcc, 15, v52
    v_mfma_f32_16x16x32_bf16 a[156:159], v[76:79], v[24:27], a[156:159]
    s_add_u32 s29, s28, 49152
    v_add_f32 v7, v7, v17
    v_mfma_f32_16x16x32_bf16 a[156:159], v[92:95], v[28:31], a[156:159]
    s_waitcnt lgkmcnt(2)
    v_exp_f32 v19, v175
    v_mfma_f32_16x16x32_bf16 a[16:19], v[64:67], v[32:35], a[16:19]
    s_and_b32 s59, vcc_lo, 0xff
    ds_read_b128 v[24:27], v21 offset:1536
    v_cvt_pk_bf16_f32 v172, v16, v17
    v_mfma_f32_16x16x32_bf16 a[16:19], v[80:83], v[36:39], a[16:19]
    s_cbranch_scc1 L_pollslow7
L_pollok7:
    v_mfma_f32_16x16x32_bf16 a[64:67], v[68:71], v[32:35], a[64:67]
    s_sub_u32 s3, s29, 147456
    v_exp_f32 v16, v108
    v_mfma_f32_16x16x32_bf16 a[64:67], v[84:87], v[36:39], a[64:67]
    v_add_f32 v7, v7, v18
    v_add_f32 v7, v7, v19
    v_mfma_f32_16x16x32_bf16 a[112:115], v[72:75], v[32:35], a[112:115]
    s_mov_b32 m0, s56
    ds_read_b128 v[28:31], v21 offset:13824
    v_mfma_f32_16x16x32_bf16 a[112:115], v[88:91], v[36:39], a[112:115]
    v_exp_f32 v17, v109
    v_mfma_f32_16x16x32_bf16 a[160:163], v[76:79], v[32:35], a[160:163]
    v_cvt_pk_bf16_f32 v173, v18, v19
    v_mfma_f32_16x16x32_bf16 a[160:163], v[92:95], v[36:39], a[160:163]
    s_waitcnt lgkmcnt(2)
    buffer_load_dwordx4 v8, s[4:7], s27 offen offset:0 sc1 lds
    v_mfma_f32_16x16x32_bf16 a[20:23], v[64:67], v[40:43], a[20:23]
    s_min_u32 s29, s29, s3
    ds_read_b128 v[32:35], v21 offset:2304
    v_mfma_f32_16x16x32_bf16 a[20:23], v[80:83], v[44:47], a[20:23]
    v_exp_f32 v18, v110
    v_mfma_f32_16x16x32_bf16 a[68:71], v[68:71], v[40:43], a[68:71]
    v_add_f32 v7, v7, v16
    v_add_f32 v7, v7, v17
    v_mfma_f32_16x16x32_bf16 a[68:71], v[84:87], v[44:47], a[68:71]
    buffer_load_dwordx4 v8, s[4:7], s27 offen offset:1024 sc1 lds
    v_mfma_f32_16x16x32_bf16 a[116:119], v[72:75], v[40:43], a[116:119]
    ds_read_b128 v[36:39], v21 offset:14592
    v_mfma_f32_16x16x32_bf16 a[116:119], v[88:91], v[44:47], a[116:119]
    v_exp_f32 v19, v111
    v_mfma_f32_16x16x32_bf16 a[164:167], v[76:79], v[40:43], a[164:167]
    s_sub_u32 s3, s29, s28
    v_cvt_pk_bf16_f32 v174, v16, v17
    v_mfma_f32_16x16x32_bf16 a[164:167], v[92:95], v[44:47], a[164:167]
    s_waitcnt lgkmcnt(2)
    v_exp_f32 v16, v176
    v_mfma_f32_16x16x32_bf16 a[24:27], v[64:67], v[24:27], a[24:27]
    ds_read_b128 v[40:43], v22 offset:0
    v_add_f32 v7, v7, v18
    v_mfma_f32_16x16x32_bf16 a[24:27], v[80:83], v[28:31], a[24:27]
    buffer_load_dwordx4 v8, s[4:7], s27 offen offset:2048 sc1 lds
    v_mfma_f32_16x16x32_bf16 a[72:75], v[68:71], v[24:27], a[72:75]
    v_add_f32 v7, v7, v19
    v_mfma_f32_16x16x32_bf16 a[72:75], v[84:87], v[28:31], a[72:75]
    v_exp_f32 v17, v177
    v_mfma_f32_16x16x32_bf16 a[120:123], v[72:75], v[24:27], a[120:123]
    s_add_u32 s27, s27, 24576
    ds_read_b128 v[44:47], v22 offset:12288
    v_cvt_pk_bf16_f32 v175, v18, v19
    v_mfma_f32_16x16x32_bf16 a[120:123], v[88:91], v[28:31], a[120:123]
    s_mov_b32 s28, s29
    v_exp_f32 v18, v178
    v_mfma_f32_16x16x32_bf16 a[168:171], v[76:79], v[24:27], a[168:171]
    v_add_f32 v4, v4, v16
    v_add_f32 v4, v4, v17
    v_mfma_f32_16x16x32_bf16 a[168:171], v[92:95], v[28:31], a[168:171]
    s_waitcnt lgkmcnt(2)
    v_exp_f32 v19, v179
    v_mfma_f32_16x16x32_bf16 a[28:31], v[64:67], v[32:35], a[28:31]
    s_add_u32 s56, s56, 12288
    ds_read_b128 v[24:27], v22 offset:768
    v_cvt_pk_bf16_f32 v176, v16, v17
    v_mfma_f32_16x16x32_bf16 a[28:31], v[80:83], v[36:39], a[28:31]
    s_mov_b32 m0, s56
    v_exp_f32 v16, v112
    v_mfma_f32_16x16x32_bf16 a[76:79], v[68:71], v[32:35], a[76:79]
    v_add_f32 v4, v4, v18
    v_mfma_f32_16x16x32_bf16 a[76:79], v[84:87], v[36:39], a[76:79]
    v_add_f32 v4, v4, v19
    v_mfma_f32_16x16x32_bf16 a[124:127], v[72:75], v[32:35], a[124:127]
    ds_read_b128 v[28:31], v22 offset:13056
    v_add_u32 v2, s3, v2
    v_mfma_f32_16x16x32_bf16 a[124:127], v[88:91], v[36:39], a[124:127]
    buffer_load_dwordx4 v8, s[4:7], s27 offen offset:0 sc1 lds
    v_mfma_f32_16x16x32_bf16 a[172:175], v[76:79], v[32:35], a[172:175]
    v_exp_f32 v17, v113
    v_mfma_f32_16x16x32_bf16 a[172:175], v[92:95], v[36:39], a[172:175]
    s_waitcnt lgkmcnt(2)
    v_cvt_pk_bf16_f32 v177, v18, v19
    v_mfma_f32_16x16x32_bf16 a[32:35], v[64:67], v[40:43], a[32:35]
    ds_read_b128 v[32:35], v22 offset:1536
    v_mfma_f32_16x16x32_bf16 a[32:35], v[80:83], v[44:47], a[32:35]
    v_exp_f32 v18, v114
    v_mfma_f32_16x16x32_bf16 a[80:83], v[68:71], v[40:43], a[80:83]
    v_add_f32 v4, v4, v16
    v_add_f32 v4, v4, v17
    v_mfma_f32_16x16x32_bf16 a[80:83], v[84:87], v[44:47], a[80:83]
    buffer_load_dwordx4 v8, s[4:7], s27 offen offset:1024 sc1 lds
    v_mfma_f32_16x16x32_bf16 a[128:131], v[72:75], v[40:43], a[128:131]
    ds_read_b128 v[36:39], v22 offset:13824
    v_add_u32 v3, s3, v3
    v_mfma_f32_16x16x32_bf16 a[128:131], v[88:91], v[44:47], a[128:131]
    v_exp_f32 v19, v115
    v_mfma_f32_16x16x32_bf16 a[176:179], v[76:79], v[40:43], a[176:179]
    v_cvt_pk_bf16_f32 v178, v16, v17
    v_mfma_f32_16x16x32_bf16 a[176:179], v[92:95], v[44:47], a[176:179]
    s_waitcnt lgkmcnt(2)
    buffer_load_dwordx4 v8, s[4:7], s27 offen offset:2048 sc1 lds
    v_mfma_f32_16x16x32_bf16 a[36:39], v[64:67], v[24:27], a[36:39]
    ds_read_b128 v[40:43], v22 offset:2304
    v_mfma_f32_16x16x32_bf16 a[36:39], v[80:83], v[28:31], a[36:39]
    v_exp_f32 v16, v180
    v_mfma_f32_16x16x32_bf16 a[84:87], v[68:71], v[24:27], a[84:87]
    v_add_f32 v4, v4, v18
    v_add_f32 v4, v4, v19
    v_mfma_f32_16x16x32_bf16 a[84:87], v[84:87], v[28:31], a[84:87]
    v_exp_f32 v17, v181
    v_mfma_f32_16x16x32_bf16 a[132:135], v[72:75], v[24:27], a[132:135]
    ds_read_b128 v[44:47], v22 offset:14592
    v_cvt_pk_bf16_f32 v179, v18, v19
    v_mfma_f32_16x16x32_bf16 a[132:135], v[88:91], v[28:31], a[132:135]
    s_waitcnt lgkmcnt(2)
    v_exp_f32 v18, v182
    v_mfma_f32_16x16x32_bf16 a[180:183], v[76:79], v[24:27], a[180:183]
    s_waitcnt vmcnt(21)
    v_add_f32 v5, v5, v16
    v_add_f32 v5, v5, v17
    v_mfma_f32_16x16x32_bf16 a[180:183], v[92:95], v[28:31], a[180:183]
    s_barrier
    s_add_u32 s27, s27, 24576
    v_mfma_f32_16x16x32_bf16 a[40:43], v[64:67], v[32:35], a[40:43]
    s_add_u32 s56, s56, 36864
    ds_read_b128 v[24:27], v2 offset:0
    v_mfma_f32_16x16x32_bf16 a[40:43], v[80:83], v[36:39], a[40:43]
    s_sub_u32 s58, s56, 147456
    v_exp_f32 v19, v183
    v_mfma_f32_16x16x32_bf16 a[88:91], v[68:71], v[32:35], a[88:91]
    v_cvt_pk_bf16_f32 v180, v16, v17
    v_mfma_f32_16x16x32_bf16 a[88:91], v[84:87], v[36:39], a[88:91]
    v_exp_f32 v16, v116
    v_mfma_f32_16x16x32_bf16 a[136:139], v[72:75], v[32:35], a[136:139]
    s_min_u32 s56, s56, s58
    ds_read_b128 v[28:31], v3 offset:0
    v_add_f32 v5, v5, v18
    v_mfma_f32_16x16x32_bf16 a[136:139], v[88:91], v[36:39], a[136:139]
    v_add_f32 v5, v5, v19
    v_mfma_f32_16x16x32_bf16 a[184:187], v[76:79], v[32:35], a[184:187]
    v_exp_f32 v17, v117
    v_mfma_f32_16x16x32_bf16 a[184:187], v[92:95], v[36:39], a[184:187]
    s_waitcnt lgkmcnt(2)
    v_cvt_pk_bf16_f32 v181, v18, v19
    v_mfma_f32_16x16x32_bf16 a[44:47], v[64:67], v[40:43], a[44:47]
    ds_read_b128 v[32:35], v2 offset:6144
    v_mfma_f32_16x16x32_bf16 a[44:47], v[80:83], v[44:47], a[44:47]
    v_exp_f32 v18, v118
    v_mfma_f32_16x16x32_bf16 a[92:95], v[68:71], v[40:43], a[92:95]
    v_add_f32 v5, v5, v16
    v_add_f32 v5, v5, v17
    v_mfma_f32_16x16x32_bf16 a[92:95], v[84:87], v[44:47], a[92:95]
    v_exp_f32 v19, v119
    v_mfma_f32_16x16x32_bf16 a[140:143], v[72:75], v[40:43], a[140:143]
    ds_read_b128 v[36:39], v3 offset:6144
    v_cvt_pk_bf16_f32 v182, v16, v17
    v_mfma_f32_16x16x32_bf16 a[140:143], v[88:91], v[44:47], a[140:143]
    v_add_f32 v5, v5, v18
    v_add_f32 v5, v5, v19
    v_mfma_f32_16x16x32_bf16 a[188:191], v[76:79], v[40:43], a[188:191]
    v_cvt_pk_bf16_f32 v183, v18, v19
    v_mfma_f32_16x16x32_bf16 a[188:191], v[92:95], v[44:47], a[188:191]
    s_waitcnt lgkmcnt(2)
    v_mfma_f32_16x16x32_bf16 v[64:67], v[24:27], a[192:195], v[128:131]
    s_mov_b32 m0, s26
    ds_read_b128 v[40:43], v2 offset:128
    v_mfma_f32_16x16x32_bf16 v[64:67], v[28:31], a[196:199], v[64:67]
    v_exp_f32 v16, v184
    v_mfma_f32_16x16x32_bf16 v[68:71], v[24:27], a[216:219], v[132:135]
    v_exp_f32 v17, v185
    v_mfma_f32_16x16x32_bf16 v[68:71], v[28:31], a[220:223], v[68:71]
    v_exp_f32 v18, v186
    v_mfma_f32_16x16x32_bf16 v[72:75], v[24:27], a[240:243], v[136:139]
    ds_read_b128 v[44:47], v3 offset:128
    v_mfma_f32_16x16x32_bf16 v[72:75], v[28:31], a[244:247], v[72:75]
    buffer_load_dwordx4 v8, s[4:7], s32 offen offset:0 sc1 lds
    v_mfma_f32_16x16x32_bf16 v[76:79], v[24:27], v[200:203], v[140:143]
    v_add_f32 v6, v6, v16
    v_add_f32 v6, v6, v17
    v_mfma_f32_16x16x32_bf16 v[76:79], v[28:31], v[204:207], v[76:79]
    s_waitcnt lgkmcnt(2)
    v_exp_f32 v19, v187
    v_mfma_f32_16x16x32_bf16 v[96:99], v[32:35], a[192:195], v[128:131]
    ds_read_b128 v[24:27], v2 offset:6272
    v_cvt_pk_bf16_f32 v184, v16, v17
    v_mfma_f32_16x16x32_bf16 v[96:99], v[36:39], a[196:199], v[96:99]
    v_mfma_f32_16x16x32_bf16 v[100:103], v[32:35], a[216:219], v[132:135]
    v_exp_f32 v16, v120
    v_mfma_f32_16x16x32_bf16 v[100:103], v[36:39], a[220:223], v[100:103]
    v_add_f32 v6, v6, v18
    v_mfma_f32_16x16x32_bf16 v[104:107], v[32:35], a[240:243], v[136:139]
    ds_read_b128 v[28:31], v3 offset:6272
    v_add_f32 v6, v6, v19
    v_mfma_f32_16x16x32_bf16 v[104:107], v[36:39], a[244:247], v[104:107]
    v_exp_f32 v17, v121
    v_mfma_f32_16x16x32_bf16 v[108:111], v[32:35], v[200:203], v[140:143]
    v_mfma_f32_16x16x32_bf16 v[108:111], v[36:39], v[204:207], v[108:111]
    s_waitcnt lgkmcnt(2)
    buffer_load_dwordx4 v8, s[4:7], s32 offen offset:1024 sc1 lds
    v_mfma_f32_16x16x32_bf16 v[64:67], v[40:43], a[200:203], v[64:67]
    ds_read_b128 v[32:35], v2 offset:256
    v_cvt_pk_bf16_f32 v185, v18, v19
    v_mfma_f32_16x16x32_bf16 v[64:67], v[44:47], a[204:207], v[64:67]
    v_exp_f32 v18, v122
    v_mfma_f32_16x16x32_bf16 v[68:71], v[40:43], a[224:227], v[68:71]
    v_add_f32 v6, v6, v16
    v_add_f32 v6, v6, v17
    v_mfma_f32_16x16x32_bf16 v[68:71], v[44:47], a[228:231], v[68:71]
    v_mfma_f32_16x16x32_bf16 v[72:75], v[40:43], a[248:251], v[72:75]
    ds_read_b128 v[36:39], v3 offset:256
    v_mfma_f32_16x16x32_bf16 v[72:75], v[44:47], a[252:255], v[72:75]
    v_exp_f32 v19, v123
    v_mfma_f32_16x16x32_bf16 v[76:79], v[40:43], v[208:211], v[76:79]
    v_cvt_pk_bf16_f32 v186, v16, v17
    v_mfma_f32_16x16x32_bf16 v[76:79], v[44:47], v[212:215], v[76:79]
    s_waitcnt lgkmcnt(2)
    buffer_load_dwordx4 v8, s[4:7], s32 offen offset:2048 sc1 lds
    v_mfma_f32_16x16x32_bf16 v[96:99], v[24:27], a[200:203], v[96:99]
    ds_read_b128 v[40:43], v2 offset:6400
    v_mfma_f32_16x16x32_bf16 v[96:99], v[28:31], a[204:207], v[96:99]
    v_exp_f32 v16, v188
    v_mfma_f32_16x16x32_bf16 v[100:103], v[24:27], a[224:227], v[100:103]
    v_add_f32 v6, v6, v18
    v_add_f32 v6, v6, v19
    v_mfma_f32_16x16x32_bf16 v[100:103], v[28:31], a[228:231], v[100:103]
    v_exp_f32 v17, v189
    v_mfma_f32_16x16x32_bf16 v[104:107], v[24:27], a[248:251], v[104:107]
    ds_read_b128 v[44:47], v3 offset:6400
    v_cvt_pk_bf16_f32 v187, v18, v19
    v_mfma_f32_16x16x32_bf16 v[104:107], v[28:31], a[252:255], v[104:107]
    v_exp_f32 v18, v190
    v_mfma_f32_16x16x32_bf16 v[108:111], v[24:27], v[208:211], v[108:111]
    s_add_u32 s29, s30, 49152
    v_add_f32 v7, v7, v16
    s_add_u32 s32, s32, 24576
    v_mfma_f32_16x16x32_bf16 v[108:111], v[28:31], v[212:215], v[108:111]
    s_waitcnt lgkmcnt(2)
    v_add_f32 v7, v7, v17
    v_mfma_f32_16x16x32_bf16 v[64:67], v[32:35], a[208:211], v[64:67]
    s_sub_u32 s3, s29, 147456
    ds_read_b128 v[24:27], v2 offset:12288
    v_mfma_f32_16x16x32_bf16 v[64:67], v[36:39], a[212:215], v[64:67]
    v_exp_f32 v19, v191
    v_mfma_f32_16x16x32_bf16 v[68:71], v[32:35], a[232:235], v[68:71]
    v_cvt_pk_bf16_f32 v188, v16, v17
    v_mfma_f32_16x16x32_bf16 v[68:71], v[36:39], a[236:239], v[68:71]
    s_add_u32 s26, s26, 12288
    v_exp_f32 v16, v124
    v_mfma_f32_16x16x32_bf16 v[72:75], v[32:35], v[192:195], v[72:75]
    ds_read_b128 v[28:31], v3 offset:12288
    v_add_f32 v7, v7, v18
    v_mfma_f32_16x16x32_bf16 v[72:75], v[36:39], v[196:199], v[72:75]
    v_add_f32 v7, v7, v19
    v_mfma_f32_16x16x32_bf16 v[76:79], v[32:35], v[216:219], v[76:79]
    s_min_u32 s29, s29, s3
    v_mfma_f32_16x16x32_bf16 v[76:79], v[36:39], v[220:223], v[76:79]
    s_waitcnt lgkmcnt(2)
    v_exp_f32 v17, v125
    v_mfma_f32_16x16x32_bf16 v[96:99], v[40:43], a[208:211], v[96:99]
    s_mov_b32 m0, s26
    ds_read_b128 v[32:35], v2 offset:18432
    v_cvt_pk_bf16_f32 v189, v18, v19
    v_mfma_f32_16x16x32_bf16 v[96:99], v[44:47], a[212:215], v[96:99]
    v_exp_f32 v18, v126
    v_mfma_f32_16x16x32_bf16 v[100:103], v[40:43], a[232:235], v[100:103]
    v_mfma_f32_16x16x32_bf16 v[100:103], v[44:47], a[236:239], v[100:103]
    v_add_f32 v7, v7, v16
    v_mfma_f32_16x16x32_bf16 v[104:107], v[40:43], v[192:195], v[104:107]
    s_sub_u32 s3, s29, s30
    ds_read_b128 v[36:39], v3 offset:18432
    v_add_f32 v7, v7, v17
    v_mfma_f32_16x16x32_bf16 v[104:107], v[44:47], v[196:199], v[104:107]
    v_exp_f32 v19, v127
    v_mfma_f32_16x16x32_bf16 v[108:111], v[40:43], v[216:219], v[108:111]
    v_cvt_pk_bf16_f32 v190, v16, v17
    v_mfma_f32_16x16x32_bf16 v[108:111], v[44:47], v[220:223], v[108:111]
    s_waitcnt lgkmcnt(2)
    buffer_load_dwordx4 v8, s[4:7], s32 offen offset:0 sc1 lds
    v_mfma_f32_16x16x32_bf16 v[80:83], v[24:27], a[192:195], v[128:131]
    ds_read_b128 v[40:43], v2 offset:12416
    v_add_f32 v7, v7, v18
    v_mfma_f32_16x16x32_bf16 v[80:83], v[28:31], a[196:199], v[80:83]
    v_add_f32 v7, v7, v19
    v_cvt_pk_bf16_f32 v191, v18, v19
    v_mfma_f32_16x16x32_bf16 v[84:87], v[24:27], a[216:219], v[132:135]
    s_mov_b32 s30, s29
    v_mfma_f32_16x16x32_bf16 v[84:87], v[28:31], a[220:223], v[84:87]
    v_mfma_f32_16x16x32_bf16 v[88:91], v[24:27], a[240:243], v[136:139]
    ds_read_b128 v[44:47], v3 offset:12416
    v_mfma_f32_16x16x32_bf16 v[88:91], v[28:31], a[244:247], v[88:91]
    v_exp_f32 v16, v64
    v_mfma_f32_16x16x32_bf16 v[92:95], v[24:27], v[200:203], v[140:143]
    v_exp_f32 v17, v65
    v_mfma_f32_16x16x32_bf16 v[92:95], v[28:31], v[204:207], v[92:95]
    s_waitcnt lgkmcnt(2)
    v_exp_f32 v18, v66
    v_mfma_f32_16x16x32_bf16 v[112:115], v[32:35], a[192:195], v[128:131]
    ds_read_b128 v[24:27], v2 offset:18560
    v_add_f32 v4, v4, v16
    v_mfma_f32_16x16x32_bf16 v[112:115], v[36:39], a[196:199], v[112:115]
    buffer_load_dwordx4 v8, s[4:7], s32 offen offset:1024 sc1 lds
    v_mfma_f32_16x16x32_bf16 v[116:119], v[32:35], a[216:219], v[132:135]
    v_add_f32 v4, v4, v17
    v_add_u32 v1, s3, v1
    v_mfma_f32_16x16x32_bf16 v[116:119], v[36:39], a[220:223], v[116:119]
    v_exp_f32 v19, v67
    v_mfma_f32_16x16x32_bf16 v[120:123], v[32:35], a[240:243], v[136:139]
    ds_read_b128 v[28:31], v3 offset:18560
    v_cvt_pk_bf16_f32 v64, v16, v17
    v_mfma_f32_16x16x32_bf16 v[120:123], v[36:39], a[244:247], v[120:123]
    v_exp_f32 v16, v96
    v_mfma_f32_16x16x32_bf16 v[124:127], v[32:35], v[200:203], v[140:143]
    v_add_f32 v4, v4, v18
    v_add_f32 v4, v4, v19
    v_mfma_f32_16x16x32_bf16 v[124:127], v[36:39], v[204:207], v[124:127]
    s_waitcnt lgkmcnt(2)
    v_exp_f32 v17, v97
    v_mfma_f32_16x16x32_bf16 v[80:83], v[40:43], a[200:203], v[80:83]
    ds_read_b128 v[32:35], v2 offset:12544
    v_add_u32 v21, s3, v21
    v_mfma_f32_16x16x32_bf16 v[80:83], v[44:47], a[204:207], v[80:83]
    buffer_load_dwordx4 v8, s[4:7], s32 offen offset:2048 sc1 lds
    v_mfma_f32_16x16x32_bf16 v[84:87], v[40:43], a[224:227], v[84:87]
    v_cvt_pk_bf16_f32 v65, v18, v19
    v_mfma_f32_16x16x32_bf16 v[84:87], v[44:47], a[228:231], v[84:87]
    v_exp_f32 v18, v98
    v_mfma_f32_16x16x32_bf16 v[88:91], v[40:43], a[248:251], v[88:91]
    ds_read_b128 v[36:39], v3 offset:12544
    v_add_f32 v4, v4, v16
    v_mfma_f32_16x16x32_bf16 v[88:91], v[44:47], a[252:255], v[88:91]
    v_add_f32 v4, v4, v17
    v_add_u32 v22, s3, v22
    v_mfma_f32_16x16x32_bf16 v[92:95], v[40:43], v[208:211], v[92:95]
    v_exp_f32 v19, v99
    v_mfma_f32_16x16x32_bf16 v[92:95], v[44:47], v[212:215], v[92:95]
    s_waitcnt lgkmcnt(2)
    v_cvt_pk_bf16_f32 v66, v16, v17
    v_mfma_f32_16x16x32_bf16 v[112:115], v[24:27], a[200:203], v[112:115]
    ds_read_b128 v[40:43], v2 offset:18688
    v_mfma_f32_16x16x32_bf16 v[112:115], v[28:31], a[204:207], v[112:115]
    v_exp_f32 v16, v68
    s_branch L_skip14
L_pad14:
    s_branch L_tb1_0
L_skip14:
    v_mfma_f32_16x16x32_bf16 v[116:119], v[24:27], a[224:227], v[116:119]
    v_add_f32 v4, v4, v18
    v_add_f32 v4, v4, v19
    v_mfma_f32_16x16x32_bf16 v[116:119], v[28:31], a[228:231], v[116:119]
    s_add_u32 s32, s32, 24576
    v_exp_f32 v17, v69
    v_mfma_f32_16x16x32_bf16 v[120:123], v[24:27], a[248:251], v[120:123]
    s_add_u32 s26, s26, 36864
    ds_read_b128 v[44:47], v3 offset:18688
    v_cvt_pk_bf16_f32 v67, v18, v19
    v_mfma_f32_16x16x32_bf16 v[120:123], v[28:31], a[252:255], v[120:123]
    s_waitcnt lgkmcnt(2)
    v_exp_f32 v18, v70
    v_mfma_f32_16x16x32_bf16 v[124:127], v[24:27], v[208:211], v[124:127]
    s_waitcnt vmcnt(20)
    v_add_f32 v5, v5, v16
    v_add_f32 v5, v5, v17
    v_mfma_f32_16x16x32_bf16 v[124:127], v[28:31], v[212:215], v[124:127]
    s_barrier
    s_sub_u32 s57, s26, 147456
    v_mfma_f32_16x16x32_bf16 v[80:83], v[32:35], a[208:211], v[80:83]
    ds_read_b128 v[24:27], v1 offset:0
    v_mfma_f32_16x16x32_bf16 v[80:83], v[36:39], a[212:215], v[80:83]
    v_exp_f32 v19, v71
    v_mfma_f32_16x16x32_bf16 v[84:87], v[32:35], a[232:235], v[84:87]
    s_min_u32 s26, s26, s57
    v_cvt_pk_bf16_f32 v68, v16, v17
    v_mfma_f32_16x16x32_bf16 v[84:87], v[36:39], a[236:239], v[84:87]
    v_exp_f32 v16, v100
    v_mfma_f32_16x16x32_bf16 v[88:91], v[32:35], v[192:195], v[88:91]
    ds_read_b128 v[28:31], v1 offset:12288
    v_add_f32 v5, v5, v18
    v_mfma_f32_16x16x32_bf16 v[88:91], v[36:39], v[196:199], v[88:91]
    v_add_f32 v5, v5, v19
    v_mfma_f32_16x16x32_bf16 v[92:95], v[32:35], v[216:219], v[92:95]
    v_exp_f32 v17, v101
    v_mfma_f32_16x16x32_bf16 v[92:95], v[36:39], v[220:223], v[92:95]
    s_waitcnt lgkmcnt(2)
    v_cvt_pk_bf16_f32 v69, v18, v19
    v_mfma_f32_16x16x32_bf16 v[112:115], v[40:43], a[208:211], v[112:115]
    ds_read_b128 v[32:35], v1 offset:768
    v_mfma_f32_16x16x32_bf16 v[112:115], v[44:47], a[212:215], v[112:115]
    v_exp_f32 v18, v102
    v_mfma_f32_16x16x32_bf16 v[116:119], v[40:43], a[232:235], v[116:119]
    v_add_f32 v5, v5, v16
    v_add_f32 v5, v5, v17
    v_mfma_f32_16x16x32_bf16 v[116:119], v[44:47], a[236:239], v[116:119]
    v_exp_f32 v19, v103
    v_mfma_f32_16x16x32_bf16 v[120:123], v[40:43], v[192:195], v[120:123]
    s_sub_u32 s31, s31, 1
    ds_read_b128 v[36:39], v1 offset:13056
    v_cvt_pk_bf16_f32 v70, v16, v17
    v_mfma_f32_16x16x32_bf16 v[120:123], v[44:47], v[196:199], v[120:123]
    v_add_f32 v5, v5, v18
    v_add_f32 v5, v5, v19
    v_mfma_f32_16x16x32_bf16 v[124:127], v[40:43], v[216:219], v[124:127]
    s_waitcnt lgkmcnt(2)
    s_cmp_lg_u32 s31, 0
    v_cvt_pk_bf16_f32 v71, v18, v19
    v_mfma_f32_16x16x32_bf16 v[124:127], v[44:47], v[220:223], v[124:127]
    s_cbranch_scc1 L_loop2
    v_mfma_f32_16x16x32_bf16 a[0:3], v[160:163], v[24:27], a[0:3]
    ds_read_b128 v[40:43], v1 offset:1536
    ds_read_b128 v[44:47], v1 offset:13824
    v_mfma_f32_16x16x32_bf16 a[0:3], v[176:179], v[28:31], a[0:3]
    s_mov_b32 m0, s56
    s_add_u32 s29, s28, 49152
    s_sub_u32 s3, s29, 147456
    v_mfma_f32_16x16x32_bf16 a[48:51], v[164:167], v[24:27], a[48:51]
    ds_read_b128 v[240:243], v1 offset:2304
    s_min_u32 s29, s29, s3
    v_mfma_f32_16x16x32_bf16 a[48:51], v[180:183], v[28:31], a[48:51]
    s_waitcnt lgkmcnt(3)
    s_sub_u32 s3, s29, s28
    s_mov_b32 s28, s29
    v_mfma_f32_16x16x32_bf16 a[4:7], v[160:163], v[32:35], a[4:7]
    ds_read_b128 v[244:247], v1 offset:14592
    ds_read_b128 v[248:251], v21 offset:0
    v_mfma_f32_16x16x32_bf16 a[4:7], v[176:179], v[36:39], a[4:7]
    buffer_load_dwordx4 v8, s[4:7], s27 offen offset:0 sc1 lds
    v_mfma_f32_16x16x32_bf16 a[52:55], v[164:167], v[32:35], a[52:55]
    ds_read_b128 v[252:255], v21 offset:12288
    v_add_u32 v2, s3, v2
    v_mfma_f32_16x16x32_bf16 a[52:55], v[180:183], v[36:39], a[52:55]
    s_waitcnt lgkmcnt(4)
    v_add_u32 v3, s3, v3
    v_mfma_f32_16x16x32_bf16 a[8:11], v[160:163], v[40:43], a[8:11]
    ds_read_b128 v[24:27], v21 offset:768
    v_mfma_f32_16x16x32_bf16 a[8:11], v[176:179], v[44:47], a[8:11]
    buffer_load_dwordx4 v8, s[4:7], s27 offen offset:1024 sc1 lds
    v_mfma_f32_16x16x32_bf16 a[56:59], v[164:167], v[40:43], a[56:59]
    ds_read_b128 v[28:31], v21 offset:13056
    v_mfma_f32_16x16x32_bf16 a[56:59], v[180:183], v[44:47], a[56:59]
    s_waitcnt lgkmcnt(4)
    v_exp_f32 v16, v80
    v_mfma_f32_16x16x32_bf16 a[12:15], v[160:163], v[240:243], a[12:15]
    ds_read_b128 v[32:35], v21 offset:1536
    v_mfma_f32_16x16x32_bf16 a[12:15], v[176:179], v[244:247], a[12:15]
    buffer_load_dwordx4 v8, s[4:7], s27 offen offset:2048 sc1 lds
    v_mfma_f32_16x16x32_bf16 a[60:63], v[164:167], v[240:243], a[60:63]
    ds_read_b128 v[36:39], v21 offset:13824
    v_mfma_f32_16x16x32_bf16 a[60:63], v[180:183], v[244:247], a[60:63]
    s_waitcnt lgkmcnt(4)
    v_exp_f32 v17, v81
    v_mfma_f32_16x16x32_bf16 a[16:19], v[160:163], v[248:251], a[16:19]
    ds_read_b128 v[40:43], v21 offset:2304
    v_mfma_f32_16x16x32_bf16 a[16:19], v[176:179], v[252:255], a[16:19]
    s_add_u32 s27, s27, 24576
    s_add_u32 s56, s56, 12288
    s_mov_b32 m0, s56
    v_mfma_f32_16x16x32_bf16 a[64:67], v[164:167], v[248:251], a[64:67]
    ds_read_b128 v[44:47], v21 offset:14592
    v_mfma_f32_16x16x32_bf16 a[64:67], v[180:183], v[252:255], a[64:67]
    s_waitcnt lgkmcnt(4)
    v_exp_f32 v18, v82
    v_mfma_f32_16x16x32_bf16 a[20:23], v[160:163], v[24:27], a[20:23]
    ds_read_b128 v[240:243], v22 offset:0
    v_add_f32 v4, v4, v16
    v_mfma_f32_16x16x32_bf16 a[20:23], v[176:179], v[28:31], a[20:23]
    buffer_load_dwordx4 v8, s[4:7], s27 offen offset:0 sc1 lds
    v_mfma_f32_16x16x32_bf16 a[68:71], v[164:167], v[24:27], a[68:71]
    ds_read_b128 v[244:247], v22 offset:12288
    v_add_f32 v4, v4, v17
    v_mfma_f32_16x16x32_bf16 a[68:71], v[180:183], v[28:31], a[68:71]
    s_waitcnt lgkmcnt(4)
    v_exp_f32 v19, v83
    v_mfma_f32_16x16x32_bf16 a[24:27], v[160:163], v[32:35], a[24:27]
    ds_read_b128 v[248:251], v22 offset:768
    v_cvt_pk_bf16_f32 v80, v16, v17
    v_mfma_f32_16x16x32_bf16 a[24:27], v[176:179], v[36:39], a[24:27]
    buffer_load_dwordx4 v8, s[4:7], s27 offen offset:1024 sc1 lds
    v_mfma_f32_16x16x32_bf16 a[72:75], v[164:167], v[32:35], a[72:75]
    ds_read_b128 v[252:255], v22 offset:13056
    v_mfma_f32_16x16x32_bf16 a[72:75], v[180:183], v[36:39], a[72:75]
    s_waitcnt lgkmcnt(4)
    v_exp_f32 v16, v112
    v_mfma_f32_16x16x32_bf16 a[28:31], v[160:163], v[40:43], a[28:31]
    ds_read_b128 v[24:27], v22 offset:1536
    v_add_f32 v4, v4, v18
    v_mfma_f32_16x16x32_bf16 a[28:31], v[176:179], v[44:47], a[28:31]
    s_waitcnt vmcnt(63)
    s_barrier
    v_mfma_f32_16x16x32_bf16 a[76:79], v[164:167], v[40:43], a[76:79]
    ds_read_b128 v[28:31], v22 offset:13824
    v_add_f32 v4, v4, v19
    v_mfma_f32_16x16x32_bf16 a[76:79], v[180:183], v[44:47], a[76:79]
    s_waitcnt lgkmcnt(4)
    v_exp_f32 v17, v113
    v_mfma_f32_16x16x32_bf16 a[32:35], v[160:163], v[240:243], a[32:35]
    ds_read_b128 v[32:35], v22 offset:2304
    v_cvt_pk_bf16_f32 v81, v18, v19
    v_mfma_f32_16x16x32_bf16 a[32:35], v[176:179], v[244:247], a[32:35]
    buffer_load_dwordx4 v8, s[4:7], s27 offen offset:2048 sc1 lds
    v_mfma_f32_16x16x32_bf16 a[80:83], v[164:167], v[240:243], a[80:83]
    ds_read_b128 v[36:39], v22 offset:14592
    v_mfma_f32_16x16x32_bf16 a[80:83], v[180:183], v[244:247], a[80:83]
    s_waitcnt lgkmcnt(4)
    v_exp_f32 v18, v114
    v_mfma_f32_16x16x32_bf16 a[36:39], v[160:163], v[248:251], a[36:39]
    ds_read_b128 v[40:43], v2 offset:0
    v_add_f32 v4, v4, v16
    v_mfma_f32_16x16x32_bf16 a[36:39], v[176:179], v[252:255], a[36:39]
    v_add_f32 v4, v4, v17
    v_mfma_f32_16x16x32_bf16 a[84:87], v[164:167], v[248:251], a[84:87]
    ds_read_b128 v[44:47], v3 offset:0
    v_mfma_f32_16x16x32_bf16 a[84:87], v[180:183], v[252:255], a[84:87]
    s_waitcnt lgkmcnt(4)
    v_exp_f32 v19, v115
    v_mfma_f32_16x16x32_bf16 a[40:43], v[160:163], v[24:27], a[40:43]
    ds_read_b128 v[240:243], v2 offset:6144
    v_cvt_pk_bf16_f32 v82, v16, v17
    v_mfma_f32_16x16x32_bf16 a[40:43], v[176:179], v[28:31], a[40:43]
    v_exp_f32 v16, v84
    v_mfma_f32_16x16x32_bf16 a[88:91], v[164:167], v[24:27], a[88:91]
    ds_read_b128 v[244:247], v3 offset:6144
    v_add_f32 v4, v4, v18
    v_mfma_f32_16x16x32_bf16 a[88:91], v[180:183], v[28:31], a[88:91]
    s_waitcnt lgkmcnt(4)
    v_add_f32 v4, v4, v19
    v_mfma_f32_16x16x32_bf16 a[44:47], v[160:163], v[32:35], a[44:47]
    ds_read_b128 v[248:251], v2 offset:128
    v_mfma_f32_16x16x32_bf16 a[44:47], v[176:179], v[36:39], a[44:47]
    v_exp_f32 v17, v85
    v_mfma_f32_16x16x32_bf16 a[92:95], v[164:167], v[32:35], a[92:95]
    ds_read_b128 v[252:255], v3 offset:128
    v_cvt_pk_bf16_f32 v83, v18, v19
    v_mfma_f32_16x16x32_bf16 a[92:95], v[180:183], v[36:39], a[92:95]
    s_waitcnt lgkmcnt(4)
    v_exp_f32 v18, v86
    v_add_f32 v5, v5, v16
    v_add_f32 v5, v5, v17
    v_exp_f32 v19, v87
    v_cvt_pk_bf16_f32 v84, v16, v17
    v_exp_f32 v16, v116
    v_add_f32 v5, v5, v18
    v_add_f32 v5, v5, v19
    v_exp_f32 v17, v117
    v_cvt_pk_bf16_f32 v85, v18, v19
    v_exp_f32 v18, v118
    v_add_f32 v5, v5, v16
    v_add_f32 v5, v5, v17
    v_exp_f32 v19, v119
    v_cvt_pk_bf16_f32 v86, v16, v17
    v_add_f32 v5, v5, v18
    v_add_f32 v5, v5, v19
    v_cvt_pk_bf16_f32 v87, v18, v19
    v_mfma_f32_16x16x32_bf16 v[160:163], v[40:43], a[192:195], v[128:131]
    ds_read_b128 v[24:27], v2 offset:6272
    v_subrev_u32 v9, 98304, v1
    v_mfma_f32_16x16x32_bf16 v[160:163], v[44:47], a[196:199], v[160:163]
    v_subrev_u32 v10, 98304, v21
    v_subrev_u32 v11, 98304, v22
    v_mfma_f32_16x16x32_bf16 v[164:167], v[40:43], a[216:219], v[132:135]
    ds_read_b128 v[28:31], v3 offset:6272
    v_subrev_u32 v12, 49152, v1
    v_mfma_f32_16x16x32_bf16 v[164:167], v[44:47], a[220:223], v[164:167]
    s_waitcnt lgkmcnt(4)
    v_subrev_u32 v13, 49152, v21
    v_subrev_u32 v0, 49152, v22
    v_mfma_f32_16x16x32_bf16 v[96:99], v[240:243], a[192:195], v[128:131]
    ds_read_b128 v[32:35], v2 offset:256
    v_bfe_u32 v63, v8, 4, 6
    v_mfma_f32_16x16x32_bf16 v[96:99], v[244:247], a[196:199], v[96:99]
    v_and_b32 v62, 48, v63
    v_and_b32 v63, 15, v63
    v_mfma_f32_16x16x32_bf16 v[100:103], v[240:243], a[216:219], v[132:135]
    ds_read_b128 v[36:39], v3 offset:256
    v_mul_u32_u24 v61, 96, v62
    v_mfma_f32_16x16x32_bf16 v[100:103], v[244:247], a[220:223], v[100:103]
    s_waitcnt lgkmcnt(4)
    v_lshl_add_u32 v60, v63, 4, v61
    v_lshl_add_u32 v61, v63, 3, v61
    v_mfma_f32_16x16x32_bf16 v[160:163], v[248:251], a[200:203], v[160:163]
    ds_read_b128 v[40:43], v2 offset:6400
    s_lshl_b32 s24, s95, 2
    v_mfma_f32_16x16x32_bf16 v[160:163], v[252:255], a[204:207], v[160:163]
    s_add_u32 s24, s24, s25
    s_mul_i32 s24, s24, 24576
    v_mov_b32 v63, 1.0
    v_mfma_f32_16x16x32_bf16 v[164:167], v[248:251], a[224:227], v[164:167]
    ds_read_b128 v[44:47], v3 offset:6400
    s_add_u32 s33, s24, 0
    v_mfma_f32_16x16x32_bf16 v[164:167], v[252:255], a[228:231], v[164:167]
    s_waitcnt lgkmcnt(4)
    s_add_u32 s34, s24, 6144
    s_add_u32 s35, s24, 12288
    v_mfma_f32_16x16x32_bf16 v[96:99], v[24:27], a[200:203], v[96:99]
    ds_read_b128 v[240:243], v2 offset:12288
    s_add_u32 s36, s24, 18432
    v_mfma_f32_16x16x32_bf16 v[96:99], v[28:31], a[204:207], v[96:99]
    v_mfma_f32_16x16x32_bf16 v[100:103], v[24:27], a[224:227], v[100:103]
    ds_read_b128 v[244:247], v3 offset:12288
    v_mfma_f32_16x16x32_bf16 v[100:103], v[28:31], a[228:231], v[100:103]
    s_waitcnt lgkmcnt(4)
    v_mfma_f32_16x16x32_bf16 v[160:163], v[32:35], a[208:211], v[160:163]
    ds_read_b128 v[248:251], v2 offset:18432
    v_mfma_f32_16x16x32_bf16 v[160:163], v[36:39], a[212:215], v[160:163]
    v_mfma_f32_16x16x32_bf16 v[164:167], v[32:35], a[232:235], v[164:167]
    ds_read_b128 v[252:255], v3 offset:18432
    v_mfma_f32_16x16x32_bf16 v[164:167], v[36:39], a[236:239], v[164:167]
    s_waitcnt lgkmcnt(4)
    v_mfma_f32_16x16x32_bf16 v[96:99], v[40:43], a[208:211], v[96:99]
    ds_read_b128 v[24:27], v2 offset:12416
    v_mfma_f32_16x16x32_bf16 v[96:99], v[44:47], a[212:215], v[96:99]
    v_mfma_f32_16x16x32_bf16 v[100:103], v[40:43], a[232:235], v[100:103]
    ds_read_b128 v[28:31], v3 offset:12416
    v_mfma_f32_16x16x32_bf16 v[100:103], v[44:47], a[236:239], v[100:103]
    s_waitcnt lgkmcnt(4)
    v_mfma_f32_16x16x32_bf16 v[176:179], v[240:243], a[192:195], v[128:131]
    ds_read_b128 v[32:35], v2 offset:18560
    v_mfma_f32_16x16x32_bf16 v[176:179], v[244:247], a[196:199], v[176:179]
    v_mfma_f32_16x16x32_bf16 v[180:183], v[240:243], a[216:219], v[132:135]
    ds_read_b128 v[36:39], v3 offset:18560
    v_mfma_f32_16x16x32_bf16 v[180:183], v[244:247], a[220:223], v[180:183]
    s_waitcnt lgkmcnt(4)
    v_mfma_f32_16x16x32_bf16 v[112:115], v[248:251], a[192:195], v[128:131]
    ds_read_b128 v[40:43], v2 offset:12544
    v_mfma_f32_16x16x32_bf16 v[112:115], v[252:255], a[196:199], v[112:115]
    s_waitcnt vmcnt(63)
    s_barrier
    v_mfma_f32_16x16x32_bf16 v[116:119], v[248:251], a[216:219], v[132:135]
    ds_read_b128 v[44:47], v3 offset:12544
    v_mfma_f32_16x16x32_bf16 v[116:119], v[252:255], a[220:223], v[116:119]
    s_waitcnt lgkmcnt(4)
    v_exp_f32 v16, v160
    v_mfma_f32_16x16x32_bf16 v[176:179], v[24:27], a[200:203], v[176:179]
    ds_read_b128 v[240:243], v2 offset:18688
    v_mfma_f32_16x16x32_bf16 v[176:179], v[28:31], a[204:207], v[176:179]
    v_exp_f32 v17, v161
    v_mfma_f32_16x16x32_bf16 v[180:183], v[24:27], a[224:227], v[180:183]
    ds_read_b128 v[244:247], v3 offset:18688
    v_mfma_f32_16x16x32_bf16 v[180:183], v[28:31], a[228:231], v[180:183]
    s_waitcnt lgkmcnt(4)
    v_exp_f32 v18, v162
    v_mfma_f32_16x16x32_bf16 v[112:115], v[32:35], a[200:203], v[112:115]
    ds_read_b128 v[248:251], v9 offset:0
    v_add_f32 v4, v4, v16
    v_mfma_f32_16x16x32_bf16 v[112:115], v[36:39], a[204:207], v[112:115]
    v_add_f32 v4, v4, v17
    v_mfma_f32_16x16x32_bf16 v[116:119], v[32:35], a[224:227], v[116:119]
    ds_read_b128 v[252:255], v9 offset:12288
    v_mfma_f32_16x16x32_bf16 v[116:119], v[36:39], a[228:231], v[116:119]
    s_waitcnt lgkmcnt(4)
    v_exp_f32 v19, v163
    v_mfma_f32_16x16x32_bf16 v[176:179], v[40:43], a[208:211], v[176:179]
    ds_read_b128 v[24:27], v9 offset:768
    v_cvt_pk_bf16_f32 v160, v16, v17
    v_mfma_f32_16x16x32_bf16 v[176:179], v[44:47], a[212:215], v[176:179]
    v_exp_f32 v16, v96
    v_mfma_f32_16x16x32_bf16 v[180:183], v[40:43], a[232:235], v[180:183]
    ds_read_b128 v[28:31], v9 offset:13056
    v_add_f32 v4, v4, v18
    v_mfma_f32_16x16x32_bf16 v[180:183], v[44:47], a[236:239], v[180:183]
    s_waitcnt lgkmcnt(4)
    v_add_f32 v4, v4, v19
    v_mfma_f32_16x16x32_bf16 v[112:115], v[240:243], a[208:211], v[112:115]
    ds_read_b128 v[32:35], v9 offset:1536
    v_mfma_f32_16x16x32_bf16 v[112:115], v[244:247], a[212:215], v[112:115]
    v_exp_f32 v17, v97
    v_mfma_f32_16x16x32_bf16 v[116:119], v[240:243], a[232:235], v[116:119]
    ds_read_b128 v[36:39], v9 offset:13824
    v_cvt_pk_bf16_f32 v161, v18, v19
    v_mfma_f32_16x16x32_bf16 v[116:119], v[244:247], a[236:239], v[116:119]
    s_waitcnt lgkmcnt(4)
    v_exp_f32 v18, v98
    v_mfma_f32_16x16x32_bf16 a[0:3], v[64:67], v[248:251], a[0:3]
    ds_read_b128 v[40:43], v9 offset:2304
    s_mov_b32 s29, 0x5f800000
    v_mfma_f32_16x16x32_bf16 a[0:3], v[80:83], v[252:255], a[0:3]
    v_add_f32 v4, v4, v16
    v_add_f32 v4, v4, v17
    v_mfma_f32_16x16x32_bf16 a[48:51], v[68:71], v[248:251], a[48:51]
    ds_read_b128 v[44:47], v9 offset:14592
    v_mfma_f32_16x16x32_bf16 a[48:51], v[84:87], v[252:255], a[48:51]
    s_waitcnt lgkmcnt(4)
    v_exp_f32 v19, v99
    v_mfma_f32_16x16x32_bf16 a[4:7], v[64:67], v[24:27], a[4:7]
    ds_read_b128 v[240:243], v10 offset:0
    v_cvt_pk_bf16_f32 v162, v16, v17
    v_mfma_f32_16x16x32_bf16 a[4:7], v[80:83], v[28:31], a[4:7]
    v_exp_f32 v16, v164
    v_mfma_f32_16x16x32_bf16 a[52:55], v[68:71], v[24:27], a[52:55]
    ds_read_b128 v[244:247], v10 offset:12288
    v_add_f32 v4, v4, v18
    v_mfma_f32_16x16x32_bf16 a[52:55], v[84:87], v[28:31], a[52:55]
    s_waitcnt lgkmcnt(4)
    v_add_f32 v4, v4, v19
    v_mfma_f32_16x16x32_bf16 a[8:11], v[64:67], v[32:35], a[8:11]
    ds_read_b128 v[248:251], v10 offset:768
    v_mfma_f32_16x16x32_bf16 a[8:11], v[80:83], v[36:39], a[8:11]
    v_exp_f32 v17, v165
    v_mfma_f32_16x16x32_bf16 a[56:59], v[68:71], v[32:35], a[56:59]
    ds_read_b128 v[252:255], v10 offset:13056
    v_cvt_pk_bf16_f32 v163, v18, v19
    v_mfma_f32_16x16x32_bf16 a[56:59], v[84:87], v[36:39], a[56:59]
    s_waitcnt lgkmcnt(4)
    v_exp_f32 v18, v166
    v_mfma_f32_16x16x32_bf16 a[12:15], v[64:67], v[40:43], a[12:15]
    ds_read_b128 v[24:27], v10 offset:1536
    v_add_f32 v5, v5, v16
    v_mfma_f32_16x16x32_bf16 a[12:15], v[80:83], v[44:47], a[12:15]
    v_add_f32 v5, v5, v17
    v_mfma_f32_16x16x32_bf16 a[60:63], v[68:71], v[40:43], a[60:63]
    ds_read_b128 v[28:31], v10 offset:13824
    v_mfma_f32_16x16x32_bf16 a[60:63], v[84:87], v[44:47], a[60:63]
    s_waitcnt lgkmcnt(4)
    v_exp_f32 v19, v167
    v_mfma_f32_16x16x32_bf16 a[16:19], v[64:67], v[240:243], a[16:19]
    ds_read_b128 v[32:35], v10 offset:2304
    v_cvt_pk_bf16_f32 v164, v16, v17
    v_mfma_f32_16x16x32_bf16 a[16:19], v[80:83], v[244:247], a[16:19]
    v_exp_f32 v16, v100
    v_mfma_f32_16x16x32_bf16 a[64:67], v[68:71], v[240:243], a[64:67]
    ds_read_b128 v[36:39], v10 offset:14592
    v_add_f32 v5, v5, v18
    v_mfma_f32_16x16x32_bf16 a[64:67], v[84:87], v[244:247], a[64:67]
    s_waitcnt lgkmcnt(4)
    v_add_f32 v5, v5, v19
    v_mfma_f32_16x16x32_bf16 a[20:23], v[64:67], v[248:251], a[20:23]
    ds_read_b128 v[40:43], v11 offset:0
    v_mfma_f32_16x16x32_bf16 a[20:23], v[80:83], v[252:255], a[20:23]
    v_exp_f32 v17, v101
    v_mfma_f32_16x16x32_bf16 a[68:71], v[68:71], v[248:251], a[68:71]
    ds_read_b128 v[44:47], v11 offset:12288
    v_cvt_pk_bf16_f32 v165, v18, v19
    v_mfma_f32_16x16x32_bf16 a[68:71], v[84:87], v[252:255], a[68:71]
    s_waitcnt lgkmcnt(4)
    v_exp_f32 v18, v102
    v_mfma_f32_16x16x32_bf16 a[24:27], v[64:67], v[24:27], a[24:27]
    ds_read_b128 v[240:243], v11 offset:768
    v_add_f32 v5, v5, v16
    v_mfma_f32_16x16x32_bf16 a[24:27], v[80:83], v[28:31], a[24:27]
    v_add_f32 v5, v5, v17
    v_mfma_f32_16x16x32_bf16 a[72:75], v[68:71], v[24:27], a[72:75]
    ds_read_b128 v[244:247], v11 offset:13056
    v_mfma_f32_16x16x32_bf16 a[72:75], v[84:87], v[28:31], a[72:75]
    s_waitcnt lgkmcnt(4)
    v_exp_f32 v19, v103
    v_mfma_f32_16x16x32_bf16 a[28:31], v[64:67], v[32:35], a[28:31]
    ds_read_b128 v[248:251], v11 offset:1536
    v_cvt_pk_bf16_f32 v166, v16, v17
    v_mfma_f32_16x16x32_bf16 a[28:31], v[80:83], v[36:39], a[28:31]
    s_waitcnt vmcnt(0)
    s_barrier
    v_mfma_f32_16x16x32_bf16 a[76:79], v[68:71], v[32:35], a[76:79]
    ds_read_b128 v[252:255], v11 offset:13824
    v_add_f32 v5, v5, v18
    v_mfma_f32_16x16x32_bf16 a[76:79], v[84:87], v[36:39], a[76:79]
    s_waitcnt lgkmcnt(4)
    v_add_f32 v5, v5, v19
    v_cvt_pk_bf16_f32 v167, v18, v19
    v_mfma_f32_16x16x32_bf16 a[32:35], v[64:67], v[40:43], a[32:35]
    ds_read_b128 v[24:27], v11 offset:2304
    v_mfma_f32_16x16x32_bf16 a[32:35], v[80:83], v[44:47], a[32:35]
    v_exp_f32 v16, v176
    v_mfma_f32_16x16x32_bf16 a[80:83], v[68:71], v[40:43], a[80:83]
    ds_read_b128 v[28:31], v11 offset:14592
    v_mfma_f32_16x16x32_bf16 a[80:83], v[84:87], v[44:47], a[80:83]
    s_waitcnt lgkmcnt(4)
    v_exp_f32 v17, v177
    v_mfma_f32_16x16x32_bf16 a[36:39], v[64:67], v[240:243], a[36:39]
    ds_read_b128 v[32:35], v12 offset:0
    v_mfma_f32_16x16x32_bf16 a[36:39], v[80:83], v[244:247], a[36:39]
    v_exp_f32 v18, v178
    v_mfma_f32_16x16x32_bf16 a[84:87], v[68:71], v[240:243], a[84:87]
    ds_read_b128 v[36:39], v12 offset:12288
    v_add_f32 v4, v4, v16
    v_mfma_f32_16x16x32_bf16 a[84:87], v[84:87], v[244:247], a[84:87]
    s_waitcnt lgkmcnt(4)
    v_add_f32 v4, v4, v17
    v_mfma_f32_16x16x32_bf16 a[40:43], v[64:67], v[248:251], a[40:43]
    ds_read_b128 v[40:43], v12 offset:768
    v_mfma_f32_16x16x32_bf16 a[40:43], v[80:83], v[252:255], a[40:43]
    v_exp_f32 v19, v179
    v_mfma_f32_16x16x32_bf16 a[88:91], v[68:71], v[248:251], a[88:91]
    ds_read_b128 v[44:47], v12 offset:13056
    v_cvt_pk_bf16_f32 v176, v16, v17
    v_mfma_f32_16x16x32_bf16 a[88:91], v[84:87], v[252:255], a[88:91]
    s_waitcnt lgkmcnt(4)
    v_exp_f32 v16, v112
    v_mfma_f32_16x16x32_bf16 a[44:47], v[64:67], v[24:27], a[44:47]
    ds_read_b128 v[240:243], v12 offset:1536
    v_add_f32 v4, v4, v18
    v_mfma_f32_16x16x32_bf16 a[44:47], v[80:83], v[28:31], a[44:47]
    v_add_f32 v4, v4, v19
    v_mfma_f32_16x16x32_bf16 a[92:95], v[68:71], v[24:27], a[92:95]
    ds_read_b128 v[244:247], v12 offset:13824
    v_mfma_f32_16x16x32_bf16 a[92:95], v[84:87], v[28:31], a[92:95]
    s_waitcnt lgkmcnt(4)
    v_exp_f32 v17, v113
    v_cvt_pk_bf16_f32 v177, v18, v19
    v_exp_f32 v18, v114
    v_add_f32 v4, v4, v16
    v_add_f32 v4, v4, v17
    v_exp_f32 v19, v115
    v_cvt_pk_bf16_f32 v178, v16, v17
    v_exp_f32 v16, v180
    v_add_f32 v4, v4, v18
    v_add_f32 v4, v4, v19
    v_exp_f32 v17, v181
    v_cvt_pk_bf16_f32 v179, v18, v19
    v_exp_f32 v18, v182
    v_add_f32 v5, v5, v16
    v_add_f32 v5, v5, v17
    v_exp_f32 v19, v183
    v_cvt_pk_bf16_f32 v180, v16, v17
    v_exp_f32 v16, v116
    v_add_f32 v5, v5, v18
    v_add_f32 v5, v5, v19
    v_exp_f32 v17, v117
    v_cvt_pk_bf16_f32 v181, v18, v19
    v_exp_f32 v18, v118
    v_add_f32 v5, v5, v16
    v_add_f32 v5, v5, v17
    v_exp_f32 v19, v119
    v_cvt_pk_bf16_f32 v182, v16, v17
    v_add_f32 v5, v5, v18
    v_add_f32 v5, v5, v19
    v_cvt_pk_bf16_f32 v183, v18, v19
    s_nop 4
    v_cmp_nge_f32 vcc, s29, v4
    v_cmp_nge_f32_e64 s[56:57], s29, v5
    s_nop 0
    s_or_b64 vcc, vcc, s[56:57]
    v_mfma_f32_16x16x4_f32 v[48:51], v4, v63, 0
    v_mfma_f32_16x16x4_f32 v[52:55], v5, v63, 0
    s_cbranch_vccnz L_slow
    v_mfma_f32_16x16x32_bf16 a[0:3], v[160:163], v[32:35], a[0:3]
    ds_read_b128 v[248:251], v12 offset:2304
    v_mfma_f32_16x16x32_bf16 a[0:3], v[176:179], v[36:39], a[0:3]
    v_exp_f32 v16, v72
    v_mfma_f32_16x16x32_bf16 a[48:51], v[164:167], v[32:35], a[48:51]
    ds_read_b128 v[252:255], v12 offset:14592
    v_mfma_f32_16x16x32_bf16 a[48:51], v[180:183], v[36:39], a[48:51]
    s_waitcnt lgkmcnt(4)
    v_exp_f32 v17, v73
    v_mfma_f32_16x16x32_bf16 a[4:7], v[160:163], v[40:43], a[4:7]
    ds_read_b128 v[24:27], v13 offset:0
    v_mfma_f32_16x16x32_bf16 a[4:7], v[176:179], v[44:47], a[4:7]
    v_exp_f32 v18, v74
    v_mfma_f32_16x16x32_bf16 a[52:55], v[164:167], v[40:43], a[52:55]
    ds_read_b128 v[28:31], v13 offset:12288
    v_add_f32 v6, v6, v16
    v_mfma_f32_16x16x32_bf16 a[52:55], v[180:183], v[44:47], a[52:55]
    s_waitcnt lgkmcnt(4)
    v_add_f32 v6, v6, v17
    v_mfma_f32_16x16x32_bf16 a[8:11], v[160:163], v[240:243], a[8:11]
    ds_read_b128 v[32:35], v13 offset:768
    v_mfma_f32_16x16x32_bf16 a[8:11], v[176:179], v[244:247], a[8:11]
    v_exp_f32 v19, v75
    v_mfma_f32_16x16x32_bf16 a[56:59], v[164:167], v[240:243], a[56:59]
    ds_read_b128 v[36:39], v13 offset:13056
    v_cvt_pk_bf16_f32 v72, v16, v17
    v_mfma_f32_16x16x32_bf16 a[56:59], v[180:183], v[244:247], a[56:59]
    s_waitcnt lgkmcnt(4)
    v_exp_f32 v16, v104
    v_mfma_f32_16x16x32_bf16 a[12:15], v[160:163], v[248:251], a[12:15]
    ds_read_b128 v[40:43], v13 offset:1536
    v_add_f32 v6, v6, v18
    v_mfma_f32_16x16x32_bf16 a[12:15], v[176:179], v[252:255], a[12:15]
    v_add_f32 v6, v6, v19
    v_mfma_f32_16x16x32_bf16 a[60:63], v[164:167], v[248:251], a[60:63]
    ds_read_b128 v[44:47], v13 offset:13824
    v_mfma_f32_16x16x32_bf16 a[60:63], v[180:183], v[252:255], a[60:63]
    s_waitcnt lgkmcnt(4)
    v_exp_f32 v17, v105
    v_mfma_f32_16x16x32_bf16 a[16:19], v[160:163], v[24:27], a[16:19]
    ds_read_b128 v[240:243], v13 offset:2304
    v_cvt_pk_bf16_f32 v73, v18, v19
    v_mfma_f32_16x16x32_bf16 a[16:19], v[176:179], v[28:31], a[16:19]
    v_exp_f32 v18, v106
    v_mfma_f32_16x16x32_bf16 a[64:67], v[164:167], v[24:27], a[64:67]
    ds_read_b128 v[244:247], v13 offset:14592
    v_add_f32 v6, v6, v16
    v_mfma_f32_16x16x32_bf16 a[64:67], v[180:183], v[28:31], a[64:67]
    s_waitcnt lgkmcnt(4)
    v_add_f32 v6, v6, v17
    v_mfma_f32_16x16x32_bf16 a[20:23], v[160:163], v[32:35], a[20:23]
    ds_read_b128 v[248:251], v0 offset:0
    v_mfma_f32_16x16x32_bf16 a[20:23], v[176:179], v[36:39], a[20:23]
    v_exp_f32 v19, v107
    v_mfma_f32_16x16x32_bf16 a[68:71], v[164:167], v[32:35], a[68:71]
    ds_read_b128 v[252:255], v0 offset:12288
    v_cvt_pk_bf16_f32 v74, v16, v17
    v_mfma_f32_16x16x32_bf16 a[68:71], v[180:183], v[36:39], a[68:71]
    s_waitcnt lgkmcnt(4)
    v_exp_f32 v16, v76
    v_mfma_f32_16x16x32_bf16 a[24:27], v[160:163], v[40:43], a[24:27]
    ds_read_b128 v[24:27], v0 offset:768
    v_add_f32 v6, v6, v18
    v_mfma_f32_16x16x32_bf16 a[24:27], v[176:179], v[44:47], a[24:27]
    v_add_f32 v6, v6, v19
    v_mfma_f32_16x16x32_bf16 a[72:75], v[164:167], v[40:43], a[72:75]
    ds_read_b128 v[28:31], v0 offset:13056
    v_mfma_f32_16x16x32_bf16 a[72:75], v[180:183], v[44:47], a[72:75]
    s_waitcnt lgkmcnt(4)
    v_exp_f32 v17, v77
    v_mfma_f32_16x16x32_bf16 a[28:31], v[160:163], v[240:243], a[28:31]
    ds_read_b128 v[32:35], v0 offset:1536
    v_cvt_pk_bf16_f32 v75, v18, v19
    v_mfma_f32_16x16x32_bf16 a[28:31], v[176:179], v[244:247], a[28:31]
    v_exp_f32 v18, v78
    v_mfma_f32_16x16x32_bf16 a[76:79], v[164:167], v[240:243], a[76:79]
    ds_read_b128 v[36:39], v0 offset:13824
    v_add_f32 v7, v7, v16
    v_mfma_f32_16x16x32_bf16 a[76:79], v[180:183], v[244:247], a[76:79]
    s_waitcnt lgkmcnt(4)
    v_add_f32 v7, v7, v17
    v_mfma_f32_16x16x32_bf16 a[32:35], v[160:163], v[248:251], a[32:35]
    ds_read_b128 v[40:43], v0 offset:2304
    v_mfma_f32_16x16x32_bf16 a[32:35], v[176:179], v[252:255], a[32:35]
    v_exp_f32 v19, v79
    v_mfma_f32_16x16x32_bf16 a[80:83], v[164:167], v[248:251], a[80:83]
    ds_read_b128 v[44:47], v0 offset:14592
    v_cvt_pk_bf16_f32 v76, v16, v17
    v_mfma_f32_16x16x32_bf16 a[80:83], v[180:183], v[252:255], a[80:83]
    s_waitcnt lgkmcnt(4)
    v_exp_f32 v16, v108
    v_mfma_f32_16x16x32_bf16 a[36:39], v[160:163], v[24:27], a[36:39]
    ds_read_b128 v[240:243], v1 offset:0
    v_add_f32 v7, v7, v18
    v_mfma_f32_16x16x32_bf16 a[36:39], v[176:179], v[28:31], a[36:39]
    v_add_f32 v7, v7, v19
    v_mfma_f32_16x16x32_bf16 a[84:87], v[164:167], v[24:27], a[84:87]
    ds_read_b128 v[244:247], v1 offset:12288
    v_mfma_f32_16x16x32_bf16 a[84:87], v[180:183], v[28:31], a[84:87]
    s_waitcnt lgkmcnt(4)
    v_exp_f32 v17, v109
    v_mfma_f32_16x16x32_bf16 a[40:43], v[160:163], v[32:35], a[40:43]
    ds_read_b128 v[248:251], v1 offset:768
    v_cvt_pk_bf16_f32 v77, v18, v19
    v_mfma_f32_16x16x32_bf16 a[40:43], v[176:179], v[36:39], a[40:43]
    v_exp_f32 v18, v110
    v_mfma_f32_16x16x32_bf16 a[88:91], v[164:167], v[32:35], a[88:91]
    ds_read_b128 v[252:255], v1 offset:13056
    v_add_f32 v7, v7, v16
    v_mfma_f32_16x16x32_bf16 a[88:91], v[180:183], v[36:39], a[88:91]
    s_waitcnt lgkmcnt(4)
    v_add_f32 v7, v7, v17
    v_mfma_f32_16x16x32_bf16 a[44:47], v[160:163], v[40:43], a[44:47]
    ds_read_b128 v[24:27], v1 offset:1536
    v_mfma_f32_16x16x32_bf16 a[44:47], v[176:179], v[44:47], a[44:47]
    v_exp_f32 v19, v111
    v_mfma_f32_16x16x32_bf16 a[92:95], v[164:167], v[40:43], a[92:95]
    ds_read_b128 v[28:31], v1 offset:13824
    v_cvt_pk_bf16_f32 v78, v16, v17
    v_mfma_f32_16x16x32_bf16 a[92:95], v[180:183], v[44:47], a[92:95]
    s_waitcnt lgkmcnt(4)
    v_add_f32 v7, v7, v18
    v_add_f32 v7, v7, v19
    v_cvt_pk_bf16_f32 v79, v18, v19
    v_rcp_f32 v48, v48
    v_rcp_f32 v49, v49
    v_rcp_f32 v50, v50
    v_rcp_f32 v51, v51
    v_rcp_f32 v52, v52
    v_rcp_f32 v53, v53
    v_rcp_f32 v54, v54
    v_rcp_f32 v55, v55
    v_mfma_f32_16x16x32_bf16 a[96:99], v[168:171], v[240:243], a[96:99]
    ds_read_b128 v[32:35], v1 offset:2304
    v_accvgpr_read_b32 v224, a0
    v_mfma_f32_16x16x32_bf16 a[96:99], v[184:187], v[244:247], a[96:99]
    s_nop 3
    v_accvgpr_read_b32 v225, a4
    v_accvgpr_read_b32 v226, a8
    v_accvgpr_read_b32 v227, a12
    s_branch L_skip15
L_pad15:
    s_branch L_tb2_0
L_skip15:
    v_mfma_f32_16x16x32_bf16 a[144:147], v[172:175], v[240:243], a[144:147]
    ds_read_b128 v[36:39], v1 offset:14592
    v_accvgpr_read_b32 v228, a16
    v_mfma_f32_16x16x32_bf16 a[144:147], v[188:191], v[244:247], a[144:147]
    s_waitcnt lgkmcnt(4)
    v_accvgpr_read_b32 v229, a20
    v_accvgpr_read_b32 v230, a24
    v_accvgpr_read_b32 v231, a28
    v_accvgpr_read_b32 v232, a32
    v_accvgpr_read_b32 v233, a36
    v_accvgpr_read_b32 v234, a40
    v_mfma_f32_16x16x32_bf16 a[100:103], v[168:171], v[248:251], a[100:103]
    ds_read_b128 v[40:43], v21 offset:0
    v_accvgpr_read_b32 v235, a44
    v_mfma_f32_16x16x32_bf16 a[100:103], v[184:187], v[252:255], a[100:103]
    v_mul_f32 v224, v224, v48
    v_mul_f32 v225, v225, v48
    v_mul_f32 v226, v226, v48
    v_mul_f32 v227, v227, v48
    v_mul_f32 v228, v228, v48
    v_mul_f32 v229, v229, v48
    v_mfma_f32_16x16x32_bf16 a[148:151], v[172:175], v[248:251], a[148:151]
    ds_read_b128 v[44:47], v21 offset:12288
    v_mul_f32 v230, v230, v48
    v_mfma_f32_16x16x32_bf16 a[148:151], v[188:191], v[252:255], a[148:151]
    s_waitcnt lgkmcnt(4)
    v_mul_f32 v231, v231, v48
    v_mul_f32 v232, v232, v48
    v_mul_f32 v233, v233, v48
    v_mul_f32 v234, v234, v48
    v_mul_f32 v235, v235, v48
    v_cvt_pk_bf16_f32 v224, v224, v225
    v_mfma_f32_16x16x32_bf16 a[104:107], v[168:171], v[24:27], a[104:107]
    ds_read_b128 v[240:243], v21 offset:768
    v_cvt_pk_bf16_f32 v225, v226, v227
    v_mfma_f32_16x16x32_bf16 a[104:107], v[184:187], v[28:31], a[104:107]
    v_cvt_pk_bf16_f32 v226, v228, v229
    v_cvt_pk_bf16_f32 v227, v230, v231
    v_cvt_pk_bf16_f32 v228, v232, v233
    v_cvt_pk_bf16_f32 v229, v234, v235
    v_mfma_f32_16x16x32_bf16 a[152:155], v[172:175], v[24:27], a[152:155]
    ds_read_b128 v[244:247], v21 offset:13056
    v_mfma_f32_16x16x32_bf16 a[152:155], v[188:191], v[28:31], a[152:155]
    s_waitcnt lgkmcnt(4)
    buffer_store_dwordx4 v[224:227], v60, s[12:15], s33 offen offset:0 sc0 sc1
    buffer_store_dwordx2 v[228:229], v61, s[12:15], s33 offen offset:256 sc0 sc1
    v_mfma_f32_16x16x32_bf16 a[108:111], v[168:171], v[32:35], a[108:111]
    ds_read_b128 v[248:251], v21 offset:1536
    v_accvgpr_read_b32 v144, a1
    v_mfma_f32_16x16x32_bf16 a[108:111], v[184:187], v[36:39], a[108:111]
    v_accvgpr_read_b32 v145, a5
    v_accvgpr_read_b32 v146, a9
    v_accvgpr_read_b32 v147, a13
    v_accvgpr_read_b32 v148, a17
    v_accvgpr_read_b32 v149, a21
    v_accvgpr_read_b32 v150, a25
    v_mfma_f32_16x16x32_bf16 a[156:159], v[172:175], v[32:35], a[156:159]
    ds_read_b128 v[252:255], v21 offset:13824
    v_accvgpr_read_b32 v151, a29
    v_mfma_f32_16x16x32_bf16 a[156:159], v[188:191], v[36:39], a[156:159]
    s_waitcnt lgkmcnt(4)
    v_accvgpr_read_b32 v152, a33
    v_accvgpr_read_b32 v153, a37
    v_accvgpr_read_b32 v154, a41
    v_accvgpr_read_b32 v155, a45
    v_mul_f32 v144, v144, v49
    v_mul_f32 v145, v145, v49
    v_mfma_f32_16x16x32_bf16 a[112:115], v[168:171], v[40:43], a[112:115]
    ds_read_b128 v[24:27], v21 offset:2304
    v_mul_f32 v146, v146, v49
    v_mfma_f32_16x16x32_bf16 a[112:115], v[184:187], v[44:47], a[112:115]
    v_mul_f32 v147, v147, v49
    v_mul_f32 v148, v148, v49
    v_mul_f32 v149, v149, v49
    v_mul_f32 v150, v150, v49
    v_mul_f32 v151, v151, v49
    v_mul_f32 v152, v152, v49
    v_mfma_f32_16x16x32_bf16 a[160:163], v[172:175], v[40:43], a[160:163]
    ds_read_b128 v[28:31], v21 offset:14592
    v_mul_f32 v153, v153, v49
    v_mfma_f32_16x16x32_bf16 a[160:163], v[188:191], v[44:47], a[160:163]
    s_waitcnt lgkmcnt(4)
    v_mul_f32 v154, v154, v49
    v_mul_f32 v155, v155, v49
    v_cvt_pk_bf16_f32 v144, v144, v145
    v_cvt_pk_bf16_f32 v145, v146, v147
    v_cvt_pk_bf16_f32 v146, v148, v149
    v_cvt_pk_bf16_f32 v147, v150, v151
    v_mfma_f32_16x16x32_bf16 a[116:119], v[168:171], v[240:243], a[116:119]
    ds_read_b128 v[32:35], v22 offset:0
    v_cvt_pk_bf16_f32 v148, v152, v153
    v_mfma_f32_16x16x32_bf16 a[116:119], v[184:187], v[244:247], a[116:119]
    v_cvt_pk_bf16_f32 v149, v154, v155
    buffer_store_dwordx4 v[144:147], v60, s[12:15], s33 offen offset:384 sc0 sc1
    v_mfma_f32_16x16x32_bf16 a[164:167], v[172:175], v[240:243], a[164:167]
    ds_read_b128 v[36:39], v22 offset:12288
    v_mfma_f32_16x16x32_bf16 a[164:167], v[188:191], v[244:247], a[164:167]
    s_waitcnt lgkmcnt(4)
    buffer_store_dwordx2 v[148:149], v61, s[12:15], s33 offen offset:640 sc0 sc1
    v_accvgpr_read_b32 v224, a2
    v_accvgpr_read_b32 v225, a6
    v_accvgpr_read_b32 v226, a10
    v_mfma_f32_16x16x32_bf16 a[120:123], v[168:171], v[248:251], a[120:123]
    ds_read_b128 v[40:43], v22 offset:768
    v_accvgpr_read_b32 v227, a14
    v_mfma_f32_16x16x32_bf16 a[120:123], v[184:187], v[252:255], a[120:123]
    v_accvgpr_read_b32 v228, a18
    v_accvgpr_read_b32 v229, a22
    v_accvgpr_read_b32 v230, a26
    v_accvgpr_read_b32 v231, a30
    v_accvgpr_read_b32 v232, a34
    v_accvgpr_read_b32 v233, a38
    v_mfma_f32_16x16x32_bf16 a[168:171], v[172:175], v[248:251], a[168:171]
    ds_read_b128 v[44:47], v22 offset:13056
    v_accvgpr_read_b32 v234, a42
    v_mfma_f32_16x16x32_bf16 a[168:171], v[188:191], v[252:255], a[168:171]
    s_waitcnt lgkmcnt(4)
    v_accvgpr_read_b32 v235, a46
    v_mul_f32 v224, v224, v50
    v_mul_f32 v225, v225, v50
    v_mul_f32 v226, v226, v50
    v_mul_f32 v227, v227, v50
    v_mul_f32 v228, v228, v50
    v_mfma_f32_16x16x32_bf16 a[124:127], v[168:171], v[24:27], a[124:127]
    ds_read_b128 v[240:243], v22 offset:1536
    v_mul_f32 v229, v229, v50
    v_mfma_f32_16x16x32_bf16 a[124:127], v[184:187], v[28:31], a[124:127]
    v_exp_f32 v16, v88
    v_exp_f32 v17, v89
    v_exp_f32 v18, v90
    v_mfma_f32_16x16x32_bf16 a[172:175], v[172:175], v[24:27], a[172:175]
    ds_read_b128 v[244:247], v22 offset:13824
    v_add_f32 v6, v6, v16
    v_mfma_f32_16x16x32_bf16 a[172:175], v[188:191], v[28:31], a[172:175]
    s_waitcnt lgkmcnt(4)
    v_add_f32 v6, v6, v17
    v_exp_f32 v19, v91
    v_cvt_pk_bf16_f32 v88, v16, v17
    v_exp_f32 v16, v120
    v_mfma_f32_16x16x32_bf16 a[128:131], v[168:171], v[32:35], a[128:131]
    ds_read_b128 v[248:251], v22 offset:2304
    v_add_f32 v6, v6, v18
    v_mfma_f32_16x16x32_bf16 a[128:131], v[184:187], v[36:39], a[128:131]
    v_add_f32 v6, v6, v19
    v_exp_f32 v17, v121
    v_cvt_pk_bf16_f32 v89, v18, v19
    v_exp_f32 v18, v122
    v_mfma_f32_16x16x32_bf16 a[176:179], v[172:175], v[32:35], a[176:179]
    ds_read_b128 v[252:255], v22 offset:14592
    v_add_f32 v6, v6, v16
    v_mfma_f32_16x16x32_bf16 a[176:179], v[188:191], v[36:39], a[176:179]
    s_waitcnt lgkmcnt(4)
    v_add_f32 v6, v6, v17
    v_exp_f32 v19, v123
    v_cvt_pk_bf16_f32 v90, v16, v17
    v_add_f32 v6, v6, v18
    v_add_f32 v6, v6, v19
    v_mfma_f32_16x16x32_bf16 a[132:135], v[168:171], v[40:43], a[132:135]
    ds_read_b128 v[24:27], v2 offset:0
    v_cvt_pk_bf16_f32 v91, v18, v19
    v_mfma_f32_16x16x32_bf16 a[132:135], v[184:187], v[44:47], a[132:135]
    v_mul_f32 v230, v230, v50
    v_mul_f32 v231, v231, v50
    v_mul_f32 v232, v232, v50
    v_mul_f32 v233, v233, v50
    v_mul_f32 v234, v234, v50
    v_mul_f32 v235, v235, v50
    v_mfma_f32_16x16x32_bf16 a[180:183], v[172:175], v[40:43], a[180:183]
    ds_read_b128 v[28:31], v3 offset:0
    v_cvt_pk_bf16_f32 v224, v224, v225
    v_mfma_f32_16x16x32_bf16 a[180:183], v[188:191], v[44:47], a[180:183]
    s_waitcnt lgkmcnt(4)
    v_cvt_pk_bf16_f32 v225, v226, v227
    v_cvt_pk_bf16_f32 v226, v228, v229
    v_cvt_pk_bf16_f32 v227, v230, v231
    v_cvt_pk_bf16_f32 v228, v232, v233
    v_cvt_pk_bf16_f32 v229, v234, v235
    v_mfma_f32_16x16x32_bf16 a[136:139], v[168:171], v[240:243], a[136:139]
    ds_read_b128 v[32:35], v2 offset:6144
    v_mfma_f32_16x16x32_bf16 a[136:139], v[184:187], v[244:247], a[136:139]
    buffer_store_dwordx4 v[224:227], v60, s[12:15], s33 offen offset:768 sc0 sc1
    buffer_store_dwordx2 v[228:229], v61, s[12:15], s33 offen offset:1024 sc0 sc1
    v_mfma_f32_16x16x32_bf16 a[184:187], v[172:175], v[240:243], a[184:187]
    ds_read_b128 v[36:39], v3 offset:6144
    v_accvgpr_read_b32 v144, a3
    v_mfma_f32_16x16x32_bf16 a[184:187], v[188:191], v[244:247], a[184:187]
    s_waitcnt lgkmcnt(4)
    v_accvgpr_read_b32 v145, a7
    v_accvgpr_read_b32 v146, a11
    v_accvgpr_read_b32 v147, a15
    v_accvgpr_read_b32 v148, a19
    v_accvgpr_read_b32 v149, a23
    v_accvgpr_read_b32 v150, a27
    v_mfma_f32_16x16x32_bf16 a[140:143], v[168:171], v[248:251], a[140:143]
    ds_read_b128 v[40:43], v2 offset:128
    v_accvgpr_read_b32 v151, a31
    v_mfma_f32_16x16x32_bf16 a[140:143], v[184:187], v[252:255], a[140:143]
    v_accvgpr_read_b32 v152, a35
    v_accvgpr_read_b32 v153, a39
    v_accvgpr_read_b32 v154, a43
    v_accvgpr_read_b32 v155, a47
    v_mul_f32 v144, v144, v51
    v_mul_f32 v145, v145, v51
    v_mfma_f32_16x16x32_bf16 a[188:191], v[172:175], v[248:251], a[188:191]
    ds_read_b128 v[44:47], v3 offset:128
    v_mul_f32 v146, v146, v51
    v_mfma_f32_16x16x32_bf16 a[188:191], v[188:191], v[252:255], a[188:191]
    s_waitcnt lgkmcnt(4)
    v_mul_f32 v147, v147, v51
    v_mul_f32 v148, v148, v51
    v_mul_f32 v149, v149, v51
    v_mul_f32 v150, v150, v51
    v_mul_f32 v151, v151, v51
    v_mul_f32 v152, v152, v51
    v_mfma_f32_16x16x32_bf16 v[168:171], v[24:27], a[240:243], v[136:139]
    ds_read_b128 v[240:243], v2 offset:6272
    v_mul_f32 v153, v153, v51
    v_mfma_f32_16x16x32_bf16 v[168:171], v[28:31], a[244:247], v[168:171]
    v_exp_f32 v16, v92
    v_exp_f32 v17, v93
    v_exp_f32 v18, v94
    v_mfma_f32_16x16x32_bf16 v[172:175], v[24:27], v[200:203], v[140:143]
    ds_read_b128 v[244:247], v3 offset:6272
    v_add_f32 v7, v7, v16
    v_mfma_f32_16x16x32_bf16 v[172:175], v[28:31], v[204:207], v[172:175]
    s_waitcnt lgkmcnt(4)
    v_add_f32 v7, v7, v17
    v_exp_f32 v19, v95
    v_cvt_pk_bf16_f32 v92, v16, v17
    v_exp_f32 v16, v124
    v_mfma_f32_16x16x32_bf16 v[104:107], v[32:35], a[240:243], v[136:139]
    ds_read_b128 v[248:251], v2 offset:256
    v_add_f32 v7, v7, v18
    v_mfma_f32_16x16x32_bf16 v[104:107], v[36:39], a[244:247], v[104:107]
    v_add_f32 v7, v7, v19
    v_exp_f32 v17, v125
    v_cvt_pk_bf16_f32 v93, v18, v19
    v_exp_f32 v18, v126
    v_mfma_f32_16x16x32_bf16 v[108:111], v[32:35], v[200:203], v[140:143]
    ds_read_b128 v[252:255], v3 offset:256
    v_add_f32 v7, v7, v16
    v_mfma_f32_16x16x32_bf16 v[108:111], v[36:39], v[204:207], v[108:111]
    s_waitcnt lgkmcnt(4)
    v_add_f32 v7, v7, v17
    v_exp_f32 v19, v127
    v_cvt_pk_bf16_f32 v94, v16, v17
    v_add_f32 v7, v7, v18
    v_add_f32 v7, v7, v19
    v_mfma_f32_16x16x32_bf16 v[168:171], v[40:43], a[248:251], v[168:171]
    ds_read_b128 v[24:27], v2 offset:6400
    v_cvt_pk_bf16_f32 v95, v18, v19
    v_mfma_f32_16x16x32_bf16 v[168:171], v[44:47], a[252:255], v[168:171]
    v_mul_f32 v154, v154, v51
    v_mul_f32 v155, v155, v51
    v_cvt_pk_bf16_f32 v144, v144, v145
    v_cvt_pk_bf16_f32 v145, v146, v147
    v_cvt_pk_bf16_f32 v146, v148, v149
    v_cvt_pk_bf16_f32 v147, v150, v151
    v_mfma_f32_16x16x32_bf16 v[172:175], v[40:43], v[208:211], v[172:175]
    ds_read_b128 v[28:31], v3 offset:6400
    v_cvt_pk_bf16_f32 v148, v152, v153
    v_mfma_f32_16x16x32_bf16 v[172:175], v[44:47], v[212:215], v[172:175]
    s_waitcnt lgkmcnt(4)
    v_cvt_pk_bf16_f32 v149, v154, v155
    buffer_store_dwordx4 v[144:147], v60, s[12:15], s33 offen offset:1152 sc0 sc1
    v_mfma_f32_16x16x32_bf16 v[104:107], v[240:243], a[248:251], v[104:107]
    ds_read_b128 v[32:35], v2 offset:12288
    v_mfma_f32_16x16x32_bf16 v[104:107], v[244:247], a[252:255], v[104:107]
    buffer_store_dwordx2 v[148:149], v61, s[12:15], s33 offen offset:1408 sc0 sc1
    v_accvgpr_read_b32 v224, a48
    v_accvgpr_read_b32 v225, a52
    v_accvgpr_read_b32 v226, a56
    v_mfma_f32_16x16x32_bf16 v[108:111], v[240:243], v[208:211], v[108:111]
    ds_read_b128 v[36:39], v3 offset:12288
    v_accvgpr_read_b32 v227, a60
    v_mfma_f32_16x16x32_bf16 v[108:111], v[244:247], v[212:215], v[108:111]
    s_waitcnt lgkmcnt(4)
    v_accvgpr_read_b32 v228, a64
    v_accvgpr_read_b32 v229, a68
    v_accvgpr_read_b32 v230, a72
    v_accvgpr_read_b32 v231, a76
    v_accvgpr_read_b32 v232, a80
    v_accvgpr_read_b32 v233, a84
    v_mfma_f32_16x16x32_bf16 v[168:171], v[248:251], v[192:195], v[168:171]
    ds_read_b128 v[40:43], v2 offset:18432
    v_accvgpr_read_b32 v234, a88
    v_mfma_f32_16x16x32_bf16 v[168:171], v[252:255], v[196:199], v[168:171]
    v_accvgpr_read_b32 v235, a92
    v_mul_f32 v224, v224, v52
    v_mul_f32 v225, v225, v52
    v_mul_f32 v226, v226, v52
    v_mul_f32 v227, v227, v52
    v_mul_f32 v228, v228, v52
    v_mfma_f32_16x16x32_bf16 v[172:175], v[248:251], v[216:219], v[172:175]
    ds_read_b128 v[44:47], v3 offset:18432
    v_mul_f32 v229, v229, v52
    v_mfma_f32_16x16x32_bf16 v[172:175], v[252:255], v[220:223], v[172:175]
    s_waitcnt lgkmcnt(4)
    v_mul_f32 v230, v230, v52
    v_mul_f32 v231, v231, v52
    v_mul_f32 v232, v232, v52
    v_mul_f32 v233, v233, v52
    v_mul_f32 v234, v234, v52
    v_mul_f32 v235, v235, v52
    v_mfma_f32_16x16x32_bf16 v[104:107], v[24:27], v[192:195], v[104:107]
    ds_read_b128 v[240:243], v2 offset:12416
    v_cvt_pk_bf16_f32 v224, v224, v225
    v_mfma_f32_16x16x32_bf16 v[104:107], v[28:31], v[196:199], v[104:107]
    v_cvt_pk_bf16_f32 v225, v226, v227
    v_cvt_pk_bf16_f32 v226, v228, v229
    v_cvt_pk_bf16_f32 v227, v230, v231
    v_cvt_pk_bf16_f32 v228, v232, v233
    v_cvt_pk_bf16_f32 v229, v234, v235
    v_mfma_f32_16x16x32_bf16 v[108:111], v[24:27], v[216:219], v[108:111]
    ds_read_b128 v[244:247], v3 offset:12416
    v_mfma_f32_16x16x32_bf16 v[108:111], v[28:31], v[220:223], v[108:111]
    s_waitcnt lgkmcnt(4)
    buffer_store_dwordx4 v[224:227], v60, s[12:15], s34 offen offset:0 sc0 sc1
    buffer_store_dwordx2 v[228:229], v61, s[12:15], s34 offen offset:256 sc0 sc1
    v_mfma_f32_16x16x32_bf16 v[184:187], v[32:35], a[240:243], v[136:139]
    ds_read_b128 v[248:251], v2 offset:18560
    v_accvgpr_read_b32 v144, a49
    v_mfma_f32_16x16x32_bf16 v[184:187], v[36:39], a[244:247], v[184:187]
    v_accvgpr_read_b32 v145, a53
    v_accvgpr_read_b32 v146, a57
    v_accvgpr_read_b32 v147, a61
    v_accvgpr_read_b32 v148, a65
    v_accvgpr_read_b32 v149, a69
    v_accvgpr_read_b32 v150, a73
    v_mfma_f32_16x16x32_bf16 v[188:191], v[32:35], v[200:203], v[140:143]
    ds_read_b128 v[252:255], v3 offset:18560
    v_accvgpr_read_b32 v151, a77
    v_mfma_f32_16x16x32_bf16 v[188:191], v[36:39], v[204:207], v[188:191]
    s_waitcnt lgkmcnt(4)
    v_accvgpr_read_b32 v152, a81
    v_accvgpr_read_b32 v153, a85
    v_accvgpr_read_b32 v154, a89
    v_accvgpr_read_b32 v155, a93
    v_mul_f32 v144, v144, v53
    v_mul_f32 v145, v145, v53
    v_mfma_f32_16x16x32_bf16 v[120:123], v[40:43], a[240:243], v[136:139]
    ds_read_b128 v[24:27], v2 offset:12544
    v_mul_f32 v146, v146, v53
    v_mfma_f32_16x16x32_bf16 v[120:123], v[44:47], a[244:247], v[120:123]
    v_exp_f32 v16, v168
    v_exp_f32 v17, v169
    v_exp_f32 v18, v170
    v_mfma_f32_16x16x32_bf16 v[124:127], v[40:43], v[200:203], v[140:143]
    ds_read_b128 v[28:31], v3 offset:12544
    v_add_f32 v6, v6, v16
    v_mfma_f32_16x16x32_bf16 v[124:127], v[44:47], v[204:207], v[124:127]
    s_waitcnt lgkmcnt(4)
    v_add_f32 v6, v6, v17
    v_exp_f32 v19, v171
    v_cvt_pk_bf16_f32 v168, v16, v17
    v_exp_f32 v16, v104
    v_mfma_f32_16x16x32_bf16 v[184:187], v[240:243], a[248:251], v[184:187]
    ds_read_b128 v[32:35], v2 offset:18688
    v_add_f32 v6, v6, v18
    v_mfma_f32_16x16x32_bf16 v[184:187], v[244:247], a[252:255], v[184:187]
    v_add_f32 v6, v6, v19
    v_exp_f32 v17, v105
    v_cvt_pk_bf16_f32 v169, v18, v19
    v_exp_f32 v18, v106
    v_mfma_f32_16x16x32_bf16 v[188:191], v[240:243], v[208:211], v[188:191]
    ds_read_b128 v[36:39], v3 offset:18688
    v_add_f32 v6, v6, v16
    v_mfma_f32_16x16x32_bf16 v[188:191], v[244:247], v[212:215], v[188:191]
    s_waitcnt lgkmcnt(4)
    v_add_f32 v6, v6, v17
    v_exp_f32 v19, v107
    v_cvt_pk_bf16_f32 v170, v16, v17
    v_exp_f32 v16, v172
    v_mfma_f32_16x16x32_bf16 v[120:123], v[248:251], a[248:251], v[120:123]
    ds_read_b128 v[40:43], v9 offset:0
    v_add_f32 v6, v6, v18
    v_mfma_f32_16x16x32_bf16 v[120:123], v[252:255], a[252:255], v[120:123]
    v_add_f32 v6, v6, v19
    v_exp_f32 v17, v173
    v_cvt_pk_bf16_f32 v171, v18, v19
    v_exp_f32 v18, v174
    v_mfma_f32_16x16x32_bf16 v[124:127], v[248:251], v[208:211], v[124:127]
    ds_read_b128 v[44:47], v9 offset:12288
    v_add_f32 v7, v7, v16
    v_mfma_f32_16x16x32_bf16 v[124:127], v[252:255], v[212:215], v[124:127]
    s_waitcnt lgkmcnt(4)
    v_add_f32 v7, v7, v17
    v_exp_f32 v19, v175
    v_cvt_pk_bf16_f32 v172, v16, v17
    v_exp_f32 v16, v108
    v_mfma_f32_16x16x32_bf16 v[184:187], v[24:27], v[192:195], v[184:187]
    ds_read_b128 v[240:243], v9 offset:768
    v_add_f32 v7, v7, v18
    v_mfma_f32_16x16x32_bf16 v[184:187], v[28:31], v[196:199], v[184:187]
    v_add_f32 v7, v7, v19
    v_exp_f32 v17, v109
    v_cvt_pk_bf16_f32 v173, v18, v19
    v_exp_f32 v18, v110
    v_mfma_f32_16x16x32_bf16 v[188:191], v[24:27], v[216:219], v[188:191]
    ds_read_b128 v[244:247], v9 offset:13056
    v_add_f32 v7, v7, v16
    v_mfma_f32_16x16x32_bf16 v[188:191], v[28:31], v[220:223], v[188:191]
    s_waitcnt lgkmcnt(4)
    v_add_f32 v7, v7, v17
    v_exp_f32 v19, v111
    v_cvt_pk_bf16_f32 v174, v16, v17
    v_add_f32 v7, v7, v18
    v_add_f32 v7, v7, v19
    v_mfma_f32_16x16x32_bf16 v[120:123], v[32:35], v[192:195], v[120:123]
    ds_read_b128 v[248:251], v9 offset:1536
    v_cvt_pk_bf16_f32 v175, v18, v19
    v_mfma_f32_16x16x32_bf16 v[120:123], v[36:39], v[196:199], v[120:123]
    v_mul_f32 v147, v147, v53
    v_mul_f32 v148, v148, v53
    v_mul_f32 v149, v149, v53
    v_mul_f32 v150, v150, v53
    v_mul_f32 v151, v151, v53
    v_mul_f32 v152, v152, v53
    v_mfma_f32_16x16x32_bf16 v[124:127], v[32:35], v[216:219], v[124:127]
    ds_read_b128 v[252:255], v9 offset:13824
    v_mul_f32 v153, v153, v53
    v_mfma_f32_16x16x32_bf16 v[124:127], v[36:39], v[220:223], v[124:127]
    s_waitcnt lgkmcnt(4)
    v_mul_f32 v154, v154, v53
    v_mul_f32 v155, v155, v53
    v_cvt_pk_bf16_f32 v144, v144, v145
    v_cvt_pk_bf16_f32 v145, v146, v147
    v_cvt_pk_bf16_f32 v146, v148, v149
    v_cvt_pk_bf16_f32 v147, v150, v151
    v_mfma_f32_16x16x32_bf16 a[96:99], v[72:75], v[40:43], a[96:99]
    ds_read_b128 v[24:27], v9 offset:2304
    v_cvt_pk_bf16_f32 v148, v152, v153
    v_mfma_f32_16x16x32_bf16 a[96:99], v[88:91], v[44:47], a[96:99]
    v_exp_f32 v16, v184
    v_exp_f32 v17, v185
    v_exp_f32 v18, v186
    v_mfma_f32_16x16x32_bf16 a[144:147], v[76:79], v[40:43], a[144:147]
    ds_read_b128 v[28:31], v9 offset:14592
    v_add_f32 v6, v6, v16
    v_mfma_f32_16x16x32_bf16 a[144:147], v[92:95], v[44:47], a[144:147]
    s_waitcnt lgkmcnt(4)
    v_add_f32 v6, v6, v17
    v_exp_f32 v19, v187
    v_cvt_pk_bf16_f32 v184, v16, v17
    v_exp_f32 v16, v120
    v_mfma_f32_16x16x32_bf16 a[100:103], v[72:75], v[240:243], a[100:103]
    ds_read_b128 v[32:35], v10 offset:0
    v_add_f32 v6, v6, v18
    v_mfma_f32_16x16x32_bf16 a[100:103], v[88:91], v[244:247], a[100:103]
    v_add_f32 v6, v6, v19
    v_exp_f32 v17, v121
    v_cvt_pk_bf16_f32 v185, v18, v19
    v_exp_f32 v18, v122
    v_mfma_f32_16x16x32_bf16 a[148:151], v[76:79], v[240:243], a[148:151]
    ds_read_b128 v[36:39], v10 offset:12288
    v_add_f32 v6, v6, v16
    v_mfma_f32_16x16x32_bf16 a[148:151], v[92:95], v[244:247], a[148:151]
    s_waitcnt lgkmcnt(4)
    v_add_f32 v6, v6, v17
    v_exp_f32 v19, v123
    v_cvt_pk_bf16_f32 v186, v16, v17
    v_exp_f32 v16, v188
    v_mfma_f32_16x16x32_bf16 a[104:107], v[72:75], v[248:251], a[104:107]
    ds_read_b128 v[40:43], v10 offset:768
    v_add_f32 v6, v6, v18
    v_mfma_f32_16x16x32_bf16 a[104:107], v[88:91], v[252:255], a[104:107]
    v_add_f32 v6, v6, v19
    v_exp_f32 v17, v189
    v_cvt_pk_bf16_f32 v187, v18, v19
    v_exp_f32 v18, v190
    v_mfma_f32_16x16x32_bf16 a[152:155], v[76:79], v[248:251], a[152:155]
    ds_read_b128 v[44:47], v10 offset:13056
    v_add_f32 v7, v7, v16
    v_mfma_f32_16x16x32_bf16 a[152:155], v[92:95], v[252:255], a[152:155]
    s_waitcnt lgkmcnt(4)
    v_add_f32 v7, v7, v17
    v_exp_f32 v19, v191
    v_cvt_pk_bf16_f32 v188, v16, v17
    v_exp_f32 v16, v124
    v_mfma_f32_16x16x32_bf16 a[108:111], v[72:75], v[24:27], a[108:111]
    ds_read_b128 v[240:243], v10 offset:1536
    v_add_f32 v7, v7, v18
    v_mfma_f32_16x16x32_bf16 a[108:111], v[88:91], v[28:31], a[108:111]
    v_add_f32 v7, v7, v19
    v_exp_f32 v17, v125
    v_cvt_pk_bf16_f32 v189, v18, v19
    v_exp_f32 v18, v126
    v_mfma_f32_16x16x32_bf16 a[156:159], v[76:79], v[24:27], a[156:159]
    ds_read_b128 v[244:247], v10 offset:13824
    v_add_f32 v7, v7, v16
    v_mfma_f32_16x16x32_bf16 a[156:159], v[92:95], v[28:31], a[156:159]
    s_waitcnt lgkmcnt(4)
    v_add_f32 v7, v7, v17
    v_exp_f32 v19, v127
    v_cvt_pk_bf16_f32 v190, v16, v17
    v_add_f32 v7, v7, v18
    v_add_f32 v7, v7, v19
    v_mfma_f32_16x16x32_bf16 a[112:115], v[72:75], v[32:35], a[112:115]
    ds_read_b128 v[248:251], v10 offset:2304
    v_cvt_pk_bf16_f32 v191, v18, v19
    v_mfma_f32_16x16x32_bf16 a[112:115], v[88:91], v[36:39], a[112:115]
    v_cvt_pk_bf16_f32 v149, v154, v155
    buffer_store_dwordx4 v[144:147], v60, s[12:15], s34 offen offset:384 sc0 sc1
    v_mfma_f32_16x16x32_bf16 a[160:163], v[76:79], v[32:35], a[160:163]
    ds_read_b128 v[252:255], v10 offset:14592
    v_mfma_f32_16x16x32_bf16 a[160:163], v[92:95], v[36:39], a[160:163]
    s_waitcnt lgkmcnt(4)
    buffer_store_dwordx2 v[148:149], v61, s[12:15], s34 offen offset:640 sc0 sc1
    v_accvgpr_read_b32 v224, a50
    v_accvgpr_read_b32 v225, a54
    v_accvgpr_read_b32 v226, a58
    v_mfma_f32_16x16x32_bf16 a[116:119], v[72:75], v[40:43], a[116:119]
    ds_read_b128 v[24:27], v11 offset:0
    v_accvgpr_read_b32 v227, a62
    v_mfma_f32_16x16x32_bf16 a[116:119], v[88:91], v[44:47], a[116:119]
    v_accvgpr_read_b32 v228, a66
    v_accvgpr_read_b32 v229, a70
    v_accvgpr_read_b32 v230, a74
    v_accvgpr_read_b32 v231, a78
    v_accvgpr_read_b32 v232, a82
    v_accvgpr_read_b32 v233, a86
    v_mfma_f32_16x16x32_bf16 a[164:167], v[76:79], v[40:43], a[164:167]
    ds_read_b128 v[28:31], v11 offset:12288
    v_accvgpr_read_b32 v234, a90
    v_mfma_f32_16x16x32_bf16 a[164:167], v[92:95], v[44:47], a[164:167]
    s_waitcnt lgkmcnt(4)
    v_accvgpr_read_b32 v235, a94
    v_mul_f32 v224, v224, v54
    v_mul_f32 v225, v225, v54
    v_mul_f32 v226, v226, v54
    v_mul_f32 v227, v227, v54
    v_mul_f32 v228, v228, v54
    v_mfma_f32_16x16x32_bf16 a[120:123], v[72:75], v[240:243], a[120:123]
    ds_read_b128 v[32:35], v11 offset:768
    v_mul_f32 v229, v229, v54
    v_mfma_f32_16x16x32_bf16 a[120:123], v[88:91], v[244:247], a[120:123]
    v_mul_f32 v230, v230, v54
    v_mul_f32 v231, v231, v54
    v_mul_f32 v232, v232, v54
    v_mul_f32 v233, v233, v54
    v_mul_f32 v234, v234, v54
    v_mul_f32 v235, v235, v54
    v_mfma_f32_16x16x32_bf16 a[168:171], v[76:79], v[240:243], a[168:171]
    ds_read_b128 v[36:39], v11 offset:13056
    v_cvt_pk_bf16_f32 v224, v224, v225
    v_mfma_f32_16x16x32_bf16 a[168:171], v[92:95], v[244:247], a[168:171]
    s_waitcnt lgkmcnt(4)
    v_cvt_pk_bf16_f32 v225, v226, v227
    v_cvt_pk_bf16_f32 v226, v228, v229
    v_cvt_pk_bf16_f32 v227, v230, v231
    v_cvt_pk_bf16_f32 v228, v232, v233
    v_cvt_pk_bf16_f32 v229, v234, v235
    v_mfma_f32_16x16x32_bf16 a[124:127], v[72:75], v[248:251], a[124:127]
    ds_read_b128 v[40:43], v11 offset:1536
    v_mfma_f32_16x16x32_bf16 a[124:127], v[88:91], v[252:255], a[124:127]
    buffer_store_dwordx4 v[224:227], v60, s[12:15], s34 offen offset:768 sc0 sc1
    buffer_store_dwordx2 v[228:229], v61, s[12:15], s34 offen offset:1024 sc0 sc1
    v_mfma_f32_16x16x32_bf16 a[172:175], v[76:79], v[248:251], a[172:175]
    ds_read_b128 v[44:47], v11 offset:13824
    v_accvgpr_read_b32 v144, a51
    v_mfma_f32_16x16x32_bf16 a[172:175], v[92:95], v[252:255], a[172:175]
    s_waitcnt lgkmcnt(4)
    v_accvgpr_read_b32 v145, a55
    v_accvgpr_read_b32 v146, a59
    v_accvgpr_read_b32 v147, a63
    v_accvgpr_read_b32 v148, a67
    v_accvgpr_read_b32 v149, a71
    v_accvgpr_read_b32 v150, a75
    v_mfma_f32_16x16x32_bf16 a[128:131], v[72:75], v[24:27], a[128:131]
    ds_read_b128 v[240:243], v11 offset:2304
    v_accvgpr_read_b32 v151, a79
    v_mfma_f32_16x16x32_bf16 a[128:131], v[88:91], v[28:31], a[128:131]
    v_accvgpr_read_b32 v152, a83
    v_accvgpr_read_b32 v153, a87
    v_accvgpr_read_b32 v154, a91
    v_accvgpr_read_b32 v155, a95
    v_mul_f32 v144, v144, v55
    v_mul_f32 v145, v145, v55
    v_mfma_f32_16x16x32_bf16 a[176:179], v[76:79], v[24:27], a[176:179]
    ds_read_b128 v[244:247], v11 offset:14592
    v_mul_f32 v146, v146, v55
    v_mfma_f32_16x16x32_bf16 a[176:179], v[92:95], v[28:31], a[176:179]
    s_waitcnt lgkmcnt(4)
    v_mul_f32 v147, v147, v55
    v_mul_f32 v148, v148, v55
    v_mul_f32 v149, v149, v55
    v_mul_f32 v150, v150, v55
    v_mul_f32 v151, v151, v55
    v_mul_f32 v152, v152, v55
    v_mfma_f32_16x16x32_bf16 a[132:135], v[72:75], v[32:35], a[132:135]
    ds_read_b128 v[248:251], v12 offset:0
    v_mul_f32 v153, v153, v55
    v_mfma_f32_16x16x32_bf16 a[132:135], v[88:91], v[36:39], a[132:135]
    v_mul_f32 v154, v154, v55
    v_mul_f32 v155, v155, v55
    v_cvt_pk_bf16_f32 v144, v144, v145
    v_cvt_pk_bf16_f32 v145, v146, v147
    v_cvt_pk_bf16_f32 v146, v148, v149
    v_cvt_pk_bf16_f32 v147, v150, v151
    v_mfma_f32_16x16x32_bf16 a[180:183], v[76:79], v[32:35], a[180:183]
    ds_read_b128 v[252:255], v12 offset:12288
    v_cvt_pk_bf16_f32 v148, v152, v153
    v_mfma_f32_16x16x32_bf16 a[180:183], v[92:95], v[36:39], a[180:183]
    s_waitcnt lgkmcnt(4)
    v_cvt_pk_bf16_f32 v149, v154, v155
    buffer_store_dwordx4 v[144:147], v60, s[12:15], s34 offen offset:1152 sc0 sc1
    v_mfma_f32_16x16x32_bf16 a[136:139], v[72:75], v[40:43], a[136:139]
    ds_read_b128 v[24:27], v12 offset:768
    v_mfma_f32_16x16x32_bf16 a[136:139], v[88:91], v[44:47], a[136:139]
    buffer_store_dwordx2 v[148:149], v61, s[12:15], s34 offen offset:1408 sc0 sc1
    v_mfma_f32_16x16x32_bf16 a[184:187], v[76:79], v[40:43], a[184:187]
    ds_read_b128 v[28:31], v12 offset:13056
    v_mfma_f32_16x16x32_bf16 a[184:187], v[92:95], v[44:47], a[184:187]
    s_waitcnt lgkmcnt(4)
    v_mfma_f32_16x16x32_bf16 a[140:143], v[72:75], v[240:243], a[140:143]
    ds_read_b128 v[32:35], v12 offset:1536
    v_mfma_f32_16x16x32_bf16 a[140:143], v[88:91], v[244:247], a[140:143]
    v_mfma_f32_16x16x32_bf16 a[188:191], v[76:79], v[240:243], a[188:191]
    ds_read_b128 v[36:39], v12 offset:13824
    v_mfma_f32_16x16x32_bf16 a[188:191], v[92:95], v[244:247], a[188:191]
    s_waitcnt lgkmcnt(4)
    s_nop 4
    v_cmp_nge_f32 vcc, s29, v6
    v_cmp_nge_f32_e64 s[56:57], s29, v7
    s_nop 0
    s_or_b64 vcc, vcc, s[56:57]
    s_branch L_skip16
L_pad16:
    s_branch L_tb2_1
L_skip16:
    v_mfma_f32_16x16x4_f32 v[56:59], v6, v63, 0
    v_mfma_f32_16x16x4_f32 v[128:131], v7, v63, 0
    s_cbranch_vccnz L_slow
    v_mfma_f32_16x16x32_bf16 a[96:99], v[168:171], v[248:251], a[96:99]
    ds_read_b128 v[40:43], v12 offset:2304
    ds_read_b128 v[44:47], v12 offset:14592
    v_mfma_f32_16x16x32_bf16 a[96:99], v[184:187], v[252:255], a[96:99]
    s_waitcnt lgkmcnt(4)
    s_nop 3
    v_rcp_f32 v56, v56
    v_rcp_f32 v57, v57
    v_mfma_f32_16x16x32_bf16 a[100:103], v[168:171], v[24:27], a[100:103]
    ds_read_b128 v[240:243], v13 offset:0
    ds_read_b128 v[244:247], v13 offset:12288
    v_mfma_f32_16x16x32_bf16 a[100:103], v[184:187], v[28:31], a[100:103]
    s_waitcnt lgkmcnt(4)
    v_rcp_f32 v58, v58
    v_rcp_f32 v59, v59
    v_rcp_f32 v128, v128
    v_rcp_f32 v129, v129
    v_rcp_f32 v130, v130
    v_rcp_f32 v131, v131
    v_mfma_f32_16x16x32_bf16 a[104:107], v[168:171], v[32:35], a[104:107]
    ds_read_b128 v[248:251], v13 offset:768
    ds_read_b128 v[252:255], v13 offset:13056
    v_mfma_f32_16x16x32_bf16 a[104:107], v[184:187], v[36:39], a[104:107]
    s_waitcnt lgkmcnt(4)
    v_mfma_f32_16x16x32_bf16 a[108:111], v[168:171], v[40:43], a[108:111]
    ds_read_b128 v[24:27], v13 offset:1536
    ds_read_b128 v[28:31], v13 offset:13824
    v_mfma_f32_16x16x32_bf16 a[108:111], v[184:187], v[44:47], a[108:111]
    s_waitcnt lgkmcnt(4)
    v_mfma_f32_16x16x32_bf16 a[112:115], v[168:171], v[240:243], a[112:115]
    ds_read_b128 v[32:35], v13 offset:2304
    ds_read_b128 v[36:39], v13 offset:14592
    v_mfma_f32_16x16x32_bf16 a[112:115], v[184:187], v[244:247], a[112:115]
    s_waitcnt lgkmcnt(4)
    v_mfma_f32_16x16x32_bf16 a[116:119], v[168:171], v[248:251], a[116:119]
    ds_read_b128 v[40:43], v0 offset:0
    ds_read_b128 v[44:47], v0 offset:12288
    v_mfma_f32_16x16x32_bf16 a[116:119], v[184:187], v[252:255], a[116:119]
    s_waitcnt lgkmcnt(4)
    v_mfma_f32_16x16x32_bf16 a[120:123], v[168:171], v[24:27], a[120:123]
    ds_read_b128 v[240:243], v0 offset:768
    ds_read_b128 v[244:247], v0 offset:13056
    v_mfma_f32_16x16x32_bf16 a[120:123], v[184:187], v[28:31], a[120:123]
    s_waitcnt lgkmcnt(4)
    v_mfma_f32_16x16x32_bf16 a[124:127], v[168:171], v[32:35], a[124:127]
    ds_read_b128 v[248:251], v0 offset:1536
    ds_read_b128 v[252:255], v0 offset:13824
    v_mfma_f32_16x16x32_bf16 a[124:127], v[184:187], v[36:39], a[124:127]
    s_waitcnt lgkmcnt(4)
    v_mfma_f32_16x16x32_bf16 a[128:131], v[168:171], v[40:43], a[128:131]
    ds_read_b128 v[24:27], v0 offset:2304
    ds_read_b128 v[28:31], v0 offset:14592
    v_mfma_f32_16x16x32_bf16 a[128:131], v[184:187], v[44:47], a[128:131]
    s_waitcnt lgkmcnt(4)
    v_mfma_f32_16x16x32_bf16 a[132:135], v[168:171], v[240:243], a[132:135]
    ds_read_b128 v[32:35], v12 offset:0
    ds_read_b128 v[36:39], v12 offset:12288
    v_mfma_f32_16x16x32_bf16 a[132:135], v[184:187], v[244:247], a[132:135]
    s_waitcnt lgkmcnt(4)
    v_mfma_f32_16x16x32_bf16 a[136:139], v[168:171], v[248:251], a[136:139]
    ds_read_b128 v[40:43], v12 offset:768
    ds_read_b128 v[44:47], v12 offset:13056
    v_mfma_f32_16x16x32_bf16 a[136:139], v[184:187], v[252:255], a[136:139]
    s_waitcnt lgkmcnt(4)
    v_mfma_f32_16x16x32_bf16 a[140:143], v[168:171], v[24:27], a[140:143]
    ds_read_b128 v[240:243], v12 offset:1536
    ds_read_b128 v[244:247], v12 offset:13824
    v_mfma_f32_16x16x32_bf16 a[140:143], v[184:187], v[28:31], a[140:143]
    s_waitcnt lgkmcnt(4)
    v_mfma_f32_16x16x32_bf16 a[144:147], v[172:175], v[32:35], a[144:147]
    ds_read_b128 v[248:251], v12 offset:2304
    ds_read_b128 v[252:255], v12 offset:14592
    v_mfma_f32_16x16x32_bf16 a[144:147], v[188:191], v[36:39], a[144:147]
    s_waitcnt lgkmcnt(4)
    s_nop 3
    v_accvgpr_read_b32 v224, a96
    v_accvgpr_read_b32 v225, a100
    v_mfma_f32_16x16x32_bf16 a[148:151], v[172:175], v[40:43], a[148:151]
    ds_read_b128 v[24:27], v13 offset:0
    ds_read_b128 v[28:31], v13 offset:12288
    v_mfma_f32_16x16x32_bf16 a[148:151], v[188:191], v[44:47], a[148:151]
    s_waitcnt lgkmcnt(4)
    v_accvgpr_read_b32 v226, a104
    v_accvgpr_read_b32 v227, a108
    v_accvgpr_read_b32 v228, a112
    v_accvgpr_read_b32 v229, a116
    v_accvgpr_read_b32 v230, a120
    v_accvgpr_read_b32 v231, a124
    v_mfma_f32_16x16x32_bf16 a[152:155], v[172:175], v[240:243], a[152:155]
    ds_read_b128 v[32:35], v13 offset:768
    ds_read_b128 v[36:39], v13 offset:13056
    v_mfma_f32_16x16x32_bf16 a[152:155], v[188:191], v[244:247], a[152:155]
    s_waitcnt lgkmcnt(4)
    v_accvgpr_read_b32 v232, a128
    v_accvgpr_read_b32 v233, a132
    v_accvgpr_read_b32 v234, a136
    v_accvgpr_read_b32 v235, a140
    v_mul_f32 v224, v224, v56
    v_mul_f32 v225, v225, v56
    v_mfma_f32_16x16x32_bf16 a[156:159], v[172:175], v[248:251], a[156:159]
    ds_read_b128 v[40:43], v13 offset:1536
    ds_read_b128 v[44:47], v13 offset:13824
    v_mfma_f32_16x16x32_bf16 a[156:159], v[188:191], v[252:255], a[156:159]
    s_waitcnt lgkmcnt(4)
    v_mul_f32 v226, v226, v56
    v_mul_f32 v227, v227, v56
    v_mul_f32 v228, v228, v56
    v_mul_f32 v229, v229, v56
    v_mul_f32 v230, v230, v56
    v_mul_f32 v231, v231, v56
    v_mfma_f32_16x16x32_bf16 a[160:163], v[172:175], v[24:27], a[160:163]
    ds_read_b128 v[240:243], v13 offset:2304
    ds_read_b128 v[244:247], v13 offset:14592
    v_mfma_f32_16x16x32_bf16 a[160:163], v[188:191], v[28:31], a[160:163]
    s_waitcnt lgkmcnt(4)
    v_mul_f32 v232, v232, v56
    v_mul_f32 v233, v233, v56
    v_mul_f32 v234, v234, v56
    v_mul_f32 v235, v235, v56
    v_cvt_pk_bf16_f32 v224, v224, v225
    v_cvt_pk_bf16_f32 v225, v226, v227
    v_mfma_f32_16x16x32_bf16 a[164:167], v[172:175], v[32:35], a[164:167]
    ds_read_b128 v[248:251], v0 offset:0
    ds_read_b128 v[252:255], v0 offset:12288
    v_mfma_f32_16x16x32_bf16 a[164:167], v[188:191], v[36:39], a[164:167]
    s_waitcnt lgkmcnt(4)
    v_cvt_pk_bf16_f32 v226, v228, v229
    v_cvt_pk_bf16_f32 v227, v230, v231
    v_cvt_pk_bf16_f32 v228, v232, v233
    v_cvt_pk_bf16_f32 v229, v234, v235
    v_mfma_f32_16x16x32_bf16 a[168:171], v[172:175], v[40:43], a[168:171]
    ds_read_b128 v[24:27], v0 offset:768
    ds_read_b128 v[28:31], v0 offset:13056
    v_mfma_f32_16x16x32_bf16 a[168:171], v[188:191], v[44:47], a[168:171]
    s_waitcnt lgkmcnt(4)
    buffer_store_dwordx4 v[224:227], v60, s[12:15], s35 offen offset:0 sc0 sc1
    buffer_store_dwordx2 v[228:229], v61, s[12:15], s35 offen offset:256 sc0 sc1
    v_mfma_f32_16x16x32_bf16 a[172:175], v[172:175], v[240:243], a[172:175]
    ds_read_b128 v[32:35], v0 offset:1536
    ds_read_b128 v[36:39], v0 offset:13824
    v_mfma_f32_16x16x32_bf16 a[172:175], v[188:191], v[244:247], a[172:175]
    s_waitcnt lgkmcnt(4)
    v_accvgpr_read_b32 v144, a97
    v_accvgpr_read_b32 v145, a101
    v_accvgpr_read_b32 v146, a105
    v_accvgpr_read_b32 v147, a109
    v_accvgpr_read_b32 v148, a113
    v_accvgpr_read_b32 v149, a117
    v_mfma_f32_16x16x32_bf16 a[176:179], v[172:175], v[248:251], a[176:179]
    ds_read_b128 v[40:43], v0 offset:2304
    ds_read_b128 v[44:47], v0 offset:14592
    v_mfma_f32_16x16x32_bf16 a[176:179], v[188:191], v[252:255], a[176:179]
    s_waitcnt lgkmcnt(4)
    v_accvgpr_read_b32 v150, a121
    v_accvgpr_read_b32 v151, a125
    v_accvgpr_read_b32 v152, a129
    v_accvgpr_read_b32 v153, a133
    v_accvgpr_read_b32 v154, a137
    v_accvgpr_read_b32 v155, a141
    v_mfma_f32_16x16x32_bf16 a[180:183], v[172:175], v[24:27], a[180:183]
    v_mul_f32 v144, v144, v57
    v_mul_f32 v145, v145, v57
    v_mfma_f32_16x16x32_bf16 a[180:183], v[188:191], v[28:31], a[180:183]
    s_waitcnt lgkmcnt(2)
    v_mul_f32 v146, v146, v57
    v_mul_f32 v147, v147, v57
    v_mul_f32 v148, v148, v57
    v_mul_f32 v149, v149, v57
    v_mul_f32 v150, v150, v57
    v_mul_f32 v151, v151, v57
    v_mfma_f32_16x16x32_bf16 a[184:187], v[172:175], v[32:35], a[184:187]
    v_mul_f32 v152, v152, v57
    v_mul_f32 v153, v153, v57
    v_mfma_f32_16x16x32_bf16 a[184:187], v[188:191], v[36:39], a[184:187]
    s_waitcnt lgkmcnt(0)
    v_mul_f32 v154, v154, v57
    v_mul_f32 v155, v155, v57
    v_cvt_pk_bf16_f32 v144, v144, v145
    v_cvt_pk_bf16_f32 v145, v146, v147
    v_cvt_pk_bf16_f32 v146, v148, v149
    v_cvt_pk_bf16_f32 v147, v150, v151
    v_mfma_f32_16x16x32_bf16 a[188:191], v[172:175], v[40:43], a[188:191]
    v_cvt_pk_bf16_f32 v148, v152, v153
    v_cvt_pk_bf16_f32 v149, v154, v155
    v_mfma_f32_16x16x32_bf16 a[188:191], v[188:191], v[44:47], a[188:191]
    buffer_store_dwordx4 v[144:147], v60, s[12:15], s35 offen offset:384 sc0 sc1
    buffer_store_dwordx2 v[148:149], v61, s[12:15], s35 offen offset:640 sc0 sc1
    v_accvgpr_read_b32 v224, a98
    v_accvgpr_read_b32 v225, a102
    v_accvgpr_read_b32 v226, a106
    v_accvgpr_read_b32 v227, a110
    v_accvgpr_read_b32 v228, a114
    v_accvgpr_read_b32 v229, a118
    v_accvgpr_read_b32 v230, a122
    v_accvgpr_read_b32 v231, a126
    v_accvgpr_read_b32 v232, a130
    v_accvgpr_read_b32 v233, a134
    v_accvgpr_read_b32 v234, a138
    v_accvgpr_read_b32 v235, a142
    v_mul_f32 v224, v224, v58
    v_mul_f32 v225, v225, v58
    v_mul_f32 v226, v226, v58
    v_mul_f32 v227, v227, v58
    v_mul_f32 v228, v228, v58
    v_mul_f32 v229, v229, v58
    v_mul_f32 v230, v230, v58
    v_mul_f32 v231, v231, v58
    v_mul_f32 v232, v232, v58
    v_mul_f32 v233, v233, v58
    v_mul_f32 v234, v234, v58
    v_mul_f32 v235, v235, v58
    v_cvt_pk_bf16_f32 v224, v224, v225
    v_cvt_pk_bf16_f32 v225, v226, v227
    v_cvt_pk_bf16_f32 v226, v228, v229
    v_cvt_pk_bf16_f32 v227, v230, v231
    v_cvt_pk_bf16_f32 v228, v232, v233
    v_cvt_pk_bf16_f32 v229, v234, v235
    buffer_store_dwordx4 v[224:227], v60, s[12:15], s35 offen offset:768 sc0 sc1
    buffer_store_dwordx2 v[228:229], v61, s[12:15], s35 offen offset:1024 sc0 sc1
    v_accvgpr_read_b32 v144, a99
    v_accvgpr_read_b32 v145, a103
    v_accvgpr_read_b32 v146, a107
    v_accvgpr_read_b32 v147, a111
    v_accvgpr_read_b32 v148, a115
    v_accvgpr_read_b32 v149, a119
    v_accvgpr_read_b32 v150, a123
    v_accvgpr_read_b32 v151, a127
    v_accvgpr_read_b32 v152, a131
    v_accvgpr_read_b32 v153, a135
    v_accvgpr_read_b32 v154, a139
    v_accvgpr_read_b32 v155, a143
    v_mul_f32 v144, v144, v59
    v_mul_f32 v145, v145, v59
    v_mul_f32 v146, v146, v59
    v_mul_f32 v147, v147, v59
    v_mul_f32 v148, v148, v59
    v_mul_f32 v149, v149, v59
    v_mul_f32 v150, v150, v59
    v_mul_f32 v151, v151, v59
    v_mul_f32 v152, v152, v59
    v_mul_f32 v153, v153, v59
    v_mul_f32 v154, v154, v59
    v_mul_f32 v155, v155, v59
    v_cvt_pk_bf16_f32 v144, v144, v145
    v_cvt_pk_bf16_f32 v145, v146, v147
    v_cvt_pk_bf16_f32 v146, v148, v149
    v_cvt_pk_bf16_f32 v147, v150, v151
    v_cvt_pk_bf16_f32 v148, v152, v153
    v_cvt_pk_bf16_f32 v149, v154, v155
    buffer_store_dwordx4 v[144:147], v60, s[12:15], s35 offen offset:1152 sc0 sc1
    buffer_store_dwordx2 v[148:149], v61, s[12:15], s35 offen offset:1408 sc0 sc1
    s_nop 4
    v_accvgpr_read_b32 v88, a144
    v_accvgpr_read_b32 v89, a148
    v_accvgpr_read_b32 v90, a152
    v_accvgpr_read_b32 v91, a156
    v_accvgpr_read_b32 v92, a160
    v_accvgpr_read_b32 v93, a164
    v_accvgpr_read_b32 v94, a168
    v_accvgpr_read_b32 v95, a172
    v_accvgpr_read_b32 v96, a176
    v_accvgpr_read_b32 v97, a180
    v_accvgpr_read_b32 v98, a184
    v_accvgpr_read_b32 v99, a188
    v_pk_mul_f32 v[88:89], v[88:89], v[128:129] op_sel:[0,0] op_sel_hi:[1,0]
    v_pk_mul_f32 v[90:91], v[90:91], v[128:129] op_sel:[0,0] op_sel_hi:[1,0]
    v_pk_mul_f32 v[92:93], v[92:93], v[128:129] op_sel:[0,0] op_sel_hi:[1,0]
    v_pk_mul_f32 v[94:95], v[94:95], v[128:129] op_sel:[0,0] op_sel_hi:[1,0]
    v_pk_mul_f32 v[96:97], v[96:97], v[128:129] op_sel:[0,0] op_sel_hi:[1,0]
    v_pk_mul_f32 v[98:99], v[98:99], v[128:129] op_sel:[0,0] op_sel_hi:[1,0]
    v_cvt_pk_bf16_f32 v88, v88, v89
    v_cvt_pk_bf16_f32 v89, v90, v91
    v_cvt_pk_bf16_f32 v90, v92, v93
    v_cvt_pk_bf16_f32 v91, v94, v95
    v_cvt_pk_bf16_f32 v92, v96, v97
    v_cvt_pk_bf16_f32 v93, v98, v99
    buffer_store_dwordx4 v[88:91], v60, s[12:15], s36 offen offset:0 sc0 sc1
    buffer_store_dwordx2 v[92:93], v61, s[12:15], s36 offen offset:256 sc0 sc1
    v_accvgpr_read_b32 v100, a145
    v_accvgpr_read_b32 v101, a149
    v_accvgpr_read_b32 v102, a153
    v_accvgpr_read_b32 v103, a157
    v_accvgpr_read_b32 v104, a161
    v_accvgpr_read_b32 v105, a165
    v_accvgpr_read_b32 v106, a169
    v_accvgpr_read_b32 v107, a173
    v_accvgpr_read_b32 v108, a177
    v_accvgpr_read_b32 v109, a181
    v_accvgpr_read_b32 v110, a185
    v_accvgpr_read_b32 v111, a189
    v_pk_mul_f32 v[100:101], v[100:101], v[128:129] op_sel:[0,1] op_sel_hi:[1,1]
    v_pk_mul_f32 v[102:103], v[102:103], v[128:129] op_sel:[0,1] op_sel_hi:[1,1]
    v_pk_mul_f32 v[104:105], v[104:105], v[128:129] op_sel:[0,1] op_sel_hi:[1,1]
    v_pk_mul_f32 v[106:107], v[106:107], v[128:129] op_sel:[0,1] op_sel_hi:[1,1]
    v_pk_mul_f32 v[108:109], v[108:109], v[128:129] op_sel:[0,1] op_sel_hi:[1,1]
    v_pk_mul_f32 v[110:111], v[110:111], v[128:129] op_sel:[0,1] op_sel_hi:[1,1]
    v_cvt_pk_bf16_f32 v100, v100, v101
    v_cvt_pk_bf16_f32 v101, v102, v103
    v_cvt_pk_bf16_f32 v102, v104, v105
    v_cvt_pk_bf16_f32 v103, v106, v107
    v_cvt_pk_bf16_f32 v104, v108, v109
    v_cvt_pk_bf16_f32 v105, v110, v111
    buffer_store_dwordx4 v[100:103], v60, s[12:15], s36 offen offset:384 sc0 sc1
    buffer_store_dwordx2 v[104:105], v61, s[12:15], s36 offen offset:640 sc0 sc1
    v_accvgpr_read_b32 v112, a146
    v_accvgpr_read_b32 v113, a150
    v_accvgpr_read_b32 v114, a154
    v_accvgpr_read_b32 v115, a158
    v_accvgpr_read_b32 v116, a162
    v_accvgpr_read_b32 v117, a166
    v_accvgpr_read_b32 v118, a170
    v_accvgpr_read_b32 v119, a174
    v_accvgpr_read_b32 v120, a178
    v_accvgpr_read_b32 v121, a182
    v_accvgpr_read_b32 v122, a186
    v_accvgpr_read_b32 v123, a190
    v_pk_mul_f32 v[112:113], v[112:113], v[130:131] op_sel:[0,0] op_sel_hi:[1,0]
    v_pk_mul_f32 v[114:115], v[114:115], v[130:131] op_sel:[0,0] op_sel_hi:[1,0]
    v_pk_mul_f32 v[116:117], v[116:117], v[130:131] op_sel:[0,0] op_sel_hi:[1,0]
    v_pk_mul_f32 v[118:119], v[118:119], v[130:131] op_sel:[0,0] op_sel_hi:[1,0]
    v_pk_mul_f32 v[120:121], v[120:121], v[130:131] op_sel:[0,0] op_sel_hi:[1,0]
    v_pk_mul_f32 v[122:123], v[122:123], v[130:131] op_sel:[0,0] op_sel_hi:[1,0]
    v_cvt_pk_bf16_f32 v112, v112, v113
    v_cvt_pk_bf16_f32 v113, v114, v115
    v_cvt_pk_bf16_f32 v114, v116, v117
    v_cvt_pk_bf16_f32 v115, v118, v119
    v_cvt_pk_bf16_f32 v116, v120, v121
    v_cvt_pk_bf16_f32 v117, v122, v123
    buffer_store_dwordx4 v[112:115], v60, s[12:15], s36 offen offset:768 sc0 sc1
    buffer_store_dwordx2 v[116:117], v61, s[12:15], s36 offen offset:1024 sc0 sc1
    v_accvgpr_read_b32 v64, a147
    v_accvgpr_read_b32 v65, a151
    v_accvgpr_read_b32 v66, a155
    v_accvgpr_read_b32 v67, a159
    v_accvgpr_read_b32 v68, a163
    v_accvgpr_read_b32 v69, a167
    v_accvgpr_read_b32 v70, a171
    v_accvgpr_read_b32 v71, a175
    v_accvgpr_read_b32 v72, a179
    v_accvgpr_read_b32 v73, a183
    v_accvgpr_read_b32 v74, a187
    v_accvgpr_read_b32 v75, a191
    v_pk_mul_f32 v[64:65], v[64:65], v[130:131] op_sel:[0,1] op_sel_hi:[1,1]
    v_pk_mul_f32 v[66:67], v[66:67], v[130:131] op_sel:[0,1] op_sel_hi:[1,1]
    v_pk_mul_f32 v[68:69], v[68:69], v[130:131] op_sel:[0,1] op_sel_hi:[1,1]
    v_pk_mul_f32 v[70:71], v[70:71], v[130:131] op_sel:[0,1] op_sel_hi:[1,1]
    v_pk_mul_f32 v[72:73], v[72:73], v[130:131] op_sel:[0,1] op_sel_hi:[1,1]
    v_pk_mul_f32 v[74:75], v[74:75], v[130:131] op_sel:[0,1] op_sel_hi:[1,1]
    v_cvt_pk_bf16_f32 v64, v64, v65
    v_cvt_pk_bf16_f32 v65, v66, v67
    v_cvt_pk_bf16_f32 v66, v68, v69
    v_cvt_pk_bf16_f32 v67, v70, v71
    v_cvt_pk_bf16_f32 v68, v72, v73
    v_cvt_pk_bf16_f32 v69, v74, v75
    buffer_store_dwordx4 v[64:67], v60, s[12:15], s36 offen offset:1152 sc0 sc1
    buffer_store_dwordx2 v[68:69], v61, s[12:15], s36 offen offset:1408 sc0 sc1
L_fin:
L_done:
    s_endpgm
L_pollslow0:
    s_mov_b32 s59, 200
L_pollsm0:
    s_buffer_load_dwordx8 s[48:55], s[20:23], 0 glc
    s_waitcnt lgkmcnt(0)
    s_sub_u32 s48, s48, s92
    s_sub_u32 s49, s49, s92
    s_sub_u32 s50, s50, s92
    s_sub_u32 s51, s51, s92
    s_sub_u32 s52, s52, s92
    s_sub_u32 s53, s53, s92
    s_sub_u32 s54, s54, s92
    s_sub_u32 s55, s55, s92
    s_max_u32 s48, s48, s49
    s_max_u32 s48, s48, s50
    s_max_u32 s48, s48, s51
    s_max_u32 s48, s48, s52
    s_max_u32 s48, s48, s53
    s_max_u32 s48, s48, s54
    s_max_u32 s48, s48, s55
    s_cmp_lt_u32 s48, 16
    s_cbranch_scc1 L_pollok0
    s_sub_u32 s59, s59, 1
    s_cbranch_scc1 L_pollvec0
    s_sleep 1
    s_branch L_pollsm0
L_pollvec0:
    s_sub_u32 s96, s96, 1
    s_cbranch_scc1 L_pollgiveup0
    s_sleep 2
    buffer_load_dword v52, v53, s[20:23], 0 offen sc1
    s_waitcnt vmcnt(0)
    v_subrev_u32 v52, s92, v52
    v_cmp_lt_u32 vcc, 15, v52
    s_nop 0
    s_and_b32 s59, vcc_lo, 0xff
    s_cbranch_scc1 L_pollvec0
    s_branch L_pollok0
L_pollgiveup0:
    s_mov_b32 s96, 0
    s_branch L_pollok0
L_pollslow1:
    s_mov_b32 s59, 200
L_pollsm1:
    s_buffer_load_dwordx8 s[48:55], s[20:23], 0 glc
    s_waitcnt lgkmcnt(0)
    s_sub_u32 s48, s48, s92
    s_sub_u32 s49, s49, s92
    s_sub_u32 s50, s50, s92
    s_sub_u32 s51, s51, s92
    s_sub_u32 s52, s52, s92
    s_sub_u32 s53, s53, s92
    s_sub_u32 s54, s54, s92
    s_sub_u32 s55, s55, s92
    s_max_u32 s48, s48, s49
    s_max_u32 s48, s48, s50
    s_max_u32 s48, s48, s51
    s_max_u32 s48, s48, s52
    s_max_u32 s48, s48, s53
    s_max_u32 s48, s48, s54
    s_max_u32 s48, s48, s55
    s_cmp_lt_u32 s48, 16
    s_cbranch_scc1 L_pollok1
    s_sub_u32 s59, s59, 1
    s_cbranch_scc1 L_pollvec1
    s_sleep 1
    s_branch L_pollsm1
L_pollvec1:
    s_sub_u32 s96, s96, 1
    s_cbranch_scc1 L_pollgiveup1
    s_sleep 2
    buffer_load_dword v52, v53, s[20:23], 0 offen sc1
    s_waitcnt vmcnt(0)
    v_subrev_u32 v52, s92, v52
    v_cmp_lt_u32 vcc, 15, v52
    s_nop 0
    s_and_b32 s59, vcc_lo, 0xff
    s_cbranch_scc1 L_pollvec1
    s_branch L_pollok1
L_pollgiveup1:
    s_mov_b32 s96, 0
    s_branch L_pollok1
L_pollslow2:
    s_mov_b32 s59, 200
L_pollsm2:
    s_buffer_load_dwordx8 s[48:55], s[20:23], 0 glc
    s_waitcnt lgkmcnt(0)
    s_sub_u32 s48, s48, s92
    s_sub_u32 s49, s49, s92
    s_sub_u32 s50, s50, s92
    s_sub_u32 s51, s51, s92
    s_sub_u32 s52, s52, s92
    s_sub_u32 s53, s53, s92
    s_sub_u32 s54, s54, s92
    s_sub_u32 s55, s55, s92
    s_max_u32 s48, s48, s49
    s_max_u32 s48, s48, s50
    s_max_u32 s48, s48, s51
    s_max_u32 s48, s48, s52
    s_max_u32 s48, s48, s53
    s_max_u32 s48, s48, s54
    s_max_u32 s48, s48, s55
    s_cmp_lt_u32 s48, 16
    s_cbranch_scc1 L_pollok2
    s_sub_u32 s59, s59, 1
    s_cbranch_scc1 L_pollvec2
    s_sleep 1
    s_branch L_pollsm2
L_pollvec2:
    s_sub_u32 s96, s96, 1
    s_cbranch_scc1 L_pollgiveup2
    s_sleep 2
    buffer_load_dword v52, v53, s[20:23], 0 offen sc1
    s_waitcnt vmcnt(0)
    v_subrev_u32 v52, s92, v52
    v_cmp_lt_u32 vcc, 15, v52
    s_nop 0
    s_and_b32 s59, vcc_lo, 0xff
    s_cbranch_scc1 L_pollvec2
    s_branch L_pollok2
L_pollgiveup2:
    s_mov_b32 s96, 0
    s_branch L_pollok2
L_pollslow3:
    s_mov_b32 s59, 200
L_pollsm3:
    s_buffer_load_dwordx8 s[48:55], s[20:23], 0 glc
    s_waitcnt lgkmcnt(0)
    s_sub_u32 s48, s48, s92
    s_sub_u32 s49, s49, s92
    s_sub_u32 s50, s50, s92
    s_sub_u32 s51, s51, s92
    s_sub_u32 s52, s52, s92
    s_sub_u32 s53, s53, s92
    s_sub_u32 s54, s54, s92
    s_sub_u32 s55, s55, s92
    s_max_u32 s48, s48, s49
    s_max_u32 s48, s48, s50
    s_max_u32 s48, s48, s51
    s_max_u32 s48, s48, s52
    s_max_u32 s48, s48, s53
    s_max_u32 s48, s48, s54
    s_max_u32 s48, s48, s55
    s_cmp_lt_u32 s48, 16
    s_cbranch_scc1 L_pollok3
    s_sub_u32 s59, s59, 1
    s_cbranch_scc1 L_pollvec3
    s_sleep 1
    s_branch L_pollsm3
L_pollvec3:
    s_sub_u32 s96, s96, 1
    s_cbranch_scc1 L_pollgiveup3
    s_sleep 2
    buffer_load_dword v52, v53, s[20:23], 0 offen sc1
    s_waitcnt vmcnt(0)
    v_subrev_u32 v52, s92, v52
    v_cmp_lt_u32 vcc, 15, v52
    s_nop 0
    s_and_b32 s59, vcc_lo, 0xff
    s_cbranch_scc1 L_pollvec3
    s_branch L_pollok3
L_pollgiveup3:
    s_mov_b32 s96, 0
    s_branch L_pollok3
L_pollslow4:
    s_mov_b32 s59, 200
L_pollsm4:
    s_buffer_load_dwordx8 s[48:55], s[20:23], 0 glc
    s_waitcnt lgkmcnt(0)
    s_sub_u32 s48, s48, s92
    s_sub_u32 s49, s49, s92
    s_sub_u32 s50, s50, s92
    s_sub_u32 s51, s51, s92
    s_sub_u32 s52, s52, s92
    s_sub_u32 s53, s53, s92
    s_sub_u32 s54, s54, s92
    s_sub_u32 s55, s55, s92
    s_max_u32 s48, s48, s49
    s_max_u32 s48, s48, s50
    s_max_u32 s48, s48, s51
    s_max_u32 s48, s48, s52
    s_max_u32 s48, s48, s53
    s_max_u32 s48, s48, s54
    s_max_u32 s48, s48, s55
    s_cmp_lt_u32 s48, 16
    s_cbranch_scc1 L_pollok4
    s_sub_u32 s59, s59, 1
    s_cbranch_scc1 L_pollvec4
    s_sleep 1
    s_branch L_pollsm4
L_pollvec4:
    s_sub_u32 s96, s96, 1
    s_cbranch_scc1 L_pollgiveup4
    s_sleep 2
    buffer_load_dword v52, v53, s[20:23], 0 offen sc1
    s_waitcnt vmcnt(0)
    v_subrev_u32 v52, s92, v52
    v_cmp_lt_u32 vcc, 15, v52
    s_nop 0
    s_and_b32 s59, vcc_lo, 0xff
    s_cbranch_scc1 L_pollvec4
    s_branch L_pollok4
L_pollgiveup4:
    s_mov_b32 s96, 0
    s_branch L_pollok4
L_pollslow5:
    s_mov_b32 s59, 200
L_pollsm5:
    s_buffer_load_dwordx8 s[48:55], s[20:23], 0 glc
    s_waitcnt lgkmcnt(0)
    s_sub_u32 s48, s48, s92
    s_sub_u32 s49, s49, s92
    s_sub_u32 s50, s50, s92
    s_sub_u32 s51, s51, s92
    s_sub_u32 s52, s52, s92
    s_sub_u32 s53, s53, s92
    s_sub_u32 s54, s54, s92
    s_sub_u32 s55, s55, s92
    s_max_u32 s48, s48, s49
    s_max_u32 s48, s48, s50
    s_max_u32 s48, s48, s51
    s_max_u32 s48, s48, s52
    s_max_u32 s48, s48, s53
    s_max_u32 s48, s48, s54
    s_max_u32 s48, s48, s55
    s_cmp_lt_u32 s48, 16
    s_cbranch_scc1 L_pollok5
    s_sub_u32 s59, s59, 1
    s_cbranch_scc1 L_pollvec5
    s_sleep 1
    s_branch L_pollsm5
L_pollvec5:
    s_sub_u32 s96, s96, 1
    s_cbranch_scc1 L_pollgiveup5
    s_sleep 2
    buffer_load_dword v52, v53, s[20:23], 0 offen sc1
    s_waitcnt vmcnt(0)
    v_subrev_u32 v52, s92, v52
    v_cmp_lt_u32 vcc, 15, v52
    s_nop 0
    s_and_b32 s59, vcc_lo, 0xff
    s_cbranch_scc1 L_pollvec5
    s_branch L_pollok5
L_pollgiveup5:
    s_mov_b32 s96, 0
    s_branch L_pollok5
L_pollslow6:
    s_mov_b32 s59, 200
L_pollsm6:
    s_buffer_load_dwordx8 s[48:55], s[20:23], 0 glc
    s_waitcnt lgkmcnt(0)
    s_sub_u32 s48, s48, s92
    s_sub_u32 s49, s49, s92
    s_sub_u32 s50, s50, s92
    s_sub_u32 s51, s51, s92
    s_sub_u32 s52, s52, s92
    s_sub_u32 s53, s53, s92
    s_sub_u32 s54, s54, s92
    s_sub_u32 s55, s55, s92
    s_max_u32 s48, s48, s49
    s_max_u32 s48, s48, s50
    s_max_u32 s48, s48, s51
    s_max_u32 s48, s48, s52
    s_max_u32 s48, s48, s53
    s_max_u32 s48, s48, s54
    s_max_u32 s48, s48, s55
    s_cmp_lt_u32 s48, 16
    s_cbranch_scc1 L_pollok6
    s_sub_u32 s59, s59, 1
    s_cbranch_scc1 L_pollvec6
    s_sleep 1
    s_branch L_pollsm6
L_pollvec6:
    s_sub_u32 s96, s96, 1
    s_cbranch_scc1 L_pollgiveup6
    s_sleep 2
    buffer_load_dword v52, v53, s[20:23], 0 offen sc1
    s_waitcnt vmcnt(0)
    v_subrev_u32 v52, s92, v52
    v_cmp_lt_u32 vcc, 15, v52
    s_nop 0
    s_and_b32 s59, vcc_lo, 0xff
    s_cbranch_scc1 L_pollvec6
    s_branch L_pollok6
L_pollgiveup6:
    s_mov_b32 s96, 0
    s_branch L_pollok6
L_pollslow7:
    s_mov_b32 s59, 200
L_pollsm7:
    s_buffer_load_dwordx8 s[48:55], s[20:23], 0 glc
    s_waitcnt lgkmcnt(0)
    s_sub_u32 s48, s48, s92
    s_sub_u32 s49, s49, s92
    s_sub_u32 s50, s50, s92
    s_sub_u32 s51, s51, s92
    s_sub_u32 s52, s52, s92
    s_sub_u32 s53, s53, s92
    s_sub_u32 s54, s54, s92
    s_sub_u32 s55, s55, s92
    s_max_u32 s48, s48, s49
    s_max_u32 s48, s48, s50
    s_max_u32 s48, s48, s51
    s_max_u32 s48, s48, s52
    s_max_u32 s48, s48, s53
    s_max_u32 s48, s48, s54
    s_max_u32 s48, s48, s55
    s_cmp_lt_u32 s48, 16
    s_cbranch_scc1 L_pollok7
    s_sub_u32 s59, s59, 1
    s_cbranch_scc1 L_pollvec7
    s_sleep 1
    s_branch L_pollsm7
L_pollvec7:
    s_sub_u32 s96, s96, 1
    s_cbranch_scc1 L_pollgiveup7
    s_sleep 2
    buffer_load_dword v52, v53, s[20:23], 0 offen sc1
    s_waitcnt vmcnt(0)
    v_subrev_u32 v52, s92, v52
    v_cmp_lt_u32 vcc, 15, v52
    s_nop 0
    s_and_b32 s59, vcc_lo, 0xff
    s_cbranch_scc1 L_pollvec7
    s_branch L_pollok7
L_pollgiveup7:
    s_mov_b32 s96, 0
    s_branch L_pollok7
L_pollslowP:
L_pollvecP:
    s_sub_u32 s96, s96, 1
    s_cbranch_scc1 L_pollgiveupP
    s_sleep 2
    buffer_load_dword v52, v53, s[20:23], 0 offen sc1
    s_waitcnt vmcnt(0)
    v_subrev_u32 v52, s92, v52
    v_cmp_lt_u32 vcc, 15, v52
    s_nop 0
    s_and_b32 s59, vcc_lo, 0xff
    s_cbranch_scc1 L_pollvecP
    s_branch L_pollokP
L_pollgiveupP:
    s_mov_b32 s96, 0
    s_branch L_pollokP
L_tagslow:
    s_sub_u32 s96, s96, 1
    s_cbranch_scc1 L_taggiveup
    s_sleep 2
    buffer_load_dword v52, off, s[88:91], s93 sc1
    s_waitcnt vmcnt(0)
    v_readfirstlane_b32 s92, v52
    s_nop 0
    s_cmp_eq_u32 s92, 0
    s_cbranch_scc1 L_tagslow
    s_branch L_tagok
L_taggiveup:
    s_mov_b32 s96, 0
    s_branch L_tagok
L_slow:
    s_waitcnt vmcnt(0) lgkmcnt(0)
    s_nop 15
    v_accvgpr_write_b32 a0, 0
    v_accvgpr_write_b32 a1, 0
    v_accvgpr_write_b32 a2, 0
    v_accvgpr_write_b32 a3, 0
    v_accvgpr_write_b32 a4, 0
    v_accvgpr_write_b32 a5, 0
    v_accvgpr_write_b32 a6, 0
    v_accvgpr_write_b32 a7, 0
    v_accvgpr_write_b32 a8, 0
    v_accvgpr_write_b32 a9, 0
    v_accvgpr_write_b32 a10, 0
    v_accvgpr_write_b32 a11, 0
    v_accvgpr_write_b32 a12, 0
    v_accvgpr_write_b32 a13, 0
    v_accvgpr_write_b32 a14, 0
    v_accvgpr_write_b32 a15, 0
    v_accvgpr_write_b32 a16, 0
    v_accvgpr_write_b32 a17, 0
    v_accvgpr_write_b32 a18, 0
    v_accvgpr_write_b32 a19, 0
    v_accvgpr_write_b32 a20, 0
    v_accvgpr_write_b32 a21, 0
    v_accvgpr_write_b32 a22, 0
    v_accvgpr_write_b32 a23, 0
    v_accvgpr_write_b32 a24, 0
    v_accvgpr_write_b32 a25, 0
    v_accvgpr_write_b32 a26, 0
    v_accvgpr_write_b32 a27, 0
    v_accvgpr_write_b32 a28, 0
    v_accvgpr_write_b32 a29, 0
    v_accvgpr_write_b32 a30, 0
    v_accvgpr_write_b32 a31, 0
    v_accvgpr_write_b32 a32, 0
    v_accvgpr_write_b32 a33, 0
    v_accvgpr_write_b32 a34, 0
    v_accvgpr_write_b32 a35, 0
    v_accvgpr_write_b32 a36, 0
    v_accvgpr_write_b32 a37, 0
    v_accvgpr_write_b32 a38, 0
    v_accvgpr_write_b32 a39, 0
    v_accvgpr_write_b32 a40, 0
    v_accvgpr_write_b32 a41, 0
    v_accvgpr_write_b32 a42, 0
    v_accvgpr_write_b32 a43, 0
    v_accvgpr_write_b32 a44, 0
    v_accvgpr_write_b32 a45, 0
    v_accvgpr_write_b32 a46, 0
    v_accvgpr_write_b32 a47, 0
    v_accvgpr_write_b32 a48, 0
    v_accvgpr_write_b32 a49, 0
    v_accvgpr_write_b32 a50, 0
    v_accvgpr_write_b32 a51, 0
    v_accvgpr_write_b32 a52, 0
    v_accvgpr_write_b32 a53, 0
    v_accvgpr_write_b32 a54, 0
    v_accvgpr_write_b32 a55, 0
    v_accvgpr_write_b32 a56, 0
    v_accvgpr_write_b32 a57, 0
    v_accvgpr_write_b32 a58, 0
    v_accvgpr_write_b32 a59, 0
    v_accvgpr_write_b32 a60, 0
    v_accvgpr_write_b32 a61, 0
    v_accvgpr_write_b32 a62, 0
    v_accvgpr_write_b32 a63, 0
    v_accvgpr_write_b32 a64, 0
    v_accvgpr_write_b32 a65, 0
    v_accvgpr_write_b32 a66, 0
    v_accvgpr_write_b32 a67, 0
    v_accvgpr_write_b32 a68, 0
    v_accvgpr_write_b32 a69, 0
    v_accvgpr_write_b32 a70, 0
    v_accvgpr_write_b32 a71, 0
    v_accvgpr_write_b32 a72, 0
    v_accvgpr_write_b32 a73, 0
    v_accvgpr_write_b32 a74, 0
    v_accvgpr_write_b32 a75, 0
    v_accvgpr_write_b32 a76, 0
    v_accvgpr_write_b32 a77, 0
    v_accvgpr_write_b32 a78, 0
    v_accvgpr_write_b32 a79, 0
    v_accvgpr_write_b32 a80, 0
    v_accvgpr_write_b32 a81, 0
    v_accvgpr_write_b32 a82, 0
    v_accvgpr_write_b32 a83, 0
    v_accvgpr_write_b32 a84, 0
    v_accvgpr_write_b32 a85, 0
    v_accvgpr_write_b32 a86, 0
    v_accvgpr_write_b32 a87, 0
    v_accvgpr_write_b32 a88, 0
    v_accvgpr_write_b32 a89, 0
    v_accvgpr_write_b32 a90, 0
    v_accvgpr_write_b32 a91, 0
    v_accvgpr_write_b32 a92, 0
    v_accvgpr_write_b32 a93, 0
    v_accvgpr_write_b32 a94, 0
    v_accvgpr_write_b32 a95, 0
    v_accvgpr_write_b32 a96, 0
    v_accvgpr_write_b32 a97, 0
    v_accvgpr_write_b32 a98, 0
    v_accvgpr_write_b32 a99, 0
    v_accvgpr_write_b32 a100, 0
    v_accvgpr_write_b32 a101, 0
    v_accvgpr_write_b32 a102, 0
    v_accvgpr_write_b32 a103, 0
    v_accvgpr_write_b32 a104, 0
    v_accvgpr_write_b32 a105, 0
    v_accvgpr_write_b32 a106, 0
    v_accvgpr_write_b32 a107, 0
    v_accvgpr_write_b32 a108, 0
    v_accvgpr_write_b32 a109, 0
    v_accvgpr_write_b32 a110, 0
    v_accvgpr_write_b32 a111, 0
    v_accvgpr_write_b32 a112, 0
    v_accvgpr_write_b32 a113, 0
    v_accvgpr_write_b32 a114, 0
    v_accvgpr_write_b32 a115, 0
    v_accvgpr_write_b32 a116, 0
    v_accvgpr_write_b32 a117, 0
    v_accvgpr_write_b32 a118, 0
    v_accvgpr_write_b32 a119, 0
    v_accvgpr_write_b32 a120, 0
    v_accvgpr_write_b32 a121, 0
    v_accvgpr_write_b32 a122, 0
    v_accvgpr_write_b32 a123, 0
    v_accvgpr_write_b32 a124, 0
    v_accvgpr_write_b32 a125, 0
    v_accvgpr_write_b32 a126, 0
    v_accvgpr_write_b32 a127, 0
    v_accvgpr_write_b32 a128, 0
    v_accvgpr_write_b32 a129, 0
    v_accvgpr_write_b32 a130, 0
    v_accvgpr_write_b32 a131, 0
    v_accvgpr_write_b32 a132, 0
    v_accvgpr_write_b32 a133, 0
    v_accvgpr_write_b32 a134, 0
    v_accvgpr_write_b32 a135, 0
    v_accvgpr_write_b32 a136, 0
    v_accvgpr_write_b32 a137, 0
    v_accvgpr_write_b32 a138, 0
    v_accvgpr_write_b32 a139, 0
    v_accvgpr_write_b32 a140, 0
    v_accvgpr_write_b32 a141, 0
    v_accvgpr_write_b32 a142, 0
    v_accvgpr_write_b32 a143, 0
    v_accvgpr_write_b32 a144, 0
    v_accvgpr_write_b32 a145, 0
    v_accvgpr_write_b32 a146, 0
    v_accvgpr_write_b32 a147, 0
    v_accvgpr_write_b32 a148, 0
    v_accvgpr_write_b32 a149, 0
    v_accvgpr_write_b32 a150, 0
    v_accvgpr_write_b32 a151, 0
    v_accvgpr_write_b32 a152, 0
    v_accvgpr_write_b32 a153, 0
    v_accvgpr_write_b32 a154, 0
    v_accvgpr_write_b32 a155, 0
    v_accvgpr_write_b32 a156, 0
    v_accvgpr_write_b32 a157, 0
    v_accvgpr_write_b32 a158, 0
    v_accvgpr_write_b32 a159, 0
    v_accvgpr_write_b32 a160, 0
    v_accvgpr_write_b32 a161, 0
    v_accvgpr_write_b32 a162, 0
    v_accvgpr_write_b32 a163, 0
    v_accvgpr_write_b32 a164, 0
    v_accvgpr_write_b32 a165, 0
    v_accvgpr_write_b32 a166, 0
    v_accvgpr_write_b32 a167, 0
    v_accvgpr_write_b32 a168, 0
    v_accvgpr_write_b32 a169, 0
    v_accvgpr_write_b32 a170, 0
    v_accvgpr_write_b32 a171, 0
    v_accvgpr_write_b32 a172, 0
    v_accvgpr_write_b32 a173, 0
    v_accvgpr_write_b32 a174, 0
    v_accvgpr_write_b32 a175, 0
    v_accvgpr_write_b32 a176, 0
    v_accvgpr_write_b32 a177, 0
    v_accvgpr_write_b32 a178, 0
    v_accvgpr_write_b32 a179, 0
    v_accvgpr_write_b32 a180, 0
    v_accvgpr_write_b32 a181, 0
    v_accvgpr_write_b32 a182, 0
    v_accvgpr_write_b32 a183, 0
    v_accvgpr_write_b32 a184, 0
    v_accvgpr_write_b32 a185, 0
    v_accvgpr_write_b32 a186, 0
    v_accvgpr_write_b32 a187, 0
    v_accvgpr_write_b32 a188, 0
    v_accvgpr_write_b32 a189, 0
    v_accvgpr_write_b32 a190, 0
    v_accvgpr_write_b32 a191, 0
    v_mov_b32 v4, 0
    v_mov_b32 v240, 0xff7fffff
    v_mov_b32 v5, 0
    v_mov_b32 v241, 0xff7fffff
    v_mov_b32 v6, 0
    v_mov_b32 v242, 0xff7fffff
    v_mov_b32 v7, 0
    v_mov_b32 v243, 0xff7fffff
    v_subrev_u32 v244, s28, v2
    v_subrev_u32 v245, s28, v3
    v_subrev_u32 v246, s30, v1
    v_subrev_u32 v247, s30, v21
    v_subrev_u32 v248, s30, v22
    s_mov_b32 s48, 0
L_slowloop:
    s_add_u32 s49, s48, 6144
    s_add_u32 s50, s48, 12288
    buffer_load_dwordx4 v[64:67], v244, s[4:7], s48 offen offset:0 sc1
    buffer_load_dwordx4 v[68:71], v245, s[4:7], s48 offen offset:0 sc1
    buffer_load_dwordx4 v[72:75], v244, s[4:7], s49 offen offset:0 sc1
    buffer_load_dwordx4 v[76:79], v245, s[4:7], s49 offen offset:0 sc1
    buffer_load_dwordx4 v[80:83], v244, s[4:7], s48 offen offset:128 sc1
    buffer_load_dwordx4 v[84:87], v245, s[4:7], s48 offen offset:128 sc1
    buffer_load_dwordx4 v[88:91], v244, s[4:7], s49 offen offset:128 sc1
    buffer_load_dwordx4 v[92:95], v245, s[4:7], s49 offen offset:128 sc1
    buffer_load_dwordx4 v[96:99], v244, s[4:7], s48 offen offset:256 sc1
    buffer_load_dwordx4 v[100:103], v245, s[4:7], s48 offen offset:256 sc1
    buffer_load_dwordx4 v[104:107], v244, s[4:7], s49 offen offset:256 sc1
    buffer_load_dwordx4 v[108:111], v245, s[4:7], s49 offen offset:256 sc1
    buffer_load_dwordx4 v[112:115], v246, s[4:7], s50 offen offset:0 sc1
    buffer_load_dwordx4 v[116:119], v246, s[4:7], s50 offen offset:768 sc1
    buffer_load_dwordx4 v[120:123], v246, s[4:7], s50 offen offset:1536 sc1
    buffer_load_dwordx4 v[124:127], v246, s[4:7], s50 offen offset:2304 sc1
    buffer_load_dwordx4 v[128:131], v247, s[4:7], s50 offen offset:0 sc1
    buffer_load_dwordx4 v[132:135], v247, s[4:7], s50 offen offset:768 sc1
    buffer_load_dwordx4 v[136:139], v247, s[4:7], s50 offen offset:1536 sc1
    buffer_load_dwordx4 v[140:143], v247, s[4:7], s50 offen offset:2304 sc1
    buffer_load_dwordx4 v[144:147], v248, s[4:7], s50 offen offset:0 sc1
    buffer_load_dwordx4 v[148:151], v248, s[4:7], s50 offen offset:768 sc1
    buffer_load_dwordx4 v[152:155], v248, s[4:7], s50 offen offset:1536 sc1
    buffer_load_dwordx4 v[156:159], v248, s[4:7], s50 offen offset:2304 sc1
    s_waitcnt vmcnt(12)
    v_mfma_f32_16x16x32_bf16 v[160:163], v[64:67], a[192:195], 0
    v_mfma_f32_16x16x32_bf16 v[168:171], v[64:67], a[216:219], 0
    v_mfma_f32_16x16x32_bf16 v[176:179], v[64:67], a[240:243], 0
    v_mfma_f32_16x16x32_bf16 v[184:187], v[64:67], v[200:203], 0
    v_mfma_f32_16x16x32_bf16 v[160:163], v[68:71], a[196:199], v[160:163]
    v_mfma_f32_16x16x32_bf16 v[168:171], v[68:71], a[220:223], v[168:171]
    v_mfma_f32_16x16x32_bf16 v[176:179], v[68:71], a[244:247], v[176:179]
    v_mfma_f32_16x16x32_bf16 v[184:187], v[68:71], v[204:207], v[184:187]
    v_mfma_f32_16x16x32_bf16 v[164:167], v[72:75], a[192:195], 0
    v_mfma_f32_16x16x32_bf16 v[172:175], v[72:75], a[216:219], 0
    v_mfma_f32_16x16x32_bf16 v[180:183], v[72:75], a[240:243], 0
    v_mfma_f32_16x16x32_bf16 v[188:191], v[72:75], v[200:203], 0
    v_mfma_f32_16x16x32_bf16 v[164:167], v[76:79], a[196:199], v[164:167]
    v_mfma_f32_16x16x32_bf16 v[172:175], v[76:79], a[220:223], v[172:175]
    v_mfma_f32_16x16x32_bf16 v[180:183], v[76:79], a[244:247], v[180:183]
    v_mfma_f32_16x16x32_bf16 v[188:191], v[76:79], v[204:207], v[188:191]
    v_mfma_f32_16x16x32_bf16 v[160:163], v[80:83], a[200:203], v[160:163]
    v_mfma_f32_16x16x32_bf16 v[168:171], v[80:83], a[224:227], v[168:171]
    v_mfma_f32_16x16x32_bf16 v[176:179], v[80:83], a[248:251], v[176:179]
    v_mfma_f32_16x16x32_bf16 v[184:187], v[80:83], v[208:211], v[184:187]
    v_mfma_f32_16x16x32_bf16 v[160:163], v[84:87], a[204:207], v[160:163]
    v_mfma_f32_16x16x32_bf16 v[168:171], v[84:87], a[228:231], v[168:171]
    v_mfma_f32_16x16x32_bf16 v[176:179], v[84:87], a[252:255], v[176:179]
    v_mfma_f32_16x16x32_bf16 v[184:187], v[84:87], v[212:215], v[184:187]
    v_mfma_f32_16x16x32_bf16 v[164:167], v[88:91], a[200:203], v[164:167]
    v_mfma_f32_16x16x32_bf16 v[172:175], v[88:91], a[224:227], v[172:175]
    v_mfma_f32_16x16x32_bf16 v[180:183], v[88:91], a[248:251], v[180:183]
    v_mfma_f32_16x16x32_bf16 v[188:191], v[88:91], v[208:211], v[188:191]
    v_mfma_f32_16x16x32_bf16 v[164:167], v[92:95], a[204:207], v[164:167]
    v_mfma_f32_16x16x32_bf16 v[172:175], v[92:95], a[228:231], v[172:175]
    v_mfma_f32_16x16x32_bf16 v[180:183], v[92:95], a[252:255], v[180:183]
    v_mfma_f32_16x16x32_bf16 v[188:191], v[92:95], v[212:215], v[188:191]
    v_mfma_f32_16x16x32_bf16 v[160:163], v[96:99], a[208:211], v[160:163]
    v_mfma_f32_16x16x32_bf16 v[168:171], v[96:99], a[232:235], v[168:171]
    v_mfma_f32_16x16x32_bf16 v[176:179], v[96:99], v[192:195], v[176:179]
    v_mfma_f32_16x16x32_bf16 v[184:187], v[96:99], v[216:219], v[184:187]
    v_mfma_f32_16x16x32_bf16 v[160:163], v[100:103], a[212:215], v[160:163]
    v_mfma_f32_16x16x32_bf16 v[168:171], v[100:103], a[236:239], v[168:171]
    v_mfma_f32_16x16x32_bf16 v[176:179], v[100:103], v[196:199], v[176:179]
    v_mfma_f32_16x16x32_bf16 v[184:187], v[100:103], v[220:223], v[184:187]
    v_mfma_f32_16x16x32_bf16 v[164:167], v[104:107], a[208:211], v[164:167]
    v_mfma_f32_16x16x32_bf16 v[172:175], v[104:107], a[232:235], v[172:175]
    v_mfma_f32_16x16x32_bf16 v[180:183], v[104:107], v[192:195], v[180:183]
    v_mfma_f32_16x16x32_bf16 v[188:191], v[104:107], v[216:219], v[188:191]
    v_mfma_f32_16x16x32_bf16 v[164:167], v[108:111], a[212:215], v[164:167]
    v_mfma_f32_16x16x32_bf16 v[172:175], v[108:111], a[236:239], v[172:175]
    v_mfma_f32_16x16x32_bf16 v[180:183], v[108:111], v[196:199], v[180:183]
    v_mfma_f32_16x16x32_bf16 v[188:191], v[108:111], v[220:223], v[188:191]
    s_nop 9
    v_max3_f32 v16, v160, v161, v162
    v_max3_f32 v16, v16, v163, v164
    v_max3_f32 v16, v16, v165, v166
    v_max3_f32 v16, v16, v167, v240
    v_mov_b32 v17, v16
    s_nop 1
    v_permlane16_swap_b32 v16, v17
    s_nop 1
    v_max_f32 v16, v16, v17
    v_mov_b32 v17, v16
    s_nop 1
    v_permlane32_swap_b32 v16, v17
    s_nop 1
    v_max_f32 v16, v16, v17
    v_sub_f32 v17, v240, v16
    v_exp_f32 v17, v17
    v_mov_b32 v240, v16
    ds_bpermute_b32 v250, v62, v17 offset:0
    ds_bpermute_b32 v251, v62, v17 offset:4
    ds_bpermute_b32 v252, v62, v17 offset:8
    ds_bpermute_b32 v253, v62, v17 offset:12
    v_sub_f32 v160, v160, v16
    v_sub_f32 v161, v161, v16
    v_sub_f32 v162, v162, v16
    v_sub_f32 v163, v163, v16
    v_sub_f32 v164, v164, v16
    v_sub_f32 v165, v165, v16
    v_sub_f32 v166, v166, v16
    v_sub_f32 v167, v167, v16
    v_exp_f32 v160, v160
    v_exp_f32 v161, v161
    v_exp_f32 v162, v162
    v_exp_f32 v163, v163
    v_exp_f32 v164, v164
    v_exp_f32 v165, v165
    v_exp_f32 v166, v166
    v_exp_f32 v167, v167
    v_mul_f32 v4, v4, v17
    v_add_f32 v4, v4, v160
    v_add_f32 v4, v4, v161
    v_add_f32 v4, v4, v162
    v_add_f32 v4, v4, v163
    v_add_f32 v4, v4, v164
    v_add_f32 v4, v4, v165
    v_add_f32 v4, v4, v166
    v_add_f32 v4, v4, v167
    v_cvt_pk_bf16_f32 v224, v160, v161
    v_cvt_pk_bf16_f32 v225, v162, v163
    v_cvt_pk_bf16_f32 v226, v164, v165
    v_cvt_pk_bf16_f32 v227, v166, v167
    s_waitcnt lgkmcnt(0)
    v_accvgpr_read_b32 v18, a0
    v_mul_f32 v18, v18, v250
    v_accvgpr_write_b32 a0, v18
    v_accvgpr_read_b32 v19, a1
    v_mul_f32 v19, v19, v251
    v_accvgpr_write_b32 a1, v19
    v_accvgpr_read_b32 v18, a2
    v_mul_f32 v18, v18, v252
    v_accvgpr_write_b32 a2, v18
    v_accvgpr_read_b32 v19, a3
    v_mul_f32 v19, v19, v253
    v_accvgpr_write_b32 a3, v19
    v_accvgpr_read_b32 v18, a4
    v_mul_f32 v18, v18, v250
    v_accvgpr_write_b32 a4, v18
    v_accvgpr_read_b32 v19, a5
    v_mul_f32 v19, v19, v251
    v_accvgpr_write_b32 a5, v19
    v_accvgpr_read_b32 v18, a6
    v_mul_f32 v18, v18, v252
    v_accvgpr_write_b32 a6, v18
    v_accvgpr_read_b32 v19, a7
    v_mul_f32 v19, v19, v253
    v_accvgpr_write_b32 a7, v19
    v_accvgpr_read_b32 v18, a8
    v_mul_f32 v18, v18, v250
    v_accvgpr_write_b32 a8, v18
    v_accvgpr_read_b32 v19, a9
    v_mul_f32 v19, v19, v251
    v_accvgpr_write_b32 a9, v19
    v_accvgpr_read_b32 v18, a10
    v_mul_f32 v18, v18, v252
    v_accvgpr_write_b32 a10, v18
    v_accvgpr_read_b32 v19, a11
    v_mul_f32 v19, v19, v253
    v_accvgpr_write_b32 a11, v19
    v_accvgpr_read_b32 v18, a12
    v_mul_f32 v18, v18, v250
    v_accvgpr_write_b32 a12, v18
    v_accvgpr_read_b32 v19, a13
    v_mul_f32 v19, v19, v251
    v_accvgpr_write_b32 a13, v19
    v_accvgpr_read_b32 v18, a14
    v_mul_f32 v18, v18, v252
    v_accvgpr_write_b32 a14, v18
    v_accvgpr_read_b32 v19, a15
    v_mul_f32 v19, v19, v253
    v_accvgpr_write_b32 a15, v19
    v_accvgpr_read_b32 v18, a16
    v_mul_f32 v18, v18, v250
    v_accvgpr_write_b32 a16, v18
    v_accvgpr_read_b32 v19, a17
    v_mul_f32 v19, v19, v251
    v_accvgpr_write_b32 a17, v19
    v_accvgpr_read_b32 v18, a18
    v_mul_f32 v18, v18, v252
    v_accvgpr_write_b32 a18, v18
    v_accvgpr_read_b32 v19, a19
    v_mul_f32 v19, v19, v253
    v_accvgpr_write_b32 a19, v19
    v_accvgpr_read_b32 v18, a20
    v_mul_f32 v18, v18, v250
    v_accvgpr_write_b32 a20, v18
    v_accvgpr_read_b32 v19, a21
    v_mul_f32 v19, v19, v251
    v_accvgpr_write_b32 a21, v19
    v_accvgpr_read_b32 v18, a22
    v_mul_f32 v18, v18, v252
    v_accvgpr_write_b32 a22, v18
    v_accvgpr_read_b32 v19, a23
    v_mul_f32 v19, v19, v253
    v_accvgpr_write_b32 a23, v19
    v_accvgpr_read_b32 v18, a24
    v_mul_f32 v18, v18, v250
    v_accvgpr_write_b32 a24, v18
    v_accvgpr_read_b32 v19, a25
    v_mul_f32 v19, v19, v251
    v_accvgpr_write_b32 a25, v19
    v_accvgpr_read_b32 v18, a26
    v_mul_f32 v18, v18, v252
    v_accvgpr_write_b32 a26, v18
    v_accvgpr_read_b32 v19, a27
    v_mul_f32 v19, v19, v253
    v_accvgpr_write_b32 a27, v19
    v_accvgpr_read_b32 v18, a28
    v_mul_f32 v18, v18, v250
    v_accvgpr_write_b32 a28, v18
    v_accvgpr_read_b32 v19, a29
    v_mul_f32 v19, v19, v251
    v_accvgpr_write_b32 a29, v19
    v_accvgpr_read_b32 v18, a30
    v_mul_f32 v18, v18, v252
    v_accvgpr_write_b32 a30, v18
    v_accvgpr_read_b32 v19, a31
    v_mul_f32 v19, v19, v253
    v_accvgpr_write_b32 a31, v19
    v_accvgpr_read_b32 v18, a32
    v_mul_f32 v18, v18, v250
    v_accvgpr_write_b32 a32, v18
    v_accvgpr_read_b32 v19, a33
    v_mul_f32 v19, v19, v251
    v_accvgpr_write_b32 a33, v19
    v_accvgpr_read_b32 v18, a34
    v_mul_f32 v18, v18, v252
    v_accvgpr_write_b32 a34, v18
    v_accvgpr_read_b32 v19, a35
    v_mul_f32 v19, v19, v253
    v_accvgpr_write_b32 a35, v19
    v_accvgpr_read_b32 v18, a36
    v_mul_f32 v18, v18, v250
    v_accvgpr_write_b32 a36, v18
    v_accvgpr_read_b32 v19, a37
    v_mul_f32 v19, v19, v251
    v_accvgpr_write_b32 a37, v19
    v_accvgpr_read_b32 v18, a38
    v_mul_f32 v18, v18, v252
    v_accvgpr_write_b32 a38, v18
    v_accvgpr_read_b32 v19, a39
    v_mul_f32 v19, v19, v253
    v_accvgpr_write_b32 a39, v19
    v_accvgpr_read_b32 v18, a40
    v_mul_f32 v18, v18, v250
    v_accvgpr_write_b32 a40, v18
    v_accvgpr_read_b32 v19, a41
    v_mul_f32 v19, v19, v251
    v_accvgpr_write_b32 a41, v19
    v_accvgpr_read_b32 v18, a42
    v_mul_f32 v18, v18, v252
    v_accvgpr_write_b32 a42, v18
    v_accvgpr_read_b32 v19, a43
    v_mul_f32 v19, v19, v253
    v_accvgpr_write_b32 a43, v19
    v_accvgpr_read_b32 v18, a44
    v_mul_f32 v18, v18, v250
    v_accvgpr_write_b32 a44, v18
    v_accvgpr_read_b32 v19, a45
    v_mul_f32 v19, v19, v251
    v_accvgpr_write_b32 a45, v19
    v_accvgpr_read_b32 v18, a46
    v_mul_f32 v18, v18, v252
    v_accvgpr_write_b32 a46, v18
    v_accvgpr_read_b32 v19, a47
    v_mul_f32 v19, v19, v253
    v_accvgpr_write_b32 a47, v19
    v_max3_f32 v16, v168, v169, v170
    v_max3_f32 v16, v16, v171, v172
    v_max3_f32 v16, v16, v173, v174
    v_max3_f32 v16, v16, v175, v241
    v_mov_b32 v17, v16
    s_nop 1
    v_permlane16_swap_b32 v16, v17
    s_nop 1
    v_max_f32 v16, v16, v17
    v_mov_b32 v17, v16
    s_nop 1
    v_permlane32_swap_b32 v16, v17
    s_nop 1
    v_max_f32 v16, v16, v17
    v_sub_f32 v17, v241, v16
    v_exp_f32 v17, v17
    v_mov_b32 v241, v16
    ds_bpermute_b32 v250, v62, v17 offset:0
    ds_bpermute_b32 v251, v62, v17 offset:4
    ds_bpermute_b32 v252, v62, v17 offset:8
    ds_bpermute_b32 v253, v62, v17 offset:12
    v_sub_f32 v168, v168, v16
    v_sub_f32 v169, v169, v16
    v_sub_f32 v170, v170, v16
    v_sub_f32 v171, v171, v16
    v_sub_f32 v172, v172, v16
    v_sub_f32 v173, v173, v16
    v_sub_f32 v174, v174, v16
    v_sub_f32 v175, v175, v16
    v_exp_f32 v168, v168
    v_exp_f32 v169, v169
    v_exp_f32 v170, v170
    v_exp_f32 v171, v171
    v_exp_f32 v172, v172
    v_exp_f32 v173, v173
    v_exp_f32 v174, v174
    v_exp_f32 v175, v175
    v_mul_f32 v5, v5, v17
    v_add_f32 v5, v5, v168
    v_add_f32 v5, v5, v169
    v_add_f32 v5, v5, v170
    v_add_f32 v5, v5, v171
    v_add_f32 v5, v5, v172
    v_add_f32 v5, v5, v173
    v_add_f32 v5, v5, v174
    v_add_f32 v5, v5, v175
    v_cvt_pk_bf16_f32 v228, v168, v169
    v_cvt_pk_bf16_f32 v229, v170, v171
    v_cvt_pk_bf16_f32 v230, v172, v173
    v_cvt_pk_bf16_f32 v231, v174, v175
    s_waitcnt lgkmcnt(0)
    v_accvgpr_read_b32 v18, a48
    v_mul_f32 v18, v18, v250
    v_accvgpr_write_b32 a48, v18
    v_accvgpr_read_b32 v19, a49
    v_mul_f32 v19, v19, v251
    v_accvgpr_write_b32 a49, v19
    v_accvgpr_read_b32 v18, a50
    v_mul_f32 v18, v18, v252
    v_accvgpr_write_b32 a50, v18
    v_accvgpr_read_b32 v19, a51
    v_mul_f32 v19, v19, v253
    v_accvgpr_write_b32 a51, v19
    v_accvgpr_read_b32 v18, a52
    v_mul_f32 v18, v18, v250
    v_accvgpr_write_b32 a52, v18
    v_accvgpr_read_b32 v19, a53
    v_mul_f32 v19, v19, v251
    v_accvgpr_write_b32 a53, v19
    v_accvgpr_read_b32 v18, a54
    v_mul_f32 v18, v18, v252
    v_accvgpr_write_b32 a54, v18
    v_accvgpr_read_b32 v19, a55
    v_mul_f32 v19, v19, v253
    v_accvgpr_write_b32 a55, v19
    v_accvgpr_read_b32 v18, a56
    v_mul_f32 v18, v18, v250
    v_accvgpr_write_b32 a56, v18
    v_accvgpr_read_b32 v19, a57
    v_mul_f32 v19, v19, v251
    v_accvgpr_write_b32 a57, v19
    v_accvgpr_read_b32 v18, a58
    v_mul_f32 v18, v18, v252
    v_accvgpr_write_b32 a58, v18
    v_accvgpr_read_b32 v19, a59
    v_mul_f32 v19, v19, v253
    v_accvgpr_write_b32 a59, v19
    v_accvgpr_read_b32 v18, a60
    v_mul_f32 v18, v18, v250
    v_accvgpr_write_b32 a60, v18
    v_accvgpr_read_b32 v19, a61
    v_mul_f32 v19, v19, v251
    v_accvgpr_write_b32 a61, v19
    v_accvgpr_read_b32 v18, a62
    v_mul_f32 v18, v18, v252
    v_accvgpr_write_b32 a62, v18
    v_accvgpr_read_b32 v19, a63
    v_mul_f32 v19, v19, v253
    v_accvgpr_write_b32 a63, v19
    v_accvgpr_read_b32 v18, a64
    v_mul_f32 v18, v18, v250
    v_accvgpr_write_b32 a64, v18
    v_accvgpr_read_b32 v19, a65
    v_mul_f32 v19, v19, v251
    v_accvgpr_write_b32 a65, v19
    v_accvgpr_read_b32 v18, a66
    v_mul_f32 v18, v18, v252
    v_accvgpr_write_b32 a66, v18
    v_accvgpr_read_b32 v19, a67
    v_mul_f32 v19, v19, v253
    v_accvgpr_write_b32 a67, v19
    v_accvgpr_read_b32 v18, a68
    v_mul_f32 v18, v18, v250
    v_accvgpr_write_b32 a68, v18
    v_accvgpr_read_b32 v19, a69
    v_mul_f32 v19, v19, v251
    v_accvgpr_write_b32 a69, v19
    v_accvgpr_read_b32 v18, a70
    v_mul_f32 v18, v18, v252
    v_accvgpr_write_b32 a70, v18
    v_accvgpr_read_b32 v19, a71
    v_mul_f32 v19, v19, v253
    v_accvgpr_write_b32 a71, v19
    v_accvgpr_read_b32 v18, a72
    v_mul_f32 v18, v18, v250
    v_accvgpr_write_b32 a72, v18
    v_accvgpr_read_b32 v19, a73
    v_mul_f32 v19, v19, v251
    v_accvgpr_write_b32 a73, v19
    v_accvgpr_read_b32 v18, a74
    v_mul_f32 v18, v18, v252
    v_accvgpr_write_b32 a74, v18
    v_accvgpr_read_b32 v19, a75
    v_mul_f32 v19, v19, v253
    v_accvgpr_write_b32 a75, v19
    v_accvgpr_read_b32 v18, a76
    v_mul_f32 v18, v18, v250
    v_accvgpr_write_b32 a76, v18
    v_accvgpr_read_b32 v19, a77
    v_mul_f32 v19, v19, v251
    v_accvgpr_write_b32 a77, v19
    v_accvgpr_read_b32 v18, a78
    v_mul_f32 v18, v18, v252
    v_accvgpr_write_b32 a78, v18
    v_accvgpr_read_b32 v19, a79
    v_mul_f32 v19, v19, v253
    v_accvgpr_write_b32 a79, v19
    v_accvgpr_read_b32 v18, a80
    v_mul_f32 v18, v18, v250
    v_accvgpr_write_b32 a80, v18
    v_accvgpr_read_b32 v19, a81
    v_mul_f32 v19, v19, v251
    v_accvgpr_write_b32 a81, v19
    v_accvgpr_read_b32 v18, a82
    v_mul_f32 v18, v18, v252
    v_accvgpr_write_b32 a82, v18
    v_accvgpr_read_b32 v19, a83
    v_mul_f32 v19, v19, v253
    v_accvgpr_write_b32 a83, v19
    v_accvgpr_read_b32 v18, a84
    v_mul_f32 v18, v18, v250
    v_accvgpr_write_b32 a84, v18
    v_accvgpr_read_b32 v19, a85
    v_mul_f32 v19, v19, v251
    v_accvgpr_write_b32 a85, v19
    v_accvgpr_read_b32 v18, a86
    v_mul_f32 v18, v18, v252
    v_accvgpr_write_b32 a86, v18
    v_accvgpr_read_b32 v19, a87
    v_mul_f32 v19, v19, v253
    v_accvgpr_write_b32 a87, v19
    v_accvgpr_read_b32 v18, a88
    v_mul_f32 v18, v18, v250
    v_accvgpr_write_b32 a88, v18
    v_accvgpr_read_b32 v19, a89
    v_mul_f32 v19, v19, v251
    v_accvgpr_write_b32 a89, v19
    v_accvgpr_read_b32 v18, a90
    v_mul_f32 v18, v18, v252
    v_accvgpr_write_b32 a90, v18
    v_accvgpr_read_b32 v19, a91
    v_mul_f32 v19, v19, v253
    v_accvgpr_write_b32 a91, v19
    v_accvgpr_read_b32 v18, a92
    v_mul_f32 v18, v18, v250
    v_accvgpr_write_b32 a92, v18
    v_accvgpr_read_b32 v19, a93
    v_mul_f32 v19, v19, v251
    v_accvgpr_write_b32 a93, v19
    v_accvgpr_read_b32 v18, a94
    v_mul_f32 v18, v18, v252
    v_accvgpr_write_b32 a94, v18
    v_accvgpr_read_b32 v19, a95
    v_mul_f32 v19, v19, v253
    v_accvgpr_write_b32 a95, v19
    v_max3_f32 v16, v176, v177, v178
    v_max3_f32 v16, v16, v179, v180
    v_max3_f32 v16, v16, v181, v182
    v_max3_f32 v16, v16, v183, v242
    v_mov_b32 v17, v16
    s_nop 1
    v_permlane16_swap_b32 v16, v17
    s_nop 1
    v_max_f32 v16, v16, v17
    v_mov_b32 v17, v16
    s_nop 1
    v_permlane32_swap_b32 v16, v17
    s_nop 1
    v_max_f32 v16, v16, v17
    v_sub_f32 v17, v242, v16
    v_exp_f32 v17, v17
    v_mov_b32 v242, v16
    ds_bpermute_b32 v250, v62, v17 offset:0
    ds_bpermute_b32 v251, v62, v17 offset:4
    ds_bpermute_b32 v252, v62, v17 offset:8
    ds_bpermute_b32 v253, v62, v17 offset:12
    v_sub_f32 v176, v176, v16
    v_sub_f32 v177, v177, v16
    v_sub_f32 v178, v178, v16
    v_sub_f32 v179, v179, v16
    v_sub_f32 v180, v180, v16
    v_sub_f32 v181, v181, v16
    v_sub_f32 v182, v182, v16
    v_sub_f32 v183, v183, v16
    v_exp_f32 v176, v176
    v_exp_f32 v177, v177
    v_exp_f32 v178, v178
    v_exp_f32 v179, v179
    v_exp_f32 v180, v180
    v_exp_f32 v181, v181
    v_exp_f32 v182, v182
    v_exp_f32 v183, v183
    v_mul_f32 v6, v6, v17
    v_add_f32 v6, v6, v176
    v_add_f32 v6, v6, v177
    v_add_f32 v6, v6, v178
    v_add_f32 v6, v6, v179
    v_add_f32 v6, v6, v180
    v_add_f32 v6, v6, v181
    v_add_f32 v6, v6, v182
    v_add_f32 v6, v6, v183
    v_cvt_pk_bf16_f32 v232, v176, v177
    v_cvt_pk_bf16_f32 v233, v178, v179
    v_cvt_pk_bf16_f32 v234, v180, v181
    v_cvt_pk_bf16_f32 v235, v182, v183
    s_waitcnt lgkmcnt(0)
    v_accvgpr_read_b32 v18, a96
    v_mul_f32 v18, v18, v250
    v_accvgpr_write_b32 a96, v18
    v_accvgpr_read_b32 v19, a97
    v_mul_f32 v19, v19, v251
    v_accvgpr_write_b32 a97, v19
    v_accvgpr_read_b32 v18, a98
    v_mul_f32 v18, v18, v252
    v_accvgpr_write_b32 a98, v18
    v_accvgpr_read_b32 v19, a99
    v_mul_f32 v19, v19, v253
    v_accvgpr_write_b32 a99, v19
    v_accvgpr_read_b32 v18, a100
    v_mul_f32 v18, v18, v250
    v_accvgpr_write_b32 a100, v18
    v_accvgpr_read_b32 v19, a101
    v_mul_f32 v19, v19, v251
    v_accvgpr_write_b32 a101, v19
    v_accvgpr_read_b32 v18, a102
    v_mul_f32 v18, v18, v252
    v_accvgpr_write_b32 a102, v18
    v_accvgpr_read_b32 v19, a103
    v_mul_f32 v19, v19, v253
    v_accvgpr_write_b32 a103, v19
    v_accvgpr_read_b32 v18, a104
    v_mul_f32 v18, v18, v250
    v_accvgpr_write_b32 a104, v18
    v_accvgpr_read_b32 v19, a105
    v_mul_f32 v19, v19, v251
    v_accvgpr_write_b32 a105, v19
    v_accvgpr_read_b32 v18, a106
    v_mul_f32 v18, v18, v252
    v_accvgpr_write_b32 a106, v18
    v_accvgpr_read_b32 v19, a107
    v_mul_f32 v19, v19, v253
    v_accvgpr_write_b32 a107, v19
    v_accvgpr_read_b32 v18, a108
    v_mul_f32 v18, v18, v250
    v_accvgpr_write_b32 a108, v18
    v_accvgpr_read_b32 v19, a109
    v_mul_f32 v19, v19, v251
    v_accvgpr_write_b32 a109, v19
    v_accvgpr_read_b32 v18, a110
    v_mul_f32 v18, v18, v252
    v_accvgpr_write_b32 a110, v18
    v_accvgpr_read_b32 v19, a111
    v_mul_f32 v19, v19, v253
    v_accvgpr_write_b32 a111, v19
    v_accvgpr_read_b32 v18, a112
    v_mul_f32 v18, v18, v250
    v_accvgpr_write_b32 a112, v18
    v_accvgpr_read_b32 v19, a113
    v_mul_f32 v19, v19, v251
    v_accvgpr_write_b32 a113, v19
    v_accvgpr_read_b32 v18, a114
    v_mul_f32 v18, v18, v252
    v_accvgpr_write_b32 a114, v18
    v_accvgpr_read_b32 v19, a115
    v_mul_f32 v19, v19, v253
    v_accvgpr_write_b32 a115, v19
    v_accvgpr_read_b32 v18, a116
    v_mul_f32 v18, v18, v250
    v_accvgpr_write_b32 a116, v18
    v_accvgpr_read_b32 v19, a117
    v_mul_f32 v19, v19, v251
    v_accvgpr_write_b32 a117, v19
    v_accvgpr_read_b32 v18, a118
    v_mul_f32 v18, v18, v252
    v_accvgpr_write_b32 a118, v18
    v_accvgpr_read_b32 v19, a119
    v_mul_f32 v19, v19, v253
    v_accvgpr_write_b32 a119, v19
    v_accvgpr_read_b32 v18, a120
    v_mul_f32 v18, v18, v250
    v_accvgpr_write_b32 a120, v18
    v_accvgpr_read_b32 v19, a121
    v_mul_f32 v19, v19, v251
    v_accvgpr_write_b32 a121, v19
    v_accvgpr_read_b32 v18, a122
    v_mul_f32 v18, v18, v252
    v_accvgpr_write_b32 a122, v18
    v_accvgpr_read_b32 v19, a123
    v_mul_f32 v19, v19, v253
    v_accvgpr_write_b32 a123, v19
    v_accvgpr_read_b32 v18, a124
    v_mul_f32 v18, v18, v250
    v_accvgpr_write_b32 a124, v18
    v_accvgpr_read_b32 v19, a125
    v_mul_f32 v19, v19, v251
    v_accvgpr_write_b32 a125, v19
    v_accvgpr_read_b32 v18, a126
    v_mul_f32 v18, v18, v252
    v_accvgpr_write_b32 a126, v18
    v_accvgpr_read_b32 v19, a127
    v_mul_f32 v19, v19, v253
    v_accvgpr_write_b32 a127, v19
    v_accvgpr_read_b32 v18, a128
    v_mul_f32 v18, v18, v250
    v_accvgpr_write_b32 a128, v18
    v_accvgpr_read_b32 v19, a129
    v_mul_f32 v19, v19, v251
    v_accvgpr_write_b32 a129, v19
    v_accvgpr_read_b32 v18, a130
    v_mul_f32 v18, v18, v252
    v_accvgpr_write_b32 a130, v18
    v_accvgpr_read_b32 v19, a131
    v_mul_f32 v19, v19, v253
    v_accvgpr_write_b32 a131, v19
    v_accvgpr_read_b32 v18, a132
    v_mul_f32 v18, v18, v250
    v_accvgpr_write_b32 a132, v18
    v_accvgpr_read_b32 v19, a133
    v_mul_f32 v19, v19, v251
    v_accvgpr_write_b32 a133, v19
    v_accvgpr_read_b32 v18, a134
    v_mul_f32 v18, v18, v252
    v_accvgpr_write_b32 a134, v18
    v_accvgpr_read_b32 v19, a135
    v_mul_f32 v19, v19, v253
    v_accvgpr_write_b32 a135, v19
    v_accvgpr_read_b32 v18, a136
    v_mul_f32 v18, v18, v250
    v_accvgpr_write_b32 a136, v18
    v_accvgpr_read_b32 v19, a137
    v_mul_f32 v19, v19, v251
    v_accvgpr_write_b32 a137, v19
    v_accvgpr_read_b32 v18, a138
    v_mul_f32 v18, v18, v252
    v_accvgpr_write_b32 a138, v18
    v_accvgpr_read_b32 v19, a139
    v_mul_f32 v19, v19, v253
    v_accvgpr_write_b32 a139, v19
    v_accvgpr_read_b32 v18, a140
    v_mul_f32 v18, v18, v250
    v_accvgpr_write_b32 a140, v18
    v_accvgpr_read_b32 v19, a141
    v_mul_f32 v19, v19, v251
    v_accvgpr_write_b32 a141, v19
    v_accvgpr_read_b32 v18, a142
    v_mul_f32 v18, v18, v252
    v_accvgpr_write_b32 a142, v18
    v_accvgpr_read_b32 v19, a143
    v_mul_f32 v19, v19, v253
    v_accvgpr_write_b32 a143, v19
    v_max3_f32 v16, v184, v185, v186
    v_max3_f32 v16, v16, v187, v188
    v_max3_f32 v16, v16, v189, v190
    v_max3_f32 v16, v16, v191, v243
    v_mov_b32 v17, v16
    s_nop 1
    v_permlane16_swap_b32 v16, v17
    s_nop 1
    v_max_f32 v16, v16, v17
    v_mov_b32 v17, v16
    s_nop 1
    v_permlane32_swap_b32 v16, v17
    s_nop 1
    v_max_f32 v16, v16, v17
    v_sub_f32 v17, v243, v16
    v_exp_f32 v17, v17
    v_mov_b32 v243, v16
    ds_bpermute_b32 v250, v62, v17 offset:0
    ds_bpermute_b32 v251, v62, v17 offset:4
    ds_bpermute_b32 v252, v62, v17 offset:8
    ds_bpermute_b32 v253, v62, v17 offset:12
    v_sub_f32 v184, v184, v16
    v_sub_f32 v185, v185, v16
    v_sub_f32 v186, v186, v16
    v_sub_f32 v187, v187, v16
    v_sub_f32 v188, v188, v16
    v_sub_f32 v189, v189, v16
    v_sub_f32 v190, v190, v16
    v_sub_f32 v191, v191, v16
    v_exp_f32 v184, v184
    v_exp_f32 v185, v185
    v_exp_f32 v186, v186
    v_exp_f32 v187, v187
    v_exp_f32 v188, v188
    v_exp_f32 v189, v189
    v_exp_f32 v190, v190
    v_exp_f32 v191, v191
    v_mul_f32 v7, v7, v17
    v_add_f32 v7, v7, v184
    v_add_f32 v7, v7, v185
    v_add_f32 v7, v7, v186
    v_add_f32 v7, v7, v187
    v_add_f32 v7, v7, v188
    v_add_f32 v7, v7, v189
    v_add_f32 v7, v7, v190
    v_add_f32 v7, v7, v191
    v_cvt_pk_bf16_f32 v236, v184, v185
    v_cvt_pk_bf16_f32 v237, v186, v187
    v_cvt_pk_bf16_f32 v238, v188, v189
    v_cvt_pk_bf16_f32 v239, v190, v191
    s_waitcnt lgkmcnt(0)
    v_accvgpr_read_b32 v18, a144
    v_mul_f32 v18, v18, v250
    v_accvgpr_write_b32 a144, v18
    v_accvgpr_read_b32 v19, a145
    v_mul_f32 v19, v19, v251
    v_accvgpr_write_b32 a145, v19
    v_accvgpr_read_b32 v18, a146
    v_mul_f32 v18, v18, v252
    v_accvgpr_write_b32 a146, v18
    v_accvgpr_read_b32 v19, a147
    v_mul_f32 v19, v19, v253
    v_accvgpr_write_b32 a147, v19
    v_accvgpr_read_b32 v18, a148
    v_mul_f32 v18, v18, v250
    v_accvgpr_write_b32 a148, v18
    v_accvgpr_read_b32 v19, a149
    v_mul_f32 v19, v19, v251
    v_accvgpr_write_b32 a149, v19
    v_accvgpr_read_b32 v18, a150
    v_mul_f32 v18, v18, v252
    v_accvgpr_write_b32 a150, v18
    v_accvgpr_read_b32 v19, a151
    v_mul_f32 v19, v19, v253
    v_accvgpr_write_b32 a151, v19
    v_accvgpr_read_b32 v18, a152
    v_mul_f32 v18, v18, v250
    v_accvgpr_write_b32 a152, v18
    v_accvgpr_read_b32 v19, a153
    v_mul_f32 v19, v19, v251
    v_accvgpr_write_b32 a153, v19
    v_accvgpr_read_b32 v18, a154
    v_mul_f32 v18, v18, v252
    v_accvgpr_write_b32 a154, v18
    v_accvgpr_read_b32 v19, a155
    v_mul_f32 v19, v19, v253
    v_accvgpr_write_b32 a155, v19
    v_accvgpr_read_b32 v18, a156
    v_mul_f32 v18, v18, v250
    v_accvgpr_write_b32 a156, v18
    v_accvgpr_read_b32 v19, a157
    v_mul_f32 v19, v19, v251
    v_accvgpr_write_b32 a157, v19
    v_accvgpr_read_b32 v18, a158
    v_mul_f32 v18, v18, v252
    v_accvgpr_write_b32 a158, v18
    v_accvgpr_read_b32 v19, a159
    v_mul_f32 v19, v19, v253
    v_accvgpr_write_b32 a159, v19
    v_accvgpr_read_b32 v18, a160
    v_mul_f32 v18, v18, v250
    v_accvgpr_write_b32 a160, v18
    v_accvgpr_read_b32 v19, a161
    v_mul_f32 v19, v19, v251
    v_accvgpr_write_b32 a161, v19
    v_accvgpr_read_b32 v18, a162
    v_mul_f32 v18, v18, v252
    v_accvgpr_write_b32 a162, v18
    v_accvgpr_read_b32 v19, a163
    v_mul_f32 v19, v19, v253
    v_accvgpr_write_b32 a163, v19
    v_accvgpr_read_b32 v18, a164
    v_mul_f32 v18, v18, v250
    v_accvgpr_write_b32 a164, v18
    v_accvgpr_read_b32 v19, a165
    v_mul_f32 v19, v19, v251
    v_accvgpr_write_b32 a165, v19
    v_accvgpr_read_b32 v18, a166
    v_mul_f32 v18, v18, v252
    v_accvgpr_write_b32 a166, v18
    v_accvgpr_read_b32 v19, a167
    v_mul_f32 v19, v19, v253
    v_accvgpr_write_b32 a167, v19
    v_accvgpr_read_b32 v18, a168
    v_mul_f32 v18, v18, v250
    v_accvgpr_write_b32 a168, v18
    v_accvgpr_read_b32 v19, a169
    v_mul_f32 v19, v19, v251
    v_accvgpr_write_b32 a169, v19
    v_accvgpr_read_b32 v18, a170
    v_mul_f32 v18, v18, v252
    v_accvgpr_write_b32 a170, v18
    v_accvgpr_read_b32 v19, a171
    v_mul_f32 v19, v19, v253
    v_accvgpr_write_b32 a171, v19
    v_accvgpr_read_b32 v18, a172
    v_mul_f32 v18, v18, v250
    v_accvgpr_write_b32 a172, v18
    v_accvgpr_read_b32 v19, a173
    v_mul_f32 v19, v19, v251
    v_accvgpr_write_b32 a173, v19
    v_accvgpr_read_b32 v18, a174
    v_mul_f32 v18, v18, v252
    v_accvgpr_write_b32 a174, v18
    v_accvgpr_read_b32 v19, a175
    v_mul_f32 v19, v19, v253
    v_accvgpr_write_b32 a175, v19
    v_accvgpr_read_b32 v18, a176
    v_mul_f32 v18, v18, v250
    v_accvgpr_write_b32 a176, v18
    v_accvgpr_read_b32 v19, a177
    v_mul_f32 v19, v19, v251
    v_accvgpr_write_b32 a177, v19
    v_accvgpr_read_b32 v18, a178
    v_mul_f32 v18, v18, v252
    v_accvgpr_write_b32 a178, v18
    v_accvgpr_read_b32 v19, a179
    v_mul_f32 v19, v19, v253
    v_accvgpr_write_b32 a179, v19
    v_accvgpr_read_b32 v18, a180
    v_mul_f32 v18, v18, v250
    v_accvgpr_write_b32 a180, v18
    v_accvgpr_read_b32 v19, a181
    v_mul_f32 v19, v19, v251
    v_accvgpr_write_b32 a181, v19
    v_accvgpr_read_b32 v18, a182
    v_mul_f32 v18, v18, v252
    v_accvgpr_write_b32 a182, v18
    v_accvgpr_read_b32 v19, a183
    v_mul_f32 v19, v19, v253
    v_accvgpr_write_b32 a183, v19
    v_accvgpr_read_b32 v18, a184
    v_mul_f32 v18, v18, v250
    v_accvgpr_write_b32 a184, v18
    v_accvgpr_read_b32 v19, a185
    v_mul_f32 v19, v19, v251
    v_accvgpr_write_b32 a185, v19
    v_accvgpr_read_b32 v18, a186
    v_mul_f32 v18, v18, v252
    v_accvgpr_write_b32 a186, v18
    v_accvgpr_read_b32 v19, a187
    v_mul_f32 v19, v19, v253
    v_accvgpr_write_b32 a187, v19
    v_accvgpr_read_b32 v18, a188
    v_mul_f32 v18, v18, v250
    v_accvgpr_write_b32 a188, v18
    v_accvgpr_read_b32 v19, a189
    v_mul_f32 v19, v19, v251
    v_accvgpr_write_b32 a189, v19
    v_accvgpr_read_b32 v18, a190
    v_mul_f32 v18, v18, v252
    v_accvgpr_write_b32 a190, v18
    v_accvgpr_read_b32 v19, a191
    v_mul_f32 v19, v19, v253
    v_accvgpr_write_b32 a191, v19
    s_waitcnt vmcnt(0)
    s_nop 1
    v_mfma_f32_16x16x32_bf16 a[0:3], v[224:227], v[112:115], a[0:3]
    v_mfma_f32_16x16x32_bf16 a[48:51], v[228:231], v[112:115], a[48:51]
    v_mfma_f32_16x16x32_bf16 a[96:99], v[232:235], v[112:115], a[96:99]
    v_mfma_f32_16x16x32_bf16 a[144:147], v[236:239], v[112:115], a[144:147]
    v_mfma_f32_16x16x32_bf16 a[4:7], v[224:227], v[116:119], a[4:7]
    v_mfma_f32_16x16x32_bf16 a[52:55], v[228:231], v[116:119], a[52:55]
    v_mfma_f32_16x16x32_bf16 a[100:103], v[232:235], v[116:119], a[100:103]
    v_mfma_f32_16x16x32_bf16 a[148:151], v[236:239], v[116:119], a[148:151]
    v_mfma_f32_16x16x32_bf16 a[8:11], v[224:227], v[120:123], a[8:11]
    v_mfma_f32_16x16x32_bf16 a[56:59], v[228:231], v[120:123], a[56:59]
    v_mfma_f32_16x16x32_bf16 a[104:107], v[232:235], v[120:123], a[104:107]
    v_mfma_f32_16x16x32_bf16 a[152:155], v[236:239], v[120:123], a[152:155]
    v_mfma_f32_16x16x32_bf16 a[12:15], v[224:227], v[124:127], a[12:15]
    v_mfma_f32_16x16x32_bf16 a[60:63], v[228:231], v[124:127], a[60:63]
    v_mfma_f32_16x16x32_bf16 a[108:111], v[232:235], v[124:127], a[108:111]
    v_mfma_f32_16x16x32_bf16 a[156:159], v[236:239], v[124:127], a[156:159]
    v_mfma_f32_16x16x32_bf16 a[16:19], v[224:227], v[128:131], a[16:19]
    v_mfma_f32_16x16x32_bf16 a[64:67], v[228:231], v[128:131], a[64:67]
    v_mfma_f32_16x16x32_bf16 a[112:115], v[232:235], v[128:131], a[112:115]
    v_mfma_f32_16x16x32_bf16 a[160:163], v[236:239], v[128:131], a[160:163]
    v_mfma_f32_16x16x32_bf16 a[20:23], v[224:227], v[132:135], a[20:23]
    v_mfma_f32_16x16x32_bf16 a[68:71], v[228:231], v[132:135], a[68:71]
    v_mfma_f32_16x16x32_bf16 a[116:119], v[232:235], v[132:135], a[116:119]
    v_mfma_f32_16x16x32_bf16 a[164:167], v[236:239], v[132:135], a[164:167]
    v_mfma_f32_16x16x32_bf16 a[24:27], v[224:227], v[136:139], a[24:27]
    v_mfma_f32_16x16x32_bf16 a[72:75], v[228:231], v[136:139], a[72:75]
    v_mfma_f32_16x16x32_bf16 a[120:123], v[232:235], v[136:139], a[120:123]
    v_mfma_f32_16x16x32_bf16 a[168:171], v[236:239], v[136:139], a[168:171]
    v_mfma_f32_16x16x32_bf16 a[28:31], v[224:227], v[140:143], a[28:31]
    v_mfma_f32_16x16x32_bf16 a[76:79], v[228:231], v[140:143], a[76:79]
    v_mfma_f32_16x16x32_bf16 a[124:127], v[232:235], v[140:143], a[124:127]
    v_mfma_f32_16x16x32_bf16 a[172:175], v[236:239], v[140:143], a[172:175]
    v_mfma_f32_16x16x32_bf16 a[32:35], v[224:227], v[144:147], a[32:35]
    v_mfma_f32_16x16x32_bf16 a[80:83], v[228:231], v[144:147], a[80:83]
    v_mfma_f32_16x16x32_bf16 a[128:131], v[232:235], v[144:147], a[128:131]
    v_mfma_f32_16x16x32_bf16 a[176:179], v[236:239], v[144:147], a[176:179]
    v_mfma_f32_16x16x32_bf16 a[36:39], v[224:227], v[148:151], a[36:39]
    v_mfma_f32_16x16x32_bf16 a[84:87], v[228:231], v[148:151], a[84:87]
    v_mfma_f32_16x16x32_bf16 a[132:135], v[232:235], v[148:151], a[132:135]
    v_mfma_f32_16x16x32_bf16 a[180:183], v[236:239], v[148:151], a[180:183]
    v_mfma_f32_16x16x32_bf16 a[40:43], v[224:227], v[152:155], a[40:43]
    v_mfma_f32_16x16x32_bf16 a[88:91], v[228:231], v[152:155], a[88:91]
    v_mfma_f32_16x16x32_bf16 a[136:139], v[232:235], v[152:155], a[136:139]
    v_mfma_f32_16x16x32_bf16 a[184:187], v[236:239], v[152:155], a[184:187]
    v_mfma_f32_16x16x32_bf16 a[44:47], v[224:227], v[156:159], a[44:47]
    v_mfma_f32_16x16x32_bf16 a[92:95], v[228:231], v[156:159], a[92:95]
    v_mfma_f32_16x16x32_bf16 a[140:143], v[232:235], v[156:159], a[140:143]
    v_mfma_f32_16x16x32_bf16 a[188:191], v[236:239], v[156:159], a[188:191]
    s_add_u32 s48, s48, 24576
    s_cmp_lt_u32 s48, 1572864
    s_nop 7
    s_cbranch_scc1 L_slowloop
    s_nop 1
    v_mfma_f32_16x16x4_f32 v[48:51], v4, v63, 0
    v_mfma_f32_16x16x4_f32 v[52:55], v5, v63, 0
    v_mfma_f32_16x16x4_f32 v[56:59], v6, v63, 0
    v_mfma_f32_16x16x4_f32 v[128:131], v7, v63, 0
    s_nop 10
    v_rcp_f32 v48, v48
    v_rcp_f32 v49, v49
    v_rcp_f32 v50, v50
    v_rcp_f32 v51, v51
    v_rcp_f32 v52, v52
    v_rcp_f32 v53, v53
    v_rcp_f32 v54, v54
    v_rcp_f32 v55, v55
    v_rcp_f32 v56, v56
    v_rcp_f32 v57, v57
    v_rcp_f32 v58, v58
    v_rcp_f32 v59, v59
    v_rcp_f32 v128, v128
    v_rcp_f32 v129, v129
    v_rcp_f32 v130, v130
    v_rcp_f32 v131, v131
    s_nop 0
    v_accvgpr_read_b32 v64, a0
    v_accvgpr_read_b32 v65, a4
    v_accvgpr_read_b32 v66, a8
    v_accvgpr_read_b32 v67, a12
    v_accvgpr_read_b32 v68, a16
    v_accvgpr_read_b32 v69, a20
    v_accvgpr_read_b32 v70, a24
    v_accvgpr_read_b32 v71, a28
    v_accvgpr_read_b32 v72, a32
    v_accvgpr_read_b32 v73, a36
    v_accvgpr_read_b32 v74, a40
    v_accvgpr_read_b32 v75, a44
    v_pk_mul_f32 v[64:65], v[64:65], v[48:49] op_sel:[0,0] op_sel_hi:[1,0]
    v_pk_mul_f32 v[66:67], v[66:67], v[48:49] op_sel:[0,0] op_sel_hi:[1,0]
    v_pk_mul_f32 v[68:69], v[68:69], v[48:49] op_sel:[0,0] op_sel_hi:[1,0]
    v_pk_mul_f32 v[70:71], v[70:71], v[48:49] op_sel:[0,0] op_sel_hi:[1,0]
    v_pk_mul_f32 v[72:73], v[72:73], v[48:49] op_sel:[0,0] op_sel_hi:[1,0]
    v_pk_mul_f32 v[74:75], v[74:75], v[48:49] op_sel:[0,0] op_sel_hi:[1,0]
    v_cvt_pk_bf16_f32 v64, v64, v65
    v_cvt_pk_bf16_f32 v65, v66, v67
    v_cvt_pk_bf16_f32 v66, v68, v69
    v_cvt_pk_bf16_f32 v67, v70, v71
    v_cvt_pk_bf16_f32 v68, v72, v73
    v_cvt_pk_bf16_f32 v69, v74, v75
    buffer_store_dwordx4 v[64:67], v60, s[12:15], s33 offen offset:0 sc0 sc1
    buffer_store_dwordx2 v[68:69], v61, s[12:15], s33 offen offset:256 sc0 sc1
    v_accvgpr_read_b32 v76, a1
    v_accvgpr_read_b32 v77, a5
    v_accvgpr_read_b32 v78, a9
    v_accvgpr_read_b32 v79, a13
    v_accvgpr_read_b32 v80, a17
    v_accvgpr_read_b32 v81, a21
    v_accvgpr_read_b32 v82, a25
    v_accvgpr_read_b32 v83, a29
    v_accvgpr_read_b32 v84, a33
    v_accvgpr_read_b32 v85, a37
    v_accvgpr_read_b32 v86, a41
    v_accvgpr_read_b32 v87, a45
    v_pk_mul_f32 v[76:77], v[76:77], v[48:49] op_sel:[0,1] op_sel_hi:[1,1]
    v_pk_mul_f32 v[78:79], v[78:79], v[48:49] op_sel:[0,1] op_sel_hi:[1,1]
    v_pk_mul_f32 v[80:81], v[80:81], v[48:49] op_sel:[0,1] op_sel_hi:[1,1]
    v_pk_mul_f32 v[82:83], v[82:83], v[48:49] op_sel:[0,1] op_sel_hi:[1,1]
    v_pk_mul_f32 v[84:85], v[84:85], v[48:49] op_sel:[0,1] op_sel_hi:[1,1]
    v_pk_mul_f32 v[86:87], v[86:87], v[48:49] op_sel:[0,1] op_sel_hi:[1,1]
    v_cvt_pk_bf16_f32 v76, v76, v77
    v_cvt_pk_bf16_f32 v77, v78, v79
    v_cvt_pk_bf16_f32 v78, v80, v81
    v_cvt_pk_bf16_f32 v79, v82, v83
    v_cvt_pk_bf16_f32 v80, v84, v85
    v_cvt_pk_bf16_f32 v81, v86, v87
    buffer_store_dwordx4 v[76:79], v60, s[12:15], s33 offen offset:384 sc0 sc1
    buffer_store_dwordx2 v[80:81], v61, s[12:15], s33 offen offset:640 sc0 sc1
    v_accvgpr_read_b32 v88, a2
    v_accvgpr_read_b32 v89, a6
    v_accvgpr_read_b32 v90, a10
    v_accvgpr_read_b32 v91, a14
    v_accvgpr_read_b32 v92, a18
    v_accvgpr_read_b32 v93, a22
    v_accvgpr_read_b32 v94, a26
    v_accvgpr_read_b32 v95, a30
    v_accvgpr_read_b32 v96, a34
    v_accvgpr_read_b32 v97, a38
    v_accvgpr_read_b32 v98, a42
    v_accvgpr_read_b32 v99, a46
    v_pk_mul_f32 v[88:89], v[88:89], v[50:51] op_sel:[0,0] op_sel_hi:[1,0]
    v_pk_mul_f32 v[90:91], v[90:91], v[50:51] op_sel:[0,0] op_sel_hi:[1,0]
    v_pk_mul_f32 v[92:93], v[92:93], v[50:51] op_sel:[0,0] op_sel_hi:[1,0]
    v_pk_mul_f32 v[94:95], v[94:95], v[50:51] op_sel:[0,0] op_sel_hi:[1,0]
    v_pk_mul_f32 v[96:97], v[96:97], v[50:51] op_sel:[0,0] op_sel_hi:[1,0]
    v_pk_mul_f32 v[98:99], v[98:99], v[50:51] op_sel:[0,0] op_sel_hi:[1,0]
    v_cvt_pk_bf16_f32 v88, v88, v89
    v_cvt_pk_bf16_f32 v89, v90, v91
    v_cvt_pk_bf16_f32 v90, v92, v93
    v_cvt_pk_bf16_f32 v91, v94, v95
    v_cvt_pk_bf16_f32 v92, v96, v97
    v_cvt_pk_bf16_f32 v93, v98, v99
    buffer_store_dwordx4 v[88:91], v60, s[12:15], s33 offen offset:768 sc0 sc1
    buffer_store_dwordx2 v[92:93], v61, s[12:15], s33 offen offset:1024 sc0 sc1
    v_accvgpr_read_b32 v100, a3
    v_accvgpr_read_b32 v101, a7
    v_accvgpr_read_b32 v102, a11
    v_accvgpr_read_b32 v103, a15
    v_accvgpr_read_b32 v104, a19
    v_accvgpr_read_b32 v105, a23
    v_accvgpr_read_b32 v106, a27
    v_accvgpr_read_b32 v107, a31
    v_accvgpr_read_b32 v108, a35
    v_accvgpr_read_b32 v109, a39
    v_accvgpr_read_b32 v110, a43
    v_accvgpr_read_b32 v111, a47
    v_pk_mul_f32 v[100:101], v[100:101], v[50:51] op_sel:[0,1] op_sel_hi:[1,1]
    v_pk_mul_f32 v[102:103], v[102:103], v[50:51] op_sel:[0,1] op_sel_hi:[1,1]
    v_pk_mul_f32 v[104:105], v[104:105], v[50:51] op_sel:[0,1] op_sel_hi:[1,1]
    v_pk_mul_f32 v[106:107], v[106:107], v[50:51] op_sel:[0,1] op_sel_hi:[1,1]
    v_pk_mul_f32 v[108:109], v[108:109], v[50:51] op_sel:[0,1] op_sel_hi:[1,1]
    v_pk_mul_f32 v[110:111], v[110:111], v[50:51] op_sel:[0,1] op_sel_hi:[1,1]
    v_cvt_pk_bf16_f32 v100, v100, v101
    v_cvt_pk_bf16_f32 v101, v102, v103
    v_cvt_pk_bf16_f32 v102, v104, v105
    v_cvt_pk_bf16_f32 v103, v106, v107
    v_cvt_pk_bf16_f32 v104, v108, v109
    v_cvt_pk_bf16_f32 v105, v110, v111
    buffer_store_dwordx4 v[100:103], v60, s[12:15], s33 offen offset:1152 sc0 sc1
    buffer_store_dwordx2 v[104:105], v61, s[12:15], s33 offen offset:1408 sc0 sc1
    v_accvgpr_read_b32 v112, a48
    v_accvgpr_read_b32 v113, a52
    v_accvgpr_read_b32 v114, a56
    v_accvgpr_read_b32 v115, a60
    v_accvgpr_read_b32 v116, a64
    v_accvgpr_read_b32 v117, a68
    v_accvgpr_read_b32 v118, a72
    v_accvgpr_read_b32 v119, a76
    v_accvgpr_read_b32 v120, a80
    v_accvgpr_read_b32 v121, a84
    v_accvgpr_read_b32 v122, a88
    v_accvgpr_read_b32 v123, a92
    v_pk_mul_f32 v[112:113], v[112:113], v[52:53] op_sel:[0,0] op_sel_hi:[1,0]
    v_pk_mul_f32 v[114:115], v[114:115], v[52:53] op_sel:[0,0] op_sel_hi:[1,0]
    v_pk_mul_f32 v[116:117], v[116:117], v[52:53] op_sel:[0,0] op_sel_hi:[1,0]
    v_pk_mul_f32 v[118:119], v[118:119], v[52:53] op_sel:[0,0] op_sel_hi:[1,0]
    v_pk_mul_f32 v[120:121], v[120:121], v[52:53] op_sel:[0,0] op_sel_hi:[1,0]
    v_pk_mul_f32 v[122:123], v[122:123], v[52:53] op_sel:[0,0] op_sel_hi:[1,0]
    v_cvt_pk_bf16_f32 v112, v112, v113
    v_cvt_pk_bf16_f32 v113, v114, v115
    v_cvt_pk_bf16_f32 v114, v116, v117
    v_cvt_pk_bf16_f32 v115, v118, v119
    v_cvt_pk_bf16_f32 v116, v120, v121
    v_cvt_pk_bf16_f32 v117, v122, v123
    buffer_store_dwordx4 v[112:115], v60, s[12:15], s34 offen offset:0 sc0 sc1
    buffer_store_dwordx2 v[116:117], v61, s[12:15], s34 offen offset:256 sc0 sc1
    v_accvgpr_read_b32 v64, a49
    v_accvgpr_read_b32 v65, a53
    v_accvgpr_read_b32 v66, a57
    v_accvgpr_read_b32 v67, a61
    v_accvgpr_read_b32 v68, a65
    v_accvgpr_read_b32 v69, a69
    v_accvgpr_read_b32 v70, a73
    v_accvgpr_read_b32 v71, a77
    v_accvgpr_read_b32 v72, a81
    v_accvgpr_read_b32 v73, a85
    v_accvgpr_read_b32 v74, a89
    v_accvgpr_read_b32 v75, a93
    v_pk_mul_f32 v[64:65], v[64:65], v[52:53] op_sel:[0,1] op_sel_hi:[1,1]
    v_pk_mul_f32 v[66:67], v[66:67], v[52:53] op_sel:[0,1] op_sel_hi:[1,1]
    v_pk_mul_f32 v[68:69], v[68:69], v[52:53] op_sel:[0,1] op_sel_hi:[1,1]
    v_pk_mul_f32 v[70:71], v[70:71], v[52:53] op_sel:[0,1] op_sel_hi:[1,1]
    v_pk_mul_f32 v[72:73], v[72:73], v[52:53] op_sel:[0,1] op_sel_hi:[1,1]
    v_pk_mul_f32 v[74:75], v[74:75], v[52:53] op_sel:[0,1] op_sel_hi:[1,1]
    v_cvt_pk_bf16_f32 v64, v64, v65
    v_cvt_pk_bf16_f32 v65, v66, v67
    v_cvt_pk_bf16_f32 v66, v68, v69
    v_cvt_pk_bf16_f32 v67, v70, v71
    v_cvt_pk_bf16_f32 v68, v72, v73
    v_cvt_pk_bf16_f32 v69, v74, v75
    buffer_store_dwordx4 v[64:67], v60, s[12:15], s34 offen offset:384 sc0 sc1
    buffer_store_dwordx2 v[68:69], v61, s[12:15], s34 offen offset:640 sc0 sc1
    v_accvgpr_read_b32 v76, a50
    v_accvgpr_read_b32 v77, a54
    v_accvgpr_read_b32 v78, a58
    v_accvgpr_read_b32 v79, a62
    v_accvgpr_read_b32 v80, a66
    v_accvgpr_read_b32 v81, a70
    v_accvgpr_read_b32 v82, a74
    v_accvgpr_read_b32 v83, a78
    v_accvgpr_read_b32 v84, a82
    v_accvgpr_read_b32 v85, a86
    v_accvgpr_read_b32 v86, a90
    v_accvgpr_read_b32 v87, a94
    v_pk_mul_f32 v[76:77], v[76:77], v[54:55] op_sel:[0,0] op_sel_hi:[1,0]
    v_pk_mul_f32 v[78:79], v[78:79], v[54:55] op_sel:[0,0] op_sel_hi:[1,0]
    v_pk_mul_f32 v[80:81], v[80:81], v[54:55] op_sel:[0,0] op_sel_hi:[1,0]
    v_pk_mul_f32 v[82:83], v[82:83], v[54:55] op_sel:[0,0] op_sel_hi:[1,0]
    v_pk_mul_f32 v[84:85], v[84:85], v[54:55] op_sel:[0,0] op_sel_hi:[1,0]
    v_pk_mul_f32 v[86:87], v[86:87], v[54:55] op_sel:[0,0] op_sel_hi:[1,0]
    v_cvt_pk_bf16_f32 v76, v76, v77
    v_cvt_pk_bf16_f32 v77, v78, v79
    v_cvt_pk_bf16_f32 v78, v80, v81
    v_cvt_pk_bf16_f32 v79, v82, v83
    v_cvt_pk_bf16_f32 v80, v84, v85
    v_cvt_pk_bf16_f32 v81, v86, v87
    buffer_store_dwordx4 v[76:79], v60, s[12:15], s34 offen offset:768 sc0 sc1
    buffer_store_dwordx2 v[80:81], v61, s[12:15], s34 offen offset:1024 sc0 sc1
    v_accvgpr_read_b32 v88, a51
    v_accvgpr_read_b32 v89, a55
    v_accvgpr_read_b32 v90, a59
    v_accvgpr_read_b32 v91, a63
    v_accvgpr_read_b32 v92, a67
    v_accvgpr_read_b32 v93, a71
    v_accvgpr_read_b32 v94, a75
    v_accvgpr_read_b32 v95, a79
    v_accvgpr_read_b32 v96, a83
    v_accvgpr_read_b32 v97, a87
    v_accvgpr_read_b32 v98, a91
    v_accvgpr_read_b32 v99, a95
    v_pk_mul_f32 v[88:89], v[88:89], v[54:55] op_sel:[0,1] op_sel_hi:[1,1]
    v_pk_mul_f32 v[90:91], v[90:91], v[54:55] op_sel:[0,1] op_sel_hi:[1,1]
    v_pk_mul_f32 v[92:93], v[92:93], v[54:55] op_sel:[0,1] op_sel_hi:[1,1]
    v_pk_mul_f32 v[94:95], v[94:95], v[54:55] op_sel:[0,1] op_sel_hi:[1,1]
    v_pk_mul_f32 v[96:97], v[96:97], v[54:55] op_sel:[0,1] op_sel_hi:[1,1]
    v_pk_mul_f32 v[98:99], v[98:99], v[54:55] op_sel:[0,1] op_sel_hi:[1,1]
    v_cvt_pk_bf16_f32 v88, v88, v89
    v_cvt_pk_bf16_f32 v89, v90, v91
    v_cvt_pk_bf16_f32 v90, v92, v93
    v_cvt_pk_bf16_f32 v91, v94, v95
    v_cvt_pk_bf16_f32 v92, v96, v97
    v_cvt_pk_bf16_f32 v93, v98, v99
    buffer_store_dwordx4 v[88:91], v60, s[12:15], s34 offen offset:1152 sc0 sc1
    buffer_store_dwordx2 v[92:93], v61, s[12:15], s34 offen offset:1408 sc0 sc1
    v_accvgpr_read_b32 v100, a96
    v_accvgpr_read_b32 v101, a100
    v_accvgpr_read_b32 v102, a104
    v_accvgpr_read_b32 v103, a108
    v_accvgpr_read_b32 v104, a112
    v_accvgpr_read_b32 v105, a116
    v_accvgpr_read_b32 v106, a120
    v_accvgpr_read_b32 v107, a124
    v_accvgpr_read_b32 v108, a128
    v_accvgpr_read_b32 v109, a132
    v_accvgpr_read_b32 v110, a136
    v_accvgpr_read_b32 v111, a140
    v_pk_mul_f32 v[100:101], v[100:101], v[56:57] op_sel:[0,0] op_sel_hi:[1,0]
    v_pk_mul_f32 v[102:103], v[102:103], v[56:57] op_sel:[0,0] op_sel_hi:[1,0]
    v_pk_mul_f32 v[104:105], v[104:105], v[56:57] op_sel:[0,0] op_sel_hi:[1,0]
    v_pk_mul_f32 v[106:107], v[106:107], v[56:57] op_sel:[0,0] op_sel_hi:[1,0]
    v_pk_mul_f32 v[108:109], v[108:109], v[56:57] op_sel:[0,0] op_sel_hi:[1,0]
    v_pk_mul_f32 v[110:111], v[110:111], v[56:57] op_sel:[0,0] op_sel_hi:[1,0]
    v_cvt_pk_bf16_f32 v100, v100, v101
    v_cvt_pk_bf16_f32 v101, v102, v103
    v_cvt_pk_bf16_f32 v102, v104, v105
    v_cvt_pk_bf16_f32 v103, v106, v107
    v_cvt_pk_bf16_f32 v104, v108, v109
    v_cvt_pk_bf16_f32 v105, v110, v111
    buffer_store_dwordx4 v[100:103], v60, s[12:15], s35 offen offset:0 sc0 sc1
    buffer_store_dwordx2 v[104:105], v61, s[12:15], s35 offen offset:256 sc0 sc1
    v_accvgpr_read_b32 v112, a97
    v_accvgpr_read_b32 v113, a101
    v_accvgpr_read_b32 v114, a105
    v_accvgpr_read_b32 v115, a109
    v_accvgpr_read_b32 v116, a113
    v_accvgpr_read_b32 v117, a117
    v_accvgpr_read_b32 v118, a121
    v_accvgpr_read_b32 v119, a125
    v_accvgpr_read_b32 v120, a129
    v_accvgpr_read_b32 v121, a133
    v_accvgpr_read_b32 v122, a137
    v_accvgpr_read_b32 v123, a141
    v_pk_mul_f32 v[112:113], v[112:113], v[56:57] op_sel:[0,1] op_sel_hi:[1,1]
    v_pk_mul_f32 v[114:115], v[114:115], v[56:57] op_sel:[0,1] op_sel_hi:[1,1]
    v_pk_mul_f32 v[116:117], v[116:117], v[56:57] op_sel:[0,1] op_sel_hi:[1,1]
    v_pk_mul_f32 v[118:119], v[118:119], v[56:57] op_sel:[0,1] op_sel_hi:[1,1]
    v_pk_mul_f32 v[120:121], v[120:121], v[56:57] op_sel:[0,1] op_sel_hi:[1,1]
    v_pk_mul_f32 v[122:123], v[122:123], v[56:57] op_sel:[0,1] op_sel_hi:[1,1]
    v_cvt_pk_bf16_f32 v112, v112, v113
    v_cvt_pk_bf16_f32 v113, v114, v115
    v_cvt_pk_bf16_f32 v114, v116, v117
    v_cvt_pk_bf16_f32 v115, v118, v119
    v_cvt_pk_bf16_f32 v116, v120, v121
    v_cvt_pk_bf16_f32 v117, v122, v123
    buffer_store_dwordx4 v[112:115], v60, s[12:15], s35 offen offset:384 sc0 sc1
    buffer_store_dwordx2 v[116:117], v61, s[12:15], s35 offen offset:640 sc0 sc1
    v_accvgpr_read_b32 v64, a98
    v_accvgpr_read_b32 v65, a102
    v_accvgpr_read_b32 v66, a106
    v_accvgpr_read_b32 v67, a110
    v_accvgpr_read_b32 v68, a114
    v_accvgpr_read_b32 v69, a118
    v_accvgpr_read_b32 v70, a122
    v_accvgpr_read_b32 v71, a126
    v_accvgpr_read_b32 v72, a130
    v_accvgpr_read_b32 v73, a134
    v_accvgpr_read_b32 v74, a138
    v_accvgpr_read_b32 v75, a142
    v_pk_mul_f32 v[64:65], v[64:65], v[58:59] op_sel:[0,0] op_sel_hi:[1,0]
    v_pk_mul_f32 v[66:67], v[66:67], v[58:59] op_sel:[0,0] op_sel_hi:[1,0]
    v_pk_mul_f32 v[68:69], v[68:69], v[58:59] op_sel:[0,0] op_sel_hi:[1,0]
    v_pk_mul_f32 v[70:71], v[70:71], v[58:59] op_sel:[0,0] op_sel_hi:[1,0]
    v_pk_mul_f32 v[72:73], v[72:73], v[58:59] op_sel:[0,0] op_sel_hi:[1,0]
    v_pk_mul_f32 v[74:75], v[74:75], v[58:59] op_sel:[0,0] op_sel_hi:[1,0]
    v_cvt_pk_bf16_f32 v64, v64, v65
    v_cvt_pk_bf16_f32 v65, v66, v67
    v_cvt_pk_bf16_f32 v66, v68, v69
    v_cvt_pk_bf16_f32 v67, v70, v71
    v_cvt_pk_bf16_f32 v68, v72, v73
    v_cvt_pk_bf16_f32 v69, v74, v75
    buffer_store_dwordx4 v[64:67], v60, s[12:15], s35 offen offset:768 sc0 sc1
    buffer_store_dwordx2 v[68:69], v61, s[12:15], s35 offen offset:1024 sc0 sc1
    v_accvgpr_read_b32 v76, a99
    v_accvgpr_read_b32 v77, a103
    v_accvgpr_read_b32 v78, a107
    v_accvgpr_read_b32 v79, a111
    v_accvgpr_read_b32 v80, a115
    v_accvgpr_read_b32 v81, a119
    v_accvgpr_read_b32 v82, a123
    v_accvgpr_read_b32 v83, a127
    v_accvgpr_read_b32 v84, a131
    v_accvgpr_read_b32 v85, a135
    v_accvgpr_read_b32 v86, a139
    v_accvgpr_read_b32 v87, a143
    v_pk_mul_f32 v[76:77], v[76:77], v[58:59] op_sel:[0,1] op_sel_hi:[1,1]
    v_pk_mul_f32 v[78:79], v[78:79], v[58:59] op_sel:[0,1] op_sel_hi:[1,1]
    v_pk_mul_f32 v[80:81], v[80:81], v[58:59] op_sel:[0,1] op_sel_hi:[1,1]
    v_pk_mul_f32 v[82:83], v[82:83], v[58:59] op_sel:[0,1] op_sel_hi:[1,1]
    v_pk_mul_f32 v[84:85], v[84:85], v[58:59] op_sel:[0,1] op_sel_hi:[1,1]
    v_pk_mul_f32 v[86:87], v[86:87], v[58:59] op_sel:[0,1] op_sel_hi:[1,1]
    v_cvt_pk_bf16_f32 v76, v76, v77
    v_cvt_pk_bf16_f32 v77, v78, v79
    v_cvt_pk_bf16_f32 v78, v80, v81
    v_cvt_pk_bf16_f32 v79, v82, v83
    v_cvt_pk_bf16_f32 v80, v84, v85
    v_cvt_pk_bf16_f32 v81, v86, v87
    buffer_store_dwordx4 v[76:79], v60, s[12:15], s35 offen offset:1152 sc0 sc1
    buffer_store_dwordx2 v[80:81], v61, s[12:15], s35 offen offset:1408 sc0 sc1
    v_accvgpr_read_b32 v88, a144
    v_accvgpr_read_b32 v89, a148
    v_accvgpr_read_b32 v90, a152
    v_accvgpr_read_b32 v91, a156
    v_accvgpr_read_b32 v92, a160
    v_accvgpr_read_b32 v93, a164
    v_accvgpr_read_b32 v94, a168
    v_accvgpr_read_b32 v95, a172
    v_accvgpr_read_b32 v96, a176
    v_accvgpr_read_b32 v97, a180
    v_accvgpr_read_b32 v98, a184
    v_accvgpr_read_b32 v99, a188
    v_pk_mul_f32 v[88:89], v[88:89], v[128:129] op_sel:[0,0] op_sel_hi:[1,0]
    v_pk_mul_f32 v[90:91], v[90:91], v[128:129] op_sel:[0,0] op_sel_hi:[1,0]
    v_pk_mul_f32 v[92:93], v[92:93], v[128:129] op_sel:[0,0] op_sel_hi:[1,0]
    v_pk_mul_f32 v[94:95], v[94:95], v[128:129] op_sel:[0,0] op_sel_hi:[1,0]
    v_pk_mul_f32 v[96:97], v[96:97], v[128:129] op_sel:[0,0] op_sel_hi:[1,0]
    v_pk_mul_f32 v[98:99], v[98:99], v[128:129] op_sel:[0,0] op_sel_hi:[1,0]
    v_cvt_pk_bf16_f32 v88, v88, v89
    v_cvt_pk_bf16_f32 v89, v90, v91
    v_cvt_pk_bf16_f32 v90, v92, v93
    v_cvt_pk_bf16_f32 v91, v94, v95
    v_cvt_pk_bf16_f32 v92, v96, v97
    v_cvt_pk_bf16_f32 v93, v98, v99
    buffer_store_dwordx4 v[88:91], v60, s[12:15], s36 offen offset:0 sc0 sc1
    buffer_store_dwordx2 v[92:93], v61, s[12:15], s36 offen offset:256 sc0 sc1
    v_accvgpr_read_b32 v100, a145
    v_accvgpr_read_b32 v101, a149
    v_accvgpr_read_b32 v102, a153
    v_accvgpr_read_b32 v103, a157
    v_accvgpr_read_b32 v104, a161
    v_accvgpr_read_b32 v105, a165
    v_accvgpr_read_b32 v106, a169
    v_accvgpr_read_b32 v107, a173
    v_accvgpr_read_b32 v108, a177
    v_accvgpr_read_b32 v109, a181
    v_accvgpr_read_b32 v110, a185
    v_accvgpr_read_b32 v111, a189
    v_pk_mul_f32 v[100:101], v[100:101], v[128:129] op_sel:[0,1] op_sel_hi:[1,1]
    v_pk_mul_f32 v[102:103], v[102:103], v[128:129] op_sel:[0,1] op_sel_hi:[1,1]
    v_pk_mul_f32 v[104:105], v[104:105], v[128:129] op_sel:[0,1] op_sel_hi:[1,1]
    v_pk_mul_f32 v[106:107], v[106:107], v[128:129] op_sel:[0,1] op_sel_hi:[1,1]
    v_pk_mul_f32 v[108:109], v[108:109], v[128:129] op_sel:[0,1] op_sel_hi:[1,1]
    v_pk_mul_f32 v[110:111], v[110:111], v[128:129] op_sel:[0,1] op_sel_hi:[1,1]
    v_cvt_pk_bf16_f32 v100, v100, v101
    v_cvt_pk_bf16_f32 v101, v102, v103
    v_cvt_pk_bf16_f32 v102, v104, v105
    v_cvt_pk_bf16_f32 v103, v106, v107
    v_cvt_pk_bf16_f32 v104, v108, v109
    v_cvt_pk_bf16_f32 v105, v110, v111
    buffer_store_dwordx4 v[100:103], v60, s[12:15], s36 offen offset:384 sc0 sc1
    buffer_store_dwordx2 v[104:105], v61, s[12:15], s36 offen offset:640 sc0 sc1
    v_accvgpr_read_b32 v112, a146
    v_accvgpr_read_b32 v113, a150
    v_accvgpr_read_b32 v114, a154
    v_accvgpr_read_b32 v115, a158
    v_accvgpr_read_b32 v116, a162
    v_accvgpr_read_b32 v117, a166
    v_accvgpr_read_b32 v118, a170
    v_accvgpr_read_b32 v119, a174
    v_accvgpr_read_b32 v120, a178
    v_accvgpr_read_b32 v121, a182
    v_accvgpr_read_b32 v122, a186
    v_accvgpr_read_b32 v123, a190
    v_pk_mul_f32 v[112:113], v[112:113], v[130:131] op_sel:[0,0] op_sel_hi:[1,0]
    v_pk_mul_f32 v[114:115], v[114:115], v[130:131] op_sel:[0,0] op_sel_hi:[1,0]
    v_pk_mul_f32 v[116:117], v[116:117], v[130:131] op_sel:[0,0] op_sel_hi:[1,0]
    v_pk_mul_f32 v[118:119], v[118:119], v[130:131] op_sel:[0,0] op_sel_hi:[1,0]
    v_pk_mul_f32 v[120:121], v[120:121], v[130:131] op_sel:[0,0] op_sel_hi:[1,0]
    v_pk_mul_f32 v[122:123], v[122:123], v[130:131] op_sel:[0,0] op_sel_hi:[1,0]
    v_cvt_pk_bf16_f32 v112, v112, v113
    v_cvt_pk_bf16_f32 v113, v114, v115
    v_cvt_pk_bf16_f32 v114, v116, v117
    v_cvt_pk_bf16_f32 v115, v118, v119
    v_cvt_pk_bf16_f32 v116, v120, v121
    v_cvt_pk_bf16_f32 v117, v122, v123
    buffer_store_dwordx4 v[112:115], v60, s[12:15], s36 offen offset:768 sc0 sc1
    buffer_store_dwordx2 v[116:117], v61, s[12:15], s36 offen offset:1024 sc0 sc1
    v_accvgpr_read_b32 v64, a147
    v_accvgpr_read_b32 v65, a151
    v_accvgpr_read_b32 v66, a155
    v_accvgpr_read_b32 v67, a159
    v_accvgpr_read_b32 v68, a163
    v_accvgpr_read_b32 v69, a167
    v_accvgpr_read_b32 v70, a171
    v_accvgpr_read_b32 v71, a175
    v_accvgpr_read_b32 v72, a179
    v_accvgpr_read_b32 v73, a183
    v_accvgpr_read_b32 v74, a187
    v_accvgpr_read_b32 v75, a191
    v_pk_mul_f32 v[64:65], v[64:65], v[130:131] op_sel:[0,1] op_sel_hi:[1,1]
    v_pk_mul_f32 v[66:67], v[66:67], v[130:131] op_sel:[0,1] op_sel_hi:[1,1]
    v_pk_mul_f32 v[68:69], v[68:69], v[130:131] op_sel:[0,1] op_sel_hi:[1,1]
    v_pk_mul_f32 v[70:71], v[70:71], v[130:131] op_sel:[0,1] op_sel_hi:[1,1]
    v_pk_mul_f32 v[72:73], v[72:73], v[130:131] op_sel:[0,1] op_sel_hi:[1,1]
    v_pk_mul_f32 v[74:75], v[74:75], v[130:131] op_sel:[0,1] op_sel_hi:[1,1]
    v_cvt_pk_bf16_f32 v64, v64, v65
    v_cvt_pk_bf16_f32 v65, v66, v67
    v_cvt_pk_bf16_f32 v66, v68, v69
    v_cvt_pk_bf16_f32 v67, v70, v71
    v_cvt_pk_bf16_f32 v68, v72, v73
    v_cvt_pk_bf16_f32 v69, v74, v75
    buffer_store_dwordx4 v[64:67], v60, s[12:15], s36 offen offset:1152 sc0 sc1
    buffer_store_dwordx2 v[68:69], v61, s[12:15], s36 offen offset:1408 sc0 sc1
    s_branch L_fin
.section .rodata,"a"
.p2align 6
.amdhsa_kernel standalone__kv_cache_quant_int4_int2_kv_with_per_channel_or_per_token_scales__prompt_kernel
  .amdhsa_next_free_vgpr 512
  .amdhsa_next_free_sgpr 102
  .amdhsa_accum_offset 256
  .amdhsa_group_segment_fixed_size 0
  .amdhsa_kernarg_size 80
  .amdhsa_user_sgpr_count 2
  .amdhsa_user_sgpr_kernarg_segment_ptr 1
  .amdhsa_system_sgpr_workgroup_id_x 1
.end_amdhsa_kernel
```

```asm
; @launch grid=(256,1,1) block=(256,1,1) lds=161920
.amdgcn_target "amdgcn-amd-amdhsa--gfx950"
.text
.globl standalone__kv_cache_quant_int4_int2_kv_with_per_channel_or_per_token_scales__prompt_kernel
.p2align 8
.type standalone__kv_cache_quant_int4_int2_kv_with_per_channel_or_per_token_scales__prompt_kernel,@function
standalone__kv_cache_quant_int4_int2_kv_with_per_channel_or_per_token_scales__prompt_kernel:
    s_load_dwordx16 s[40:55], s[0:1], 0
    s_getpc_b64 s[60:61]
L_pc:
    s_movk_i32 s62, 0x4000
    s_lshl_b32 s63, 1, 17
    v_lshlrev_b32 v31, 6, v0
    buffer_load_dword v15, v31, s[60:63], 0 offen
    s_lshr_b32 s24, s2, 8
    s_cbranch_scc1 L_done
    s_load_dwordx4 s[16:19], s[0:1], 64
    v_lshlrev_b32 v30, 4, v0
    v_and_b32 v25, 63, v0
    v_lshrrev_b32 v24, 6, v0
    s_movk_i32 s24, 5120
    v_mul_u32_u24 v26, 43, v25
    v_mad_u32_u24 v12, v24, s24, v30
    s_movk_i32 s24, 384
    v_lshrrev_b32 v26, 10, v26
    s_and_b32 s22, s2, 7
    s_mul_i32 s29, s22, 264
    v_mad_u32_u24 v9, v26, s24, v12
    s_andn2_b32 s23, s2, 63
    s_bfe_u32 s95, s2, 0x30003
    s_add_u32 s29, s29, s23
    s_add_u32 s29, s29, s95
    s_lshr_b32 s23, s29, 1
    s_mulk_i32 s23, 384
    s_mul_i32 s24, s29, 24576
    v_lshl_add_u32 v27, v25, 3, s23
    s_addk_i32 s24, 2048
    s_mov_b32 exec_hi, 0xffff
    s_waitcnt lgkmcnt(0)
    global_load_dwordx2 v[32:33], v27, s[46:47]
    global_load_dwordx2 v[34:35], v27, s[48:49]
    s_add_u32 s56, s42, s24
    s_addc_u32 s57, s43, 0
    global_load_dwordx4 v[64:67], v9, s[56:57] offset:-2048 nt
    global_load_dwordx4 v[68:71], v9, s[56:57] offset:-512 nt
    global_load_dwordx4 v[72:75], v9, s[56:57] offset:1024 nt
    global_load_dwordx4 v[76:79], v9, s[56:57] offset:2560 nt
    global_load_dwordx4 v[80:83], v9, s[56:57] offset:-1664 nt
    global_load_dwordx4 v[84:87], v9, s[56:57] offset:-128 nt
    global_load_dwordx4 v[88:91], v9, s[56:57] offset:1408 nt
    global_load_dwordx4 v[92:95], v9, s[56:57] offset:2944 nt
    s_add_u32 s58, s44, s24
    s_addc_u32 s59, s45, 0
    global_load_dwordx4 v[96:99], v12, s[58:59] offset:-2048 nt
    global_load_dwordx4 v[100:103], v12, s[58:59] offset:-1280 nt
    global_load_dwordx4 v[104:107], v12, s[58:59] offset:-512 nt
    global_load_dwordx4 v[108:111], v12, s[58:59] offset:256 nt
    v_readfirstlane_b32 s25, v24
    s_lshl_b32 s23, s29, 6
    s_lshr_b32 s94, s29, 6
    s_lshl4_add_u32 s23, s25, s23
    s_load_dwordx4 s[64:67], s[50:51], s23
    s_load_dwordx4 s[68:71], s[52:53], s23
    s_lshl_b32 s22, s94, 10
    s_add_u32 s22, s22, 67108864
    s_or_b32 s83, s95, s25
    s_cbranch_scc1 L_notleader0
    s_load_dwordx8 s[72:79], s[18:19], s22 glc
L_notleader0:
    s_mov_b32 exec_hi, -1
    s_mov_b32 exec_hi, 0xffff
    global_load_dwordx4 v[112:115], v12, s[58:59] offset:1024 nt
    s_mov_b32 exec_hi, -1
    s_mul_i32 s24, s94, 786432
    s_add_u32 s8, s40, s24
    s_addc_u32 s9, s41, 0
    s_mov_b32 s10, 786432
    s_mov_b32 s11, 0x20000
    s_add_u32 s12, s54, s24
    s_addc_u32 s13, s55, 0
    s_mov_b32 s14, 786432
    s_mov_b32 s15, 0x20000
    s_lshl2_add_u32 s24, s95, s25
    s_mul_i32 s24, s24, 24576
    s_mul_i32 s82, s25, 6144
    s_add_u32 s82, s82, 73728
    v_add_u32 v208, 0, v25
    v_add_u32 v209, 64, v25
    v_add_u32 v210, 128, v25
    v_add_u32 v211, 192, v25
    v_add_u32 v212, 256, v25
    v_add_u32 v213, 320, v25
    v_mul_u32_u24 v216, 2731, v208
    v_mul_u32_u24 v217, 2731, v209
    v_mul_u32_u24 v218, 2731, v210
    v_mul_u32_u24 v219, 2731, v211
    v_mul_u32_u24 v220, 2731, v212
    s_mov_b32 exec_hi, 0xffff
    global_load_dwordx4 v[116:119], v12, s[58:59] offset:1792 nt
    s_mov_b32 exec_hi, -1
    v_mul_u32_u24 v221, 2731, v213
    v_bfe_u32 v216, v216, 17, 3
    v_bfe_u32 v217, v217, 17, 3
    v_bfe_u32 v218, v218, 17, 3
    v_bfe_u32 v219, v219, 17, 3
    v_bfe_u32 v220, v220, 17, 3
    v_bfe_u32 v221, v221, 17, 3
    v_xor_b32 v208, v208, v216
    v_xor_b32 v209, v209, v217
    v_xor_b32 v210, v210, v218
    v_xor_b32 v211, v211, v219
    v_xor_b32 v212, v212, v220
    v_xor_b32 v213, v213, v221
    v_lshl_add_u32 v208, v208, 4, s24
    v_lshl_add_u32 v209, v209, 4, s24
    v_lshl_add_u32 v210, v210, 4, s24
    v_lshl_add_u32 v211, v211, 4, s24
    v_lshl_add_u32 v212, v212, 4, s24
    v_lshl_add_u32 v213, v213, 4, s24
    v_mov_b32 v16, 0
    v_mov_b32 v17, 147456
    ds_write_b32 v17, v16
    s_mov_b32 s97, 0xffff0000
    s_mov_b32 s38, 0x3dd53b95
    v_mul_u32_u24 v27, 24, v26
    s_mov_b32 exec_hi, 0xffff
    global_load_dwordx4 v[120:123], v12, s[58:59] offset:2560 nt
    s_mov_b32 exec_hi, -1
    v_sub_u32 v27, v25, v27
    v_lshlrev_b32 v10, 4, v27
    v_add_u32 v10, 147584, v10
    v_mul_u32_u24 v36, 768, v26
    v_add_u32 v36, v36, v10
    s_waitcnt vmcnt(15)
    v_lshlrev_b32 v128, 16, v32
    v_and_b32 v129, s97, v32
    v_lshlrev_b32 v130, 16, v34
    v_and_b32 v131, s97, v34
    v_lshlrev_b32 v132, 16, v33
    v_and_b32 v133, s97, v33
    v_lshlrev_b32 v134, 16, v35
    v_and_b32 v135, s97, v35
    v_mul_f32 v128, s38, v128
    v_mul_f32 v129, s38, v129
    v_mul_f32 v132, s38, v132
    v_mul_f32 v133, s38, v133
    v_mul_f32_e64 v130, -v130, v128
    v_mul_f32_e64 v131, -v131, v129
    v_mul_f32_e64 v134, -v134, v132
    v_mul_f32_e64 v135, -v135, v133
    s_mov_b32 exec_hi, 0xffff
    ds_write_b128 v36, v[128:131] offset:0
    ds_write_b128 v36, v[132:135] offset:384
    s_mov_b32 exec_hi, -1
    ds_read_b128 v[128:131], v10 offset:0
    ds_read_b128 v[132:135], v10 offset:384
    s_mov_b32 exec_hi, 0xffff
    global_load_dwordx4 v[124:127], v12, s[58:59] offset:3328 nt
    s_mov_b32 exec_hi, -1
    ds_read_b128 v[136:139], v10 offset:768
    ds_read_b128 v[140:143], v10 offset:1152
    v_lshrrev_b32 v48, 1, v26
    v_lshlrev_b32 v48, 30, v48
    v_lshlrev_b32 v31, 4, v25
    v_mul_u32_u24 v30, 3072, v24
    v_add_u32 v8, v30, v31
    v_lshl_add_u32 v49, v24, 2, v26
    v_mul_u32_u24 v49, 384, v49
    v_lshlrev_b32 v50, 1, v24
    v_xor_b32 v50, v27, v50
    v_lshl_add_u32 v49, v50, 4, v49
    v_or_b32 v11, v49, v48
    v_xor_b32 v54, 16, v11
    v_lshrrev_b32 v49, 5, v25
    v_sub_u32 v49, 1, v49
    v_and_b32 v49, v49, v24
    v_lshlrev_b32 v49, 4, v49
    v_xor_b32 v49, v49, v8
    v_add_u32 v49, 12288, v49
    v_or_b32 v20, v49, v48
    s_mul_i32 s37, s95, 24576
    s_add_u32 s80, s37, 6144
    s_mov_b32 s81, s37
    s_mul_i32 s39, s94, 1769472
    s_mov_b32 s62, L_slow-L_pc
    s_bfe_u32 s24, s2, 0x20003
    s_add_u32 s24, s24, 1
    s_lshl_b32 s24, s24, 14
    v_lshlrev_b32 v15, 6, v0
    buffer_load_dword v15, v15, s[60:63], s24 offen
    v_or_b32 v9, v9, v48
    v_or_b32 v12, v12, v48
    s_waitcnt lgkmcnt(0)
    s_barrier
    s_add_u32 s4, s18, s39
    s_addc_u32 s5, s19, 0
    s_mov_b32 s6, 1572864
    s_mov_b32 s7, 0x20000
    s_add_u32 s20, s18, s22
    s_addc_u32 s21, s19, 0
    s_mov_b32 s22, 32
    s_mov_b32 s23, 0x20000
    s_mov_b32 s88, s16
    s_mov_b32 s89, s17
    s_movk_i32 s90, 256
    s_mov_b32 s91, s63
    s_lshl_b32 s93, s94, 3
    s_cmp_lg_u32 s83, 0
    s_cbranch_scc1 L_notleader
    s_mov_b32 s24, 1
    s_lshr_b32 s72, s72, 8
    s_min_u32 s72, s72, 31
    s_bitset1_b32 s24, s72
    s_lshr_b32 s73, s73, 8
    s_min_u32 s73, s73, 31
    s_bitset1_b32 s24, s73
    s_lshr_b32 s74, s74, 8
    s_min_u32 s74, s74, 31
    s_bitset1_b32 s24, s74
    s_lshr_b32 s75, s75, 8
    s_min_u32 s75, s75, 31
    s_bitset1_b32 s24, s75
    s_lshr_b32 s76, s76, 8
    s_min_u32 s76, s76, 31
    s_bitset1_b32 s24, s76
    s_lshr_b32 s77, s77, 8
    s_min_u32 s77, s77, 31
    s_bitset1_b32 s24, s77
    s_lshr_b32 s78, s78, 8
    s_min_u32 s78, s78, 31
    s_bitset1_b32 s24, s78
    s_lshr_b32 s79, s79, 8
    s_min_u32 s79, s79, 31
    s_bitset1_b32 s24, s79
    s_ff0_i32_b32 s24, s24
    s_lshl_b32 s24, s24, 8
    v_mov_b32 v52, s24
    s_mov_b64 exec, 1
    buffer_store_dword v52, off, s[88:91], s93 sc1
    s_mov_b64 exec, -1
L_notleader:
    s_add_u32 m0, s82, 0
    s_movk_i32 s24, 0
    buffer_load_dwordx4 v208, s[8:11], s24 offen nt lds
    s_waitcnt vmcnt(16)
    v_cvt_f32_i32 v64, v64
    v_cvt_f32_i32 v65, v65
    v_cvt_f32_i32 v68, v68
    v_cvt_f32_i32 v69, v69
    v_fma_f32 v64, v64, v128, v130
    v_fma_f32 v65, v65, v129, v131
    v_fma_f32 v68, v68, v128, v130
    v_fma_f32 v69, v69, v129, v131
    v_cvt_pk_bf16_f32 v64, v64, v65
    v_cvt_pk_bf16_f32 v68, v68, v69
    v_cvt_f32_i32 v66, v66
    v_cvt_f32_i32 v67, v67
    v_cvt_f32_i32 v70, v70
    v_cvt_f32_i32 v71, v71
    v_fma_f32 v66, v66, v132, v134
    v_fma_f32 v67, v67, v133, v135
    v_fma_f32 v70, v70, v132, v134
    v_fma_f32 v71, v71, v133, v135
    v_cvt_pk_bf16_f32 v65, v66, v67
    v_cvt_pk_bf16_f32 v69, v70, v71
    s_waitcnt vmcnt(14)
    v_cvt_f32_i32 v72, v72
    v_cvt_f32_i32 v73, v73
    v_cvt_f32_i32 v76, v76
    v_cvt_f32_i32 v77, v77
    v_fma_f32 v72, v72, v128, v130
    v_fma_f32 v73, v73, v129, v131
    s_add_u32 m0, s82, 1024
    s_movk_i32 s24, 0
    buffer_load_dwordx4 v209, s[8:11], s24 offen nt lds
    v_fma_f32 v76, v76, v128, v130
    v_fma_f32 v77, v77, v129, v131
    v_cvt_pk_bf16_f32 v72, v72, v73
    v_cvt_pk_bf16_f32 v76, v76, v77
    v_cvt_f32_i32 v74, v74
    v_cvt_f32_i32 v75, v75
    v_cvt_f32_i32 v78, v78
    v_cvt_f32_i32 v79, v79
    v_fma_f32 v74, v74, v132, v134
    v_fma_f32 v75, v75, v133, v135
    v_fma_f32 v78, v78, v132, v134
    v_fma_f32 v79, v79, v133, v135
    v_cvt_pk_bf16_f32 v73, v74, v75
    v_cvt_pk_bf16_f32 v77, v78, v79
    s_waitcnt vmcnt(13)
    v_cvt_f32_i32 v80, v80
    v_cvt_f32_i32 v81, v81
    v_cvt_f32_i32 v84, v84
    v_cvt_f32_i32 v85, v85
    v_fma_f32 v80, v80, v136, v138
    v_fma_f32 v81, v81, v137, v139
    v_fma_f32 v84, v84, v136, v138
    v_fma_f32 v85, v85, v137, v139
    v_cvt_pk_bf16_f32 v66, v80, v81
    v_cvt_pk_bf16_f32 v70, v84, v85
    v_cvt_f32_i32 v82, v82
    v_cvt_f32_i32 v83, v83
    v_cvt_f32_i32 v86, v86
    s_add_u32 m0, s82, 2048
    s_movk_i32 s24, 0
    buffer_load_dwordx4 v210, s[8:11], s24 offen nt lds
    v_cvt_f32_i32 v87, v87
    v_fma_f32 v82, v82, v140, v142
    v_fma_f32 v83, v83, v141, v143
    v_fma_f32 v86, v86, v140, v142
    v_fma_f32 v87, v87, v141, v143
    v_cvt_pk_bf16_f32 v67, v82, v83
    v_cvt_pk_bf16_f32 v71, v86, v87
    s_waitcnt vmcnt(12)
    v_cvt_f32_i32 v88, v88
    v_cvt_f32_i32 v89, v89
    v_cvt_f32_i32 v92, v92
    v_cvt_f32_i32 v93, v93
    v_fma_f32 v88, v88, v136, v138
    v_fma_f32 v89, v89, v137, v139
    v_fma_f32 v92, v92, v136, v138
    v_fma_f32 v93, v93, v137, v139
    v_cvt_pk_bf16_f32 v74, v88, v89
    v_cvt_pk_bf16_f32 v78, v92, v93
    v_cvt_f32_i32 v90, v90
    v_cvt_f32_i32 v91, v91
    v_cvt_f32_i32 v94, v94
    v_cvt_f32_i32 v95, v95
    v_fma_f32 v90, v90, v140, v142
    v_fma_f32 v91, v91, v141, v143
    v_fma_f32 v94, v94, v140, v142
    v_fma_f32 v95, v95, v141, v143
    v_cvt_pk_bf16_f32 v75, v90, v91
    v_cvt_pk_bf16_f32 v79, v94, v95
    buffer_store_dwordx4 v[64:67], v11, s[4:7], s37 offen offset:0 sc1
    buffer_store_dwordx4 v[68:71], v54, s[4:7], s37 offen offset:768 sc1
    buffer_store_dwordx4 v[72:75], v11, s[4:7], s80 offen offset:0 sc1
    buffer_store_dwordx4 v[76:79], v54, s[4:7], s80 offen offset:768 sc1
    s_mov_b32 exec_hi, 0xffff
    ds_write_b128 v11, v[64:67] offset:0
    ds_write_b128 v54, v[68:71] offset:768
    ds_write_b128 v11, v[72:75] offset:6144
    ds_write_b128 v54, v[76:79] offset:6912
    s_mov_b32 exec_hi, -1
    s_add_u32 m0, s82, 3072
    s_movk_i32 s24, 0
    buffer_load_dwordx4 v211, s[8:11], s24 offen nt lds
    s_lshl_b32 s57, s64, 16
    s_and_b32 s58, s64, s97
    v_mov_b32 v128, s57
    v_mov_b32 v129, s58
    s_lshl_b32 s57, s68, 16
    s_and_b32 s58, s68, s97
    v_mul_f32_e64 v130, -s57, v128
    v_mul_f32_e64 v131, -s58, v129
    s_lshl_b32 s57, s65, 16
    s_and_b32 s58, s65, s97
    v_mov_b32 v132, s57
    v_mov_b32 v133, s58
    s_lshl_b32 s57, s69, 16
    s_and_b32 s58, s69, s97
    v_mul_f32_e64 v134, -s57, v132
    v_mul_f32_e64 v135, -s58, v133
    s_lshl_b32 s57, s66, 16
    s_and_b32 s58, s66, s97
    v_mov_b32 v136, s57
    v_mov_b32 v137, s58
    s_lshl_b32 s57, s70, 16
    s_and_b32 s58, s70, s97
    v_mul_f32_e64 v138, -s57, v136
    v_mul_f32_e64 v139, -s58, v137
    s_lshl_b32 s57, s67, 16
    s_and_b32 s58, s67, s97
    v_mov_b32 v140, s57
    v_mov_b32 v141, s58
    s_lshl_b32 s57, s71, 16
    s_and_b32 s58, s71, s97
    v_mul_f32_e64 v142, -s57, v140
    v_mul_f32_e64 v143, -s58, v141
    s_waitcnt vmcnt(15)
    v_cvt_f32_i32 v96, v96
    v_cvt_f32_i32 v100, v100
    v_cvt_f32_i32 v97, v97
    v_cvt_f32_i32 v101, v101
    v_fma_f32 v96, v96, v128, v130
    s_add_u32 m0, s82, 4096
    s_movk_i32 s24, 0
    buffer_load_dwordx4 v212, s[8:11], s24 offen nt lds
    v_fma_f32 v100, v100, v129, v131
    v_fma_f32 v97, v97, v128, v130
    v_fma_f32 v101, v101, v129, v131
    v_cvt_f32_i32 v98, v98
    v_cvt_f32_i32 v102, v102
    v_cvt_f32_i32 v99, v99
    v_cvt_f32_i32 v103, v103
    v_fma_f32 v98, v98, v128, v130
    v_fma_f32 v102, v102, v129, v131
    v_fma_f32 v99, v99, v128, v130
    v_fma_f32 v103, v103, v129, v131
    s_waitcnt vmcnt(14)
    v_cvt_f32_i32 v104, v104
    v_cvt_f32_i32 v108, v108
    v_cvt_f32_i32 v105, v105
    v_cvt_f32_i32 v109, v109
    v_fma_f32 v104, v104, v132, v134
    v_fma_f32 v108, v108, v133, v135
    v_fma_f32 v105, v105, v132, v134
    v_fma_f32 v109, v109, v133, v135
    v_cvt_f32_i32 v106, v106
    v_cvt_f32_i32 v110, v110
    v_cvt_f32_i32 v107, v107
    v_cvt_f32_i32 v111, v111
    v_fma_f32 v106, v106, v132, v134
    v_fma_f32 v110, v110, v133, v135
    v_fma_f32 v107, v107, v132, v134
    v_fma_f32 v111, v111, v133, v135
    v_cvt_pk_bf16_f32 v96, v96, v100
    v_cvt_pk_bf16_f32 v100, v97, v101
    v_cvt_pk_bf16_f32 v97, v104, v108
    v_cvt_pk_bf16_f32 v101, v105, v109
    v_cvt_pk_bf16_f32 v104, v98, v102
    v_cvt_pk_bf16_f32 v105, v106, v110
    v_cvt_pk_bf16_f32 v108, v99, v103
    v_cvt_pk_bf16_f32 v109, v107, v111
    s_waitcnt vmcnt(12)
    v_cvt_f32_i32 v112, v112
    v_cvt_f32_i32 v116, v116
    s_add_u32 m0, s82, 5120
    s_movk_i32 s24, 0
    buffer_load_dwordx4 v213, s[8:11], s24 offen nt lds
    v_cvt_f32_i32 v113, v113
    v_cvt_f32_i32 v117, v117
    v_fma_f32 v112, v112, v136, v138
    v_fma_f32 v116, v116, v137, v139
    v_fma_f32 v113, v113, v136, v138
    v_fma_f32 v117, v117, v137, v139
    v_cvt_f32_i32 v114, v114
    v_cvt_f32_i32 v118, v118
    v_cvt_f32_i32 v115, v115
    v_cvt_f32_i32 v119, v119
    v_fma_f32 v114, v114, v136, v138
    v_fma_f32 v118, v118, v137, v139
    v_fma_f32 v115, v115, v136, v138
    v_fma_f32 v119, v119, v137, v139
    s_waitcnt vmcnt(11)
    v_cvt_f32_i32 v120, v120
    v_cvt_f32_i32 v124, v124
    v_cvt_f32_i32 v121, v121
    v_cvt_f32_i32 v125, v125
    v_fma_f32 v120, v120, v140, v142
    v_fma_f32 v124, v124, v141, v143
    v_fma_f32 v121, v121, v140, v142
    v_fma_f32 v125, v125, v141, v143
    v_cvt_f32_i32 v122, v122
    v_cvt_f32_i32 v126, v126
    v_cvt_f32_i32 v123, v123
    v_cvt_f32_i32 v127, v127
    v_fma_f32 v122, v122, v140, v142
    v_fma_f32 v126, v126, v141, v143
    v_fma_f32 v123, v123, v140, v142
    v_fma_f32 v127, v127, v141, v143
    v_cvt_pk_bf16_f32 v98, v112, v116
    v_cvt_pk_bf16_f32 v102, v113, v117
    v_cvt_pk_bf16_f32 v99, v120, v124
    v_cvt_pk_bf16_f32 v103, v121, v125
    v_cvt_pk_bf16_f32 v106, v114, v118
    v_cvt_pk_bf16_f32 v107, v122, v126
    v_cvt_pk_bf16_f32 v110, v115, v119
    v_cvt_pk_bf16_f32 v111, v123, v127
    buffer_store_dwordx4 v[96:99], v20, s[4:7], s81 offen offset:0 sc1
    buffer_store_dwordx4 v[100:103], v20, s[4:7], s81 offen offset:768 sc1
    buffer_store_dwordx4 v[104:107], v20, s[4:7], s81 offen offset:1536 sc1
    buffer_store_dwordx4 v[108:111], v20, s[4:7], s81 offen offset:2304 sc1
    s_mov_b32 exec_hi, 0xffff
    ds_write_b128 v20, v[96:99] offset:12288
    ds_write_b128 v20, v[100:103] offset:13056
    ds_write_b128 v20, v[104:107] offset:13824
    ds_write_b128 v20, v[108:111] offset:14592
    s_mov_b32 exec_hi, -1
    v_mov_b32 v52, 0
    buffer_load_dword v52, off, s[88:91], s93 sc1
    s_lshl_b32 s39, s95, 2
    v_lshl_add_u32 v13, v0, 2, s39
    v_cmp_lt_u32 vcc, 0, v0
    v_mov_b32 v30, 0x40000000
    s_mov_b32 s96, 100000
    v_cndmask_b32 v13, v13, v30, vcc
    s_mul_i32 s39, s94, 1572864
    s_add_u32 s64, s42, s39
    s_addc_u32 s65, s43, 0
    s_mov_b32 s66, 1572864
    s_mov_b32 s67, 0x20000
    s_add_u32 s68, s44, s39
    s_addc_u32 s69, s45, 0
    s_mov_b32 s70, 1572864
    s_mov_b32 s71, 0x20000
    s_waitcnt vmcnt(11)
    s_add_u32 m0, s82, 24576
    s_movk_i32 s24, 6144
    buffer_load_dwordx4 v208, s[8:11], s24 offen nt lds
    s_and_b32 s33, s29, 63
    s_mul_i32 s33, s33, 24576
    s_mov_b32 s35, s33
    s_mul_i32 s26, s25, 3072
    s_add_u32 s26, s26, 12288
    s_add_u32 s56, s26, 24576
    s_add_u32 s39, s95, 1
    s_and_b32 s39, s39, 7
    s_mul_i32 s32, s39, 24576
    s_waitcnt vmcnt(11)
    s_add_u32 m0, s82, 25600
    s_movk_i32 s24, 6144
    buffer_load_dwordx4 v209, s[8:11], s24 offen nt lds
    s_add_u32 s27, s32, 12288
    s_mov_b32 s28, 0
    s_mov_b32 s30, 24576
    v_and_b32 v26, 15, v25
    v_lshrrev_b32 v49, 4, v25
    v_bfe_u32 v28, v25, 1, 3
    v_xor_b32 v29, v49, v28
    v_mul_u32_u24 v30, 384, v26
    v_lshl_add_u32 v2, v29, 4, v30
    s_waitcnt vmcnt(11)
    s_add_u32 m0, s82, 26624
    s_movk_i32 s24, 6144
    buffer_load_dwordx4 v210, s[8:11], s24 offen nt lds
    v_xor_b32 v3, 64, v2
    v_mul_u32_u24 v50, 3072, v49
    v_add_u32 v50, 24576, v50
    v_and_b32 v51, 1, v49
    v_lshl_add_u32 v51, v26, 1, v51
    v_lshl_add_u32 v1, v51, 4, v50
    v_xor_b32 v21, 16, v1
    v_lshl_add_u32 v22, v26, 4, v50
    v_add_u32 v22, 512, v22
    s_waitcnt vmcnt(11)
    s_add_u32 m0, s82, 27648
    s_movk_i32 s24, 6144
    buffer_load_dwordx4 v211, s[8:11], s24 offen nt lds
    v_lshrrev_b32 v29, 1, v49
    v_xor_b32 v29, v29, v28
    v_lshl_add_u32 v31, v29, 4, v30
    v_and_b32 v29, 1, v49
    v_lshl_add_u32 v31, v29, 3, v31
    v_add_u32 v0, s82, v31
    v_mov_b32 v4, 0
    v_mov_b32 v5, 0
    v_mov_b32 v6, 0
    v_mov_b32 v7, 0
    s_branch L_anchor
.p2align 12
L_anchor:
    s_cmp_eq_u32 s25, 1
    s_cbranch_scc1 L_t1_1
    s_cmp_eq_u32 s25, 2
    s_cbranch_scc1 L_t1_2
    s_cmp_eq_u32 s25, 3
    s_cbranch_scc1 L_t1_3
L_t1_0:
    s_branch L_pad14
L_tb1_0:
    s_branch L_pad10
L_tb1_4:
    s_branch L_pad6
L_tb1_8:
    s_branch L_pad2
L_tb1_12:
    s_branch L_t1_end
L_t1_1:
    s_branch L_pad13
L_tb1_1:
    s_branch L_pad9
L_tb1_5:
    s_branch L_pad5
L_tb1_9:
    s_branch L_pad1
L_tb1_13:
    s_branch L_t1_end
L_t1_2:
    s_branch L_pad12
L_tb1_2:
    s_branch L_pad8
L_tb1_6:
    s_branch L_pad4
L_tb1_10:
    s_branch L_t1_end
L_t1_3:
    s_branch L_pad11
L_tb1_3:
    s_branch L_pad7
L_tb1_7:
    s_branch L_pad3
L_tb1_11:
L_t1_end:
    s_waitcnt vmcnt(4)
    v_readfirstlane_b32 s92, v52
    s_mov_b32 s39, 100
L_tagretry:
    s_cmp_lg_u32 s92, 0
    s_cbranch_scc1 L_tagok
    s_sub_u32 s39, s39, 1
    s_cbranch_scc1 L_tagslow
    s_sleep 8
    s_buffer_load_dword s92, s[88:91], s93 glc
    s_waitcnt lgkmcnt(0)
    s_branch L_tagretry
L_tagok:
    s_add_u32 s92, s92, 1
    v_mov_b32 v55, s92
    s_mov_b64 exec, 1
    v_mov_b32 v16, 1
    v_mov_b32 v17, 147456
    ds_add_rtn_u32 v16, v17, v16
    s_waitcnt lgkmcnt(0)
    v_readfirstlane_b32 s24, v16
    s_nop 0
    s_cmp_lg_u32 s24, 3
    s_cbranch_scc1 L_nopost
    s_lshl_b32 s39, s95, 2
    buffer_store_dword v55, off, s[20:23], s39 sc1
L_nopost:
    s_mov_b64 exec, -1
    s_waitcnt vmcnt(11)
    s_add_u32 m0, s82, 28672
    s_movk_i32 s24, 6144
    buffer_load_dwordx4 v212, s[8:11], s24 offen nt lds
    s_waitcnt vmcnt(11)
    s_add_u32 m0, s82, 29696
    s_movk_i32 s24, 6144
    buffer_load_dwordx4 v213, s[8:11], s24 offen nt lds
    v_xor_b32 v17, 32, v0
    v_xor_b32 v18, 64, v0
    v_xor_b32 v19, 96, v0
    s_waitcnt vmcnt(6)
    ds_read_b64 a[192:193], v0 offset:0
    ds_read_b64 a[194:195], v18 offset:128
    ds_read_b64 a[196:197], v17 offset:0
    ds_read_b64 a[198:199], v19 offset:128
    ds_read_b64 a[200:201], v18 offset:0
    ds_read_b64 a[202:203], v0 offset:256
    ds_read_b64 a[204:205], v19 offset:0
    ds_read_b64 a[206:207], v17 offset:256
    ds_read_b64 a[208:209], v0 offset:128
    ds_read_b64 a[210:211], v18 offset:256
    ds_read_b64 a[212:213], v17 offset:128
    ds_read_b64 a[214:215], v19 offset:256
    s_waitcnt lgkmcnt(0)
    s_barrier
    s_lshl_b32 s24, s25, 4
    s_add_u32 s24, s24, s29
    s_and_b32 s58, s24, 63
    s_add_u32 s24, s24, 8
    s_and_b32 s57, s24, 63
    s_andn2_b32 s24, s29, 63
    s_or_b32 s58, s58, s24
    s_or_b32 s57, s57, s24
    v_mov_b32 v37, s58
    v_mov_b32 v38, s57
    v_cmp_lt_u32 vcc, 15, v25
    s_lshr_b32 s58, s58, 1
    s_lshr_b32 s57, s57, 1
    s_mulk_i32 s58, 384
    s_mulk_i32 s57, 384
    v_cndmask_b32 v37, v37, v38, vcc
    v_lshl_add_u32 v38, v25, 3, s58
    v_lshl_add_u32 v39, v25, 3, s57
    v_lshlrev_b32 v37, 6, v37
    v_lshl_add_u32 v37, v26, 2, v37
    s_mov_b32 exec_hi, 0xffff
    global_load_dwordx2 v[80:81], v38, s[46:47]
    global_load_dwordx2 v[82:83], v38, s[48:49]
    global_load_dwordx2 v[84:85], v39, s[46:47]
    global_load_dwordx2 v[86:87], v39, s[48:49]
    s_mov_b32 exec_hi, 0
    global_load_dword v88, v37, s[50:51]
    global_load_dword v89, v37, s[52:53]
    s_mov_b32 exec_hi, -1
    ds_read_b128 v[144:147], v2 offset:0
    ds_read_b128 v[148:151], v3 offset:0
    ds_read_b128 v[152:155], v2 offset:6144
    ds_read_b128 v[156:159], v3 offset:6144
    ds_read_b128 v[160:163], v2 offset:128
    ds_read_b128 v[164:167], v3 offset:128
    ds_read_b128 v[168:171], v2 offset:6272
    ds_read_b128 v[172:175], v3 offset:6272
    ds_read_b128 v[176:179], v2 offset:256
    ds_read_b128 v[180:183], v3 offset:256
    ds_read_b128 v[184:187], v2 offset:6400
    ds_read_b128 v[188:191], v3 offset:6400
    s_waitcnt lgkmcnt(0)
    v_mfma_f32_16x16x32_bf16 v[64:67], v[144:147], a[192:195], 0
    v_mfma_f32_16x16x32_bf16 v[64:67], v[148:151], a[196:199], v[64:67]
    v_mfma_f32_16x16x32_bf16 v[64:67], v[160:163], a[200:203], v[64:67]
    v_mfma_f32_16x16x32_bf16 v[64:67], v[164:167], a[204:207], v[64:67]
    v_mfma_f32_16x16x32_bf16 v[64:67], v[176:179], a[208:211], v[64:67]
    v_mfma_f32_16x16x32_bf16 v[64:67], v[180:183], a[212:215], v[64:67]
    v_mfma_f32_16x16x32_bf16 v[96:99], v[152:155], a[192:195], 0
    v_mfma_f32_16x16x32_bf16 v[96:99], v[156:159], a[196:199], v[96:99]
    v_mfma_f32_16x16x32_bf16 v[96:99], v[168:171], a[200:203], v[96:99]
    v_mfma_f32_16x16x32_bf16 v[96:99], v[172:175], a[204:207], v[96:99]
    v_mfma_f32_16x16x32_bf16 v[96:99], v[184:187], a[208:211], v[96:99]
    v_mfma_f32_16x16x32_bf16 v[96:99], v[188:191], a[212:215], v[96:99]
    s_nop 7
    s_waitcnt vmcnt(11)
    s_add_u32 m0, s82, 49152
    s_movk_i32 s24, 12288
    buffer_load_dwordx4 v208, s[8:11], s24 offen nt lds
    v_max3_f32 v48, v64, v65, v66
    v_max3_f32 v48, v48, v67, v96
    v_max3_f32 v48, v48, v97, v98
    v_max_f32 v48, v48, v99
    v_mov_b32 v49, v48
    s_nop 1
    v_permlane16_swap_b32 v48, v49
    s_nop 1
    v_max_f32 v48, v48, v49
    v_mov_b32 v49, v48
    s_nop 1
    v_permlane32_swap_b32 v48, v49
    s_nop 1
    v_max_f32 v48, v48, v49
    v_sub_f32 v128, 0, v48
    v_sub_f32 v129, 0, v48
    v_sub_f32 v130, 0, v48
    v_sub_f32 v131, 0, v48
    v_sub_f32 v64, v64, v48
    v_sub_f32 v65, v65, v48
    v_sub_f32 v66, v66, v48
    v_sub_f32 v67, v67, v48
    v_sub_f32 v96, v96, v48
    s_waitcnt vmcnt(11)
    s_add_u32 m0, s82, 50176
    s_movk_i32 s24, 12288
    buffer_load_dwordx4 v209, s[8:11], s24 offen nt lds
    v_sub_f32 v97, v97, v48
    v_sub_f32 v98, v98, v48
    v_sub_f32 v99, v99, v48
    v_exp_f32 v64, v64
    v_exp_f32 v65, v65
    v_exp_f32 v66, v66
    v_exp_f32 v67, v67
    v_exp_f32 v96, v96
    v_exp_f32 v97, v97
    v_exp_f32 v98, v98
    v_exp_f32 v99, v99
    v_add_f32 v4, v4, v64
    v_add_f32 v4, v4, v65
    v_add_f32 v4, v4, v66
    v_add_f32 v4, v4, v67
    v_add_f32 v4, v4, v96
    v_add_f32 v4, v4, v97
    v_add_f32 v4, v4, v98
    v_add_f32 v4, v4, v99
    v_cvt_pk_bf16_f32 v64, v64, v65
    v_cvt_pk_bf16_f32 v65, v66, v67
    v_cvt_pk_bf16_f32 v66, v96, v97
    v_cvt_pk_bf16_f32 v67, v98, v99
    s_buffer_load_dwordx8 s[72:79], s[20:23], 0 glc
    s_waitcnt vmcnt(8)
    s_add_u32 m0, s82, 51200
    s_movk_i32 s24, 12288
    buffer_load_dwordx4 v210, s[8:11], s24 offen nt lds
    s_add_u32 s33, s33, 196608
    s_sub_u32 s34, s33, 1572864
    s_min_u32 s33, s33, s34
    s_add_u32 s34, s33, 3072
    s_add_u32 s37, s37, 196608
    s_add_u32 s80, s80, 196608
    s_add_u32 s35, s35, 196608
    s_sub_u32 s36, s35, 1572864
    s_min_u32 s35, s35, s36
    s_add_u32 s36, s35, 3072
    s_add_u32 s81, s81, 196608
    s_mov_b32 s88, s60
    s_mov_b32 s89, s61
    s_mov_b32 s90, L_slow-L_pc
    s_lshr_b32 s59, s2, 3
    s_mul_i32 s93, s59, 43
    s_lshr_b32 s93, s93, 7
    s_mul_i32 s39, s93, 3
    s_sub_u32 s59, s59, s39
    s_lshl_b32 s59, s59, 10
    s_mul_i32 s93, s93, 12288
    s_add_u32 s93, s93, s59
    s_waitcnt vmcnt(3)
    v_lshlrev_b32 v112, 16, v80
    v_and_b32 v113, s97, v80
    v_lshlrev_b32 v114, 16, v82
    v_and_b32 v115, s97, v82
    v_lshlrev_b32 v116, 16, v81
    v_and_b32 v117, s97, v81
    v_lshlrev_b32 v118, 16, v83
    v_and_b32 v119, s97, v83
    v_lshlrev_b32 v120, 16, v84
    v_and_b32 v121, s97, v84
    v_lshlrev_b32 v122, 16, v86
    v_and_b32 v123, s97, v86
    v_lshlrev_b32 v124, 16, v85
    v_and_b32 v125, s97, v85
    v_lshlrev_b32 v126, 16, v87
    v_and_b32 v127, s97, v87
    v_lshlrev_b32 v92, 16, v88
    v_and_b32 v93, s97, v88
    s_waitcnt vmcnt(8)
    s_add_u32 m0, s82, 52224
    s_movk_i32 s24, 12288
    buffer_load_dwordx4 v211, s[8:11], s24 offen nt lds
    v_lshlrev_b32 v94, 16, v89
    v_and_b32 v95, s97, v89
    v_mul_f32 v112, s38, v112
    v_mul_f32 v113, s38, v113
    v_mul_f32 v116, s38, v116
    v_mul_f32 v117, s38, v117
    v_mul_f32 v120, s38, v120
    v_mul_f32 v121, s38, v121
    v_mul_f32 v124, s38, v124
    v_mul_f32 v125, s38, v125
    v_mul_f32_e64 v114, -v114, v112
    v_mul_f32_e64 v115, -v115, v113
    v_mul_f32_e64 v118, -v118, v116
    v_mul_f32_e64 v119, -v119, v117
    v_mul_f32_e64 v122, -v122, v120
    v_mul_f32_e64 v123, -v123, v121
    v_mul_f32_e64 v126, -v126, v124
    v_mul_f32_e64 v127, -v127, v125
    v_mul_f32_e64 v94, -v94, v92
    v_mul_f32_e64 v95, -v95, v93
    s_mul_i32 s57, s25, 3584
    v_add_u32 v36, s57, v36
    s_add_u32 s57, s57, 147584
    v_lshrrev_b32 v37, 4, v25
    v_mul_u32_u24 v37, 1792, v37
    v_lshl_add_u32 v37, v26, 4, v37
    v_add_u32 v37, s57, v37
    s_mov_b32 exec_hi, 0xffff
    ds_write_b128 v36, v[112:115] offset:0
    ds_write_b128 v36, v[116:119] offset:384
    ds_write_b128 v36, v[120:123] offset:1792
    ds_write_b128 v36, v[124:127] offset:2176
    s_mov_b32 exec_hi, 0
    ds_write_b128 v37, v[92:95] offset:1536
    s_mov_b32 exec_hi, -1
    v_add_u32 v10, 1792, v10
    s_lshl_b32 s57, s25, 6
    s_add_u32 s57, s57, 150912
    v_mov_b32 v23, s57
    v_bfe_u32 v53, v8, 4, 6
    v_lshlrev_b32 v53, 2, v53
    s_mov_b32 s39, 200
    s_waitcnt lgkmcnt(0)
    s_sub_u32 s72, s72, s92
    s_sub_u32 s73, s73, s92
    s_sub_u32 s74, s74, s92
    s_sub_u32 s75, s75, s92
    s_sub_u32 s76, s76, s92
    s_sub_u32 s77, s77, s92
    s_sub_u32 s78, s78, s92
    s_sub_u32 s79, s79, s92
    s_max_u32 s72, s72, s73
    s_max_u32 s72, s72, s74
    s_max_u32 s72, s72, s75
    s_max_u32 s72, s72, s76
    s_max_u32 s72, s72, s77
    s_max_u32 s72, s72, s78
    s_max_u32 s72, s72, s79
    s_cmp_lt_u32 s72, 16
    s_cbranch_scc1 L_pollokP
L_pollretry:
    s_buffer_load_dwordx8 s[48:55], s[20:23], 0 glc
    s_waitcnt lgkmcnt(0)
    s_sub_u32 s48, s48, s92
    s_sub_u32 s49, s49, s92
    s_sub_u32 s50, s50, s92
    s_sub_u32 s51, s51, s92
    s_sub_u32 s52, s52, s92
    s_sub_u32 s53, s53, s92
    s_sub_u32 s54, s54, s92
    s_sub_u32 s55, s55, s92
    s_max_u32 s48, s48, s49
    s_max_u32 s48, s48, s50
    s_max_u32 s48, s48, s51
    s_max_u32 s48, s48, s52
    s_max_u32 s48, s48, s53
    s_max_u32 s48, s48, s54
    s_max_u32 s48, s48, s55
    s_cmp_lt_u32 s48, 16
    s_cbranch_scc1 L_pollokP
    s_sub_u32 s39, s39, 1
    s_cbranch_scc1 L_pollslowP
    s_sleep 1
    s_branch L_pollretry
L_pollokP:
    s_add_u32 s92, s92, 1
    s_mov_b32 m0, s26
    s_nop 0
    buffer_load_dwordx4 v8, s[4:7], s32 offen offset:0 sc1 lds
    buffer_load_dwordx4 v8, s[4:7], s32 offen offset:1024 sc1 lds
    buffer_load_dwordx4 v8, s[4:7], s32 offen offset:2048 sc1 lds
    s_add_u32 s32, s32, 24576
    s_sub_u32 s57, s32, 196608
    s_min_u32 s32, s32, s57
    s_add_u32 s26, s26, 36864
    s_sub_u32 s57, s26, 147456
    s_min_u32 s26, s26, s57
    v_xor_b32 v17, 32, v0
    v_xor_b32 v18, 64, v0
    v_xor_b32 v19, 96, v0
    s_waitcnt vmcnt(7)
    ds_read_b64 a[216:217], v0 offset:24576
    ds_read_b64 a[218:219], v18 offset:24704
    ds_read_b64 a[220:221], v17 offset:24576
    ds_read_b64 a[222:223], v19 offset:24704
    ds_read_b64 a[224:225], v18 offset:24576
    ds_read_b64 a[226:227], v0 offset:24832
    ds_read_b64 a[228:229], v19 offset:24576
    ds_read_b64 a[230:231], v17 offset:24832
    ds_read_b64 a[232:233], v0 offset:24704
    ds_read_b64 a[234:235], v18 offset:24832
    ds_read_b64 a[236:237], v17 offset:24704
    ds_read_b64 a[238:239], v19 offset:24832
    s_waitcnt lgkmcnt(0)
    v_mfma_f32_16x16x32_bf16 v[68:71], v[144:147], a[216:219], 0
    v_mfma_f32_16x16x32_bf16 v[68:71], v[148:151], a[220:223], v[68:71]
    v_mfma_f32_16x16x32_bf16 v[68:71], v[160:163], a[224:227], v[68:71]
    v_mfma_f32_16x16x32_bf16 v[68:71], v[164:167], a[228:231], v[68:71]
    v_mfma_f32_16x16x32_bf16 v[68:71], v[176:179], a[232:235], v[68:71]
    v_mfma_f32_16x16x32_bf16 v[68:71], v[180:183], a[236:239], v[68:71]
    v_mfma_f32_16x16x32_bf16 v[100:103], v[152:155], a[216:219], 0
    v_mfma_f32_16x16x32_bf16 v[100:103], v[156:159], a[220:223], v[100:103]
    v_mfma_f32_16x16x32_bf16 v[100:103], v[168:171], a[224:227], v[100:103]
    v_mfma_f32_16x16x32_bf16 v[100:103], v[172:175], a[228:231], v[100:103]
    v_mfma_f32_16x16x32_bf16 v[100:103], v[184:187], a[232:235], v[100:103]
    v_mfma_f32_16x16x32_bf16 v[100:103], v[188:191], a[236:239], v[100:103]
    s_nop 7
    s_mov_b32 m0, s26
    s_nop 0
    buffer_load_dwordx4 v8, s[4:7], s32 offen offset:0 sc1 lds
    buffer_load_dwordx4 v8, s[4:7], s32 offen offset:1024 sc1 lds
    buffer_load_dwordx4 v8, s[4:7], s32 offen offset:2048 sc1 lds
    s_add_u32 s32, s32, 24576
    s_sub_u32 s57, s32, 196608
    s_min_u32 s32, s32, s57
    s_add_u32 s26, s26, 12288
    v_max3_f32 v48, v68, v69, v70
    v_max3_f32 v48, v48, v71, v100
    v_max3_f32 v48, v48, v101, v102
    v_max_f32 v48, v48, v103
    v_mov_b32 v49, v48
    s_nop 1
    v_permlane16_swap_b32 v48, v49
    s_nop 1
    v_max_f32 v48, v48, v49
    v_mov_b32 v49, v48
    s_nop 1
    v_permlane32_swap_b32 v48, v49
    s_nop 1
    v_max_f32 v48, v48, v49
    v_sub_f32 v132, 0, v48
    s_mov_b32 m0, s26
    s_nop 0
    buffer_load_dwordx4 v8, s[4:7], s32 offen offset:0 sc1 lds
    buffer_load_dwordx4 v8, s[4:7], s32 offen offset:1024 sc1 lds
    buffer_load_dwordx4 v8, s[4:7], s32 offen offset:2048 sc1 lds
    s_add_u32 s32, s32, 24576
    s_sub_u32 s57, s32, 196608
    s_min_u32 s32, s32, s57
    s_add_u32 s26, s26, 36864
    s_sub_u32 s57, s26, 147456
    s_min_u32 s26, s26, s57
    v_sub_f32 v133, 0, v48
    v_sub_f32 v134, 0, v48
    v_sub_f32 v135, 0, v48
    v_sub_f32 v68, v68, v48
    v_sub_f32 v69, v69, v48
    v_sub_f32 v70, v70, v48
    v_sub_f32 v71, v71, v48
    v_sub_f32 v100, v100, v48
    v_sub_f32 v101, v101, v48
    v_sub_f32 v102, v102, v48
    v_sub_f32 v103, v103, v48
    v_exp_f32 v68, v68
    v_exp_f32 v69, v69
    v_exp_f32 v70, v70
    v_exp_f32 v71, v71
    s_mov_b32 m0, s56
    s_nop 0
    buffer_load_dwordx4 v8, s[4:7], s27 offen offset:0 sc1 lds
    buffer_load_dwordx4 v8, s[4:7], s27 offen offset:1024 sc1 lds
    buffer_load_dwordx4 v8, s[4:7], s27 offen offset:2048 sc1 lds
    s_add_u32 s27, s27, 24576
    s_sub_u32 s58, s27, 196608
    s_min_u32 s27, s27, s58
    s_add_u32 s56, s56, 36864
    s_sub_u32 s58, s56, 147456
    s_min_u32 s56, s56, s58
    v_exp_f32 v100, v100
    v_exp_f32 v101, v101
    v_exp_f32 v102, v102
    v_exp_f32 v103, v103
    v_add_f32 v5, v5, v68
    v_add_f32 v5, v5, v69
    v_add_f32 v5, v5, v70
    v_add_f32 v5, v5, v71
    v_add_f32 v5, v5, v100
    v_add_f32 v5, v5, v101
    v_add_f32 v5, v5, v102
    v_add_f32 v5, v5, v103
    v_cvt_pk_bf16_f32 v68, v68, v69
    v_cvt_pk_bf16_f32 v69, v70, v71
    v_cvt_pk_bf16_f32 v70, v100, v101
    v_cvt_pk_bf16_f32 v71, v102, v103
    s_waitcnt vmcnt(9)
    s_waitcnt lgkmcnt(0)
    s_barrier
    ds_read_b128 v[24:27], v2 offset:12288
    ds_read_b128 v[28:31], v3 offset:12288
    ds_read_b128 v[32:35], v2 offset:18432
    ds_read_b128 v[36:39], v3 offset:18432
    s_waitcnt lgkmcnt(2)
    v_mfma_f32_16x16x32_bf16 v[80:83], v[24:27], a[192:195], v[128:131]
    ds_read_b128 v[40:43], v2 offset:12416
    v_mfma_f32_16x16x32_bf16 v[80:83], v[28:31], a[196:199], v[80:83]
    s_add_u32 m0, s82, 53248
    s_movk_i32 s24, 12288
    buffer_load_dwordx4 v212, s[8:11], s24 offen nt lds
    v_mfma_f32_16x16x32_bf16 v[84:87], v[24:27], a[216:219], v[132:135]
    ds_read_b128 v[44:47], v3 offset:12416
    v_mfma_f32_16x16x32_bf16 v[84:87], v[28:31], a[220:223], v[84:87]
    s_waitcnt lgkmcnt(2)
    v_mfma_f32_16x16x32_bf16 v[112:115], v[32:35], a[192:195], v[128:131]
    ds_read_b128 v[24:27], v2 offset:18560
    v_mfma_f32_16x16x32_bf16 v[112:115], v[36:39], a[196:199], v[112:115]
    s_add_u32 m0, s82, 54272
    s_movk_i32 s24, 12288
    buffer_load_dwordx4 v213, s[8:11], s24 offen nt lds
    v_mfma_f32_16x16x32_bf16 v[116:119], v[32:35], a[216:219], v[132:135]
    ds_read_b128 v[28:31], v3 offset:18560
    v_mfma_f32_16x16x32_bf16 v[116:119], v[36:39], a[220:223], v[116:119]
    s_waitcnt lgkmcnt(2)
    v_mfma_f32_16x16x32_bf16 v[80:83], v[40:43], a[200:203], v[80:83]
    ds_read_b128 v[32:35], v2 offset:12544
    v_mfma_f32_16x16x32_bf16 v[80:83], v[44:47], a[204:207], v[80:83]
    s_add_u32 m0, s82, 24576
    s_movk_i32 s24, 18432
    buffer_load_dwordx4 v208, s[8:11], s24 offen nt lds
    v_mfma_f32_16x16x32_bf16 v[84:87], v[40:43], a[224:227], v[84:87]
    ds_read_b128 v[36:39], v3 offset:12544
    v_mfma_f32_16x16x32_bf16 v[84:87], v[44:47], a[228:231], v[84:87]
    s_waitcnt lgkmcnt(2)
    v_mfma_f32_16x16x32_bf16 v[112:115], v[24:27], a[200:203], v[112:115]
    ds_read_b128 v[40:43], v2 offset:18688
    v_mfma_f32_16x16x32_bf16 v[112:115], v[28:31], a[204:207], v[112:115]
    s_waitcnt vmcnt(6)
    s_barrier
    v_mfma_f32_16x16x32_bf16 v[116:119], v[24:27], a[224:227], v[116:119]
    ds_read_b128 v[44:47], v3 offset:18688
    v_mfma_f32_16x16x32_bf16 v[116:119], v[28:31], a[228:231], v[116:119]
    s_waitcnt lgkmcnt(2)
    v_mfma_f32_16x16x32_bf16 v[80:83], v[32:35], a[208:211], v[80:83]
    v_add_u32 v2, 49152, v2
    v_add_u32 v3, 49152, v3
    ds_read_b128 v[24:27], v2 offset:0
    v_mfma_f32_16x16x32_bf16 v[80:83], v[36:39], a[212:215], v[80:83]
    s_add_u32 m0, s82, 25600
    s_movk_i32 s24, 18432
    buffer_load_dwordx4 v209, s[8:11], s24 offen nt lds
    v_mfma_f32_16x16x32_bf16 v[84:87], v[32:35], a[232:235], v[84:87]
    ds_read_b128 v[28:31], v3 offset:0
    v_mfma_f32_16x16x32_bf16 v[84:87], v[36:39], a[236:239], v[84:87]
    s_waitcnt lgkmcnt(2)
    v_mfma_f32_16x16x32_bf16 v[112:115], v[40:43], a[208:211], v[112:115]
    ds_read_b128 v[32:35], v2 offset:6144
    v_mfma_f32_16x16x32_bf16 v[112:115], v[44:47], a[212:215], v[112:115]
    s_add_u32 m0, s82, 26624
    s_movk_i32 s24, 18432
    buffer_load_dwordx4 v210, s[8:11], s24 offen nt lds
    v_mfma_f32_16x16x32_bf16 v[116:119], v[40:43], a[232:235], v[116:119]
    ds_read_b128 v[36:39], v3 offset:6144
    v_mfma_f32_16x16x32_bf16 v[116:119], v[44:47], a[236:239], v[116:119]
    s_waitcnt lgkmcnt(2)
    v_mfma_f32_16x16x32_bf16 v[160:163], v[24:27], a[192:195], v[128:131]
    ds_read_b128 v[40:43], v2 offset:128
    v_mfma_f32_16x16x32_bf16 v[160:163], v[28:31], a[196:199], v[160:163]
    s_add_u32 m0, s82, 27648
    s_movk_i32 s24, 18432
    buffer_load_dwordx4 v211, s[8:11], s24 offen nt lds
    v_exp_f32 v16, v80
    v_mfma_f32_16x16x32_bf16 v[164:167], v[24:27], a[216:219], v[132:135]
    ds_read_b128 v[44:47], v3 offset:128
    v_mfma_f32_16x16x32_bf16 v[164:167], v[28:31], a[220:223], v[164:167]
    s_waitcnt lgkmcnt(2)
    v_exp_f32 v17, v81
    v_exp_f32 v18, v82
    v_add_f32 v4, v4, v16
    v_mfma_f32_16x16x32_bf16 v[96:99], v[32:35], a[192:195], v[128:131]
    ds_read_b128 v[24:27], v2 offset:6272
    v_add_f32 v4, v4, v17
    v_mfma_f32_16x16x32_bf16 v[96:99], v[36:39], a[196:199], v[96:99]
    s_add_u32 m0, s82, 28672
    s_movk_i32 s24, 18432
    buffer_load_dwordx4 v212, s[8:11], s24 offen nt lds
    v_exp_f32 v19, v83
    v_mfma_f32_16x16x32_bf16 v[100:103], v[32:35], a[216:219], v[132:135]
    ds_read_b128 v[28:31], v3 offset:6272
    v_cvt_pk_bf16_f32 v80, v16, v17
    v_mfma_f32_16x16x32_bf16 v[100:103], v[36:39], a[220:223], v[100:103]
    s_waitcnt lgkmcnt(2)
    v_exp_f32 v16, v112
    v_add_f32 v4, v4, v18
    v_add_f32 v4, v4, v19
    v_mfma_f32_16x16x32_bf16 v[160:163], v[40:43], a[200:203], v[160:163]
    ds_read_b128 v[32:35], v2 offset:256
    v_mfma_f32_16x16x32_bf16 v[160:163], v[44:47], a[204:207], v[160:163]
    s_add_u32 m0, s82, 29696
    s_movk_i32 s24, 18432
    buffer_load_dwordx4 v213, s[8:11], s24 offen nt lds
    v_exp_f32 v17, v113
    v_mfma_f32_16x16x32_bf16 v[164:167], v[40:43], a[224:227], v[164:167]
    ds_read_b128 v[36:39], v3 offset:256
    v_cvt_pk_bf16_f32 v81, v18, v19
    v_mfma_f32_16x16x32_bf16 v[164:167], v[44:47], a[228:231], v[164:167]
    s_waitcnt lgkmcnt(2)
    v_exp_f32 v18, v114
    v_add_f32 v4, v4, v16
    v_add_f32 v4, v4, v17
    v_mfma_f32_16x16x32_bf16 v[96:99], v[24:27], a[200:203], v[96:99]
    ds_read_b128 v[40:43], v2 offset:6400
    v_mfma_f32_16x16x32_bf16 v[96:99], v[28:31], a[204:207], v[96:99]
    s_mov_b32 m0, s56
    v_exp_f32 v19, v115
    v_cvt_pk_bf16_f32 v82, v16, v17
    v_exp_f32 v16, v84
    v_mfma_f32_16x16x32_bf16 v[100:103], v[24:27], a[224:227], v[100:103]
    ds_read_b128 v[44:47], v3 offset:6400
    v_add_f32 v4, v4, v18
    v_mfma_f32_16x16x32_bf16 v[100:103], v[28:31], a[228:231], v[100:103]
    s_waitcnt lgkmcnt(2)
    v_add_f32 v4, v4, v19
    v_exp_f32 v17, v85
    v_cvt_pk_bf16_f32 v83, v18, v19
    v_mfma_f32_16x16x32_bf16 v[160:163], v[32:35], a[208:211], v[160:163]
    ds_read_b128 v[24:27], v2 offset:12288
    v_mfma_f32_16x16x32_bf16 v[160:163], v[36:39], a[212:215], v[160:163]
    buffer_load_dwordx4 v8, s[4:7], s27 offen offset:0 sc1 lds
    v_exp_f32 v18, v86
    v_add_f32 v5, v5, v16
    v_mfma_f32_16x16x32_bf16 v[164:167], v[32:35], a[232:235], v[164:167]
    ds_read_b128 v[28:31], v3 offset:12288
    v_add_f32 v5, v5, v17
    v_mfma_f32_16x16x32_bf16 v[164:167], v[36:39], a[236:239], v[164:167]
    s_waitcnt lgkmcnt(2)
    v_exp_f32 v19, v87
    v_cvt_pk_bf16_f32 v84, v16, v17
    v_exp_f32 v16, v116
    v_mfma_f32_16x16x32_bf16 v[96:99], v[40:43], a[208:211], v[96:99]
    ds_read_b128 v[32:35], v2 offset:18432
    v_add_f32 v5, v5, v18
    v_mfma_f32_16x16x32_bf16 v[96:99], v[44:47], a[212:215], v[96:99]
    buffer_load_dwordx4 v8, s[4:7], s27 offen offset:1024 sc1 lds
    v_add_f32 v5, v5, v19
    v_exp_f32 v17, v117
    v_mfma_f32_16x16x32_bf16 v[100:103], v[40:43], a[232:235], v[100:103]
    ds_read_b128 v[36:39], v3 offset:18432
    v_cvt_pk_bf16_f32 v85, v18, v19
    v_mfma_f32_16x16x32_bf16 v[100:103], v[44:47], a[236:239], v[100:103]
    s_waitcnt lgkmcnt(2)
    v_exp_f32 v18, v118
    v_add_f32 v5, v5, v16
    v_add_f32 v5, v5, v17
    v_mfma_f32_16x16x32_bf16 v[176:179], v[24:27], a[192:195], v[128:131]
    ds_read_b128 v[40:43], v2 offset:12416
    v_mfma_f32_16x16x32_bf16 v[176:179], v[28:31], a[196:199], v[176:179]
    buffer_load_dwordx4 v8, s[4:7], s27 offen offset:2048 sc1 lds
    v_exp_f32 v19, v119
    v_cvt_pk_bf16_f32 v86, v16, v17
    v_mfma_f32_16x16x32_bf16 v[180:183], v[24:27], a[216:219], v[132:135]
    ds_read_b128 v[44:47], v3 offset:12416
    v_add_f32 v5, v5, v18
    v_mfma_f32_16x16x32_bf16 v[180:183], v[28:31], a[220:223], v[180:183]
    s_waitcnt lgkmcnt(2)
    v_add_f32 v5, v5, v19
    v_cvt_pk_bf16_f32 v87, v18, v19
    v_mfma_f32_16x16x32_bf16 v[120:123], v[32:35], a[192:195], v[128:131]
    ds_read_b128 v[24:27], v2 offset:18560
    v_mfma_f32_16x16x32_bf16 v[120:123], v[36:39], a[196:199], v[120:123]
    s_add_u32 s27, s27, 24576
    s_sub_u32 s58, s27, 196608
    s_min_u32 s27, s27, s58
    v_exp_f32 v16, v160
    v_mfma_f32_16x16x32_bf16 v[124:127], v[32:35], a[216:219], v[132:135]
    ds_read_b128 v[28:31], v3 offset:18560
    v_mfma_f32_16x16x32_bf16 v[124:127], v[36:39], a[220:223], v[124:127]
    s_waitcnt lgkmcnt(2)
    v_exp_f32 v17, v161
    v_exp_f32 v18, v162
    v_add_f32 v4, v4, v16
    v_mfma_f32_16x16x32_bf16 v[176:179], v[40:43], a[200:203], v[176:179]
    ds_read_b128 v[32:35], v2 offset:12544
    v_add_f32 v4, v4, v17
    v_mfma_f32_16x16x32_bf16 v[176:179], v[44:47], a[204:207], v[176:179]
    s_add_u32 s56, s56, 12288
    v_exp_f32 v19, v163
    v_cvt_pk_bf16_f32 v160, v16, v17
    v_exp_f32 v16, v96
    v_mfma_f32_16x16x32_bf16 v[180:183], v[40:43], a[224:227], v[180:183]
    ds_read_b128 v[36:39], v3 offset:12544
    v_add_f32 v4, v4, v18
    v_mfma_f32_16x16x32_bf16 v[180:183], v[44:47], a[228:231], v[180:183]
    s_waitcnt lgkmcnt(2)
    v_add_f32 v4, v4, v19
    v_exp_f32 v17, v97
    v_cvt_pk_bf16_f32 v161, v18, v19
    v_mfma_f32_16x16x32_bf16 v[120:123], v[24:27], a[200:203], v[120:123]
    ds_read_b128 v[40:43], v2 offset:18688
    v_mfma_f32_16x16x32_bf16 v[120:123], v[28:31], a[204:207], v[120:123]
    s_waitcnt vmcnt(11)
    s_barrier
    v_exp_f32 v18, v98
    v_add_f32 v4, v4, v16
    v_mfma_f32_16x16x32_bf16 v[124:127], v[24:27], a[224:227], v[124:127]
    ds_read_b128 v[44:47], v3 offset:18688
    v_add_f32 v4, v4, v17
    v_mfma_f32_16x16x32_bf16 v[124:127], v[28:31], a[228:231], v[124:127]
    s_waitcnt lgkmcnt(2)
    v_exp_f32 v19, v99
    v_cvt_pk_bf16_f32 v162, v16, v17
    v_exp_f32 v16, v164
    v_mfma_f32_16x16x32_bf16 v[176:179], v[32:35], a[208:211], v[176:179]
    ds_read_b128 v[24:27], v1 offset:0
    v_add_f32 v4, v4, v18
    v_mfma_f32_16x16x32_bf16 v[176:179], v[36:39], a[212:215], v[176:179]
    s_mov_b32 m0, s56
    v_add_f32 v4, v4, v19
    v_exp_f32 v17, v165
    v_cvt_pk_bf16_f32 v163, v18, v19
    v_mfma_f32_16x16x32_bf16 v[180:183], v[32:35], a[232:235], v[180:183]
    ds_read_b128 v[28:31], v1 offset:12288
    v_mfma_f32_16x16x32_bf16 v[180:183], v[36:39], a[236:239], v[180:183]
    s_waitcnt lgkmcnt(2)
    v_exp_f32 v18, v166
    v_add_f32 v5, v5, v16
    v_add_f32 v5, v5, v17
    v_mfma_f32_16x16x32_bf16 v[120:123], v[40:43], a[208:211], v[120:123]
    ds_read_b128 v[32:35], v1 offset:768
    v_mfma_f32_16x16x32_bf16 v[120:123], v[44:47], a[212:215], v[120:123]
    buffer_load_dwordx4 v8, s[4:7], s27 offen offset:0 sc1 lds
    v_exp_f32 v19, v167
    v_cvt_pk_bf16_f32 v164, v16, v17
    v_mfma_f32_16x16x32_bf16 v[124:127], v[40:43], a[232:235], v[124:127]
    ds_read_b128 v[36:39], v1 offset:13056
    v_mfma_f32_16x16x32_bf16 v[124:127], v[44:47], a[236:239], v[124:127]
    s_waitcnt lgkmcnt(2)
    v_exp_f32 v16, v100
    v_add_f32 v5, v5, v18
    v_add_f32 v5, v5, v19
    v_mfma_f32_16x16x32_bf16 a[0:3], v[64:67], v[24:27], 0
    ds_read_b128 v[40:43], v1 offset:1536
    v_mfma_f32_16x16x32_bf16 a[0:3], v[80:83], v[28:31], a[0:3]
    buffer_load_dwordx4 v8, s[4:7], s27 offen offset:1024 sc1 lds
    v_exp_f32 v17, v101
    v_cvt_pk_bf16_f32 v165, v18, v19
    v_mfma_f32_16x16x32_bf16 a[48:51], v[68:71], v[24:27], 0
    ds_read_b128 v[44:47], v1 offset:13824
    v_mfma_f32_16x16x32_bf16 a[48:51], v[84:87], v[28:31], a[48:51]
    s_waitcnt lgkmcnt(2)
    v_exp_f32 v18, v102
    v_add_f32 v5, v5, v16
    v_add_f32 v5, v5, v17
    v_mfma_f32_16x16x32_bf16 a[4:7], v[64:67], v[32:35], 0
    ds_read_b128 v[24:27], v1 offset:2304
    v_mfma_f32_16x16x32_bf16 a[4:7], v[80:83], v[36:39], a[4:7]
    buffer_load_dwordx4 v8, s[4:7], s27 offen offset:2048 sc1 lds
    v_exp_f32 v19, v103
    v_cvt_pk_bf16_f32 v166, v16, v17
    s_branch L_skip1
L_pad1:
    s_branch L_tb1_13
L_skip1:
    v_mfma_f32_16x16x32_bf16 a[52:55], v[68:71], v[32:35], 0
    ds_read_b128 v[28:31], v1 offset:14592
    v_add_f32 v5, v5, v18
    v_mfma_f32_16x16x32_bf16 a[52:55], v[84:87], v[36:39], a[52:55]
    s_waitcnt lgkmcnt(2)
    v_add_f32 v5, v5, v19
    v_cvt_pk_bf16_f32 v167, v18, v19
    v_exp_f32 v16, v176
    v_mfma_f32_16x16x32_bf16 a[8:11], v[64:67], v[40:43], 0
    ds_read_b128 v[32:35], v21 offset:0
    v_mfma_f32_16x16x32_bf16 a[8:11], v[80:83], v[44:47], a[8:11]
    s_add_u32 s27, s27, 24576
    s_sub_u32 s58, s27, 196608
    s_min_u32 s27, s27, s58
    v_exp_f32 v17, v177
    v_mfma_f32_16x16x32_bf16 a[56:59], v[68:71], v[40:43], 0
    ds_read_b128 v[36:39], v21 offset:12288
    v_mfma_f32_16x16x32_bf16 a[56:59], v[84:87], v[44:47], a[56:59]
    s_waitcnt lgkmcnt(2)
    v_exp_f32 v18, v178
    v_add_f32 v4, v4, v16
    v_add_f32 v4, v4, v17
    v_mfma_f32_16x16x32_bf16 a[12:15], v[64:67], v[24:27], 0
    ds_read_b128 v[40:43], v21 offset:768
    v_mfma_f32_16x16x32_bf16 a[12:15], v[80:83], v[28:31], a[12:15]
    s_add_u32 s56, s56, 36864
    s_sub_u32 s58, s56, 147456
    s_min_u32 s56, s56, s58
    v_exp_f32 v19, v179
    v_cvt_pk_bf16_f32 v176, v16, v17
    v_mfma_f32_16x16x32_bf16 a[60:63], v[68:71], v[24:27], 0
    ds_read_b128 v[44:47], v21 offset:13056
    v_mfma_f32_16x16x32_bf16 a[60:63], v[84:87], v[28:31], a[60:63]
    s_waitcnt lgkmcnt(2)
    v_exp_f32 v16, v120
    v_add_f32 v4, v4, v18
    v_add_f32 v4, v4, v19
    v_mfma_f32_16x16x32_bf16 a[16:19], v[64:67], v[32:35], 0
    ds_read_b128 v[24:27], v21 offset:1536
    v_mfma_f32_16x16x32_bf16 a[16:19], v[80:83], v[36:39], a[16:19]
    buffer_load_dwordx4 v[224:227], v9, s[64:67], s33 offen offset:0 nt
    v_exp_f32 v17, v121
    v_cvt_pk_bf16_f32 v177, v18, v19
    v_mfma_f32_16x16x32_bf16 a[64:67], v[68:71], v[32:35], 0
    ds_read_b128 v[28:31], v21 offset:13824
    v_mfma_f32_16x16x32_bf16 a[64:67], v[84:87], v[36:39], a[64:67]
    s_waitcnt lgkmcnt(2)
    v_exp_f32 v18, v122
    v_add_f32 v4, v4, v16
    v_add_f32 v4, v4, v17
    v_mfma_f32_16x16x32_bf16 a[20:23], v[64:67], v[40:43], 0
    ds_read_b128 v[32:35], v21 offset:2304
    v_mfma_f32_16x16x32_bf16 a[20:23], v[80:83], v[44:47], a[20:23]
    buffer_load_dwordx4 v[228:231], v9, s[64:67], s33 offen offset:1536 nt
    v_exp_f32 v19, v123
    v_cvt_pk_bf16_f32 v178, v16, v17
    v_mfma_f32_16x16x32_bf16 a[68:71], v[68:71], v[40:43], 0
    ds_read_b128 v[36:39], v21 offset:14592
    v_mfma_f32_16x16x32_bf16 a[68:71], v[84:87], v[44:47], a[68:71]
    s_waitcnt lgkmcnt(2)
    v_exp_f32 v16, v180
    v_add_f32 v4, v4, v18
    v_add_f32 v4, v4, v19
    v_mfma_f32_16x16x32_bf16 a[24:27], v[64:67], v[24:27], 0
    ds_read_b128 v[40:43], v22 offset:0
    v_mfma_f32_16x16x32_bf16 a[24:27], v[80:83], v[28:31], a[24:27]
    buffer_load_dwordx4 v[232:235], v9, s[64:67], s34 offen offset:0 nt
    v_exp_f32 v17, v181
    v_cvt_pk_bf16_f32 v179, v18, v19
    v_mfma_f32_16x16x32_bf16 a[72:75], v[68:71], v[24:27], 0
    ds_read_b128 v[44:47], v22 offset:12288
    v_mfma_f32_16x16x32_bf16 a[72:75], v[84:87], v[28:31], a[72:75]
    s_waitcnt lgkmcnt(2)
    v_exp_f32 v18, v182
    v_add_f32 v5, v5, v16
    v_add_f32 v5, v5, v17
    v_mfma_f32_16x16x32_bf16 a[28:31], v[64:67], v[32:35], 0
    ds_read_b128 v[24:27], v22 offset:768
    v_mfma_f32_16x16x32_bf16 a[28:31], v[80:83], v[36:39], a[28:31]
    buffer_load_dwordx4 v[236:239], v9, s[64:67], s34 offen offset:1536 nt
    v_exp_f32 v19, v183
    v_cvt_pk_bf16_f32 v180, v16, v17
    v_mfma_f32_16x16x32_bf16 a[76:79], v[68:71], v[32:35], 0
    ds_read_b128 v[28:31], v22 offset:13056
    v_mfma_f32_16x16x32_bf16 a[76:79], v[84:87], v[36:39], a[76:79]
    s_waitcnt lgkmcnt(2)
    v_exp_f32 v16, v124
    v_add_f32 v5, v5, v18
    v_add_f32 v5, v5, v19
    v_mfma_f32_16x16x32_bf16 a[32:35], v[64:67], v[40:43], 0
    ds_read_b128 v[32:35], v22 offset:1536
    v_mfma_f32_16x16x32_bf16 a[32:35], v[80:83], v[44:47], a[32:35]
    buffer_load_dwordx4 v[240:243], v9, s[64:67], s33 offen offset:384 nt
    v_exp_f32 v17, v125
    v_cvt_pk_bf16_f32 v181, v18, v19
    v_mfma_f32_16x16x32_bf16 a[80:83], v[68:71], v[40:43], 0
    ds_read_b128 v[36:39], v22 offset:13824
    v_mfma_f32_16x16x32_bf16 a[80:83], v[84:87], v[44:47], a[80:83]
    s_waitcnt lgkmcnt(2)
    v_exp_f32 v18, v126
    v_add_f32 v5, v5, v16
    v_add_f32 v5, v5, v17
    v_mfma_f32_16x16x32_bf16 a[36:39], v[64:67], v[24:27], 0
    ds_read_b128 v[40:43], v22 offset:2304
    v_mfma_f32_16x16x32_bf16 a[36:39], v[80:83], v[28:31], a[36:39]
    buffer_load_dwordx4 v[244:247], v9, s[64:67], s33 offen offset:1920 nt
    v_exp_f32 v19, v127
    v_cvt_pk_bf16_f32 v182, v16, v17
    v_mfma_f32_16x16x32_bf16 a[84:87], v[68:71], v[24:27], 0
    ds_read_b128 v[44:47], v22 offset:14592
    v_add_f32 v5, v5, v18
    v_mfma_f32_16x16x32_bf16 a[84:87], v[84:87], v[28:31], a[84:87]
    s_waitcnt lgkmcnt(2)
    v_add_f32 v5, v5, v19
    v_cvt_pk_bf16_f32 v183, v18, v19
    v_mfma_f32_16x16x32_bf16 a[40:43], v[64:67], v[32:35], 0
    v_add_u32 v2, 4294918144, v2
    v_add_u32 v3, 4294918144, v3
    ds_read_b128 v[24:27], v2 offset:0
    v_mfma_f32_16x16x32_bf16 a[40:43], v[80:83], v[36:39], a[40:43]
    v_mfma_f32_16x16x32_bf16 a[88:91], v[68:71], v[32:35], 0
    ds_read_b128 v[28:31], v3 offset:0
    v_mfma_f32_16x16x32_bf16 a[88:91], v[84:87], v[36:39], a[88:91]
    s_waitcnt lgkmcnt(2)
    v_mfma_f32_16x16x32_bf16 a[44:47], v[64:67], v[40:43], 0
    ds_read_b128 v[32:35], v2 offset:6144
    v_mfma_f32_16x16x32_bf16 a[44:47], v[80:83], v[44:47], a[44:47]
    v_mfma_f32_16x16x32_bf16 a[92:95], v[68:71], v[40:43], 0
    ds_read_b128 v[36:39], v3 offset:6144
    v_mfma_f32_16x16x32_bf16 a[92:95], v[84:87], v[44:47], a[92:95]
    s_waitcnt lgkmcnt(2)
    ds_read_b128 v[48:51], v10 offset:0
    v_xor_b32 v17, 32, v0
    v_xor_b32 v18, 64, v0
    v_xor_b32 v19, 96, v0
    s_waitcnt vmcnt(12)
    ds_read_b64 a[240:241], v0 offset:49152
    ds_read_b64 a[242:243], v18 offset:49280
    ds_read_b64 a[244:245], v17 offset:49152
    ds_read_b64 a[246:247], v19 offset:49280
    ds_read_b64 a[248:249], v18 offset:49152
    ds_read_b64 a[250:251], v0 offset:49408
    ds_read_b64 a[252:253], v19 offset:49152
    ds_read_b64 a[254:255], v17 offset:49408
    ds_read_b64 v[192:193], v0 offset:49280
    ds_read_b64 v[194:195], v18 offset:49408
    ds_read_b64 v[196:197], v17 offset:49280
    ds_read_b64 v[198:199], v19 offset:49408
    s_cmp_eq_u32 s25, 1
    s_cbranch_scc1 L_t2_1
    s_cmp_eq_u32 s25, 2
    s_cbranch_scc1 L_t2_2
    s_cmp_eq_u32 s25, 3
    s_cbranch_scc1 L_t2_3
L_t2_0:
    s_branch L_pad15
L_tb2_0:
    s_branch L_t2_end
L_t2_1:
    s_branch L_pad16
L_tb2_1:
    s_branch L_t2_end
L_t2_2:
    s_branch L_t2_end
L_t2_3:
L_t2_end:
    v_xor_b32 v17, 32, v0
    v_xor_b32 v18, 64, v0
    v_xor_b32 v19, 96, v0
    s_waitcnt vmcnt(6)
    ds_read_b64 v[200:201], v0 offset:24576
    ds_read_b64 v[202:203], v18 offset:24704
    ds_read_b64 v[204:205], v17 offset:24576
    ds_read_b64 v[206:207], v19 offset:24704
    ds_read_b64 v[208:209], v18 offset:24576
    ds_read_b64 v[210:211], v0 offset:24832
    ds_read_b64 v[212:213], v19 offset:24576
    ds_read_b64 v[214:215], v17 offset:24832
    ds_read_b64 v[216:217], v0 offset:24704
    ds_read_b64 v[218:219], v18 offset:24832
    ds_read_b64 v[220:221], v17 offset:24704
    ds_read_b64 v[222:223], v19 offset:24832
    s_waitcnt lgkmcnt(0)
    s_barrier
    v_mfma_f32_16x16x32_bf16 v[72:75], v[24:27], a[240:243], 0
    ds_read_b128 v[40:43], v2 offset:128
    ds_read_b128 v[56:59], v10 offset:384
    v_mfma_f32_16x16x32_bf16 v[72:75], v[28:31], a[244:247], v[72:75]
    s_mov_b32 m0, s26
    s_waitcnt vmcnt(4)
    v_cvt_f32_i32 v224, v224
    v_cvt_f32_i32 v225, v225
    v_cvt_f32_i32 v228, v228
    v_mfma_f32_16x16x32_bf16 v[76:79], v[24:27], v[200:203], 0
    ds_read_b128 v[44:47], v3 offset:128
    ds_read_b128 v[60:63], v10 offset:768
    v_mfma_f32_16x16x32_bf16 v[76:79], v[28:31], v[204:207], v[76:79]
    s_nop 0
    v_cvt_f32_i32 v229, v229
    v_fma_f32 v224, v224, v48, v50
    v_fma_f32 v225, v225, v49, v51
    v_fma_f32 v228, v228, v48, v50
    v_fma_f32 v229, v229, v49, v51
    v_mfma_f32_16x16x32_bf16 v[104:107], v[32:35], a[240:243], 0
    ds_read_b128 v[24:27], v2 offset:6272
    v_cvt_pk_bf16_f32 v224, v224, v225
    v_mfma_f32_16x16x32_bf16 v[104:107], v[36:39], a[244:247], v[104:107]
    buffer_load_dwordx4 v8, s[4:7], s32 offen offset:0 sc1 lds
    v_cvt_pk_bf16_f32 v228, v228, v229
    s_waitcnt lgkmcnt(3)
    v_cvt_f32_i32 v226, v226
    v_cvt_f32_i32 v227, v227
    v_mfma_f32_16x16x32_bf16 v[108:111], v[32:35], v[200:203], 0
    ds_read_b128 v[28:31], v3 offset:6272
    v_cvt_f32_i32 v230, v230
    v_mfma_f32_16x16x32_bf16 v[108:111], v[36:39], v[204:207], v[108:111]
    s_waitcnt lgkmcnt(3)
    v_cvt_f32_i32 v231, v231
    v_fma_f32 v226, v226, v56, v58
    v_fma_f32 v227, v227, v57, v59
    v_fma_f32 v230, v230, v56, v58
    v_fma_f32 v231, v231, v57, v59
    v_mfma_f32_16x16x32_bf16 v[72:75], v[40:43], a[248:251], v[72:75]
    ds_read_b128 v[32:35], v2 offset:256
    v_cvt_pk_bf16_f32 v225, v226, v227
    v_mfma_f32_16x16x32_bf16 v[72:75], v[44:47], a[252:255], v[72:75]
    buffer_load_dwordx4 v8, s[4:7], s32 offen offset:1024 sc1 lds
    v_cvt_pk_bf16_f32 v229, v230, v231
    v_mfma_f32_16x16x32_bf16 v[76:79], v[40:43], v[208:211], v[76:79]
    ds_read_b128 v[36:39], v3 offset:256
    v_mfma_f32_16x16x32_bf16 v[76:79], v[44:47], v[212:215], v[76:79]
    s_waitcnt lgkmcnt(2)
    v_mfma_f32_16x16x32_bf16 v[104:107], v[24:27], a[248:251], v[104:107]
    ds_read_b128 v[40:43], v2 offset:6400
    v_mfma_f32_16x16x32_bf16 v[104:107], v[28:31], a[252:255], v[104:107]
    buffer_load_dwordx4 v8, s[4:7], s32 offen offset:2048 sc1 lds
    v_mfma_f32_16x16x32_bf16 v[108:111], v[24:27], v[208:211], v[108:111]
    ds_read_b128 v[44:47], v3 offset:6400
    v_mfma_f32_16x16x32_bf16 v[108:111], v[28:31], v[212:215], v[108:111]
    s_waitcnt lgkmcnt(2)
    v_mfma_f32_16x16x32_bf16 v[72:75], v[32:35], v[192:195], v[72:75]
    ds_read_b128 v[24:27], v2 offset:12288
    v_mfma_f32_16x16x32_bf16 v[72:75], v[36:39], v[196:199], v[72:75]
    s_add_u32 s32, s32, 24576
    s_sub_u32 s57, s32, 196608
    s_min_u32 s32, s32, s57
    v_mfma_f32_16x16x32_bf16 v[76:79], v[32:35], v[216:219], v[76:79]
    ds_read_b128 v[28:31], v3 offset:12288
    v_mfma_f32_16x16x32_bf16 v[76:79], v[36:39], v[220:223], v[76:79]
    s_waitcnt lgkmcnt(2)
    v_mfma_f32_16x16x32_bf16 v[104:107], v[40:43], v[192:195], v[104:107]
    ds_read_b128 v[32:35], v2 offset:18432
    v_mfma_f32_16x16x32_bf16 v[104:107], v[44:47], v[196:199], v[104:107]
    s_add_u32 s26, s26, 12288
    v_mfma_f32_16x16x32_bf16 v[108:111], v[40:43], v[216:219], v[108:111]
    ds_read_b128 v[36:39], v3 offset:18432
    v_mfma_f32_16x16x32_bf16 v[108:111], v[44:47], v[220:223], v[108:111]
    s_waitcnt lgkmcnt(2)
    v_mfma_f32_16x16x32_bf16 v[88:91], v[24:27], a[240:243], 0
    ds_read_b128 v[40:43], v2 offset:12416
    v_mfma_f32_16x16x32_bf16 v[88:91], v[28:31], a[244:247], v[88:91]
    v_mfma_f32_16x16x32_bf16 v[92:95], v[24:27], v[200:203], 0
    ds_read_b128 v[44:47], v3 offset:12416
    v_mfma_f32_16x16x32_bf16 v[92:95], v[28:31], v[204:207], v[92:95]
    s_waitcnt lgkmcnt(2)
    v_mfma_f32_16x16x32_bf16 v[120:123], v[32:35], a[240:243], 0
    ds_read_b128 v[24:27], v2 offset:18560
    v_max3_f32 v16, v72, v73, v74
    v_mfma_f32_16x16x32_bf16 v[120:123], v[36:39], a[244:247], v[120:123]
    v_max3_f32 v18, v76, v77, v78
    v_max3_f32 v16, v16, v75, v104
    v_max3_f32 v18, v18, v79, v108
    v_max3_f32 v16, v16, v105, v106
    v_max3_f32 v18, v18, v109, v110
    v_mfma_f32_16x16x32_bf16 v[124:127], v[32:35], v[200:203], 0
    ds_read_b128 v[28:31], v3 offset:18560
    v_max_f32 v16, v16, v107
    v_mfma_f32_16x16x32_bf16 v[124:127], v[36:39], v[204:207], v[124:127]
    s_waitcnt lgkmcnt(2)
    v_max_f32 v18, v18, v111
    v_mov_b32 v17, v16
    v_mov_b32 v19, v18
    s_nop 0
    v_permlane16_swap_b32 v16, v17
    v_mfma_f32_16x16x32_bf16 v[88:91], v[40:43], a[248:251], v[88:91]
    ds_read_b128 v[32:35], v2 offset:12544
    v_permlane16_swap_b32 v18, v19
    v_mfma_f32_16x16x32_bf16 v[88:91], v[44:47], a[252:255], v[88:91]
    s_nop 0
    v_max_f32 v16, v16, v17
    v_max_f32 v18, v18, v19
    v_mov_b32 v17, v16
    v_mov_b32 v19, v18
    s_nop 0
    v_mfma_f32_16x16x32_bf16 v[92:95], v[40:43], v[208:211], v[92:95]
    ds_read_b128 v[36:39], v3 offset:12544
    v_permlane32_swap_b32 v16, v17
    v_mfma_f32_16x16x32_bf16 v[92:95], v[44:47], v[212:215], v[92:95]
    s_waitcnt lgkmcnt(2)
    v_permlane32_swap_b32 v18, v19
    s_nop 0
    v_max_f32 v16, v16, v17
    v_max_f32 v18, v18, v19
    v_sub_f32 v136, 0, v16
    v_mfma_f32_16x16x32_bf16 v[120:123], v[24:27], a[248:251], v[120:123]
    ds_read_b128 v[40:43], v2 offset:18688
    v_sub_f32 v137, 0, v16
    v_mfma_f32_16x16x32_bf16 v[120:123], v[28:31], a[252:255], v[120:123]
    s_waitcnt vmcnt(3)
    s_barrier
    v_sub_f32 v138, 0, v16
    v_sub_f32 v139, 0, v16
    v_sub_f32 v140, 0, v18
    v_mfma_f32_16x16x32_bf16 v[124:127], v[24:27], v[208:211], v[124:127]
    ds_read_b128 v[44:47], v3 offset:18688
    v_sub_f32 v141, 0, v18
    v_mfma_f32_16x16x32_bf16 v[124:127], v[28:31], v[212:215], v[124:127]
    s_waitcnt lgkmcnt(2)
    v_sub_f32 v142, 0, v18
    v_sub_f32 v143, 0, v18
    v_add_f32 v72, v72, v136
    v_add_f32 v73, v73, v136
    v_add_f32 v74, v74, v136
    v_mfma_f32_16x16x32_bf16 v[88:91], v[32:35], v[192:195], v[88:91]
    v_add_u32 v1, 49152, v1
    v_add_u32 v21, 49152, v21
    v_add_u32 v22, 49152, v22
    ds_read_b128 v[24:27], v1 offset:0
    v_mfma_f32_16x16x32_bf16 v[88:91], v[36:39], v[196:199], v[88:91]
    buffer_load_dwordx4 v[248:251], v9, s[64:67], s34 offen offset:384 nt
    v_add_f32 v75, v75, v136
    v_add_f32 v104, v104, v136
    v_add_f32 v105, v105, v136
    v_mfma_f32_16x16x32_bf16 v[92:95], v[32:35], v[216:219], v[92:95]
    ds_read_b128 v[28:31], v1 offset:12288
    v_add_f32 v106, v106, v136
    v_mfma_f32_16x16x32_bf16 v[92:95], v[36:39], v[220:223], v[92:95]
    s_waitcnt lgkmcnt(2)
    v_add_f32 v107, v107, v136
    v_add_f32 v76, v76, v140
    v_add_f32 v77, v77, v140
    v_add_f32 v78, v78, v140
    v_add_f32 v79, v79, v140
    v_mfma_f32_16x16x32_bf16 v[120:123], v[40:43], v[192:195], v[120:123]
    ds_read_b128 v[32:35], v1 offset:768
    v_add_f32 v108, v108, v140
    v_mfma_f32_16x16x32_bf16 v[120:123], v[44:47], v[196:199], v[120:123]
    buffer_load_dwordx4 v[252:255], v9, s[64:67], s34 offen offset:1920 nt
    v_add_f32 v109, v109, v140
    v_add_f32 v110, v110, v140
    v_add_f32 v111, v111, v140
    v_mfma_f32_16x16x32_bf16 v[124:127], v[40:43], v[216:219], v[124:127]
    ds_read_b128 v[36:39], v1 offset:13056
    v_mfma_f32_16x16x32_bf16 v[124:127], v[44:47], v[220:223], v[124:127]
    s_waitcnt lgkmcnt(2)
    v_exp_f32 v16, v72
    v_exp_f32 v17, v73
    v_mfma_f32_16x16x32_bf16 a[0:3], v[160:163], v[24:27], a[0:3]
    ds_read_b128 v[40:43], v1 offset:1536
    s_waitcnt vmcnt(7)
    v_mfma_f32_16x16x32_bf16 a[0:3], v[176:179], v[28:31], a[0:3]
    buffer_load_dwordx4 v[144:147], v12, s[68:71], s35 offen offset:0 nt
    v_exp_f32 v18, v74
    v_add_f32 v6, v6, v16
    v_add_f32 v6, v6, v17
    v_cvt_f32_i32 v232, v232
    v_mfma_f32_16x16x32_bf16 a[48:51], v[164:167], v[24:27], a[48:51]
    ds_read_b128 v[44:47], v1 offset:13824
    v_cvt_f32_i32 v233, v233
    v_mfma_f32_16x16x32_bf16 a[48:51], v[180:183], v[28:31], a[48:51]
    s_waitcnt lgkmcnt(2)
    v_exp_f32 v19, v75
    v_cvt_pk_bf16_f32 v72, v16, v17
    v_exp_f32 v16, v104
    v_add_f32 v6, v6, v18
    v_add_f32 v6, v6, v19
    v_mfma_f32_16x16x32_bf16 a[4:7], v[160:163], v[32:35], a[4:7]
    ds_read_b128 v[24:27], v1 offset:2304
    v_cvt_f32_i32 v236, v236
    v_mfma_f32_16x16x32_bf16 a[4:7], v[176:179], v[36:39], a[4:7]
    buffer_load_dwordx4 v[148:151], v12, s[68:71], s35 offen offset:768 nt
    v_exp_f32 v17, v105
    v_cvt_pk_bf16_f32 v73, v18, v19
    v_exp_f32 v18, v106
    v_mfma_f32_16x16x32_bf16 a[52:55], v[164:167], v[32:35], a[52:55]
    ds_read_b128 v[28:31], v1 offset:14592
    v_add_f32 v6, v6, v16
    v_mfma_f32_16x16x32_bf16 a[52:55], v[180:183], v[36:39], a[52:55]
    s_waitcnt lgkmcnt(2)
    v_add_f32 v6, v6, v17
    v_exp_f32 v19, v107
    v_cvt_pk_bf16_f32 v74, v16, v17
    v_exp_f32 v16, v76
    v_add_f32 v6, v6, v18
    v_mfma_f32_16x16x32_bf16 a[8:11], v[160:163], v[40:43], a[8:11]
    ds_read_b128 v[32:35], v21 offset:0
    v_add_f32 v6, v6, v19
    v_mfma_f32_16x16x32_bf16 a[8:11], v[176:179], v[44:47], a[8:11]
    buffer_load_dwordx4 v[152:155], v12, s[68:71], s35 offen offset:1536 nt
    v_exp_f32 v17, v77
    v_cvt_pk_bf16_f32 v75, v18, v19
    v_exp_f32 v18, v78
    v_mfma_f32_16x16x32_bf16 a[56:59], v[164:167], v[40:43], a[56:59]
    ds_read_b128 v[36:39], v21 offset:12288
    v_add_f32 v7, v7, v16
    v_mfma_f32_16x16x32_bf16 a[56:59], v[180:183], v[44:47], a[56:59]
    s_waitcnt lgkmcnt(2)
    v_add_f32 v7, v7, v17
    v_exp_f32 v19, v79
    v_cvt_pk_bf16_f32 v76, v16, v17
    v_exp_f32 v16, v108
    v_add_f32 v7, v7, v18
    v_mfma_f32_16x16x32_bf16 a[12:15], v[160:163], v[24:27], a[12:15]
    ds_read_b128 v[40:43], v21 offset:768
    v_add_f32 v7, v7, v19
    v_mfma_f32_16x16x32_bf16 a[12:15], v[176:179], v[28:31], a[12:15]
    buffer_load_dwordx4 v[156:159], v12, s[68:71], s35 offen offset:2304 nt
    v_exp_f32 v17, v109
    v_cvt_pk_bf16_f32 v77, v18, v19
    v_exp_f32 v18, v110
    v_mfma_f32_16x16x32_bf16 a[60:63], v[164:167], v[24:27], a[60:63]
    ds_read_b128 v[44:47], v21 offset:13056
    v_add_f32 v7, v7, v16
    v_mfma_f32_16x16x32_bf16 a[60:63], v[180:183], v[28:31], a[60:63]
    s_waitcnt lgkmcnt(2)
    v_add_f32 v7, v7, v17
    v_exp_f32 v19, v111
    v_cvt_pk_bf16_f32 v78, v16, v17
    v_add_f32 v7, v7, v18
    v_add_f32 v7, v7, v19
    v_cvt_pk_bf16_f32 v79, v18, v19
    v_mfma_f32_16x16x32_bf16 a[16:19], v[160:163], v[32:35], a[16:19]
    ds_read_b128 v[24:27], v21 offset:1536
    v_add_f32 v88, v88, v136
    v_mfma_f32_16x16x32_bf16 a[16:19], v[176:179], v[36:39], a[16:19]
    s_mov_b32 m0, s26
    v_add_f32 v89, v89, v136
    v_add_f32 v90, v90, v136
    v_add_f32 v91, v91, v136
    v_add_f32 v120, v120, v136
    v_add_f32 v121, v121, v136
    v_add_f32 v122, v122, v136
    v_add_f32 v123, v123, v136
    v_mfma_f32_16x16x32_bf16 a[64:67], v[164:167], v[32:35], a[64:67]
    ds_read_b128 v[28:31], v21 offset:13824
    v_add_f32 v92, v92, v140
    v_mfma_f32_16x16x32_bf16 a[64:67], v[180:183], v[36:39], a[64:67]
    s_waitcnt lgkmcnt(2)
    v_add_f32 v93, v93, v140
    v_add_f32 v94, v94, v140
    v_add_f32 v95, v95, v140
    v_add_f32 v124, v124, v140
    v_add_f32 v125, v125, v140
    v_add_f32 v126, v126, v140
    v_add_f32 v127, v127, v140
    v_mfma_f32_16x16x32_bf16 a[20:23], v[160:163], v[40:43], a[20:23]
    ds_read_b128 v[32:35], v21 offset:2304
    v_cvt_f32_i32 v237, v237
    v_mfma_f32_16x16x32_bf16 a[20:23], v[176:179], v[44:47], a[20:23]
    buffer_load_dwordx4 v8, s[4:7], s32 offen offset:0 sc1 lds
    v_exp_f32 v16, v88
    v_exp_f32 v17, v89
    v_fma_f32 v232, v232, v48, v50
    v_mfma_f32_16x16x32_bf16 a[68:71], v[164:167], v[40:43], a[68:71]
    ds_read_b128 v[36:39], v21 offset:14592
    v_fma_f32 v233, v233, v49, v51
    v_mfma_f32_16x16x32_bf16 a[68:71], v[180:183], v[44:47], a[68:71]
    s_waitcnt lgkmcnt(2)
    v_exp_f32 v18, v90
    v_add_f32 v6, v6, v16
    v_add_f32 v6, v6, v17
    v_exp_f32 v19, v91
    v_cvt_pk_bf16_f32 v88, v16, v17
    v_mfma_f32_16x16x32_bf16 a[24:27], v[160:163], v[24:27], a[24:27]
    ds_read_b128 v[40:43], v22 offset:0
    v_fma_f32 v236, v236, v48, v50
    v_mfma_f32_16x16x32_bf16 a[24:27], v[176:179], v[28:31], a[24:27]
    buffer_load_dwordx4 v8, s[4:7], s32 offen offset:1024 sc1 lds
    v_exp_f32 v16, v120
    v_add_f32 v6, v6, v18
    v_add_f32 v6, v6, v19
    v_fma_f32 v237, v237, v49, v51
    v_mfma_f32_16x16x32_bf16 a[72:75], v[164:167], v[24:27], a[72:75]
    ds_read_b128 v[44:47], v22 offset:12288
    v_cvt_pk_bf16_f32 v232, v232, v233
    v_mfma_f32_16x16x32_bf16 a[72:75], v[180:183], v[28:31], a[72:75]
    s_waitcnt lgkmcnt(2)
    v_exp_f32 v17, v121
    v_cvt_pk_bf16_f32 v89, v18, v19
    v_exp_f32 v18, v122
    v_add_f32 v6, v6, v16
    v_add_f32 v6, v6, v17
    v_mfma_f32_16x16x32_bf16 a[28:31], v[160:163], v[32:35], a[28:31]
    ds_read_b128 v[24:27], v22 offset:768
    v_cvt_pk_bf16_f32 v236, v236, v237
    v_mfma_f32_16x16x32_bf16 a[28:31], v[176:179], v[36:39], a[28:31]
    buffer_load_dwordx4 v8, s[4:7], s32 offen offset:2048 sc1 lds
    v_exp_f32 v19, v123
    v_cvt_pk_bf16_f32 v90, v16, v17
    v_exp_f32 v16, v92
    v_mfma_f32_16x16x32_bf16 a[76:79], v[164:167], v[32:35], a[76:79]
    ds_read_b128 v[28:31], v22 offset:13056
    v_add_f32 v6, v6, v18
    v_mfma_f32_16x16x32_bf16 a[76:79], v[180:183], v[36:39], a[76:79]
    s_waitcnt lgkmcnt(2)
    v_add_f32 v6, v6, v19
    v_exp_f32 v17, v93
    v_cvt_pk_bf16_f32 v91, v18, v19
    v_exp_f32 v18, v94
    v_add_f32 v7, v7, v16
    v_mfma_f32_16x16x32_bf16 a[32:35], v[160:163], v[40:43], a[32:35]
    ds_read_b128 v[32:35], v22 offset:1536
    v_add_f32 v7, v7, v17
    v_mfma_f32_16x16x32_bf16 a[32:35], v[176:179], v[44:47], a[32:35]
    s_add_u32 s32, s32, 24576
    s_sub_u32 s57, s32, 196608
    s_min_u32 s32, s32, s57
    v_exp_f32 v19, v95
    v_cvt_pk_bf16_f32 v92, v16, v17
    v_exp_f32 v16, v124
    v_mfma_f32_16x16x32_bf16 a[80:83], v[164:167], v[40:43], a[80:83]
    ds_read_b128 v[36:39], v22 offset:13824
    v_add_f32 v7, v7, v18
    v_mfma_f32_16x16x32_bf16 a[80:83], v[180:183], v[44:47], a[80:83]
    s_waitcnt lgkmcnt(2)
    v_add_f32 v7, v7, v19
    v_exp_f32 v17, v125
    v_cvt_pk_bf16_f32 v93, v18, v19
    v_exp_f32 v18, v126
    v_add_f32 v7, v7, v16
    v_mfma_f32_16x16x32_bf16 a[36:39], v[160:163], v[24:27], a[36:39]
    ds_read_b128 v[40:43], v22 offset:2304
    v_add_f32 v7, v7, v17
    v_mfma_f32_16x16x32_bf16 a[36:39], v[176:179], v[28:31], a[36:39]
    s_add_u32 s26, s26, 36864
    s_sub_u32 s57, s26, 147456
    s_min_u32 s26, s26, s57
    v_exp_f32 v19, v127
    v_cvt_pk_bf16_f32 v94, v16, v17
    v_add_f32 v7, v7, v18
    v_add_f32 v7, v7, v19
    v_mfma_f32_16x16x32_bf16 a[84:87], v[164:167], v[24:27], a[84:87]
    ds_read_b128 v[44:47], v22 offset:14592
    v_cvt_pk_bf16_f32 v95, v18, v19
    v_mfma_f32_16x16x32_bf16 a[84:87], v[180:183], v[28:31], a[84:87]
    s_waitcnt lgkmcnt(2)
    v_cvt_f32_i32 v234, v234
    v_cvt_f32_i32 v235, v235
    v_cvt_f32_i32 v238, v238
    v_cvt_f32_i32 v239, v239
    v_fma_f32 v234, v234, v56, v58
    v_fma_f32 v235, v235, v57, v59
    v_fma_f32 v238, v238, v56, v58
    v_mfma_f32_16x16x32_bf16 a[40:43], v[160:163], v[32:35], a[40:43]
    v_add_u32 v2, 49152, v2
    v_add_u32 v3, 49152, v3
    ds_read_b128 v[24:27], v2 offset:0
    v_mfma_f32_16x16x32_bf16 a[40:43], v[176:179], v[36:39], a[40:43]
    v_fma_f32 v239, v239, v57, v59
    v_cvt_pk_bf16_f32 v233, v234, v235
    v_cvt_pk_bf16_f32 v237, v238, v239
    v_mfma_f32_16x16x32_bf16 a[88:91], v[164:167], v[32:35], a[88:91]
    ds_read_b128 v[28:31], v3 offset:0
    ds_read_b128 v[48:51], v10 offset:1152
    v_mfma_f32_16x16x32_bf16 a[88:91], v[180:183], v[36:39], a[88:91]
    s_waitcnt lgkmcnt(3)
    s_waitcnt vmcnt(12)
    v_cvt_f32_i32 v240, v240
    v_cvt_f32_i32 v241, v241
    v_cvt_f32_i32 v244, v244
    v_mfma_f32_16x16x32_bf16 a[44:47], v[160:163], v[40:43], a[44:47]
    ds_read_b128 v[32:35], v2 offset:6144
    ds_read_b128 v[56:59], v23 offset:0
    v_mfma_f32_16x16x32_bf16 a[44:47], v[176:179], v[44:47], a[44:47]
    v_add_u32 v10, 1792, v10
    v_cvt_f32_i32 v245, v245
    v_fma_f32 v240, v240, v60, v62
    v_fma_f32 v241, v241, v61, v63
    v_fma_f32 v244, v244, v60, v62
    v_fma_f32 v245, v245, v61, v63
    v_cvt_pk_bf16_f32 v226, v240, v241
    v_mfma_f32_16x16x32_bf16 a[92:95], v[164:167], v[40:43], a[92:95]
    ds_read_b128 v[36:39], v3 offset:6144
    v_cvt_pk_bf16_f32 v230, v244, v245
    s_waitcnt lgkmcnt(3)
    v_mfma_f32_16x16x32_bf16 a[92:95], v[180:183], v[44:47], a[92:95]
    s_nop 0
    v_cvt_f32_i32 v242, v242
    v_cvt_f32_i32 v243, v243
    v_cvt_f32_i32 v246, v246
    v_cvt_f32_i32 v247, v247
    v_fma_f32 v242, v242, v48, v50
    v_fma_f32 v243, v243, v49, v51
    v_fma_f32 v246, v246, v48, v50
    v_fma_f32 v247, v247, v49, v51
    v_cvt_pk_bf16_f32 v227, v242, v243
    v_cvt_pk_bf16_f32 v231, v246, v247
    s_waitcnt vmcnt(7)
    v_cvt_f32_i32 v248, v248
    v_cvt_f32_i32 v249, v249
    v_cvt_f32_i32 v252, v252
    v_cvt_f32_i32 v253, v253
    v_fma_f32 v248, v248, v60, v62
    v_fma_f32 v249, v249, v61, v63
    v_fma_f32 v252, v252, v60, v62
    v_fma_f32 v253, v253, v61, v63
    v_cvt_pk_bf16_f32 v234, v248, v249
    v_cvt_pk_bf16_f32 v238, v252, v253
    v_cvt_f32_i32 v250, v250
    v_cvt_f32_i32 v251, v251
    v_cvt_f32_i32 v254, v254
    v_cvt_f32_i32 v255, v255
    v_fma_f32 v250, v250, v48, v50
    v_fma_f32 v251, v251, v49, v51
    v_fma_f32 v254, v254, v48, v50
    v_fma_f32 v255, v255, v49, v51
    v_cvt_pk_bf16_f32 v235, v250, v251
    v_cvt_pk_bf16_f32 v239, v254, v255
    v_mfma_f32_16x16x32_bf16 v[168:171], v[24:27], a[240:243], v[136:139]
    ds_read_b128 v[40:43], v2 offset:128
    v_mfma_f32_16x16x32_bf16 v[168:171], v[28:31], a[244:247], v[168:171]
    buffer_store_dwordx4 v[224:227], v11, s[4:7], s37 offen offset:0 sc1
    v_mfma_f32_16x16x32_bf16 v[172:175], v[24:27], v[200:203], v[140:143]
    ds_read_b128 v[44:47], v3 offset:128
    v_mfma_f32_16x16x32_bf16 v[172:175], v[28:31], v[204:207], v[172:175]
    s_waitcnt lgkmcnt(2)
    v_mfma_f32_16x16x32_bf16 v[96:99], v[32:35], a[240:243], v[136:139]
    ds_read_b128 v[24:27], v2 offset:6272
    v_mfma_f32_16x16x32_bf16 v[96:99], v[36:39], a[244:247], v[96:99]
    v_mfma_f32_16x16x32_bf16 v[100:103], v[32:35], v[200:203], v[140:143]
    ds_read_b128 v[28:31], v3 offset:6272
    v_mfma_f32_16x16x32_bf16 v[100:103], v[36:39], v[204:207], v[100:103]
    s_waitcnt lgkmcnt(2)
    v_mfma_f32_16x16x32_bf16 v[168:171], v[40:43], a[248:251], v[168:171]
    ds_read_b128 v[32:35], v2 offset:256
    v_mfma_f32_16x16x32_bf16 v[168:171], v[44:47], a[252:255], v[168:171]
    v_mfma_f32_16x16x32_bf16 v[172:175], v[40:43], v[208:211], v[172:175]
    ds_read_b128 v[36:39], v3 offset:256
    v_mfma_f32_16x16x32_bf16 v[172:175], v[44:47], v[212:215], v[172:175]
    s_waitcnt lgkmcnt(2)
    v_mfma_f32_16x16x32_bf16 v[96:99], v[24:27], a[248:251], v[96:99]
    ds_read_b128 v[40:43], v2 offset:6400
    v_mfma_f32_16x16x32_bf16 v[96:99], v[28:31], a[252:255], v[96:99]
    buffer_store_dwordx4 v[228:231], v54, s[4:7], s37 offen offset:768 sc1
    v_mfma_f32_16x16x32_bf16 v[100:103], v[24:27], v[208:211], v[100:103]
    ds_read_b128 v[44:47], v3 offset:6400
    v_mfma_f32_16x16x32_bf16 v[100:103], v[28:31], v[212:215], v[100:103]
    s_waitcnt lgkmcnt(2)
    s_branch L_skip2
L_pad2:
    s_branch L_tb1_12
L_skip2:
    v_mfma_f32_16x16x32_bf16 v[168:171], v[32:35], v[192:195], v[168:171]
    ds_read_b128 v[24:27], v2 offset:12288
    v_mfma_f32_16x16x32_bf16 v[168:171], v[36:39], v[196:199], v[168:171]
    v_mfma_f32_16x16x32_bf16 v[172:175], v[32:35], v[216:219], v[172:175]
    ds_read_b128 v[28:31], v3 offset:12288
    v_mfma_f32_16x16x32_bf16 v[172:175], v[36:39], v[220:223], v[172:175]
    s_waitcnt lgkmcnt(2)
    v_mfma_f32_16x16x32_bf16 v[96:99], v[40:43], v[192:195], v[96:99]
    ds_read_b128 v[32:35], v2 offset:18432
    v_mfma_f32_16x16x32_bf16 v[96:99], v[44:47], v[196:199], v[96:99]
    v_mfma_f32_16x16x32_bf16 v[100:103], v[40:43], v[216:219], v[100:103]
    ds_read_b128 v[36:39], v3 offset:18432
    v_mfma_f32_16x16x32_bf16 v[100:103], v[44:47], v[220:223], v[100:103]
    s_waitcnt lgkmcnt(2)
    v_mfma_f32_16x16x32_bf16 v[184:187], v[24:27], a[240:243], v[136:139]
    ds_read_b128 v[40:43], v2 offset:12416
    v_mfma_f32_16x16x32_bf16 v[184:187], v[28:31], a[244:247], v[184:187]
    buffer_store_dwordx4 v[232:235], v11, s[4:7], s80 offen offset:0 sc1
    v_mfma_f32_16x16x32_bf16 v[188:191], v[24:27], v[200:203], v[140:143]
    ds_read_b128 v[44:47], v3 offset:12416
    v_mfma_f32_16x16x32_bf16 v[188:191], v[28:31], v[204:207], v[188:191]
    s_waitcnt lgkmcnt(2)
    v_mfma_f32_16x16x32_bf16 v[112:115], v[32:35], a[240:243], v[136:139]
    ds_read_b128 v[24:27], v2 offset:18560
    v_mfma_f32_16x16x32_bf16 v[112:115], v[36:39], a[244:247], v[112:115]
    v_exp_f32 v16, v168
    v_exp_f32 v17, v169
    v_mfma_f32_16x16x32_bf16 v[116:119], v[32:35], v[200:203], v[140:143]
    ds_read_b128 v[28:31], v3 offset:18560
    v_mfma_f32_16x16x32_bf16 v[116:119], v[36:39], v[204:207], v[116:119]
    s_waitcnt lgkmcnt(2)
    v_exp_f32 v18, v170
    v_add_f32 v6, v6, v16
    v_add_f32 v6, v6, v17
    v_mfma_f32_16x16x32_bf16 v[184:187], v[40:43], a[248:251], v[184:187]
    ds_read_b128 v[32:35], v2 offset:12544
    v_mfma_f32_16x16x32_bf16 v[184:187], v[44:47], a[252:255], v[184:187]
    v_exp_f32 v19, v171
    v_cvt_pk_bf16_f32 v168, v16, v17
    v_mfma_f32_16x16x32_bf16 v[188:191], v[40:43], v[208:211], v[188:191]
    ds_read_b128 v[36:39], v3 offset:12544
    v_mfma_f32_16x16x32_bf16 v[188:191], v[44:47], v[212:215], v[188:191]
    s_waitcnt lgkmcnt(2)
    v_exp_f32 v16, v96
    v_add_f32 v6, v6, v18
    v_add_f32 v6, v6, v19
    v_mfma_f32_16x16x32_bf16 v[112:115], v[24:27], a[248:251], v[112:115]
    ds_read_b128 v[40:43], v2 offset:18688
    v_mfma_f32_16x16x32_bf16 v[112:115], v[28:31], a[252:255], v[112:115]
    buffer_store_dwordx4 v[236:239], v54, s[4:7], s80 offen offset:768 sc1
    v_mfma_f32_16x16x32_bf16 v[116:119], v[24:27], v[208:211], v[116:119]
    ds_read_b128 v[44:47], v3 offset:18688
    v_mfma_f32_16x16x32_bf16 v[116:119], v[28:31], v[212:215], v[116:119]
    s_waitcnt lgkmcnt(2)
    v_exp_f32 v17, v97
    v_cvt_pk_bf16_f32 v169, v18, v19
    v_mfma_f32_16x16x32_bf16 v[184:187], v[32:35], v[192:195], v[184:187]
    v_add_u32 v1, 4294918144, v1
    v_add_u32 v21, 4294918144, v21
    v_add_u32 v22, 4294918144, v22
    ds_read_b128 v[24:27], v1 offset:0
    v_mfma_f32_16x16x32_bf16 v[184:187], v[36:39], v[196:199], v[184:187]
    v_exp_f32 v18, v98
    v_add_f32 v6, v6, v16
    v_add_f32 v6, v6, v17
    v_mfma_f32_16x16x32_bf16 v[188:191], v[32:35], v[216:219], v[188:191]
    ds_read_b128 v[28:31], v1 offset:12288
    v_mfma_f32_16x16x32_bf16 v[188:191], v[36:39], v[220:223], v[188:191]
    s_waitcnt lgkmcnt(2)
    v_exp_f32 v19, v99
    v_cvt_pk_bf16_f32 v170, v16, v17
    v_mfma_f32_16x16x32_bf16 v[112:115], v[40:43], v[192:195], v[112:115]
    ds_read_b128 v[32:35], v1 offset:768
    v_mfma_f32_16x16x32_bf16 v[112:115], v[44:47], v[196:199], v[112:115]
    v_exp_f32 v16, v172
    v_add_f32 v6, v6, v18
    v_add_f32 v6, v6, v19
    v_mfma_f32_16x16x32_bf16 v[116:119], v[40:43], v[216:219], v[116:119]
    ds_read_b128 v[36:39], v1 offset:13056
    v_mfma_f32_16x16x32_bf16 v[116:119], v[44:47], v[220:223], v[116:119]
    s_waitcnt lgkmcnt(2)
    v_exp_f32 v17, v173
    v_cvt_pk_bf16_f32 v171, v18, v19
    v_mfma_f32_16x16x32_bf16 a[96:99], v[72:75], v[24:27], 0
    ds_read_b128 v[40:43], v1 offset:1536
    ds_read_b128 v[60:63], v23 offset:16
    v_mfma_f32_16x16x32_bf16 a[96:99], v[88:91], v[28:31], a[96:99]
    s_mov_b32 m0, s56
    v_exp_f32 v18, v174
    v_add_f32 v7, v7, v16
    v_add_f32 v7, v7, v17
    v_mfma_f32_16x16x32_bf16 a[144:147], v[76:79], v[24:27], 0
    ds_read_b128 v[44:47], v1 offset:13824
    s_waitcnt vmcnt(9)
    v_mfma_f32_16x16x32_bf16 a[144:147], v[92:95], v[28:31], a[144:147]
    s_waitcnt lgkmcnt(3)
    v_exp_f32 v19, v175
    v_cvt_pk_bf16_f32 v172, v16, v17
    v_cvt_f32_i32 v144, v144
    v_mfma_f32_16x16x32_bf16 a[100:103], v[72:75], v[32:35], 0
    ds_read_b128 v[24:27], v1 offset:2304
    v_cvt_f32_i32 v148, v148
    v_mfma_f32_16x16x32_bf16 a[100:103], v[88:91], v[36:39], a[100:103]
    buffer_load_dwordx4 v8, s[4:7], s27 offen offset:0 sc1 lds
    v_exp_f32 v16, v100
    v_mfma_f32_16x16x32_bf16 a[148:151], v[76:79], v[32:35], 0
    ds_read_b128 v[28:31], v1 offset:14592
    v_add_f32 v7, v7, v18
    v_mfma_f32_16x16x32_bf16 a[148:151], v[92:95], v[36:39], a[148:151]
    s_waitcnt lgkmcnt(2)
    v_add_f32 v7, v7, v19
    v_exp_f32 v17, v101
    v_cvt_pk_bf16_f32 v173, v18, v19
    v_mfma_f32_16x16x32_bf16 a[104:107], v[72:75], v[40:43], 0
    ds_read_b128 v[32:35], v21 offset:0
    v_cvt_f32_i32 v145, v145
    v_mfma_f32_16x16x32_bf16 a[104:107], v[88:91], v[44:47], a[104:107]
    buffer_load_dwordx4 v8, s[4:7], s27 offen offset:1024 sc1 lds
    v_exp_f32 v18, v102
    v_mfma_f32_16x16x32_bf16 a[152:155], v[76:79], v[40:43], 0
    ds_read_b128 v[36:39], v21 offset:12288
    v_add_f32 v7, v7, v16
    v_mfma_f32_16x16x32_bf16 a[152:155], v[92:95], v[44:47], a[152:155]
    s_waitcnt lgkmcnt(2)
    v_add_f32 v7, v7, v17
    v_exp_f32 v19, v103
    v_cvt_pk_bf16_f32 v174, v16, v17
    v_mfma_f32_16x16x32_bf16 a[108:111], v[72:75], v[24:27], 0
    ds_read_b128 v[40:43], v21 offset:768
    v_add_f32 v7, v7, v18
    v_mfma_f32_16x16x32_bf16 a[108:111], v[88:91], v[28:31], a[108:111]
    buffer_load_dwordx4 v8, s[4:7], s27 offen offset:2048 sc1 lds
    v_add_f32 v7, v7, v19
    v_cvt_pk_bf16_f32 v175, v18, v19
    v_mfma_f32_16x16x32_bf16 a[156:159], v[76:79], v[24:27], 0
    ds_read_b128 v[44:47], v21 offset:13056
    ds_read_b128 v[48:51], v23 offset:32
    v_mfma_f32_16x16x32_bf16 a[156:159], v[92:95], v[28:31], a[156:159]
    s_waitcnt lgkmcnt(3)
    v_cvt_f32_i32 v149, v149
    v_fma_f32 v144, v144, v56, v58
    v_fma_f32 v148, v148, v57, v59
    v_fma_f32 v145, v145, v56, v58
    v_mfma_f32_16x16x32_bf16 a[112:115], v[72:75], v[32:35], 0
    ds_read_b128 v[24:27], v21 offset:1536
    v_fma_f32 v149, v149, v57, v59
    v_mfma_f32_16x16x32_bf16 a[112:115], v[88:91], v[36:39], a[112:115]
    s_add_u32 s27, s27, 24576
    s_sub_u32 s58, s27, 196608
    s_min_u32 s27, s27, s58
    v_cvt_f32_i32 v146, v146
    v_cvt_f32_i32 v150, v150
    v_mfma_f32_16x16x32_bf16 a[160:163], v[76:79], v[32:35], 0
    ds_read_b128 v[28:31], v21 offset:13824
    v_cvt_f32_i32 v147, v147
    v_mfma_f32_16x16x32_bf16 a[160:163], v[92:95], v[36:39], a[160:163]
    s_waitcnt lgkmcnt(3)
    v_cvt_f32_i32 v151, v151
    v_fma_f32 v146, v146, v56, v58
    v_fma_f32 v150, v150, v57, v59
    v_fma_f32 v147, v147, v56, v58
    v_mfma_f32_16x16x32_bf16 a[116:119], v[72:75], v[40:43], 0
    ds_read_b128 v[32:35], v21 offset:2304
    v_fma_f32 v151, v151, v57, v59
    v_mfma_f32_16x16x32_bf16 a[116:119], v[88:91], v[44:47], a[116:119]
    s_add_u32 s56, s56, 12288
    v_mfma_f32_16x16x32_bf16 a[164:167], v[76:79], v[40:43], 0
    ds_read_b128 v[36:39], v21 offset:14592
    v_mfma_f32_16x16x32_bf16 a[164:167], v[92:95], v[44:47], a[164:167]
    s_waitcnt lgkmcnt(2)
    v_mfma_f32_16x16x32_bf16 a[120:123], v[72:75], v[24:27], 0
    ds_read_b128 v[40:43], v22 offset:0
    v_mfma_f32_16x16x32_bf16 a[120:123], v[88:91], v[28:31], a[120:123]
    v_mfma_f32_16x16x32_bf16 a[168:171], v[76:79], v[24:27], 0
    ds_read_b128 v[44:47], v22 offset:12288
    v_mfma_f32_16x16x32_bf16 a[168:171], v[92:95], v[28:31], a[168:171]
    s_waitcnt lgkmcnt(2)
    v_mfma_f32_16x16x32_bf16 a[124:127], v[72:75], v[32:35], 0
    ds_read_b128 v[24:27], v22 offset:768
    v_mfma_f32_16x16x32_bf16 a[124:127], v[88:91], v[36:39], a[124:127]
    v_mfma_f32_16x16x32_bf16 a[172:175], v[76:79], v[32:35], 0
    ds_read_b128 v[28:31], v22 offset:13056
    v_mfma_f32_16x16x32_bf16 a[172:175], v[92:95], v[36:39], a[172:175]
    s_waitcnt lgkmcnt(2)
    v_mfma_f32_16x16x32_bf16 a[128:131], v[72:75], v[40:43], 0
    ds_read_b128 v[32:35], v22 offset:1536
    v_mfma_f32_16x16x32_bf16 a[128:131], v[88:91], v[44:47], a[128:131]
    v_mfma_f32_16x16x32_bf16 a[176:179], v[76:79], v[40:43], 0
    ds_read_b128 v[36:39], v22 offset:13824
    v_mfma_f32_16x16x32_bf16 a[176:179], v[92:95], v[44:47], a[176:179]
    s_waitcnt lgkmcnt(2)
    v_mfma_f32_16x16x32_bf16 a[132:135], v[72:75], v[24:27], 0
    ds_read_b128 v[40:43], v22 offset:2304
    v_mfma_f32_16x16x32_bf16 a[132:135], v[88:91], v[28:31], a[132:135]
    s_waitcnt vmcnt(3)
    s_barrier
    v_mfma_f32_16x16x32_bf16 a[180:183], v[76:79], v[24:27], 0
    ds_read_b128 v[44:47], v22 offset:14592
    v_mfma_f32_16x16x32_bf16 a[180:183], v[92:95], v[28:31], a[180:183]
    s_waitcnt lgkmcnt(2)
    v_mfma_f32_16x16x32_bf16 a[136:139], v[72:75], v[32:35], 0
    v_add_u32 v2, 49152, v2
    v_add_u32 v3, 49152, v3
    s_mov_b32 s28, 98304
    ds_read_b128 v[24:27], v2 offset:0
    v_mfma_f32_16x16x32_bf16 a[136:139], v[88:91], v[36:39], a[136:139]
    v_add_u32 v55, 1, v55
    buffer_store_dword v55, v13, s[20:23], 0 offen sc1
    buffer_load_dwordx4 v[240:243], v12, s[68:71], s36 offen offset:0 nt
    v_mfma_f32_16x16x32_bf16 a[184:187], v[76:79], v[32:35], 0
    ds_read_b128 v[28:31], v3 offset:0
    v_mfma_f32_16x16x32_bf16 a[184:187], v[92:95], v[36:39], a[184:187]
    s_waitcnt lgkmcnt(2)
    v_mfma_f32_16x16x32_bf16 a[140:143], v[72:75], v[40:43], 0
    ds_read_b128 v[32:35], v2 offset:6144
    v_mfma_f32_16x16x32_bf16 a[140:143], v[88:91], v[44:47], a[140:143]
    buffer_load_dwordx4 v[244:247], v12, s[68:71], s36 offen offset:768 nt
    v_mfma_f32_16x16x32_bf16 a[188:191], v[76:79], v[40:43], 0
    ds_read_b128 v[36:39], v3 offset:6144
    v_mfma_f32_16x16x32_bf16 a[188:191], v[92:95], v[44:47], a[188:191]
    s_waitcnt lgkmcnt(2)
    s_mov_b32 s31, 5
    v_mfma_f32_16x16x32_bf16 v[64:67], v[24:27], a[192:195], v[128:131]
    ds_read_b128 v[40:43], v2 offset:128
    v_mfma_f32_16x16x32_bf16 v[64:67], v[28:31], a[196:199], v[64:67]
    buffer_load_dwordx4 v[248:251], v12, s[68:71], s36 offen offset:1536 nt
    v_mfma_f32_16x16x32_bf16 v[68:71], v[24:27], a[216:219], v[132:135]
    v_exp_f32 v16, v184
    v_mfma_f32_16x16x32_bf16 v[68:71], v[28:31], a[220:223], v[68:71]
    v_exp_f32 v17, v185
    v_mfma_f32_16x16x32_bf16 v[72:75], v[24:27], a[240:243], v[136:139]
    ds_read_b128 v[44:47], v3 offset:128
    v_mfma_f32_16x16x32_bf16 v[72:75], v[28:31], a[244:247], v[72:75]
    buffer_load_dwordx4 v[252:255], v12, s[68:71], s36 offen offset:2304 nt
    v_mfma_f32_16x16x32_bf16 v[76:79], v[24:27], v[200:203], v[140:143]
    v_exp_f32 v18, v186
    v_mfma_f32_16x16x32_bf16 v[76:79], v[28:31], v[204:207], v[76:79]
    s_waitcnt lgkmcnt(2)
    v_add_f32 v6, v6, v16
    v_add_f32 v6, v6, v17
    v_mfma_f32_16x16x32_bf16 v[96:99], v[32:35], a[192:195], v[128:131]
    ds_read_b128 v[24:27], v2 offset:6272
    v_mfma_f32_16x16x32_bf16 v[96:99], v[36:39], a[196:199], v[96:99]
    v_exp_f32 v19, v187
    v_mfma_f32_16x16x32_bf16 v[100:103], v[32:35], a[216:219], v[132:135]
    s_mov_b32 m0, s56
    ds_read_b128 v[56:59], v23 offset:48
    v_cvt_pk_bf16_f32 v184, v16, v17
    v_mfma_f32_16x16x32_bf16 v[100:103], v[36:39], a[220:223], v[100:103]
    s_waitcnt vmcnt(15)
    v_exp_f32 v16, v112
    v_mfma_f32_16x16x32_bf16 v[104:107], v[32:35], a[240:243], v[136:139]
    ds_read_b128 v[28:31], v3 offset:6272
    v_add_f32 v6, v6, v18
    v_mfma_f32_16x16x32_bf16 v[104:107], v[36:39], a[244:247], v[104:107]
    buffer_load_dwordx4 v8, s[4:7], s27 offen offset:0 sc1 lds
    v_mfma_f32_16x16x32_bf16 v[108:111], v[32:35], v[200:203], v[140:143]
    v_add_f32 v6, v6, v19
    v_cvt_f32_i32 v152, v152
    v_mfma_f32_16x16x32_bf16 v[108:111], v[36:39], v[204:207], v[108:111]
    s_waitcnt lgkmcnt(3)
    v_exp_f32 v17, v113
    v_mfma_f32_16x16x32_bf16 v[64:67], v[40:43], a[200:203], v[64:67]
    ds_read_b128 v[32:35], v2 offset:256
    v_cvt_pk_bf16_f32 v185, v18, v19
    v_mfma_f32_16x16x32_bf16 v[64:67], v[44:47], a[204:207], v[64:67]
    buffer_load_dwordx4 v8, s[4:7], s27 offen offset:1024 sc1 lds
    v_mfma_f32_16x16x32_bf16 v[68:71], v[40:43], a[224:227], v[68:71]
    v_exp_f32 v18, v114
    v_mfma_f32_16x16x32_bf16 v[68:71], v[44:47], a[228:231], v[68:71]
    v_add_f32 v6, v6, v16
    v_add_f32 v6, v6, v17
    v_mfma_f32_16x16x32_bf16 v[72:75], v[40:43], a[248:251], v[72:75]
    ds_read_b128 v[36:39], v3 offset:256
    v_cvt_f32_i32 v156, v156
    v_mfma_f32_16x16x32_bf16 v[72:75], v[44:47], a[252:255], v[72:75]
    buffer_load_dwordx4 v8, s[4:7], s27 offen offset:2048 sc1 lds
    v_mfma_f32_16x16x32_bf16 v[76:79], v[40:43], v[208:211], v[76:79]
    v_exp_f32 v19, v115
    v_mfma_f32_16x16x32_bf16 v[76:79], v[44:47], v[212:215], v[76:79]
    s_waitcnt lgkmcnt(2)
    v_cvt_pk_bf16_f32 v186, v16, v17
    v_cvt_f32_i32 v153, v153
    v_mfma_f32_16x16x32_bf16 v[96:99], v[24:27], a[200:203], v[96:99]
    s_add_u32 s27, s27, 24576
    ds_read_b128 v[40:43], v2 offset:6400
    v_mfma_f32_16x16x32_bf16 v[96:99], v[28:31], a[204:207], v[96:99]
    v_exp_f32 v16, v188
    v_mfma_f32_16x16x32_bf16 v[100:103], v[24:27], a[224:227], v[100:103]
    s_sub_u32 s58, s27, 196608
    v_add_f32 v6, v6, v18
    v_add_f32 v6, v6, v19
    v_mfma_f32_16x16x32_bf16 v[100:103], v[28:31], a[228:231], v[100:103]
    v_exp_f32 v17, v189
    v_mfma_f32_16x16x32_bf16 v[104:107], v[24:27], a[248:251], v[104:107]
    s_min_u32 s27, s27, s58
    ds_read_b128 v[44:47], v3 offset:6400
    v_cvt_pk_bf16_f32 v187, v18, v19
    v_mfma_f32_16x16x32_bf16 v[104:107], v[28:31], a[252:255], v[104:107]
    v_exp_f32 v18, v190
    v_mfma_f32_16x16x32_bf16 v[108:111], v[24:27], v[208:211], v[108:111]
    s_add_u32 s29, s30, 49152
    v_add_u32 v23, 1792, v23
    v_add_f32 v7, v7, v16
    v_mfma_f32_16x16x32_bf16 v[108:111], v[28:31], v[212:215], v[108:111]
    s_waitcnt lgkmcnt(2)
    v_add_f32 v7, v7, v17
    s_add_u32 s56, s56, 36864
    v_mfma_f32_16x16x32_bf16 v[64:67], v[32:35], a[208:211], v[64:67]
    s_sub_u32 s3, s29, 147456
    ds_read_b128 v[24:27], v2 offset:12288
    v_cvt_f32_i32 v157, v157
    v_mfma_f32_16x16x32_bf16 v[64:67], v[36:39], a[212:215], v[64:67]
    s_sub_u32 s58, s56, 147456
    v_exp_f32 v19, v191
    v_mfma_f32_16x16x32_bf16 v[68:71], v[32:35], a[232:235], v[68:71]
    v_cvt_pk_bf16_f32 v188, v16, v17
    v_mfma_f32_16x16x32_bf16 v[68:71], v[36:39], a[236:239], v[68:71]
    s_min_u32 s56, s56, s58
    v_exp_f32 v16, v116
    v_mfma_f32_16x16x32_bf16 v[72:75], v[32:35], v[192:195], v[72:75]
    ds_read_b128 v[28:31], v3 offset:12288
    v_add_f32 v7, v7, v18
    v_mfma_f32_16x16x32_bf16 v[72:75], v[36:39], v[196:199], v[72:75]
    s_mov_b32 m0, s26
    v_add_f32 v7, v7, v19
    v_mfma_f32_16x16x32_bf16 v[76:79], v[32:35], v[216:219], v[76:79]
    s_min_u32 s29, s29, s3
    v_fma_f32 v152, v152, v60, v62
    v_mfma_f32_16x16x32_bf16 v[76:79], v[36:39], v[220:223], v[76:79]
    s_waitcnt lgkmcnt(2)
    v_exp_f32 v17, v117
    v_mfma_f32_16x16x32_bf16 v[96:99], v[40:43], a[208:211], v[96:99]
    ds_read_b128 v[32:35], v2 offset:18432
    v_cvt_pk_bf16_f32 v189, v18, v19
    v_mfma_f32_16x16x32_bf16 v[96:99], v[44:47], a[212:215], v[96:99]
    buffer_load_dwordx4 v8, s[4:7], s32 offen offset:0 sc1 lds
    v_mfma_f32_16x16x32_bf16 v[100:103], v[40:43], a[232:235], v[100:103]
    v_exp_f32 v18, v118
    v_mfma_f32_16x16x32_bf16 v[100:103], v[44:47], a[236:239], v[100:103]
    v_add_f32 v7, v7, v16
    v_mfma_f32_16x16x32_bf16 v[104:107], v[40:43], v[192:195], v[104:107]
    s_sub_u32 s3, s29, s30
    ds_read_b128 v[36:39], v3 offset:18432
    v_add_f32 v7, v7, v17
    v_mfma_f32_16x16x32_bf16 v[104:107], v[44:47], v[196:199], v[104:107]
    buffer_load_dwordx4 v8, s[4:7], s32 offen offset:1024 sc1 lds
    v_mfma_f32_16x16x32_bf16 v[108:111], v[40:43], v[216:219], v[108:111]
    v_exp_f32 v19, v119
    v_mfma_f32_16x16x32_bf16 v[108:111], v[44:47], v[220:223], v[108:111]
    s_waitcnt lgkmcnt(2)
    v_cvt_pk_bf16_f32 v190, v16, v17
    v_fma_f32 v156, v156, v61, v63
    v_mfma_f32_16x16x32_bf16 v[80:83], v[24:27], a[192:195], v[128:131]
    ds_read_b128 v[40:43], v2 offset:12416
    v_add_f32 v7, v7, v18
    v_mfma_f32_16x16x32_bf16 v[80:83], v[28:31], a[196:199], v[80:83]
    v_add_f32 v7, v7, v19
    v_cvt_pk_bf16_f32 v191, v18, v19
    v_mfma_f32_16x16x32_bf16 v[84:87], v[24:27], a[216:219], v[132:135]
    s_mov_b32 s30, s29
    v_fma_f32 v153, v153, v60, v62
    v_mfma_f32_16x16x32_bf16 v[84:87], v[28:31], a[220:223], v[84:87]
    buffer_load_dwordx4 v8, s[4:7], s32 offen offset:2048 sc1 lds
    v_mfma_f32_16x16x32_bf16 v[88:91], v[24:27], a[240:243], v[136:139]
    ds_read_b128 v[44:47], v3 offset:12416
    v_mfma_f32_16x16x32_bf16 v[88:91], v[28:31], a[244:247], v[88:91]
    s_add_u32 s32, s32, 24576
    v_exp_f32 v16, v64
    v_mfma_f32_16x16x32_bf16 v[92:95], v[24:27], v[200:203], v[140:143]
    v_exp_f32 v17, v65
    v_mfma_f32_16x16x32_bf16 v[92:95], v[28:31], v[204:207], v[92:95]
    s_waitcnt lgkmcnt(2)
    v_exp_f32 v18, v66
    v_mfma_f32_16x16x32_bf16 v[112:115], v[32:35], a[192:195], v[128:131]
    s_sub_u32 s57, s32, 196608
    ds_read_b128 v[24:27], v2 offset:18560
    v_add_f32 v4, v4, v16
    v_mfma_f32_16x16x32_bf16 v[112:115], v[36:39], a[196:199], v[112:115]
    s_min_u32 s32, s32, s57
    v_add_f32 v4, v4, v17
    v_add_u32 v1, s3, v1
    v_mfma_f32_16x16x32_bf16 v[116:119], v[32:35], a[216:219], v[132:135]
    v_exp_f32 v19, v67
    v_mfma_f32_16x16x32_bf16 v[116:119], v[36:39], a[220:223], v[116:119]
    v_cvt_pk_bf16_f32 v64, v16, v17
    v_fma_f32 v157, v157, v61, v63
    v_mfma_f32_16x16x32_bf16 v[120:123], v[32:35], a[240:243], v[136:139]
    s_add_u32 s26, s26, 12288
    ds_read_b128 v[28:31], v3 offset:18560
    v_mfma_f32_16x16x32_bf16 v[120:123], v[36:39], a[244:247], v[120:123]
    v_exp_f32 v16, v96
    v_mfma_f32_16x16x32_bf16 v[124:127], v[32:35], v[200:203], v[140:143]
    s_mov_b32 m0, s26
    v_add_f32 v4, v4, v18
    v_add_f32 v4, v4, v19
    v_mfma_f32_16x16x32_bf16 v[124:127], v[36:39], v[204:207], v[124:127]
    s_waitcnt lgkmcnt(2)
    v_exp_f32 v17, v97
    v_mfma_f32_16x16x32_bf16 v[80:83], v[40:43], a[200:203], v[80:83]
    ds_read_b128 v[32:35], v2 offset:12544
    v_add_u32 v21, s3, v21
    v_mfma_f32_16x16x32_bf16 v[80:83], v[44:47], a[204:207], v[80:83]
    buffer_load_dwordx4 v8, s[4:7], s32 offen offset:0 sc1 lds
    v_mfma_f32_16x16x32_bf16 v[84:87], v[40:43], a[224:227], v[84:87]
    v_cvt_pk_bf16_f32 v65, v18, v19
    v_cvt_f32_i32 v154, v154
    v_mfma_f32_16x16x32_bf16 v[84:87], v[44:47], a[228:231], v[84:87]
    v_exp_f32 v18, v98
    v_mfma_f32_16x16x32_bf16 v[88:91], v[40:43], a[248:251], v[88:91]
    ds_read_b128 v[36:39], v3 offset:12544
    v_add_f32 v4, v4, v16
    v_mfma_f32_16x16x32_bf16 v[88:91], v[44:47], a[252:255], v[88:91]
    v_add_f32 v4, v4, v17
    v_cvt_f32_i32 v158, v158
    v_mfma_f32_16x16x32_bf16 v[92:95], v[40:43], v[208:211], v[92:95]
    v_exp_f32 v19, v99
    v_mfma_f32_16x16x32_bf16 v[92:95], v[44:47], v[212:215], v[92:95]
    s_waitcnt lgkmcnt(2)
    buffer_load_dwordx4 v8, s[4:7], s32 offen offset:1024 sc1 lds
    v_mfma_f32_16x16x32_bf16 v[112:115], v[24:27], a[200:203], v[112:115]
    ds_read_b128 v[40:43], v2 offset:18688
    v_cvt_pk_bf16_f32 v66, v16, v17
    v_mfma_f32_16x16x32_bf16 v[112:115], v[28:31], a[204:207], v[112:115]
    v_exp_f32 v16, v68
    v_mfma_f32_16x16x32_bf16 v[116:119], v[24:27], a[224:227], v[116:119]
    v_add_f32 v4, v4, v18
    v_add_u32 v22, s3, v22
    v_mfma_f32_16x16x32_bf16 v[116:119], v[28:31], a[228:231], v[116:119]
    buffer_load_dwordx4 v8, s[4:7], s32 offen offset:2048 sc1 lds
    v_mfma_f32_16x16x32_bf16 v[120:123], v[24:27], a[248:251], v[120:123]
    ds_read_b128 v[44:47], v3 offset:18688
    v_add_f32 v4, v4, v19
    v_mfma_f32_16x16x32_bf16 v[120:123], v[28:31], a[252:255], v[120:123]
    s_waitcnt lgkmcnt(2)
    v_exp_f32 v17, v69
    v_mfma_f32_16x16x32_bf16 v[124:127], v[24:27], v[208:211], v[124:127]
    s_waitcnt vmcnt(18)
    v_cvt_pk_bf16_f32 v67, v18, v19
    v_cvt_f32_i32 v155, v155
    v_mfma_f32_16x16x32_bf16 v[124:127], v[28:31], v[212:215], v[124:127]
    s_barrier
    s_mov_b32 s32, 196608
    v_mfma_f32_16x16x32_bf16 v[80:83], v[32:35], a[208:211], v[80:83]
    s_add_u32 s26, s26, 36864
    ds_read_b128 v[24:27], v1 offset:0
    v_cvt_f32_i32 v159, v159
    v_mfma_f32_16x16x32_bf16 v[80:83], v[36:39], a[212:215], v[80:83]
    v_exp_f32 v18, v70
    v_mfma_f32_16x16x32_bf16 v[84:87], v[32:35], a[232:235], v[84:87]
    v_add_f32 v5, v5, v16
    v_add_f32 v5, v5, v17
    v_mfma_f32_16x16x32_bf16 v[84:87], v[36:39], a[236:239], v[84:87]
    s_sub_u32 s57, s26, 147456
    v_exp_f32 v19, v71
    v_mfma_f32_16x16x32_bf16 v[88:91], v[32:35], v[192:195], v[88:91]
    ds_read_b128 v[28:31], v1 offset:12288
    v_cvt_pk_bf16_f32 v68, v16, v17
    v_mfma_f32_16x16x32_bf16 v[88:91], v[36:39], v[196:199], v[88:91]
    v_exp_f32 v16, v100
    v_mfma_f32_16x16x32_bf16 v[92:95], v[32:35], v[216:219], v[92:95]
    s_min_u32 s26, s26, s57
    v_add_f32 v5, v5, v18
    v_add_f32 v5, v5, v19
    v_mfma_f32_16x16x32_bf16 v[92:95], v[36:39], v[220:223], v[92:95]
    s_waitcnt lgkmcnt(2)
    v_exp_f32 v17, v101
    v_mfma_f32_16x16x32_bf16 v[112:115], v[40:43], a[208:211], v[112:115]
    ds_read_b128 v[32:35], v1 offset:768
    v_cvt_pk_bf16_f32 v69, v18, v19
    v_mfma_f32_16x16x32_bf16 v[112:115], v[44:47], a[212:215], v[112:115]
    v_exp_f32 v18, v102
    v_mfma_f32_16x16x32_bf16 v[116:119], v[40:43], a[232:235], v[116:119]
    v_add_f32 v5, v5, v16
    v_add_f32 v5, v5, v17
    v_mfma_f32_16x16x32_bf16 v[116:119], v[44:47], a[236:239], v[116:119]
    v_exp_f32 v19, v103
    v_mfma_f32_16x16x32_bf16 v[120:123], v[40:43], v[192:195], v[120:123]
    ds_read_b128 v[36:39], v1 offset:13056
    v_fma_f32 v154, v154, v60, v62
    v_mfma_f32_16x16x32_bf16 v[120:123], v[44:47], v[196:199], v[120:123]
    v_cvt_pk_bf16_f32 v70, v16, v17
    v_add_f32 v5, v5, v18
    v_mfma_f32_16x16x32_bf16 v[124:127], v[40:43], v[216:219], v[124:127]
    v_add_f32 v5, v5, v19
    v_cvt_pk_bf16_f32 v71, v18, v19
    v_mfma_f32_16x16x32_bf16 v[124:127], v[44:47], v[220:223], v[124:127]
    s_waitcnt lgkmcnt(2)
    v_mfma_f32_16x16x32_bf16 a[96:99], v[168:171], v[24:27], a[96:99]
    ds_read_b128 v[40:43], v1 offset:1536
    s_add_u32 s29, s28, 49152
    v_mfma_f32_16x16x32_bf16 a[96:99], v[184:187], v[28:31], a[96:99]
    s_mov_b32 m0, s56
    s_sub_u32 s3, s29, 147456
    s_min_u32 s29, s29, s3
    s_sub_u32 s3, s29, s28
    s_mov_b32 s28, s29
    v_mfma_f32_16x16x32_bf16 a[144:147], v[172:175], v[24:27], a[144:147]
    ds_read_b128 v[44:47], v1 offset:13824
    v_add_u32 v2, s3, v2
    v_mfma_f32_16x16x32_bf16 a[144:147], v[188:191], v[28:31], a[144:147]
    s_waitcnt lgkmcnt(2)
    v_add_u32 v3, s3, v3
    v_exp_f32 v16, v72
    v_fma_f32 v158, v158, v61, v63
    v_mfma_f32_16x16x32_bf16 a[100:103], v[168:171], v[32:35], a[100:103]
    ds_read_b128 v[24:27], v1 offset:2304
    v_fma_f32 v155, v155, v60, v62
    v_mfma_f32_16x16x32_bf16 a[100:103], v[184:187], v[36:39], a[100:103]
    buffer_load_dwordx4 v8, s[4:7], s27 offen offset:0 sc1 lds
    v_exp_f32 v17, v73
    v_mfma_f32_16x16x32_bf16 a[148:151], v[172:175], v[32:35], a[148:151]
    ds_read_b128 v[28:31], v1 offset:14592
    v_fma_f32 v159, v159, v61, v63
    v_mfma_f32_16x16x32_bf16 a[148:151], v[188:191], v[36:39], a[148:151]
    s_waitcnt lgkmcnt(2)
    v_exp_f32 v18, v74
    v_add_f32 v6, v6, v16
    v_add_f32 v6, v6, v17
    v_mfma_f32_16x16x32_bf16 a[104:107], v[168:171], v[40:43], a[104:107]
    ds_read_b128 v[32:35], v21 offset:0
    v_cvt_pk_bf16_f32 v144, v144, v148
    v_mfma_f32_16x16x32_bf16 a[104:107], v[184:187], v[44:47], a[104:107]
    buffer_load_dwordx4 v8, s[4:7], s27 offen offset:1024 sc1 lds
    v_exp_f32 v19, v75
    v_mfma_f32_16x16x32_bf16 a[152:155], v[172:175], v[40:43], a[152:155]
    ds_read_b128 v[36:39], v21 offset:12288
    v_cvt_pk_bf16_f32 v72, v16, v17
    v_mfma_f32_16x16x32_bf16 a[152:155], v[188:191], v[44:47], a[152:155]
    s_waitcnt lgkmcnt(2)
    v_exp_f32 v16, v104
    v_add_f32 v6, v6, v18
    v_add_f32 v6, v6, v19
    v_mfma_f32_16x16x32_bf16 a[108:111], v[168:171], v[24:27], a[108:111]
    ds_read_b128 v[40:43], v21 offset:768
    v_cvt_pk_bf16_f32 v148, v145, v149
    v_mfma_f32_16x16x32_bf16 a[108:111], v[184:187], v[28:31], a[108:111]
    buffer_load_dwordx4 v8, s[4:7], s27 offen offset:2048 sc1 lds
    v_exp_f32 v17, v105
    v_mfma_f32_16x16x32_bf16 a[156:159], v[172:175], v[24:27], a[156:159]
    ds_read_b128 v[44:47], v21 offset:13056
    v_cvt_pk_bf16_f32 v73, v18, v19
    v_mfma_f32_16x16x32_bf16 a[156:159], v[188:191], v[28:31], a[156:159]
    s_waitcnt lgkmcnt(2)
    v_exp_f32 v18, v106
    v_add_f32 v6, v6, v16
    v_add_f32 v6, v6, v17
    v_mfma_f32_16x16x32_bf16 a[112:115], v[168:171], v[32:35], a[112:115]
    ds_read_b128 v[24:27], v21 offset:1536
    v_cvt_pk_bf16_f32 v145, v152, v156
    v_mfma_f32_16x16x32_bf16 a[112:115], v[184:187], v[36:39], a[112:115]
    s_add_u32 s27, s27, 24576
    s_sub_u32 s58, s27, 196608
    s_min_u32 s27, s27, s58
    s_add_u32 s56, s56, 12288
    v_cvt_pk_bf16_f32 v149, v153, v157
    v_mfma_f32_16x16x32_bf16 a[160:163], v[172:175], v[32:35], a[160:163]
    ds_read_b128 v[28:31], v21 offset:13824
    v_cvt_pk_bf16_f32 v152, v146, v150
    v_mfma_f32_16x16x32_bf16 a[160:163], v[188:191], v[36:39], a[160:163]
    s_waitcnt lgkmcnt(2)
    v_exp_f32 v19, v107
    v_cvt_pk_bf16_f32 v74, v16, v17
    v_cvt_pk_bf16_f32 v153, v154, v158
    v_mfma_f32_16x16x32_bf16 a[116:119], v[168:171], v[40:43], a[116:119]
    ds_read_b128 v[32:35], v21 offset:2304
    v_cvt_pk_bf16_f32 v156, v147, v151
    v_mfma_f32_16x16x32_bf16 a[116:119], v[184:187], v[44:47], a[116:119]
    s_mov_b32 m0, s56
    v_exp_f32 v16, v76
    v_add_f32 v6, v6, v18
    v_add_f32 v6, v6, v19
    v_mfma_f32_16x16x32_bf16 a[164:167], v[172:175], v[40:43], a[164:167]
    ds_read_b128 v[36:39], v21 offset:14592
    v_cvt_pk_bf16_f32 v157, v155, v159
    v_mfma_f32_16x16x32_bf16 a[164:167], v[188:191], v[44:47], a[164:167]
    s_waitcnt lgkmcnt(2)
    v_exp_f32 v17, v77
    v_cvt_pk_bf16_f32 v75, v18, v19
    s_waitcnt vmcnt(14)
    v_mfma_f32_16x16x32_bf16 a[120:123], v[168:171], v[24:27], a[120:123]
    ds_read_b128 v[40:43], v22 offset:0
    v_cvt_f32_i32 v240, v240
    v_mfma_f32_16x16x32_bf16 a[120:123], v[184:187], v[28:31], a[120:123]
    buffer_load_dwordx4 v8, s[4:7], s27 offen offset:0 sc1 lds
    v_exp_f32 v18, v78
    v_mfma_f32_16x16x32_bf16 a[168:171], v[172:175], v[24:27], a[168:171]
    ds_read_b128 v[44:47], v22 offset:12288
    v_add_f32 v7, v7, v16
    v_mfma_f32_16x16x32_bf16 a[168:171], v[188:191], v[28:31], a[168:171]
    s_waitcnt lgkmcnt(2)
    v_add_f32 v7, v7, v17
    v_exp_f32 v19, v79
    v_cvt_pk_bf16_f32 v76, v16, v17
    v_mfma_f32_16x16x32_bf16 a[124:127], v[168:171], v[32:35], a[124:127]
    ds_read_b128 v[24:27], v22 offset:768
    v_cvt_f32_i32 v244, v244
    v_mfma_f32_16x16x32_bf16 a[124:127], v[184:187], v[36:39], a[124:127]
    buffer_load_dwordx4 v8, s[4:7], s27 offen offset:1024 sc1 lds
    v_exp_f32 v16, v108
    v_mfma_f32_16x16x32_bf16 a[172:175], v[172:175], v[32:35], a[172:175]
    ds_read_b128 v[28:31], v22 offset:13056
    v_add_f32 v7, v7, v18
    v_mfma_f32_16x16x32_bf16 a[172:175], v[188:191], v[36:39], a[172:175]
    s_waitcnt lgkmcnt(2)
    v_add_f32 v7, v7, v19
    v_exp_f32 v17, v109
    v_cvt_pk_bf16_f32 v77, v18, v19
    v_mfma_f32_16x16x32_bf16 a[128:131], v[168:171], v[40:43], a[128:131]
    ds_read_b128 v[32:35], v22 offset:1536
    v_cvt_f32_i32 v241, v241
    v_mfma_f32_16x16x32_bf16 a[128:131], v[184:187], v[44:47], a[128:131]
    buffer_load_dwordx4 v8, s[4:7], s27 offen offset:2048 sc1 lds
    v_exp_f32 v18, v110
    v_mfma_f32_16x16x32_bf16 a[176:179], v[172:175], v[40:43], a[176:179]
    ds_read_b128 v[36:39], v22 offset:13824
    v_add_f32 v7, v7, v16
    v_mfma_f32_16x16x32_bf16 a[176:179], v[188:191], v[44:47], a[176:179]
    s_waitcnt lgkmcnt(2)
    v_add_f32 v7, v7, v17
    v_exp_f32 v19, v111
    v_cvt_pk_bf16_f32 v78, v16, v17
    s_branch L_skip3
L_pad3:
    s_branch L_tb1_11
L_skip3:
    v_mfma_f32_16x16x32_bf16 a[132:135], v[168:171], v[24:27], a[132:135]
    ds_read_b128 v[40:43], v22 offset:2304
    v_mfma_f32_16x16x32_bf16 a[132:135], v[184:187], v[28:31], a[132:135]
    s_waitcnt vmcnt(6)
    s_barrier
    v_exp_f32 v16, v80
    v_mfma_f32_16x16x32_bf16 a[180:183], v[172:175], v[24:27], a[180:183]
    ds_read_b128 v[44:47], v22 offset:14592
    v_add_f32 v7, v7, v18
    v_mfma_f32_16x16x32_bf16 a[180:183], v[188:191], v[28:31], a[180:183]
    s_waitcnt lgkmcnt(2)
    v_add_f32 v7, v7, v19
    v_exp_f32 v17, v81
    v_cvt_pk_bf16_f32 v79, v18, v19
    v_mfma_f32_16x16x32_bf16 a[136:139], v[168:171], v[32:35], a[136:139]
    ds_read_b128 v[24:27], v2 offset:0
    v_mfma_f32_16x16x32_bf16 a[136:139], v[184:187], v[36:39], a[136:139]
    s_mov_b32 s27, 208896
    s_add_u32 s56, s56, 36864
    s_sub_u32 s58, s56, 147456
    s_min_u32 s56, s56, s58
    v_mfma_f32_16x16x32_bf16 a[184:187], v[172:175], v[32:35], a[184:187]
    ds_read_b128 v[28:31], v3 offset:0
    v_mfma_f32_16x16x32_bf16 a[184:187], v[188:191], v[36:39], a[184:187]
    s_waitcnt lgkmcnt(2)
    v_exp_f32 v18, v82
    v_add_f32 v4, v4, v16
    v_add_f32 v4, v4, v17
    v_mfma_f32_16x16x32_bf16 a[140:143], v[168:171], v[40:43], a[140:143]
    ds_read_b128 v[32:35], v2 offset:6144
    v_mfma_f32_16x16x32_bf16 a[140:143], v[184:187], v[44:47], a[140:143]
    v_exp_f32 v19, v83
    v_cvt_pk_bf16_f32 v80, v16, v17
    v_mfma_f32_16x16x32_bf16 a[188:191], v[172:175], v[40:43], a[188:191]
    ds_read_b128 v[36:39], v3 offset:6144
    v_mfma_f32_16x16x32_bf16 a[188:191], v[188:191], v[44:47], a[188:191]
    s_waitcnt lgkmcnt(2)
    v_exp_f32 v16, v112
    v_add_f32 v4, v4, v18
    v_add_f32 v4, v4, v19
    v_exp_f32 v17, v113
    v_cvt_pk_bf16_f32 v81, v18, v19
    v_exp_f32 v18, v114
    v_add_f32 v4, v4, v16
    v_add_f32 v4, v4, v17
    v_exp_f32 v19, v115
    v_cvt_pk_bf16_f32 v82, v16, v17
    v_exp_f32 v16, v84
    v_add_f32 v4, v4, v18
    v_add_f32 v4, v4, v19
    v_exp_f32 v17, v85
    v_cvt_pk_bf16_f32 v83, v18, v19
    v_exp_f32 v18, v86
    v_add_f32 v5, v5, v16
    v_add_f32 v5, v5, v17
    v_exp_f32 v19, v87
    v_cvt_pk_bf16_f32 v84, v16, v17
    v_exp_f32 v16, v116
    v_add_f32 v5, v5, v18
    v_add_f32 v5, v5, v19
    v_exp_f32 v17, v117
    v_cvt_pk_bf16_f32 v85, v18, v19
    v_exp_f32 v18, v118
    v_add_f32 v5, v5, v16
    v_add_f32 v5, v5, v17
    v_exp_f32 v19, v119
    v_cvt_pk_bf16_f32 v86, v16, v17
    v_add_f32 v5, v5, v18
    v_add_f32 v5, v5, v19
    v_cvt_pk_bf16_f32 v87, v18, v19
    v_mfma_f32_16x16x32_bf16 v[160:163], v[24:27], a[192:195], v[128:131]
    ds_read_b128 v[40:43], v2 offset:128
    v_bfe_u32 v53, v8, 4, 6
    v_mfma_f32_16x16x32_bf16 v[160:163], v[28:31], a[196:199], v[160:163]
    v_exp_f32 v16, v88
    v_mfma_f32_16x16x32_bf16 v[164:167], v[24:27], a[216:219], v[132:135]
    v_lshlrev_b32 v53, 2, v53
    v_cvt_f32_i32 v245, v245
    v_mfma_f32_16x16x32_bf16 v[164:167], v[28:31], a[220:223], v[164:167]
    buffer_load_dword v52, v53, s[20:23], 0 offen sc1
    v_mfma_f32_16x16x32_bf16 v[168:171], v[24:27], a[240:243], v[136:139]
    ds_read_b128 v[44:47], v3 offset:128
    v_fma_f32 v240, v240, v48, v50
    v_mfma_f32_16x16x32_bf16 v[168:171], v[28:31], a[244:247], v[168:171]
    v_exp_f32 v17, v89
    v_mfma_f32_16x16x32_bf16 v[172:175], v[24:27], v[200:203], v[140:143]
    v_exp_f32 v18, v90
    v_mfma_f32_16x16x32_bf16 v[172:175], v[28:31], v[204:207], v[172:175]
    s_waitcnt lgkmcnt(2)
    v_add_f32 v6, v6, v16
    v_add_f32 v6, v6, v17
    v_mfma_f32_16x16x32_bf16 v[96:99], v[32:35], a[192:195], v[128:131]
    ds_read_b128 v[24:27], v2 offset:6272
    v_fma_f32 v244, v244, v49, v51
    v_mfma_f32_16x16x32_bf16 v[96:99], v[36:39], a[196:199], v[96:99]
    s_add_u32 s33, s33, 196608
    v_exp_f32 v19, v91
    v_mfma_f32_16x16x32_bf16 v[100:103], v[32:35], a[216:219], v[132:135]
    s_sub_u32 s34, s33, 1572864
    v_cvt_pk_bf16_f32 v88, v16, v17
    v_fma_f32 v241, v241, v48, v50
    v_mfma_f32_16x16x32_bf16 v[100:103], v[36:39], a[220:223], v[100:103]
    s_min_u32 s33, s33, s34
    v_exp_f32 v16, v120
    v_mfma_f32_16x16x32_bf16 v[104:107], v[32:35], a[240:243], v[136:139]
    ds_read_b128 v[28:31], v3 offset:6272
    v_add_f32 v6, v6, v18
    v_mfma_f32_16x16x32_bf16 v[104:107], v[36:39], a[244:247], v[104:107]
    s_add_u32 s34, s33, 3072
    v_add_f32 v6, v6, v19
    v_fma_f32 v245, v245, v49, v51
    v_mfma_f32_16x16x32_bf16 v[108:111], v[32:35], v[200:203], v[140:143]
    v_exp_f32 v17, v121
    v_mfma_f32_16x16x32_bf16 v[108:111], v[36:39], v[204:207], v[108:111]
    s_waitcnt lgkmcnt(2)
    v_cvt_f32_i32 v242, v242
    v_cvt_pk_bf16_f32 v89, v18, v19
    v_mfma_f32_16x16x32_bf16 v[160:163], v[40:43], a[200:203], v[160:163]
    s_add_u32 s37, s37, 196608
    ds_read_b128 v[32:35], v2 offset:256
    v_cvt_f32_i32 v246, v246
    v_mfma_f32_16x16x32_bf16 v[160:163], v[44:47], a[204:207], v[160:163]
    s_add_u32 s80, s80, 196608
    v_exp_f32 v18, v122
    v_mfma_f32_16x16x32_bf16 v[164:167], v[40:43], a[224:227], v[164:167]
    v_add_f32 v6, v6, v16
    v_cvt_f32_i32 v243, v243
    v_mfma_f32_16x16x32_bf16 v[164:167], v[44:47], a[228:231], v[164:167]
    v_add_f32 v6, v6, v17
    v_cvt_f32_i32 v247, v247
    v_mfma_f32_16x16x32_bf16 v[168:171], v[40:43], a[248:251], v[168:171]
    ds_read_b128 v[36:39], v3 offset:256
    v_fma_f32 v242, v242, v48, v50
    v_mfma_f32_16x16x32_bf16 v[168:171], v[44:47], a[252:255], v[168:171]
    buffer_load_dwordx4 v[224:227], v9, s[64:67], s33 offen offset:0 nt
    v_mfma_f32_16x16x32_bf16 v[172:175], v[40:43], v[208:211], v[172:175]
    v_exp_f32 v19, v123
    v_mfma_f32_16x16x32_bf16 v[172:175], v[44:47], v[212:215], v[172:175]
    s_waitcnt lgkmcnt(2)
    v_cvt_pk_bf16_f32 v90, v16, v17
    v_fma_f32 v246, v246, v49, v51
    v_mfma_f32_16x16x32_bf16 v[96:99], v[24:27], a[200:203], v[96:99]
    ds_read_b128 v[40:43], v2 offset:6400
    v_mfma_f32_16x16x32_bf16 v[96:99], v[28:31], a[204:207], v[96:99]
    buffer_load_dwordx4 v[228:231], v9, s[64:67], s33 offen offset:1536 nt
    v_mfma_f32_16x16x32_bf16 v[100:103], v[24:27], a[224:227], v[100:103]
    v_exp_f32 v16, v92
    v_mfma_f32_16x16x32_bf16 v[100:103], v[28:31], a[228:231], v[100:103]
    v_add_f32 v6, v6, v18
    v_add_f32 v6, v6, v19
    v_mfma_f32_16x16x32_bf16 v[104:107], v[24:27], a[248:251], v[104:107]
    ds_read_b128 v[44:47], v3 offset:6400
    v_fma_f32 v243, v243, v48, v50
    v_mfma_f32_16x16x32_bf16 v[104:107], v[28:31], a[252:255], v[104:107]
    buffer_load_dwordx4 v[232:235], v9, s[64:67], s34 offen offset:0 nt
    v_mfma_f32_16x16x32_bf16 v[108:111], v[24:27], v[208:211], v[108:111]
    s_add_u32 s29, s30, 49152
    v_exp_f32 v17, v93
    v_mfma_f32_16x16x32_bf16 v[108:111], v[28:31], v[212:215], v[108:111]
    s_waitcnt lgkmcnt(2)
    v_cvt_pk_bf16_f32 v91, v18, v19
    v_fma_f32 v247, v247, v49, v51
    v_mfma_f32_16x16x32_bf16 v[160:163], v[32:35], a[208:211], v[160:163]
    s_sub_u32 s3, s29, 147456
    ds_read_b128 v[24:27], v2 offset:12288
    v_mfma_f32_16x16x32_bf16 v[160:163], v[36:39], a[212:215], v[160:163]
    buffer_load_dwordx4 v[236:239], v9, s[64:67], s34 offen offset:1536 nt
    v_mfma_f32_16x16x32_bf16 v[164:167], v[32:35], a[232:235], v[164:167]
    v_exp_f32 v18, v94
    v_mfma_f32_16x16x32_bf16 v[164:167], v[36:39], a[236:239], v[164:167]
    v_add_f32 v7, v7, v16
    v_add_f32 v7, v7, v17
    v_mfma_f32_16x16x32_bf16 v[168:171], v[32:35], v[192:195], v[168:171]
    ds_read_b128 v[28:31], v3 offset:12288
    v_mfma_f32_16x16x32_bf16 v[168:171], v[36:39], v[196:199], v[168:171]
    v_exp_f32 v19, v95
    v_mfma_f32_16x16x32_bf16 v[172:175], v[32:35], v[216:219], v[172:175]
    s_min_u32 s29, s29, s3
    ds_read_b128 v[48:51], v10 offset:0
    v_cvt_pk_bf16_f32 v92, v16, v17
    v_mfma_f32_16x16x32_bf16 v[172:175], v[36:39], v[220:223], v[172:175]
    s_waitcnt lgkmcnt(3)
    v_exp_f32 v16, v124
    v_mfma_f32_16x16x32_bf16 v[96:99], v[40:43], a[208:211], v[96:99]
    ds_read_b128 v[32:35], v2 offset:18432
    v_add_f32 v7, v7, v18
    v_mfma_f32_16x16x32_bf16 v[96:99], v[44:47], a[212:215], v[96:99]
    v_add_f32 v7, v7, v19
    v_cvt_pk_bf16_f32 v146, v240, v244
    v_mfma_f32_16x16x32_bf16 v[100:103], v[40:43], a[232:235], v[100:103]
    v_exp_f32 v17, v125
    v_mfma_f32_16x16x32_bf16 v[100:103], v[44:47], a[236:239], v[100:103]
    v_cvt_pk_bf16_f32 v93, v18, v19
    v_cvt_pk_bf16_f32 v150, v241, v245
    v_mfma_f32_16x16x32_bf16 v[104:107], v[40:43], v[192:195], v[104:107]
    s_sub_u32 s3, s29, s30
    ds_read_b128 v[36:39], v3 offset:18432
    v_cvt_pk_bf16_f32 v154, v242, v246
    v_mfma_f32_16x16x32_bf16 v[104:107], v[44:47], v[196:199], v[104:107]
    v_exp_f32 v18, v126
    v_mfma_f32_16x16x32_bf16 v[108:111], v[40:43], v[216:219], v[108:111]
    v_add_f32 v7, v7, v16
    v_add_f32 v7, v7, v17
    v_mfma_f32_16x16x32_bf16 v[108:111], v[44:47], v[220:223], v[108:111]
    s_waitcnt lgkmcnt(3)
    v_exp_f32 v19, v127
    v_mfma_f32_16x16x32_bf16 v[176:179], v[24:27], a[192:195], v[128:131]
    ds_read_b128 v[40:43], v2 offset:12416
    v_cvt_pk_bf16_f32 v94, v16, v17
    v_mfma_f32_16x16x32_bf16 v[176:179], v[28:31], a[196:199], v[176:179]
    v_add_f32 v7, v7, v18
    v_add_f32 v7, v7, v19
    v_mfma_f32_16x16x32_bf16 v[180:183], v[24:27], a[216:219], v[132:135]
    s_mov_b32 s30, s29
    v_cvt_pk_bf16_f32 v95, v18, v19
    v_cvt_pk_bf16_f32 v158, v243, v247
    v_mfma_f32_16x16x32_bf16 v[180:183], v[28:31], a[220:223], v[180:183]
    buffer_load_dwordx4 v[240:243], v9, s[64:67], s33 offen offset:384 nt
    buffer_load_dwordx4 v[244:247], v9, s[64:67], s33 offen offset:1920 nt
    v_mfma_f32_16x16x32_bf16 v[184:187], v[24:27], a[240:243], v[136:139]
    s_waitcnt vmcnt(22)
    ds_read_b128 v[44:47], v3 offset:12416
    v_cvt_f32_i32 v248, v248
    v_mfma_f32_16x16x32_bf16 v[184:187], v[28:31], a[244:247], v[184:187]
    s_waitcnt vmcnt(6)
    v_subrev_u32 v52, s92, v52
    v_cmp_lt_u32 vcc, 15, v52
    v_mfma_f32_16x16x32_bf16 v[188:191], v[24:27], v[200:203], v[140:143]
    v_exp_f32 v16, v160
    v_mfma_f32_16x16x32_bf16 v[188:191], v[28:31], v[204:207], v[188:191]
    s_waitcnt lgkmcnt(2)
    v_exp_f32 v17, v161
    v_mfma_f32_16x16x32_bf16 v[112:115], v[32:35], a[192:195], v[128:131]
    s_and_b32 s59, vcc_lo, 0xff
    ds_read_b128 v[24:27], v2 offset:18560
    v_cvt_f32_i32 v252, v252
    v_mfma_f32_16x16x32_bf16 v[112:115], v[36:39], a[196:199], v[112:115]
    s_cbranch_scc1 L_pollslow0
L_pollok0:
    v_mfma_f32_16x16x32_bf16 v[116:119], v[32:35], a[216:219], v[132:135]
    s_add_u32 s92, s92, 1
    v_exp_f32 v18, v162
    v_mfma_f32_16x16x32_bf16 v[116:119], v[36:39], a[220:223], v[116:119]
    s_mov_b32 m0, s26
    v_add_f32 v4, v4, v16
    v_cvt_f32_i32 v249, v249
    v_mfma_f32_16x16x32_bf16 v[120:123], v[32:35], a[240:243], v[136:139]
    ds_read_b128 v[28:31], v3 offset:18560
    v_add_f32 v4, v4, v17
    v_mfma_f32_16x16x32_bf16 v[120:123], v[36:39], a[244:247], v[120:123]
    buffer_load_dwordx4 v8, s[4:7], s32 offen offset:0 sc1 lds
    v_mfma_f32_16x16x32_bf16 v[124:127], v[32:35], v[200:203], v[140:143]
    v_exp_f32 v19, v163
    v_mfma_f32_16x16x32_bf16 v[124:127], v[36:39], v[204:207], v[124:127]
    s_waitcnt lgkmcnt(2)
    v_cvt_pk_bf16_f32 v160, v16, v17
    v_cvt_f32_i32 v253, v253
    v_mfma_f32_16x16x32_bf16 v[176:179], v[40:43], a[200:203], v[176:179]
    ds_read_b128 v[32:35], v2 offset:12544
    v_fma_f32 v248, v248, v56, v58
    v_mfma_f32_16x16x32_bf16 v[176:179], v[44:47], a[204:207], v[176:179]
    buffer_load_dwordx4 v8, s[4:7], s32 offen offset:1024 sc1 lds
    v_mfma_f32_16x16x32_bf16 v[180:183], v[40:43], a[224:227], v[180:183]
    v_exp_f32 v16, v96
    v_mfma_f32_16x16x32_bf16 v[180:183], v[44:47], a[228:231], v[180:183]
    v_add_f32 v4, v4, v18
    v_add_f32 v4, v4, v19
    v_mfma_f32_16x16x32_bf16 v[184:187], v[40:43], a[248:251], v[184:187]
    ds_read_b128 v[36:39], v3 offset:12544
    v_fma_f32 v252, v252, v57, v59
    v_mfma_f32_16x16x32_bf16 v[184:187], v[44:47], a[252:255], v[184:187]
    buffer_load_dwordx4 v8, s[4:7], s32 offen offset:2048 sc1 lds
    v_mfma_f32_16x16x32_bf16 v[188:191], v[40:43], v[208:211], v[188:191]
    v_exp_f32 v17, v97
    v_mfma_f32_16x16x32_bf16 v[188:191], v[44:47], v[212:215], v[188:191]
    s_waitcnt lgkmcnt(2)
    v_cvt_pk_bf16_f32 v161, v18, v19
    v_exp_f32 v18, v98
    v_mfma_f32_16x16x32_bf16 v[112:115], v[24:27], a[200:203], v[112:115]
    s_add_u32 s32, s32, 24576
    ds_read_b128 v[40:43], v2 offset:18688
    v_add_f32 v4, v4, v16
    v_mfma_f32_16x16x32_bf16 v[112:115], v[28:31], a[204:207], v[112:115]
    v_add_f32 v4, v4, v17
    v_add_u32 v1, s3, v1
    v_mfma_f32_16x16x32_bf16 v[116:119], v[24:27], a[224:227], v[116:119]
    s_add_u32 s26, s26, 12288
    v_exp_f32 v19, v99
    v_mfma_f32_16x16x32_bf16 v[116:119], v[28:31], a[228:231], v[116:119]
    v_cvt_pk_bf16_f32 v162, v16, v17
    v_add_u32 v21, s3, v21
    v_mfma_f32_16x16x32_bf16 v[120:123], v[24:27], a[248:251], v[120:123]
    ds_read_b128 v[44:47], v3 offset:18688
    v_add_u32 v22, s3, v22
    v_mfma_f32_16x16x32_bf16 v[120:123], v[28:31], a[252:255], v[120:123]
    s_waitcnt lgkmcnt(2)
    v_exp_f32 v16, v164
    v_fma_f32 v249, v249, v56, v58
    v_mfma_f32_16x16x32_bf16 v[124:127], v[24:27], v[208:211], v[124:127]
    s_waitcnt vmcnt(15)
    v_add_f32 v4, v4, v18
    v_add_f32 v4, v4, v19
    v_mfma_f32_16x16x32_bf16 v[124:127], v[28:31], v[212:215], v[124:127]
    s_barrier
    v_exp_f32 v17, v165
    v_mfma_f32_16x16x32_bf16 v[176:179], v[32:35], a[208:211], v[176:179]
    s_mov_b32 m0, s26
    ds_read_b128 v[24:27], v1 offset:0
    v_fma_f32 v253, v253, v57, v59
    v_mfma_f32_16x16x32_bf16 v[176:179], v[36:39], a[212:215], v[176:179]
    buffer_load_dwordx4 v8, s[4:7], s32 offen offset:0 sc1 lds
    v_cvt_pk_bf16_f32 v163, v18, v19
    v_mfma_f32_16x16x32_bf16 v[180:183], v[32:35], a[232:235], v[180:183]
    v_exp_f32 v18, v166
    v_mfma_f32_16x16x32_bf16 v[180:183], v[36:39], a[236:239], v[180:183]
    v_cvt_f32_i32 v250, v250
    v_add_f32 v5, v5, v16
    v_cvt_f32_i32 v254, v254
    v_mfma_f32_16x16x32_bf16 v[184:187], v[32:35], v[192:195], v[184:187]
    ds_read_b128 v[28:31], v1 offset:12288
    v_add_f32 v5, v5, v17
    v_mfma_f32_16x16x32_bf16 v[184:187], v[36:39], v[196:199], v[184:187]
    buffer_load_dwordx4 v8, s[4:7], s32 offen offset:1024 sc1 lds
    v_mfma_f32_16x16x32_bf16 v[188:191], v[32:35], v[216:219], v[188:191]
    v_exp_f32 v19, v167
    v_mfma_f32_16x16x32_bf16 v[188:191], v[36:39], v[220:223], v[188:191]
    s_waitcnt lgkmcnt(2)
    v_cvt_pk_bf16_f32 v164, v16, v17
    v_exp_f32 v16, v100
    v_mfma_f32_16x16x32_bf16 v[112:115], v[40:43], a[208:211], v[112:115]
    ds_read_b128 v[32:35], v1 offset:768
    v_cvt_f32_i32 v251, v251
    v_mfma_f32_16x16x32_bf16 v[112:115], v[44:47], a[212:215], v[112:115]
    buffer_load_dwordx4 v8, s[4:7], s32 offen offset:2048 sc1 lds
    v_add_f32 v5, v5, v18
    v_mfma_f32_16x16x32_bf16 v[116:119], v[40:43], a[232:235], v[116:119]
    v_add_f32 v5, v5, v19
    v_cvt_f32_i32 v255, v255
    v_mfma_f32_16x16x32_bf16 v[116:119], v[44:47], a[236:239], v[116:119]
    v_exp_f32 v17, v101
    v_fma_f32 v250, v250, v56, v58
    v_mfma_f32_16x16x32_bf16 v[120:123], v[40:43], v[192:195], v[120:123]
    ds_read_b128 v[36:39], v1 offset:13056
    v_cvt_pk_bf16_f32 v165, v18, v19
    v_mfma_f32_16x16x32_bf16 v[120:123], v[44:47], v[196:199], v[120:123]
    v_exp_f32 v18, v102
    v_fma_f32 v254, v254, v57, v59
    v_mfma_f32_16x16x32_bf16 v[124:127], v[40:43], v[216:219], v[124:127]
    s_add_u32 s32, s32, 24576
    v_add_f32 v5, v5, v16
    v_add_f32 v5, v5, v17
    v_mfma_f32_16x16x32_bf16 v[124:127], v[44:47], v[220:223], v[124:127]
    s_waitcnt lgkmcnt(2)
    v_exp_f32 v19, v103
    v_fma_f32 v251, v251, v56, v58
    v_fma_f32 v255, v255, v57, v59
    v_cvt_pk_bf16_f32 v166, v16, v17
    v_cvt_pk_bf16_f32 v147, v248, v252
    v_add_f32 v5, v5, v18
    s_add_u32 s26, s26, 36864
    v_cvt_pk_bf16_f32 v151, v249, v253
    v_add_f32 v5, v5, v19
    s_sub_u32 s57, s26, 147456
    v_cvt_pk_bf16_f32 v155, v250, v254
    v_cvt_pk_bf16_f32 v167, v18, v19
    s_min_u32 s26, s26, s57
    v_cvt_pk_bf16_f32 v159, v251, v255
    v_mfma_f32_16x16x32_bf16 a[0:3], v[64:67], v[24:27], a[0:3]
    ds_read_b128 v[40:43], v1 offset:1536
    v_mfma_f32_16x16x32_bf16 a[0:3], v[80:83], v[28:31], a[0:3]
    buffer_store_dwordx4 v[144:147], v20, s[4:7], s81 offen offset:0 sc1
    v_mfma_f32_16x16x32_bf16 a[48:51], v[68:71], v[24:27], a[48:51]
    v_exp_f32 v16, v168
    v_mfma_f32_16x16x32_bf16 a[48:51], v[84:87], v[28:31], a[48:51]
    v_exp_f32 v17, v169
    v_mfma_f32_16x16x32_bf16 a[96:99], v[72:75], v[24:27], a[96:99]
    ds_read_b128 v[44:47], v1 offset:13824
    v_mfma_f32_16x16x32_bf16 a[96:99], v[88:91], v[28:31], a[96:99]
    v_exp_f32 v18, v170
    v_mfma_f32_16x16x32_bf16 a[144:147], v[76:79], v[24:27], a[144:147]
    v_add_f32 v6, v6, v16
    v_add_f32 v6, v6, v17
    v_mfma_f32_16x16x32_bf16 a[144:147], v[92:95], v[28:31], a[144:147]
    s_waitcnt lgkmcnt(2)
    v_exp_f32 v19, v171
    v_mfma_f32_16x16x32_bf16 a[4:7], v[64:67], v[32:35], a[4:7]
    ds_read_b128 v[24:27], v1 offset:2304
    v_cvt_pk_bf16_f32 v168, v16, v17
    v_mfma_f32_16x16x32_bf16 a[4:7], v[80:83], v[36:39], a[4:7]
    buffer_store_dwordx4 v[148:151], v20, s[4:7], s81 offen offset:768 sc1
    v_mfma_f32_16x16x32_bf16 a[52:55], v[68:71], v[32:35], a[52:55]
    v_exp_f32 v16, v104
    v_mfma_f32_16x16x32_bf16 a[52:55], v[84:87], v[36:39], a[52:55]
    v_add_f32 v6, v6, v18
    v_add_f32 v6, v6, v19
    v_mfma_f32_16x16x32_bf16 a[100:103], v[72:75], v[32:35], a[100:103]
    ds_read_b128 v[28:31], v1 offset:14592
    v_mfma_f32_16x16x32_bf16 a[100:103], v[88:91], v[36:39], a[100:103]
    v_exp_f32 v17, v105
    v_mfma_f32_16x16x32_bf16 a[148:151], v[76:79], v[32:35], a[148:151]
    v_cvt_pk_bf16_f32 v169, v18, v19
    v_mfma_f32_16x16x32_bf16 a[148:151], v[92:95], v[36:39], a[148:151]
    s_waitcnt lgkmcnt(2)
    v_exp_f32 v18, v106
    v_mfma_f32_16x16x32_bf16 a[8:11], v[64:67], v[40:43], a[8:11]
    ds_read_b128 v[32:35], v21 offset:0
    v_add_f32 v6, v6, v16
    v_mfma_f32_16x16x32_bf16 a[8:11], v[80:83], v[44:47], a[8:11]
    buffer_store_dwordx4 v[152:155], v20, s[4:7], s81 offen offset:1536 sc1
    v_mfma_f32_16x16x32_bf16 a[56:59], v[68:71], v[40:43], a[56:59]
    v_add_f32 v6, v6, v17
    v_mfma_f32_16x16x32_bf16 a[56:59], v[84:87], v[44:47], a[56:59]
    v_exp_f32 v19, v107
    v_mfma_f32_16x16x32_bf16 a[104:107], v[72:75], v[40:43], a[104:107]
    ds_read_b128 v[36:39], v21 offset:12288
    v_cvt_pk_bf16_f32 v170, v16, v17
    v_mfma_f32_16x16x32_bf16 a[104:107], v[88:91], v[44:47], a[104:107]
    v_exp_f32 v16, v172
    v_mfma_f32_16x16x32_bf16 a[152:155], v[76:79], v[40:43], a[152:155]
    v_add_f32 v6, v6, v18
    v_mfma_f32_16x16x32_bf16 a[152:155], v[92:95], v[44:47], a[152:155]
    s_waitcnt lgkmcnt(2)
    v_add_f32 v6, v6, v19
    v_mfma_f32_16x16x32_bf16 a[12:15], v[64:67], v[24:27], a[12:15]
    ds_read_b128 v[40:43], v21 offset:768
    v_mfma_f32_16x16x32_bf16 a[12:15], v[80:83], v[28:31], a[12:15]
    buffer_store_dwordx4 v[156:159], v20, s[4:7], s81 offen offset:2304 sc1
    v_mfma_f32_16x16x32_bf16 a[60:63], v[68:71], v[24:27], a[60:63]
    v_exp_f32 v17, v173
    v_mfma_f32_16x16x32_bf16 a[60:63], v[84:87], v[28:31], a[60:63]
    v_cvt_pk_bf16_f32 v171, v18, v19
    v_mfma_f32_16x16x32_bf16 a[108:111], v[72:75], v[24:27], a[108:111]
    ds_read_b128 v[44:47], v21 offset:13056
    v_mfma_f32_16x16x32_bf16 a[108:111], v[88:91], v[28:31], a[108:111]
    v_exp_f32 v18, v174
    v_mfma_f32_16x16x32_bf16 a[156:159], v[76:79], v[24:27], a[156:159]
    s_add_u32 s29, s28, 49152
    v_add_f32 v7, v7, v16
    v_add_f32 v7, v7, v17
    v_mfma_f32_16x16x32_bf16 a[156:159], v[92:95], v[28:31], a[156:159]
    s_waitcnt lgkmcnt(2)
    v_exp_f32 v19, v175
    v_mfma_f32_16x16x32_bf16 a[16:19], v[64:67], v[32:35], a[16:19]
    ds_read_b128 v[24:27], v21 offset:1536
    v_cvt_pk_bf16_f32 v172, v16, v17
    v_mfma_f32_16x16x32_bf16 a[16:19], v[80:83], v[36:39], a[16:19]
    s_sub_u32 s3, s29, 147456
    ds_read_b128 v[56:59], v10 offset:384
    s_waitcnt vmcnt(14)
    v_mfma_f32_16x16x32_bf16 a[64:67], v[68:71], v[32:35], a[64:67]
    s_mov_b32 m0, s26
    v_exp_f32 v16, v108
    v_mfma_f32_16x16x32_bf16 a[64:67], v[84:87], v[36:39], a[64:67]
    v_add_f32 v7, v7, v18
    v_cvt_f32_i32 v224, v224
    v_mfma_f32_16x16x32_bf16 a[112:115], v[72:75], v[32:35], a[112:115]
    ds_read_b128 v[28:31], v21 offset:13824
    v_add_f32 v7, v7, v19
    v_mfma_f32_16x16x32_bf16 a[112:115], v[88:91], v[36:39], a[112:115]
    buffer_load_dwordx4 v8, s[4:7], s32 offen offset:0 sc1 lds
    v_mfma_f32_16x16x32_bf16 a[160:163], v[76:79], v[32:35], a[160:163]
    v_exp_f32 v17, v109
    v_mfma_f32_16x16x32_bf16 a[160:163], v[92:95], v[36:39], a[160:163]
    s_waitcnt lgkmcnt(3)
    v_cvt_pk_bf16_f32 v173, v18, v19
    v_cvt_f32_i32 v225, v225
    v_mfma_f32_16x16x32_bf16 a[20:23], v[64:67], v[40:43], a[20:23]
    s_min_u32 s29, s29, s3
    ds_read_b128 v[32:35], v21 offset:2304
    v_cvt_f32_i32 v228, v228
    v_mfma_f32_16x16x32_bf16 a[20:23], v[80:83], v[44:47], a[20:23]
    v_exp_f32 v18, v110
    v_mfma_f32_16x16x32_bf16 a[68:71], v[68:71], v[40:43], a[68:71]
    v_add_f32 v7, v7, v16
    v_add_f32 v7, v7, v17
    v_mfma_f32_16x16x32_bf16 a[68:71], v[84:87], v[44:47], a[68:71]
    buffer_load_dwordx4 v8, s[4:7], s32 offen offset:1024 sc1 lds
    v_mfma_f32_16x16x32_bf16 a[116:119], v[72:75], v[40:43], a[116:119]
    ds_read_b128 v[36:39], v21 offset:14592
    v_mfma_f32_16x16x32_bf16 a[116:119], v[88:91], v[44:47], a[116:119]
    v_exp_f32 v19, v111
    v_mfma_f32_16x16x32_bf16 a[164:167], v[76:79], v[40:43], a[164:167]
    s_sub_u32 s3, s29, s28
    ds_read_b128 v[60:63], v10 offset:768
    v_cvt_pk_bf16_f32 v174, v16, v17
    v_mfma_f32_16x16x32_bf16 a[164:167], v[92:95], v[44:47], a[164:167]
    s_waitcnt lgkmcnt(3)
    v_exp_f32 v16, v176
    v_mfma_f32_16x16x32_bf16 a[24:27], v[64:67], v[24:27], a[24:27]
    ds_read_b128 v[40:43], v22 offset:0
    v_add_f32 v7, v7, v18
    v_mfma_f32_16x16x32_bf16 a[24:27], v[80:83], v[28:31], a[24:27]
    buffer_load_dwordx4 v8, s[4:7], s32 offen offset:2048 sc1 lds
    v_mfma_f32_16x16x32_bf16 a[72:75], v[68:71], v[24:27], a[72:75]
    v_add_f32 v7, v7, v19
    v_cvt_f32_i32 v229, v229
    v_mfma_f32_16x16x32_bf16 a[72:75], v[84:87], v[28:31], a[72:75]
    v_exp_f32 v17, v177
    v_mfma_f32_16x16x32_bf16 a[120:123], v[72:75], v[24:27], a[120:123]
    s_add_u32 s32, s32, 24576
    ds_read_b128 v[44:47], v22 offset:12288
    v_cvt_pk_bf16_f32 v175, v18, v19
    v_mfma_f32_16x16x32_bf16 a[120:123], v[88:91], v[28:31], a[120:123]
    s_mov_b32 s28, s29
    v_fma_f32 v224, v224, v48, v50
    v_fma_f32 v225, v225, v49, v51
    v_mfma_f32_16x16x32_bf16 a[168:171], v[76:79], v[24:27], a[168:171]
    v_exp_f32 v18, v178
    v_mfma_f32_16x16x32_bf16 a[168:171], v[92:95], v[28:31], a[168:171]
    s_waitcnt lgkmcnt(3)
    v_add_f32 v4, v4, v16
    v_add_f32 v4, v4, v17
    v_mfma_f32_16x16x32_bf16 a[28:31], v[64:67], v[32:35], a[28:31]
    s_add_u32 s26, s26, 12288
    ds_read_b128 v[24:27], v22 offset:768
    v_fma_f32 v228, v228, v48, v50
    v_mfma_f32_16x16x32_bf16 a[28:31], v[80:83], v[36:39], a[28:31]
    s_mov_b32 m0, s26
    v_exp_f32 v19, v179
    v_mfma_f32_16x16x32_bf16 a[76:79], v[68:71], v[32:35], a[76:79]
    v_cvt_pk_bf16_f32 v176, v16, v17
    v_fma_f32 v229, v229, v49, v51
    v_mfma_f32_16x16x32_bf16 a[76:79], v[84:87], v[36:39], a[76:79]
    v_exp_f32 v16, v112
    v_mfma_f32_16x16x32_bf16 a[124:127], v[72:75], v[32:35], a[124:127]
    ds_read_b128 v[28:31], v22 offset:13056
    v_add_f32 v4, v4, v18
    v_mfma_f32_16x16x32_bf16 a[124:127], v[88:91], v[36:39], a[124:127]
    v_cvt_pk_bf16_f32 v224, v224, v225
    v_add_f32 v4, v4, v19
    v_mfma_f32_16x16x32_bf16 a[172:175], v[76:79], v[32:35], a[172:175]
    v_exp_f32 v17, v113
    v_mfma_f32_16x16x32_bf16 a[172:175], v[92:95], v[36:39], a[172:175]
    s_waitcnt lgkmcnt(2)
    buffer_load_dwordx4 v8, s[4:7], s32 offen offset:0 sc1 lds
    v_mfma_f32_16x16x32_bf16 a[32:35], v[64:67], v[40:43], a[32:35]
    ds_read_b128 v[32:35], v22 offset:1536
    v_cvt_pk_bf16_f32 v228, v228, v229
    v_mfma_f32_16x16x32_bf16 a[32:35], v[80:83], v[44:47], a[32:35]
    v_cvt_pk_bf16_f32 v177, v18, v19
    v_cvt_f32_i32 v226, v226
    v_mfma_f32_16x16x32_bf16 a[80:83], v[68:71], v[40:43], a[80:83]
    v_exp_f32 v18, v114
    v_mfma_f32_16x16x32_bf16 a[80:83], v[84:87], v[44:47], a[80:83]
    buffer_load_dwordx4 v8, s[4:7], s32 offen offset:1024 sc1 lds
    v_mfma_f32_16x16x32_bf16 a[128:131], v[72:75], v[40:43], a[128:131]
    ds_read_b128 v[36:39], v22 offset:13824
    v_add_f32 v4, v4, v16
    v_mfma_f32_16x16x32_bf16 a[128:131], v[88:91], v[44:47], a[128:131]
    v_add_f32 v4, v4, v17
    v_cvt_f32_i32 v227, v227
    v_mfma_f32_16x16x32_bf16 a[176:179], v[76:79], v[40:43], a[176:179]
    v_exp_f32 v19, v115
    v_mfma_f32_16x16x32_bf16 a[176:179], v[92:95], v[44:47], a[176:179]
    s_waitcnt lgkmcnt(2)
    v_cvt_pk_bf16_f32 v178, v16, v17
    v_cvt_f32_i32 v230, v230
    v_mfma_f32_16x16x32_bf16 a[36:39], v[64:67], v[24:27], a[36:39]
    ds_read_b128 v[40:43], v22 offset:2304
    v_add_u32 v2, s3, v2
    v_mfma_f32_16x16x32_bf16 a[36:39], v[80:83], v[28:31], a[36:39]
    buffer_load_dwordx4 v8, s[4:7], s32 offen offset:2048 sc1 lds
    v_mfma_f32_16x16x32_bf16 a[84:87], v[68:71], v[24:27], a[84:87]
    v_exp_f32 v16, v180
    v_mfma_f32_16x16x32_bf16 a[84:87], v[84:87], v[28:31], a[84:87]
    v_add_f32 v4, v4, v18
    v_add_f32 v4, v4, v19
    v_mfma_f32_16x16x32_bf16 a[132:135], v[72:75], v[24:27], a[132:135]
    ds_read_b128 v[44:47], v22 offset:14592
    v_add_u32 v3, s3, v3
    v_mfma_f32_16x16x32_bf16 a[132:135], v[88:91], v[28:31], a[132:135]
    s_waitcnt lgkmcnt(2)
    v_exp_f32 v17, v181
    v_mfma_f32_16x16x32_bf16 a[180:183], v[76:79], v[24:27], a[180:183]
    s_waitcnt vmcnt(6)
    v_cvt_pk_bf16_f32 v179, v18, v19
    v_cvt_f32_i32 v231, v231
    v_mfma_f32_16x16x32_bf16 a[180:183], v[92:95], v[28:31], a[180:183]
    s_barrier
    v_fma_f32 v226, v226, v56, v58
    v_mfma_f32_16x16x32_bf16 a[40:43], v[64:67], v[32:35], a[40:43]
    s_add_u32 s32, s32, 24576
    ds_read_b128 v[24:27], v2 offset:0
    v_fma_f32 v227, v227, v57, v59
    v_mfma_f32_16x16x32_bf16 a[40:43], v[80:83], v[36:39], a[40:43]
    s_add_u32 s26, s26, 36864
    v_exp_f32 v18, v182
    v_mfma_f32_16x16x32_bf16 a[88:91], v[68:71], v[32:35], a[88:91]
    v_add_f32 v5, v5, v16
    v_add_f32 v5, v5, v17
    v_mfma_f32_16x16x32_bf16 a[88:91], v[84:87], v[36:39], a[88:91]
    s_sub_u32 s57, s26, 147456
    v_exp_f32 v19, v183
    v_mfma_f32_16x16x32_bf16 a[136:139], v[72:75], v[32:35], a[136:139]
    ds_read_b128 v[28:31], v3 offset:0
    v_cvt_pk_bf16_f32 v180, v16, v17
    v_mfma_f32_16x16x32_bf16 a[136:139], v[88:91], v[36:39], a[136:139]
    buffer_load_dwordx4 v[248:251], v9, s[64:67], s34 offen offset:384 nt
    v_mfma_f32_16x16x32_bf16 a[184:187], v[76:79], v[32:35], a[184:187]
    s_min_u32 s26, s26, s57
    v_exp_f32 v16, v116
    v_mfma_f32_16x16x32_bf16 a[184:187], v[92:95], v[36:39], a[184:187]
    s_waitcnt lgkmcnt(2)
    v_add_f32 v5, v5, v18
    v_fma_f32 v230, v230, v56, v58
    v_mfma_f32_16x16x32_bf16 a[44:47], v[64:67], v[40:43], a[44:47]
    ds_read_b128 v[32:35], v2 offset:6144
    v_add_f32 v5, v5, v19
    v_mfma_f32_16x16x32_bf16 a[44:47], v[80:83], v[44:47], a[44:47]
    buffer_load_dwordx4 v[252:255], v9, s[64:67], s34 offen offset:1920 nt
    v_mfma_f32_16x16x32_bf16 a[92:95], v[68:71], v[40:43], a[92:95]
    v_exp_f32 v17, v117
    v_mfma_f32_16x16x32_bf16 a[92:95], v[84:87], v[44:47], a[92:95]
    v_cvt_pk_bf16_f32 v181, v18, v19
    v_fma_f32 v231, v231, v57, v59
    v_mfma_f32_16x16x32_bf16 a[140:143], v[72:75], v[40:43], a[140:143]
    ds_read_b128 v[36:39], v3 offset:6144
    v_cvt_pk_bf16_f32 v225, v226, v227
    v_mfma_f32_16x16x32_bf16 a[140:143], v[88:91], v[44:47], a[140:143]
    v_add_u32 v55, 1, v55
    buffer_store_dword v55, v13, s[20:23], 0 offen sc1
    v_mfma_f32_16x16x32_bf16 a[188:191], v[76:79], v[40:43], a[188:191]
    v_exp_f32 v18, v118
    v_mfma_f32_16x16x32_bf16 a[188:191], v[92:95], v[44:47], a[188:191]
    s_waitcnt lgkmcnt(2)
    v_add_f32 v5, v5, v16
    v_add_f32 v5, v5, v17
    v_exp_f32 v19, v119
    v_cvt_pk_bf16_f32 v229, v230, v231
    s_waitcnt vmcnt(21)
    v_cvt_pk_bf16_f32 v182, v16, v17
    v_cvt_f32_i32 v232, v232
    v_add_f32 v5, v5, v18
    v_cvt_f32_i32 v233, v233
    v_add_f32 v5, v5, v19
    v_cvt_f32_i32 v236, v236
    v_cvt_pk_bf16_f32 v183, v18, v19
    v_cvt_f32_i32 v237, v237
    s_branch L_skip4
L_pad4:
    s_branch L_tb1_10
L_skip4:
    v_mfma_f32_16x16x32_bf16 v[64:67], v[24:27], a[192:195], v[128:131]
    ds_read_b128 v[40:43], v2 offset:128
    s_add_u32 s35, s35, 196608
    v_mfma_f32_16x16x32_bf16 v[64:67], v[28:31], a[196:199], v[64:67]
    s_sub_u32 s36, s35, 1572864
    v_exp_f32 v16, v184
    v_mfma_f32_16x16x32_bf16 v[68:71], v[24:27], a[216:219], v[132:135]
    v_exp_f32 v17, v185
    v_mfma_f32_16x16x32_bf16 v[68:71], v[28:31], a[220:223], v[68:71]
    s_min_u32 s35, s35, s36
    v_fma_f32 v232, v232, v48, v50
    v_fma_f32 v233, v233, v49, v51
    v_mfma_f32_16x16x32_bf16 v[72:75], v[24:27], a[240:243], v[136:139]
    ds_read_b128 v[44:47], v3 offset:128
    v_fma_f32 v236, v236, v48, v50
    v_mfma_f32_16x16x32_bf16 v[72:75], v[28:31], a[244:247], v[72:75]
    s_add_u32 s36, s35, 3072
    v_exp_f32 v18, v186
    v_mfma_f32_16x16x32_bf16 v[76:79], v[24:27], v[200:203], v[140:143]
    v_add_f32 v6, v6, v16
    v_add_f32 v6, v6, v17
    v_mfma_f32_16x16x32_bf16 v[76:79], v[28:31], v[204:207], v[76:79]
    s_waitcnt lgkmcnt(2)
    v_exp_f32 v19, v187
    v_mfma_f32_16x16x32_bf16 v[96:99], v[32:35], a[192:195], v[128:131]
    s_add_u32 s81, s81, 196608
    ds_read_b128 v[24:27], v2 offset:6272
    v_fma_f32 v237, v237, v49, v51
    v_mfma_f32_16x16x32_bf16 v[96:99], v[36:39], a[196:199], v[96:99]
    v_cvt_pk_bf16_f32 v184, v16, v17
    v_cvt_pk_bf16_f32 v232, v232, v233
    v_mfma_f32_16x16x32_bf16 v[100:103], v[32:35], a[216:219], v[132:135]
    v_exp_f32 v16, v120
    v_mfma_f32_16x16x32_bf16 v[100:103], v[36:39], a[220:223], v[100:103]
    buffer_load_dwordx4 v[144:147], v12, s[68:71], s35 offen offset:0 nt
    v_mfma_f32_16x16x32_bf16 v[104:107], v[32:35], a[240:243], v[136:139]
    ds_read_b128 v[28:31], v3 offset:6272
    v_add_f32 v6, v6, v18
    v_mfma_f32_16x16x32_bf16 v[104:107], v[36:39], a[244:247], v[104:107]
    v_add_f32 v6, v6, v19
    v_cvt_pk_bf16_f32 v236, v236, v237
    v_mfma_f32_16x16x32_bf16 v[108:111], v[32:35], v[200:203], v[140:143]
    v_exp_f32 v17, v121
    v_mfma_f32_16x16x32_bf16 v[108:111], v[36:39], v[204:207], v[108:111]
    s_waitcnt lgkmcnt(2)
    v_cvt_pk_bf16_f32 v185, v18, v19
    v_cvt_f32_i32 v234, v234
    v_mfma_f32_16x16x32_bf16 v[64:67], v[40:43], a[200:203], v[64:67]
    ds_read_b128 v[32:35], v2 offset:256
    v_mfma_f32_16x16x32_bf16 v[64:67], v[44:47], a[204:207], v[64:67]
    buffer_load_dwordx4 v[148:151], v12, s[68:71], s35 offen offset:768 nt
    v_mfma_f32_16x16x32_bf16 v[68:71], v[40:43], a[224:227], v[68:71]
    v_exp_f32 v18, v122
    v_mfma_f32_16x16x32_bf16 v[68:71], v[44:47], a[228:231], v[68:71]
    v_add_f32 v6, v6, v16
    v_add_f32 v6, v6, v17
    v_mfma_f32_16x16x32_bf16 v[72:75], v[40:43], a[248:251], v[72:75]
    ds_read_b128 v[36:39], v3 offset:256
    v_cvt_f32_i32 v235, v235
    v_mfma_f32_16x16x32_bf16 v[72:75], v[44:47], a[252:255], v[72:75]
    buffer_load_dwordx4 v[152:155], v12, s[68:71], s35 offen offset:1536 nt
    v_mfma_f32_16x16x32_bf16 v[76:79], v[40:43], v[208:211], v[76:79]
    v_exp_f32 v19, v123
    v_mfma_f32_16x16x32_bf16 v[76:79], v[44:47], v[212:215], v[76:79]
    s_waitcnt lgkmcnt(2)
    v_cvt_pk_bf16_f32 v186, v16, v17
    v_cvt_f32_i32 v238, v238
    v_mfma_f32_16x16x32_bf16 v[96:99], v[24:27], a[200:203], v[96:99]
    ds_read_b128 v[40:43], v2 offset:6400
    v_cvt_f32_i32 v239, v239
    v_mfma_f32_16x16x32_bf16 v[96:99], v[28:31], a[204:207], v[96:99]
    v_exp_f32 v16, v188
    v_mfma_f32_16x16x32_bf16 v[100:103], v[24:27], a[224:227], v[100:103]
    v_add_f32 v6, v6, v18
    v_add_f32 v6, v6, v19
    v_mfma_f32_16x16x32_bf16 v[100:103], v[28:31], a[228:231], v[100:103]
    buffer_load_dwordx4 v[156:159], v12, s[68:71], s35 offen offset:2304 nt
    v_mfma_f32_16x16x32_bf16 v[104:107], v[24:27], a[248:251], v[104:107]
    ds_read_b128 v[44:47], v3 offset:6400
    v_fma_f32 v234, v234, v56, v58
    v_mfma_f32_16x16x32_bf16 v[104:107], v[28:31], a[252:255], v[104:107]
    v_exp_f32 v17, v189
    v_mfma_f32_16x16x32_bf16 v[108:111], v[24:27], v[208:211], v[108:111]
    s_add_u32 s29, s30, 49152
    v_cvt_pk_bf16_f32 v187, v18, v19
    v_fma_f32 v235, v235, v57, v59
    v_mfma_f32_16x16x32_bf16 v[108:111], v[28:31], v[212:215], v[108:111]
    s_waitcnt lgkmcnt(2)
    v_exp_f32 v18, v190
    v_mfma_f32_16x16x32_bf16 v[64:67], v[32:35], a[208:211], v[64:67]
    s_mov_b32 m0, s26
    ds_read_b128 v[24:27], v2 offset:12288
    v_add_f32 v7, v7, v16
    v_mfma_f32_16x16x32_bf16 v[64:67], v[36:39], a[212:215], v[64:67]
    s_sub_u32 s3, s29, 147456
    buffer_load_dwordx4 v8, s[4:7], s32 offen offset:0 sc1 lds
    v_mfma_f32_16x16x32_bf16 v[68:71], v[32:35], a[232:235], v[68:71]
    v_add_f32 v7, v7, v17
    v_fma_f32 v238, v238, v56, v58
    v_mfma_f32_16x16x32_bf16 v[68:71], v[36:39], a[236:239], v[68:71]
    v_exp_f32 v19, v191
    v_mfma_f32_16x16x32_bf16 v[72:75], v[32:35], v[192:195], v[72:75]
    ds_read_b128 v[28:31], v3 offset:12288
    v_cvt_pk_bf16_f32 v188, v16, v17
    v_mfma_f32_16x16x32_bf16 v[72:75], v[36:39], v[196:199], v[72:75]
    buffer_load_dwordx4 v8, s[4:7], s32 offen offset:1024 sc1 lds
    v_mfma_f32_16x16x32_bf16 v[76:79], v[32:35], v[216:219], v[76:79]
    s_min_u32 s29, s29, s3
    v_exp_f32 v16, v124
    v_mfma_f32_16x16x32_bf16 v[76:79], v[36:39], v[220:223], v[76:79]
    s_waitcnt lgkmcnt(2)
    v_add_f32 v7, v7, v18
    v_add_f32 v7, v7, v19
    v_mfma_f32_16x16x32_bf16 v[96:99], v[40:43], a[208:211], v[96:99]
    ds_read_b128 v[32:35], v2 offset:18432
    v_fma_f32 v239, v239, v57, v59
    v_mfma_f32_16x16x32_bf16 v[96:99], v[44:47], a[212:215], v[96:99]
    buffer_load_dwordx4 v8, s[4:7], s32 offen offset:2048 sc1 lds
    v_mfma_f32_16x16x32_bf16 v[100:103], v[40:43], a[232:235], v[100:103]
    v_exp_f32 v17, v125
    v_mfma_f32_16x16x32_bf16 v[100:103], v[44:47], a[236:239], v[100:103]
    v_cvt_pk_bf16_f32 v189, v18, v19
    v_cvt_pk_bf16_f32 v233, v234, v235
    v_mfma_f32_16x16x32_bf16 v[104:107], v[40:43], v[192:195], v[104:107]
    s_add_u32 s32, s32, 24576
    ds_read_b128 v[36:39], v3 offset:18432
    v_cvt_pk_bf16_f32 v237, v238, v239
    v_mfma_f32_16x16x32_bf16 v[104:107], v[44:47], v[196:199], v[104:107]
    s_sub_u32 s3, s29, s30
    v_exp_f32 v18, v126
    v_mfma_f32_16x16x32_bf16 v[108:111], v[40:43], v[216:219], v[108:111]
    s_add_u32 s26, s26, 12288
    v_add_f32 v7, v7, v16
    v_add_f32 v7, v7, v17
    v_mfma_f32_16x16x32_bf16 v[108:111], v[44:47], v[220:223], v[108:111]
    s_waitcnt lgkmcnt(2)
    v_exp_f32 v19, v127
    v_mfma_f32_16x16x32_bf16 v[80:83], v[24:27], a[192:195], v[128:131]
    s_mov_b32 m0, s26
    ds_read_b128 v[40:43], v2 offset:12416
    v_cvt_pk_bf16_f32 v190, v16, v17
    v_mfma_f32_16x16x32_bf16 v[80:83], v[28:31], a[196:199], v[80:83]
    v_add_f32 v7, v7, v18
    v_add_f32 v7, v7, v19
    v_mfma_f32_16x16x32_bf16 v[84:87], v[24:27], a[216:219], v[132:135]
    s_mov_b32 s30, s29
    ds_read_b128 v[48:51], v10 offset:1152
    v_cvt_pk_bf16_f32 v191, v18, v19
    v_mfma_f32_16x16x32_bf16 v[84:87], v[28:31], a[220:223], v[84:87]
    s_waitcnt vmcnt(26)
    buffer_load_dwordx4 v8, s[4:7], s32 offen offset:0 sc1 lds
    v_mfma_f32_16x16x32_bf16 v[88:91], v[24:27], a[240:243], v[136:139]
    ds_read_b128 v[44:47], v3 offset:12416
    v_cvt_f32_i32 v240, v240
    v_mfma_f32_16x16x32_bf16 v[88:91], v[28:31], a[244:247], v[88:91]
    v_exp_f32 v16, v64
    v_mfma_f32_16x16x32_bf16 v[92:95], v[24:27], v[200:203], v[140:143]
    v_exp_f32 v17, v65
    v_mfma_f32_16x16x32_bf16 v[92:95], v[28:31], v[204:207], v[92:95]
    s_waitcnt lgkmcnt(3)
    buffer_load_dwordx4 v8, s[4:7], s32 offen offset:1024 sc1 lds
    v_mfma_f32_16x16x32_bf16 v[112:115], v[32:35], a[192:195], v[128:131]
    ds_read_b128 v[24:27], v2 offset:18560
    v_cvt_f32_i32 v241, v241
    v_mfma_f32_16x16x32_bf16 v[112:115], v[36:39], a[196:199], v[112:115]
    v_exp_f32 v18, v66
    v_mfma_f32_16x16x32_bf16 v[116:119], v[32:35], a[216:219], v[132:135]
    v_add_f32 v4, v4, v16
    v_add_f32 v4, v4, v17
    v_mfma_f32_16x16x32_bf16 v[116:119], v[36:39], a[220:223], v[116:119]
    buffer_load_dwordx4 v8, s[4:7], s32 offen offset:2048 sc1 lds
    v_mfma_f32_16x16x32_bf16 v[120:123], v[32:35], a[240:243], v[136:139]
    ds_read_b128 v[28:31], v3 offset:18560
    v_cvt_f32_i32 v244, v244
    v_mfma_f32_16x16x32_bf16 v[120:123], v[36:39], a[244:247], v[120:123]
    v_exp_f32 v19, v67
    v_mfma_f32_16x16x32_bf16 v[124:127], v[32:35], v[200:203], v[140:143]
    ds_read_b128 v[56:59], v23 offset:0
    v_cvt_pk_bf16_f32 v64, v16, v17
    v_mfma_f32_16x16x32_bf16 v[124:127], v[36:39], v[204:207], v[124:127]
    s_waitcnt lgkmcnt(3)
    v_exp_f32 v16, v96
    v_mfma_f32_16x16x32_bf16 v[80:83], v[40:43], a[200:203], v[80:83]
    s_add_u32 s32, s32, 24576
    ds_read_b128 v[32:35], v2 offset:12544
    v_add_f32 v4, v4, v18
    v_mfma_f32_16x16x32_bf16 v[80:83], v[44:47], a[204:207], v[80:83]
    s_add_u32 s26, s26, 36864
    v_add_f32 v4, v4, v19
    v_add_u32 v10, 1792, v10
    v_mfma_f32_16x16x32_bf16 v[84:87], v[40:43], a[224:227], v[84:87]
    v_exp_f32 v17, v97
    v_mfma_f32_16x16x32_bf16 v[84:87], v[44:47], a[228:231], v[84:87]
    s_sub_u32 s57, s26, 147456
    v_cvt_pk_bf16_f32 v65, v18, v19
    v_bfe_u32 v53, v8, 4, 6
    v_mfma_f32_16x16x32_bf16 v[88:91], v[40:43], a[248:251], v[88:91]
    ds_read_b128 v[36:39], v3 offset:12544
    v_add_u32 v1, s3, v1
    v_mfma_f32_16x16x32_bf16 v[88:91], v[44:47], a[252:255], v[88:91]
    v_exp_f32 v18, v98
    v_mfma_f32_16x16x32_bf16 v[92:95], v[40:43], v[208:211], v[92:95]
    s_min_u32 s26, s26, s57
    v_lshlrev_b32 v53, 2, v53
    v_add_f32 v4, v4, v16
    v_mfma_f32_16x16x32_bf16 v[92:95], v[44:47], v[212:215], v[92:95]
    s_waitcnt lgkmcnt(3)
    buffer_load_dword v52, v53, s[20:23], 0 offen sc1
    v_mfma_f32_16x16x32_bf16 v[112:115], v[24:27], a[200:203], v[112:115]
    ds_read_b128 v[40:43], v2 offset:18688
    v_add_f32 v4, v4, v17
    v_mfma_f32_16x16x32_bf16 v[112:115], v[28:31], a[204:207], v[112:115]
    v_exp_f32 v19, v99
    v_mfma_f32_16x16x32_bf16 v[116:119], v[24:27], a[224:227], v[116:119]
    v_cvt_pk_bf16_f32 v66, v16, v17
    v_add_u32 v21, s3, v21
    v_mfma_f32_16x16x32_bf16 v[116:119], v[28:31], a[228:231], v[116:119]
    v_exp_f32 v16, v68
    v_mfma_f32_16x16x32_bf16 v[120:123], v[24:27], a[248:251], v[120:123]
    ds_read_b128 v[44:47], v3 offset:18688
    v_add_u32 v22, s3, v22
    v_mfma_f32_16x16x32_bf16 v[120:123], v[28:31], a[252:255], v[120:123]
    s_waitcnt lgkmcnt(2)
    v_add_f32 v4, v4, v18
    v_cvt_f32_i32 v245, v245
    v_mfma_f32_16x16x32_bf16 v[124:127], v[24:27], v[208:211], v[124:127]
    s_waitcnt vmcnt(18)
    v_add_f32 v4, v4, v19
    v_fma_f32 v240, v240, v60, v62
    v_mfma_f32_16x16x32_bf16 v[124:127], v[28:31], v[212:215], v[124:127]
    s_barrier
    v_exp_f32 v17, v69
    v_mfma_f32_16x16x32_bf16 v[80:83], v[32:35], a[208:211], v[80:83]
    ds_read_b128 v[24:27], v1 offset:0
    v_cvt_pk_bf16_f32 v67, v18, v19
    v_mfma_f32_16x16x32_bf16 v[80:83], v[36:39], a[212:215], v[80:83]
    v_exp_f32 v18, v70
    v_mfma_f32_16x16x32_bf16 v[84:87], v[32:35], a[232:235], v[84:87]
    v_add_f32 v5, v5, v16
    v_fma_f32 v241, v241, v61, v63
    v_mfma_f32_16x16x32_bf16 v[84:87], v[36:39], a[236:239], v[84:87]
    v_add_f32 v5, v5, v17
    v_fma_f32 v244, v244, v60, v62
    v_mfma_f32_16x16x32_bf16 v[88:91], v[32:35], v[192:195], v[88:91]
    ds_read_b128 v[28:31], v1 offset:12288
    v_fma_f32 v245, v245, v61, v63
    v_mfma_f32_16x16x32_bf16 v[88:91], v[36:39], v[196:199], v[88:91]
    v_exp_f32 v19, v71
    v_mfma_f32_16x16x32_bf16 v[92:95], v[32:35], v[216:219], v[92:95]
    v_cvt_pk_bf16_f32 v68, v16, v17
    v_cvt_pk_bf16_f32 v226, v240, v241
    v_mfma_f32_16x16x32_bf16 v[92:95], v[36:39], v[220:223], v[92:95]
    s_waitcnt lgkmcnt(2)
    v_exp_f32 v16, v100
    v_mfma_f32_16x16x32_bf16 v[112:115], v[40:43], a[208:211], v[112:115]
    ds_read_b128 v[32:35], v1 offset:768
    v_add_f32 v5, v5, v18
    v_mfma_f32_16x16x32_bf16 v[112:115], v[44:47], a[212:215], v[112:115]
    v_add_f32 v5, v5, v19
    v_cvt_pk_bf16_f32 v230, v244, v245
    v_mfma_f32_16x16x32_bf16 v[116:119], v[40:43], a[232:235], v[116:119]
    v_exp_f32 v17, v101
    v_mfma_f32_16x16x32_bf16 v[116:119], v[44:47], a[236:239], v[116:119]
    v_cvt_pk_bf16_f32 v69, v18, v19
    v_cvt_f32_i32 v242, v242
    v_mfma_f32_16x16x32_bf16 v[120:123], v[40:43], v[192:195], v[120:123]
    ds_read_b128 v[36:39], v1 offset:13056
    v_cvt_f32_i32 v243, v243
    v_mfma_f32_16x16x32_bf16 v[120:123], v[44:47], v[196:199], v[120:123]
    v_exp_f32 v18, v102
    v_mfma_f32_16x16x32_bf16 v[124:127], v[40:43], v[216:219], v[124:127]
    v_add_f32 v5, v5, v16
    v_add_f32 v5, v5, v17
    v_mfma_f32_16x16x32_bf16 v[124:127], v[44:47], v[220:223], v[124:127]
    s_waitcnt lgkmcnt(2)
    v_exp_f32 v19, v103
    v_cvt_pk_bf16_f32 v70, v16, v17
    v_add_f32 v5, v5, v18
    v_cvt_f32_i32 v246, v246
    v_add_f32 v5, v5, v19
    v_cvt_f32_i32 v247, v247
    v_cvt_pk_bf16_f32 v71, v18, v19
    v_fma_f32 v242, v242, v48, v50
    v_mfma_f32_16x16x32_bf16 a[0:3], v[160:163], v[24:27], a[0:3]
    ds_read_b128 v[40:43], v1 offset:1536
    v_fma_f32 v243, v243, v49, v51
    v_mfma_f32_16x16x32_bf16 a[0:3], v[176:179], v[28:31], a[0:3]
    v_exp_f32 v16, v72
    v_mfma_f32_16x16x32_bf16 a[48:51], v[164:167], v[24:27], a[48:51]
    v_exp_f32 v17, v73
    v_mfma_f32_16x16x32_bf16 a[48:51], v[180:183], v[28:31], a[48:51]
    v_exp_f32 v18, v74
    v_mfma_f32_16x16x32_bf16 a[96:99], v[168:171], v[24:27], a[96:99]
    ds_read_b128 v[44:47], v1 offset:13824
    v_fma_f32 v246, v246, v48, v50
    v_mfma_f32_16x16x32_bf16 a[96:99], v[184:187], v[28:31], a[96:99]
    v_add_f32 v6, v6, v16
    v_add_f32 v6, v6, v17
    v_mfma_f32_16x16x32_bf16 a[144:147], v[172:175], v[24:27], a[144:147]
    v_exp_f32 v19, v75
    v_mfma_f32_16x16x32_bf16 a[144:147], v[188:191], v[28:31], a[144:147]
    s_waitcnt lgkmcnt(2)
    v_fma_f32 v247, v247, v49, v51
    v_mfma_f32_16x16x32_bf16 a[4:7], v[160:163], v[32:35], a[4:7]
    ds_read_b128 v[24:27], v1 offset:2304
    v_cvt_pk_bf16_f32 v72, v16, v17
    v_mfma_f32_16x16x32_bf16 a[4:7], v[176:179], v[36:39], a[4:7]
    v_exp_f32 v16, v104
    v_mfma_f32_16x16x32_bf16 a[52:55], v[164:167], v[32:35], a[52:55]
    v_cvt_pk_bf16_f32 v227, v242, v243
    v_add_f32 v6, v6, v18
    v_mfma_f32_16x16x32_bf16 a[52:55], v[180:183], v[36:39], a[52:55]
    v_add_f32 v6, v6, v19
    v_mfma_f32_16x16x32_bf16 a[100:103], v[168:171], v[32:35], a[100:103]
    ds_read_b128 v[28:31], v1 offset:14592
    v_cvt_pk_bf16_f32 v231, v246, v247
    v_mfma_f32_16x16x32_bf16 a[100:103], v[184:187], v[36:39], a[100:103]
    v_exp_f32 v17, v105
    v_mfma_f32_16x16x32_bf16 a[148:151], v[172:175], v[32:35], a[148:151]
    v_cvt_pk_bf16_f32 v73, v18, v19
    v_mfma_f32_16x16x32_bf16 a[148:151], v[188:191], v[36:39], a[148:151]
    s_waitcnt lgkmcnt(2)
    v_exp_f32 v18, v106
    v_mfma_f32_16x16x32_bf16 a[8:11], v[160:163], v[40:43], a[8:11]
    s_waitcnt vmcnt(12)
    ds_read_b128 v[32:35], v21 offset:0
    v_add_f32 v6, v6, v16
    v_mfma_f32_16x16x32_bf16 a[8:11], v[176:179], v[44:47], a[8:11]
    v_add_f32 v6, v6, v17
    v_mfma_f32_16x16x32_bf16 a[56:59], v[164:167], v[40:43], a[56:59]
    v_exp_f32 v19, v107
    v_mfma_f32_16x16x32_bf16 a[56:59], v[180:183], v[44:47], a[56:59]
    v_mfma_f32_16x16x32_bf16 a[104:107], v[168:171], v[40:43], a[104:107]
    ds_read_b128 v[36:39], v21 offset:12288
    v_cvt_pk_bf16_f32 v74, v16, v17
    v_mfma_f32_16x16x32_bf16 a[104:107], v[184:187], v[44:47], a[104:107]
    v_exp_f32 v16, v76
    v_mfma_f32_16x16x32_bf16 a[152:155], v[172:175], v[40:43], a[152:155]
    v_cvt_f32_i32 v248, v248
    v_add_f32 v6, v6, v18
    v_mfma_f32_16x16x32_bf16 a[152:155], v[188:191], v[44:47], a[152:155]
    s_waitcnt lgkmcnt(2)
    v_add_f32 v6, v6, v19
    v_cvt_f32_i32 v249, v249
    v_mfma_f32_16x16x32_bf16 a[12:15], v[160:163], v[24:27], a[12:15]
    ds_read_b128 v[40:43], v21 offset:768
    v_mfma_f32_16x16x32_bf16 a[12:15], v[176:179], v[28:31], a[12:15]
    buffer_load_dwordx4 v[240:243], v12, s[68:71], s36 offen offset:0 nt
    v_mfma_f32_16x16x32_bf16 a[60:63], v[164:167], v[24:27], a[60:63]
    v_exp_f32 v17, v77
    v_mfma_f32_16x16x32_bf16 a[60:63], v[180:183], v[28:31], a[60:63]
    v_cvt_pk_bf16_f32 v75, v18, v19
    v_cvt_f32_i32 v252, v252
    v_mfma_f32_16x16x32_bf16 a[108:111], v[168:171], v[24:27], a[108:111]
    ds_read_b128 v[44:47], v21 offset:13056
    v_mfma_f32_16x16x32_bf16 a[108:111], v[184:187], v[28:31], a[108:111]
    v_exp_f32 v18, v78
    v_mfma_f32_16x16x32_bf16 a[156:159], v[172:175], v[24:27], a[156:159]
    s_add_u32 s29, s28, 49152
    v_add_f32 v7, v7, v16
    v_add_f32 v7, v7, v17
    v_mfma_f32_16x16x32_bf16 a[156:159], v[188:191], v[28:31], a[156:159]
    s_waitcnt lgkmcnt(2)
    v_exp_f32 v19, v79
    v_mfma_f32_16x16x32_bf16 a[16:19], v[160:163], v[32:35], a[16:19]
    ds_read_b128 v[24:27], v21 offset:1536
    v_cvt_pk_bf16_f32 v76, v16, v17
    v_mfma_f32_16x16x32_bf16 a[16:19], v[176:179], v[36:39], a[16:19]
    s_sub_u32 s3, s29, 147456
    buffer_load_dwordx4 v[244:247], v12, s[68:71], s36 offen offset:768 nt
    v_mfma_f32_16x16x32_bf16 a[64:67], v[164:167], v[32:35], a[64:67]
    v_exp_f32 v16, v108
    v_mfma_f32_16x16x32_bf16 a[64:67], v[180:183], v[36:39], a[64:67]
    v_add_f32 v7, v7, v18
    v_cvt_f32_i32 v253, v253
    v_mfma_f32_16x16x32_bf16 a[112:115], v[168:171], v[32:35], a[112:115]
    ds_read_b128 v[28:31], v21 offset:13824
    v_add_f32 v7, v7, v19
    v_mfma_f32_16x16x32_bf16 a[112:115], v[184:187], v[36:39], a[112:115]
    v_exp_f32 v17, v109
    v_mfma_f32_16x16x32_bf16 a[160:163], v[172:175], v[32:35], a[160:163]
    v_fma_f32 v248, v248, v60, v62
    v_cvt_pk_bf16_f32 v77, v18, v19
    v_mfma_f32_16x16x32_bf16 a[160:163], v[188:191], v[36:39], a[160:163]
    s_waitcnt lgkmcnt(2)
    v_exp_f32 v18, v110
    v_mfma_f32_16x16x32_bf16 a[20:23], v[160:163], v[40:43], a[20:23]
    s_min_u32 s29, s29, s3
    ds_read_b128 v[32:35], v21 offset:2304
    v_fma_f32 v249, v249, v61, v63
    v_mfma_f32_16x16x32_bf16 a[20:23], v[176:179], v[44:47], a[20:23]
    v_add_f32 v7, v7, v16
    v_add_f32 v7, v7, v17
    v_mfma_f32_16x16x32_bf16 a[68:71], v[164:167], v[40:43], a[68:71]
    v_exp_f32 v19, v111
    v_mfma_f32_16x16x32_bf16 a[68:71], v[180:183], v[44:47], a[68:71]
    v_fma_f32 v252, v252, v60, v62
    v_mfma_f32_16x16x32_bf16 a[116:119], v[168:171], v[40:43], a[116:119]
    ds_read_b128 v[36:39], v21 offset:14592
    v_cvt_pk_bf16_f32 v78, v16, v17
    v_mfma_f32_16x16x32_bf16 a[116:119], v[184:187], v[44:47], a[116:119]
    s_waitcnt vmcnt(2)
    v_subrev_u32 v52, s92, v52
    v_cmp_lt_u32 vcc, 15, v52
    v_mfma_f32_16x16x32_bf16 a[164:167], v[172:175], v[40:43], a[164:167]
    s_sub_u32 s3, s29, s28
    v_exp_f32 v16, v80
    v_mfma_f32_16x16x32_bf16 a[164:167], v[188:191], v[44:47], a[164:167]
    s_waitcnt lgkmcnt(2)
    v_add_f32 v7, v7, v18
    v_add_f32 v7, v7, v19
    v_mfma_f32_16x16x32_bf16 a[24:27], v[160:163], v[24:27], a[24:27]
    s_and_b32 s59, vcc_lo, 0xff
    ds_read_b128 v[40:43], v22 offset:0
    v_fma_f32 v253, v253, v61, v63
    v_mfma_f32_16x16x32_bf16 a[24:27], v[176:179], v[28:31], a[24:27]
    s_cbranch_scc1 L_pollslow1
L_pollok1:
    v_mfma_f32_16x16x32_bf16 a[72:75], v[164:167], v[24:27], a[72:75]
    s_add_u32 s92, s92, 1
    v_exp_f32 v17, v81
    v_mfma_f32_16x16x32_bf16 a[72:75], v[180:183], v[28:31], a[72:75]
    s_mov_b32 m0, s56
    v_cvt_pk_bf16_f32 v79, v18, v19
    v_cvt_pk_bf16_f32 v234, v248, v249
    v_mfma_f32_16x16x32_bf16 a[120:123], v[168:171], v[24:27], a[120:123]
    ds_read_b128 v[44:47], v22 offset:12288
    v_mfma_f32_16x16x32_bf16 a[120:123], v[184:187], v[28:31], a[120:123]
    s_mov_b32 s28, s29
    buffer_load_dwordx4 v8, s[4:7], s27 offen offset:0 sc1 lds
    v_mfma_f32_16x16x32_bf16 a[168:171], v[172:175], v[24:27], a[168:171]
    v_exp_f32 v18, v82
    v_mfma_f32_16x16x32_bf16 a[168:171], v[188:191], v[28:31], a[168:171]
    s_waitcnt lgkmcnt(2)
    v_add_f32 v4, v4, v16
    v_add_f32 v4, v4, v17
    v_mfma_f32_16x16x32_bf16 a[28:31], v[160:163], v[32:35], a[28:31]
    ds_read_b128 v[24:27], v22 offset:768
    v_cvt_pk_bf16_f32 v238, v252, v253
    v_mfma_f32_16x16x32_bf16 a[28:31], v[176:179], v[36:39], a[28:31]
    buffer_load_dwordx4 v8, s[4:7], s27 offen offset:1024 sc1 lds
    v_mfma_f32_16x16x32_bf16 a[76:79], v[164:167], v[32:35], a[76:79]
    v_exp_f32 v19, v83
    v_mfma_f32_16x16x32_bf16 a[76:79], v[180:183], v[36:39], a[76:79]
    v_cvt_pk_bf16_f32 v80, v16, v17
    v_cvt_f32_i32 v250, v250
    v_mfma_f32_16x16x32_bf16 a[124:127], v[168:171], v[32:35], a[124:127]
    ds_read_b128 v[28:31], v22 offset:13056
    v_cvt_f32_i32 v251, v251
    v_mfma_f32_16x16x32_bf16 a[124:127], v[184:187], v[36:39], a[124:127]
    buffer_load_dwordx4 v8, s[4:7], s27 offen offset:2048 sc1 lds
    v_mfma_f32_16x16x32_bf16 a[172:175], v[172:175], v[32:35], a[172:175]
    v_exp_f32 v16, v112
    v_mfma_f32_16x16x32_bf16 a[172:175], v[188:191], v[36:39], a[172:175]
    s_waitcnt lgkmcnt(2)
    v_add_f32 v4, v4, v18
    v_add_f32 v4, v4, v19
    v_mfma_f32_16x16x32_bf16 a[32:35], v[160:163], v[40:43], a[32:35]
    s_add_u32 s27, s27, 24576
    ds_read_b128 v[32:35], v22 offset:1536
    v_add_u32 v2, s3, v2
    v_mfma_f32_16x16x32_bf16 a[32:35], v[176:179], v[44:47], a[32:35]
    v_exp_f32 v17, v113
    v_mfma_f32_16x16x32_bf16 a[80:83], v[164:167], v[40:43], a[80:83]
    s_add_u32 s56, s56, 12288
    v_cvt_pk_bf16_f32 v81, v18, v19
    v_cvt_f32_i32 v254, v254
    v_mfma_f32_16x16x32_bf16 a[80:83], v[180:183], v[44:47], a[80:83]
    v_exp_f32 v18, v114
    v_mfma_f32_16x16x32_bf16 a[128:131], v[168:171], v[40:43], a[128:131]
    ds_read_b128 v[36:39], v22 offset:13824
    v_add_f32 v4, v4, v16
    v_mfma_f32_16x16x32_bf16 a[128:131], v[184:187], v[44:47], a[128:131]
    s_mov_b32 m0, s56
    v_add_f32 v4, v4, v17
    v_cvt_f32_i32 v255, v255
    v_mfma_f32_16x16x32_bf16 a[176:179], v[172:175], v[40:43], a[176:179]
    v_exp_f32 v19, v115
    v_mfma_f32_16x16x32_bf16 a[176:179], v[188:191], v[44:47], a[176:179]
    s_waitcnt lgkmcnt(2)
    v_cvt_pk_bf16_f32 v82, v16, v17
    v_add_u32 v3, s3, v3
    v_mfma_f32_16x16x32_bf16 a[36:39], v[160:163], v[24:27], a[36:39]
    ds_read_b128 v[40:43], v22 offset:2304
    v_fma_f32 v250, v250, v48, v50
    v_mfma_f32_16x16x32_bf16 a[36:39], v[176:179], v[28:31], a[36:39]
    buffer_load_dwordx4 v8, s[4:7], s27 offen offset:0 sc1 lds
    v_mfma_f32_16x16x32_bf16 a[84:87], v[164:167], v[24:27], a[84:87]
    v_exp_f32 v16, v84
    v_mfma_f32_16x16x32_bf16 a[84:87], v[180:183], v[28:31], a[84:87]
    v_add_f32 v4, v4, v18
    v_add_f32 v4, v4, v19
    v_mfma_f32_16x16x32_bf16 a[132:135], v[168:171], v[24:27], a[132:135]
    ds_read_b128 v[44:47], v22 offset:14592
    v_fma_f32 v251, v251, v49, v51
    v_mfma_f32_16x16x32_bf16 a[132:135], v[184:187], v[28:31], a[132:135]
    s_waitcnt lgkmcnt(2)
    buffer_load_dwordx4 v8, s[4:7], s27 offen offset:1024 sc1 lds
    v_mfma_f32_16x16x32_bf16 a[180:183], v[172:175], v[24:27], a[180:183]
    s_waitcnt vmcnt(11)
    v_exp_f32 v17, v85
    v_mfma_f32_16x16x32_bf16 a[180:183], v[188:191], v[28:31], a[180:183]
    s_barrier
    v_cvt_pk_bf16_f32 v83, v18, v19
    v_mfma_f32_16x16x32_bf16 a[40:43], v[160:163], v[32:35], a[40:43]
    ds_read_b128 v[24:27], v2 offset:0
    v_fma_f32 v254, v254, v48, v50
    v_mfma_f32_16x16x32_bf16 a[40:43], v[176:179], v[36:39], a[40:43]
    buffer_load_dwordx4 v8, s[4:7], s27 offen offset:2048 sc1 lds
    v_mfma_f32_16x16x32_bf16 a[88:91], v[164:167], v[32:35], a[88:91]
    v_exp_f32 v18, v86
    v_mfma_f32_16x16x32_bf16 a[88:91], v[180:183], v[36:39], a[88:91]
    v_add_f32 v5, v5, v16
    v_add_f32 v5, v5, v17
    v_mfma_f32_16x16x32_bf16 a[136:139], v[168:171], v[32:35], a[136:139]
    ds_read_b128 v[28:31], v3 offset:0
    v_fma_f32 v255, v255, v49, v51
    v_mfma_f32_16x16x32_bf16 a[136:139], v[184:187], v[36:39], a[136:139]
    v_exp_f32 v19, v87
    v_cvt_pk_bf16_f32 v84, v16, v17
    v_mfma_f32_16x16x32_bf16 a[184:187], v[172:175], v[32:35], a[184:187]
    s_add_u32 s27, s27, 24576
    v_exp_f32 v16, v116
    v_mfma_f32_16x16x32_bf16 a[184:187], v[188:191], v[36:39], a[184:187]
    s_waitcnt lgkmcnt(2)
    v_add_f32 v5, v5, v18
    v_add_f32 v5, v5, v19
    v_mfma_f32_16x16x32_bf16 a[44:47], v[160:163], v[40:43], a[44:47]
    s_add_u32 s56, s56, 36864
    ds_read_b128 v[32:35], v2 offset:6144
    v_cvt_pk_bf16_f32 v235, v250, v251
    v_mfma_f32_16x16x32_bf16 a[44:47], v[176:179], v[44:47], a[44:47]
    s_sub_u32 s58, s56, 147456
    v_exp_f32 v17, v117
    v_mfma_f32_16x16x32_bf16 a[92:95], v[164:167], v[40:43], a[92:95]
    v_cvt_pk_bf16_f32 v85, v18, v19
    v_cvt_pk_bf16_f32 v239, v254, v255
    v_mfma_f32_16x16x32_bf16 a[92:95], v[180:183], v[44:47], a[92:95]
    s_min_u32 s56, s56, s58
    v_exp_f32 v18, v118
    v_mfma_f32_16x16x32_bf16 a[140:143], v[168:171], v[40:43], a[140:143]
    ds_read_b128 v[36:39], v3 offset:6144
    v_add_f32 v5, v5, v16
    v_mfma_f32_16x16x32_bf16 a[140:143], v[184:187], v[44:47], a[140:143]
    v_add_f32 v5, v5, v17
    v_mfma_f32_16x16x32_bf16 a[188:191], v[172:175], v[40:43], a[188:191]
    v_exp_f32 v19, v119
    v_mfma_f32_16x16x32_bf16 a[188:191], v[188:191], v[44:47], a[188:191]
    s_waitcnt lgkmcnt(2)
    v_cvt_pk_bf16_f32 v86, v16, v17
    v_add_f32 v5, v5, v18
    v_add_f32 v5, v5, v19
    v_cvt_pk_bf16_f32 v87, v18, v19
    v_mfma_f32_16x16x32_bf16 v[160:163], v[24:27], a[192:195], v[128:131]
    ds_read_b128 v[40:43], v2 offset:128
    v_mfma_f32_16x16x32_bf16 v[160:163], v[28:31], a[196:199], v[160:163]
    buffer_store_dwordx4 v[224:227], v11, s[4:7], s37 offen offset:0 sc1
    v_mfma_f32_16x16x32_bf16 v[164:167], v[24:27], a[216:219], v[132:135]
    v_exp_f32 v16, v88
    v_mfma_f32_16x16x32_bf16 v[164:167], v[28:31], a[220:223], v[164:167]
    v_exp_f32 v17, v89
    v_mfma_f32_16x16x32_bf16 v[168:171], v[24:27], a[240:243], v[136:139]
    ds_read_b128 v[44:47], v3 offset:128
    v_mfma_f32_16x16x32_bf16 v[168:171], v[28:31], a[244:247], v[168:171]
    v_exp_f32 v18, v90
    v_mfma_f32_16x16x32_bf16 v[172:175], v[24:27], v[200:203], v[140:143]
    v_add_f32 v6, v6, v16
    v_add_f32 v6, v6, v17
    v_mfma_f32_16x16x32_bf16 v[172:175], v[28:31], v[204:207], v[172:175]
    s_waitcnt lgkmcnt(2)
    v_exp_f32 v19, v91
    v_mfma_f32_16x16x32_bf16 v[96:99], v[32:35], a[192:195], v[128:131]
    ds_read_b128 v[24:27], v2 offset:6272
    v_cvt_pk_bf16_f32 v88, v16, v17
    v_mfma_f32_16x16x32_bf16 v[96:99], v[36:39], a[196:199], v[96:99]
    buffer_store_dwordx4 v[228:231], v54, s[4:7], s37 offen offset:768 sc1
    v_mfma_f32_16x16x32_bf16 v[100:103], v[32:35], a[216:219], v[132:135]
    v_exp_f32 v16, v120
    v_mfma_f32_16x16x32_bf16 v[100:103], v[36:39], a[220:223], v[100:103]
    v_add_f32 v6, v6, v18
    v_mfma_f32_16x16x32_bf16 v[104:107], v[32:35], a[240:243], v[136:139]
    ds_read_b128 v[28:31], v3 offset:6272
    v_add_f32 v6, v6, v19
    v_mfma_f32_16x16x32_bf16 v[104:107], v[36:39], a[244:247], v[104:107]
    v_exp_f32 v17, v121
    v_mfma_f32_16x16x32_bf16 v[108:111], v[32:35], v[200:203], v[140:143]
    v_mfma_f32_16x16x32_bf16 v[108:111], v[36:39], v[204:207], v[108:111]
    s_waitcnt lgkmcnt(2)
    v_cvt_pk_bf16_f32 v89, v18, v19
    v_mfma_f32_16x16x32_bf16 v[160:163], v[40:43], a[200:203], v[160:163]
    ds_read_b128 v[32:35], v2 offset:256
    v_mfma_f32_16x16x32_bf16 v[160:163], v[44:47], a[204:207], v[160:163]
    buffer_store_dwordx4 v[232:235], v11, s[4:7], s80 offen offset:0 sc1
    v_mfma_f32_16x16x32_bf16 v[164:167], v[40:43], a[224:227], v[164:167]
    v_exp_f32 v18, v122
    v_mfma_f32_16x16x32_bf16 v[164:167], v[44:47], a[228:231], v[164:167]
    v_add_f32 v6, v6, v16
    v_add_f32 v6, v6, v17
    v_mfma_f32_16x16x32_bf16 v[168:171], v[40:43], a[248:251], v[168:171]
    ds_read_b128 v[36:39], v3 offset:256
    v_mfma_f32_16x16x32_bf16 v[168:171], v[44:47], a[252:255], v[168:171]
    v_exp_f32 v19, v123
    v_mfma_f32_16x16x32_bf16 v[172:175], v[40:43], v[208:211], v[172:175]
    v_cvt_pk_bf16_f32 v90, v16, v17
    v_mfma_f32_16x16x32_bf16 v[172:175], v[44:47], v[212:215], v[172:175]
    s_waitcnt lgkmcnt(2)
    v_exp_f32 v16, v92
    v_mfma_f32_16x16x32_bf16 v[96:99], v[24:27], a[200:203], v[96:99]
    ds_read_b128 v[40:43], v2 offset:6400
    v_add_f32 v6, v6, v18
    v_mfma_f32_16x16x32_bf16 v[96:99], v[28:31], a[204:207], v[96:99]
    buffer_store_dwordx4 v[236:239], v54, s[4:7], s80 offen offset:768 sc1
    v_mfma_f32_16x16x32_bf16 v[100:103], v[24:27], a[224:227], v[100:103]
    v_add_f32 v6, v6, v19
    v_mfma_f32_16x16x32_bf16 v[100:103], v[28:31], a[228:231], v[100:103]
    v_exp_f32 v17, v93
    v_mfma_f32_16x16x32_bf16 v[104:107], v[24:27], a[248:251], v[104:107]
    ds_read_b128 v[44:47], v3 offset:6400
    v_cvt_pk_bf16_f32 v91, v18, v19
    v_mfma_f32_16x16x32_bf16 v[104:107], v[28:31], a[252:255], v[104:107]
    v_exp_f32 v18, v94
    s_branch L_skip5
L_pad5:
    s_branch L_tb1_9
L_skip5:
    v_mfma_f32_16x16x32_bf16 v[108:111], v[24:27], v[208:211], v[108:111]
    s_add_u32 s29, s30, 49152
    ds_read_b128 v[60:63], v23 offset:16
    v_add_f32 v7, v7, v16
    v_mfma_f32_16x16x32_bf16 v[108:111], v[28:31], v[212:215], v[108:111]
    s_waitcnt lgkmcnt(3)
    v_add_f32 v7, v7, v17
    s_waitcnt vmcnt(21)
    v_mfma_f32_16x16x32_bf16 v[160:163], v[32:35], a[208:211], v[160:163]
    s_sub_u32 s3, s29, 147456
    ds_read_b128 v[24:27], v2 offset:12288
    v_mfma_f32_16x16x32_bf16 v[160:163], v[36:39], a[212:215], v[160:163]
    v_exp_f32 v19, v95
    v_mfma_f32_16x16x32_bf16 v[164:167], v[32:35], a[232:235], v[164:167]
    s_mov_b32 m0, s56
    v_cvt_pk_bf16_f32 v92, v16, v17
    v_cvt_f32_i32 v144, v144
    v_mfma_f32_16x16x32_bf16 v[164:167], v[36:39], a[236:239], v[164:167]
    v_exp_f32 v16, v124
    v_mfma_f32_16x16x32_bf16 v[168:171], v[32:35], v[192:195], v[168:171]
    ds_read_b128 v[28:31], v3 offset:12288
    v_cvt_f32_i32 v148, v148
    v_mfma_f32_16x16x32_bf16 v[168:171], v[36:39], v[196:199], v[168:171]
    buffer_load_dwordx4 v8, s[4:7], s27 offen offset:0 sc1 lds
    v_mfma_f32_16x16x32_bf16 v[172:175], v[32:35], v[216:219], v[172:175]
    s_min_u32 s29, s29, s3
    v_add_f32 v7, v7, v18
    v_add_f32 v7, v7, v19
    v_mfma_f32_16x16x32_bf16 v[172:175], v[36:39], v[220:223], v[172:175]
    s_waitcnt lgkmcnt(3)
    v_exp_f32 v17, v125
    v_mfma_f32_16x16x32_bf16 v[96:99], v[40:43], a[208:211], v[96:99]
    ds_read_b128 v[32:35], v2 offset:18432
    v_cvt_f32_i32 v145, v145
    v_mfma_f32_16x16x32_bf16 v[96:99], v[44:47], a[212:215], v[96:99]
    ds_read_b128 v[48:51], v23 offset:32
    v_cvt_pk_bf16_f32 v93, v18, v19
    v_mfma_f32_16x16x32_bf16 v[100:103], v[40:43], a[232:235], v[100:103]
    v_exp_f32 v18, v126
    v_mfma_f32_16x16x32_bf16 v[100:103], v[44:47], a[236:239], v[100:103]
    buffer_load_dwordx4 v8, s[4:7], s27 offen offset:1024 sc1 lds
    v_mfma_f32_16x16x32_bf16 v[104:107], v[40:43], v[192:195], v[104:107]
    s_sub_u32 s3, s29, s30
    ds_read_b128 v[36:39], v3 offset:18432
    v_add_f32 v7, v7, v16
    v_mfma_f32_16x16x32_bf16 v[104:107], v[44:47], v[196:199], v[104:107]
    v_add_f32 v7, v7, v17
    v_cvt_f32_i32 v149, v149
    v_mfma_f32_16x16x32_bf16 v[108:111], v[40:43], v[216:219], v[108:111]
    v_exp_f32 v19, v127
    v_mfma_f32_16x16x32_bf16 v[108:111], v[44:47], v[220:223], v[108:111]
    s_waitcnt lgkmcnt(3)
    v_cvt_pk_bf16_f32 v94, v16, v17
    v_fma_f32 v144, v144, v56, v58
    v_mfma_f32_16x16x32_bf16 v[176:179], v[24:27], a[192:195], v[128:131]
    ds_read_b128 v[40:43], v2 offset:12416
    v_add_f32 v7, v7, v18
    v_mfma_f32_16x16x32_bf16 v[176:179], v[28:31], a[196:199], v[176:179]
    buffer_load_dwordx4 v8, s[4:7], s27 offen offset:2048 sc1 lds
    v_mfma_f32_16x16x32_bf16 v[180:183], v[24:27], a[216:219], v[132:135]
    s_mov_b32 s30, s29
    v_add_f32 v7, v7, v19
    v_cvt_pk_bf16_f32 v95, v18, v19
    v_mfma_f32_16x16x32_bf16 v[180:183], v[28:31], a[220:223], v[180:183]
    v_fma_f32 v148, v148, v57, v59
    v_fma_f32 v145, v145, v56, v58
    v_mfma_f32_16x16x32_bf16 v[184:187], v[24:27], a[240:243], v[136:139]
    s_add_u32 s27, s27, 24576
    ds_read_b128 v[44:47], v3 offset:12416
    v_fma_f32 v149, v149, v57, v59
    v_mfma_f32_16x16x32_bf16 v[184:187], v[28:31], a[244:247], v[184:187]
    v_exp_f32 v16, v160
    v_mfma_f32_16x16x32_bf16 v[188:191], v[24:27], v[200:203], v[140:143]
    v_exp_f32 v17, v161
    v_mfma_f32_16x16x32_bf16 v[188:191], v[28:31], v[204:207], v[188:191]
    s_waitcnt lgkmcnt(2)
    v_exp_f32 v18, v162
    v_mfma_f32_16x16x32_bf16 v[112:115], v[32:35], a[192:195], v[128:131]
    s_add_u32 s56, s56, 12288
    ds_read_b128 v[24:27], v2 offset:18560
    v_cvt_f32_i32 v146, v146
    v_mfma_f32_16x16x32_bf16 v[112:115], v[36:39], a[196:199], v[112:115]
    s_mov_b32 m0, s56
    v_add_f32 v4, v4, v16
    v_add_f32 v4, v4, v17
    v_mfma_f32_16x16x32_bf16 v[116:119], v[32:35], a[216:219], v[132:135]
    v_exp_f32 v19, v163
    v_mfma_f32_16x16x32_bf16 v[116:119], v[36:39], a[220:223], v[116:119]
    v_cvt_f32_i32 v150, v150
    v_cvt_pk_bf16_f32 v160, v16, v17
    v_mfma_f32_16x16x32_bf16 v[120:123], v[32:35], a[240:243], v[136:139]
    ds_read_b128 v[28:31], v3 offset:18560
    v_cvt_f32_i32 v147, v147
    v_mfma_f32_16x16x32_bf16 v[120:123], v[36:39], a[244:247], v[120:123]
    v_exp_f32 v16, v96
    v_mfma_f32_16x16x32_bf16 v[124:127], v[32:35], v[200:203], v[140:143]
    v_add_f32 v4, v4, v18
    v_add_u32 v1, s3, v1
    v_mfma_f32_16x16x32_bf16 v[124:127], v[36:39], v[204:207], v[124:127]
    s_waitcnt lgkmcnt(2)
    buffer_load_dwordx4 v8, s[4:7], s27 offen offset:0 sc1 lds
    v_mfma_f32_16x16x32_bf16 v[176:179], v[40:43], a[200:203], v[176:179]
    ds_read_b128 v[32:35], v2 offset:12544
    v_add_f32 v4, v4, v19
    v_mfma_f32_16x16x32_bf16 v[176:179], v[44:47], a[204:207], v[176:179]
    v_exp_f32 v17, v97
    v_mfma_f32_16x16x32_bf16 v[180:183], v[40:43], a[224:227], v[180:183]
    v_cvt_f32_i32 v151, v151
    v_cvt_pk_bf16_f32 v161, v18, v19
    v_mfma_f32_16x16x32_bf16 v[180:183], v[44:47], a[228:231], v[180:183]
    buffer_load_dwordx4 v8, s[4:7], s27 offen offset:1024 sc1 lds
    v_mfma_f32_16x16x32_bf16 v[184:187], v[40:43], a[248:251], v[184:187]
    ds_read_b128 v[36:39], v3 offset:12544
    v_fma_f32 v146, v146, v56, v58
    v_mfma_f32_16x16x32_bf16 v[184:187], v[44:47], a[252:255], v[184:187]
    v_exp_f32 v18, v98
    v_mfma_f32_16x16x32_bf16 v[188:191], v[40:43], v[208:211], v[188:191]
    v_add_f32 v4, v4, v16
    v_add_f32 v4, v4, v17
    v_mfma_f32_16x16x32_bf16 v[188:191], v[44:47], v[212:215], v[188:191]
    s_waitcnt lgkmcnt(2)
    v_exp_f32 v19, v99
    v_mfma_f32_16x16x32_bf16 v[112:115], v[24:27], a[200:203], v[112:115]
    ds_read_b128 v[40:43], v2 offset:18688
    v_fma_f32 v150, v150, v57, v59
    v_mfma_f32_16x16x32_bf16 v[112:115], v[28:31], a[204:207], v[112:115]
    buffer_load_dwordx4 v8, s[4:7], s27 offen offset:2048 sc1 lds
    v_mfma_f32_16x16x32_bf16 v[116:119], v[24:27], a[224:227], v[116:119]
    v_cvt_pk_bf16_f32 v162, v16, v17
    v_add_u32 v21, s3, v21
    v_mfma_f32_16x16x32_bf16 v[116:119], v[28:31], a[228:231], v[116:119]
    v_exp_f32 v16, v164
    v_mfma_f32_16x16x32_bf16 v[120:123], v[24:27], a[248:251], v[120:123]
    ds_read_b128 v[44:47], v3 offset:18688
    v_add_u32 v22, s3, v22
    v_mfma_f32_16x16x32_bf16 v[120:123], v[28:31], a[252:255], v[120:123]
    s_waitcnt lgkmcnt(2)
    v_add_f32 v4, v4, v18
    v_add_f32 v4, v4, v19
    v_mfma_f32_16x16x32_bf16 v[124:127], v[24:27], v[208:211], v[124:127]
    s_waitcnt vmcnt(6)
    v_exp_f32 v17, v165
    v_mfma_f32_16x16x32_bf16 v[124:127], v[28:31], v[212:215], v[124:127]
    s_barrier
    v_fma_f32 v147, v147, v56, v58
    v_mfma_f32_16x16x32_bf16 v[176:179], v[32:35], a[208:211], v[176:179]
    s_add_u32 s27, s27, 24576
    ds_read_b128 v[24:27], v1 offset:0
    v_cvt_pk_bf16_f32 v163, v18, v19
    v_mfma_f32_16x16x32_bf16 v[176:179], v[36:39], a[212:215], v[176:179]
    s_add_u32 s56, s56, 36864
    v_exp_f32 v18, v166
    v_mfma_f32_16x16x32_bf16 v[180:183], v[32:35], a[232:235], v[180:183]
    v_add_f32 v5, v5, v16
    v_fma_f32 v151, v151, v57, v59
    v_mfma_f32_16x16x32_bf16 v[180:183], v[36:39], a[236:239], v[180:183]
    s_sub_u32 s58, s56, 147456
    ds_read_b128 v[56:59], v23 offset:48
    v_add_f32 v5, v5, v17
    v_mfma_f32_16x16x32_bf16 v[184:187], v[32:35], v[192:195], v[184:187]
    ds_read_b128 v[28:31], v1 offset:12288
    s_waitcnt vmcnt(25)
    v_mfma_f32_16x16x32_bf16 v[184:187], v[36:39], v[196:199], v[184:187]
    buffer_load_dwordx4 v[248:251], v12, s[68:71], s36 offen offset:1536 nt
    v_mfma_f32_16x16x32_bf16 v[188:191], v[32:35], v[216:219], v[188:191]
    s_min_u32 s56, s56, s58
    v_exp_f32 v19, v167
    v_mfma_f32_16x16x32_bf16 v[188:191], v[36:39], v[220:223], v[188:191]
    s_waitcnt lgkmcnt(3)
    v_cvt_pk_bf16_f32 v164, v16, v17
    v_exp_f32 v16, v100
    v_mfma_f32_16x16x32_bf16 v[112:115], v[40:43], a[208:211], v[112:115]
    ds_read_b128 v[32:35], v1 offset:768
    v_add_f32 v5, v5, v18
    v_mfma_f32_16x16x32_bf16 v[112:115], v[44:47], a[212:215], v[112:115]
    buffer_load_dwordx4 v[252:255], v12, s[68:71], s36 offen offset:2304 nt
    v_add_f32 v5, v5, v19
    v_mfma_f32_16x16x32_bf16 v[116:119], v[40:43], a[232:235], v[116:119]
    v_exp_f32 v17, v101
    v_mfma_f32_16x16x32_bf16 v[116:119], v[44:47], a[236:239], v[116:119]
    v_cvt_f32_i32 v152, v152
    v_cvt_pk_bf16_f32 v165, v18, v19
    v_mfma_f32_16x16x32_bf16 v[120:123], v[40:43], v[192:195], v[120:123]
    ds_read_b128 v[36:39], v1 offset:13056
    v_cvt_f32_i32 v156, v156
    v_mfma_f32_16x16x32_bf16 v[120:123], v[44:47], v[196:199], v[120:123]
    v_add_u32 v55, 1, v55
    buffer_store_dword v55, v13, s[20:23], 0 offen sc1
    v_mfma_f32_16x16x32_bf16 v[124:127], v[40:43], v[216:219], v[124:127]
    v_exp_f32 v18, v102
    v_mfma_f32_16x16x32_bf16 v[124:127], v[44:47], v[220:223], v[124:127]
    s_waitcnt lgkmcnt(2)
    v_add_f32 v5, v5, v16
    v_add_f32 v5, v5, v17
    v_exp_f32 v19, v103
    v_cvt_f32_i32 v153, v153
    v_add_u32 v23, 1792, v23
    v_cvt_pk_bf16_f32 v166, v16, v17
    v_cvt_f32_i32 v157, v157
    v_add_f32 v5, v5, v18
    v_fma_f32 v152, v152, v60, v62
    v_add_f32 v5, v5, v19
    v_fma_f32 v156, v156, v61, v63
    v_cvt_pk_bf16_f32 v167, v18, v19
    v_fma_f32 v153, v153, v60, v62
    v_mfma_f32_16x16x32_bf16 a[0:3], v[64:67], v[24:27], a[0:3]
    s_mov_b32 m0, s26
    ds_read_b128 v[40:43], v1 offset:1536
    v_fma_f32 v157, v157, v61, v63
    v_mfma_f32_16x16x32_bf16 a[0:3], v[80:83], v[28:31], a[0:3]
    v_exp_f32 v16, v168
    v_mfma_f32_16x16x32_bf16 a[48:51], v[68:71], v[24:27], a[48:51]
    v_exp_f32 v17, v169
    v_mfma_f32_16x16x32_bf16 a[48:51], v[84:87], v[28:31], a[48:51]
    buffer_load_dwordx4 v8, s[4:7], s32 offen offset:0 sc1 lds
    v_mfma_f32_16x16x32_bf16 a[96:99], v[72:75], v[24:27], a[96:99]
    ds_read_b128 v[44:47], v1 offset:13824
    v_cvt_f32_i32 v154, v154
    v_mfma_f32_16x16x32_bf16 a[96:99], v[88:91], v[28:31], a[96:99]
    v_exp_f32 v18, v170
    v_mfma_f32_16x16x32_bf16 a[144:147], v[76:79], v[24:27], a[144:147]
    v_add_f32 v6, v6, v16
    v_add_f32 v6, v6, v17
    v_mfma_f32_16x16x32_bf16 a[144:147], v[92:95], v[28:31], a[144:147]
    s_waitcnt lgkmcnt(2)
    buffer_load_dwordx4 v8, s[4:7], s32 offen offset:1024 sc1 lds
    v_mfma_f32_16x16x32_bf16 a[4:7], v[64:67], v[32:35], a[4:7]
    ds_read_b128 v[24:27], v1 offset:2304
    v_cvt_f32_i32 v158, v158
    v_mfma_f32_16x16x32_bf16 a[4:7], v[80:83], v[36:39], a[4:7]
    v_exp_f32 v19, v171
    v_mfma_f32_16x16x32_bf16 a[52:55], v[68:71], v[32:35], a[52:55]
    v_cvt_pk_bf16_f32 v168, v16, v17
    v_cvt_f32_i32 v155, v155
    v_mfma_f32_16x16x32_bf16 a[52:55], v[84:87], v[36:39], a[52:55]
    v_exp_f32 v16, v104
    v_mfma_f32_16x16x32_bf16 a[100:103], v[72:75], v[32:35], a[100:103]
    ds_read_b128 v[28:31], v1 offset:14592
    v_add_f32 v6, v6, v18
    v_mfma_f32_16x16x32_bf16 a[100:103], v[88:91], v[36:39], a[100:103]
    buffer_load_dwordx4 v8, s[4:7], s32 offen offset:2048 sc1 lds
    v_mfma_f32_16x16x32_bf16 a[148:151], v[76:79], v[32:35], a[148:151]
    v_add_f32 v6, v6, v19
    v_cvt_f32_i32 v159, v159
    v_mfma_f32_16x16x32_bf16 a[148:151], v[92:95], v[36:39], a[148:151]
    s_waitcnt lgkmcnt(2)
    v_exp_f32 v17, v105
    v_mfma_f32_16x16x32_bf16 a[8:11], v[64:67], v[40:43], a[8:11]
    s_add_u32 s32, s32, 24576
    ds_read_b128 v[32:35], v21 offset:0
    v_cvt_pk_bf16_f32 v169, v18, v19
    v_mfma_f32_16x16x32_bf16 a[8:11], v[80:83], v[44:47], a[8:11]
    v_exp_f32 v18, v106
    v_mfma_f32_16x16x32_bf16 a[56:59], v[68:71], v[40:43], a[56:59]
    v_add_f32 v6, v6, v16
    v_add_f32 v6, v6, v17
    v_mfma_f32_16x16x32_bf16 a[56:59], v[84:87], v[44:47], a[56:59]
    s_add_u32 s26, s26, 12288
    v_fma_f32 v154, v154, v60, v62
    v_fma_f32 v158, v158, v61, v63
    v_mfma_f32_16x16x32_bf16 a[104:107], v[72:75], v[40:43], a[104:107]
    ds_read_b128 v[36:39], v21 offset:12288
    v_fma_f32 v155, v155, v60, v62
    v_mfma_f32_16x16x32_bf16 a[104:107], v[88:91], v[44:47], a[104:107]
    v_exp_f32 v19, v107
    v_mfma_f32_16x16x32_bf16 a[152:155], v[76:79], v[40:43], a[152:155]
    s_mov_b32 m0, s56
    v_cvt_pk_bf16_f32 v170, v16, v17
    v_mfma_f32_16x16x32_bf16 a[152:155], v[92:95], v[44:47], a[152:155]
    s_waitcnt lgkmcnt(2)
    v_exp_f32 v16, v172
    v_mfma_f32_16x16x32_bf16 a[12:15], v[64:67], v[24:27], a[12:15]
    ds_read_b128 v[40:43], v21 offset:768
    v_add_f32 v6, v6, v18
    v_mfma_f32_16x16x32_bf16 a[12:15], v[80:83], v[28:31], a[12:15]
    buffer_load_dwordx4 v8, s[4:7], s27 offen offset:0 sc1 lds
    v_mfma_f32_16x16x32_bf16 a[60:63], v[68:71], v[24:27], a[60:63]
    v_add_f32 v6, v6, v19
    v_fma_f32 v159, v159, v61, v63
    v_mfma_f32_16x16x32_bf16 a[60:63], v[84:87], v[28:31], a[60:63]
    v_exp_f32 v17, v173
    v_mfma_f32_16x16x32_bf16 a[108:111], v[72:75], v[24:27], a[108:111]
    ds_read_b128 v[44:47], v21 offset:13056
    v_cvt_pk_bf16_f32 v171, v18, v19
    v_mfma_f32_16x16x32_bf16 a[108:111], v[88:91], v[28:31], a[108:111]
    v_exp_f32 v18, v174
    v_mfma_f32_16x16x32_bf16 a[156:159], v[76:79], v[24:27], a[156:159]
    s_add_u32 s29, s28, 49152
    v_add_f32 v7, v7, v16
    v_add_f32 v7, v7, v17
    v_mfma_f32_16x16x32_bf16 a[156:159], v[92:95], v[28:31], a[156:159]
    s_waitcnt lgkmcnt(2)
    buffer_load_dwordx4 v8, s[4:7], s27 offen offset:1024 sc1 lds
    v_mfma_f32_16x16x32_bf16 a[16:19], v[64:67], v[32:35], a[16:19]
    ds_read_b128 v[24:27], v21 offset:1536
    v_cvt_pk_bf16_f32 v144, v144, v148
    v_mfma_f32_16x16x32_bf16 a[16:19], v[80:83], v[36:39], a[16:19]
    s_sub_u32 s3, s29, 147456
    v_exp_f32 v19, v175
    v_mfma_f32_16x16x32_bf16 a[64:67], v[68:71], v[32:35], a[64:67]
    v_cvt_pk_bf16_f32 v172, v16, v17
    v_cvt_pk_bf16_f32 v148, v145, v149
    v_mfma_f32_16x16x32_bf16 a[64:67], v[84:87], v[36:39], a[64:67]
    v_exp_f32 v16, v108
    v_mfma_f32_16x16x32_bf16 a[112:115], v[72:75], v[32:35], a[112:115]
    ds_read_b128 v[28:31], v21 offset:13824
    v_add_f32 v7, v7, v18
    v_mfma_f32_16x16x32_bf16 a[112:115], v[88:91], v[36:39], a[112:115]
    buffer_load_dwordx4 v8, s[4:7], s27 offen offset:2048 sc1 lds
    v_mfma_f32_16x16x32_bf16 a[160:163], v[76:79], v[32:35], a[160:163]
    v_add_f32 v7, v7, v19
    v_cvt_pk_bf16_f32 v145, v152, v156
    v_mfma_f32_16x16x32_bf16 a[160:163], v[92:95], v[36:39], a[160:163]
    s_waitcnt lgkmcnt(2)
    v_exp_f32 v17, v109
    v_mfma_f32_16x16x32_bf16 a[20:23], v[64:67], v[40:43], a[20:23]
    s_add_u32 s27, s27, 24576
    ds_read_b128 v[32:35], v21 offset:2304
    v_cvt_pk_bf16_f32 v173, v18, v19
    v_mfma_f32_16x16x32_bf16 a[20:23], v[80:83], v[44:47], a[20:23]
    s_min_u32 s29, s29, s3
    v_exp_f32 v18, v110
    v_mfma_f32_16x16x32_bf16 a[68:71], v[68:71], v[40:43], a[68:71]
    s_add_u32 s56, s56, 12288
    v_add_f32 v7, v7, v16
    v_cvt_pk_bf16_f32 v149, v153, v157
    v_mfma_f32_16x16x32_bf16 a[68:71], v[84:87], v[44:47], a[68:71]
    v_add_f32 v7, v7, v17
    v_cvt_pk_bf16_f32 v152, v146, v150
    v_mfma_f32_16x16x32_bf16 a[116:119], v[72:75], v[40:43], a[116:119]
    ds_read_b128 v[36:39], v21 offset:14592
    v_cvt_pk_bf16_f32 v153, v154, v158
    v_mfma_f32_16x16x32_bf16 a[116:119], v[88:91], v[44:47], a[116:119]
    s_mov_b32 m0, s56
    v_exp_f32 v19, v111
    v_mfma_f32_16x16x32_bf16 a[164:167], v[76:79], v[40:43], a[164:167]
    s_sub_u32 s3, s29, s28
    v_cvt_pk_bf16_f32 v174, v16, v17
    v_cvt_pk_bf16_f32 v156, v147, v151
    v_mfma_f32_16x16x32_bf16 a[164:167], v[92:95], v[44:47], a[164:167]
    s_waitcnt lgkmcnt(2)
    v_exp_f32 v16, v176
    v_mfma_f32_16x16x32_bf16 a[24:27], v[64:67], v[24:27], a[24:27]
    ds_read_b128 v[40:43], v22 offset:0
    v_add_f32 v7, v7, v18
    v_mfma_f32_16x16x32_bf16 a[24:27], v[80:83], v[28:31], a[24:27]
    buffer_load_dwordx4 v8, s[4:7], s27 offen offset:0 sc1 lds
    v_mfma_f32_16x16x32_bf16 a[72:75], v[68:71], v[24:27], a[72:75]
    v_add_f32 v7, v7, v19
    v_cvt_pk_bf16_f32 v157, v155, v159
    v_mfma_f32_16x16x32_bf16 a[72:75], v[84:87], v[28:31], a[72:75]
    s_waitcnt vmcnt(26)
    v_exp_f32 v17, v177
    v_mfma_f32_16x16x32_bf16 a[120:123], v[72:75], v[24:27], a[120:123]
    ds_read_b128 v[44:47], v22 offset:12288
    v_cvt_pk_bf16_f32 v175, v18, v19
    v_mfma_f32_16x16x32_bf16 a[120:123], v[88:91], v[28:31], a[120:123]
    s_mov_b32 s28, s29
    v_exp_f32 v18, v178
    v_mfma_f32_16x16x32_bf16 a[168:171], v[76:79], v[24:27], a[168:171]
    v_add_f32 v4, v4, v16
    v_add_f32 v4, v4, v17
    v_mfma_f32_16x16x32_bf16 a[168:171], v[92:95], v[28:31], a[168:171]
    s_waitcnt lgkmcnt(2)
    buffer_load_dwordx4 v8, s[4:7], s27 offen offset:1024 sc1 lds
    v_mfma_f32_16x16x32_bf16 a[28:31], v[64:67], v[32:35], a[28:31]
    ds_read_b128 v[24:27], v22 offset:768
    v_cvt_f32_i32 v240, v240
    v_mfma_f32_16x16x32_bf16 a[28:31], v[80:83], v[36:39], a[28:31]
    v_exp_f32 v19, v179
    v_mfma_f32_16x16x32_bf16 a[76:79], v[68:71], v[32:35], a[76:79]
    v_cvt_pk_bf16_f32 v176, v16, v17
    v_cvt_f32_i32 v244, v244
    v_mfma_f32_16x16x32_bf16 a[76:79], v[84:87], v[36:39], a[76:79]
    buffer_load_dwordx4 v8, s[4:7], s27 offen offset:2048 sc1 lds
    v_mfma_f32_16x16x32_bf16 a[124:127], v[72:75], v[32:35], a[124:127]
    ds_read_b128 v[28:31], v22 offset:13056
    v_cvt_f32_i32 v241, v241
    v_mfma_f32_16x16x32_bf16 a[124:127], v[88:91], v[36:39], a[124:127]
    v_exp_f32 v16, v112
    v_mfma_f32_16x16x32_bf16 a[172:175], v[76:79], v[32:35], a[172:175]
    v_add_f32 v4, v4, v18
    v_add_f32 v4, v4, v19
    v_mfma_f32_16x16x32_bf16 a[172:175], v[92:95], v[36:39], a[172:175]
    s_waitcnt lgkmcnt(2)
    v_exp_f32 v17, v113
    v_mfma_f32_16x16x32_bf16 a[32:35], v[64:67], v[40:43], a[32:35]
    ds_read_b128 v[32:35], v22 offset:1536
    v_cvt_pk_bf16_f32 v177, v18, v19
    v_mfma_f32_16x16x32_bf16 a[32:35], v[80:83], v[44:47], a[32:35]
    s_add_u32 s27, s27, 24576
    v_exp_f32 v18, v114
    v_mfma_f32_16x16x32_bf16 a[80:83], v[68:71], v[40:43], a[80:83]
    s_add_u32 s56, s56, 36864
    v_add_f32 v4, v4, v16
    v_add_f32 v4, v4, v17
    v_mfma_f32_16x16x32_bf16 a[80:83], v[84:87], v[44:47], a[80:83]
    v_exp_f32 v19, v115
    v_mfma_f32_16x16x32_bf16 a[128:131], v[72:75], v[40:43], a[128:131]
    ds_read_b128 v[36:39], v22 offset:13824
    v_add_u32 v2, s3, v2
    v_mfma_f32_16x16x32_bf16 a[128:131], v[88:91], v[44:47], a[128:131]
    s_sub_u32 s58, s56, 147456
    v_bfe_u32 v53, v8, 4, 6
    v_cvt_pk_bf16_f32 v178, v16, v17
    v_mfma_f32_16x16x32_bf16 a[176:179], v[76:79], v[40:43], a[176:179]
    v_cvt_f32_i32 v245, v245
    v_lshlrev_b32 v53, 2, v53
    v_mfma_f32_16x16x32_bf16 a[176:179], v[92:95], v[44:47], a[176:179]
    s_waitcnt lgkmcnt(2)
    buffer_load_dword v52, v53, s[20:23], 0 offen sc1
    v_mfma_f32_16x16x32_bf16 a[36:39], v[64:67], v[24:27], a[36:39]
    s_min_u32 s56, s56, s58
    ds_read_b128 v[40:43], v22 offset:2304
    v_fma_f32 v240, v240, v48, v50
    v_mfma_f32_16x16x32_bf16 a[36:39], v[80:83], v[28:31], a[36:39]
    v_exp_f32 v16, v180
    v_mfma_f32_16x16x32_bf16 a[84:87], v[68:71], v[24:27], a[84:87]
    v_add_f32 v4, v4, v18
    v_add_f32 v4, v4, v19
    v_mfma_f32_16x16x32_bf16 a[84:87], v[84:87], v[28:31], a[84:87]
    v_exp_f32 v17, v181
    v_mfma_f32_16x16x32_bf16 a[132:135], v[72:75], v[24:27], a[132:135]
    ds_read_b128 v[44:47], v22 offset:14592
    v_add_u32 v3, s3, v3
    v_mfma_f32_16x16x32_bf16 a[132:135], v[88:91], v[28:31], a[132:135]
    s_waitcnt lgkmcnt(2)
    v_cvt_pk_bf16_f32 v179, v18, v19
    v_fma_f32 v244, v244, v49, v51
    v_mfma_f32_16x16x32_bf16 a[180:183], v[76:79], v[24:27], a[180:183]
    s_waitcnt vmcnt(21)
    v_exp_f32 v18, v182
    v_mfma_f32_16x16x32_bf16 a[180:183], v[92:95], v[28:31], a[180:183]
    s_barrier
    v_add_f32 v5, v5, v16
    v_mfma_f32_16x16x32_bf16 a[40:43], v[64:67], v[32:35], a[40:43]
    s_add_u32 s33, s33, 196608
    ds_read_b128 v[24:27], v2 offset:0
    v_add_f32 v5, v5, v17
    v_mfma_f32_16x16x32_bf16 a[40:43], v[80:83], v[36:39], a[40:43]
    s_sub_u32 s34, s33, 1572864
    v_exp_f32 v19, v183
    v_mfma_f32_16x16x32_bf16 a[88:91], v[68:71], v[32:35], a[88:91]
    s_min_u32 s33, s33, s34
    v_cvt_pk_bf16_f32 v180, v16, v17
    v_fma_f32 v241, v241, v48, v50
    v_mfma_f32_16x16x32_bf16 a[88:91], v[84:87], v[36:39], a[88:91]
    s_add_u32 s34, s33, 3072
    v_exp_f32 v16, v116
    v_mfma_f32_16x16x32_bf16 a[136:139], v[72:75], v[32:35], a[136:139]
    s_add_u32 s37, s37, 196608
    ds_read_b128 v[28:31], v3 offset:0
    v_fma_f32 v245, v245, v49, v51
    v_mfma_f32_16x16x32_bf16 a[136:139], v[88:91], v[36:39], a[136:139]
    s_add_u32 s80, s80, 196608
    v_add_f32 v5, v5, v18
    v_add_f32 v5, v5, v19
    v_mfma_f32_16x16x32_bf16 a[184:187], v[76:79], v[32:35], a[184:187]
    v_exp_f32 v17, v117
    v_mfma_f32_16x16x32_bf16 a[184:187], v[92:95], v[36:39], a[184:187]
    s_waitcnt lgkmcnt(2)
    buffer_load_dwordx4 v[224:227], v9, s[64:67], s33 offen offset:0 nt
    v_mfma_f32_16x16x32_bf16 a[44:47], v[64:67], v[40:43], a[44:47]
    ds_read_b128 v[32:35], v2 offset:6144
    v_cvt_pk_bf16_f32 v181, v18, v19
    v_mfma_f32_16x16x32_bf16 a[44:47], v[80:83], v[44:47], a[44:47]
    v_cvt_f32_i32 v242, v242
    v_cvt_f32_i32 v246, v246
    v_mfma_f32_16x16x32_bf16 a[92:95], v[68:71], v[40:43], a[92:95]
    v_exp_f32 v18, v118
    v_mfma_f32_16x16x32_bf16 a[92:95], v[84:87], v[44:47], a[92:95]
    buffer_load_dwordx4 v[228:231], v9, s[64:67], s33 offen offset:1536 nt
    v_mfma_f32_16x16x32_bf16 a[140:143], v[72:75], v[40:43], a[140:143]
    ds_read_b128 v[36:39], v3 offset:6144
    v_add_f32 v5, v5, v16
    v_mfma_f32_16x16x32_bf16 a[140:143], v[88:91], v[44:47], a[140:143]
    v_add_f32 v5, v5, v17
    v_cvt_f32_i32 v243, v243
    v_mfma_f32_16x16x32_bf16 a[188:191], v[76:79], v[40:43], a[188:191]
    buffer_load_dwordx4 v[232:235], v9, s[64:67], s34 offen offset:0 nt
    buffer_load_dwordx4 v[236:239], v9, s[64:67], s34 offen offset:1536 nt
    v_mfma_f32_16x16x32_bf16 a[188:191], v[92:95], v[44:47], a[188:191]
    s_waitcnt lgkmcnt(2)
    v_exp_f32 v19, v119
    v_cvt_pk_bf16_f32 v182, v16, v17
    v_add_f32 v5, v5, v18
    v_add_f32 v5, v5, v19
    v_cvt_f32_i32 v247, v247
    v_cvt_pk_bf16_f32 v183, v18, v19
    v_fma_f32 v242, v242, v48, v50
    v_mfma_f32_16x16x32_bf16 v[64:67], v[24:27], a[192:195], v[128:131]
    s_mov_b32 m0, s26
    ds_read_b128 v[40:43], v2 offset:128
    v_fma_f32 v246, v246, v49, v51
    v_mfma_f32_16x16x32_bf16 v[64:67], v[28:31], a[196:199], v[64:67]
    v_exp_f32 v16, v184
    v_mfma_f32_16x16x32_bf16 v[68:71], v[24:27], a[216:219], v[132:135]
    v_exp_f32 v17, v185
    v_mfma_f32_16x16x32_bf16 v[68:71], v[28:31], a[220:223], v[68:71]
    buffer_load_dwordx4 v8, s[4:7], s32 offen offset:0 sc1 lds
    v_mfma_f32_16x16x32_bf16 v[72:75], v[24:27], a[240:243], v[136:139]
    ds_read_b128 v[44:47], v3 offset:128
    v_fma_f32 v243, v243, v48, v50
    v_mfma_f32_16x16x32_bf16 v[72:75], v[28:31], a[244:247], v[72:75]
    v_exp_f32 v18, v186
    v_mfma_f32_16x16x32_bf16 v[76:79], v[24:27], v[200:203], v[140:143]
    v_add_f32 v6, v6, v16
    v_add_f32 v6, v6, v17
    v_mfma_f32_16x16x32_bf16 v[76:79], v[28:31], v[204:207], v[76:79]
    s_waitcnt lgkmcnt(2)
    v_exp_f32 v19, v187
    v_mfma_f32_16x16x32_bf16 v[96:99], v[32:35], a[192:195], v[128:131]
    ds_read_b128 v[24:27], v2 offset:6272
    v_fma_f32 v247, v247, v49, v51
    v_mfma_f32_16x16x32_bf16 v[96:99], v[36:39], a[196:199], v[96:99]
    ds_read_b128 v[48:51], v10 offset:0
    v_cvt_pk_bf16_f32 v184, v16, v17
    v_mfma_f32_16x16x32_bf16 v[100:103], v[32:35], a[216:219], v[132:135]
    v_exp_f32 v16, v120
    v_mfma_f32_16x16x32_bf16 v[100:103], v[36:39], a[220:223], v[100:103]
    buffer_load_dwordx4 v8, s[4:7], s32 offen offset:1024 sc1 lds
    v_mfma_f32_16x16x32_bf16 v[104:107], v[32:35], a[240:243], v[136:139]
    ds_read_b128 v[28:31], v3 offset:6272
    v_add_f32 v6, v6, v18
    v_mfma_f32_16x16x32_bf16 v[104:107], v[36:39], a[244:247], v[104:107]
    v_add_f32 v6, v6, v19
    v_cvt_pk_bf16_f32 v146, v240, v244
    v_mfma_f32_16x16x32_bf16 v[108:111], v[32:35], v[200:203], v[140:143]
    v_exp_f32 v17, v121
    v_mfma_f32_16x16x32_bf16 v[108:111], v[36:39], v[204:207], v[108:111]
    s_waitcnt lgkmcnt(3)
    v_cvt_pk_bf16_f32 v185, v18, v19
    v_cvt_pk_bf16_f32 v150, v241, v245
    v_mfma_f32_16x16x32_bf16 v[64:67], v[40:43], a[200:203], v[64:67]
    ds_read_b128 v[32:35], v2 offset:256
    v_mfma_f32_16x16x32_bf16 v[64:67], v[44:47], a[204:207], v[64:67]
    buffer_load_dwordx4 v8, s[4:7], s32 offen offset:2048 sc1 lds
    v_mfma_f32_16x16x32_bf16 v[68:71], v[40:43], a[224:227], v[68:71]
    v_exp_f32 v18, v122
    v_mfma_f32_16x16x32_bf16 v[68:71], v[44:47], a[228:231], v[68:71]
    v_add_f32 v6, v6, v16
    v_add_f32 v6, v6, v17
    v_mfma_f32_16x16x32_bf16 v[72:75], v[40:43], a[248:251], v[72:75]
    ds_read_b128 v[36:39], v3 offset:256
    v_cvt_pk_bf16_f32 v154, v242, v246
    v_mfma_f32_16x16x32_bf16 v[72:75], v[44:47], a[252:255], v[72:75]
    v_exp_f32 v19, v123
    v_mfma_f32_16x16x32_bf16 v[76:79], v[40:43], v[208:211], v[76:79]
    v_cvt_pk_bf16_f32 v186, v16, v17
    v_cvt_pk_bf16_f32 v158, v243, v247
    v_mfma_f32_16x16x32_bf16 v[76:79], v[44:47], v[212:215], v[76:79]
    s_waitcnt lgkmcnt(2)
    v_exp_f32 v16, v188
    v_mfma_f32_16x16x32_bf16 v[96:99], v[24:27], a[200:203], v[96:99]
    s_waitcnt vmcnt(18)
    ds_read_b128 v[40:43], v2 offset:6400
    v_add_f32 v6, v6, v18
    v_mfma_f32_16x16x32_bf16 v[96:99], v[28:31], a[204:207], v[96:99]
    s_add_u32 s32, s32, 24576
    v_add_f32 v6, v6, v19
    v_mfma_f32_16x16x32_bf16 v[100:103], v[24:27], a[224:227], v[100:103]
    s_add_u32 s26, s26, 36864
    v_exp_f32 v17, v189
    v_mfma_f32_16x16x32_bf16 v[100:103], v[28:31], a[228:231], v[100:103]
    v_cvt_pk_bf16_f32 v187, v18, v19
    v_mfma_f32_16x16x32_bf16 v[104:107], v[24:27], a[248:251], v[104:107]
    ds_read_b128 v[44:47], v3 offset:6400
    v_cvt_f32_i32 v248, v248
    v_mfma_f32_16x16x32_bf16 v[104:107], v[28:31], a[252:255], v[104:107]
    s_sub_u32 s57, s26, 147456
    v_exp_f32 v18, v190
    v_mfma_f32_16x16x32_bf16 v[108:111], v[24:27], v[208:211], v[108:111]
    s_add_u32 s29, s30, 49152
    v_add_f32 v7, v7, v16
    v_mfma_f32_16x16x32_bf16 v[108:111], v[28:31], v[212:215], v[108:111]
    s_waitcnt lgkmcnt(2)
    buffer_load_dwordx4 v[240:243], v9, s[64:67], s33 offen offset:384 nt
    v_mfma_f32_16x16x32_bf16 v[64:67], v[32:35], a[208:211], v[64:67]
    s_sub_u32 s3, s29, 147456
    ds_read_b128 v[24:27], v2 offset:12288
    v_add_f32 v7, v7, v17
    v_mfma_f32_16x16x32_bf16 v[64:67], v[36:39], a[212:215], v[64:67]
    s_min_u32 s26, s26, s57
    v_exp_f32 v19, v191
    v_mfma_f32_16x16x32_bf16 v[68:71], v[32:35], a[232:235], v[68:71]
    v_cvt_pk_bf16_f32 v188, v16, v17
    v_cvt_f32_i32 v252, v252
    v_mfma_f32_16x16x32_bf16 v[68:71], v[36:39], a[236:239], v[68:71]
    buffer_load_dwordx4 v[244:247], v9, s[64:67], s33 offen offset:1920 nt
    v_mfma_f32_16x16x32_bf16 v[72:75], v[32:35], v[192:195], v[72:75]
    ds_read_b128 v[28:31], v3 offset:12288
    v_cvt_f32_i32 v249, v249
    v_mfma_f32_16x16x32_bf16 v[72:75], v[36:39], v[196:199], v[72:75]
    v_exp_f32 v16, v124
    v_mfma_f32_16x16x32_bf16 v[76:79], v[32:35], v[216:219], v[76:79]
    s_min_u32 s29, s29, s3
    v_add_f32 v7, v7, v18
    v_add_f32 v7, v7, v19
    v_mfma_f32_16x16x32_bf16 v[76:79], v[36:39], v[220:223], v[76:79]
    s_waitcnt lgkmcnt(2)
    v_exp_f32 v17, v125
    v_mfma_f32_16x16x32_bf16 v[96:99], v[40:43], a[208:211], v[96:99]
    ds_read_b128 v[32:35], v2 offset:18432
    v_cvt_f32_i32 v253, v253
    v_mfma_f32_16x16x32_bf16 v[96:99], v[44:47], a[212:215], v[96:99]
    v_cvt_pk_bf16_f32 v189, v18, v19
    v_fma_f32 v248, v248, v56, v58
    v_mfma_f32_16x16x32_bf16 v[100:103], v[40:43], a[232:235], v[100:103]
    v_exp_f32 v18, v126
    v_mfma_f32_16x16x32_bf16 v[100:103], v[44:47], a[236:239], v[100:103]
    v_add_f32 v7, v7, v16
    v_mfma_f32_16x16x32_bf16 v[104:107], v[40:43], v[192:195], v[104:107]
    s_sub_u32 s3, s29, s30
    ds_read_b128 v[36:39], v3 offset:18432
    v_add_f32 v7, v7, v17
    v_mfma_f32_16x16x32_bf16 v[104:107], v[44:47], v[196:199], v[104:107]
    s_waitcnt vmcnt(9)
    v_subrev_u32 v52, s92, v52
    v_cmp_lt_u32 vcc, 15, v52
    v_mfma_f32_16x16x32_bf16 v[108:111], v[40:43], v[216:219], v[108:111]
    v_exp_f32 v19, v127
    v_mfma_f32_16x16x32_bf16 v[108:111], v[44:47], v[220:223], v[108:111]
    s_waitcnt lgkmcnt(2)
    v_cvt_pk_bf16_f32 v190, v16, v17
    v_fma_f32 v252, v252, v57, v59
    s_branch L_skip6
L_pad6:
    s_branch L_tb1_8
L_skip6:
    v_mfma_f32_16x16x32_bf16 v[80:83], v[24:27], a[192:195], v[128:131]
    s_and_b32 s59, vcc_lo, 0xff
    ds_read_b128 v[40:43], v2 offset:12416
    v_add_f32 v7, v7, v18
    v_mfma_f32_16x16x32_bf16 v[80:83], v[28:31], a[196:199], v[80:83]
    s_cbranch_scc1 L_pollslow2
L_pollok2:
    v_mfma_f32_16x16x32_bf16 v[84:87], v[24:27], a[216:219], v[132:135]
    s_add_u32 s92, s92, 1
    v_add_f32 v7, v7, v19
    v_cvt_pk_bf16_f32 v191, v18, v19
    v_mfma_f32_16x16x32_bf16 v[84:87], v[28:31], a[220:223], v[84:87]
    s_mov_b32 m0, s26
    v_fma_f32 v249, v249, v56, v58
    v_fma_f32 v253, v253, v57, v59
    v_mfma_f32_16x16x32_bf16 v[88:91], v[24:27], a[240:243], v[136:139]
    s_mov_b32 s30, s29
    ds_read_b128 v[44:47], v3 offset:12416
    v_mfma_f32_16x16x32_bf16 v[88:91], v[28:31], a[244:247], v[88:91]
    buffer_load_dwordx4 v8, s[4:7], s32 offen offset:0 sc1 lds
    v_mfma_f32_16x16x32_bf16 v[92:95], v[24:27], v[200:203], v[140:143]
    v_exp_f32 v16, v64
    v_mfma_f32_16x16x32_bf16 v[92:95], v[28:31], v[204:207], v[92:95]
    s_waitcnt lgkmcnt(2)
    v_exp_f32 v17, v65
    v_mfma_f32_16x16x32_bf16 v[112:115], v[32:35], a[192:195], v[128:131]
    ds_read_b128 v[24:27], v2 offset:18560
    v_cvt_f32_i32 v250, v250
    v_mfma_f32_16x16x32_bf16 v[112:115], v[36:39], a[196:199], v[112:115]
    v_exp_f32 v18, v66
    v_mfma_f32_16x16x32_bf16 v[116:119], v[32:35], a[216:219], v[132:135]
    v_add_f32 v4, v4, v16
    v_add_f32 v4, v4, v17
    v_mfma_f32_16x16x32_bf16 v[116:119], v[36:39], a[220:223], v[116:119]
    buffer_load_dwordx4 v8, s[4:7], s32 offen offset:1024 sc1 lds
    v_mfma_f32_16x16x32_bf16 v[120:123], v[32:35], a[240:243], v[136:139]
    ds_read_b128 v[28:31], v3 offset:18560
    v_cvt_f32_i32 v254, v254
    v_mfma_f32_16x16x32_bf16 v[120:123], v[36:39], a[244:247], v[120:123]
    v_exp_f32 v19, v67
    v_mfma_f32_16x16x32_bf16 v[124:127], v[32:35], v[200:203], v[140:143]
    v_cvt_pk_bf16_f32 v64, v16, v17
    v_add_u32 v1, s3, v1
    v_mfma_f32_16x16x32_bf16 v[124:127], v[36:39], v[204:207], v[124:127]
    s_waitcnt lgkmcnt(2)
    v_exp_f32 v16, v96
    v_mfma_f32_16x16x32_bf16 v[80:83], v[40:43], a[200:203], v[80:83]
    ds_read_b128 v[32:35], v2 offset:12544
    v_add_f32 v4, v4, v18
    v_mfma_f32_16x16x32_bf16 v[80:83], v[44:47], a[204:207], v[80:83]
    buffer_load_dwordx4 v8, s[4:7], s32 offen offset:2048 sc1 lds
    v_mfma_f32_16x16x32_bf16 v[84:87], v[40:43], a[224:227], v[84:87]
    v_add_f32 v4, v4, v19
    v_cvt_f32_i32 v251, v251
    v_mfma_f32_16x16x32_bf16 v[84:87], v[44:47], a[228:231], v[84:87]
    v_exp_f32 v17, v97
    v_mfma_f32_16x16x32_bf16 v[88:91], v[40:43], a[248:251], v[88:91]
    s_add_u32 s32, s32, 24576
    ds_read_b128 v[36:39], v3 offset:12544
    v_cvt_pk_bf16_f32 v65, v18, v19
    v_mfma_f32_16x16x32_bf16 v[88:91], v[44:47], a[252:255], v[88:91]
    v_exp_f32 v18, v98
    v_mfma_f32_16x16x32_bf16 v[92:95], v[40:43], v[208:211], v[92:95]
    s_add_u32 s26, s26, 12288
    v_add_f32 v4, v4, v16
    v_add_f32 v4, v4, v17
    v_mfma_f32_16x16x32_bf16 v[92:95], v[44:47], v[212:215], v[92:95]
    s_waitcnt lgkmcnt(2)
    v_exp_f32 v19, v99
    v_mfma_f32_16x16x32_bf16 v[112:115], v[24:27], a[200:203], v[112:115]
    ds_read_b128 v[40:43], v2 offset:18688
    v_add_u32 v21, s3, v21
    v_mfma_f32_16x16x32_bf16 v[112:115], v[28:31], a[204:207], v[112:115]
    s_mov_b32 m0, s26
    v_cvt_pk_bf16_f32 v66, v16, v17
    v_cvt_f32_i32 v255, v255
    v_mfma_f32_16x16x32_bf16 v[116:119], v[24:27], a[224:227], v[116:119]
    v_exp_f32 v16, v68
    v_mfma_f32_16x16x32_bf16 v[116:119], v[28:31], a[228:231], v[116:119]
    v_add_f32 v4, v4, v18
    v_add_u32 v22, s3, v22
    v_mfma_f32_16x16x32_bf16 v[120:123], v[24:27], a[248:251], v[120:123]
    ds_read_b128 v[44:47], v3 offset:18688
    v_add_f32 v4, v4, v19
    v_mfma_f32_16x16x32_bf16 v[120:123], v[28:31], a[252:255], v[120:123]
    s_waitcnt lgkmcnt(2)
    buffer_load_dwordx4 v8, s[4:7], s32 offen offset:0 sc1 lds
    v_mfma_f32_16x16x32_bf16 v[124:127], v[24:27], v[208:211], v[124:127]
    s_waitcnt vmcnt(16)
    v_exp_f32 v17, v69
    v_mfma_f32_16x16x32_bf16 v[124:127], v[28:31], v[212:215], v[124:127]
    s_barrier
    v_cvt_pk_bf16_f32 v67, v18, v19
    v_mfma_f32_16x16x32_bf16 v[80:83], v[32:35], a[208:211], v[80:83]
    ds_read_b128 v[24:27], v1 offset:0
    v_fma_f32 v250, v250, v56, v58
    v_mfma_f32_16x16x32_bf16 v[80:83], v[36:39], a[212:215], v[80:83]
    v_exp_f32 v18, v70
    v_mfma_f32_16x16x32_bf16 v[84:87], v[32:35], a[232:235], v[84:87]
    v_add_f32 v5, v5, v16
    v_add_f32 v5, v5, v17
    v_mfma_f32_16x16x32_bf16 v[84:87], v[36:39], a[236:239], v[84:87]
    buffer_load_dwordx4 v8, s[4:7], s32 offen offset:1024 sc1 lds
    v_mfma_f32_16x16x32_bf16 v[88:91], v[32:35], v[192:195], v[88:91]
    ds_read_b128 v[28:31], v1 offset:12288
    v_fma_f32 v254, v254, v57, v59
    v_mfma_f32_16x16x32_bf16 v[88:91], v[36:39], v[196:199], v[88:91]
    v_exp_f32 v19, v71
    v_mfma_f32_16x16x32_bf16 v[92:95], v[32:35], v[216:219], v[92:95]
    v_cvt_pk_bf16_f32 v68, v16, v17
    v_fma_f32 v251, v251, v56, v58
    v_mfma_f32_16x16x32_bf16 v[92:95], v[36:39], v[220:223], v[92:95]
    s_waitcnt lgkmcnt(2)
    buffer_load_dwordx4 v8, s[4:7], s32 offen offset:2048 sc1 lds
    v_mfma_f32_16x16x32_bf16 v[112:115], v[40:43], a[208:211], v[112:115]
    ds_read_b128 v[32:35], v1 offset:768
    v_fma_f32 v255, v255, v57, v59
    v_mfma_f32_16x16x32_bf16 v[112:115], v[44:47], a[212:215], v[112:115]
    v_exp_f32 v16, v100
    v_add_f32 v5, v5, v18
    v_mfma_f32_16x16x32_bf16 v[116:119], v[40:43], a[232:235], v[116:119]
    v_add_f32 v5, v5, v19
    v_cvt_pk_bf16_f32 v147, v248, v252
    v_mfma_f32_16x16x32_bf16 v[116:119], v[44:47], a[236:239], v[116:119]
    v_exp_f32 v17, v101
    v_mfma_f32_16x16x32_bf16 v[120:123], v[40:43], v[192:195], v[120:123]
    ds_read_b128 v[36:39], v1 offset:13056
    v_cvt_pk_bf16_f32 v69, v18, v19
    v_mfma_f32_16x16x32_bf16 v[120:123], v[44:47], v[196:199], v[120:123]
    s_add_u32 s32, s32, 24576
    v_exp_f32 v18, v102
    v_mfma_f32_16x16x32_bf16 v[124:127], v[40:43], v[216:219], v[124:127]
    s_add_u32 s26, s26, 36864
    v_add_f32 v5, v5, v16
    v_add_f32 v5, v5, v17
    v_mfma_f32_16x16x32_bf16 v[124:127], v[44:47], v[220:223], v[124:127]
    s_waitcnt lgkmcnt(2)
    v_exp_f32 v19, v103
    v_cvt_pk_bf16_f32 v70, v16, v17
    v_add_f32 v5, v5, v18
    v_cvt_pk_bf16_f32 v151, v249, v253
    v_add_f32 v5, v5, v19
    s_sub_u32 s57, s26, 147456
    v_cvt_pk_bf16_f32 v155, v250, v254
    v_cvt_pk_bf16_f32 v71, v18, v19
    s_min_u32 s26, s26, s57
    v_cvt_pk_bf16_f32 v159, v251, v255
    v_mfma_f32_16x16x32_bf16 a[0:3], v[160:163], v[24:27], a[0:3]
    ds_read_b128 v[40:43], v1 offset:1536
    v_mfma_f32_16x16x32_bf16 a[0:3], v[176:179], v[28:31], a[0:3]
    buffer_store_dwordx4 v[144:147], v20, s[4:7], s81 offen offset:0 sc1
    v_mfma_f32_16x16x32_bf16 a[48:51], v[164:167], v[24:27], a[48:51]
    v_exp_f32 v16, v72
    v_mfma_f32_16x16x32_bf16 a[48:51], v[180:183], v[28:31], a[48:51]
    v_exp_f32 v17, v73
    v_mfma_f32_16x16x32_bf16 a[96:99], v[168:171], v[24:27], a[96:99]
    ds_read_b128 v[44:47], v1 offset:13824
    v_mfma_f32_16x16x32_bf16 a[96:99], v[184:187], v[28:31], a[96:99]
    v_exp_f32 v18, v74
    v_mfma_f32_16x16x32_bf16 a[144:147], v[172:175], v[24:27], a[144:147]
    v_add_f32 v6, v6, v16
    v_add_f32 v6, v6, v17
    v_mfma_f32_16x16x32_bf16 a[144:147], v[188:191], v[28:31], a[144:147]
    s_waitcnt lgkmcnt(2)
    v_exp_f32 v19, v75
    v_mfma_f32_16x16x32_bf16 a[4:7], v[160:163], v[32:35], a[4:7]
    ds_read_b128 v[24:27], v1 offset:2304
    v_cvt_pk_bf16_f32 v72, v16, v17
    v_mfma_f32_16x16x32_bf16 a[4:7], v[176:179], v[36:39], a[4:7]
    buffer_store_dwordx4 v[148:151], v20, s[4:7], s81 offen offset:768 sc1
    v_mfma_f32_16x16x32_bf16 a[52:55], v[164:167], v[32:35], a[52:55]
    v_exp_f32 v16, v104
    v_mfma_f32_16x16x32_bf16 a[52:55], v[180:183], v[36:39], a[52:55]
    v_add_f32 v6, v6, v18
    v_add_f32 v6, v6, v19
    v_mfma_f32_16x16x32_bf16 a[100:103], v[168:171], v[32:35], a[100:103]
    ds_read_b128 v[28:31], v1 offset:14592
    v_mfma_f32_16x16x32_bf16 a[100:103], v[184:187], v[36:39], a[100:103]
    v_exp_f32 v17, v105
    v_mfma_f32_16x16x32_bf16 a[148:151], v[172:175], v[32:35], a[148:151]
    v_cvt_pk_bf16_f32 v73, v18, v19
    v_mfma_f32_16x16x32_bf16 a[148:151], v[188:191], v[36:39], a[148:151]
    s_waitcnt lgkmcnt(2)
    v_exp_f32 v18, v106
    v_mfma_f32_16x16x32_bf16 a[8:11], v[160:163], v[40:43], a[8:11]
    ds_read_b128 v[32:35], v21 offset:0
    v_add_f32 v6, v6, v16
    v_mfma_f32_16x16x32_bf16 a[8:11], v[176:179], v[44:47], a[8:11]
    buffer_store_dwordx4 v[152:155], v20, s[4:7], s81 offen offset:1536 sc1
    v_mfma_f32_16x16x32_bf16 a[56:59], v[164:167], v[40:43], a[56:59]
    v_add_f32 v6, v6, v17
    v_mfma_f32_16x16x32_bf16 a[56:59], v[180:183], v[44:47], a[56:59]
    v_exp_f32 v19, v107
    v_mfma_f32_16x16x32_bf16 a[104:107], v[168:171], v[40:43], a[104:107]
    ds_read_b128 v[36:39], v21 offset:12288
    v_cvt_pk_bf16_f32 v74, v16, v17
    v_mfma_f32_16x16x32_bf16 a[104:107], v[184:187], v[44:47], a[104:107]
    v_exp_f32 v16, v76
    v_mfma_f32_16x16x32_bf16 a[152:155], v[172:175], v[40:43], a[152:155]
    v_add_f32 v6, v6, v18
    v_mfma_f32_16x16x32_bf16 a[152:155], v[188:191], v[44:47], a[152:155]
    s_waitcnt lgkmcnt(2)
    v_add_f32 v6, v6, v19
    v_mfma_f32_16x16x32_bf16 a[12:15], v[160:163], v[24:27], a[12:15]
    ds_read_b128 v[40:43], v21 offset:768
    v_mfma_f32_16x16x32_bf16 a[12:15], v[176:179], v[28:31], a[12:15]
    buffer_store_dwordx4 v[156:159], v20, s[4:7], s81 offen offset:2304 sc1
    v_mfma_f32_16x16x32_bf16 a[60:63], v[164:167], v[24:27], a[60:63]
    v_exp_f32 v17, v77
    v_mfma_f32_16x16x32_bf16 a[60:63], v[180:183], v[28:31], a[60:63]
    v_cvt_pk_bf16_f32 v75, v18, v19
    v_mfma_f32_16x16x32_bf16 a[108:111], v[168:171], v[24:27], a[108:111]
    ds_read_b128 v[44:47], v21 offset:13056
    v_mfma_f32_16x16x32_bf16 a[108:111], v[184:187], v[28:31], a[108:111]
    v_exp_f32 v18, v78
    v_mfma_f32_16x16x32_bf16 a[156:159], v[172:175], v[24:27], a[156:159]
    s_add_u32 s29, s28, 49152
    v_add_f32 v7, v7, v16
    v_add_f32 v7, v7, v17
    v_mfma_f32_16x16x32_bf16 a[156:159], v[188:191], v[28:31], a[156:159]
    s_waitcnt lgkmcnt(2)
    v_exp_f32 v19, v79
    v_mfma_f32_16x16x32_bf16 a[16:19], v[160:163], v[32:35], a[16:19]
    ds_read_b128 v[24:27], v21 offset:1536
    v_cvt_pk_bf16_f32 v76, v16, v17
    v_mfma_f32_16x16x32_bf16 a[16:19], v[176:179], v[36:39], a[16:19]
    s_sub_u32 s3, s29, 147456
    ds_read_b128 v[56:59], v10 offset:384
    s_waitcnt vmcnt(17)
    v_mfma_f32_16x16x32_bf16 a[64:67], v[164:167], v[32:35], a[64:67]
    s_mov_b32 m0, s56
    v_exp_f32 v16, v108
    v_mfma_f32_16x16x32_bf16 a[64:67], v[180:183], v[36:39], a[64:67]
    v_add_f32 v7, v7, v18
    v_cvt_f32_i32 v224, v224
    v_mfma_f32_16x16x32_bf16 a[112:115], v[168:171], v[32:35], a[112:115]
    ds_read_b128 v[28:31], v21 offset:13824
    v_add_f32 v7, v7, v19
    v_mfma_f32_16x16x32_bf16 a[112:115], v[184:187], v[36:39], a[112:115]
    buffer_load_dwordx4 v8, s[4:7], s27 offen offset:0 sc1 lds
    v_mfma_f32_16x16x32_bf16 a[160:163], v[172:175], v[32:35], a[160:163]
    v_exp_f32 v17, v109
    v_mfma_f32_16x16x32_bf16 a[160:163], v[188:191], v[36:39], a[160:163]
    s_waitcnt lgkmcnt(3)
    v_cvt_pk_bf16_f32 v77, v18, v19
    v_cvt_f32_i32 v225, v225
    v_mfma_f32_16x16x32_bf16 a[20:23], v[160:163], v[40:43], a[20:23]
    s_min_u32 s29, s29, s3
    ds_read_b128 v[32:35], v21 offset:2304
    v_cvt_f32_i32 v228, v228
    v_mfma_f32_16x16x32_bf16 a[20:23], v[176:179], v[44:47], a[20:23]
    v_exp_f32 v18, v110
    v_mfma_f32_16x16x32_bf16 a[68:71], v[164:167], v[40:43], a[68:71]
    v_add_f32 v7, v7, v16
    v_add_f32 v7, v7, v17
    v_mfma_f32_16x16x32_bf16 a[68:71], v[180:183], v[44:47], a[68:71]
    buffer_load_dwordx4 v8, s[4:7], s27 offen offset:1024 sc1 lds
    v_mfma_f32_16x16x32_bf16 a[116:119], v[168:171], v[40:43], a[116:119]
    ds_read_b128 v[36:39], v21 offset:14592
    v_mfma_f32_16x16x32_bf16 a[116:119], v[184:187], v[44:47], a[116:119]
    v_exp_f32 v19, v111
    v_mfma_f32_16x16x32_bf16 a[164:167], v[172:175], v[40:43], a[164:167]
    s_sub_u32 s3, s29, s28
    ds_read_b128 v[60:63], v10 offset:768
    v_cvt_pk_bf16_f32 v78, v16, v17
    v_mfma_f32_16x16x32_bf16 a[164:167], v[188:191], v[44:47], a[164:167]
    s_waitcnt lgkmcnt(3)
    v_exp_f32 v16, v80
    v_mfma_f32_16x16x32_bf16 a[24:27], v[160:163], v[24:27], a[24:27]
    ds_read_b128 v[40:43], v22 offset:0
    v_add_f32 v7, v7, v18
    v_mfma_f32_16x16x32_bf16 a[24:27], v[176:179], v[28:31], a[24:27]
    buffer_load_dwordx4 v8, s[4:7], s27 offen offset:2048 sc1 lds
    v_mfma_f32_16x16x32_bf16 a[72:75], v[164:167], v[24:27], a[72:75]
    v_add_f32 v7, v7, v19
    v_cvt_f32_i32 v229, v229
    v_mfma_f32_16x16x32_bf16 a[72:75], v[180:183], v[28:31], a[72:75]
    v_exp_f32 v17, v81
    v_mfma_f32_16x16x32_bf16 a[120:123], v[168:171], v[24:27], a[120:123]
    s_add_u32 s27, s27, 24576
    ds_read_b128 v[44:47], v22 offset:12288
    v_cvt_pk_bf16_f32 v79, v18, v19
    v_mfma_f32_16x16x32_bf16 a[120:123], v[184:187], v[28:31], a[120:123]
    s_mov_b32 s28, s29
    v_exp_f32 v18, v82
    v_mfma_f32_16x16x32_bf16 a[168:171], v[172:175], v[24:27], a[168:171]
    v_add_f32 v4, v4, v16
    v_fma_f32 v224, v224, v48, v50
    v_mfma_f32_16x16x32_bf16 a[168:171], v[188:191], v[28:31], a[168:171]
    s_waitcnt lgkmcnt(3)
    v_add_f32 v4, v4, v17
    v_fma_f32 v225, v225, v49, v51
    v_mfma_f32_16x16x32_bf16 a[28:31], v[160:163], v[32:35], a[28:31]
    s_add_u32 s56, s56, 12288
    ds_read_b128 v[24:27], v22 offset:768
    v_fma_f32 v228, v228, v48, v50
    v_mfma_f32_16x16x32_bf16 a[28:31], v[176:179], v[36:39], a[28:31]
    s_mov_b32 m0, s56
    v_exp_f32 v19, v83
    v_mfma_f32_16x16x32_bf16 a[76:79], v[164:167], v[32:35], a[76:79]
    v_cvt_pk_bf16_f32 v80, v16, v17
    v_fma_f32 v229, v229, v49, v51
    v_mfma_f32_16x16x32_bf16 a[76:79], v[180:183], v[36:39], a[76:79]
    v_exp_f32 v16, v112
    v_mfma_f32_16x16x32_bf16 a[124:127], v[168:171], v[32:35], a[124:127]
    ds_read_b128 v[28:31], v22 offset:13056
    v_add_f32 v4, v4, v18
    v_mfma_f32_16x16x32_bf16 a[124:127], v[184:187], v[36:39], a[124:127]
    v_add_f32 v4, v4, v19
    v_cvt_pk_bf16_f32 v224, v224, v225
    v_mfma_f32_16x16x32_bf16 a[172:175], v[172:175], v[32:35], a[172:175]
    v_exp_f32 v17, v113
    v_mfma_f32_16x16x32_bf16 a[172:175], v[188:191], v[36:39], a[172:175]
    s_waitcnt lgkmcnt(2)
    buffer_load_dwordx4 v8, s[4:7], s27 offen offset:0 sc1 lds
    v_mfma_f32_16x16x32_bf16 a[32:35], v[160:163], v[40:43], a[32:35]
    ds_read_b128 v[32:35], v22 offset:1536
    v_cvt_pk_bf16_f32 v81, v18, v19
    v_mfma_f32_16x16x32_bf16 a[32:35], v[176:179], v[44:47], a[32:35]
    v_exp_f32 v18, v114
    v_mfma_f32_16x16x32_bf16 a[80:83], v[164:167], v[40:43], a[80:83]
    v_add_f32 v4, v4, v16
    v_add_f32 v4, v4, v17
    v_mfma_f32_16x16x32_bf16 a[80:83], v[180:183], v[44:47], a[80:83]
    buffer_load_dwordx4 v8, s[4:7], s27 offen offset:1024 sc1 lds
    v_mfma_f32_16x16x32_bf16 a[128:131], v[168:171], v[40:43], a[128:131]
    ds_read_b128 v[36:39], v22 offset:13824
    v_cvt_pk_bf16_f32 v228, v228, v229
    v_mfma_f32_16x16x32_bf16 a[128:131], v[184:187], v[44:47], a[128:131]
    v_exp_f32 v19, v115
    v_mfma_f32_16x16x32_bf16 a[176:179], v[172:175], v[40:43], a[176:179]
    v_cvt_pk_bf16_f32 v82, v16, v17
    v_add_u32 v2, s3, v2
    v_mfma_f32_16x16x32_bf16 a[176:179], v[188:191], v[44:47], a[176:179]
    s_waitcnt lgkmcnt(2)
    v_exp_f32 v16, v84
    v_mfma_f32_16x16x32_bf16 a[36:39], v[160:163], v[24:27], a[36:39]
    ds_read_b128 v[40:43], v22 offset:2304
    v_add_f32 v4, v4, v18
    v_mfma_f32_16x16x32_bf16 a[36:39], v[176:179], v[28:31], a[36:39]
    buffer_load_dwordx4 v8, s[4:7], s27 offen offset:2048 sc1 lds
    v_mfma_f32_16x16x32_bf16 a[84:87], v[164:167], v[24:27], a[84:87]
    v_add_f32 v4, v4, v19
    v_cvt_f32_i32 v226, v226
    v_mfma_f32_16x16x32_bf16 a[84:87], v[180:183], v[28:31], a[84:87]
    v_exp_f32 v17, v85
    v_mfma_f32_16x16x32_bf16 a[132:135], v[168:171], v[24:27], a[132:135]
    ds_read_b128 v[44:47], v22 offset:14592
    v_add_u32 v3, s3, v3
    v_mfma_f32_16x16x32_bf16 a[132:135], v[184:187], v[28:31], a[132:135]
    s_waitcnt lgkmcnt(2)
    v_cvt_pk_bf16_f32 v83, v18, v19
    v_cvt_f32_i32 v227, v227
    v_mfma_f32_16x16x32_bf16 a[180:183], v[172:175], v[24:27], a[180:183]
    s_waitcnt vmcnt(6)
    v_exp_f32 v18, v86
    v_mfma_f32_16x16x32_bf16 a[180:183], v[188:191], v[28:31], a[180:183]
    s_barrier
    v_add_f32 v5, v5, v16
    v_mfma_f32_16x16x32_bf16 a[40:43], v[160:163], v[32:35], a[40:43]
    s_add_u32 s27, s27, 24576
    ds_read_b128 v[24:27], v2 offset:0
    v_add_f32 v5, v5, v17
    v_mfma_f32_16x16x32_bf16 a[40:43], v[176:179], v[36:39], a[40:43]
    s_add_u32 s56, s56, 36864
    v_exp_f32 v19, v87
    v_mfma_f32_16x16x32_bf16 a[88:91], v[164:167], v[32:35], a[88:91]
    v_cvt_f32_i32 v230, v230
    v_cvt_pk_bf16_f32 v84, v16, v17
    v_mfma_f32_16x16x32_bf16 a[88:91], v[180:183], v[36:39], a[88:91]
    s_sub_u32 s58, s56, 147456
    v_exp_f32 v16, v116
    v_mfma_f32_16x16x32_bf16 a[136:139], v[168:171], v[32:35], a[136:139]
    ds_read_b128 v[28:31], v3 offset:0
    v_cvt_f32_i32 v231, v231
    v_mfma_f32_16x16x32_bf16 a[136:139], v[184:187], v[36:39], a[136:139]
    buffer_load_dwordx4 v[248:251], v9, s[64:67], s34 offen offset:384 nt
    v_mfma_f32_16x16x32_bf16 a[184:187], v[172:175], v[32:35], a[184:187]
    s_min_u32 s56, s56, s58
    v_add_f32 v5, v5, v18
    v_add_f32 v5, v5, v19
    v_mfma_f32_16x16x32_bf16 a[184:187], v[188:191], v[36:39], a[184:187]
    s_waitcnt lgkmcnt(2)
    v_exp_f32 v17, v117
    v_mfma_f32_16x16x32_bf16 a[44:47], v[160:163], v[40:43], a[44:47]
    ds_read_b128 v[32:35], v2 offset:6144
    v_fma_f32 v226, v226, v56, v58
    v_mfma_f32_16x16x32_bf16 a[44:47], v[176:179], v[44:47], a[44:47]
    buffer_load_dwordx4 v[252:255], v9, s[64:67], s34 offen offset:1920 nt
    v_mfma_f32_16x16x32_bf16 a[92:95], v[164:167], v[40:43], a[92:95]
    v_cvt_pk_bf16_f32 v85, v18, v19
    v_fma_f32 v227, v227, v57, v59
    v_mfma_f32_16x16x32_bf16 a[92:95], v[180:183], v[44:47], a[92:95]
    v_exp_f32 v18, v118
    v_mfma_f32_16x16x32_bf16 a[140:143], v[168:171], v[40:43], a[140:143]
    ds_read_b128 v[36:39], v3 offset:6144
    v_add_f32 v5, v5, v16
    v_mfma_f32_16x16x32_bf16 a[140:143], v[184:187], v[44:47], a[140:143]
    v_add_u32 v55, 1, v55
    buffer_store_dword v55, v13, s[20:23], 0 offen sc1
    v_mfma_f32_16x16x32_bf16 a[188:191], v[172:175], v[40:43], a[188:191]
    v_add_f32 v5, v5, v17
    v_fma_f32 v230, v230, v56, v58
    v_mfma_f32_16x16x32_bf16 a[188:191], v[188:191], v[44:47], a[188:191]
    s_waitcnt lgkmcnt(2)
    v_exp_f32 v19, v119
    v_cvt_pk_bf16_f32 v86, v16, v17
    v_add_f32 v5, v5, v18
    v_fma_f32 v231, v231, v57, v59
    v_add_f32 v5, v5, v19
    v_cvt_pk_bf16_f32 v225, v226, v227
    v_cvt_pk_bf16_f32 v87, v18, v19
    v_cvt_pk_bf16_f32 v229, v230, v231
    v_mfma_f32_16x16x32_bf16 v[160:163], v[24:27], a[192:195], v[128:131]
    ds_read_b128 v[40:43], v2 offset:128
    s_add_u32 s35, s35, 196608
    v_mfma_f32_16x16x32_bf16 v[160:163], v[28:31], a[196:199], v[160:163]
    s_waitcnt vmcnt(24)
    v_exp_f32 v16, v88
    v_mfma_f32_16x16x32_bf16 v[164:167], v[24:27], a[216:219], v[132:135]
    s_sub_u32 s36, s35, 1572864
    v_exp_f32 v17, v89
    v_mfma_f32_16x16x32_bf16 v[164:167], v[28:31], a[220:223], v[164:167]
    s_min_u32 s35, s35, s36
    v_exp_f32 v18, v90
    v_mfma_f32_16x16x32_bf16 v[168:171], v[24:27], a[240:243], v[136:139]
    ds_read_b128 v[44:47], v3 offset:128
    v_cvt_f32_i32 v232, v232
    v_mfma_f32_16x16x32_bf16 v[168:171], v[28:31], a[244:247], v[168:171]
    s_add_u32 s36, s35, 3072
    v_add_f32 v6, v6, v16
    v_cvt_f32_i32 v233, v233
    v_mfma_f32_16x16x32_bf16 v[172:175], v[24:27], v[200:203], v[140:143]
    v_add_f32 v6, v6, v17
    v_mfma_f32_16x16x32_bf16 v[172:175], v[28:31], v[204:207], v[172:175]
    s_waitcnt lgkmcnt(2)
    v_exp_f32 v19, v91
    v_mfma_f32_16x16x32_bf16 v[96:99], v[32:35], a[192:195], v[128:131]
    s_add_u32 s81, s81, 196608
    ds_read_b128 v[24:27], v2 offset:6272
    v_cvt_f32_i32 v236, v236
    v_mfma_f32_16x16x32_bf16 v[96:99], v[36:39], a[196:199], v[96:99]
    v_cvt_pk_bf16_f32 v88, v16, v17
    v_mfma_f32_16x16x32_bf16 v[100:103], v[32:35], a[216:219], v[132:135]
    v_exp_f32 v16, v120
    v_mfma_f32_16x16x32_bf16 v[100:103], v[36:39], a[220:223], v[100:103]
    buffer_load_dwordx4 v[144:147], v12, s[68:71], s35 offen offset:0 nt
    v_mfma_f32_16x16x32_bf16 v[104:107], v[32:35], a[240:243], v[136:139]
    ds_read_b128 v[28:31], v3 offset:6272
    v_add_f32 v6, v6, v18
    v_mfma_f32_16x16x32_bf16 v[104:107], v[36:39], a[244:247], v[104:107]
    v_add_f32 v6, v6, v19
    v_cvt_f32_i32 v237, v237
    v_mfma_f32_16x16x32_bf16 v[108:111], v[32:35], v[200:203], v[140:143]
    v_exp_f32 v17, v121
    v_mfma_f32_16x16x32_bf16 v[108:111], v[36:39], v[204:207], v[108:111]
    s_waitcnt lgkmcnt(2)
    v_cvt_pk_bf16_f32 v89, v18, v19
    v_fma_f32 v232, v232, v48, v50
    v_mfma_f32_16x16x32_bf16 v[160:163], v[40:43], a[200:203], v[160:163]
    ds_read_b128 v[32:35], v2 offset:256
    v_fma_f32 v233, v233, v49, v51
    v_mfma_f32_16x16x32_bf16 v[160:163], v[44:47], a[204:207], v[160:163]
    buffer_load_dwordx4 v[148:151], v12, s[68:71], s35 offen offset:768 nt
    v_mfma_f32_16x16x32_bf16 v[164:167], v[40:43], a[224:227], v[164:167]
    v_exp_f32 v18, v122
    v_mfma_f32_16x16x32_bf16 v[164:167], v[44:47], a[228:231], v[164:167]
    v_add_f32 v6, v6, v16
    v_add_f32 v6, v6, v17
    v_mfma_f32_16x16x32_bf16 v[168:171], v[40:43], a[248:251], v[168:171]
    ds_read_b128 v[36:39], v3 offset:256
    v_fma_f32 v236, v236, v48, v50
    v_mfma_f32_16x16x32_bf16 v[168:171], v[44:47], a[252:255], v[168:171]
    buffer_load_dwordx4 v[152:155], v12, s[68:71], s35 offen offset:1536 nt
    v_mfma_f32_16x16x32_bf16 v[172:175], v[40:43], v[208:211], v[172:175]
    v_exp_f32 v19, v123
    v_mfma_f32_16x16x32_bf16 v[172:175], v[44:47], v[212:215], v[172:175]
    s_waitcnt lgkmcnt(2)
    v_cvt_pk_bf16_f32 v90, v16, v17
    v_fma_f32 v237, v237, v49, v51
    v_mfma_f32_16x16x32_bf16 v[96:99], v[24:27], a[200:203], v[96:99]
    ds_read_b128 v[40:43], v2 offset:6400
    v_mfma_f32_16x16x32_bf16 v[96:99], v[28:31], a[204:207], v[96:99]
    v_exp_f32 v16, v92
    v_mfma_f32_16x16x32_bf16 v[100:103], v[24:27], a[224:227], v[100:103]
    v_add_f32 v6, v6, v18
    v_add_f32 v6, v6, v19
    v_mfma_f32_16x16x32_bf16 v[100:103], v[28:31], a[228:231], v[100:103]
    buffer_load_dwordx4 v[156:159], v12, s[68:71], s35 offen offset:2304 nt
    v_mfma_f32_16x16x32_bf16 v[104:107], v[24:27], a[248:251], v[104:107]
    ds_read_b128 v[44:47], v3 offset:6400
    v_cvt_pk_bf16_f32 v232, v232, v233
    v_mfma_f32_16x16x32_bf16 v[104:107], v[28:31], a[252:255], v[104:107]
    v_exp_f32 v17, v93
    v_mfma_f32_16x16x32_bf16 v[108:111], v[24:27], v[208:211], v[108:111]
    s_add_u32 s29, s30, 49152
    v_cvt_pk_bf16_f32 v91, v18, v19
    v_cvt_pk_bf16_f32 v236, v236, v237
    v_mfma_f32_16x16x32_bf16 v[108:111], v[28:31], v[212:215], v[108:111]
    s_waitcnt lgkmcnt(2)
    v_exp_f32 v18, v94
    v_mfma_f32_16x16x32_bf16 v[160:163], v[32:35], a[208:211], v[160:163]
    s_mov_b32 m0, s26
    ds_read_b128 v[24:27], v2 offset:12288
    v_add_f32 v7, v7, v16
    v_mfma_f32_16x16x32_bf16 v[160:163], v[36:39], a[212:215], v[160:163]
    s_sub_u32 s3, s29, 147456
    buffer_load_dwordx4 v8, s[4:7], s32 offen offset:0 sc1 lds
    v_mfma_f32_16x16x32_bf16 v[164:167], v[32:35], a[232:235], v[164:167]
    v_add_f32 v7, v7, v17
    v_cvt_f32_i32 v234, v234
    v_mfma_f32_16x16x32_bf16 v[164:167], v[36:39], a[236:239], v[164:167]
    v_exp_f32 v19, v95
    v_mfma_f32_16x16x32_bf16 v[168:171], v[32:35], v[192:195], v[168:171]
    ds_read_b128 v[28:31], v3 offset:12288
    v_cvt_pk_bf16_f32 v92, v16, v17
    v_mfma_f32_16x16x32_bf16 v[168:171], v[36:39], v[196:199], v[168:171]
    buffer_load_dwordx4 v8, s[4:7], s32 offen offset:1024 sc1 lds
    v_mfma_f32_16x16x32_bf16 v[172:175], v[32:35], v[216:219], v[172:175]
    s_min_u32 s29, s29, s3
    v_exp_f32 v16, v124
    v_mfma_f32_16x16x32_bf16 v[172:175], v[36:39], v[220:223], v[172:175]
    s_waitcnt lgkmcnt(2)
    v_add_f32 v7, v7, v18
    v_add_f32 v7, v7, v19
    v_mfma_f32_16x16x32_bf16 v[96:99], v[40:43], a[208:211], v[96:99]
    ds_read_b128 v[32:35], v2 offset:18432
    v_cvt_f32_i32 v235, v235
    v_mfma_f32_16x16x32_bf16 v[96:99], v[44:47], a[212:215], v[96:99]
    buffer_load_dwordx4 v8, s[4:7], s32 offen offset:2048 sc1 lds
    v_mfma_f32_16x16x32_bf16 v[100:103], v[40:43], a[232:235], v[100:103]
    v_exp_f32 v17, v125
    v_mfma_f32_16x16x32_bf16 v[100:103], v[44:47], a[236:239], v[100:103]
    v_cvt_pk_bf16_f32 v93, v18, v19
    v_cvt_f32_i32 v238, v238
    v_mfma_f32_16x16x32_bf16 v[104:107], v[40:43], v[192:195], v[104:107]
    s_add_u32 s32, s32, 24576
    ds_read_b128 v[36:39], v3 offset:18432
    v_cvt_f32_i32 v239, v239
    v_mfma_f32_16x16x32_bf16 v[104:107], v[44:47], v[196:199], v[104:107]
    s_sub_u32 s3, s29, s30
    v_exp_f32 v18, v126
    v_mfma_f32_16x16x32_bf16 v[108:111], v[40:43], v[216:219], v[108:111]
    s_add_u32 s26, s26, 12288
    v_add_f32 v7, v7, v16
    v_add_f32 v7, v7, v17
    v_mfma_f32_16x16x32_bf16 v[108:111], v[44:47], v[220:223], v[108:111]
    s_waitcnt lgkmcnt(2)
    v_exp_f32 v19, v127
    v_mfma_f32_16x16x32_bf16 v[176:179], v[24:27], a[192:195], v[128:131]
    s_mov_b32 m0, s26
    ds_read_b128 v[40:43], v2 offset:12416
    v_cvt_pk_bf16_f32 v94, v16, v17
    v_mfma_f32_16x16x32_bf16 v[176:179], v[28:31], a[196:199], v[176:179]
    v_add_f32 v7, v7, v18
    v_add_f32 v7, v7, v19
    v_mfma_f32_16x16x32_bf16 v[180:183], v[24:27], a[216:219], v[132:135]
    s_mov_b32 s30, s29
    v_cvt_pk_bf16_f32 v95, v18, v19
    v_fma_f32 v234, v234, v56, v58
    v_mfma_f32_16x16x32_bf16 v[180:183], v[28:31], a[220:223], v[180:183]
    buffer_load_dwordx4 v8, s[4:7], s32 offen offset:0 sc1 lds
    v_mfma_f32_16x16x32_bf16 v[184:187], v[24:27], a[240:243], v[136:139]
    ds_read_b128 v[44:47], v3 offset:12416
    v_fma_f32 v235, v235, v57, v59
    v_mfma_f32_16x16x32_bf16 v[184:187], v[28:31], a[244:247], v[184:187]
    v_exp_f32 v16, v160
    v_mfma_f32_16x16x32_bf16 v[188:191], v[24:27], v[200:203], v[140:143]
    v_exp_f32 v17, v161
    v_mfma_f32_16x16x32_bf16 v[188:191], v[28:31], v[204:207], v[188:191]
    s_waitcnt lgkmcnt(2)
    buffer_load_dwordx4 v8, s[4:7], s32 offen offset:1024 sc1 lds
    v_mfma_f32_16x16x32_bf16 v[112:115], v[32:35], a[192:195], v[128:131]
    ds_read_b128 v[24:27], v2 offset:18560
    v_fma_f32 v238, v238, v56, v58
    v_mfma_f32_16x16x32_bf16 v[112:115], v[36:39], a[196:199], v[112:115]
    v_exp_f32 v18, v162
    v_mfma_f32_16x16x32_bf16 v[116:119], v[32:35], a[216:219], v[132:135]
    v_add_f32 v4, v4, v16
    v_add_f32 v4, v4, v17
    v_mfma_f32_16x16x32_bf16 v[116:119], v[36:39], a[220:223], v[116:119]
    buffer_load_dwordx4 v8, s[4:7], s32 offen offset:2048 sc1 lds
    v_mfma_f32_16x16x32_bf16 v[120:123], v[32:35], a[240:243], v[136:139]
    ds_read_b128 v[28:31], v3 offset:18560
    v_fma_f32 v239, v239, v57, v59
    v_mfma_f32_16x16x32_bf16 v[120:123], v[36:39], a[244:247], v[120:123]
    v_exp_f32 v19, v163
    v_mfma_f32_16x16x32_bf16 v[124:127], v[32:35], v[200:203], v[140:143]
    v_cvt_pk_bf16_f32 v160, v16, v17
    v_cvt_pk_bf16_f32 v233, v234, v235
    v_mfma_f32_16x16x32_bf16 v[124:127], v[36:39], v[204:207], v[124:127]
    s_waitcnt lgkmcnt(2)
    v_exp_f32 v16, v96
    v_mfma_f32_16x16x32_bf16 v[176:179], v[40:43], a[200:203], v[176:179]
    s_add_u32 s32, s32, 24576
    ds_read_b128 v[32:35], v2 offset:12544
    v_add_f32 v4, v4, v18
    v_mfma_f32_16x16x32_bf16 v[176:179], v[44:47], a[204:207], v[176:179]
    s_add_u32 s26, s26, 36864
    v_add_f32 v4, v4, v19
    v_cvt_pk_bf16_f32 v237, v238, v239
    v_mfma_f32_16x16x32_bf16 v[180:183], v[40:43], a[224:227], v[180:183]
    v_exp_f32 v17, v97
    v_mfma_f32_16x16x32_bf16 v[180:183], v[44:47], a[228:231], v[180:183]
    s_sub_u32 s57, s26, 147456
    v_cvt_pk_bf16_f32 v161, v18, v19
    v_bfe_u32 v53, v8, 4, 6
    v_mfma_f32_16x16x32_bf16 v[184:187], v[40:43], a[248:251], v[184:187]
    ds_read_b128 v[36:39], v3 offset:12544
    v_add_u32 v1, s3, v1
    v_mfma_f32_16x16x32_bf16 v[184:187], v[44:47], a[252:255], v[184:187]
    v_exp_f32 v18, v98
    v_mfma_f32_16x16x32_bf16 v[188:191], v[40:43], v[208:211], v[188:191]
    s_min_u32 s26, s26, s57
    v_lshlrev_b32 v53, 2, v53
    v_add_f32 v4, v4, v16
    v_mfma_f32_16x16x32_bf16 v[188:191], v[44:47], v[212:215], v[188:191]
    s_waitcnt lgkmcnt(2)
    buffer_load_dword v52, v53, s[20:23], 0 offen sc1
    v_mfma_f32_16x16x32_bf16 v[112:115], v[24:27], a[200:203], v[112:115]
    ds_read_b128 v[40:43], v2 offset:18688
    v_add_f32 v4, v4, v17
    v_mfma_f32_16x16x32_bf16 v[112:115], v[28:31], a[204:207], v[112:115]
    v_exp_f32 v19, v99
    s_branch L_skip7
L_pad7:
    s_branch L_tb1_7
L_skip7:
    v_mfma_f32_16x16x32_bf16 v[116:119], v[24:27], a[224:227], v[116:119]
    v_cvt_pk_bf16_f32 v162, v16, v17
    v_add_u32 v21, s3, v21
    v_mfma_f32_16x16x32_bf16 v[116:119], v[28:31], a[228:231], v[116:119]
    v_exp_f32 v16, v164
    v_mfma_f32_16x16x32_bf16 v[120:123], v[24:27], a[248:251], v[120:123]
    ds_read_b128 v[44:47], v3 offset:18688
    v_add_u32 v22, s3, v22
    v_mfma_f32_16x16x32_bf16 v[120:123], v[28:31], a[252:255], v[120:123]
    s_waitcnt lgkmcnt(2)
    v_add_f32 v4, v4, v18
    v_add_f32 v4, v4, v19
    v_mfma_f32_16x16x32_bf16 v[124:127], v[24:27], v[208:211], v[124:127]
    s_waitcnt vmcnt(21)
    v_exp_f32 v17, v165
    v_mfma_f32_16x16x32_bf16 v[124:127], v[28:31], v[212:215], v[124:127]
    s_barrier
    ds_read_b128 v[48:51], v10 offset:1152
    v_mfma_f32_16x16x32_bf16 v[176:179], v[32:35], a[208:211], v[176:179]
    s_waitcnt vmcnt(30)
    ds_read_b128 v[24:27], v1 offset:0
    v_cvt_pk_bf16_f32 v163, v18, v19
    v_mfma_f32_16x16x32_bf16 v[176:179], v[36:39], a[212:215], v[176:179]
    v_exp_f32 v18, v166
    v_mfma_f32_16x16x32_bf16 v[180:183], v[32:35], a[232:235], v[180:183]
    v_add_f32 v5, v5, v16
    v_cvt_f32_i32 v240, v240
    v_mfma_f32_16x16x32_bf16 v[180:183], v[36:39], a[236:239], v[180:183]
    v_add_f32 v5, v5, v17
    v_cvt_f32_i32 v241, v241
    v_mfma_f32_16x16x32_bf16 v[184:187], v[32:35], v[192:195], v[184:187]
    ds_read_b128 v[28:31], v1 offset:12288
    v_cvt_f32_i32 v244, v244
    v_mfma_f32_16x16x32_bf16 v[184:187], v[36:39], v[196:199], v[184:187]
    v_exp_f32 v19, v167
    v_mfma_f32_16x16x32_bf16 v[188:191], v[32:35], v[216:219], v[188:191]
    ds_read_b128 v[56:59], v23 offset:0
    v_cvt_pk_bf16_f32 v164, v16, v17
    v_mfma_f32_16x16x32_bf16 v[188:191], v[36:39], v[220:223], v[188:191]
    s_waitcnt lgkmcnt(4)
    v_exp_f32 v16, v100
    v_mfma_f32_16x16x32_bf16 v[112:115], v[40:43], a[208:211], v[112:115]
    ds_read_b128 v[32:35], v1 offset:768
    v_add_f32 v5, v5, v18
    v_mfma_f32_16x16x32_bf16 v[112:115], v[44:47], a[212:215], v[112:115]
    v_add_f32 v5, v5, v19
    v_add_u32 v10, 1792, v10
    v_mfma_f32_16x16x32_bf16 v[116:119], v[40:43], a[232:235], v[116:119]
    v_exp_f32 v17, v101
    v_mfma_f32_16x16x32_bf16 v[116:119], v[44:47], a[236:239], v[116:119]
    v_cvt_pk_bf16_f32 v165, v18, v19
    v_cvt_f32_i32 v245, v245
    v_mfma_f32_16x16x32_bf16 v[120:123], v[40:43], v[192:195], v[120:123]
    ds_read_b128 v[36:39], v1 offset:13056
    v_fma_f32 v240, v240, v60, v62
    v_mfma_f32_16x16x32_bf16 v[120:123], v[44:47], v[196:199], v[120:123]
    v_exp_f32 v18, v102
    v_mfma_f32_16x16x32_bf16 v[124:127], v[40:43], v[216:219], v[124:127]
    v_add_f32 v5, v5, v16
    v_add_f32 v5, v5, v17
    v_mfma_f32_16x16x32_bf16 v[124:127], v[44:47], v[220:223], v[124:127]
    s_waitcnt lgkmcnt(3)
    v_exp_f32 v19, v103
    v_cvt_pk_bf16_f32 v166, v16, v17
    v_add_f32 v5, v5, v18
    v_add_f32 v5, v5, v19
    v_fma_f32 v241, v241, v61, v63
    v_cvt_pk_bf16_f32 v167, v18, v19
    v_fma_f32 v244, v244, v60, v62
    v_mfma_f32_16x16x32_bf16 a[0:3], v[64:67], v[24:27], a[0:3]
    ds_read_b128 v[40:43], v1 offset:1536
    v_fma_f32 v245, v245, v61, v63
    v_mfma_f32_16x16x32_bf16 a[0:3], v[80:83], v[28:31], a[0:3]
    v_exp_f32 v16, v168
    v_mfma_f32_16x16x32_bf16 a[48:51], v[68:71], v[24:27], a[48:51]
    v_exp_f32 v17, v169
    v_mfma_f32_16x16x32_bf16 a[48:51], v[84:87], v[28:31], a[48:51]
    v_exp_f32 v18, v170
    v_mfma_f32_16x16x32_bf16 a[96:99], v[72:75], v[24:27], a[96:99]
    ds_read_b128 v[44:47], v1 offset:13824
    v_cvt_pk_bf16_f32 v226, v240, v241
    v_mfma_f32_16x16x32_bf16 a[96:99], v[88:91], v[28:31], a[96:99]
    v_add_f32 v6, v6, v16
    v_cvt_pk_bf16_f32 v230, v244, v245
    v_mfma_f32_16x16x32_bf16 a[144:147], v[76:79], v[24:27], a[144:147]
    v_add_f32 v6, v6, v17
    v_cvt_f32_i32 v242, v242
    v_mfma_f32_16x16x32_bf16 a[144:147], v[92:95], v[28:31], a[144:147]
    s_waitcnt lgkmcnt(2)
    v_exp_f32 v19, v171
    v_mfma_f32_16x16x32_bf16 a[4:7], v[64:67], v[32:35], a[4:7]
    ds_read_b128 v[24:27], v1 offset:2304
    v_cvt_pk_bf16_f32 v168, v16, v17
    v_mfma_f32_16x16x32_bf16 a[4:7], v[80:83], v[36:39], a[4:7]
    v_exp_f32 v16, v104
    v_mfma_f32_16x16x32_bf16 a[52:55], v[68:71], v[32:35], a[52:55]
    v_add_f32 v6, v6, v18
    v_cvt_f32_i32 v243, v243
    v_mfma_f32_16x16x32_bf16 a[52:55], v[84:87], v[36:39], a[52:55]
    v_add_f32 v6, v6, v19
    v_mfma_f32_16x16x32_bf16 a[100:103], v[72:75], v[32:35], a[100:103]
    ds_read_b128 v[28:31], v1 offset:14592
    v_cvt_f32_i32 v246, v246
    v_mfma_f32_16x16x32_bf16 a[100:103], v[88:91], v[36:39], a[100:103]
    v_exp_f32 v17, v105
    v_mfma_f32_16x16x32_bf16 a[148:151], v[76:79], v[32:35], a[148:151]
    v_cvt_pk_bf16_f32 v169, v18, v19
    v_mfma_f32_16x16x32_bf16 a[148:151], v[92:95], v[36:39], a[148:151]
    s_waitcnt lgkmcnt(2)
    v_exp_f32 v18, v106
    v_mfma_f32_16x16x32_bf16 a[8:11], v[64:67], v[40:43], a[8:11]
    ds_read_b128 v[32:35], v21 offset:0
    v_cvt_f32_i32 v247, v247
    v_mfma_f32_16x16x32_bf16 a[8:11], v[80:83], v[44:47], a[8:11]
    v_add_f32 v6, v6, v16
    v_add_f32 v6, v6, v17
    v_mfma_f32_16x16x32_bf16 a[56:59], v[68:71], v[40:43], a[56:59]
    v_exp_f32 v19, v107
    v_mfma_f32_16x16x32_bf16 a[56:59], v[84:87], v[44:47], a[56:59]
    v_fma_f32 v242, v242, v48, v50
    v_cvt_pk_bf16_f32 v170, v16, v17
    v_mfma_f32_16x16x32_bf16 a[104:107], v[72:75], v[40:43], a[104:107]
    ds_read_b128 v[36:39], v21 offset:12288
    v_fma_f32 v243, v243, v49, v51
    v_mfma_f32_16x16x32_bf16 a[104:107], v[88:91], v[44:47], a[104:107]
    v_exp_f32 v16, v172
    v_mfma_f32_16x16x32_bf16 a[152:155], v[76:79], v[40:43], a[152:155]
    v_add_f32 v6, v6, v18
    v_mfma_f32_16x16x32_bf16 a[152:155], v[92:95], v[44:47], a[152:155]
    s_waitcnt lgkmcnt(2)
    v_add_f32 v6, v6, v19
    v_fma_f32 v246, v246, v48, v50
    v_mfma_f32_16x16x32_bf16 a[12:15], v[64:67], v[24:27], a[12:15]
    ds_read_b128 v[40:43], v21 offset:768
    v_mfma_f32_16x16x32_bf16 a[12:15], v[80:83], v[28:31], a[12:15]
    v_exp_f32 v17, v173
    v_mfma_f32_16x16x32_bf16 a[60:63], v[68:71], v[24:27], a[60:63]
    v_cvt_pk_bf16_f32 v171, v18, v19
    v_fma_f32 v247, v247, v49, v51
    v_mfma_f32_16x16x32_bf16 a[60:63], v[84:87], v[28:31], a[60:63]
    v_exp_f32 v18, v174
    v_mfma_f32_16x16x32_bf16 a[108:111], v[72:75], v[24:27], a[108:111]
    ds_read_b128 v[44:47], v21 offset:13056
    v_add_f32 v7, v7, v16
    v_mfma_f32_16x16x32_bf16 a[108:111], v[88:91], v[28:31], a[108:111]
    v_add_f32 v7, v7, v17
    v_cvt_pk_bf16_f32 v227, v242, v243
    v_mfma_f32_16x16x32_bf16 a[156:159], v[76:79], v[24:27], a[156:159]
    s_add_u32 s29, s28, 49152
    v_exp_f32 v19, v175
    v_mfma_f32_16x16x32_bf16 a[156:159], v[92:95], v[28:31], a[156:159]
    s_waitcnt lgkmcnt(2)
    v_cvt_pk_bf16_f32 v172, v16, v17
    v_mfma_f32_16x16x32_bf16 a[16:19], v[64:67], v[32:35], a[16:19]
    ds_read_b128 v[24:27], v21 offset:1536
    v_cvt_pk_bf16_f32 v231, v246, v247
    v_mfma_f32_16x16x32_bf16 a[16:19], v[80:83], v[36:39], a[16:19]
    s_sub_u32 s3, s29, 147456
    v_exp_f32 v16, v108
    v_mfma_f32_16x16x32_bf16 a[64:67], v[68:71], v[32:35], a[64:67]
    s_waitcnt vmcnt(12)
    v_add_f32 v7, v7, v18
    v_mfma_f32_16x16x32_bf16 a[64:67], v[84:87], v[36:39], a[64:67]
    v_add_f32 v7, v7, v19
    v_mfma_f32_16x16x32_bf16 a[112:115], v[72:75], v[32:35], a[112:115]
    ds_read_b128 v[28:31], v21 offset:13824
    v_mfma_f32_16x16x32_bf16 a[112:115], v[88:91], v[36:39], a[112:115]
    v_exp_f32 v17, v109
    v_mfma_f32_16x16x32_bf16 a[160:163], v[76:79], v[32:35], a[160:163]
    v_cvt_pk_bf16_f32 v173, v18, v19
    v_cvt_f32_i32 v248, v248
    v_mfma_f32_16x16x32_bf16 a[160:163], v[92:95], v[36:39], a[160:163]
    s_waitcnt lgkmcnt(2)
    v_exp_f32 v18, v110
    v_mfma_f32_16x16x32_bf16 a[20:23], v[64:67], v[40:43], a[20:23]
    s_min_u32 s29, s29, s3
    ds_read_b128 v[32:35], v21 offset:2304
    v_add_f32 v7, v7, v16
    v_mfma_f32_16x16x32_bf16 a[20:23], v[80:83], v[44:47], a[20:23]
    v_add_f32 v7, v7, v17
    v_cvt_f32_i32 v249, v249
    v_mfma_f32_16x16x32_bf16 a[68:71], v[68:71], v[40:43], a[68:71]
    v_exp_f32 v19, v111
    v_mfma_f32_16x16x32_bf16 a[68:71], v[84:87], v[44:47], a[68:71]
    v_cvt_pk_bf16_f32 v174, v16, v17
    v_cvt_f32_i32 v252, v252
    v_mfma_f32_16x16x32_bf16 a[116:119], v[72:75], v[40:43], a[116:119]
    ds_read_b128 v[36:39], v21 offset:14592
    v_mfma_f32_16x16x32_bf16 a[116:119], v[88:91], v[44:47], a[116:119]
    s_waitcnt vmcnt(0)
    v_subrev_u32 v52, s92, v52
    v_cmp_lt_u32 vcc, 15, v52
    v_mfma_f32_16x16x32_bf16 a[164:167], v[76:79], v[40:43], a[164:167]
    s_sub_u32 s3, s29, s28
    v_exp_f32 v16, v176
    v_mfma_f32_16x16x32_bf16 a[164:167], v[92:95], v[44:47], a[164:167]
    s_waitcnt lgkmcnt(2)
    v_add_f32 v7, v7, v18
    v_add_f32 v7, v7, v19
    v_mfma_f32_16x16x32_bf16 a[24:27], v[64:67], v[24:27], a[24:27]
    s_and_b32 s59, vcc_lo, 0xff
    ds_read_b128 v[40:43], v22 offset:0
    v_cvt_f32_i32 v253, v253
    v_mfma_f32_16x16x32_bf16 a[24:27], v[80:83], v[28:31], a[24:27]
    s_cbranch_scc1 L_pollslow3
L_pollok3:
    v_mfma_f32_16x16x32_bf16 a[72:75], v[68:71], v[24:27], a[72:75]
    s_add_u32 s92, s92, 1
    v_exp_f32 v17, v177
    v_mfma_f32_16x16x32_bf16 a[72:75], v[84:87], v[28:31], a[72:75]
    s_mov_b32 m0, s56
    v_cvt_pk_bf16_f32 v175, v18, v19
    v_fma_f32 v248, v248, v60, v62
    v_mfma_f32_16x16x32_bf16 a[120:123], v[72:75], v[24:27], a[120:123]
    ds_read_b128 v[44:47], v22 offset:12288
    v_fma_f32 v249, v249, v61, v63
    v_mfma_f32_16x16x32_bf16 a[120:123], v[88:91], v[28:31], a[120:123]
    s_mov_b32 s28, s29
    buffer_load_dwordx4 v8, s[4:7], s27 offen offset:0 sc1 lds
    v_mfma_f32_16x16x32_bf16 a[168:171], v[76:79], v[24:27], a[168:171]
    v_exp_f32 v18, v178
    v_mfma_f32_16x16x32_bf16 a[168:171], v[92:95], v[28:31], a[168:171]
    s_waitcnt lgkmcnt(2)
    v_add_f32 v4, v4, v16
    v_add_f32 v4, v4, v17
    v_mfma_f32_16x16x32_bf16 a[28:31], v[64:67], v[32:35], a[28:31]
    ds_read_b128 v[24:27], v22 offset:768
    v_fma_f32 v252, v252, v60, v62
    v_mfma_f32_16x16x32_bf16 a[28:31], v[80:83], v[36:39], a[28:31]
    buffer_load_dwordx4 v8, s[4:7], s27 offen offset:1024 sc1 lds
    v_mfma_f32_16x16x32_bf16 a[76:79], v[68:71], v[32:35], a[76:79]
    v_exp_f32 v19, v179
    v_mfma_f32_16x16x32_bf16 a[76:79], v[84:87], v[36:39], a[76:79]
    v_cvt_pk_bf16_f32 v176, v16, v17
    v_fma_f32 v253, v253, v61, v63
    v_mfma_f32_16x16x32_bf16 a[124:127], v[72:75], v[32:35], a[124:127]
    ds_read_b128 v[28:31], v22 offset:13056
    v_cvt_pk_bf16_f32 v234, v248, v249
    v_mfma_f32_16x16x32_bf16 a[124:127], v[88:91], v[36:39], a[124:127]
    buffer_load_dwordx4 v8, s[4:7], s27 offen offset:2048 sc1 lds
    v_mfma_f32_16x16x32_bf16 a[172:175], v[76:79], v[32:35], a[172:175]
    s_add_u32 s27, s27, 24576
    v_exp_f32 v16, v112
    v_mfma_f32_16x16x32_bf16 a[172:175], v[92:95], v[36:39], a[172:175]
    s_waitcnt lgkmcnt(2)
    v_add_f32 v4, v4, v18
    v_add_f32 v4, v4, v19
    v_mfma_f32_16x16x32_bf16 a[32:35], v[64:67], v[40:43], a[32:35]
    s_add_u32 s56, s56, 12288
    ds_read_b128 v[32:35], v22 offset:1536
    v_add_u32 v2, s3, v2
    v_mfma_f32_16x16x32_bf16 a[32:35], v[80:83], v[44:47], a[32:35]
    s_mov_b32 m0, s56
    v_exp_f32 v17, v113
    v_mfma_f32_16x16x32_bf16 a[80:83], v[68:71], v[40:43], a[80:83]
    v_cvt_pk_bf16_f32 v177, v18, v19
    v_cvt_pk_bf16_f32 v238, v252, v253
    v_mfma_f32_16x16x32_bf16 a[80:83], v[84:87], v[44:47], a[80:83]
    v_exp_f32 v18, v114
    v_mfma_f32_16x16x32_bf16 a[128:131], v[72:75], v[40:43], a[128:131]
    ds_read_b128 v[36:39], v22 offset:13824
    v_add_f32 v4, v4, v16
    v_mfma_f32_16x16x32_bf16 a[128:131], v[88:91], v[44:47], a[128:131]
    buffer_load_dwordx4 v8, s[4:7], s27 offen offset:0 sc1 lds
    v_mfma_f32_16x16x32_bf16 a[176:179], v[76:79], v[40:43], a[176:179]
    v_add_f32 v4, v4, v17
    v_cvt_f32_i32 v250, v250
    v_mfma_f32_16x16x32_bf16 a[176:179], v[92:95], v[44:47], a[176:179]
    s_waitcnt lgkmcnt(2)
    v_exp_f32 v19, v115
    v_mfma_f32_16x16x32_bf16 a[36:39], v[64:67], v[24:27], a[36:39]
    ds_read_b128 v[40:43], v22 offset:2304
    v_cvt_pk_bf16_f32 v178, v16, v17
    v_mfma_f32_16x16x32_bf16 a[36:39], v[80:83], v[28:31], a[36:39]
    buffer_load_dwordx4 v8, s[4:7], s27 offen offset:1024 sc1 lds
    v_mfma_f32_16x16x32_bf16 a[84:87], v[68:71], v[24:27], a[84:87]
    v_exp_f32 v16, v180
    v_mfma_f32_16x16x32_bf16 a[84:87], v[84:87], v[28:31], a[84:87]
    v_add_f32 v4, v4, v18
    v_add_f32 v4, v4, v19
    v_mfma_f32_16x16x32_bf16 a[132:135], v[72:75], v[24:27], a[132:135]
    ds_read_b128 v[44:47], v22 offset:14592
    v_add_u32 v3, s3, v3
    v_mfma_f32_16x16x32_bf16 a[132:135], v[88:91], v[28:31], a[132:135]
    s_waitcnt lgkmcnt(2)
    buffer_load_dwordx4 v8, s[4:7], s27 offen offset:2048 sc1 lds
    v_mfma_f32_16x16x32_bf16 a[180:183], v[76:79], v[24:27], a[180:183]
    s_waitcnt vmcnt(18)
    v_exp_f32 v17, v181
    v_mfma_f32_16x16x32_bf16 a[180:183], v[92:95], v[28:31], a[180:183]
    s_barrier
    v_cvt_pk_bf16_f32 v179, v18, v19
    v_mfma_f32_16x16x32_bf16 a[40:43], v[64:67], v[32:35], a[40:43]
    s_add_u32 s27, s27, 24576
    ds_read_b128 v[24:27], v2 offset:0
    v_cvt_f32_i32 v251, v251
    v_mfma_f32_16x16x32_bf16 a[40:43], v[80:83], v[36:39], a[40:43]
    v_exp_f32 v18, v182
    v_add_f32 v5, v5, v16
    v_mfma_f32_16x16x32_bf16 a[88:91], v[68:71], v[32:35], a[88:91]
    s_add_u32 s56, s56, 36864
    v_add_f32 v5, v5, v17
    v_cvt_f32_i32 v254, v254
    v_mfma_f32_16x16x32_bf16 a[88:91], v[84:87], v[36:39], a[88:91]
    s_sub_u32 s58, s56, 147456
    v_exp_f32 v19, v183
    v_mfma_f32_16x16x32_bf16 a[136:139], v[72:75], v[32:35], a[136:139]
    ds_read_b128 v[28:31], v3 offset:0
    v_cvt_pk_bf16_f32 v180, v16, v17
    v_mfma_f32_16x16x32_bf16 a[136:139], v[88:91], v[36:39], a[136:139]
    buffer_load_dwordx4 v[240:243], v12, s[68:71], s36 offen offset:0 nt
    v_mfma_f32_16x16x32_bf16 a[184:187], v[76:79], v[32:35], a[184:187]
    s_min_u32 s56, s56, s58
    v_exp_f32 v16, v116
    v_mfma_f32_16x16x32_bf16 a[184:187], v[92:95], v[36:39], a[184:187]
    s_waitcnt lgkmcnt(2)
    v_add_f32 v5, v5, v18
    v_add_f32 v5, v5, v19
    v_mfma_f32_16x16x32_bf16 a[44:47], v[64:67], v[40:43], a[44:47]
    ds_read_b128 v[32:35], v2 offset:6144
    v_cvt_f32_i32 v255, v255
    v_mfma_f32_16x16x32_bf16 a[44:47], v[80:83], v[44:47], a[44:47]
    buffer_load_dwordx4 v[244:247], v12, s[68:71], s36 offen offset:768 nt
    v_mfma_f32_16x16x32_bf16 a[92:95], v[68:71], v[40:43], a[92:95]
    v_exp_f32 v17, v117
    v_mfma_f32_16x16x32_bf16 a[92:95], v[84:87], v[44:47], a[92:95]
    v_cvt_pk_bf16_f32 v181, v18, v19
    v_exp_f32 v18, v118
    v_mfma_f32_16x16x32_bf16 a[140:143], v[72:75], v[40:43], a[140:143]
    s_nop 0
    ds_read_b128 v[36:39], v3 offset:6144
    v_add_f32 v5, v5, v16
    v_mfma_f32_16x16x32_bf16 a[140:143], v[88:91], v[44:47], a[140:143]
    v_add_f32 v5, v5, v17
    v_fma_f32 v250, v250, v48, v50
    v_mfma_f32_16x16x32_bf16 a[188:191], v[76:79], v[40:43], a[188:191]
    s_waitcnt lgkmcnt(2)
    v_exp_f32 v19, v119
    v_fma_f32 v251, v251, v49, v51
    v_cvt_pk_bf16_f32 v182, v16, v17
    v_fma_f32 v254, v254, v48, v50
    v_add_f32 v5, v5, v18
    v_fma_f32 v255, v255, v49, v51
    v_add_f32 v5, v5, v19
    v_cvt_pk_bf16_f32 v235, v250, v251
    v_cvt_pk_bf16_f32 v183, v18, v19
    v_cvt_pk_bf16_f32 v239, v254, v255
    v_mfma_f32_16x16x32_bf16 a[188:191], v[92:95], v[44:47], a[188:191]
    s_branch L_join
.p2align 6
L_loop:
    v_mfma_f32_16x16x32_bf16 a[0:3], v[160:163], v[24:27], a[0:3]
    ds_read_b128 v[40:43], v1 offset:1536
    v_cvt_f32_i32 v154, v154
    v_mfma_f32_16x16x32_bf16 a[0:3], v[176:179], v[28:31], a[0:3]
    buffer_load_dwordx4 v[248:251], v12, s[68:71], s36 offen offset:1536 nt
    v_mfma_f32_16x16x32_bf16 a[48:51], v[164:167], v[24:27], a[48:51]
    v_exp_f32 v16, v72
    v_mfma_f32_16x16x32_bf16 a[48:51], v[180:183], v[28:31], a[48:51]
    v_exp_f32 v17, v73
    v_mfma_f32_16x16x32_bf16 a[96:99], v[168:171], v[24:27], a[96:99]
    ds_read_b128 v[44:47], v1 offset:13824
    v_cvt_f32_i32 v158, v158
    v_mfma_f32_16x16x32_bf16 a[96:99], v[184:187], v[28:31], a[96:99]
    v_exp_f32 v18, v74
    v_mfma_f32_16x16x32_bf16 a[144:147], v[172:175], v[24:27], a[144:147]
    v_add_f32 v6, v6, v16
    v_add_f32 v6, v6, v17
    v_mfma_f32_16x16x32_bf16 a[144:147], v[188:191], v[28:31], a[144:147]
    s_waitcnt lgkmcnt(2)
    buffer_load_dwordx4 v[252:255], v12, s[68:71], s36 offen offset:2304 nt
    v_mfma_f32_16x16x32_bf16 a[4:7], v[160:163], v[32:35], a[4:7]
    ds_read_b128 v[24:27], v1 offset:2304
    v_cvt_f32_i32 v155, v155
    v_mfma_f32_16x16x32_bf16 a[4:7], v[176:179], v[36:39], a[4:7]
    v_exp_f32 v19, v75
    v_mfma_f32_16x16x32_bf16 a[52:55], v[164:167], v[32:35], a[52:55]
    v_cvt_pk_bf16_f32 v72, v16, v17
    v_cvt_f32_i32 v159, v159
    v_mfma_f32_16x16x32_bf16 a[52:55], v[180:183], v[36:39], a[52:55]
    v_exp_f32 v16, v104
    v_mfma_f32_16x16x32_bf16 a[100:103], v[168:171], v[32:35], a[100:103]
    ds_read_b128 v[28:31], v1 offset:14592
    v_add_f32 v6, v6, v18
    v_mfma_f32_16x16x32_bf16 a[100:103], v[184:187], v[36:39], a[100:103]
    v_add_f32 v6, v6, v19
    v_fma_f32 v154, v154, v60, v62
    v_mfma_f32_16x16x32_bf16 a[148:151], v[172:175], v[32:35], a[148:151]
    v_exp_f32 v17, v105
    v_mfma_f32_16x16x32_bf16 a[148:151], v[188:191], v[36:39], a[148:151]
    s_waitcnt lgkmcnt(2)
    v_cvt_pk_bf16_f32 v73, v18, v19
    v_fma_f32 v158, v158, v61, v63
    v_mfma_f32_16x16x32_bf16 a[8:11], v[160:163], v[40:43], a[8:11]
    ds_read_b128 v[32:35], v21 offset:0
    s_add_u32 s33, s33, 196608
    v_mfma_f32_16x16x32_bf16 a[8:11], v[176:179], v[44:47], a[8:11]
    s_sub_u32 s34, s33, 1572864
    v_exp_f32 v18, v106
    v_mfma_f32_16x16x32_bf16 a[56:59], v[164:167], v[40:43], a[56:59]
    v_add_f32 v6, v6, v16
    v_add_f32 v6, v6, v17
    v_mfma_f32_16x16x32_bf16 a[56:59], v[180:183], v[44:47], a[56:59]
    s_min_u32 s33, s33, s34
    v_exp_f32 v19, v107
    v_mfma_f32_16x16x32_bf16 a[104:107], v[168:171], v[40:43], a[104:107]
    s_mov_b32 m0, s56
    ds_read_b128 v[36:39], v21 offset:12288
    v_cvt_pk_bf16_f32 v74, v16, v17
    v_mfma_f32_16x16x32_bf16 a[104:107], v[184:187], v[44:47], a[104:107]
    v_exp_f32 v16, v76
    v_mfma_f32_16x16x32_bf16 a[152:155], v[172:175], v[40:43], a[152:155]
    s_add_u32 s34, s33, 3072
    v_fma_f32 v155, v155, v60, v62
    v_fma_f32 v159, v159, v61, v63
    v_mfma_f32_16x16x32_bf16 a[152:155], v[188:191], v[44:47], a[152:155]
    s_waitcnt lgkmcnt(2)
    buffer_load_dwordx4 v8, s[4:7], s27 offen offset:0 sc1 lds
    v_mfma_f32_16x16x32_bf16 a[12:15], v[160:163], v[24:27], a[12:15]
    s_add_u32 s37, s37, 196608
    ds_read_b128 v[40:43], v21 offset:768
    v_add_f32 v6, v6, v18
    v_mfma_f32_16x16x32_bf16 a[12:15], v[176:179], v[28:31], a[12:15]
    v_add_f32 v6, v6, v19
    v_cvt_pk_bf16_f32 v144, v144, v148
    v_mfma_f32_16x16x32_bf16 a[60:63], v[164:167], v[24:27], a[60:63]
    v_exp_f32 v17, v77
    v_mfma_f32_16x16x32_bf16 a[60:63], v[180:183], v[28:31], a[60:63]
    s_add_u32 s80, s80, 196608
    v_cvt_pk_bf16_f32 v75, v18, v19
    v_mfma_f32_16x16x32_bf16 a[108:111], v[168:171], v[24:27], a[108:111]
    ds_read_b128 v[44:47], v21 offset:13056
    v_cvt_pk_bf16_f32 v148, v145, v149
    v_mfma_f32_16x16x32_bf16 a[108:111], v[184:187], v[28:31], a[108:111]
    v_exp_f32 v18, v78
    v_mfma_f32_16x16x32_bf16 a[156:159], v[172:175], v[24:27], a[156:159]
    s_add_u32 s29, s28, 49152
    v_add_f32 v7, v7, v16
    v_add_f32 v7, v7, v17
    v_mfma_f32_16x16x32_bf16 a[156:159], v[188:191], v[28:31], a[156:159]
    s_waitcnt lgkmcnt(2)
    buffer_load_dwordx4 v[224:227], v9, s[64:67], s33 offen offset:0 nt
    v_mfma_f32_16x16x32_bf16 a[16:19], v[160:163], v[32:35], a[16:19]
    ds_read_b128 v[24:27], v21 offset:1536
    v_cvt_pk_bf16_f32 v145, v152, v156
    v_mfma_f32_16x16x32_bf16 a[16:19], v[176:179], v[36:39], a[16:19]
    s_sub_u32 s3, s29, 147456
    v_exp_f32 v19, v79
    v_mfma_f32_16x16x32_bf16 a[64:67], v[164:167], v[32:35], a[64:67]
    v_cvt_pk_bf16_f32 v76, v16, v17
    v_cvt_pk_bf16_f32 v149, v153, v157
    v_mfma_f32_16x16x32_bf16 a[64:67], v[180:183], v[36:39], a[64:67]
    buffer_load_dwordx4 v8, s[4:7], s27 offen offset:1024 sc1 lds
    v_mfma_f32_16x16x32_bf16 a[112:115], v[168:171], v[32:35], a[112:115]
    ds_read_b128 v[28:31], v21 offset:13824
    v_mfma_f32_16x16x32_bf16 a[112:115], v[184:187], v[36:39], a[112:115]
    v_exp_f32 v16, v108
    v_mfma_f32_16x16x32_bf16 a[160:163], v[172:175], v[32:35], a[160:163]
    v_add_f32 v7, v7, v18
    v_add_f32 v7, v7, v19
    v_mfma_f32_16x16x32_bf16 a[160:163], v[188:191], v[36:39], a[160:163]
    s_waitcnt lgkmcnt(2)
    buffer_load_dwordx4 v[228:231], v9, s[64:67], s33 offen offset:1536 nt
    v_mfma_f32_16x16x32_bf16 a[20:23], v[160:163], v[40:43], a[20:23]
    s_min_u32 s29, s29, s3
    ds_read_b128 v[32:35], v21 offset:2304
    v_cvt_pk_bf16_f32 v152, v146, v150
    v_mfma_f32_16x16x32_bf16 a[20:23], v[176:179], v[44:47], a[20:23]
    v_exp_f32 v17, v109
    v_mfma_f32_16x16x32_bf16 a[68:71], v[164:167], v[40:43], a[68:71]
    v_cvt_pk_bf16_f32 v77, v18, v19
    v_cvt_pk_bf16_f32 v153, v154, v158
    v_mfma_f32_16x16x32_bf16 a[68:71], v[180:183], v[44:47], a[68:71]
    buffer_load_dwordx4 v[232:235], v9, s[64:67], s34 offen offset:0 nt
    v_mfma_f32_16x16x32_bf16 a[116:119], v[168:171], v[40:43], a[116:119]
    ds_read_b128 v[36:39], v21 offset:14592
    v_cvt_pk_bf16_f32 v156, v147, v151
    v_mfma_f32_16x16x32_bf16 a[116:119], v[184:187], v[44:47], a[116:119]
    v_exp_f32 v18, v110
    v_mfma_f32_16x16x32_bf16 a[164:167], v[172:175], v[40:43], a[164:167]
    s_sub_u32 s3, s29, s28
    v_add_f32 v7, v7, v16
    v_add_f32 v7, v7, v17
    v_mfma_f32_16x16x32_bf16 a[164:167], v[188:191], v[44:47], a[164:167]
    s_waitcnt lgkmcnt(2)
    buffer_load_dwordx4 v8, s[4:7], s27 offen offset:2048 sc1 lds
    v_mfma_f32_16x16x32_bf16 a[24:27], v[160:163], v[24:27], a[24:27]
    s_add_u32 s27, s27, 24576
    ds_read_b128 v[40:43], v22 offset:0
    s_add_u32 s56, s56, 12288
    v_mfma_f32_16x16x32_bf16 a[24:27], v[176:179], v[28:31], a[24:27]
    v_exp_f32 v19, v111
    v_cvt_pk_bf16_f32 v78, v16, v17
    v_mfma_f32_16x16x32_bf16 a[72:75], v[164:167], v[24:27], a[72:75]
    s_mov_b32 m0, s56
    s_nop 0
    buffer_load_dwordx4 v[236:239], v9, s[64:67], s34 offen offset:1536 nt
    v_mfma_f32_16x16x32_bf16 a[72:75], v[180:183], v[28:31], a[72:75]
    v_exp_f32 v16, v80
    v_mfma_f32_16x16x32_bf16 a[120:123], v[168:171], v[24:27], a[120:123]
    ds_read_b128 v[44:47], v22 offset:12288
    v_add_f32 v7, v7, v18
    v_mfma_f32_16x16x32_bf16 a[120:123], v[184:187], v[28:31], a[120:123]
    s_mov_b32 s28, s29
    v_add_f32 v7, v7, v19
    v_cvt_pk_bf16_f32 v157, v155, v159
    v_mfma_f32_16x16x32_bf16 a[168:171], v[172:175], v[24:27], a[168:171]
    s_waitcnt vmcnt(19)
    v_exp_f32 v17, v81
    v_mfma_f32_16x16x32_bf16 a[168:171], v[188:191], v[28:31], a[168:171]
    s_waitcnt lgkmcnt(2)
    buffer_load_dwordx4 v8, s[4:7], s27 offen offset:0 sc1 lds
    v_cvt_pk_bf16_f32 v79, v18, v19
    v_mfma_f32_16x16x32_bf16 a[28:31], v[160:163], v[32:35], a[28:31]
    ds_read_b128 v[24:27], v22 offset:768
    v_cvt_f32_i32 v240, v240
    v_mfma_f32_16x16x32_bf16 a[28:31], v[176:179], v[36:39], a[28:31]
    v_exp_f32 v18, v82
    v_mfma_f32_16x16x32_bf16 a[76:79], v[164:167], v[32:35], a[76:79]
    v_add_f32 v4, v4, v16
    v_add_f32 v4, v4, v17
    v_mfma_f32_16x16x32_bf16 a[76:79], v[180:183], v[36:39], a[76:79]
    v_exp_f32 v19, v83
    v_mfma_f32_16x16x32_bf16 a[124:127], v[168:171], v[32:35], a[124:127]
    ds_read_b128 v[28:31], v22 offset:13056
    v_cvt_pk_bf16_f32 v80, v16, v17
    v_mfma_f32_16x16x32_bf16 a[124:127], v[184:187], v[36:39], a[124:127]
    buffer_load_dwordx4 v8, s[4:7], s27 offen offset:1024 sc1 lds
    v_mfma_f32_16x16x32_bf16 a[172:175], v[172:175], v[32:35], a[172:175]
    v_exp_f32 v16, v112
    v_mfma_f32_16x16x32_bf16 a[172:175], v[188:191], v[36:39], a[172:175]
    s_waitcnt lgkmcnt(2)
    v_add_f32 v4, v4, v18
    v_add_f32 v4, v4, v19
    v_mfma_f32_16x16x32_bf16 a[32:35], v[160:163], v[40:43], a[32:35]
    ds_read_b128 v[32:35], v22 offset:1536
    v_cvt_f32_i32 v244, v244
    v_mfma_f32_16x16x32_bf16 a[32:35], v[176:179], v[44:47], a[32:35]
    v_exp_f32 v17, v113
    v_mfma_f32_16x16x32_bf16 a[80:83], v[164:167], v[40:43], a[80:83]
    v_cvt_pk_bf16_f32 v81, v18, v19
    v_cvt_f32_i32 v241, v241
    v_mfma_f32_16x16x32_bf16 a[80:83], v[180:183], v[44:47], a[80:83]
    v_exp_f32 v18, v114
    v_mfma_f32_16x16x32_bf16 a[128:131], v[168:171], v[40:43], a[128:131]
    ds_read_b128 v[36:39], v22 offset:13824
    v_add_f32 v4, v4, v16
    v_mfma_f32_16x16x32_bf16 a[128:131], v[184:187], v[44:47], a[128:131]
    buffer_load_dwordx4 v8, s[4:7], s27 offen offset:2048 sc1 lds
    v_mfma_f32_16x16x32_bf16 a[176:179], v[172:175], v[40:43], a[176:179]
    v_add_f32 v4, v4, v17
    v_add_u32 v2, s3, v2
    v_mfma_f32_16x16x32_bf16 a[176:179], v[188:191], v[44:47], a[176:179]
    s_waitcnt lgkmcnt(2)
    v_exp_f32 v19, v115
    v_mfma_f32_16x16x32_bf16 a[36:39], v[160:163], v[24:27], a[36:39]
    ds_read_b128 v[40:43], v22 offset:2304
    v_cvt_pk_bf16_f32 v82, v16, v17
    v_mfma_f32_16x16x32_bf16 a[36:39], v[176:179], v[28:31], a[36:39]
    v_exp_f32 v16, v84
    v_mfma_f32_16x16x32_bf16 a[84:87], v[164:167], v[24:27], a[84:87]
    v_add_f32 v4, v4, v18
    v_add_f32 v4, v4, v19
    v_mfma_f32_16x16x32_bf16 a[84:87], v[180:183], v[28:31], a[84:87]
    s_add_u32 s27, s27, 24576
    v_exp_f32 v17, v85
    v_mfma_f32_16x16x32_bf16 a[132:135], v[168:171], v[24:27], a[132:135]
    s_add_u32 s56, s56, 36864
    ds_read_b128 v[44:47], v22 offset:14592
    v_add_u32 v3, s3, v3
    v_mfma_f32_16x16x32_bf16 a[132:135], v[184:187], v[28:31], a[132:135]
    s_waitcnt lgkmcnt(2)
    v_cvt_pk_bf16_f32 v83, v18, v19
    v_cvt_f32_i32 v245, v245
    v_mfma_f32_16x16x32_bf16 a[180:183], v[172:175], v[24:27], a[180:183]
    s_waitcnt vmcnt(15)
    v_exp_f32 v18, v86
    v_mfma_f32_16x16x32_bf16 a[180:183], v[188:191], v[28:31], a[180:183]
    s_barrier
    v_add_f32 v5, v5, v16
    v_mfma_f32_16x16x32_bf16 a[40:43], v[160:163], v[32:35], a[40:43]
    s_sub_u32 s58, s56, 147456
    ds_read_b128 v[24:27], v2 offset:0
    v_add_f32 v5, v5, v17
    v_mfma_f32_16x16x32_bf16 a[40:43], v[176:179], v[36:39], a[40:43]
    v_fma_f32 v240, v240, v48, v50
    v_fma_f32 v244, v244, v49, v51
    v_mfma_f32_16x16x32_bf16 a[88:91], v[164:167], v[32:35], a[88:91]
    s_min_u32 s56, s56, s58
    v_exp_f32 v19, v87
    v_mfma_f32_16x16x32_bf16 a[88:91], v[180:183], v[36:39], a[88:91]
    v_cvt_pk_bf16_f32 v84, v16, v17
    v_fma_f32 v241, v241, v48, v50
    v_mfma_f32_16x16x32_bf16 a[136:139], v[168:171], v[32:35], a[136:139]
    ds_read_b128 v[28:31], v3 offset:0
    v_fma_f32 v245, v245, v49, v51
    v_mfma_f32_16x16x32_bf16 a[136:139], v[184:187], v[36:39], a[136:139]
    v_exp_f32 v16, v116
    v_mfma_f32_16x16x32_bf16 a[184:187], v[172:175], v[32:35], a[184:187]
    v_add_f32 v5, v5, v18
    v_add_f32 v5, v5, v19
    v_mfma_f32_16x16x32_bf16 a[184:187], v[188:191], v[36:39], a[184:187]
    s_waitcnt lgkmcnt(2)
    v_exp_f32 v17, v117
    v_mfma_f32_16x16x32_bf16 a[44:47], v[160:163], v[40:43], a[44:47]
    ds_read_b128 v[32:35], v2 offset:6144
    v_cvt_pk_bf16_f32 v85, v18, v19
    v_mfma_f32_16x16x32_bf16 a[44:47], v[176:179], v[44:47], a[44:47]
    v_exp_f32 v18, v118
    v_mfma_f32_16x16x32_bf16 a[92:95], v[164:167], v[40:43], a[92:95]
    v_add_u32 v55, 1, v55
    v_cvt_f32_i32 v242, v242
    v_mfma_f32_16x16x32_bf16 a[92:95], v[180:183], v[44:47], a[92:95]
    buffer_store_dword v55, v13, s[20:23], 0 offen sc1
    v_mfma_f32_16x16x32_bf16 a[140:143], v[168:171], v[40:43], a[140:143]
    ds_read_b128 v[36:39], v3 offset:6144
    v_add_f32 v5, v5, v16
    v_mfma_f32_16x16x32_bf16 a[140:143], v[184:187], v[44:47], a[140:143]
    v_add_f32 v5, v5, v17
    v_cvt_f32_i32 v246, v246
    v_mfma_f32_16x16x32_bf16 a[188:191], v[172:175], v[40:43], a[188:191]
    v_exp_f32 v19, v119
    v_mfma_f32_16x16x32_bf16 a[188:191], v[188:191], v[44:47], a[188:191]
    s_waitcnt lgkmcnt(2)
    v_cvt_pk_bf16_f32 v86, v16, v17
    v_add_f32 v5, v5, v18
    v_add_f32 v5, v5, v19
    v_cvt_f32_i32 v243, v243
    v_cvt_pk_bf16_f32 v87, v18, v19
    v_cvt_f32_i32 v247, v247
    s_branch L_skip8
L_pad8:
    s_branch L_tb1_6
L_skip8:
    v_mfma_f32_16x16x32_bf16 v[160:163], v[24:27], a[192:195], v[128:131]
    s_mov_b32 m0, s26
    ds_read_b128 v[40:43], v2 offset:128
    v_fma_f32 v242, v242, v48, v50
    v_mfma_f32_16x16x32_bf16 v[160:163], v[28:31], a[196:199], v[160:163]
    v_exp_f32 v16, v88
    v_mfma_f32_16x16x32_bf16 v[164:167], v[24:27], a[216:219], v[132:135]
    v_exp_f32 v17, v89
    v_mfma_f32_16x16x32_bf16 v[164:167], v[28:31], a[220:223], v[164:167]
    v_exp_f32 v18, v90
    v_mfma_f32_16x16x32_bf16 v[168:171], v[24:27], a[240:243], v[136:139]
    ds_read_b128 v[44:47], v3 offset:128
    v_fma_f32 v246, v246, v49, v51
    v_mfma_f32_16x16x32_bf16 v[168:171], v[28:31], a[244:247], v[168:171]
    buffer_load_dwordx4 v8, s[4:7], s32 offen offset:0 sc1 lds
    v_mfma_f32_16x16x32_bf16 v[172:175], v[24:27], v[200:203], v[140:143]
    v_add_f32 v6, v6, v16
    v_add_f32 v6, v6, v17
    v_mfma_f32_16x16x32_bf16 v[172:175], v[28:31], v[204:207], v[172:175]
    s_waitcnt lgkmcnt(2)
    v_exp_f32 v19, v91
    v_mfma_f32_16x16x32_bf16 v[96:99], v[32:35], a[192:195], v[128:131]
    ds_read_b128 v[24:27], v2 offset:6272
    v_fma_f32 v243, v243, v48, v50
    v_mfma_f32_16x16x32_bf16 v[96:99], v[36:39], a[196:199], v[96:99]
    v_cvt_pk_bf16_f32 v88, v16, v17
    v_fma_f32 v247, v247, v49, v51
    v_mfma_f32_16x16x32_bf16 v[100:103], v[32:35], a[216:219], v[132:135]
    v_exp_f32 v16, v120
    v_mfma_f32_16x16x32_bf16 v[100:103], v[36:39], a[220:223], v[100:103]
    ds_read_b128 v[48:51], v10 offset:0
    v_add_f32 v6, v6, v18
    v_mfma_f32_16x16x32_bf16 v[104:107], v[32:35], a[240:243], v[136:139]
    ds_read_b128 v[28:31], v3 offset:6272
    v_add_f32 v6, v6, v19
    v_mfma_f32_16x16x32_bf16 v[104:107], v[36:39], a[244:247], v[104:107]
    buffer_load_dwordx4 v8, s[4:7], s32 offen offset:1024 sc1 lds
    v_mfma_f32_16x16x32_bf16 v[108:111], v[32:35], v[200:203], v[140:143]
    v_exp_f32 v17, v121
    v_mfma_f32_16x16x32_bf16 v[108:111], v[36:39], v[204:207], v[108:111]
    s_waitcnt lgkmcnt(3)
    v_cvt_pk_bf16_f32 v89, v18, v19
    v_cvt_pk_bf16_f32 v146, v240, v244
    v_mfma_f32_16x16x32_bf16 v[160:163], v[40:43], a[200:203], v[160:163]
    ds_read_b128 v[32:35], v2 offset:256
    v_mfma_f32_16x16x32_bf16 v[160:163], v[44:47], a[204:207], v[160:163]
    v_exp_f32 v18, v122
    v_mfma_f32_16x16x32_bf16 v[164:167], v[40:43], a[224:227], v[164:167]
    v_add_f32 v6, v6, v16
    v_cvt_pk_bf16_f32 v150, v241, v245
    v_mfma_f32_16x16x32_bf16 v[164:167], v[44:47], a[228:231], v[164:167]
    v_add_f32 v6, v6, v17
    v_mfma_f32_16x16x32_bf16 v[168:171], v[40:43], a[248:251], v[168:171]
    ds_read_b128 v[36:39], v3 offset:256
    v_cvt_pk_bf16_f32 v154, v242, v246
    v_mfma_f32_16x16x32_bf16 v[168:171], v[44:47], a[252:255], v[168:171]
    v_exp_f32 v19, v123
    v_mfma_f32_16x16x32_bf16 v[172:175], v[40:43], v[208:211], v[172:175]
    v_cvt_pk_bf16_f32 v90, v16, v17
    v_mfma_f32_16x16x32_bf16 v[172:175], v[44:47], v[212:215], v[172:175]
    s_waitcnt lgkmcnt(2)
    buffer_load_dwordx4 v8, s[4:7], s32 offen offset:2048 sc1 lds
    v_mfma_f32_16x16x32_bf16 v[96:99], v[24:27], a[200:203], v[96:99]
    ds_read_b128 v[40:43], v2 offset:6400
    v_cvt_pk_bf16_f32 v158, v243, v247
    v_mfma_f32_16x16x32_bf16 v[96:99], v[28:31], a[204:207], v[96:99]
    v_exp_f32 v16, v92
    v_mfma_f32_16x16x32_bf16 v[100:103], v[24:27], a[224:227], v[100:103]
    v_add_f32 v6, v6, v18
    v_add_f32 v6, v6, v19
    v_mfma_f32_16x16x32_bf16 v[100:103], v[28:31], a[228:231], v[100:103]
    s_waitcnt vmcnt(14)
    v_exp_f32 v17, v93
    v_mfma_f32_16x16x32_bf16 v[104:107], v[24:27], a[248:251], v[104:107]
    ds_read_b128 v[44:47], v3 offset:6400
    v_cvt_pk_bf16_f32 v91, v18, v19
    v_mfma_f32_16x16x32_bf16 v[104:107], v[28:31], a[252:255], v[104:107]
    s_add_u32 s32, s32, 24576
    v_exp_f32 v18, v94
    v_mfma_f32_16x16x32_bf16 v[108:111], v[24:27], v[208:211], v[108:111]
    s_add_u32 s29, s30, 49152
    v_add_f32 v7, v7, v16
    v_cvt_f32_i32 v248, v248
    v_mfma_f32_16x16x32_bf16 v[108:111], v[28:31], v[212:215], v[108:111]
    s_waitcnt lgkmcnt(2)
    v_add_f32 v7, v7, v17
    v_mfma_f32_16x16x32_bf16 v[160:163], v[32:35], a[208:211], v[160:163]
    s_sub_u32 s3, s29, 147456
    ds_read_b128 v[24:27], v2 offset:12288
    v_mfma_f32_16x16x32_bf16 v[160:163], v[36:39], a[212:215], v[160:163]
    v_exp_f32 v19, v95
    v_mfma_f32_16x16x32_bf16 v[164:167], v[32:35], a[232:235], v[164:167]
    s_add_u32 s26, s26, 12288
    v_cvt_pk_bf16_f32 v92, v16, v17
    v_cvt_f32_i32 v252, v252
    v_mfma_f32_16x16x32_bf16 v[164:167], v[36:39], a[236:239], v[164:167]
    v_exp_f32 v16, v124
    v_mfma_f32_16x16x32_bf16 v[168:171], v[32:35], v[192:195], v[168:171]
    ds_read_b128 v[28:31], v3 offset:12288
    v_cvt_f32_i32 v249, v249
    v_mfma_f32_16x16x32_bf16 v[168:171], v[36:39], v[196:199], v[168:171]
    v_add_f32 v7, v7, v18
    v_add_f32 v7, v7, v19
    v_mfma_f32_16x16x32_bf16 v[172:175], v[32:35], v[216:219], v[172:175]
    s_min_u32 s29, s29, s3
    s_mov_b32 m0, s26
    v_mfma_f32_16x16x32_bf16 v[172:175], v[36:39], v[220:223], v[172:175]
    s_waitcnt lgkmcnt(2)
    v_exp_f32 v17, v125
    v_mfma_f32_16x16x32_bf16 v[96:99], v[40:43], a[208:211], v[96:99]
    ds_read_b128 v[32:35], v2 offset:18432
    v_cvt_pk_bf16_f32 v93, v18, v19
    v_mfma_f32_16x16x32_bf16 v[96:99], v[44:47], a[212:215], v[96:99]
    v_exp_f32 v18, v126
    v_mfma_f32_16x16x32_bf16 v[100:103], v[40:43], a[232:235], v[100:103]
    v_cvt_f32_i32 v253, v253
    v_mfma_f32_16x16x32_bf16 v[100:103], v[44:47], a[236:239], v[100:103]
    v_add_f32 v7, v7, v16
    v_fma_f32 v248, v248, v56, v58
    v_mfma_f32_16x16x32_bf16 v[104:107], v[40:43], v[192:195], v[104:107]
    s_sub_u32 s3, s29, s30
    ds_read_b128 v[36:39], v3 offset:18432
    v_add_f32 v7, v7, v17
    v_mfma_f32_16x16x32_bf16 v[104:107], v[44:47], v[196:199], v[104:107]
    buffer_load_dwordx4 v8, s[4:7], s32 offen offset:0 sc1 lds
    v_mfma_f32_16x16x32_bf16 v[108:111], v[40:43], v[216:219], v[108:111]
    v_exp_f32 v19, v127
    v_mfma_f32_16x16x32_bf16 v[108:111], v[44:47], v[220:223], v[108:111]
    s_waitcnt lgkmcnt(2)
    v_cvt_pk_bf16_f32 v94, v16, v17
    v_fma_f32 v252, v252, v57, v59
    v_mfma_f32_16x16x32_bf16 v[176:179], v[24:27], a[192:195], v[128:131]
    ds_read_b128 v[40:43], v2 offset:12416
    v_add_f32 v7, v7, v18
    v_mfma_f32_16x16x32_bf16 v[176:179], v[28:31], a[196:199], v[176:179]
    v_add_f32 v7, v7, v19
    v_fma_f32 v249, v249, v56, v58
    v_mfma_f32_16x16x32_bf16 v[180:183], v[24:27], a[216:219], v[132:135]
    s_mov_b32 s30, s29
    v_cvt_pk_bf16_f32 v95, v18, v19
    v_mfma_f32_16x16x32_bf16 v[180:183], v[28:31], a[220:223], v[180:183]
    v_mfma_f32_16x16x32_bf16 v[184:187], v[24:27], a[240:243], v[136:139]
    ds_read_b128 v[44:47], v3 offset:12416
    v_fma_f32 v253, v253, v57, v59
    v_mfma_f32_16x16x32_bf16 v[184:187], v[28:31], a[244:247], v[184:187]
    v_exp_f32 v16, v160
    v_mfma_f32_16x16x32_bf16 v[188:191], v[24:27], v[200:203], v[140:143]
    v_exp_f32 v17, v161
    v_mfma_f32_16x16x32_bf16 v[188:191], v[28:31], v[204:207], v[188:191]
    s_waitcnt lgkmcnt(2)
    buffer_load_dwordx4 v8, s[4:7], s32 offen offset:1024 sc1 lds
    v_mfma_f32_16x16x32_bf16 v[112:115], v[32:35], a[192:195], v[128:131]
    ds_read_b128 v[24:27], v2 offset:18560
    v_cvt_f32_i32 v250, v250
    v_mfma_f32_16x16x32_bf16 v[112:115], v[36:39], a[196:199], v[112:115]
    v_exp_f32 v18, v162
    v_mfma_f32_16x16x32_bf16 v[116:119], v[32:35], a[216:219], v[132:135]
    v_add_f32 v4, v4, v16
    v_add_f32 v4, v4, v17
    v_mfma_f32_16x16x32_bf16 v[116:119], v[36:39], a[220:223], v[116:119]
    v_exp_f32 v19, v163
    v_mfma_f32_16x16x32_bf16 v[120:123], v[32:35], a[240:243], v[136:139]
    ds_read_b128 v[28:31], v3 offset:18560
    v_cvt_pk_bf16_f32 v160, v16, v17
    v_mfma_f32_16x16x32_bf16 v[120:123], v[36:39], a[244:247], v[120:123]
    v_exp_f32 v16, v96
    v_mfma_f32_16x16x32_bf16 v[124:127], v[32:35], v[200:203], v[140:143]
    v_add_f32 v4, v4, v18
    v_add_u32 v1, s3, v1
    v_mfma_f32_16x16x32_bf16 v[124:127], v[36:39], v[204:207], v[124:127]
    s_waitcnt lgkmcnt(2)
    buffer_load_dwordx4 v8, s[4:7], s32 offen offset:2048 sc1 lds
    v_mfma_f32_16x16x32_bf16 v[176:179], v[40:43], a[200:203], v[176:179]
    ds_read_b128 v[32:35], v2 offset:12544
    v_add_f32 v4, v4, v19
    v_mfma_f32_16x16x32_bf16 v[176:179], v[44:47], a[204:207], v[176:179]
    v_exp_f32 v17, v97
    v_mfma_f32_16x16x32_bf16 v[180:183], v[40:43], a[224:227], v[180:183]
    v_cvt_pk_bf16_f32 v161, v18, v19
    v_cvt_f32_i32 v254, v254
    v_mfma_f32_16x16x32_bf16 v[180:183], v[44:47], a[228:231], v[180:183]
    v_exp_f32 v18, v98
    v_mfma_f32_16x16x32_bf16 v[184:187], v[40:43], a[248:251], v[184:187]
    ds_read_b128 v[36:39], v3 offset:12544
    v_add_f32 v4, v4, v16
    v_mfma_f32_16x16x32_bf16 v[184:187], v[44:47], a[252:255], v[184:187]
    v_add_f32 v4, v4, v17
    v_cvt_f32_i32 v251, v251
    v_mfma_f32_16x16x32_bf16 v[188:191], v[40:43], v[208:211], v[188:191]
    v_exp_f32 v19, v99
    v_mfma_f32_16x16x32_bf16 v[188:191], v[44:47], v[212:215], v[188:191]
    s_waitcnt lgkmcnt(2)
    v_add_u32 v21, s3, v21
    v_cvt_f32_i32 v255, v255
    v_mfma_f32_16x16x32_bf16 v[112:115], v[24:27], a[200:203], v[112:115]
    ds_read_b128 v[40:43], v2 offset:18688
    v_cvt_pk_bf16_f32 v162, v16, v17
    v_mfma_f32_16x16x32_bf16 v[112:115], v[28:31], a[204:207], v[112:115]
    s_add_u32 s32, s32, 24576
    v_exp_f32 v16, v164
    v_mfma_f32_16x16x32_bf16 v[116:119], v[24:27], a[224:227], v[116:119]
    s_add_u32 s26, s26, 36864
    v_add_f32 v4, v4, v18
    v_add_u32 v22, s3, v22
    v_mfma_f32_16x16x32_bf16 v[116:119], v[28:31], a[228:231], v[116:119]
    v_add_f32 v4, v4, v19
    v_fma_f32 v250, v250, v56, v58
    v_mfma_f32_16x16x32_bf16 v[120:123], v[24:27], a[248:251], v[120:123]
    ds_read_b128 v[44:47], v3 offset:18688
    v_fma_f32 v254, v254, v57, v59
    v_mfma_f32_16x16x32_bf16 v[120:123], v[28:31], a[252:255], v[120:123]
    s_waitcnt lgkmcnt(2)
    buffer_load_dwordx4 v[240:243], v9, s[64:67], s33 offen offset:384 nt
    v_mfma_f32_16x16x32_bf16 v[124:127], v[24:27], v[208:211], v[124:127]
    s_waitcnt vmcnt(18)
    v_exp_f32 v17, v165
    v_mfma_f32_16x16x32_bf16 v[124:127], v[28:31], v[212:215], v[124:127]
    s_barrier
    v_cvt_pk_bf16_f32 v163, v18, v19
    v_mfma_f32_16x16x32_bf16 v[176:179], v[32:35], a[208:211], v[176:179]
    s_sub_u32 s57, s26, 147456
    ds_read_b128 v[24:27], v1 offset:0
    v_fma_f32 v251, v251, v56, v58
    v_mfma_f32_16x16x32_bf16 v[176:179], v[36:39], a[212:215], v[176:179]
    s_min_u32 s26, s26, s57
    v_exp_f32 v18, v166
    v_mfma_f32_16x16x32_bf16 v[180:183], v[32:35], a[232:235], v[180:183]
    v_add_f32 v5, v5, v16
    v_add_f32 v5, v5, v17
    v_mfma_f32_16x16x32_bf16 v[180:183], v[36:39], a[236:239], v[180:183]
    v_exp_f32 v19, v167
    v_mfma_f32_16x16x32_bf16 v[184:187], v[32:35], v[192:195], v[184:187]
    ds_read_b128 v[28:31], v1 offset:12288
    v_cvt_pk_bf16_f32 v164, v16, v17
    v_mfma_f32_16x16x32_bf16 v[184:187], v[36:39], v[196:199], v[184:187]
    buffer_load_dwordx4 v[244:247], v9, s[64:67], s33 offen offset:1920 nt
    v_mfma_f32_16x16x32_bf16 v[188:191], v[32:35], v[216:219], v[188:191]
    v_exp_f32 v16, v100
    v_mfma_f32_16x16x32_bf16 v[188:191], v[36:39], v[220:223], v[188:191]
    s_waitcnt lgkmcnt(2)
    v_add_f32 v5, v5, v18
    v_add_f32 v5, v5, v19
    v_mfma_f32_16x16x32_bf16 v[112:115], v[40:43], a[208:211], v[112:115]
    ds_read_b128 v[32:35], v1 offset:768
    v_fma_f32 v255, v255, v57, v59
    v_mfma_f32_16x16x32_bf16 v[112:115], v[44:47], a[212:215], v[112:115]
    v_exp_f32 v17, v101
    v_mfma_f32_16x16x32_bf16 v[116:119], v[40:43], a[232:235], v[116:119]
    v_cvt_pk_bf16_f32 v165, v18, v19
    v_cvt_pk_bf16_f32 v147, v248, v252
    v_mfma_f32_16x16x32_bf16 v[116:119], v[44:47], a[236:239], v[116:119]
    v_exp_f32 v18, v102
    v_mfma_f32_16x16x32_bf16 v[120:123], v[40:43], v[192:195], v[120:123]
    ds_read_b128 v[36:39], v1 offset:13056
    v_add_f32 v5, v5, v16
    v_mfma_f32_16x16x32_bf16 v[120:123], v[44:47], v[196:199], v[120:123]
    v_add_f32 v5, v5, v17
    v_cvt_pk_bf16_f32 v151, v249, v253
    v_mfma_f32_16x16x32_bf16 v[124:127], v[40:43], v[216:219], v[124:127]
    v_exp_f32 v19, v103
    v_mfma_f32_16x16x32_bf16 v[124:127], v[44:47], v[220:223], v[124:127]
    s_waitcnt lgkmcnt(2)
    v_cvt_pk_bf16_f32 v166, v16, v17
    v_add_f32 v5, v5, v18
    v_add_f32 v5, v5, v19
    v_cvt_pk_bf16_f32 v155, v250, v254
    v_cvt_pk_bf16_f32 v167, v18, v19
    v_cvt_pk_bf16_f32 v159, v251, v255
    v_mfma_f32_16x16x32_bf16 a[0:3], v[64:67], v[24:27], a[0:3]
    ds_read_b128 v[40:43], v1 offset:1536
    v_bfe_u32 v53, v8, 4, 6
    v_mfma_f32_16x16x32_bf16 a[0:3], v[80:83], v[28:31], a[0:3]
    v_exp_f32 v16, v168
    v_mfma_f32_16x16x32_bf16 a[48:51], v[68:71], v[24:27], a[48:51]
    v_exp_f32 v17, v169
    v_mfma_f32_16x16x32_bf16 a[48:51], v[84:87], v[28:31], a[48:51]
    ds_read_b128 v[56:59], v10 offset:384
    v_lshlrev_b32 v53, 2, v53
    v_mfma_f32_16x16x32_bf16 a[96:99], v[72:75], v[24:27], a[96:99]
    s_waitcnt vmcnt(15)
    ds_read_b128 v[44:47], v1 offset:13824
    v_mfma_f32_16x16x32_bf16 a[96:99], v[88:91], v[28:31], a[96:99]
    buffer_store_dwordx4 v[144:147], v20, s[4:7], s81 offen offset:0 sc1
    v_mfma_f32_16x16x32_bf16 a[144:147], v[76:79], v[24:27], a[144:147]
    v_exp_f32 v18, v170
    v_mfma_f32_16x16x32_bf16 a[144:147], v[92:95], v[28:31], a[144:147]
    s_waitcnt lgkmcnt(3)
    v_add_f32 v6, v6, v16
    v_add_f32 v6, v6, v17
    v_mfma_f32_16x16x32_bf16 a[4:7], v[64:67], v[32:35], a[4:7]
    ds_read_b128 v[24:27], v1 offset:2304
    buffer_load_dword v52, v53, s[20:23], 0 offen sc1
    v_mfma_f32_16x16x32_bf16 a[4:7], v[80:83], v[36:39], a[4:7]
    v_exp_f32 v19, v171
    v_mfma_f32_16x16x32_bf16 a[52:55], v[68:71], v[32:35], a[52:55]
    s_mov_b32 m0, s56
    v_cvt_pk_bf16_f32 v168, v16, v17
    v_cvt_f32_i32 v224, v224
    v_mfma_f32_16x16x32_bf16 a[52:55], v[84:87], v[36:39], a[52:55]
    v_exp_f32 v16, v104
    v_mfma_f32_16x16x32_bf16 a[100:103], v[72:75], v[32:35], a[100:103]
    ds_read_b128 v[28:31], v1 offset:14592
    v_add_f32 v6, v6, v18
    v_mfma_f32_16x16x32_bf16 a[100:103], v[88:91], v[36:39], a[100:103]
    v_add_f32 v6, v6, v19
    v_mfma_f32_16x16x32_bf16 a[148:151], v[76:79], v[32:35], a[148:151]
    v_exp_f32 v17, v105
    v_mfma_f32_16x16x32_bf16 a[148:151], v[92:95], v[36:39], a[148:151]
    s_waitcnt lgkmcnt(2)
    buffer_load_dwordx4 v8, s[4:7], s27 offen offset:0 sc1 lds
    v_mfma_f32_16x16x32_bf16 a[8:11], v[64:67], v[40:43], a[8:11]
    ds_read_b128 v[32:35], v21 offset:0
    v_cvt_pk_bf16_f32 v169, v18, v19
    v_mfma_f32_16x16x32_bf16 a[8:11], v[80:83], v[44:47], a[8:11]
    v_exp_f32 v18, v106
    v_mfma_f32_16x16x32_bf16 a[56:59], v[68:71], v[40:43], a[56:59]
    v_add_f32 v6, v6, v16
    v_add_f32 v6, v6, v17
    v_mfma_f32_16x16x32_bf16 a[56:59], v[84:87], v[44:47], a[56:59]
    v_exp_f32 v19, v107
    v_mfma_f32_16x16x32_bf16 a[104:107], v[72:75], v[40:43], a[104:107]
    ds_read_b128 v[36:39], v21 offset:12288
    v_cvt_f32_i32 v225, v225
    v_mfma_f32_16x16x32_bf16 a[104:107], v[88:91], v[44:47], a[104:107]
    buffer_store_dwordx4 v[148:151], v20, s[4:7], s81 offen offset:768 sc1
    v_mfma_f32_16x16x32_bf16 a[152:155], v[76:79], v[40:43], a[152:155]
    v_cvt_pk_bf16_f32 v170, v16, v17
    v_cvt_f32_i32 v228, v228
    v_mfma_f32_16x16x32_bf16 a[152:155], v[92:95], v[44:47], a[152:155]
    s_waitcnt lgkmcnt(2)
    v_exp_f32 v16, v172
    v_mfma_f32_16x16x32_bf16 a[12:15], v[64:67], v[24:27], a[12:15]
    ds_read_b128 v[40:43], v21 offset:768
    v_add_f32 v6, v6, v18
    v_mfma_f32_16x16x32_bf16 a[12:15], v[80:83], v[28:31], a[12:15]
    buffer_load_dwordx4 v8, s[4:7], s27 offen offset:1024 sc1 lds
    v_mfma_f32_16x16x32_bf16 a[60:63], v[68:71], v[24:27], a[60:63]
    ds_read_b128 v[60:63], v10 offset:768
    v_add_f32 v6, v6, v19
    v_mfma_f32_16x16x32_bf16 a[60:63], v[84:87], v[28:31], a[60:63]
    v_exp_f32 v17, v173
    v_mfma_f32_16x16x32_bf16 a[108:111], v[72:75], v[24:27], a[108:111]
    ds_read_b128 v[44:47], v21 offset:13056
    v_cvt_pk_bf16_f32 v171, v18, v19
    v_mfma_f32_16x16x32_bf16 a[108:111], v[88:91], v[28:31], a[108:111]
    v_exp_f32 v18, v174
    v_mfma_f32_16x16x32_bf16 a[156:159], v[76:79], v[24:27], a[156:159]
    s_add_u32 s29, s28, 49152
    v_add_f32 v7, v7, v16
    v_add_f32 v7, v7, v17
    v_mfma_f32_16x16x32_bf16 a[156:159], v[92:95], v[28:31], a[156:159]
    s_waitcnt lgkmcnt(3)
    v_exp_f32 v19, v175
    v_mfma_f32_16x16x32_bf16 a[16:19], v[64:67], v[32:35], a[16:19]
    ds_read_b128 v[24:27], v21 offset:1536
    v_cvt_pk_bf16_f32 v172, v16, v17
    v_mfma_f32_16x16x32_bf16 a[16:19], v[80:83], v[36:39], a[16:19]
    s_sub_u32 s3, s29, 147456
    v_exp_f32 v16, v108
    v_mfma_f32_16x16x32_bf16 a[64:67], v[68:71], v[32:35], a[64:67]
    v_cvt_f32_i32 v229, v229
    v_add_f32 v7, v7, v18
    v_mfma_f32_16x16x32_bf16 a[64:67], v[84:87], v[36:39], a[64:67]
    v_add_f32 v7, v7, v19
    v_mfma_f32_16x16x32_bf16 a[112:115], v[72:75], v[32:35], a[112:115]
    ds_read_b128 v[28:31], v21 offset:13824
    v_fma_f32 v224, v224, v48, v50
    v_mfma_f32_16x16x32_bf16 a[112:115], v[88:91], v[36:39], a[112:115]
    buffer_store_dwordx4 v[152:155], v20, s[4:7], s81 offen offset:1536 sc1
    v_mfma_f32_16x16x32_bf16 a[160:163], v[76:79], v[32:35], a[160:163]
    v_exp_f32 v17, v109
    v_mfma_f32_16x16x32_bf16 a[160:163], v[92:95], v[36:39], a[160:163]
    s_waitcnt lgkmcnt(2)
    v_cvt_pk_bf16_f32 v173, v18, v19
    v_mfma_f32_16x16x32_bf16 a[20:23], v[64:67], v[40:43], a[20:23]
    s_min_u32 s29, s29, s3
    ds_read_b128 v[32:35], v21 offset:2304
    v_mfma_f32_16x16x32_bf16 a[20:23], v[80:83], v[44:47], a[20:23]
    buffer_load_dwordx4 v8, s[4:7], s27 offen offset:2048 sc1 lds
    v_mfma_f32_16x16x32_bf16 a[68:71], v[68:71], v[40:43], a[68:71]
    v_exp_f32 v18, v110
    v_mfma_f32_16x16x32_bf16 a[68:71], v[84:87], v[44:47], a[68:71]
    s_add_u32 s27, s27, 24576
    v_add_f32 v7, v7, v16
    v_add_f32 v7, v7, v17
    v_mfma_f32_16x16x32_bf16 a[116:119], v[72:75], v[40:43], a[116:119]
    ds_read_b128 v[36:39], v21 offset:14592
    v_fma_f32 v225, v225, v49, v51
    v_mfma_f32_16x16x32_bf16 a[116:119], v[88:91], v[44:47], a[116:119]
    v_exp_f32 v19, v111
    v_mfma_f32_16x16x32_bf16 a[164:167], v[76:79], v[40:43], a[164:167]
    s_sub_u32 s3, s29, s28
    v_cvt_pk_bf16_f32 v174, v16, v17
    v_mfma_f32_16x16x32_bf16 a[164:167], v[92:95], v[44:47], a[164:167]
    s_waitcnt lgkmcnt(2)
    v_exp_f32 v16, v176
    v_mfma_f32_16x16x32_bf16 a[24:27], v[64:67], v[24:27], a[24:27]
    s_add_u32 s56, s56, 12288
    ds_read_b128 v[40:43], v22 offset:0
    v_add_f32 v7, v7, v18
    v_mfma_f32_16x16x32_bf16 a[24:27], v[80:83], v[28:31], a[24:27]
    v_add_f32 v7, v7, v19
    v_fma_f32 v228, v228, v48, v50
    v_mfma_f32_16x16x32_bf16 a[72:75], v[68:71], v[24:27], a[72:75]
    v_exp_f32 v17, v177
    v_mfma_f32_16x16x32_bf16 a[72:75], v[84:87], v[28:31], a[72:75]
    v_cvt_pk_bf16_f32 v175, v18, v19
    v_mfma_f32_16x16x32_bf16 a[120:123], v[72:75], v[24:27], a[120:123]
    ds_read_b128 v[44:47], v22 offset:12288
    v_mfma_f32_16x16x32_bf16 a[120:123], v[88:91], v[28:31], a[120:123]
    buffer_store_dwordx4 v[156:159], v20, s[4:7], s81 offen offset:2304 sc1
    v_mfma_f32_16x16x32_bf16 a[168:171], v[76:79], v[24:27], a[168:171]
    s_mov_b32 m0, s56
    v_exp_f32 v18, v178
    v_mfma_f32_16x16x32_bf16 a[168:171], v[92:95], v[28:31], a[168:171]
    s_waitcnt lgkmcnt(2)
    v_add_f32 v4, v4, v16
    v_add_f32 v4, v4, v17
    v_mfma_f32_16x16x32_bf16 a[28:31], v[64:67], v[32:35], a[28:31]
    s_mov_b32 s28, s29
    ds_read_b128 v[24:27], v22 offset:768
    v_fma_f32 v229, v229, v49, v51
    v_mfma_f32_16x16x32_bf16 a[28:31], v[80:83], v[36:39], a[28:31]
    v_exp_f32 v19, v179
    v_mfma_f32_16x16x32_bf16 a[76:79], v[68:71], v[32:35], a[76:79]
    v_cvt_pk_bf16_f32 v176, v16, v17
    v_mfma_f32_16x16x32_bf16 a[76:79], v[84:87], v[36:39], a[76:79]
    v_exp_f32 v16, v112
    v_mfma_f32_16x16x32_bf16 a[124:127], v[72:75], v[32:35], a[124:127]
    ds_read_b128 v[28:31], v22 offset:13056
    v_add_f32 v4, v4, v18
    v_mfma_f32_16x16x32_bf16 a[124:127], v[88:91], v[36:39], a[124:127]
    buffer_load_dwordx4 v8, s[4:7], s27 offen offset:0 sc1 lds
    v_mfma_f32_16x16x32_bf16 a[172:175], v[76:79], v[32:35], a[172:175]
    v_add_f32 v4, v4, v19
    v_cvt_pk_bf16_f32 v224, v224, v225
    v_mfma_f32_16x16x32_bf16 a[172:175], v[92:95], v[36:39], a[172:175]
    s_waitcnt lgkmcnt(2)
    v_exp_f32 v17, v113
    v_mfma_f32_16x16x32_bf16 a[32:35], v[64:67], v[40:43], a[32:35]
    ds_read_b128 v[32:35], v22 offset:1536
    v_cvt_pk_bf16_f32 v177, v18, v19
    v_mfma_f32_16x16x32_bf16 a[32:35], v[80:83], v[44:47], a[32:35]
    v_exp_f32 v18, v114
    v_mfma_f32_16x16x32_bf16 a[80:83], v[68:71], v[40:43], a[80:83]
    v_add_f32 v4, v4, v16
    v_add_f32 v4, v4, v17
    v_mfma_f32_16x16x32_bf16 a[80:83], v[84:87], v[44:47], a[80:83]
    v_exp_f32 v19, v115
    v_mfma_f32_16x16x32_bf16 a[128:131], v[72:75], v[40:43], a[128:131]
    ds_read_b128 v[36:39], v22 offset:13824
    v_add_u32 v2, s3, v2
    v_mfma_f32_16x16x32_bf16 a[128:131], v[88:91], v[44:47], a[128:131]
    v_cvt_pk_bf16_f32 v178, v16, v17
    v_cvt_pk_bf16_f32 v228, v228, v229
    v_mfma_f32_16x16x32_bf16 a[176:179], v[76:79], v[40:43], a[176:179]
    v_exp_f32 v16, v180
    v_mfma_f32_16x16x32_bf16 a[176:179], v[92:95], v[44:47], a[176:179]
    s_waitcnt lgkmcnt(2)
    v_add_f32 v4, v4, v18
    v_add_u32 v3, s3, v3
    v_mfma_f32_16x16x32_bf16 a[36:39], v[64:67], v[24:27], a[36:39]
    ds_read_b128 v[40:43], v22 offset:2304
    v_add_f32 v4, v4, v19
    v_mfma_f32_16x16x32_bf16 a[36:39], v[80:83], v[28:31], a[36:39]
    buffer_load_dwordx4 v8, s[4:7], s27 offen offset:1024 sc1 lds
    v_mfma_f32_16x16x32_bf16 a[84:87], v[68:71], v[24:27], a[84:87]
    v_exp_f32 v17, v181
    v_mfma_f32_16x16x32_bf16 a[84:87], v[84:87], v[28:31], a[84:87]
    v_cvt_pk_bf16_f32 v179, v18, v19
    v_cvt_f32_i32 v226, v226
    v_mfma_f32_16x16x32_bf16 a[132:135], v[72:75], v[24:27], a[132:135]
    ds_read_b128 v[44:47], v22 offset:14592
    v_cvt_f32_i32 v227, v227
    v_mfma_f32_16x16x32_bf16 a[132:135], v[88:91], v[28:31], a[132:135]
    s_waitcnt lgkmcnt(2)
    v_exp_f32 v18, v182
    v_mfma_f32_16x16x32_bf16 a[180:183], v[76:79], v[24:27], a[180:183]
    s_waitcnt vmcnt(17)
    v_add_f32 v5, v5, v16
    v_add_f32 v5, v5, v17
    v_mfma_f32_16x16x32_bf16 a[180:183], v[92:95], v[28:31], a[180:183]
    s_barrier
    v_mfma_f32_16x16x32_bf16 a[40:43], v[64:67], v[32:35], a[40:43]
    ds_read_b128 v[24:27], v2 offset:0
    v_mfma_f32_16x16x32_bf16 a[40:43], v[80:83], v[36:39], a[40:43]
    v_exp_f32 v19, v183
    v_mfma_f32_16x16x32_bf16 a[88:91], v[68:71], v[32:35], a[88:91]
    v_cvt_pk_bf16_f32 v180, v16, v17
    v_cvt_f32_i32 v230, v230
    v_mfma_f32_16x16x32_bf16 a[88:91], v[84:87], v[36:39], a[88:91]
    buffer_load_dwordx4 v8, s[4:7], s27 offen offset:2048 sc1 lds
    v_mfma_f32_16x16x32_bf16 a[136:139], v[72:75], v[32:35], a[136:139]
    ds_read_b128 v[28:31], v3 offset:0
    v_mfma_f32_16x16x32_bf16 a[136:139], v[88:91], v[36:39], a[136:139]
    v_exp_f32 v16, v116
    v_mfma_f32_16x16x32_bf16 a[184:187], v[76:79], v[32:35], a[184:187]
    v_add_f32 v5, v5, v18
    v_add_f32 v5, v5, v19
    v_mfma_f32_16x16x32_bf16 a[184:187], v[92:95], v[36:39], a[184:187]
    s_waitcnt lgkmcnt(2)
    v_exp_f32 v17, v117
    v_mfma_f32_16x16x32_bf16 a[44:47], v[64:67], v[40:43], a[44:47]
    ds_read_b128 v[32:35], v2 offset:6144
    v_cvt_pk_bf16_f32 v181, v18, v19
    v_mfma_f32_16x16x32_bf16 a[44:47], v[80:83], v[44:47], a[44:47]
    v_exp_f32 v18, v118
    v_mfma_f32_16x16x32_bf16 a[92:95], v[68:71], v[40:43], a[92:95]
    v_add_f32 v5, v5, v16
    v_add_f32 v5, v5, v17
    v_mfma_f32_16x16x32_bf16 a[92:95], v[84:87], v[44:47], a[92:95]
    v_exp_f32 v19, v119
    v_mfma_f32_16x16x32_bf16 a[140:143], v[72:75], v[40:43], a[140:143]
    ds_read_b128 v[36:39], v3 offset:6144
    v_cvt_pk_bf16_f32 v182, v16, v17
    v_mfma_f32_16x16x32_bf16 a[140:143], v[88:91], v[44:47], a[140:143]
    s_add_u32 s27, s27, 24576
    v_add_f32 v5, v5, v18
    v_cvt_f32_i32 v231, v231
    v_mfma_f32_16x16x32_bf16 a[188:191], v[76:79], v[40:43], a[188:191]
    s_add_u32 s56, s56, 36864
    v_add_f32 v5, v5, v19
    s_sub_u32 s58, s56, 147456
    v_mfma_f32_16x16x32_bf16 a[188:191], v[92:95], v[44:47], a[188:191]
    s_waitcnt lgkmcnt(2)
    v_cvt_pk_bf16_f32 v183, v18, v19
    s_min_u32 s56, s56, s58
    v_mfma_f32_16x16x32_bf16 v[64:67], v[24:27], a[192:195], v[128:131]
    ds_read_b128 v[40:43], v2 offset:128
    v_fma_f32 v226, v226, v56, v58
    v_mfma_f32_16x16x32_bf16 v[64:67], v[28:31], a[196:199], v[64:67]
    buffer_load_dwordx4 v[248:251], v9, s[64:67], s34 offen offset:384 nt
    v_mfma_f32_16x16x32_bf16 v[68:71], v[24:27], a[216:219], v[132:135]
    v_exp_f32 v16, v184
    v_mfma_f32_16x16x32_bf16 v[68:71], v[28:31], a[220:223], v[68:71]
    v_exp_f32 v17, v185
    v_mfma_f32_16x16x32_bf16 v[72:75], v[24:27], a[240:243], v[136:139]
    ds_read_b128 v[44:47], v3 offset:128
    v_fma_f32 v227, v227, v57, v59
    v_mfma_f32_16x16x32_bf16 v[72:75], v[28:31], a[244:247], v[72:75]
    v_exp_f32 v18, v186
    v_mfma_f32_16x16x32_bf16 v[76:79], v[24:27], v[200:203], v[140:143]
    v_add_f32 v6, v6, v16
    v_add_f32 v6, v6, v17
    v_mfma_f32_16x16x32_bf16 v[76:79], v[28:31], v[204:207], v[76:79]
    s_waitcnt lgkmcnt(2)
    v_exp_f32 v19, v187
    v_mfma_f32_16x16x32_bf16 v[96:99], v[32:35], a[192:195], v[128:131]
    ds_read_b128 v[24:27], v2 offset:6272
    v_cvt_pk_bf16_f32 v184, v16, v17
    v_mfma_f32_16x16x32_bf16 v[96:99], v[36:39], a[196:199], v[96:99]
    v_fma_f32 v230, v230, v56, v58
    v_mfma_f32_16x16x32_bf16 v[100:103], v[32:35], a[216:219], v[132:135]
    v_exp_f32 v16, v120
    v_mfma_f32_16x16x32_bf16 v[100:103], v[36:39], a[220:223], v[100:103]
    buffer_load_dwordx4 v[252:255], v9, s[64:67], s34 offen offset:1920 nt
    v_mfma_f32_16x16x32_bf16 v[104:107], v[32:35], a[240:243], v[136:139]
    ds_read_b128 v[28:31], v3 offset:6272
    v_add_f32 v6, v6, v18
    v_mfma_f32_16x16x32_bf16 v[104:107], v[36:39], a[244:247], v[104:107]
    v_add_f32 v6, v6, v19
    v_fma_f32 v231, v231, v57, v59
    v_mfma_f32_16x16x32_bf16 v[108:111], v[32:35], v[200:203], v[140:143]
    v_exp_f32 v17, v121
    v_mfma_f32_16x16x32_bf16 v[108:111], v[36:39], v[204:207], v[108:111]
    s_waitcnt lgkmcnt(2)
    v_cvt_pk_bf16_f32 v185, v18, v19
    v_mfma_f32_16x16x32_bf16 v[64:67], v[40:43], a[200:203], v[64:67]
    ds_read_b128 v[32:35], v2 offset:256
    v_mfma_f32_16x16x32_bf16 v[64:67], v[44:47], a[204:207], v[64:67]
    v_exp_f32 v18, v122
    v_mfma_f32_16x16x32_bf16 v[68:71], v[40:43], a[224:227], v[68:71]
    v_add_f32 v6, v6, v16
    v_add_f32 v6, v6, v17
    v_mfma_f32_16x16x32_bf16 v[68:71], v[44:47], a[228:231], v[68:71]
    v_cvt_pk_bf16_f32 v225, v226, v227
    v_mfma_f32_16x16x32_bf16 v[72:75], v[40:43], a[248:251], v[72:75]
    ds_read_b128 v[36:39], v3 offset:256
    v_mfma_f32_16x16x32_bf16 v[72:75], v[44:47], a[252:255], v[72:75]
    v_exp_f32 v19, v123
    v_mfma_f32_16x16x32_bf16 v[76:79], v[40:43], v[208:211], v[76:79]
    v_cvt_pk_bf16_f32 v186, v16, v17
    v_mfma_f32_16x16x32_bf16 v[76:79], v[44:47], v[212:215], v[76:79]
    s_waitcnt lgkmcnt(2)
    v_exp_f32 v16, v188
    v_mfma_f32_16x16x32_bf16 v[96:99], v[24:27], a[200:203], v[96:99]
    ds_read_b128 v[40:43], v2 offset:6400
    v_add_f32 v6, v6, v18
    v_mfma_f32_16x16x32_bf16 v[96:99], v[28:31], a[204:207], v[96:99]
    v_add_f32 v6, v6, v19
    v_cvt_pk_bf16_f32 v229, v230, v231
    v_mfma_f32_16x16x32_bf16 v[100:103], v[24:27], a[224:227], v[100:103]
    v_exp_f32 v17, v189
    v_mfma_f32_16x16x32_bf16 v[100:103], v[28:31], a[228:231], v[100:103]
    v_cvt_pk_bf16_f32 v187, v18, v19
    v_mfma_f32_16x16x32_bf16 v[104:107], v[24:27], a[248:251], v[104:107]
    ds_read_b128 v[44:47], v3 offset:6400
    v_mfma_f32_16x16x32_bf16 v[104:107], v[28:31], a[252:255], v[104:107]
    s_waitcnt vmcnt(11)
    v_subrev_u32 v52, s92, v52
    v_cmp_lt_u32 vcc, 15, v52
    v_mfma_f32_16x16x32_bf16 v[108:111], v[24:27], v[208:211], v[108:111]
    s_add_u32 s29, s30, 49152
    v_exp_f32 v18, v190
    v_mfma_f32_16x16x32_bf16 v[108:111], v[28:31], v[212:215], v[108:111]
    s_waitcnt lgkmcnt(2)
    v_add_f32 v7, v7, v16
    v_add_f32 v7, v7, v17
    v_mfma_f32_16x16x32_bf16 v[64:67], v[32:35], a[208:211], v[64:67]
    s_and_b32 s59, vcc_lo, 0xff
    ds_read_b128 v[24:27], v2 offset:12288
    v_mfma_f32_16x16x32_bf16 v[64:67], v[36:39], a[212:215], v[64:67]
    s_cbranch_scc1 L_pollslow4
L_pollok4:
    v_mfma_f32_16x16x32_bf16 v[68:71], v[32:35], a[232:235], v[68:71]
    s_add_u32 s92, s92, 1
    v_exp_f32 v19, v191
    v_mfma_f32_16x16x32_bf16 v[68:71], v[36:39], a[236:239], v[68:71]
    s_waitcnt vmcnt(25)
    v_cvt_pk_bf16_f32 v188, v16, v17
    s_sub_u32 s3, s29, 147456
    s_branch L_skip9
L_pad9:
    s_branch L_tb1_5
L_skip9:
    v_mfma_f32_16x16x32_bf16 v[72:75], v[32:35], v[192:195], v[72:75]
    s_mov_b32 m0, s26
    ds_read_b128 v[28:31], v3 offset:12288
    v_cvt_f32_i32 v232, v232
    v_mfma_f32_16x16x32_bf16 v[72:75], v[36:39], v[196:199], v[72:75]
    v_exp_f32 v16, v124
    v_mfma_f32_16x16x32_bf16 v[76:79], v[32:35], v[216:219], v[76:79]
    s_min_u32 s29, s29, s3
    v_add_f32 v7, v7, v18
    v_add_f32 v7, v7, v19
    v_mfma_f32_16x16x32_bf16 v[76:79], v[36:39], v[220:223], v[76:79]
    s_waitcnt lgkmcnt(2)
    buffer_load_dwordx4 v8, s[4:7], s32 offen offset:0 sc1 lds
    v_mfma_f32_16x16x32_bf16 v[96:99], v[40:43], a[208:211], v[96:99]
    ds_read_b128 v[32:35], v2 offset:18432
    v_cvt_f32_i32 v233, v233
    v_mfma_f32_16x16x32_bf16 v[96:99], v[44:47], a[212:215], v[96:99]
    v_exp_f32 v17, v125
    v_mfma_f32_16x16x32_bf16 v[100:103], v[40:43], a[232:235], v[100:103]
    v_cvt_pk_bf16_f32 v189, v18, v19
    v_mfma_f32_16x16x32_bf16 v[100:103], v[44:47], a[236:239], v[100:103]
    buffer_load_dwordx4 v8, s[4:7], s32 offen offset:1024 sc1 lds
    v_mfma_f32_16x16x32_bf16 v[104:107], v[40:43], v[192:195], v[104:107]
    s_sub_u32 s3, s29, s30
    ds_read_b128 v[36:39], v3 offset:18432
    v_mfma_f32_16x16x32_bf16 v[104:107], v[44:47], v[196:199], v[104:107]
    v_exp_f32 v18, v126
    v_mfma_f32_16x16x32_bf16 v[108:111], v[40:43], v[216:219], v[108:111]
    v_add_f32 v7, v7, v16
    v_add_f32 v7, v7, v17
    v_mfma_f32_16x16x32_bf16 v[108:111], v[44:47], v[220:223], v[108:111]
    s_waitcnt lgkmcnt(2)
    v_exp_f32 v19, v127
    v_mfma_f32_16x16x32_bf16 v[80:83], v[24:27], a[192:195], v[128:131]
    ds_read_b128 v[40:43], v2 offset:12416
    v_cvt_pk_bf16_f32 v190, v16, v17
    v_mfma_f32_16x16x32_bf16 v[80:83], v[28:31], a[196:199], v[80:83]
    buffer_load_dwordx4 v8, s[4:7], s32 offen offset:2048 sc1 lds
    v_mfma_f32_16x16x32_bf16 v[84:87], v[24:27], a[216:219], v[132:135]
    v_add_f32 v7, v7, v18
    v_add_f32 v7, v7, v19
    v_cvt_pk_bf16_f32 v191, v18, v19
    v_mfma_f32_16x16x32_bf16 v[84:87], v[28:31], a[220:223], v[84:87]
    s_mov_b32 s30, s29
    v_cvt_f32_i32 v236, v236
    v_cvt_f32_i32 v237, v237
    v_mfma_f32_16x16x32_bf16 v[88:91], v[24:27], a[240:243], v[136:139]
    s_add_u32 s32, s32, 24576
    ds_read_b128 v[44:47], v3 offset:12416
    v_mfma_f32_16x16x32_bf16 v[88:91], v[28:31], a[244:247], v[88:91]
    v_exp_f32 v16, v64
    v_mfma_f32_16x16x32_bf16 v[92:95], v[24:27], v[200:203], v[140:143]
    v_exp_f32 v17, v65
    v_mfma_f32_16x16x32_bf16 v[92:95], v[28:31], v[204:207], v[92:95]
    s_waitcnt lgkmcnt(2)
    v_exp_f32 v18, v66
    v_mfma_f32_16x16x32_bf16 v[112:115], v[32:35], a[192:195], v[128:131]
    s_add_u32 s26, s26, 12288
    ds_read_b128 v[24:27], v2 offset:18560
    v_add_f32 v4, v4, v16
    v_mfma_f32_16x16x32_bf16 v[112:115], v[36:39], a[196:199], v[112:115]
    s_mov_b32 m0, s26
    v_add_f32 v4, v4, v17
    v_fma_f32 v232, v232, v48, v50
    v_mfma_f32_16x16x32_bf16 v[116:119], v[32:35], a[216:219], v[132:135]
    v_exp_f32 v19, v67
    v_mfma_f32_16x16x32_bf16 v[116:119], v[36:39], a[220:223], v[116:119]
    v_cvt_pk_bf16_f32 v64, v16, v17
    v_add_u32 v1, s3, v1
    v_mfma_f32_16x16x32_bf16 v[120:123], v[32:35], a[240:243], v[136:139]
    ds_read_b128 v[28:31], v3 offset:18560
    v_mfma_f32_16x16x32_bf16 v[120:123], v[36:39], a[244:247], v[120:123]
    buffer_load_dwordx4 v8, s[4:7], s32 offen offset:0 sc1 lds
    v_mfma_f32_16x16x32_bf16 v[124:127], v[32:35], v[200:203], v[140:143]
    v_exp_f32 v16, v96
    v_mfma_f32_16x16x32_bf16 v[124:127], v[36:39], v[204:207], v[124:127]
    s_waitcnt lgkmcnt(2)
    v_add_f32 v4, v4, v18
    v_add_f32 v4, v4, v19
    v_mfma_f32_16x16x32_bf16 v[80:83], v[40:43], a[200:203], v[80:83]
    ds_read_b128 v[32:35], v2 offset:12544
    v_fma_f32 v233, v233, v49, v51
    v_mfma_f32_16x16x32_bf16 v[80:83], v[44:47], a[204:207], v[80:83]
    v_exp_f32 v17, v97
    v_mfma_f32_16x16x32_bf16 v[84:87], v[40:43], a[224:227], v[84:87]
    v_cvt_pk_bf16_f32 v65, v18, v19
    v_add_u32 v21, s3, v21
    v_mfma_f32_16x16x32_bf16 v[84:87], v[44:47], a[228:231], v[84:87]
    buffer_load_dwordx4 v8, s[4:7], s32 offen offset:1024 sc1 lds
    v_mfma_f32_16x16x32_bf16 v[88:91], v[40:43], a[248:251], v[88:91]
    ds_read_b128 v[36:39], v3 offset:12544
    v_fma_f32 v236, v236, v48, v50
    v_mfma_f32_16x16x32_bf16 v[88:91], v[44:47], a[252:255], v[88:91]
    v_exp_f32 v18, v98
    v_mfma_f32_16x16x32_bf16 v[92:95], v[40:43], v[208:211], v[92:95]
    v_add_f32 v4, v4, v16
    v_add_f32 v4, v4, v17
    v_mfma_f32_16x16x32_bf16 v[92:95], v[44:47], v[212:215], v[92:95]
    s_waitcnt lgkmcnt(2)
    buffer_load_dwordx4 v8, s[4:7], s32 offen offset:2048 sc1 lds
    v_mfma_f32_16x16x32_bf16 v[112:115], v[24:27], a[200:203], v[112:115]
    ds_read_b128 v[40:43], v2 offset:18688
    v_add_u32 v22, s3, v22
    v_mfma_f32_16x16x32_bf16 v[112:115], v[28:31], a[204:207], v[112:115]
    v_exp_f32 v19, v99
    v_mfma_f32_16x16x32_bf16 v[116:119], v[24:27], a[224:227], v[116:119]
    v_cvt_pk_bf16_f32 v66, v16, v17
    v_fma_f32 v237, v237, v49, v51
    v_mfma_f32_16x16x32_bf16 v[116:119], v[28:31], a[228:231], v[116:119]
    v_exp_f32 v16, v68
    v_mfma_f32_16x16x32_bf16 v[120:123], v[24:27], a[248:251], v[120:123]
    ds_read_b128 v[44:47], v3 offset:18688
    v_add_f32 v4, v4, v18
    v_mfma_f32_16x16x32_bf16 v[120:123], v[28:31], a[252:255], v[120:123]
    s_waitcnt lgkmcnt(2)
    v_add_f32 v4, v4, v19
    s_add_u32 s32, s32, 24576
    v_mfma_f32_16x16x32_bf16 v[124:127], v[24:27], v[208:211], v[124:127]
    s_waitcnt vmcnt(11)
    v_exp_f32 v17, v69
    v_mfma_f32_16x16x32_bf16 v[124:127], v[28:31], v[212:215], v[124:127]
    s_barrier
    v_cvt_pk_bf16_f32 v67, v18, v19
    v_mfma_f32_16x16x32_bf16 v[80:83], v[32:35], a[208:211], v[80:83]
    s_add_u32 s26, s26, 36864
    ds_read_b128 v[24:27], v1 offset:0
    v_add_u32 v55, 1, v55
    v_mfma_f32_16x16x32_bf16 v[80:83], v[36:39], a[212:215], v[80:83]
    s_sub_u32 s57, s26, 147456
    v_exp_f32 v18, v70
    v_mfma_f32_16x16x32_bf16 v[84:87], v[32:35], a[232:235], v[84:87]
    v_add_f32 v5, v5, v16
    v_add_f32 v5, v5, v17
    v_mfma_f32_16x16x32_bf16 v[84:87], v[36:39], a[236:239], v[84:87]
    v_exp_f32 v19, v71
    v_mfma_f32_16x16x32_bf16 v[88:91], v[32:35], v[192:195], v[88:91]
    s_min_u32 s26, s26, s57
    ds_read_b128 v[28:31], v1 offset:12288
    v_cvt_pk_bf16_f32 v68, v16, v17
    v_mfma_f32_16x16x32_bf16 v[88:91], v[36:39], v[196:199], v[88:91]
    buffer_store_dword v55, v13, s[20:23], 0 offen sc1
    v_mfma_f32_16x16x32_bf16 v[92:95], v[32:35], v[216:219], v[92:95]
    v_exp_f32 v16, v100
    v_mfma_f32_16x16x32_bf16 v[92:95], v[36:39], v[220:223], v[92:95]
    s_waitcnt lgkmcnt(2)
    v_add_f32 v5, v5, v18
    v_add_f32 v5, v5, v19
    v_mfma_f32_16x16x32_bf16 v[112:115], v[40:43], a[208:211], v[112:115]
    ds_read_b128 v[32:35], v1 offset:768
    v_cvt_pk_bf16_f32 v232, v232, v233
    v_mfma_f32_16x16x32_bf16 v[112:115], v[44:47], a[212:215], v[112:115]
    v_exp_f32 v17, v101
    v_mfma_f32_16x16x32_bf16 v[116:119], v[40:43], a[232:235], v[116:119]
    v_cvt_pk_bf16_f32 v69, v18, v19
    v_cvt_pk_bf16_f32 v236, v236, v237
    v_mfma_f32_16x16x32_bf16 v[116:119], v[44:47], a[236:239], v[116:119]
    v_exp_f32 v18, v102
    v_mfma_f32_16x16x32_bf16 v[120:123], v[40:43], v[192:195], v[120:123]
    ds_read_b128 v[36:39], v1 offset:13056
    v_add_f32 v5, v5, v16
    v_mfma_f32_16x16x32_bf16 v[120:123], v[44:47], v[196:199], v[120:123]
    v_add_f32 v5, v5, v17
    v_cvt_f32_i32 v234, v234
    v_mfma_f32_16x16x32_bf16 v[124:127], v[40:43], v[216:219], v[124:127]
    v_exp_f32 v19, v103
    v_mfma_f32_16x16x32_bf16 v[124:127], v[44:47], v[220:223], v[124:127]
    s_waitcnt lgkmcnt(2)
    v_cvt_pk_bf16_f32 v70, v16, v17
    v_add_f32 v5, v5, v18
    v_add_f32 v5, v5, v19
    v_cvt_pk_bf16_f32 v71, v18, v19
    v_mfma_f32_16x16x32_bf16 a[0:3], v[160:163], v[24:27], a[0:3]
    ds_read_b128 v[40:43], v1 offset:1536
    s_add_u32 s35, s35, 196608
    v_mfma_f32_16x16x32_bf16 a[0:3], v[176:179], v[28:31], a[0:3]
    s_mov_b32 m0, s56
    v_exp_f32 v16, v72
    v_mfma_f32_16x16x32_bf16 a[48:51], v[164:167], v[24:27], a[48:51]
    s_sub_u32 s36, s35, 1572864
    v_exp_f32 v17, v73
    v_mfma_f32_16x16x32_bf16 a[48:51], v[180:183], v[28:31], a[48:51]
    v_cvt_f32_i32 v235, v235
    v_cvt_f32_i32 v238, v238
    v_mfma_f32_16x16x32_bf16 a[96:99], v[168:171], v[24:27], a[96:99]
    ds_read_b128 v[44:47], v1 offset:13824
    v_mfma_f32_16x16x32_bf16 a[96:99], v[184:187], v[28:31], a[96:99]
    s_min_u32 s35, s35, s36
    buffer_load_dwordx4 v8, s[4:7], s27 offen offset:0 sc1 lds
    v_mfma_f32_16x16x32_bf16 a[144:147], v[172:175], v[24:27], a[144:147]
    v_exp_f32 v18, v74
    v_mfma_f32_16x16x32_bf16 a[144:147], v[188:191], v[28:31], a[144:147]
    s_waitcnt lgkmcnt(2)
    v_add_f32 v6, v6, v16
    v_add_f32 v6, v6, v17
    v_mfma_f32_16x16x32_bf16 a[4:7], v[160:163], v[32:35], a[4:7]
    s_add_u32 s36, s35, 3072
    ds_read_b128 v[24:27], v1 offset:2304
    v_cvt_f32_i32 v239, v239
    v_mfma_f32_16x16x32_bf16 a[4:7], v[176:179], v[36:39], a[4:7]
    v_exp_f32 v19, v75
    v_mfma_f32_16x16x32_bf16 a[52:55], v[164:167], v[32:35], a[52:55]
    v_cvt_pk_bf16_f32 v72, v16, v17
    v_mfma_f32_16x16x32_bf16 a[52:55], v[180:183], v[36:39], a[52:55]
    v_exp_f32 v16, v104
    v_mfma_f32_16x16x32_bf16 a[100:103], v[168:171], v[32:35], a[100:103]
    s_add_u32 s81, s81, 196608
    ds_read_b128 v[28:31], v1 offset:14592
    v_add_f32 v6, v6, v18
    v_mfma_f32_16x16x32_bf16 a[100:103], v[184:187], v[36:39], a[100:103]
    v_add_f32 v6, v6, v19
    v_fma_f32 v234, v234, v56, v58
    v_mfma_f32_16x16x32_bf16 a[148:151], v[172:175], v[32:35], a[148:151]
    v_exp_f32 v17, v105
    v_mfma_f32_16x16x32_bf16 a[148:151], v[188:191], v[36:39], a[148:151]
    s_waitcnt lgkmcnt(2)
    buffer_load_dwordx4 v8, s[4:7], s27 offen offset:1024 sc1 lds
    v_mfma_f32_16x16x32_bf16 a[8:11], v[160:163], v[40:43], a[8:11]
    ds_read_b128 v[32:35], v21 offset:0
    v_cvt_pk_bf16_f32 v73, v18, v19
    v_mfma_f32_16x16x32_bf16 a[8:11], v[176:179], v[44:47], a[8:11]
    v_exp_f32 v18, v106
    v_mfma_f32_16x16x32_bf16 a[56:59], v[164:167], v[40:43], a[56:59]
    v_add_f32 v6, v6, v16
    v_add_f32 v6, v6, v17
    v_mfma_f32_16x16x32_bf16 a[56:59], v[180:183], v[44:47], a[56:59]
    buffer_load_dwordx4 v[144:147], v12, s[68:71], s35 offen offset:0 nt
    v_mfma_f32_16x16x32_bf16 a[104:107], v[168:171], v[40:43], a[104:107]
    ds_read_b128 v[36:39], v21 offset:12288
    v_fma_f32 v235, v235, v57, v59
    v_mfma_f32_16x16x32_bf16 a[104:107], v[184:187], v[44:47], a[104:107]
    v_exp_f32 v19, v107
    v_mfma_f32_16x16x32_bf16 a[152:155], v[172:175], v[40:43], a[152:155]
    v_cvt_pk_bf16_f32 v74, v16, v17
    v_fma_f32 v238, v238, v56, v58
    v_mfma_f32_16x16x32_bf16 a[152:155], v[188:191], v[44:47], a[152:155]
    s_waitcnt lgkmcnt(2)
    buffer_load_dwordx4 v8, s[4:7], s27 offen offset:2048 sc1 lds
    v_mfma_f32_16x16x32_bf16 a[12:15], v[160:163], v[24:27], a[12:15]
    ds_read_b128 v[40:43], v21 offset:768
    v_mfma_f32_16x16x32_bf16 a[12:15], v[176:179], v[28:31], a[12:15]
    v_exp_f32 v16, v76
    v_mfma_f32_16x16x32_bf16 a[60:63], v[164:167], v[24:27], a[60:63]
    v_add_f32 v6, v6, v18
    v_add_f32 v6, v6, v19
    v_mfma_f32_16x16x32_bf16 a[60:63], v[180:183], v[28:31], a[60:63]
    buffer_load_dwordx4 v[148:151], v12, s[68:71], s35 offen offset:768 nt
    v_mfma_f32_16x16x32_bf16 a[108:111], v[168:171], v[24:27], a[108:111]
    ds_read_b128 v[44:47], v21 offset:13056
    v_fma_f32 v239, v239, v57, v59
    v_mfma_f32_16x16x32_bf16 a[108:111], v[184:187], v[28:31], a[108:111]
    v_exp_f32 v17, v77
    v_mfma_f32_16x16x32_bf16 a[156:159], v[172:175], v[24:27], a[156:159]
    s_add_u32 s29, s28, 49152
    v_cvt_pk_bf16_f32 v75, v18, v19
    s_add_u32 s27, s27, 24576
    v_mfma_f32_16x16x32_bf16 a[156:159], v[188:191], v[28:31], a[156:159]
    s_waitcnt lgkmcnt(2)
    buffer_load_dwordx4 v[152:155], v12, s[68:71], s35 offen offset:1536 nt
    v_mfma_f32_16x16x32_bf16 a[16:19], v[160:163], v[32:35], a[16:19]
    ds_read_b128 v[24:27], v21 offset:1536
    v_cvt_pk_bf16_f32 v233, v234, v235
    v_mfma_f32_16x16x32_bf16 a[16:19], v[176:179], v[36:39], a[16:19]
    s_sub_u32 s3, s29, 147456
    v_exp_f32 v18, v78
    v_mfma_f32_16x16x32_bf16 a[64:67], v[164:167], v[32:35], a[64:67]
    v_add_f32 v7, v7, v16
    v_add_f32 v7, v7, v17
    v_mfma_f32_16x16x32_bf16 a[64:67], v[180:183], v[36:39], a[64:67]
    s_add_u32 s56, s56, 12288
    v_exp_f32 v19, v79
    v_mfma_f32_16x16x32_bf16 a[112:115], v[168:171], v[32:35], a[112:115]
    ds_read_b128 v[28:31], v21 offset:13824
    v_cvt_pk_bf16_f32 v76, v16, v17
    v_mfma_f32_16x16x32_bf16 a[112:115], v[184:187], v[36:39], a[112:115]
    v_exp_f32 v16, v108
    v_mfma_f32_16x16x32_bf16 a[160:163], v[172:175], v[32:35], a[160:163]
    v_add_f32 v7, v7, v18
    v_add_f32 v7, v7, v19
    v_mfma_f32_16x16x32_bf16 a[160:163], v[188:191], v[36:39], a[160:163]
    s_waitcnt lgkmcnt(2)
    buffer_load_dwordx4 v[156:159], v12, s[68:71], s35 offen offset:2304 nt
    v_mfma_f32_16x16x32_bf16 a[20:23], v[160:163], v[40:43], a[20:23]
    s_mov_b32 m0, s56
    ds_read_b128 v[32:35], v21 offset:2304
    v_cvt_pk_bf16_f32 v237, v238, v239
    v_mfma_f32_16x16x32_bf16 a[20:23], v[176:179], v[44:47], a[20:23]
    s_min_u32 s29, s29, s3
    v_exp_f32 v17, v109
    v_mfma_f32_16x16x32_bf16 a[68:71], v[164:167], v[40:43], a[68:71]
    ds_read_b128 v[48:51], v10 offset:1152
    v_cvt_pk_bf16_f32 v77, v18, v19
    v_mfma_f32_16x16x32_bf16 a[68:71], v[180:183], v[44:47], a[68:71]
    v_exp_f32 v18, v110
    v_mfma_f32_16x16x32_bf16 a[116:119], v[168:171], v[40:43], a[116:119]
    ds_read_b128 v[36:39], v21 offset:14592
    v_add_f32 v7, v7, v16
    v_mfma_f32_16x16x32_bf16 a[116:119], v[184:187], v[44:47], a[116:119]
    s_waitcnt vmcnt(27)
    v_add_f32 v7, v7, v17
    v_mfma_f32_16x16x32_bf16 a[164:167], v[172:175], v[40:43], a[164:167]
    s_sub_u32 s3, s29, s28
    v_exp_f32 v19, v111
    v_mfma_f32_16x16x32_bf16 a[164:167], v[188:191], v[44:47], a[164:167]
    s_waitcnt lgkmcnt(3)
    buffer_load_dwordx4 v8, s[4:7], s27 offen offset:0 sc1 lds
    v_mfma_f32_16x16x32_bf16 a[24:27], v[160:163], v[24:27], a[24:27]
    ds_read_b128 v[40:43], v22 offset:0
    v_cvt_pk_bf16_f32 v78, v16, v17
    v_mfma_f32_16x16x32_bf16 a[24:27], v[176:179], v[28:31], a[24:27]
    v_exp_f32 v16, v80
    v_mfma_f32_16x16x32_bf16 a[72:75], v[164:167], v[24:27], a[72:75]
    v_add_f32 v7, v7, v18
    v_add_f32 v7, v7, v19
    v_mfma_f32_16x16x32_bf16 a[72:75], v[180:183], v[28:31], a[72:75]
    v_exp_f32 v17, v81
    v_mfma_f32_16x16x32_bf16 a[120:123], v[168:171], v[24:27], a[120:123]
    ds_read_b128 v[44:47], v22 offset:12288
    v_cvt_pk_bf16_f32 v79, v18, v19
    v_mfma_f32_16x16x32_bf16 a[120:123], v[184:187], v[28:31], a[120:123]
    s_mov_b32 s28, s29
    v_exp_f32 v18, v82
    v_mfma_f32_16x16x32_bf16 a[168:171], v[172:175], v[24:27], a[168:171]
    v_add_f32 v4, v4, v16
    v_add_f32 v4, v4, v17
    v_mfma_f32_16x16x32_bf16 a[168:171], v[188:191], v[28:31], a[168:171]
    s_waitcnt lgkmcnt(2)
    v_exp_f32 v19, v83
    v_mfma_f32_16x16x32_bf16 a[28:31], v[160:163], v[32:35], a[28:31]
    ds_read_b128 v[24:27], v22 offset:768
    v_cvt_f32_i32 v240, v240
    v_mfma_f32_16x16x32_bf16 a[28:31], v[176:179], v[36:39], a[28:31]
    buffer_load_dwordx4 v8, s[4:7], s27 offen offset:1024 sc1 lds
    v_mfma_f32_16x16x32_bf16 a[76:79], v[164:167], v[32:35], a[76:79]
    v_cvt_pk_bf16_f32 v80, v16, v17
    v_cvt_f32_i32 v241, v241
    v_mfma_f32_16x16x32_bf16 a[76:79], v[180:183], v[36:39], a[76:79]
    v_exp_f32 v16, v112
    v_mfma_f32_16x16x32_bf16 a[124:127], v[168:171], v[32:35], a[124:127]
    ds_read_b128 v[28:31], v22 offset:13056
    v_add_f32 v4, v4, v18
    v_mfma_f32_16x16x32_bf16 a[124:127], v[184:187], v[36:39], a[124:127]
    v_add_f32 v4, v4, v19
    v_cvt_f32_i32 v244, v244
    v_mfma_f32_16x16x32_bf16 a[172:175], v[172:175], v[32:35], a[172:175]
    v_exp_f32 v17, v113
    v_mfma_f32_16x16x32_bf16 a[172:175], v[188:191], v[36:39], a[172:175]
    s_waitcnt lgkmcnt(2)
    v_cvt_pk_bf16_f32 v81, v18, v19
    v_add_u32 v2, s3, v2
    v_mfma_f32_16x16x32_bf16 a[32:35], v[160:163], v[40:43], a[32:35]
    ds_read_b128 v[32:35], v22 offset:1536
    v_mfma_f32_16x16x32_bf16 a[32:35], v[176:179], v[44:47], a[32:35]
    buffer_load_dwordx4 v8, s[4:7], s27 offen offset:2048 sc1 lds
    v_mfma_f32_16x16x32_bf16 a[80:83], v[164:167], v[40:43], a[80:83]
    v_exp_f32 v18, v114
    v_mfma_f32_16x16x32_bf16 a[80:83], v[180:183], v[44:47], a[80:83]
    v_add_f32 v4, v4, v16
    v_add_f32 v4, v4, v17
    v_mfma_f32_16x16x32_bf16 a[128:131], v[168:171], v[40:43], a[128:131]
    ds_read_b128 v[36:39], v22 offset:13824
    v_add_u32 v3, s3, v3
    v_mfma_f32_16x16x32_bf16 a[128:131], v[184:187], v[44:47], a[128:131]
    v_exp_f32 v19, v115
    v_mfma_f32_16x16x32_bf16 a[176:179], v[172:175], v[40:43], a[176:179]
    ds_read_b128 v[56:59], v23 offset:0
    v_cvt_pk_bf16_f32 v82, v16, v17
    v_mfma_f32_16x16x32_bf16 a[176:179], v[188:191], v[44:47], a[176:179]
    s_waitcnt lgkmcnt(3)
    v_exp_f32 v16, v84
    v_mfma_f32_16x16x32_bf16 a[36:39], v[160:163], v[24:27], a[36:39]
    ds_read_b128 v[40:43], v22 offset:2304
    v_add_f32 v4, v4, v18
    v_mfma_f32_16x16x32_bf16 a[36:39], v[176:179], v[28:31], a[36:39]
    v_add_f32 v4, v4, v19
    v_add_u32 v10, 1792, v10
    v_mfma_f32_16x16x32_bf16 a[84:87], v[164:167], v[24:27], a[84:87]
    v_exp_f32 v17, v85
    v_mfma_f32_16x16x32_bf16 a[84:87], v[180:183], v[28:31], a[84:87]
    s_add_u32 s27, s27, 24576
    v_cvt_pk_bf16_f32 v83, v18, v19
    v_cvt_f32_i32 v245, v245
    v_mfma_f32_16x16x32_bf16 a[132:135], v[168:171], v[24:27], a[132:135]
    s_add_u32 s56, s56, 36864
    ds_read_b128 v[44:47], v22 offset:14592
    v_mfma_f32_16x16x32_bf16 a[132:135], v[184:187], v[28:31], a[132:135]
    s_waitcnt lgkmcnt(3)
    v_exp_f32 v18, v86
    v_mfma_f32_16x16x32_bf16 a[180:183], v[172:175], v[24:27], a[180:183]
    s_waitcnt vmcnt(18)
    v_add_f32 v5, v5, v16
    v_add_f32 v5, v5, v17
    v_mfma_f32_16x16x32_bf16 a[180:183], v[188:191], v[28:31], a[180:183]
    s_barrier
    v_fma_f32 v240, v240, v60, v62
    v_mfma_f32_16x16x32_bf16 a[40:43], v[160:163], v[32:35], a[40:43]
    s_sub_u32 s58, s56, 147456
    ds_read_b128 v[24:27], v2 offset:0
    v_mfma_f32_16x16x32_bf16 a[40:43], v[176:179], v[36:39], a[40:43]
    v_exp_f32 v19, v87
    v_mfma_f32_16x16x32_bf16 a[88:91], v[164:167], v[32:35], a[88:91]
    s_min_u32 s56, s56, s58
    v_cvt_pk_bf16_f32 v84, v16, v17
    v_mfma_f32_16x16x32_bf16 a[88:91], v[180:183], v[36:39], a[88:91]
    v_exp_f32 v16, v116
    v_mfma_f32_16x16x32_bf16 a[136:139], v[168:171], v[32:35], a[136:139]
    ds_read_b128 v[28:31], v3 offset:0
    v_add_f32 v5, v5, v18
    v_mfma_f32_16x16x32_bf16 a[136:139], v[184:187], v[36:39], a[136:139]
    v_add_f32 v5, v5, v19
    v_fma_f32 v241, v241, v61, v63
    v_mfma_f32_16x16x32_bf16 a[184:187], v[172:175], v[32:35], a[184:187]
    v_exp_f32 v17, v117
    v_mfma_f32_16x16x32_bf16 a[184:187], v[188:191], v[36:39], a[184:187]
    s_waitcnt lgkmcnt(2)
    v_cvt_pk_bf16_f32 v85, v18, v19
    v_mfma_f32_16x16x32_bf16 a[44:47], v[160:163], v[40:43], a[44:47]
    ds_read_b128 v[32:35], v2 offset:6144
    v_fma_f32 v244, v244, v60, v62
    v_mfma_f32_16x16x32_bf16 a[44:47], v[176:179], v[44:47], a[44:47]
    v_exp_f32 v18, v118
    v_mfma_f32_16x16x32_bf16 a[92:95], v[164:167], v[40:43], a[92:95]
    v_add_f32 v5, v5, v16
    v_add_f32 v5, v5, v17
    v_mfma_f32_16x16x32_bf16 a[92:95], v[180:183], v[44:47], a[92:95]
    v_exp_f32 v19, v119
    v_mfma_f32_16x16x32_bf16 a[140:143], v[168:171], v[40:43], a[140:143]
    ds_read_b128 v[36:39], v3 offset:6144
    v_cvt_pk_bf16_f32 v86, v16, v17
    v_mfma_f32_16x16x32_bf16 a[140:143], v[184:187], v[44:47], a[140:143]
    v_add_f32 v5, v5, v18
    v_add_f32 v5, v5, v19
    v_mfma_f32_16x16x32_bf16 a[188:191], v[172:175], v[40:43], a[188:191]
    v_cvt_pk_bf16_f32 v87, v18, v19
    v_mfma_f32_16x16x32_bf16 a[188:191], v[188:191], v[44:47], a[188:191]
    s_waitcnt lgkmcnt(2)
    v_mfma_f32_16x16x32_bf16 v[160:163], v[24:27], a[192:195], v[128:131]
    s_mov_b32 m0, s26
    ds_read_b128 v[40:43], v2 offset:128
    v_fma_f32 v245, v245, v61, v63
    v_mfma_f32_16x16x32_bf16 v[160:163], v[28:31], a[196:199], v[160:163]
    v_exp_f32 v16, v88
    v_mfma_f32_16x16x32_bf16 v[164:167], v[24:27], a[216:219], v[132:135]
    v_exp_f32 v17, v89
    v_mfma_f32_16x16x32_bf16 v[164:167], v[28:31], a[220:223], v[164:167]
    v_bfe_u32 v53, v8, 4, 6
    v_cvt_pk_bf16_f32 v226, v240, v241
    v_mfma_f32_16x16x32_bf16 v[168:171], v[24:27], a[240:243], v[136:139]
    ds_read_b128 v[44:47], v3 offset:128
    v_lshlrev_b32 v53, 2, v53
    v_mfma_f32_16x16x32_bf16 v[168:171], v[28:31], a[244:247], v[168:171]
    buffer_load_dwordx4 v8, s[4:7], s32 offen offset:0 sc1 lds
    v_mfma_f32_16x16x32_bf16 v[172:175], v[24:27], v[200:203], v[140:143]
    v_exp_f32 v18, v90
    v_mfma_f32_16x16x32_bf16 v[172:175], v[28:31], v[204:207], v[172:175]
    s_waitcnt lgkmcnt(2)
    v_add_f32 v6, v6, v16
    v_add_f32 v6, v6, v17
    v_mfma_f32_16x16x32_bf16 v[96:99], v[32:35], a[192:195], v[128:131]
    ds_read_b128 v[24:27], v2 offset:6272
    v_cvt_pk_bf16_f32 v230, v244, v245
    v_mfma_f32_16x16x32_bf16 v[96:99], v[36:39], a[196:199], v[96:99]
    buffer_load_dword v52, v53, s[20:23], 0 offen sc1
    v_mfma_f32_16x16x32_bf16 v[100:103], v[32:35], a[216:219], v[132:135]
    v_exp_f32 v19, v91
    v_mfma_f32_16x16x32_bf16 v[100:103], v[36:39], a[220:223], v[100:103]
    v_cvt_pk_bf16_f32 v88, v16, v17
    v_mfma_f32_16x16x32_bf16 v[104:107], v[32:35], a[240:243], v[136:139]
    ds_read_b128 v[28:31], v3 offset:6272
    v_mfma_f32_16x16x32_bf16 v[104:107], v[36:39], a[244:247], v[104:107]
    v_exp_f32 v16, v120
    v_mfma_f32_16x16x32_bf16 v[108:111], v[32:35], v[200:203], v[140:143]
    v_add_f32 v6, v6, v18
    v_add_f32 v6, v6, v19
    v_mfma_f32_16x16x32_bf16 v[108:111], v[36:39], v[204:207], v[108:111]
    s_waitcnt lgkmcnt(2)
    buffer_load_dwordx4 v8, s[4:7], s32 offen offset:1024 sc1 lds
    v_mfma_f32_16x16x32_bf16 v[160:163], v[40:43], a[200:203], v[160:163]
    ds_read_b128 v[32:35], v2 offset:256
    v_cvt_f32_i32 v242, v242
    v_mfma_f32_16x16x32_bf16 v[160:163], v[44:47], a[204:207], v[160:163]
    v_exp_f32 v17, v121
    v_mfma_f32_16x16x32_bf16 v[164:167], v[40:43], a[224:227], v[164:167]
    v_cvt_pk_bf16_f32 v89, v18, v19
    v_cvt_f32_i32 v243, v243
    v_mfma_f32_16x16x32_bf16 v[164:167], v[44:47], a[228:231], v[164:167]
    v_exp_f32 v18, v122
    v_mfma_f32_16x16x32_bf16 v[168:171], v[40:43], a[248:251], v[168:171]
    ds_read_b128 v[36:39], v3 offset:256
    v_add_f32 v6, v6, v16
    v_mfma_f32_16x16x32_bf16 v[168:171], v[44:47], a[252:255], v[168:171]
    v_add_f32 v6, v6, v17
    v_mfma_f32_16x16x32_bf16 v[172:175], v[40:43], v[208:211], v[172:175]
    v_exp_f32 v19, v123
    v_mfma_f32_16x16x32_bf16 v[172:175], v[44:47], v[212:215], v[172:175]
    s_waitcnt lgkmcnt(2)
    buffer_load_dwordx4 v8, s[4:7], s32 offen offset:2048 sc1 lds
    v_mfma_f32_16x16x32_bf16 v[96:99], v[24:27], a[200:203], v[96:99]
    ds_read_b128 v[40:43], v2 offset:6400
    v_cvt_pk_bf16_f32 v90, v16, v17
    v_mfma_f32_16x16x32_bf16 v[96:99], v[28:31], a[204:207], v[96:99]
    v_exp_f32 v16, v92
    v_mfma_f32_16x16x32_bf16 v[100:103], v[24:27], a[224:227], v[100:103]
    v_add_f32 v6, v6, v18
    v_add_f32 v6, v6, v19
    v_mfma_f32_16x16x32_bf16 v[100:103], v[28:31], a[228:231], v[100:103]
    v_exp_f32 v17, v93
    v_mfma_f32_16x16x32_bf16 v[104:107], v[24:27], a[248:251], v[104:107]
    ds_read_b128 v[44:47], v3 offset:6400
    v_cvt_pk_bf16_f32 v91, v18, v19
    v_mfma_f32_16x16x32_bf16 v[104:107], v[28:31], a[252:255], v[104:107]
    v_exp_f32 v18, v94
    v_mfma_f32_16x16x32_bf16 v[108:111], v[24:27], v[208:211], v[108:111]
    s_add_u32 s29, s30, 49152
    v_cvt_f32_i32 v246, v246
    v_add_f32 v7, v7, v16
    v_mfma_f32_16x16x32_bf16 v[108:111], v[28:31], v[212:215], v[108:111]
    s_waitcnt lgkmcnt(2)
    v_add_f32 v7, v7, v17
    v_cvt_f32_i32 v247, v247
    v_mfma_f32_16x16x32_bf16 v[160:163], v[32:35], a[208:211], v[160:163]
    s_add_u32 s32, s32, 24576
    ds_read_b128 v[24:27], v2 offset:12288
    s_sub_u32 s3, s29, 147456
    v_mfma_f32_16x16x32_bf16 v[160:163], v[36:39], a[212:215], v[160:163]
    v_exp_f32 v19, v95
    v_mfma_f32_16x16x32_bf16 v[164:167], v[32:35], a[232:235], v[164:167]
    v_cvt_pk_bf16_f32 v92, v16, v17
    v_fma_f32 v242, v242, v48, v50
    v_mfma_f32_16x16x32_bf16 v[164:167], v[36:39], a[236:239], v[164:167]
    s_add_u32 s26, s26, 12288
    v_exp_f32 v16, v124
    v_mfma_f32_16x16x32_bf16 v[168:171], v[32:35], v[192:195], v[168:171]
    ds_read_b128 v[28:31], v3 offset:12288
    v_add_f32 v7, v7, v18
    v_mfma_f32_16x16x32_bf16 v[168:171], v[36:39], v[196:199], v[168:171]
    v_add_f32 v7, v7, v19
    v_mfma_f32_16x16x32_bf16 v[172:175], v[32:35], v[216:219], v[172:175]
    s_min_u32 s29, s29, s3
    v_mfma_f32_16x16x32_bf16 v[172:175], v[36:39], v[220:223], v[172:175]
    s_waitcnt lgkmcnt(2)
    v_exp_f32 v17, v125
    v_mfma_f32_16x16x32_bf16 v[96:99], v[40:43], a[208:211], v[96:99]
    s_mov_b32 m0, s26
    ds_read_b128 v[32:35], v2 offset:18432
    v_cvt_pk_bf16_f32 v93, v18, v19
    v_mfma_f32_16x16x32_bf16 v[96:99], v[44:47], a[212:215], v[96:99]
    v_exp_f32 v18, v126
    v_mfma_f32_16x16x32_bf16 v[100:103], v[40:43], a[232:235], v[100:103]
    v_fma_f32 v243, v243, v49, v51
    v_mfma_f32_16x16x32_bf16 v[100:103], v[44:47], a[236:239], v[100:103]
    v_add_f32 v7, v7, v16
    v_mfma_f32_16x16x32_bf16 v[104:107], v[40:43], v[192:195], v[104:107]
    s_sub_u32 s3, s29, s30
    ds_read_b128 v[36:39], v3 offset:18432
    v_add_f32 v7, v7, v17
    v_mfma_f32_16x16x32_bf16 v[104:107], v[44:47], v[196:199], v[104:107]
    v_exp_f32 v19, v127
    v_mfma_f32_16x16x32_bf16 v[108:111], v[40:43], v[216:219], v[108:111]
    v_fma_f32 v246, v246, v48, v50
    v_cvt_pk_bf16_f32 v94, v16, v17
    v_mfma_f32_16x16x32_bf16 v[108:111], v[44:47], v[220:223], v[108:111]
    s_waitcnt lgkmcnt(2)
    buffer_load_dwordx4 v8, s[4:7], s32 offen offset:0 sc1 lds
    v_mfma_f32_16x16x32_bf16 v[176:179], v[24:27], a[192:195], v[128:131]
    ds_read_b128 v[40:43], v2 offset:12416
    v_add_f32 v7, v7, v18
    v_mfma_f32_16x16x32_bf16 v[176:179], v[28:31], a[196:199], v[176:179]
    v_add_f32 v7, v7, v19
    v_cvt_pk_bf16_f32 v95, v18, v19
    v_mfma_f32_16x16x32_bf16 v[180:183], v[24:27], a[216:219], v[132:135]
    s_mov_b32 s30, s29
    v_fma_f32 v247, v247, v49, v51
    v_mfma_f32_16x16x32_bf16 v[180:183], v[28:31], a[220:223], v[180:183]
    v_mfma_f32_16x16x32_bf16 v[184:187], v[24:27], a[240:243], v[136:139]
    ds_read_b128 v[44:47], v3 offset:12416
    v_mfma_f32_16x16x32_bf16 v[184:187], v[28:31], a[244:247], v[184:187]
    v_exp_f32 v16, v160
    v_mfma_f32_16x16x32_bf16 v[188:191], v[24:27], v[200:203], v[140:143]
    v_exp_f32 v17, v161
    v_mfma_f32_16x16x32_bf16 v[188:191], v[28:31], v[204:207], v[188:191]
    s_waitcnt lgkmcnt(2)
    v_exp_f32 v18, v162
    v_mfma_f32_16x16x32_bf16 v[112:115], v[32:35], a[192:195], v[128:131]
    ds_read_b128 v[24:27], v2 offset:18560
    v_add_f32 v4, v4, v16
    v_mfma_f32_16x16x32_bf16 v[112:115], v[36:39], a[196:199], v[112:115]
    buffer_load_dwordx4 v8, s[4:7], s32 offen offset:1024 sc1 lds
    v_mfma_f32_16x16x32_bf16 v[116:119], v[32:35], a[216:219], v[132:135]
    v_add_f32 v4, v4, v17
    v_cvt_pk_bf16_f32 v227, v242, v243
    v_mfma_f32_16x16x32_bf16 v[116:119], v[36:39], a[220:223], v[116:119]
    v_exp_f32 v19, v163
    v_mfma_f32_16x16x32_bf16 v[120:123], v[32:35], a[240:243], v[136:139]
    ds_read_b128 v[28:31], v3 offset:18560
    v_cvt_pk_bf16_f32 v160, v16, v17
    v_mfma_f32_16x16x32_bf16 v[120:123], v[36:39], a[244:247], v[120:123]
    buffer_load_dword v0, v8, s[88:91], s93 offen
    v_mfma_f32_16x16x32_bf16 v[124:127], v[32:35], v[200:203], v[140:143]
    v_exp_f32 v16, v96
    v_mfma_f32_16x16x32_bf16 v[124:127], v[36:39], v[204:207], v[124:127]
    s_waitcnt lgkmcnt(2)
    v_add_f32 v4, v4, v18
    v_add_f32 v4, v4, v19
    v_mfma_f32_16x16x32_bf16 v[176:179], v[40:43], a[200:203], v[176:179]
    ds_read_b128 v[32:35], v2 offset:12544
    v_add_u32 v1, s3, v1
    v_mfma_f32_16x16x32_bf16 v[176:179], v[44:47], a[204:207], v[176:179]
    buffer_load_dwordx4 v8, s[4:7], s32 offen offset:2048 sc1 lds
    v_mfma_f32_16x16x32_bf16 v[180:183], v[40:43], a[224:227], v[180:183]
    v_exp_f32 v17, v97
    v_mfma_f32_16x16x32_bf16 v[180:183], v[44:47], a[228:231], v[180:183]
    v_cvt_pk_bf16_f32 v161, v18, v19
    v_add_u32 v21, s3, v21
    v_mfma_f32_16x16x32_bf16 v[184:187], v[40:43], a[248:251], v[184:187]
    ds_read_b128 v[36:39], v3 offset:12544
    v_cvt_pk_bf16_f32 v231, v246, v247
    v_mfma_f32_16x16x32_bf16 v[184:187], v[44:47], a[252:255], v[184:187]
    s_waitcnt vmcnt(25)
    v_exp_f32 v18, v98
    v_mfma_f32_16x16x32_bf16 v[188:191], v[40:43], v[208:211], v[188:191]
    v_add_f32 v4, v4, v16
    v_add_f32 v4, v4, v17
    v_mfma_f32_16x16x32_bf16 v[188:191], v[44:47], v[212:215], v[188:191]
    s_waitcnt lgkmcnt(2)
    v_exp_f32 v19, v99
    s_branch L_skip10
L_pad10:
    s_branch L_tb1_4
L_skip10:
    v_mfma_f32_16x16x32_bf16 v[112:115], v[24:27], a[200:203], v[112:115]
    ds_read_b128 v[40:43], v2 offset:18688
    v_cvt_pk_bf16_f32 v162, v16, v17
    v_mfma_f32_16x16x32_bf16 v[112:115], v[28:31], a[204:207], v[112:115]
    v_exp_f32 v16, v164
    v_mfma_f32_16x16x32_bf16 v[116:119], v[24:27], a[224:227], v[116:119]
    v_add_f32 v4, v4, v18
    v_add_u32 v22, s3, v22
    v_mfma_f32_16x16x32_bf16 v[116:119], v[28:31], a[228:231], v[116:119]
    s_add_u32 s32, s32, 24576
    v_add_f32 v4, v4, v19
    v_cvt_f32_i32 v248, v248
    v_mfma_f32_16x16x32_bf16 v[120:123], v[24:27], a[248:251], v[120:123]
    s_add_u32 s26, s26, 36864
    ds_read_b128 v[44:47], v3 offset:18688
    v_mfma_f32_16x16x32_bf16 v[120:123], v[28:31], a[252:255], v[120:123]
    s_waitcnt lgkmcnt(2)
    v_exp_f32 v17, v165
    v_mfma_f32_16x16x32_bf16 v[124:127], v[24:27], v[208:211], v[124:127]
    s_waitcnt vmcnt(18)
    v_cvt_pk_bf16_f32 v163, v18, v19
    v_cvt_f32_i32 v249, v249
    v_mfma_f32_16x16x32_bf16 v[124:127], v[28:31], v[212:215], v[124:127]
    s_barrier
    s_sub_u32 s57, s26, 147456
    v_mfma_f32_16x16x32_bf16 v[176:179], v[32:35], a[208:211], v[176:179]
    ds_read_b128 v[24:27], v1 offset:0
    v_mfma_f32_16x16x32_bf16 v[176:179], v[36:39], a[212:215], v[176:179]
    v_exp_f32 v18, v166
    v_mfma_f32_16x16x32_bf16 v[180:183], v[32:35], a[232:235], v[180:183]
    s_min_u32 s26, s26, s57
    v_add_f32 v5, v5, v16
    v_add_f32 v5, v5, v17
    v_mfma_f32_16x16x32_bf16 v[180:183], v[36:39], a[236:239], v[180:183]
    v_exp_f32 v19, v167
    v_mfma_f32_16x16x32_bf16 v[184:187], v[32:35], v[192:195], v[184:187]
    ds_read_b128 v[28:31], v1 offset:12288
    v_cvt_pk_bf16_f32 v164, v16, v17
    v_mfma_f32_16x16x32_bf16 v[184:187], v[36:39], v[196:199], v[184:187]
    v_exp_f32 v16, v100
    v_mfma_f32_16x16x32_bf16 v[188:191], v[32:35], v[216:219], v[188:191]
    v_add_f32 v5, v5, v18
    v_add_f32 v5, v5, v19
    v_mfma_f32_16x16x32_bf16 v[188:191], v[36:39], v[220:223], v[188:191]
    s_waitcnt lgkmcnt(2)
    v_exp_f32 v17, v101
    v_mfma_f32_16x16x32_bf16 v[112:115], v[40:43], a[208:211], v[112:115]
    ds_read_b128 v[32:35], v1 offset:768
    v_cvt_pk_bf16_f32 v165, v18, v19
    v_mfma_f32_16x16x32_bf16 v[112:115], v[44:47], a[212:215], v[112:115]
    v_exp_f32 v18, v102
    v_mfma_f32_16x16x32_bf16 v[116:119], v[40:43], a[232:235], v[116:119]
    v_add_f32 v5, v5, v16
    v_cvt_f32_i32 v252, v252
    v_mfma_f32_16x16x32_bf16 v[116:119], v[44:47], a[236:239], v[116:119]
    v_add_f32 v5, v5, v17
    v_cvt_f32_i32 v253, v253
    v_mfma_f32_16x16x32_bf16 v[120:123], v[40:43], v[192:195], v[120:123]
    ds_read_b128 v[36:39], v1 offset:13056
    v_mfma_f32_16x16x32_bf16 v[120:123], v[44:47], v[196:199], v[120:123]
    v_exp_f32 v19, v103
    v_mfma_f32_16x16x32_bf16 v[124:127], v[40:43], v[216:219], v[124:127]
    v_cvt_pk_bf16_f32 v166, v16, v17
    v_add_f32 v5, v5, v18
    v_mfma_f32_16x16x32_bf16 v[124:127], v[44:47], v[220:223], v[124:127]
    s_waitcnt lgkmcnt(2)
    v_add_f32 v5, v5, v19
    v_cvt_pk_bf16_f32 v167, v18, v19
    v_mfma_f32_16x16x32_bf16 a[0:3], v[64:67], v[24:27], a[0:3]
    ds_read_b128 v[40:43], v1 offset:1536
    v_fma_f32 v248, v248, v60, v62
    v_mfma_f32_16x16x32_bf16 a[0:3], v[80:83], v[28:31], a[0:3]
    v_exp_f32 v16, v168
    v_mfma_f32_16x16x32_bf16 a[48:51], v[68:71], v[24:27], a[48:51]
    v_exp_f32 v17, v169
    v_mfma_f32_16x16x32_bf16 a[48:51], v[84:87], v[28:31], a[48:51]
    v_exp_f32 v18, v170
    v_mfma_f32_16x16x32_bf16 a[96:99], v[72:75], v[24:27], a[96:99]
    ds_read_b128 v[44:47], v1 offset:13824
    v_fma_f32 v249, v249, v61, v63
    v_mfma_f32_16x16x32_bf16 a[96:99], v[88:91], v[28:31], a[96:99]
    v_add_f32 v6, v6, v16
    v_add_f32 v6, v6, v17
    v_mfma_f32_16x16x32_bf16 a[144:147], v[76:79], v[24:27], a[144:147]
    v_exp_f32 v19, v171
    v_mfma_f32_16x16x32_bf16 a[144:147], v[92:95], v[28:31], a[144:147]
    s_waitcnt lgkmcnt(2)
    v_mfma_f32_16x16x32_bf16 a[4:7], v[64:67], v[32:35], a[4:7]
    ds_read_b128 v[24:27], v1 offset:2304
    v_cvt_pk_bf16_f32 v168, v16, v17
    v_mfma_f32_16x16x32_bf16 a[4:7], v[80:83], v[36:39], a[4:7]
    v_exp_f32 v16, v104
    v_mfma_f32_16x16x32_bf16 a[52:55], v[68:71], v[32:35], a[52:55]
    v_add_f32 v6, v6, v18
    v_fma_f32 v252, v252, v60, v62
    v_mfma_f32_16x16x32_bf16 a[52:55], v[84:87], v[36:39], a[52:55]
    v_add_f32 v6, v6, v19
    v_mfma_f32_16x16x32_bf16 a[100:103], v[72:75], v[32:35], a[100:103]
    ds_read_b128 v[28:31], v1 offset:14592
    v_mfma_f32_16x16x32_bf16 a[100:103], v[88:91], v[36:39], a[100:103]
    v_exp_f32 v17, v105
    v_mfma_f32_16x16x32_bf16 a[148:151], v[76:79], v[32:35], a[148:151]
    v_cvt_pk_bf16_f32 v169, v18, v19
    v_fma_f32 v253, v253, v61, v63
    v_mfma_f32_16x16x32_bf16 a[148:151], v[92:95], v[36:39], a[148:151]
    s_waitcnt lgkmcnt(2)
    v_exp_f32 v18, v106
    v_mfma_f32_16x16x32_bf16 a[8:11], v[64:67], v[40:43], a[8:11]
    ds_read_b128 v[32:35], v21 offset:0
    v_add_f32 v6, v6, v16
    v_mfma_f32_16x16x32_bf16 a[8:11], v[80:83], v[44:47], a[8:11]
    v_add_f32 v6, v6, v17
    v_mfma_f32_16x16x32_bf16 a[56:59], v[68:71], v[40:43], a[56:59]
    v_exp_f32 v19, v107
    v_mfma_f32_16x16x32_bf16 a[56:59], v[84:87], v[44:47], a[56:59]
    v_mfma_f32_16x16x32_bf16 a[104:107], v[72:75], v[40:43], a[104:107]
    ds_read_b128 v[36:39], v21 offset:12288
    v_cvt_pk_bf16_f32 v170, v16, v17
    v_mfma_f32_16x16x32_bf16 a[104:107], v[88:91], v[44:47], a[104:107]
    v_exp_f32 v16, v172
    v_mfma_f32_16x16x32_bf16 a[152:155], v[76:79], v[40:43], a[152:155]
    v_cvt_pk_bf16_f32 v234, v248, v249
    v_add_f32 v6, v6, v18
    v_mfma_f32_16x16x32_bf16 a[152:155], v[92:95], v[44:47], a[152:155]
    s_waitcnt lgkmcnt(2)
    v_add_f32 v6, v6, v19
    v_mfma_f32_16x16x32_bf16 a[12:15], v[64:67], v[24:27], a[12:15]
    ds_read_b128 v[40:43], v21 offset:768
    v_mfma_f32_16x16x32_bf16 a[12:15], v[80:83], v[28:31], a[12:15]
    v_exp_f32 v17, v173
    v_mfma_f32_16x16x32_bf16 a[60:63], v[68:71], v[24:27], a[60:63]
    v_cvt_pk_bf16_f32 v171, v18, v19
    v_cvt_pk_bf16_f32 v238, v252, v253
    v_mfma_f32_16x16x32_bf16 a[60:63], v[84:87], v[28:31], a[60:63]
    v_exp_f32 v18, v174
    v_mfma_f32_16x16x32_bf16 a[108:111], v[72:75], v[24:27], a[108:111]
    ds_read_b128 v[44:47], v21 offset:13056
    v_add_f32 v7, v7, v16
    v_mfma_f32_16x16x32_bf16 a[108:111], v[88:91], v[28:31], a[108:111]
    s_waitcnt vmcnt(6)
    v_subrev_u32 v52, s92, v52
    v_cmp_lt_u32 vcc, 15, v52
    v_mfma_f32_16x16x32_bf16 a[156:159], v[76:79], v[24:27], a[156:159]
    s_add_u32 s29, s28, 49152
    v_add_f32 v7, v7, v17
    v_mfma_f32_16x16x32_bf16 a[156:159], v[92:95], v[28:31], a[156:159]
    s_waitcnt lgkmcnt(2)
    v_exp_f32 v19, v175
    v_mfma_f32_16x16x32_bf16 a[16:19], v[64:67], v[32:35], a[16:19]
    s_and_b32 s59, vcc_lo, 0xff
    ds_read_b128 v[24:27], v21 offset:1536
    v_cvt_pk_bf16_f32 v172, v16, v17
    v_mfma_f32_16x16x32_bf16 a[16:19], v[80:83], v[36:39], a[16:19]
    s_cbranch_scc1 L_pollslow5
L_pollok5:
    v_mfma_f32_16x16x32_bf16 a[64:67], v[68:71], v[32:35], a[64:67]
    s_add_u32 s92, s92, 1
    v_exp_f32 v16, v108
    v_mfma_f32_16x16x32_bf16 a[64:67], v[84:87], v[36:39], a[64:67]
    s_sub_u32 s3, s29, 147456
    v_add_f32 v7, v7, v18
    v_add_f32 v7, v7, v19
    v_mfma_f32_16x16x32_bf16 a[112:115], v[72:75], v[32:35], a[112:115]
    s_mov_b32 m0, s56
    ds_read_b128 v[28:31], v21 offset:13824
    v_cvt_f32_i32 v250, v250
    v_mfma_f32_16x16x32_bf16 a[112:115], v[88:91], v[36:39], a[112:115]
    v_exp_f32 v17, v109
    v_mfma_f32_16x16x32_bf16 a[160:163], v[76:79], v[32:35], a[160:163]
    v_cvt_pk_bf16_f32 v173, v18, v19
    v_cvt_f32_i32 v251, v251
    v_mfma_f32_16x16x32_bf16 a[160:163], v[92:95], v[36:39], a[160:163]
    s_waitcnt lgkmcnt(2)
    buffer_load_dwordx4 v8, s[4:7], s27 offen offset:0 sc1 lds
    v_mfma_f32_16x16x32_bf16 a[20:23], v[64:67], v[40:43], a[20:23]
    s_min_u32 s29, s29, s3
    ds_read_b128 v[32:35], v21 offset:2304
    v_mfma_f32_16x16x32_bf16 a[20:23], v[80:83], v[44:47], a[20:23]
    v_exp_f32 v18, v110
    v_mfma_f32_16x16x32_bf16 a[68:71], v[68:71], v[40:43], a[68:71]
    v_add_f32 v7, v7, v16
    v_add_f32 v7, v7, v17
    v_mfma_f32_16x16x32_bf16 a[68:71], v[84:87], v[44:47], a[68:71]
    buffer_load_dwordx4 v8, s[4:7], s27 offen offset:1024 sc1 lds
    v_mfma_f32_16x16x32_bf16 a[116:119], v[72:75], v[40:43], a[116:119]
    ds_read_b128 v[36:39], v21 offset:14592
    v_cvt_f32_i32 v254, v254
    v_mfma_f32_16x16x32_bf16 a[116:119], v[88:91], v[44:47], a[116:119]
    v_exp_f32 v19, v111
    v_mfma_f32_16x16x32_bf16 a[164:167], v[76:79], v[40:43], a[164:167]
    s_sub_u32 s3, s29, s28
    v_cvt_pk_bf16_f32 v174, v16, v17
    v_mfma_f32_16x16x32_bf16 a[164:167], v[92:95], v[44:47], a[164:167]
    s_waitcnt lgkmcnt(2)
    v_exp_f32 v16, v176
    v_mfma_f32_16x16x32_bf16 a[24:27], v[64:67], v[24:27], a[24:27]
    ds_read_b128 v[40:43], v22 offset:0
    v_add_f32 v7, v7, v18
    v_mfma_f32_16x16x32_bf16 a[24:27], v[80:83], v[28:31], a[24:27]
    buffer_load_dwordx4 v8, s[4:7], s27 offen offset:2048 sc1 lds
    v_mfma_f32_16x16x32_bf16 a[72:75], v[68:71], v[24:27], a[72:75]
    v_add_f32 v7, v7, v19
    v_cvt_f32_i32 v255, v255
    v_mfma_f32_16x16x32_bf16 a[72:75], v[84:87], v[28:31], a[72:75]
    v_exp_f32 v17, v177
    v_mfma_f32_16x16x32_bf16 a[120:123], v[72:75], v[24:27], a[120:123]
    s_add_u32 s27, s27, 24576
    ds_read_b128 v[44:47], v22 offset:12288
    v_cvt_pk_bf16_f32 v175, v18, v19
    v_mfma_f32_16x16x32_bf16 a[120:123], v[88:91], v[28:31], a[120:123]
    s_mov_b32 s28, s29
    v_exp_f32 v18, v178
    v_mfma_f32_16x16x32_bf16 a[168:171], v[76:79], v[24:27], a[168:171]
    v_add_f32 v4, v4, v16
    v_add_f32 v4, v4, v17
    v_mfma_f32_16x16x32_bf16 a[168:171], v[92:95], v[28:31], a[168:171]
    s_waitcnt lgkmcnt(2)
    v_exp_f32 v19, v179
    v_mfma_f32_16x16x32_bf16 a[28:31], v[64:67], v[32:35], a[28:31]
    s_add_u32 s56, s56, 12288
    ds_read_b128 v[24:27], v22 offset:768
    v_cvt_pk_bf16_f32 v176, v16, v17
    v_mfma_f32_16x16x32_bf16 a[28:31], v[80:83], v[36:39], a[28:31]
    s_mov_b32 m0, s56
    v_exp_f32 v16, v112
    v_mfma_f32_16x16x32_bf16 a[76:79], v[68:71], v[32:35], a[76:79]
    v_fma_f32 v250, v250, v48, v50
    v_add_f32 v4, v4, v18
    v_mfma_f32_16x16x32_bf16 a[76:79], v[84:87], v[36:39], a[76:79]
    v_add_f32 v4, v4, v19
    v_mfma_f32_16x16x32_bf16 a[124:127], v[72:75], v[32:35], a[124:127]
    ds_read_b128 v[28:31], v22 offset:13056
    v_add_u32 v2, s3, v2
    v_mfma_f32_16x16x32_bf16 a[124:127], v[88:91], v[36:39], a[124:127]
    buffer_load_dwordx4 v8, s[4:7], s27 offen offset:0 sc1 lds
    v_mfma_f32_16x16x32_bf16 a[172:175], v[76:79], v[32:35], a[172:175]
    v_exp_f32 v17, v113
    v_mfma_f32_16x16x32_bf16 a[172:175], v[92:95], v[36:39], a[172:175]
    s_waitcnt lgkmcnt(2)
    v_cvt_pk_bf16_f32 v177, v18, v19
    v_fma_f32 v251, v251, v49, v51
    v_mfma_f32_16x16x32_bf16 a[32:35], v[64:67], v[40:43], a[32:35]
    ds_read_b128 v[32:35], v22 offset:1536
    v_mfma_f32_16x16x32_bf16 a[32:35], v[80:83], v[44:47], a[32:35]
    v_exp_f32 v18, v114
    v_mfma_f32_16x16x32_bf16 a[80:83], v[68:71], v[40:43], a[80:83]
    v_add_f32 v4, v4, v16
    v_add_f32 v4, v4, v17
    v_mfma_f32_16x16x32_bf16 a[80:83], v[84:87], v[44:47], a[80:83]
    buffer_load_dwordx4 v8, s[4:7], s27 offen offset:1024 sc1 lds
    v_mfma_f32_16x16x32_bf16 a[128:131], v[72:75], v[40:43], a[128:131]
    ds_read_b128 v[36:39], v22 offset:13824
    v_add_u32 v3, s3, v3
    v_mfma_f32_16x16x32_bf16 a[128:131], v[88:91], v[44:47], a[128:131]
    v_exp_f32 v19, v115
    v_mfma_f32_16x16x32_bf16 a[176:179], v[76:79], v[40:43], a[176:179]
    v_cvt_pk_bf16_f32 v178, v16, v17
    v_fma_f32 v254, v254, v48, v50
    v_mfma_f32_16x16x32_bf16 a[176:179], v[92:95], v[44:47], a[176:179]
    s_waitcnt lgkmcnt(2)
    buffer_load_dwordx4 v8, s[4:7], s27 offen offset:2048 sc1 lds
    v_mfma_f32_16x16x32_bf16 a[36:39], v[64:67], v[24:27], a[36:39]
    ds_read_b128 v[40:43], v22 offset:2304
    v_mfma_f32_16x16x32_bf16 a[36:39], v[80:83], v[28:31], a[36:39]
    v_exp_f32 v16, v180
    v_mfma_f32_16x16x32_bf16 a[84:87], v[68:71], v[24:27], a[84:87]
    v_add_f32 v4, v4, v18
    v_add_f32 v4, v4, v19
    v_mfma_f32_16x16x32_bf16 a[84:87], v[84:87], v[28:31], a[84:87]
    v_exp_f32 v17, v181
    v_mfma_f32_16x16x32_bf16 a[132:135], v[72:75], v[24:27], a[132:135]
    ds_read_b128 v[44:47], v22 offset:14592
    v_cvt_pk_bf16_f32 v179, v18, v19
    v_mfma_f32_16x16x32_bf16 a[132:135], v[88:91], v[28:31], a[132:135]
    s_waitcnt lgkmcnt(2)
    v_exp_f32 v18, v182
    v_mfma_f32_16x16x32_bf16 a[180:183], v[76:79], v[24:27], a[180:183]
    s_waitcnt vmcnt(18)
    v_add_f32 v5, v5, v16
    v_add_f32 v5, v5, v17
    v_mfma_f32_16x16x32_bf16 a[180:183], v[92:95], v[28:31], a[180:183]
    s_barrier
    s_add_u32 s27, s27, 24576
    v_mfma_f32_16x16x32_bf16 a[40:43], v[64:67], v[32:35], a[40:43]
    ds_read_b128 v[24:27], v2 offset:0
    v_fma_f32 v255, v255, v49, v51
    v_mfma_f32_16x16x32_bf16 a[40:43], v[80:83], v[36:39], a[40:43]
    s_add_u32 s56, s56, 36864
    buffer_load_dwordx4 v[240:243], v12, s[68:71], s36 offen offset:0 nt
    v_mfma_f32_16x16x32_bf16 a[88:91], v[68:71], v[32:35], a[88:91]
    s_sub_u32 s58, s56, 147456
    v_exp_f32 v19, v183
    v_mfma_f32_16x16x32_bf16 a[88:91], v[84:87], v[36:39], a[88:91]
    v_cvt_pk_bf16_f32 v180, v16, v17
    v_cvt_pk_bf16_f32 v235, v250, v251
    v_mfma_f32_16x16x32_bf16 a[136:139], v[72:75], v[32:35], a[136:139]
    s_min_u32 s56, s56, s58
    ds_read_b128 v[28:31], v3 offset:0
    v_mfma_f32_16x16x32_bf16 a[136:139], v[88:91], v[36:39], a[136:139]
    v_exp_f32 v16, v116
    v_mfma_f32_16x16x32_bf16 a[184:187], v[76:79], v[32:35], a[184:187]
    v_add_f32 v5, v5, v18
    v_add_f32 v5, v5, v19
    v_mfma_f32_16x16x32_bf16 a[184:187], v[92:95], v[36:39], a[184:187]
    s_waitcnt lgkmcnt(2)
    buffer_load_dwordx4 v[244:247], v12, s[68:71], s36 offen offset:768 nt
    v_mfma_f32_16x16x32_bf16 a[44:47], v[64:67], v[40:43], a[44:47]
    ds_read_b128 v[32:35], v2 offset:6144
    v_cvt_pk_bf16_f32 v239, v254, v255
    v_mfma_f32_16x16x32_bf16 a[44:47], v[80:83], v[44:47], a[44:47]
    v_exp_f32 v17, v117
    v_mfma_f32_16x16x32_bf16 a[92:95], v[68:71], v[40:43], a[92:95]
    v_cvt_pk_bf16_f32 v181, v18, v19
    v_mfma_f32_16x16x32_bf16 a[92:95], v[84:87], v[44:47], a[92:95]
    v_exp_f32 v18, v118
    v_mfma_f32_16x16x32_bf16 a[140:143], v[72:75], v[40:43], a[140:143]
    ds_read_b128 v[36:39], v3 offset:6144
    v_add_f32 v5, v5, v16
    v_mfma_f32_16x16x32_bf16 a[140:143], v[88:91], v[44:47], a[140:143]
    v_add_f32 v5, v5, v17
    v_mfma_f32_16x16x32_bf16 a[188:191], v[76:79], v[40:43], a[188:191]
    v_exp_f32 v19, v119
    v_mfma_f32_16x16x32_bf16 a[188:191], v[92:95], v[44:47], a[188:191]
    s_waitcnt lgkmcnt(2)
    v_cvt_pk_bf16_f32 v182, v16, v17
    v_add_f32 v5, v5, v18
    v_add_f32 v5, v5, v19
    v_cvt_pk_bf16_f32 v183, v18, v19
L_join:
    v_mfma_f32_16x16x32_bf16 v[64:67], v[24:27], a[192:195], v[128:131]
    ds_read_b128 v[40:43], v2 offset:128
    v_mfma_f32_16x16x32_bf16 v[64:67], v[28:31], a[196:199], v[64:67]
    v_exp_f32 v16, v184
    v_mfma_f32_16x16x32_bf16 v[68:71], v[24:27], a[216:219], v[132:135]
    v_exp_f32 v17, v185
    v_mfma_f32_16x16x32_bf16 v[68:71], v[28:31], a[220:223], v[68:71]
    ds_read_b128 v[60:63], v23 offset:16
    s_waitcnt vmcnt(17)
    v_mfma_f32_16x16x32_bf16 v[72:75], v[24:27], a[240:243], v[136:139]
    ds_read_b128 v[44:47], v3 offset:128
    v_cvt_f32_i32 v144, v144
    v_mfma_f32_16x16x32_bf16 v[72:75], v[28:31], a[244:247], v[72:75]
    buffer_store_dwordx4 v[224:227], v11, s[4:7], s37 offen offset:0 sc1
    v_mfma_f32_16x16x32_bf16 v[76:79], v[24:27], v[200:203], v[140:143]
    v_exp_f32 v18, v186
    v_mfma_f32_16x16x32_bf16 v[76:79], v[28:31], v[204:207], v[76:79]
    s_waitcnt lgkmcnt(3)
    v_add_f32 v6, v6, v16
    v_add_f32 v6, v6, v17
    v_mfma_f32_16x16x32_bf16 v[96:99], v[32:35], a[192:195], v[128:131]
    ds_read_b128 v[24:27], v2 offset:6272
    v_cvt_f32_i32 v148, v148
    v_mfma_f32_16x16x32_bf16 v[96:99], v[36:39], a[196:199], v[96:99]
    v_exp_f32 v19, v187
    v_mfma_f32_16x16x32_bf16 v[100:103], v[32:35], a[216:219], v[132:135]
    s_mov_b32 m0, s26
    v_cvt_pk_bf16_f32 v184, v16, v17
    v_mfma_f32_16x16x32_bf16 v[100:103], v[36:39], a[220:223], v[100:103]
    v_exp_f32 v16, v120
    v_mfma_f32_16x16x32_bf16 v[104:107], v[32:35], a[240:243], v[136:139]
    ds_read_b128 v[28:31], v3 offset:6272
    v_add_f32 v6, v6, v18
    v_mfma_f32_16x16x32_bf16 v[104:107], v[36:39], a[244:247], v[104:107]
    v_add_f32 v6, v6, v19
    v_cvt_f32_i32 v145, v145
    v_mfma_f32_16x16x32_bf16 v[108:111], v[32:35], v[200:203], v[140:143]
    v_exp_f32 v17, v121
    v_mfma_f32_16x16x32_bf16 v[108:111], v[36:39], v[204:207], v[108:111]
    s_waitcnt lgkmcnt(2)
    buffer_load_dwordx4 v8, s[4:7], s32 offen offset:0 sc1 lds
    v_mfma_f32_16x16x32_bf16 v[64:67], v[40:43], a[200:203], v[64:67]
    ds_read_b128 v[32:35], v2 offset:256
    v_cvt_pk_bf16_f32 v185, v18, v19
    v_mfma_f32_16x16x32_bf16 v[64:67], v[44:47], a[204:207], v[64:67]
    v_exp_f32 v18, v122
    v_mfma_f32_16x16x32_bf16 v[68:71], v[40:43], a[224:227], v[68:71]
    ds_read_b128 v[48:51], v23 offset:32
    v_add_f32 v6, v6, v16
    v_mfma_f32_16x16x32_bf16 v[68:71], v[44:47], a[228:231], v[68:71]
    v_add_f32 v6, v6, v17
    v_cvt_f32_i32 v149, v149
    v_mfma_f32_16x16x32_bf16 v[72:75], v[40:43], a[248:251], v[72:75]
    ds_read_b128 v[36:39], v3 offset:256
    v_fma_f32 v144, v144, v56, v58
    v_mfma_f32_16x16x32_bf16 v[72:75], v[44:47], a[252:255], v[72:75]
    buffer_store_dwordx4 v[228:231], v54, s[4:7], s37 offen offset:768 sc1
    v_mfma_f32_16x16x32_bf16 v[76:79], v[40:43], v[208:211], v[76:79]
    v_exp_f32 v19, v123
    v_mfma_f32_16x16x32_bf16 v[76:79], v[44:47], v[212:215], v[76:79]
    s_waitcnt lgkmcnt(3)
    v_cvt_pk_bf16_f32 v186, v16, v17
    v_fma_f32 v148, v148, v57, v59
    v_mfma_f32_16x16x32_bf16 v[96:99], v[24:27], a[200:203], v[96:99]
    ds_read_b128 v[40:43], v2 offset:6400
    v_mfma_f32_16x16x32_bf16 v[96:99], v[28:31], a[204:207], v[96:99]
    buffer_load_dwordx4 v8, s[4:7], s32 offen offset:1024 sc1 lds
    v_mfma_f32_16x16x32_bf16 v[100:103], v[24:27], a[224:227], v[100:103]
    v_exp_f32 v16, v188
    v_mfma_f32_16x16x32_bf16 v[100:103], v[28:31], a[228:231], v[100:103]
    v_add_f32 v6, v6, v18
    v_add_f32 v6, v6, v19
    v_mfma_f32_16x16x32_bf16 v[104:107], v[24:27], a[248:251], v[104:107]
    ds_read_b128 v[44:47], v3 offset:6400
    v_fma_f32 v145, v145, v56, v58
    v_mfma_f32_16x16x32_bf16 v[104:107], v[28:31], a[252:255], v[104:107]
    v_exp_f32 v17, v189
    v_mfma_f32_16x16x32_bf16 v[108:111], v[24:27], v[208:211], v[108:111]
    s_add_u32 s29, s30, 49152
    v_cvt_pk_bf16_f32 v187, v18, v19
    v_fma_f32 v149, v149, v57, v59
    v_mfma_f32_16x16x32_bf16 v[108:111], v[28:31], v[212:215], v[108:111]
    s_waitcnt lgkmcnt(2)
    v_exp_f32 v18, v190
    v_mfma_f32_16x16x32_bf16 v[64:67], v[32:35], a[208:211], v[64:67]
    s_sub_u32 s3, s29, 147456
    ds_read_b128 v[24:27], v2 offset:12288
    v_add_f32 v7, v7, v16
    v_mfma_f32_16x16x32_bf16 v[64:67], v[36:39], a[212:215], v[64:67]
    v_add_f32 v7, v7, v17
    v_cvt_f32_i32 v146, v146
    v_mfma_f32_16x16x32_bf16 v[68:71], v[32:35], a[232:235], v[68:71]
    v_exp_f32 v19, v191
    v_mfma_f32_16x16x32_bf16 v[68:71], v[36:39], a[236:239], v[68:71]
    v_cvt_pk_bf16_f32 v188, v16, v17
    v_mfma_f32_16x16x32_bf16 v[72:75], v[32:35], v[192:195], v[72:75]
    ds_read_b128 v[28:31], v3 offset:12288
    v_cvt_f32_i32 v150, v150
    v_mfma_f32_16x16x32_bf16 v[72:75], v[36:39], v[196:199], v[72:75]
    buffer_store_dwordx4 v[232:235], v11, s[4:7], s80 offen offset:0 sc1
    v_mfma_f32_16x16x32_bf16 v[76:79], v[32:35], v[216:219], v[76:79]
    s_min_u32 s29, s29, s3
    v_exp_f32 v16, v124
    v_mfma_f32_16x16x32_bf16 v[76:79], v[36:39], v[220:223], v[76:79]
    s_waitcnt lgkmcnt(2)
    v_add_f32 v7, v7, v18
    v_add_f32 v7, v7, v19
    v_mfma_f32_16x16x32_bf16 v[96:99], v[40:43], a[208:211], v[96:99]
    ds_read_b128 v[32:35], v2 offset:18432
    v_cvt_f32_i32 v147, v147
    v_mfma_f32_16x16x32_bf16 v[96:99], v[44:47], a[212:215], v[96:99]
    buffer_load_dwordx4 v8, s[4:7], s32 offen offset:2048 sc1 lds
    v_mfma_f32_16x16x32_bf16 v[100:103], v[40:43], a[232:235], v[100:103]
    v_exp_f32 v17, v125
    v_mfma_f32_16x16x32_bf16 v[100:103], v[44:47], a[236:239], v[100:103]
    s_add_u32 s32, s32, 24576
    v_cvt_pk_bf16_f32 v189, v18, v19
    v_cvt_f32_i32 v151, v151
    v_mfma_f32_16x16x32_bf16 v[104:107], v[40:43], v[192:195], v[104:107]
    s_sub_u32 s3, s29, s30
    ds_read_b128 v[36:39], v3 offset:18432
    v_mfma_f32_16x16x32_bf16 v[104:107], v[44:47], v[196:199], v[104:107]
    v_exp_f32 v18, v126
    v_mfma_f32_16x16x32_bf16 v[108:111], v[40:43], v[216:219], v[108:111]
    v_add_f32 v7, v7, v16
    v_add_f32 v7, v7, v17
    v_mfma_f32_16x16x32_bf16 v[108:111], v[44:47], v[220:223], v[108:111]
    s_waitcnt lgkmcnt(2)
    v_exp_f32 v19, v127
    v_mfma_f32_16x16x32_bf16 v[80:83], v[24:27], a[192:195], v[128:131]
    s_add_u32 s26, s26, 12288
    ds_read_b128 v[40:43], v2 offset:12416
    v_cvt_pk_bf16_f32 v190, v16, v17
    v_mfma_f32_16x16x32_bf16 v[80:83], v[28:31], a[196:199], v[80:83]
    v_add_f32 v7, v7, v18
    v_add_f32 v7, v7, v19
    v_mfma_f32_16x16x32_bf16 v[84:87], v[24:27], a[216:219], v[132:135]
    s_mov_b32 s30, s29
    v_cvt_pk_bf16_f32 v191, v18, v19
    v_fma_f32 v146, v146, v56, v58
    v_mfma_f32_16x16x32_bf16 v[84:87], v[28:31], a[220:223], v[84:87]
    v_fma_f32 v150, v150, v57, v59
    v_mfma_f32_16x16x32_bf16 v[88:91], v[24:27], a[240:243], v[136:139]
    ds_read_b128 v[44:47], v3 offset:12416
    v_fma_f32 v147, v147, v56, v58
    v_mfma_f32_16x16x32_bf16 v[88:91], v[28:31], a[244:247], v[88:91]
    buffer_store_dwordx4 v[236:239], v54, s[4:7], s80 offen offset:768 sc1
    v_mfma_f32_16x16x32_bf16 v[92:95], v[24:27], v[200:203], v[140:143]
    s_mov_b32 m0, s26
    v_exp_f32 v16, v64
    v_mfma_f32_16x16x32_bf16 v[92:95], v[28:31], v[204:207], v[92:95]
    s_waitcnt lgkmcnt(2)
    v_exp_f32 v17, v65
    v_mfma_f32_16x16x32_bf16 v[112:115], v[32:35], a[192:195], v[128:131]
    ds_read_b128 v[24:27], v2 offset:18560
    v_fma_f32 v151, v151, v57, v59
    v_mfma_f32_16x16x32_bf16 v[112:115], v[36:39], a[196:199], v[112:115]
    v_exp_f32 v18, v66
    v_mfma_f32_16x16x32_bf16 v[116:119], v[32:35], a[216:219], v[132:135]
    v_add_f32 v4, v4, v16
    v_add_f32 v4, v4, v17
    v_mfma_f32_16x16x32_bf16 v[116:119], v[36:39], a[220:223], v[116:119]
    v_exp_f32 v19, v67
    v_mfma_f32_16x16x32_bf16 v[120:123], v[32:35], a[240:243], v[136:139]
    ds_read_b128 v[28:31], v3 offset:18560
    v_cvt_pk_bf16_f32 v64, v16, v17
    v_mfma_f32_16x16x32_bf16 v[120:123], v[36:39], a[244:247], v[120:123]
    buffer_load_dwordx4 v8, s[4:7], s32 offen offset:0 sc1 lds
    v_mfma_f32_16x16x32_bf16 v[124:127], v[32:35], v[200:203], v[140:143]
    v_exp_f32 v16, v96
    v_mfma_f32_16x16x32_bf16 v[124:127], v[36:39], v[204:207], v[124:127]
    s_waitcnt lgkmcnt(2)
    v_add_f32 v4, v4, v18
    v_add_f32 v4, v4, v19
    v_mfma_f32_16x16x32_bf16 v[80:83], v[40:43], a[200:203], v[80:83]
    ds_read_b128 v[32:35], v2 offset:12544
    v_add_u32 v1, s3, v1
    v_mfma_f32_16x16x32_bf16 v[80:83], v[44:47], a[204:207], v[80:83]
    v_exp_f32 v17, v97
    v_mfma_f32_16x16x32_bf16 v[84:87], v[40:43], a[224:227], v[84:87]
    ds_read_b128 v[56:59], v23 offset:48
    v_cvt_pk_bf16_f32 v65, v18, v19
    v_mfma_f32_16x16x32_bf16 v[84:87], v[44:47], a[228:231], v[84:87]
    s_waitcnt vmcnt(23)
    v_exp_f32 v18, v98
    v_mfma_f32_16x16x32_bf16 v[88:91], v[40:43], a[248:251], v[88:91]
    ds_read_b128 v[36:39], v3 offset:12544
    v_add_f32 v4, v4, v16
    v_mfma_f32_16x16x32_bf16 v[88:91], v[44:47], a[252:255], v[88:91]
    v_add_f32 v4, v4, v17
    v_add_u32 v21, s3, v21
    v_mfma_f32_16x16x32_bf16 v[92:95], v[40:43], v[208:211], v[92:95]
    v_exp_f32 v19, v99
    v_mfma_f32_16x16x32_bf16 v[92:95], v[44:47], v[212:215], v[92:95]
    s_waitcnt lgkmcnt(3)
    v_cvt_pk_bf16_f32 v66, v16, v17
    v_cvt_f32_i32 v152, v152
    v_mfma_f32_16x16x32_bf16 v[112:115], v[24:27], a[200:203], v[112:115]
    ds_read_b128 v[40:43], v2 offset:18688
    v_cvt_f32_i32 v156, v156
    v_mfma_f32_16x16x32_bf16 v[112:115], v[28:31], a[204:207], v[112:115]
    buffer_load_dwordx4 v8, s[4:7], s32 offen offset:1024 sc1 lds
    v_mfma_f32_16x16x32_bf16 v[116:119], v[24:27], a[224:227], v[116:119]
    v_exp_f32 v16, v68
    v_mfma_f32_16x16x32_bf16 v[116:119], v[28:31], a[228:231], v[116:119]
    v_add_f32 v4, v4, v18
    v_add_f32 v4, v4, v19
    v_mfma_f32_16x16x32_bf16 v[120:123], v[24:27], a[248:251], v[120:123]
    ds_read_b128 v[44:47], v3 offset:18688
    v_add_u32 v22, s3, v22
    v_mfma_f32_16x16x32_bf16 v[120:123], v[28:31], a[252:255], v[120:123]
    s_waitcnt lgkmcnt(2)
    v_exp_f32 v17, v69
    v_mfma_f32_16x16x32_bf16 v[124:127], v[24:27], v[208:211], v[124:127]
    s_waitcnt vmcnt(17)
    v_cvt_pk_bf16_f32 v67, v18, v19
    v_cvt_f32_i32 v153, v153
    v_mfma_f32_16x16x32_bf16 v[124:127], v[28:31], v[212:215], v[124:127]
    s_barrier
    v_add_u32 v23, 1792, v23
    v_mfma_f32_16x16x32_bf16 v[80:83], v[32:35], a[208:211], v[80:83]
    ds_read_b128 v[24:27], v1 offset:0
    v_cvt_f32_i32 v157, v157
    v_mfma_f32_16x16x32_bf16 v[80:83], v[36:39], a[212:215], v[80:83]
    v_exp_f32 v18, v70
    v_mfma_f32_16x16x32_bf16 v[84:87], v[32:35], a[232:235], v[84:87]
    v_add_f32 v5, v5, v16
    v_add_f32 v5, v5, v17
    v_mfma_f32_16x16x32_bf16 v[84:87], v[36:39], a[236:239], v[84:87]
    buffer_load_dwordx4 v8, s[4:7], s32 offen offset:2048 sc1 lds
    v_mfma_f32_16x16x32_bf16 v[88:91], v[32:35], v[192:195], v[88:91]
    ds_read_b128 v[28:31], v1 offset:12288
    v_fma_f32 v152, v152, v60, v62
    v_mfma_f32_16x16x32_bf16 v[88:91], v[36:39], v[196:199], v[88:91]
    v_exp_f32 v19, v71
    v_cvt_pk_bf16_f32 v68, v16, v17
    v_mfma_f32_16x16x32_bf16 v[92:95], v[32:35], v[216:219], v[92:95]
    v_exp_f32 v16, v100
    v_mfma_f32_16x16x32_bf16 v[92:95], v[36:39], v[220:223], v[92:95]
    s_waitcnt lgkmcnt(2)
    v_add_f32 v5, v5, v18
    v_add_f32 v5, v5, v19
    v_mfma_f32_16x16x32_bf16 v[112:115], v[40:43], a[208:211], v[112:115]
    ds_read_b128 v[32:35], v1 offset:768
    v_fma_f32 v156, v156, v61, v63
    v_mfma_f32_16x16x32_bf16 v[112:115], v[44:47], a[212:215], v[112:115]
    v_exp_f32 v17, v101
    v_mfma_f32_16x16x32_bf16 v[116:119], v[40:43], a[232:235], v[116:119]
    v_cvt_pk_bf16_f32 v69, v18, v19
    v_fma_f32 v153, v153, v60, v62
    v_mfma_f32_16x16x32_bf16 v[116:119], v[44:47], a[236:239], v[116:119]
    v_exp_f32 v18, v102
    v_mfma_f32_16x16x32_bf16 v[120:123], v[40:43], v[192:195], v[120:123]
    s_sub_u32 s31, s31, 1
    ds_read_b128 v[36:39], v1 offset:13056
    v_add_f32 v5, v5, v16
    v_mfma_f32_16x16x32_bf16 v[120:123], v[44:47], v[196:199], v[120:123]
    s_add_u32 s32, s32, 24576
    s_add_u32 s26, s26, 36864
    s_sub_u32 s57, s26, 147456
    s_min_u32 s26, s26, s57
    v_mfma_f32_16x16x32_bf16 v[124:127], v[40:43], v[216:219], v[124:127]
    s_waitcnt lgkmcnt(2)
    s_cmp_lg_u32 s31, 0
    v_add_f32 v5, v5, v17
    v_exp_f32 v19, v103
    v_cvt_pk_bf16_f32 v70, v16, v17
    v_add_f32 v5, v5, v18
    v_add_f32 v5, v5, v19
    v_cvt_pk_bf16_f32 v71, v18, v19
    v_fma_f32 v157, v157, v61, v63
    v_mfma_f32_16x16x32_bf16 v[124:127], v[44:47], v[220:223], v[124:127]
    s_cbranch_scc1 L_loop
    v_mfma_f32_16x16x32_bf16 a[0:3], v[160:163], v[24:27], a[0:3]
    ds_read_b128 v[40:43], v1 offset:1536
    v_cvt_f32_i32 v154, v154
    v_mfma_f32_16x16x32_bf16 a[0:3], v[176:179], v[28:31], a[0:3]
    buffer_load_dwordx4 v[248:251], v12, s[68:71], s36 offen offset:1536 nt
    v_mfma_f32_16x16x32_bf16 a[48:51], v[164:167], v[24:27], a[48:51]
    v_exp_f32 v16, v72
    v_mfma_f32_16x16x32_bf16 a[48:51], v[180:183], v[28:31], a[48:51]
    v_exp_f32 v17, v73
    v_mfma_f32_16x16x32_bf16 a[96:99], v[168:171], v[24:27], a[96:99]
    ds_read_b128 v[44:47], v1 offset:13824
    v_cvt_f32_i32 v158, v158
    v_mfma_f32_16x16x32_bf16 a[96:99], v[184:187], v[28:31], a[96:99]
    v_exp_f32 v18, v74
    v_mfma_f32_16x16x32_bf16 a[144:147], v[172:175], v[24:27], a[144:147]
    v_add_f32 v6, v6, v16
    v_add_f32 v6, v6, v17
    v_mfma_f32_16x16x32_bf16 a[144:147], v[188:191], v[28:31], a[144:147]
    s_waitcnt lgkmcnt(2)
    buffer_load_dwordx4 v[252:255], v12, s[68:71], s36 offen offset:2304 nt
    v_mfma_f32_16x16x32_bf16 a[4:7], v[160:163], v[32:35], a[4:7]
    ds_read_b128 v[24:27], v1 offset:2304
    v_cvt_f32_i32 v155, v155
    v_mfma_f32_16x16x32_bf16 a[4:7], v[176:179], v[36:39], a[4:7]
    v_exp_f32 v19, v75
    v_mfma_f32_16x16x32_bf16 a[52:55], v[164:167], v[32:35], a[52:55]
    v_cvt_pk_bf16_f32 v72, v16, v17
    v_cvt_f32_i32 v159, v159
    v_mfma_f32_16x16x32_bf16 a[52:55], v[180:183], v[36:39], a[52:55]
    v_exp_f32 v16, v104
    v_mfma_f32_16x16x32_bf16 a[100:103], v[168:171], v[32:35], a[100:103]
    ds_read_b128 v[28:31], v1 offset:14592
    v_add_f32 v6, v6, v18
    v_mfma_f32_16x16x32_bf16 a[100:103], v[184:187], v[36:39], a[100:103]
    v_add_f32 v6, v6, v19
    v_fma_f32 v154, v154, v60, v62
    s_branch L_skip11
L_pad11:
    s_branch L_tb1_3
L_skip11:
    v_mfma_f32_16x16x32_bf16 a[148:151], v[172:175], v[32:35], a[148:151]
    v_exp_f32 v17, v105
    v_mfma_f32_16x16x32_bf16 a[148:151], v[188:191], v[36:39], a[148:151]
    s_waitcnt lgkmcnt(2)
    v_cvt_pk_bf16_f32 v73, v18, v19
    v_fma_f32 v158, v158, v61, v63
    v_mfma_f32_16x16x32_bf16 a[8:11], v[160:163], v[40:43], a[8:11]
    ds_read_b128 v[32:35], v21 offset:0
    v_mfma_f32_16x16x32_bf16 a[8:11], v[176:179], v[44:47], a[8:11]
    v_exp_f32 v18, v106
    v_mfma_f32_16x16x32_bf16 a[56:59], v[164:167], v[40:43], a[56:59]
    v_add_f32 v6, v6, v16
    v_add_f32 v6, v6, v17
    v_mfma_f32_16x16x32_bf16 a[56:59], v[180:183], v[44:47], a[56:59]
    v_exp_f32 v19, v107
    v_mfma_f32_16x16x32_bf16 a[104:107], v[168:171], v[40:43], a[104:107]
    s_mov_b32 m0, s56
    ds_read_b128 v[36:39], v21 offset:12288
    v_cvt_pk_bf16_f32 v74, v16, v17
    v_mfma_f32_16x16x32_bf16 a[104:107], v[184:187], v[44:47], a[104:107]
    v_exp_f32 v16, v76
    v_mfma_f32_16x16x32_bf16 a[152:155], v[172:175], v[40:43], a[152:155]
    v_fma_f32 v155, v155, v60, v62
    v_fma_f32 v159, v159, v61, v63
    v_mfma_f32_16x16x32_bf16 a[152:155], v[188:191], v[44:47], a[152:155]
    s_waitcnt lgkmcnt(2)
    buffer_load_dwordx4 v8, s[4:7], s27 offen offset:0 sc1 lds
    v_mfma_f32_16x16x32_bf16 a[12:15], v[160:163], v[24:27], a[12:15]
    ds_read_b128 v[40:43], v21 offset:768
    v_add_f32 v6, v6, v18
    v_mfma_f32_16x16x32_bf16 a[12:15], v[176:179], v[28:31], a[12:15]
    v_add_f32 v6, v6, v19
    v_cvt_pk_bf16_f32 v144, v144, v148
    v_mfma_f32_16x16x32_bf16 a[60:63], v[164:167], v[24:27], a[60:63]
    v_exp_f32 v17, v77
    v_mfma_f32_16x16x32_bf16 a[60:63], v[180:183], v[28:31], a[60:63]
    v_cvt_pk_bf16_f32 v75, v18, v19
    v_mfma_f32_16x16x32_bf16 a[108:111], v[168:171], v[24:27], a[108:111]
    ds_read_b128 v[44:47], v21 offset:13056
    v_cvt_pk_bf16_f32 v148, v145, v149
    v_mfma_f32_16x16x32_bf16 a[108:111], v[184:187], v[28:31], a[108:111]
    v_exp_f32 v18, v78
    v_mfma_f32_16x16x32_bf16 a[156:159], v[172:175], v[24:27], a[156:159]
    s_add_u32 s29, s28, 49152
    v_add_f32 v7, v7, v16
    v_add_f32 v7, v7, v17
    v_mfma_f32_16x16x32_bf16 a[156:159], v[188:191], v[28:31], a[156:159]
    s_waitcnt lgkmcnt(2)
    buffer_load_dwordx4 v8, s[4:7], s27 offen offset:1024 sc1 lds
    v_mfma_f32_16x16x32_bf16 a[16:19], v[160:163], v[32:35], a[16:19]
    ds_read_b128 v[24:27], v21 offset:1536
    v_cvt_pk_bf16_f32 v145, v152, v156
    v_mfma_f32_16x16x32_bf16 a[16:19], v[176:179], v[36:39], a[16:19]
    s_sub_u32 s3, s29, 147456
    v_exp_f32 v19, v79
    v_mfma_f32_16x16x32_bf16 a[64:67], v[164:167], v[32:35], a[64:67]
    v_cvt_pk_bf16_f32 v76, v16, v17
    v_cvt_pk_bf16_f32 v149, v153, v157
    v_mfma_f32_16x16x32_bf16 a[64:67], v[180:183], v[36:39], a[64:67]
    v_exp_f32 v16, v108
    v_mfma_f32_16x16x32_bf16 a[112:115], v[168:171], v[32:35], a[112:115]
    ds_read_b128 v[28:31], v21 offset:13824
    v_add_f32 v7, v7, v18
    v_mfma_f32_16x16x32_bf16 a[112:115], v[184:187], v[36:39], a[112:115]
    buffer_load_dwordx4 v8, s[4:7], s27 offen offset:2048 sc1 lds
    v_mfma_f32_16x16x32_bf16 a[160:163], v[172:175], v[32:35], a[160:163]
    v_add_f32 v7, v7, v19
    v_cvt_pk_bf16_f32 v152, v146, v150
    v_mfma_f32_16x16x32_bf16 a[160:163], v[188:191], v[36:39], a[160:163]
    s_waitcnt lgkmcnt(2)
    v_exp_f32 v17, v109
    v_mfma_f32_16x16x32_bf16 a[20:23], v[160:163], v[40:43], a[20:23]
    s_min_u32 s29, s29, s3
    ds_read_b128 v[32:35], v21 offset:2304
    v_cvt_pk_bf16_f32 v77, v18, v19
    v_mfma_f32_16x16x32_bf16 a[20:23], v[176:179], v[44:47], a[20:23]
    v_exp_f32 v18, v110
    v_mfma_f32_16x16x32_bf16 a[68:71], v[164:167], v[40:43], a[68:71]
    s_add_u32 s27, s27, 24576
    v_add_f32 v7, v7, v16
    v_add_f32 v7, v7, v17
    v_mfma_f32_16x16x32_bf16 a[68:71], v[180:183], v[44:47], a[68:71]
    v_exp_f32 v19, v111
    v_mfma_f32_16x16x32_bf16 a[116:119], v[168:171], v[40:43], a[116:119]
    ds_read_b128 v[36:39], v21 offset:14592
    v_cvt_pk_bf16_f32 v153, v154, v158
    v_mfma_f32_16x16x32_bf16 a[116:119], v[184:187], v[44:47], a[116:119]
    s_add_u32 s56, s56, 12288
    v_cvt_pk_bf16_f32 v78, v16, v17
    v_cvt_pk_bf16_f32 v156, v147, v151
    v_mfma_f32_16x16x32_bf16 a[164:167], v[172:175], v[40:43], a[164:167]
    s_sub_u32 s3, s29, s28
    v_exp_f32 v16, v80
    v_mfma_f32_16x16x32_bf16 a[164:167], v[188:191], v[44:47], a[164:167]
    s_waitcnt lgkmcnt(2)
    v_add_f32 v7, v7, v18
    v_add_f32 v7, v7, v19
    v_mfma_f32_16x16x32_bf16 a[24:27], v[160:163], v[24:27], a[24:27]
    ds_read_b128 v[40:43], v22 offset:0
    v_cvt_pk_bf16_f32 v157, v155, v159
    v_mfma_f32_16x16x32_bf16 a[24:27], v[176:179], v[28:31], a[24:27]
    s_mov_b32 m0, s56
    v_exp_f32 v17, v81
    v_mfma_f32_16x16x32_bf16 a[72:75], v[164:167], v[24:27], a[72:75]
    v_cvt_pk_bf16_f32 v79, v18, v19
    v_mfma_f32_16x16x32_bf16 a[72:75], v[180:183], v[28:31], a[72:75]
    s_waitcnt vmcnt(15)
    v_exp_f32 v18, v82
    v_mfma_f32_16x16x32_bf16 a[120:123], v[168:171], v[24:27], a[120:123]
    ds_read_b128 v[44:47], v22 offset:12288
    v_add_f32 v4, v4, v16
    v_mfma_f32_16x16x32_bf16 a[120:123], v[184:187], v[28:31], a[120:123]
    s_mov_b32 s28, s29
    v_add_f32 v4, v4, v17
    v_mfma_f32_16x16x32_bf16 a[168:171], v[172:175], v[24:27], a[168:171]
    v_exp_f32 v19, v83
    v_mfma_f32_16x16x32_bf16 a[168:171], v[188:191], v[28:31], a[168:171]
    s_waitcnt lgkmcnt(2)
    buffer_load_dwordx4 v8, s[4:7], s27 offen offset:0 sc1 lds
    v_mfma_f32_16x16x32_bf16 a[28:31], v[160:163], v[32:35], a[28:31]
    ds_read_b128 v[24:27], v22 offset:768
    v_cvt_pk_bf16_f32 v80, v16, v17
    v_mfma_f32_16x16x32_bf16 a[28:31], v[176:179], v[36:39], a[28:31]
    v_exp_f32 v16, v112
    v_mfma_f32_16x16x32_bf16 a[76:79], v[164:167], v[32:35], a[76:79]
    v_cvt_f32_i32 v240, v240
    v_add_f32 v4, v4, v18
    v_mfma_f32_16x16x32_bf16 a[76:79], v[180:183], v[36:39], a[76:79]
    v_cvt_f32_i32 v244, v244
    v_add_f32 v4, v4, v19
    v_mfma_f32_16x16x32_bf16 a[124:127], v[168:171], v[32:35], a[124:127]
    ds_read_b128 v[28:31], v22 offset:13056
    v_add_u32 v2, s3, v2
    v_mfma_f32_16x16x32_bf16 a[124:127], v[184:187], v[36:39], a[124:127]
    buffer_load_dwordx4 v8, s[4:7], s27 offen offset:1024 sc1 lds
    v_mfma_f32_16x16x32_bf16 a[172:175], v[172:175], v[32:35], a[172:175]
    v_exp_f32 v17, v113
    v_mfma_f32_16x16x32_bf16 a[172:175], v[188:191], v[36:39], a[172:175]
    s_waitcnt lgkmcnt(2)
    v_cvt_pk_bf16_f32 v81, v18, v19
    v_cvt_f32_i32 v241, v241
    v_mfma_f32_16x16x32_bf16 a[32:35], v[160:163], v[40:43], a[32:35]
    ds_read_b128 v[32:35], v22 offset:1536
    v_cvt_f32_i32 v245, v245
    v_mfma_f32_16x16x32_bf16 a[32:35], v[176:179], v[44:47], a[32:35]
    v_exp_f32 v18, v114
    v_mfma_f32_16x16x32_bf16 a[80:83], v[164:167], v[40:43], a[80:83]
    v_add_f32 v4, v4, v16
    v_add_f32 v4, v4, v17
    v_mfma_f32_16x16x32_bf16 a[80:83], v[180:183], v[44:47], a[80:83]
    v_exp_f32 v19, v115
    v_mfma_f32_16x16x32_bf16 a[128:131], v[168:171], v[40:43], a[128:131]
    ds_read_b128 v[36:39], v22 offset:13824
    v_cvt_pk_bf16_f32 v82, v16, v17
    v_mfma_f32_16x16x32_bf16 a[128:131], v[184:187], v[44:47], a[128:131]
    buffer_load_dwordx4 v8, s[4:7], s27 offen offset:2048 sc1 lds
    v_mfma_f32_16x16x32_bf16 a[176:179], v[172:175], v[40:43], a[176:179]
    v_exp_f32 v16, v84
    v_mfma_f32_16x16x32_bf16 a[176:179], v[188:191], v[44:47], a[176:179]
    s_waitcnt lgkmcnt(2)
    v_add_f32 v4, v4, v18
    v_fma_f32 v240, v240, v48, v50
    v_mfma_f32_16x16x32_bf16 a[36:39], v[160:163], v[24:27], a[36:39]
    ds_read_b128 v[40:43], v22 offset:2304
    v_add_f32 v4, v4, v19
    v_mfma_f32_16x16x32_bf16 a[36:39], v[176:179], v[28:31], a[36:39]
    v_exp_f32 v17, v85
    v_mfma_f32_16x16x32_bf16 a[84:87], v[164:167], v[24:27], a[84:87]
    v_add_u32 v3, s3, v3
    v_fma_f32 v244, v244, v49, v51
    v_mfma_f32_16x16x32_bf16 a[84:87], v[180:183], v[28:31], a[84:87]
    s_add_u32 s27, s27, 24576
    v_cvt_pk_bf16_f32 v83, v18, v19
    v_fma_f32 v241, v241, v48, v50
    v_mfma_f32_16x16x32_bf16 a[132:135], v[168:171], v[24:27], a[132:135]
    s_add_u32 s56, s56, 36864
    ds_read_b128 v[44:47], v22 offset:14592
    v_mfma_f32_16x16x32_bf16 a[132:135], v[184:187], v[28:31], a[132:135]
    s_waitcnt lgkmcnt(2)
    v_exp_f32 v18, v86
    v_mfma_f32_16x16x32_bf16 a[180:183], v[172:175], v[24:27], a[180:183]
    s_waitcnt vmcnt(11)
    v_add_f32 v5, v5, v16
    v_add_f32 v5, v5, v17
    v_mfma_f32_16x16x32_bf16 a[180:183], v[188:191], v[28:31], a[180:183]
    s_barrier
    v_fma_f32 v245, v245, v49, v51
    v_mfma_f32_16x16x32_bf16 a[40:43], v[160:163], v[32:35], a[40:43]
    s_sub_u32 s58, s56, 147456
    ds_read_b128 v[24:27], v2 offset:0
    v_add_u32 v55, 1, v55
    v_mfma_f32_16x16x32_bf16 a[40:43], v[176:179], v[36:39], a[40:43]
    v_exp_f32 v19, v87
    v_mfma_f32_16x16x32_bf16 a[88:91], v[164:167], v[32:35], a[88:91]
    s_min_u32 s56, s56, s58
    v_cvt_pk_bf16_f32 v84, v16, v17
    v_cvt_f32_i32 v242, v242
    v_mfma_f32_16x16x32_bf16 a[88:91], v[180:183], v[36:39], a[88:91]
    v_exp_f32 v16, v116
    v_mfma_f32_16x16x32_bf16 a[136:139], v[168:171], v[32:35], a[136:139]
    ds_read_b128 v[28:31], v3 offset:0
    v_add_f32 v5, v5, v18
    v_mfma_f32_16x16x32_bf16 a[136:139], v[184:187], v[36:39], a[136:139]
    buffer_store_dword v55, v13, s[20:23], 0 offen sc1
    v_mfma_f32_16x16x32_bf16 a[184:187], v[172:175], v[32:35], a[184:187]
    v_add_f32 v5, v5, v19
    v_cvt_f32_i32 v246, v246
    v_mfma_f32_16x16x32_bf16 a[184:187], v[188:191], v[36:39], a[184:187]
    s_waitcnt lgkmcnt(2)
    v_exp_f32 v17, v117
    v_mfma_f32_16x16x32_bf16 a[44:47], v[160:163], v[40:43], a[44:47]
    ds_read_b128 v[32:35], v2 offset:6144
    v_cvt_pk_bf16_f32 v85, v18, v19
    v_mfma_f32_16x16x32_bf16 a[44:47], v[176:179], v[44:47], a[44:47]
    v_exp_f32 v18, v118
    v_mfma_f32_16x16x32_bf16 a[92:95], v[164:167], v[40:43], a[92:95]
    v_add_f32 v5, v5, v16
    v_add_f32 v5, v5, v17
    v_mfma_f32_16x16x32_bf16 a[92:95], v[180:183], v[44:47], a[92:95]
    v_exp_f32 v19, v119
    v_mfma_f32_16x16x32_bf16 a[140:143], v[168:171], v[40:43], a[140:143]
    ds_read_b128 v[36:39], v3 offset:6144
    v_cvt_f32_i32 v243, v243
    v_mfma_f32_16x16x32_bf16 a[140:143], v[184:187], v[44:47], a[140:143]
    v_cvt_pk_bf16_f32 v86, v16, v17
    v_add_f32 v5, v5, v18
    v_mfma_f32_16x16x32_bf16 a[188:191], v[172:175], v[40:43], a[188:191]
    v_add_f32 v5, v5, v19
    v_cvt_f32_i32 v247, v247
    v_mfma_f32_16x16x32_bf16 a[188:191], v[188:191], v[44:47], a[188:191]
    s_waitcnt lgkmcnt(2)
    v_cvt_pk_bf16_f32 v87, v18, v19
    v_mfma_f32_16x16x32_bf16 v[160:163], v[24:27], a[192:195], v[128:131]
    s_mov_b32 m0, s26
    ds_read_b128 v[40:43], v2 offset:128
    v_fma_f32 v242, v242, v48, v50
    v_mfma_f32_16x16x32_bf16 v[160:163], v[28:31], a[196:199], v[160:163]
    v_exp_f32 v16, v88
    v_mfma_f32_16x16x32_bf16 v[164:167], v[24:27], a[216:219], v[132:135]
    v_exp_f32 v17, v89
    v_mfma_f32_16x16x32_bf16 v[164:167], v[28:31], a[220:223], v[164:167]
    v_exp_f32 v18, v90
    v_mfma_f32_16x16x32_bf16 v[168:171], v[24:27], a[240:243], v[136:139]
    ds_read_b128 v[44:47], v3 offset:128
    v_fma_f32 v246, v246, v49, v51
    v_mfma_f32_16x16x32_bf16 v[168:171], v[28:31], a[244:247], v[168:171]
    buffer_load_dwordx4 v8, s[4:7], s32 offen offset:0 sc1 lds
    v_mfma_f32_16x16x32_bf16 v[172:175], v[24:27], v[200:203], v[140:143]
    v_add_f32 v6, v6, v16
    v_add_f32 v6, v6, v17
    v_mfma_f32_16x16x32_bf16 v[172:175], v[28:31], v[204:207], v[172:175]
    s_waitcnt lgkmcnt(2)
    v_exp_f32 v19, v91
    v_mfma_f32_16x16x32_bf16 v[96:99], v[32:35], a[192:195], v[128:131]
    ds_read_b128 v[24:27], v2 offset:6272
    v_fma_f32 v243, v243, v48, v50
    v_mfma_f32_16x16x32_bf16 v[96:99], v[36:39], a[196:199], v[96:99]
    v_cvt_pk_bf16_f32 v88, v16, v17
    v_fma_f32 v247, v247, v49, v51
    v_mfma_f32_16x16x32_bf16 v[100:103], v[32:35], a[216:219], v[132:135]
    v_exp_f32 v16, v120
    v_mfma_f32_16x16x32_bf16 v[100:103], v[36:39], a[220:223], v[100:103]
    v_add_f32 v6, v6, v18
    v_cvt_pk_bf16_f32 v146, v240, v244
    v_mfma_f32_16x16x32_bf16 v[104:107], v[32:35], a[240:243], v[136:139]
    ds_read_b128 v[28:31], v3 offset:6272
    v_add_f32 v6, v6, v19
    v_mfma_f32_16x16x32_bf16 v[104:107], v[36:39], a[244:247], v[104:107]
    buffer_load_dwordx4 v8, s[4:7], s32 offen offset:1024 sc1 lds
    v_mfma_f32_16x16x32_bf16 v[108:111], v[32:35], v[200:203], v[140:143]
    v_exp_f32 v17, v121
    v_mfma_f32_16x16x32_bf16 v[108:111], v[36:39], v[204:207], v[108:111]
    s_waitcnt lgkmcnt(2)
    v_cvt_pk_bf16_f32 v89, v18, v19
    v_cvt_pk_bf16_f32 v150, v241, v245
    v_mfma_f32_16x16x32_bf16 v[160:163], v[40:43], a[200:203], v[160:163]
    ds_read_b128 v[32:35], v2 offset:256
    v_mfma_f32_16x16x32_bf16 v[160:163], v[44:47], a[204:207], v[160:163]
    v_exp_f32 v18, v122
    v_mfma_f32_16x16x32_bf16 v[164:167], v[40:43], a[224:227], v[164:167]
    v_add_f32 v6, v6, v16
    v_add_f32 v6, v6, v17
    v_mfma_f32_16x16x32_bf16 v[164:167], v[44:47], a[228:231], v[164:167]
    v_cvt_pk_bf16_f32 v154, v242, v246
    v_mfma_f32_16x16x32_bf16 v[168:171], v[40:43], a[248:251], v[168:171]
    ds_read_b128 v[36:39], v3 offset:256
    v_mfma_f32_16x16x32_bf16 v[168:171], v[44:47], a[252:255], v[168:171]
    v_exp_f32 v19, v123
    v_mfma_f32_16x16x32_bf16 v[172:175], v[40:43], v[208:211], v[172:175]
    v_cvt_pk_bf16_f32 v90, v16, v17
    v_cvt_pk_bf16_f32 v158, v243, v247
    v_mfma_f32_16x16x32_bf16 v[172:175], v[44:47], v[212:215], v[172:175]
    s_waitcnt lgkmcnt(2)
    buffer_load_dwordx4 v8, s[4:7], s32 offen offset:2048 sc1 lds
    v_mfma_f32_16x16x32_bf16 v[96:99], v[24:27], a[200:203], v[96:99]
    s_waitcnt vmcnt(10)
    ds_read_b128 v[40:43], v2 offset:6400
    v_mfma_f32_16x16x32_bf16 v[96:99], v[28:31], a[204:207], v[96:99]
    v_exp_f32 v16, v92
    v_mfma_f32_16x16x32_bf16 v[100:103], v[24:27], a[224:227], v[100:103]
    v_add_f32 v6, v6, v18
    v_add_f32 v6, v6, v19
    v_mfma_f32_16x16x32_bf16 v[100:103], v[28:31], a[228:231], v[100:103]
    v_exp_f32 v17, v93
    v_mfma_f32_16x16x32_bf16 v[104:107], v[24:27], a[248:251], v[104:107]
    ds_read_b128 v[44:47], v3 offset:6400
    v_cvt_pk_bf16_f32 v91, v18, v19
    v_mfma_f32_16x16x32_bf16 v[104:107], v[28:31], a[252:255], v[104:107]
    s_add_u32 s32, s32, 24576
    v_exp_f32 v18, v94
    v_mfma_f32_16x16x32_bf16 v[108:111], v[24:27], v[208:211], v[108:111]
    s_add_u32 s29, s30, 49152
    v_cvt_f32_i32 v248, v248
    v_add_f32 v7, v7, v16
    v_mfma_f32_16x16x32_bf16 v[108:111], v[28:31], v[212:215], v[108:111]
    s_waitcnt lgkmcnt(2)
    v_add_f32 v7, v7, v17
    v_cvt_f32_i32 v252, v252
    v_mfma_f32_16x16x32_bf16 v[160:163], v[32:35], a[208:211], v[160:163]
    s_sub_u32 s3, s29, 147456
    ds_read_b128 v[24:27], v2 offset:12288
    v_mfma_f32_16x16x32_bf16 v[160:163], v[36:39], a[212:215], v[160:163]
    v_exp_f32 v19, v95
    v_mfma_f32_16x16x32_bf16 v[164:167], v[32:35], a[232:235], v[164:167]
    s_add_u32 s26, s26, 12288
    v_cvt_pk_bf16_f32 v92, v16, v17
    v_cvt_f32_i32 v249, v249
    v_mfma_f32_16x16x32_bf16 v[164:167], v[36:39], a[236:239], v[164:167]
    v_exp_f32 v16, v124
    v_mfma_f32_16x16x32_bf16 v[168:171], v[32:35], v[192:195], v[168:171]
    ds_read_b128 v[28:31], v3 offset:12288
    v_add_f32 v7, v7, v18
    v_mfma_f32_16x16x32_bf16 v[168:171], v[36:39], v[196:199], v[168:171]
    v_add_f32 v7, v7, v19
    v_mfma_f32_16x16x32_bf16 v[172:175], v[32:35], v[216:219], v[172:175]
    s_min_u32 s29, s29, s3
    v_cvt_f32_i32 v253, v253
    s_mov_b32 m0, s26
    v_mfma_f32_16x16x32_bf16 v[172:175], v[36:39], v[220:223], v[172:175]
    s_waitcnt lgkmcnt(2)
    v_exp_f32 v17, v125
    v_mfma_f32_16x16x32_bf16 v[96:99], v[40:43], a[208:211], v[96:99]
    ds_read_b128 v[32:35], v2 offset:18432
    v_cvt_pk_bf16_f32 v93, v18, v19
    v_mfma_f32_16x16x32_bf16 v[96:99], v[44:47], a[212:215], v[96:99]
    v_exp_f32 v18, v126
    v_mfma_f32_16x16x32_bf16 v[100:103], v[40:43], a[232:235], v[100:103]
    v_fma_f32 v248, v248, v56, v58
    v_mfma_f32_16x16x32_bf16 v[100:103], v[44:47], a[236:239], v[100:103]
    v_add_f32 v7, v7, v16
    v_mfma_f32_16x16x32_bf16 v[104:107], v[40:43], v[192:195], v[104:107]
    s_sub_u32 s3, s29, s30
    ds_read_b128 v[36:39], v3 offset:18432
    v_add_f32 v7, v7, v17
    v_mfma_f32_16x16x32_bf16 v[104:107], v[44:47], v[196:199], v[104:107]
    buffer_load_dwordx4 v8, s[4:7], s32 offen offset:0 sc1 lds
    v_mfma_f32_16x16x32_bf16 v[108:111], v[40:43], v[216:219], v[108:111]
    v_exp_f32 v19, v127
    v_mfma_f32_16x16x32_bf16 v[108:111], v[44:47], v[220:223], v[108:111]
    s_waitcnt lgkmcnt(2)
    v_cvt_pk_bf16_f32 v94, v16, v17
    v_fma_f32 v252, v252, v57, v59
    v_mfma_f32_16x16x32_bf16 v[176:179], v[24:27], a[192:195], v[128:131]
    ds_read_b128 v[40:43], v2 offset:12416
    v_add_f32 v7, v7, v18
    v_mfma_f32_16x16x32_bf16 v[176:179], v[28:31], a[196:199], v[176:179]
    v_add_f32 v7, v7, v19
    v_fma_f32 v249, v249, v56, v58
    v_mfma_f32_16x16x32_bf16 v[180:183], v[24:27], a[216:219], v[132:135]
    s_mov_b32 s30, s29
    v_cvt_pk_bf16_f32 v95, v18, v19
    v_mfma_f32_16x16x32_bf16 v[180:183], v[28:31], a[220:223], v[180:183]
    v_fma_f32 v253, v253, v57, v59
    v_mfma_f32_16x16x32_bf16 v[184:187], v[24:27], a[240:243], v[136:139]
    ds_read_b128 v[44:47], v3 offset:12416
    v_mfma_f32_16x16x32_bf16 v[184:187], v[28:31], a[244:247], v[184:187]
    v_exp_f32 v16, v160
    v_mfma_f32_16x16x32_bf16 v[188:191], v[24:27], v[200:203], v[140:143]
    v_exp_f32 v17, v161
    v_mfma_f32_16x16x32_bf16 v[188:191], v[28:31], v[204:207], v[188:191]
    s_waitcnt lgkmcnt(2)
    buffer_load_dwordx4 v8, s[4:7], s32 offen offset:1024 sc1 lds
    v_mfma_f32_16x16x32_bf16 v[112:115], v[32:35], a[192:195], v[128:131]
    ds_read_b128 v[24:27], v2 offset:18560
    v_cvt_f32_i32 v250, v250
    v_mfma_f32_16x16x32_bf16 v[112:115], v[36:39], a[196:199], v[112:115]
    v_exp_f32 v18, v162
    v_mfma_f32_16x16x32_bf16 v[116:119], v[32:35], a[216:219], v[132:135]
    v_add_f32 v4, v4, v16
    v_add_f32 v4, v4, v17
    v_mfma_f32_16x16x32_bf16 v[116:119], v[36:39], a[220:223], v[116:119]
    v_exp_f32 v19, v163
    v_mfma_f32_16x16x32_bf16 v[120:123], v[32:35], a[240:243], v[136:139]
    ds_read_b128 v[28:31], v3 offset:18560
    v_cvt_pk_bf16_f32 v160, v16, v17
    v_mfma_f32_16x16x32_bf16 v[120:123], v[36:39], a[244:247], v[120:123]
    v_exp_f32 v16, v96
    v_mfma_f32_16x16x32_bf16 v[124:127], v[32:35], v[200:203], v[140:143]
    v_cvt_f32_i32 v254, v254
    v_add_f32 v4, v4, v18
    v_mfma_f32_16x16x32_bf16 v[124:127], v[36:39], v[204:207], v[124:127]
    s_waitcnt lgkmcnt(2)
    buffer_load_dwordx4 v8, s[4:7], s32 offen offset:2048 sc1 lds
    v_mfma_f32_16x16x32_bf16 v[176:179], v[40:43], a[200:203], v[176:179]
    ds_read_b128 v[32:35], v2 offset:12544
    v_add_f32 v4, v4, v19
    v_mfma_f32_16x16x32_bf16 v[176:179], v[44:47], a[204:207], v[176:179]
    v_exp_f32 v17, v97
    v_mfma_f32_16x16x32_bf16 v[180:183], v[40:43], a[224:227], v[180:183]
    v_add_u32 v1, s3, v1
    v_cvt_pk_bf16_f32 v161, v18, v19
    v_mfma_f32_16x16x32_bf16 v[180:183], v[44:47], a[228:231], v[180:183]
    v_exp_f32 v18, v98
    v_mfma_f32_16x16x32_bf16 v[184:187], v[40:43], a[248:251], v[184:187]
    ds_read_b128 v[36:39], v3 offset:12544
    v_cvt_f32_i32 v251, v251
    v_mfma_f32_16x16x32_bf16 v[184:187], v[44:47], a[252:255], v[184:187]
    v_add_f32 v4, v4, v16
    v_add_f32 v4, v4, v17
    v_mfma_f32_16x16x32_bf16 v[188:191], v[40:43], v[208:211], v[188:191]
    v_exp_f32 v19, v99
    v_mfma_f32_16x16x32_bf16 v[188:191], v[44:47], v[212:215], v[188:191]
    s_waitcnt lgkmcnt(2)
    v_add_u32 v21, s3, v21
    v_cvt_f32_i32 v255, v255
    v_mfma_f32_16x16x32_bf16 v[112:115], v[24:27], a[200:203], v[112:115]
    ds_read_b128 v[40:43], v2 offset:18688
    v_cvt_pk_bf16_f32 v162, v16, v17
    v_mfma_f32_16x16x32_bf16 v[112:115], v[28:31], a[204:207], v[112:115]
    s_add_u32 s32, s32, 24576
    v_exp_f32 v16, v164
    v_mfma_f32_16x16x32_bf16 v[116:119], v[24:27], a[224:227], v[116:119]
    s_add_u32 s26, s26, 36864
    v_add_f32 v4, v4, v18
    v_add_u32 v22, s3, v22
    v_mfma_f32_16x16x32_bf16 v[116:119], v[28:31], a[228:231], v[116:119]
    v_add_f32 v4, v4, v19
    v_fma_f32 v250, v250, v56, v58
    v_mfma_f32_16x16x32_bf16 v[120:123], v[24:27], a[248:251], v[120:123]
    ds_read_b128 v[44:47], v3 offset:18688
    v_fma_f32 v254, v254, v57, v59
    v_mfma_f32_16x16x32_bf16 v[120:123], v[28:31], a[252:255], v[120:123]
    s_waitcnt lgkmcnt(2)
    v_exp_f32 v17, v165
    v_mfma_f32_16x16x32_bf16 v[124:127], v[24:27], v[208:211], v[124:127]
    s_waitcnt vmcnt(18)
    v_cvt_pk_bf16_f32 v163, v18, v19
    v_fma_f32 v251, v251, v56, v58
    v_mfma_f32_16x16x32_bf16 v[124:127], v[28:31], v[212:215], v[124:127]
    s_barrier
    s_sub_u32 s57, s26, 147456
    v_mfma_f32_16x16x32_bf16 v[176:179], v[32:35], a[208:211], v[176:179]
    s_min_u32 s26, s26, s57
    ds_read_b128 v[24:27], v1 offset:0
    v_fma_f32 v255, v255, v57, v59
    v_mfma_f32_16x16x32_bf16 v[176:179], v[36:39], a[212:215], v[176:179]
    v_exp_f32 v18, v166
    v_mfma_f32_16x16x32_bf16 v[180:183], v[32:35], a[232:235], v[180:183]
    v_add_f32 v5, v5, v16
    v_add_f32 v5, v5, v17
    v_mfma_f32_16x16x32_bf16 v[180:183], v[36:39], a[236:239], v[180:183]
    v_exp_f32 v19, v167
    v_mfma_f32_16x16x32_bf16 v[184:187], v[32:35], v[192:195], v[184:187]
    ds_read_b128 v[28:31], v1 offset:12288
    v_cvt_pk_bf16_f32 v164, v16, v17
    v_mfma_f32_16x16x32_bf16 v[184:187], v[36:39], v[196:199], v[184:187]
    v_exp_f32 v16, v100
    v_mfma_f32_16x16x32_bf16 v[188:191], v[32:35], v[216:219], v[188:191]
    v_add_f32 v5, v5, v18
    v_add_f32 v5, v5, v19
    v_mfma_f32_16x16x32_bf16 v[188:191], v[36:39], v[220:223], v[188:191]
    s_waitcnt lgkmcnt(2)
    v_exp_f32 v17, v101
    v_mfma_f32_16x16x32_bf16 v[112:115], v[40:43], a[208:211], v[112:115]
    ds_read_b128 v[32:35], v1 offset:768
    v_cvt_pk_bf16_f32 v165, v18, v19
    v_mfma_f32_16x16x32_bf16 v[112:115], v[44:47], a[212:215], v[112:115]
    v_exp_f32 v18, v102
    v_mfma_f32_16x16x32_bf16 v[116:119], v[40:43], a[232:235], v[116:119]
    v_cvt_pk_bf16_f32 v147, v248, v252
    v_add_f32 v5, v5, v16
    v_mfma_f32_16x16x32_bf16 v[116:119], v[44:47], a[236:239], v[116:119]
    v_add_f32 v5, v5, v17
    v_cvt_pk_bf16_f32 v151, v249, v253
    v_mfma_f32_16x16x32_bf16 v[120:123], v[40:43], v[192:195], v[120:123]
    ds_read_b128 v[36:39], v1 offset:13056
    v_cvt_pk_bf16_f32 v155, v250, v254
    v_mfma_f32_16x16x32_bf16 v[120:123], v[44:47], v[196:199], v[120:123]
    v_exp_f32 v19, v103
    v_mfma_f32_16x16x32_bf16 v[124:127], v[40:43], v[216:219], v[124:127]
    v_cvt_pk_bf16_f32 v166, v16, v17
    v_add_f32 v5, v5, v18
    v_mfma_f32_16x16x32_bf16 v[124:127], v[44:47], v[220:223], v[124:127]
    s_waitcnt lgkmcnt(2)
    v_add_f32 v5, v5, v19
    v_cvt_pk_bf16_f32 v167, v18, v19
    v_cvt_pk_bf16_f32 v159, v251, v255
    v_mfma_f32_16x16x32_bf16 a[0:3], v[64:67], v[24:27], a[0:3]
    ds_read_b128 v[40:43], v1 offset:1536
    v_bfe_u32 v53, v8, 4, 6
    v_mfma_f32_16x16x32_bf16 a[0:3], v[80:83], v[28:31], a[0:3]
    v_exp_f32 v16, v168
    v_mfma_f32_16x16x32_bf16 a[48:51], v[68:71], v[24:27], a[48:51]
    v_exp_f32 v17, v169
    v_mfma_f32_16x16x32_bf16 a[48:51], v[84:87], v[28:31], a[48:51]
    v_lshlrev_b32 v53, 2, v53
    v_mfma_f32_16x16x32_bf16 a[96:99], v[72:75], v[24:27], a[96:99]
    ds_read_b128 v[44:47], v1 offset:13824
    v_mfma_f32_16x16x32_bf16 a[96:99], v[88:91], v[28:31], a[96:99]
    buffer_store_dwordx4 v[144:147], v20, s[4:7], s81 offen offset:0 sc1
    v_mfma_f32_16x16x32_bf16 a[144:147], v[76:79], v[24:27], a[144:147]
    v_exp_f32 v18, v170
    v_mfma_f32_16x16x32_bf16 a[144:147], v[92:95], v[28:31], a[144:147]
    s_waitcnt lgkmcnt(2)
    v_add_f32 v6, v6, v16
    v_add_f32 v6, v6, v17
    v_mfma_f32_16x16x32_bf16 a[4:7], v[64:67], v[32:35], a[4:7]
    ds_read_b128 v[24:27], v1 offset:2304
    buffer_load_dword v52, v53, s[20:23], 0 offen sc1
    v_mfma_f32_16x16x32_bf16 a[4:7], v[80:83], v[36:39], a[4:7]
    v_exp_f32 v19, v171
    v_mfma_f32_16x16x32_bf16 a[52:55], v[68:71], v[32:35], a[52:55]
    s_mov_b32 m0, s56
    v_cvt_pk_bf16_f32 v168, v16, v17
    v_mfma_f32_16x16x32_bf16 a[52:55], v[84:87], v[36:39], a[52:55]
    v_exp_f32 v16, v104
    v_mfma_f32_16x16x32_bf16 a[100:103], v[72:75], v[32:35], a[100:103]
    ds_read_b128 v[28:31], v1 offset:14592
    v_add_f32 v6, v6, v18
    v_mfma_f32_16x16x32_bf16 a[100:103], v[88:91], v[36:39], a[100:103]
    v_add_f32 v6, v6, v19
    v_mfma_f32_16x16x32_bf16 a[148:151], v[76:79], v[32:35], a[148:151]
    v_exp_f32 v17, v105
    v_mfma_f32_16x16x32_bf16 a[148:151], v[92:95], v[36:39], a[148:151]
    s_waitcnt lgkmcnt(2)
    buffer_load_dwordx4 v8, s[4:7], s27 offen offset:0 sc1 lds
    v_mfma_f32_16x16x32_bf16 a[8:11], v[64:67], v[40:43], a[8:11]
    ds_read_b128 v[32:35], v21 offset:0
    v_cvt_pk_bf16_f32 v169, v18, v19
    v_mfma_f32_16x16x32_bf16 a[8:11], v[80:83], v[44:47], a[8:11]
    v_exp_f32 v18, v106
    v_mfma_f32_16x16x32_bf16 a[56:59], v[68:71], v[40:43], a[56:59]
    v_add_f32 v6, v6, v16
    v_add_f32 v6, v6, v17
    v_mfma_f32_16x16x32_bf16 a[56:59], v[84:87], v[44:47], a[56:59]
    v_exp_f32 v19, v107
    v_mfma_f32_16x16x32_bf16 a[104:107], v[72:75], v[40:43], a[104:107]
    ds_read_b128 v[36:39], v21 offset:12288
    v_cvt_pk_bf16_f32 v170, v16, v17
    v_mfma_f32_16x16x32_bf16 a[104:107], v[88:91], v[44:47], a[104:107]
    buffer_store_dwordx4 v[148:151], v20, s[4:7], s81 offen offset:768 sc1
    v_mfma_f32_16x16x32_bf16 a[152:155], v[76:79], v[40:43], a[152:155]
    v_exp_f32 v16, v172
    v_mfma_f32_16x16x32_bf16 a[152:155], v[92:95], v[44:47], a[152:155]
    s_waitcnt lgkmcnt(2)
    v_add_f32 v6, v6, v18
    v_add_f32 v6, v6, v19
    v_mfma_f32_16x16x32_bf16 a[12:15], v[64:67], v[24:27], a[12:15]
    ds_read_b128 v[40:43], v21 offset:768
    v_mfma_f32_16x16x32_bf16 a[12:15], v[80:83], v[28:31], a[12:15]
    buffer_load_dwordx4 v8, s[4:7], s27 offen offset:1024 sc1 lds
    v_mfma_f32_16x16x32_bf16 a[60:63], v[68:71], v[24:27], a[60:63]
    v_exp_f32 v17, v173
    v_mfma_f32_16x16x32_bf16 a[60:63], v[84:87], v[28:31], a[60:63]
    v_cvt_pk_bf16_f32 v171, v18, v19
    v_mfma_f32_16x16x32_bf16 a[108:111], v[72:75], v[24:27], a[108:111]
    ds_read_b128 v[44:47], v21 offset:13056
    v_mfma_f32_16x16x32_bf16 a[108:111], v[88:91], v[28:31], a[108:111]
    v_exp_f32 v18, v174
    v_mfma_f32_16x16x32_bf16 a[156:159], v[76:79], v[24:27], a[156:159]
    s_add_u32 s29, s28, 49152
    v_add_f32 v7, v7, v16
    v_add_f32 v7, v7, v17
    v_mfma_f32_16x16x32_bf16 a[156:159], v[92:95], v[28:31], a[156:159]
    s_waitcnt lgkmcnt(2)
    v_exp_f32 v19, v175
    v_mfma_f32_16x16x32_bf16 a[16:19], v[64:67], v[32:35], a[16:19]
    ds_read_b128 v[24:27], v21 offset:1536
    v_cvt_pk_bf16_f32 v172, v16, v17
    v_mfma_f32_16x16x32_bf16 a[16:19], v[80:83], v[36:39], a[16:19]
    s_sub_u32 s3, s29, 147456
    v_exp_f32 v16, v108
    v_mfma_f32_16x16x32_bf16 a[64:67], v[68:71], v[32:35], a[64:67]
    v_add_f32 v7, v7, v18
    v_mfma_f32_16x16x32_bf16 a[64:67], v[84:87], v[36:39], a[64:67]
    v_add_f32 v7, v7, v19
    v_mfma_f32_16x16x32_bf16 a[112:115], v[72:75], v[32:35], a[112:115]
    ds_read_b128 v[28:31], v21 offset:13824
    v_mfma_f32_16x16x32_bf16 a[112:115], v[88:91], v[36:39], a[112:115]
    buffer_store_dwordx4 v[152:155], v20, s[4:7], s81 offen offset:1536 sc1
    v_mfma_f32_16x16x32_bf16 a[160:163], v[76:79], v[32:35], a[160:163]
    v_exp_f32 v17, v109
    v_mfma_f32_16x16x32_bf16 a[160:163], v[92:95], v[36:39], a[160:163]
    s_waitcnt lgkmcnt(2)
    v_cvt_pk_bf16_f32 v173, v18, v19
    v_mfma_f32_16x16x32_bf16 a[20:23], v[64:67], v[40:43], a[20:23]
    s_min_u32 s29, s29, s3
    ds_read_b128 v[32:35], v21 offset:2304
    v_mfma_f32_16x16x32_bf16 a[20:23], v[80:83], v[44:47], a[20:23]
    buffer_load_dwordx4 v8, s[4:7], s27 offen offset:2048 sc1 lds
    v_mfma_f32_16x16x32_bf16 a[68:71], v[68:71], v[40:43], a[68:71]
    v_exp_f32 v18, v110
    v_mfma_f32_16x16x32_bf16 a[68:71], v[84:87], v[44:47], a[68:71]
    s_add_u32 s27, s27, 24576
    v_add_f32 v7, v7, v16
    v_add_f32 v7, v7, v17
    v_mfma_f32_16x16x32_bf16 a[116:119], v[72:75], v[40:43], a[116:119]
    ds_read_b128 v[36:39], v21 offset:14592
    v_mfma_f32_16x16x32_bf16 a[116:119], v[88:91], v[44:47], a[116:119]
    v_exp_f32 v19, v111
    v_mfma_f32_16x16x32_bf16 a[164:167], v[76:79], v[40:43], a[164:167]
    s_sub_u32 s3, s29, s28
    v_cvt_pk_bf16_f32 v174, v16, v17
    v_mfma_f32_16x16x32_bf16 a[164:167], v[92:95], v[44:47], a[164:167]
    s_waitcnt lgkmcnt(2)
    v_exp_f32 v16, v176
    v_mfma_f32_16x16x32_bf16 a[24:27], v[64:67], v[24:27], a[24:27]
    s_add_u32 s56, s56, 12288
    ds_read_b128 v[40:43], v22 offset:0
    v_add_f32 v7, v7, v18
    v_mfma_f32_16x16x32_bf16 a[24:27], v[80:83], v[28:31], a[24:27]
    v_add_f32 v7, v7, v19
    s_branch L_skip12
L_pad12:
    s_branch L_tb1_2
L_skip12:
    v_mfma_f32_16x16x32_bf16 a[72:75], v[68:71], v[24:27], a[72:75]
    v_exp_f32 v17, v177
    v_mfma_f32_16x16x32_bf16 a[72:75], v[84:87], v[28:31], a[72:75]
    v_cvt_pk_bf16_f32 v175, v18, v19
    v_mfma_f32_16x16x32_bf16 a[120:123], v[72:75], v[24:27], a[120:123]
    ds_read_b128 v[44:47], v22 offset:12288
    v_mfma_f32_16x16x32_bf16 a[120:123], v[88:91], v[28:31], a[120:123]
    buffer_store_dwordx4 v[156:159], v20, s[4:7], s81 offen offset:2304 sc1
    v_mfma_f32_16x16x32_bf16 a[168:171], v[76:79], v[24:27], a[168:171]
    s_mov_b32 m0, s56
    v_exp_f32 v18, v178
    v_mfma_f32_16x16x32_bf16 a[168:171], v[92:95], v[28:31], a[168:171]
    s_waitcnt lgkmcnt(2)
    v_add_f32 v4, v4, v16
    v_add_f32 v4, v4, v17
    v_mfma_f32_16x16x32_bf16 a[28:31], v[64:67], v[32:35], a[28:31]
    s_mov_b32 s28, s29
    ds_read_b128 v[24:27], v22 offset:768
    v_mfma_f32_16x16x32_bf16 a[28:31], v[80:83], v[36:39], a[28:31]
    v_exp_f32 v19, v179
    v_mfma_f32_16x16x32_bf16 a[76:79], v[68:71], v[32:35], a[76:79]
    v_cvt_pk_bf16_f32 v176, v16, v17
    v_mfma_f32_16x16x32_bf16 a[76:79], v[84:87], v[36:39], a[76:79]
    v_exp_f32 v16, v112
    v_mfma_f32_16x16x32_bf16 a[124:127], v[72:75], v[32:35], a[124:127]
    ds_read_b128 v[28:31], v22 offset:13056
    v_add_f32 v4, v4, v18
    v_mfma_f32_16x16x32_bf16 a[124:127], v[88:91], v[36:39], a[124:127]
    buffer_load_dwordx4 v8, s[4:7], s27 offen offset:0 sc1 lds
    v_mfma_f32_16x16x32_bf16 a[172:175], v[76:79], v[32:35], a[172:175]
    v_add_f32 v4, v4, v19
    v_add_u32 v2, s3, v2
    v_mfma_f32_16x16x32_bf16 a[172:175], v[92:95], v[36:39], a[172:175]
    s_waitcnt lgkmcnt(2)
    v_exp_f32 v17, v113
    v_mfma_f32_16x16x32_bf16 a[32:35], v[64:67], v[40:43], a[32:35]
    ds_read_b128 v[32:35], v22 offset:1536
    v_cvt_pk_bf16_f32 v177, v18, v19
    v_mfma_f32_16x16x32_bf16 a[32:35], v[80:83], v[44:47], a[32:35]
    v_exp_f32 v18, v114
    v_mfma_f32_16x16x32_bf16 a[80:83], v[68:71], v[40:43], a[80:83]
    v_add_f32 v4, v4, v16
    v_add_f32 v4, v4, v17
    v_mfma_f32_16x16x32_bf16 a[80:83], v[84:87], v[44:47], a[80:83]
    v_exp_f32 v19, v115
    v_mfma_f32_16x16x32_bf16 a[128:131], v[72:75], v[40:43], a[128:131]
    ds_read_b128 v[36:39], v22 offset:13824
    v_cvt_pk_bf16_f32 v178, v16, v17
    v_mfma_f32_16x16x32_bf16 a[128:131], v[88:91], v[44:47], a[128:131]
    v_exp_f32 v16, v180
    v_mfma_f32_16x16x32_bf16 a[176:179], v[76:79], v[40:43], a[176:179]
    v_add_u32 v3, s3, v3
    v_add_f32 v4, v4, v18
    v_mfma_f32_16x16x32_bf16 a[176:179], v[92:95], v[44:47], a[176:179]
    s_waitcnt lgkmcnt(2)
    v_add_f32 v4, v4, v19
    v_mfma_f32_16x16x32_bf16 a[36:39], v[64:67], v[24:27], a[36:39]
    ds_read_b128 v[40:43], v22 offset:2304
    v_mfma_f32_16x16x32_bf16 a[36:39], v[80:83], v[28:31], a[36:39]
    buffer_load_dwordx4 v8, s[4:7], s27 offen offset:1024 sc1 lds
    v_mfma_f32_16x16x32_bf16 a[84:87], v[68:71], v[24:27], a[84:87]
    v_exp_f32 v17, v181
    v_mfma_f32_16x16x32_bf16 a[84:87], v[84:87], v[28:31], a[84:87]
    v_cvt_pk_bf16_f32 v179, v18, v19
    v_mfma_f32_16x16x32_bf16 a[132:135], v[72:75], v[24:27], a[132:135]
    ds_read_b128 v[44:47], v22 offset:14592
    v_mfma_f32_16x16x32_bf16 a[132:135], v[88:91], v[28:31], a[132:135]
    s_waitcnt lgkmcnt(2)
    v_exp_f32 v18, v182
    v_mfma_f32_16x16x32_bf16 a[180:183], v[76:79], v[24:27], a[180:183]
    s_waitcnt vmcnt(17)
    v_add_f32 v5, v5, v16
    v_add_f32 v5, v5, v17
    v_mfma_f32_16x16x32_bf16 a[180:183], v[92:95], v[28:31], a[180:183]
    s_barrier
    v_mfma_f32_16x16x32_bf16 a[40:43], v[64:67], v[32:35], a[40:43]
    ds_read_b128 v[24:27], v2 offset:0
    v_mfma_f32_16x16x32_bf16 a[40:43], v[80:83], v[36:39], a[40:43]
    v_exp_f32 v19, v183
    v_mfma_f32_16x16x32_bf16 a[88:91], v[68:71], v[32:35], a[88:91]
    v_cvt_pk_bf16_f32 v180, v16, v17
    v_mfma_f32_16x16x32_bf16 a[88:91], v[84:87], v[36:39], a[88:91]
    buffer_load_dwordx4 v8, s[4:7], s27 offen offset:2048 sc1 lds
    v_mfma_f32_16x16x32_bf16 a[136:139], v[72:75], v[32:35], a[136:139]
    ds_read_b128 v[28:31], v3 offset:0
    v_mfma_f32_16x16x32_bf16 a[136:139], v[88:91], v[36:39], a[136:139]
    v_exp_f32 v16, v116
    v_mfma_f32_16x16x32_bf16 a[184:187], v[76:79], v[32:35], a[184:187]
    v_add_f32 v5, v5, v18
    v_add_f32 v5, v5, v19
    v_mfma_f32_16x16x32_bf16 a[184:187], v[92:95], v[36:39], a[184:187]
    s_waitcnt lgkmcnt(2)
    v_exp_f32 v17, v117
    v_mfma_f32_16x16x32_bf16 a[44:47], v[64:67], v[40:43], a[44:47]
    ds_read_b128 v[32:35], v2 offset:6144
    v_cvt_pk_bf16_f32 v181, v18, v19
    v_mfma_f32_16x16x32_bf16 a[44:47], v[80:83], v[44:47], a[44:47]
    v_exp_f32 v18, v118
    v_mfma_f32_16x16x32_bf16 a[92:95], v[68:71], v[40:43], a[92:95]
    v_add_f32 v5, v5, v16
    v_add_f32 v5, v5, v17
    v_mfma_f32_16x16x32_bf16 a[92:95], v[84:87], v[44:47], a[92:95]
    v_exp_f32 v19, v119
    v_mfma_f32_16x16x32_bf16 a[140:143], v[72:75], v[40:43], a[140:143]
    ds_read_b128 v[36:39], v3 offset:6144
    v_cvt_pk_bf16_f32 v182, v16, v17
    v_mfma_f32_16x16x32_bf16 a[140:143], v[88:91], v[44:47], a[140:143]
    s_add_u32 s27, s27, 24576
    v_add_f32 v5, v5, v18
    s_add_u32 s56, s56, 36864
    v_mfma_f32_16x16x32_bf16 a[188:191], v[76:79], v[40:43], a[188:191]
    s_sub_u32 s58, s56, 147456
    v_add_f32 v5, v5, v19
    v_cvt_pk_bf16_f32 v183, v18, v19
    v_mfma_f32_16x16x32_bf16 a[188:191], v[92:95], v[44:47], a[188:191]
    s_waitcnt lgkmcnt(2)
    s_min_u32 s56, s56, s58
    v_mfma_f32_16x16x32_bf16 v[64:67], v[24:27], a[192:195], v[128:131]
    ds_read_b128 v[40:43], v2 offset:128
    v_mfma_f32_16x16x32_bf16 v[64:67], v[28:31], a[196:199], v[64:67]
    v_exp_f32 v16, v184
    v_mfma_f32_16x16x32_bf16 v[68:71], v[24:27], a[216:219], v[132:135]
    v_exp_f32 v17, v185
    v_mfma_f32_16x16x32_bf16 v[68:71], v[28:31], a[220:223], v[68:71]
    v_exp_f32 v18, v186
    v_mfma_f32_16x16x32_bf16 v[72:75], v[24:27], a[240:243], v[136:139]
    ds_read_b128 v[44:47], v3 offset:128
    v_mfma_f32_16x16x32_bf16 v[72:75], v[28:31], a[244:247], v[72:75]
    v_add_f32 v6, v6, v16
    v_add_f32 v6, v6, v17
    v_mfma_f32_16x16x32_bf16 v[76:79], v[24:27], v[200:203], v[140:143]
    v_mfma_f32_16x16x32_bf16 v[76:79], v[28:31], v[204:207], v[76:79]
    s_waitcnt lgkmcnt(2)
    v_exp_f32 v19, v187
    v_mfma_f32_16x16x32_bf16 v[96:99], v[32:35], a[192:195], v[128:131]
    ds_read_b128 v[24:27], v2 offset:6272
    v_cvt_pk_bf16_f32 v184, v16, v17
    v_mfma_f32_16x16x32_bf16 v[96:99], v[36:39], a[196:199], v[96:99]
    v_mfma_f32_16x16x32_bf16 v[100:103], v[32:35], a[216:219], v[132:135]
    v_exp_f32 v16, v120
    v_mfma_f32_16x16x32_bf16 v[100:103], v[36:39], a[220:223], v[100:103]
    v_add_f32 v6, v6, v18
    v_mfma_f32_16x16x32_bf16 v[104:107], v[32:35], a[240:243], v[136:139]
    ds_read_b128 v[28:31], v3 offset:6272
    v_add_f32 v6, v6, v19
    v_mfma_f32_16x16x32_bf16 v[104:107], v[36:39], a[244:247], v[104:107]
    v_exp_f32 v17, v121
    v_mfma_f32_16x16x32_bf16 v[108:111], v[32:35], v[200:203], v[140:143]
    v_mfma_f32_16x16x32_bf16 v[108:111], v[36:39], v[204:207], v[108:111]
    s_waitcnt lgkmcnt(2)
    v_cvt_pk_bf16_f32 v185, v18, v19
    v_mfma_f32_16x16x32_bf16 v[64:67], v[40:43], a[200:203], v[64:67]
    ds_read_b128 v[32:35], v2 offset:256
    v_mfma_f32_16x16x32_bf16 v[64:67], v[44:47], a[204:207], v[64:67]
    v_exp_f32 v18, v122
    v_mfma_f32_16x16x32_bf16 v[68:71], v[40:43], a[224:227], v[68:71]
    v_add_f32 v6, v6, v16
    v_add_f32 v6, v6, v17
    v_mfma_f32_16x16x32_bf16 v[68:71], v[44:47], a[228:231], v[68:71]
    v_mfma_f32_16x16x32_bf16 v[72:75], v[40:43], a[248:251], v[72:75]
    ds_read_b128 v[36:39], v3 offset:256
    v_mfma_f32_16x16x32_bf16 v[72:75], v[44:47], a[252:255], v[72:75]
    v_exp_f32 v19, v123
    v_mfma_f32_16x16x32_bf16 v[76:79], v[40:43], v[208:211], v[76:79]
    v_cvt_pk_bf16_f32 v186, v16, v17
    v_mfma_f32_16x16x32_bf16 v[76:79], v[44:47], v[212:215], v[76:79]
    s_waitcnt lgkmcnt(2)
    v_exp_f32 v16, v188
    v_mfma_f32_16x16x32_bf16 v[96:99], v[24:27], a[200:203], v[96:99]
    ds_read_b128 v[40:43], v2 offset:6400
    v_add_f32 v6, v6, v18
    v_mfma_f32_16x16x32_bf16 v[96:99], v[28:31], a[204:207], v[96:99]
    v_add_f32 v6, v6, v19
    v_mfma_f32_16x16x32_bf16 v[100:103], v[24:27], a[224:227], v[100:103]
    v_exp_f32 v17, v189
    v_mfma_f32_16x16x32_bf16 v[100:103], v[28:31], a[228:231], v[100:103]
    v_cvt_pk_bf16_f32 v187, v18, v19
    v_mfma_f32_16x16x32_bf16 v[104:107], v[24:27], a[248:251], v[104:107]
    ds_read_b128 v[44:47], v3 offset:6400
    v_mfma_f32_16x16x32_bf16 v[104:107], v[28:31], a[252:255], v[104:107]
    s_waitcnt vmcnt(9)
    v_subrev_u32 v52, s92, v52
    v_cmp_lt_u32 vcc, 15, v52
    v_mfma_f32_16x16x32_bf16 v[108:111], v[24:27], v[208:211], v[108:111]
    s_add_u32 s29, s30, 49152
    v_exp_f32 v18, v190
    v_mfma_f32_16x16x32_bf16 v[108:111], v[28:31], v[212:215], v[108:111]
    s_waitcnt lgkmcnt(2)
    v_add_f32 v7, v7, v16
    v_add_f32 v7, v7, v17
    v_mfma_f32_16x16x32_bf16 v[64:67], v[32:35], a[208:211], v[64:67]
    s_and_b32 s59, vcc_lo, 0xff
    ds_read_b128 v[24:27], v2 offset:12288
    v_mfma_f32_16x16x32_bf16 v[64:67], v[36:39], a[212:215], v[64:67]
    s_cbranch_scc1 L_pollslow6
L_pollok6:
    v_mfma_f32_16x16x32_bf16 v[68:71], v[32:35], a[232:235], v[68:71]
    s_add_u32 s92, s92, 1
    v_exp_f32 v19, v191
    v_mfma_f32_16x16x32_bf16 v[68:71], v[36:39], a[236:239], v[68:71]
    s_sub_u32 s3, s29, 147456
    v_cvt_pk_bf16_f32 v188, v16, v17
    v_mfma_f32_16x16x32_bf16 v[72:75], v[32:35], v[192:195], v[72:75]
    s_mov_b32 m0, s26
    ds_read_b128 v[28:31], v3 offset:12288
    v_mfma_f32_16x16x32_bf16 v[72:75], v[36:39], v[196:199], v[72:75]
    v_exp_f32 v16, v124
    v_mfma_f32_16x16x32_bf16 v[76:79], v[32:35], v[216:219], v[76:79]
    s_min_u32 s29, s29, s3
    v_add_f32 v7, v7, v18
    v_add_f32 v7, v7, v19
    v_mfma_f32_16x16x32_bf16 v[76:79], v[36:39], v[220:223], v[76:79]
    s_waitcnt lgkmcnt(2)
    buffer_load_dwordx4 v8, s[4:7], s32 offen offset:0 sc1 lds
    v_mfma_f32_16x16x32_bf16 v[96:99], v[40:43], a[208:211], v[96:99]
    ds_read_b128 v[32:35], v2 offset:18432
    v_mfma_f32_16x16x32_bf16 v[96:99], v[44:47], a[212:215], v[96:99]
    v_exp_f32 v17, v125
    v_mfma_f32_16x16x32_bf16 v[100:103], v[40:43], a[232:235], v[100:103]
    v_cvt_pk_bf16_f32 v189, v18, v19
    v_mfma_f32_16x16x32_bf16 v[100:103], v[44:47], a[236:239], v[100:103]
    buffer_load_dwordx4 v8, s[4:7], s32 offen offset:1024 sc1 lds
    v_mfma_f32_16x16x32_bf16 v[104:107], v[40:43], v[192:195], v[104:107]
    s_sub_u32 s3, s29, s30
    ds_read_b128 v[36:39], v3 offset:18432
    v_mfma_f32_16x16x32_bf16 v[104:107], v[44:47], v[196:199], v[104:107]
    v_exp_f32 v18, v126
    v_mfma_f32_16x16x32_bf16 v[108:111], v[40:43], v[216:219], v[108:111]
    v_add_f32 v7, v7, v16
    v_add_f32 v7, v7, v17
    v_mfma_f32_16x16x32_bf16 v[108:111], v[44:47], v[220:223], v[108:111]
    s_waitcnt lgkmcnt(2)
    v_exp_f32 v19, v127
    v_mfma_f32_16x16x32_bf16 v[80:83], v[24:27], a[192:195], v[128:131]
    ds_read_b128 v[40:43], v2 offset:12416
    v_cvt_pk_bf16_f32 v190, v16, v17
    v_mfma_f32_16x16x32_bf16 v[80:83], v[28:31], a[196:199], v[80:83]
    buffer_load_dwordx4 v8, s[4:7], s32 offen offset:2048 sc1 lds
    v_mfma_f32_16x16x32_bf16 v[84:87], v[24:27], a[216:219], v[132:135]
    v_add_f32 v7, v7, v18
    v_add_f32 v7, v7, v19
    v_cvt_pk_bf16_f32 v191, v18, v19
    v_mfma_f32_16x16x32_bf16 v[84:87], v[28:31], a[220:223], v[84:87]
    s_mov_b32 s30, s29
    v_mfma_f32_16x16x32_bf16 v[88:91], v[24:27], a[240:243], v[136:139]
    s_add_u32 s32, s32, 24576
    ds_read_b128 v[44:47], v3 offset:12416
    v_mfma_f32_16x16x32_bf16 v[88:91], v[28:31], a[244:247], v[88:91]
    v_exp_f32 v16, v64
    v_mfma_f32_16x16x32_bf16 v[92:95], v[24:27], v[200:203], v[140:143]
    v_exp_f32 v17, v65
    v_mfma_f32_16x16x32_bf16 v[92:95], v[28:31], v[204:207], v[92:95]
    s_waitcnt lgkmcnt(2)
    v_exp_f32 v18, v66
    v_mfma_f32_16x16x32_bf16 v[112:115], v[32:35], a[192:195], v[128:131]
    s_add_u32 s26, s26, 12288
    ds_read_b128 v[24:27], v2 offset:18560
    v_add_f32 v4, v4, v16
    v_mfma_f32_16x16x32_bf16 v[112:115], v[36:39], a[196:199], v[112:115]
    s_mov_b32 m0, s26
    v_add_f32 v4, v4, v17
    v_add_u32 v1, s3, v1
    v_mfma_f32_16x16x32_bf16 v[116:119], v[32:35], a[216:219], v[132:135]
    v_exp_f32 v19, v67
    v_mfma_f32_16x16x32_bf16 v[116:119], v[36:39], a[220:223], v[116:119]
    v_cvt_pk_bf16_f32 v64, v16, v17
    v_mfma_f32_16x16x32_bf16 v[120:123], v[32:35], a[240:243], v[136:139]
    ds_read_b128 v[28:31], v3 offset:18560
    v_mfma_f32_16x16x32_bf16 v[120:123], v[36:39], a[244:247], v[120:123]
    buffer_load_dwordx4 v8, s[4:7], s32 offen offset:0 sc1 lds
    v_mfma_f32_16x16x32_bf16 v[124:127], v[32:35], v[200:203], v[140:143]
    v_exp_f32 v16, v96
    v_mfma_f32_16x16x32_bf16 v[124:127], v[36:39], v[204:207], v[124:127]
    s_waitcnt lgkmcnt(2)
    v_add_f32 v4, v4, v18
    v_add_f32 v4, v4, v19
    v_mfma_f32_16x16x32_bf16 v[80:83], v[40:43], a[200:203], v[80:83]
    ds_read_b128 v[32:35], v2 offset:12544
    v_add_u32 v21, s3, v21
    v_mfma_f32_16x16x32_bf16 v[80:83], v[44:47], a[204:207], v[80:83]
    v_exp_f32 v17, v97
    v_mfma_f32_16x16x32_bf16 v[84:87], v[40:43], a[224:227], v[84:87]
    v_cvt_pk_bf16_f32 v65, v18, v19
    v_mfma_f32_16x16x32_bf16 v[84:87], v[44:47], a[228:231], v[84:87]
    buffer_load_dwordx4 v8, s[4:7], s32 offen offset:1024 sc1 lds
    v_mfma_f32_16x16x32_bf16 v[88:91], v[40:43], a[248:251], v[88:91]
    ds_read_b128 v[36:39], v3 offset:12544
    v_add_u32 v22, s3, v22
    v_mfma_f32_16x16x32_bf16 v[88:91], v[44:47], a[252:255], v[88:91]
    v_exp_f32 v18, v98
    v_mfma_f32_16x16x32_bf16 v[92:95], v[40:43], v[208:211], v[92:95]
    v_add_f32 v4, v4, v16
    v_add_f32 v4, v4, v17
    v_mfma_f32_16x16x32_bf16 v[92:95], v[44:47], v[212:215], v[92:95]
    s_waitcnt lgkmcnt(2)
    buffer_load_dwordx4 v8, s[4:7], s32 offen offset:2048 sc1 lds
    v_mfma_f32_16x16x32_bf16 v[112:115], v[24:27], a[200:203], v[112:115]
    ds_read_b128 v[40:43], v2 offset:18688
    v_mfma_f32_16x16x32_bf16 v[112:115], v[28:31], a[204:207], v[112:115]
    v_exp_f32 v19, v99
    v_mfma_f32_16x16x32_bf16 v[116:119], v[24:27], a[224:227], v[116:119]
    v_cvt_pk_bf16_f32 v66, v16, v17
    v_mfma_f32_16x16x32_bf16 v[116:119], v[28:31], a[228:231], v[116:119]
    v_exp_f32 v16, v68
    v_mfma_f32_16x16x32_bf16 v[120:123], v[24:27], a[248:251], v[120:123]
    ds_read_b128 v[44:47], v3 offset:18688
    v_add_f32 v4, v4, v18
    v_mfma_f32_16x16x32_bf16 v[120:123], v[28:31], a[252:255], v[120:123]
    s_waitcnt lgkmcnt(2)
    v_add_f32 v4, v4, v19
    s_add_u32 s32, s32, 24576
    v_mfma_f32_16x16x32_bf16 v[124:127], v[24:27], v[208:211], v[124:127]
    s_waitcnt vmcnt(9)
    v_exp_f32 v17, v69
    v_mfma_f32_16x16x32_bf16 v[124:127], v[28:31], v[212:215], v[124:127]
    s_barrier
    v_cvt_pk_bf16_f32 v67, v18, v19
    v_mfma_f32_16x16x32_bf16 v[80:83], v[32:35], a[208:211], v[80:83]
    s_add_u32 s26, s26, 36864
    ds_read_b128 v[24:27], v1 offset:0
    v_add_u32 v55, 1, v55
    v_mfma_f32_16x16x32_bf16 v[80:83], v[36:39], a[212:215], v[80:83]
    s_sub_u32 s57, s26, 147456
    v_exp_f32 v18, v70
    v_mfma_f32_16x16x32_bf16 v[84:87], v[32:35], a[232:235], v[84:87]
    v_add_f32 v5, v5, v16
    v_add_f32 v5, v5, v17
    v_mfma_f32_16x16x32_bf16 v[84:87], v[36:39], a[236:239], v[84:87]
    v_exp_f32 v19, v71
    v_mfma_f32_16x16x32_bf16 v[88:91], v[32:35], v[192:195], v[88:91]
    s_min_u32 s26, s26, s57
    ds_read_b128 v[28:31], v1 offset:12288
    v_cvt_pk_bf16_f32 v68, v16, v17
    v_mfma_f32_16x16x32_bf16 v[88:91], v[36:39], v[196:199], v[88:91]
    buffer_store_dword v55, v13, s[20:23], 0 offen sc1
    v_mfma_f32_16x16x32_bf16 v[92:95], v[32:35], v[216:219], v[92:95]
    v_exp_f32 v16, v100
    v_mfma_f32_16x16x32_bf16 v[92:95], v[36:39], v[220:223], v[92:95]
    s_waitcnt lgkmcnt(2)
    v_add_f32 v5, v5, v18
    v_add_f32 v5, v5, v19
    v_mfma_f32_16x16x32_bf16 v[112:115], v[40:43], a[208:211], v[112:115]
    ds_read_b128 v[32:35], v1 offset:768
    v_mfma_f32_16x16x32_bf16 v[112:115], v[44:47], a[212:215], v[112:115]
    v_exp_f32 v17, v101
    v_mfma_f32_16x16x32_bf16 v[116:119], v[40:43], a[232:235], v[116:119]
    v_cvt_pk_bf16_f32 v69, v18, v19
    v_mfma_f32_16x16x32_bf16 v[116:119], v[44:47], a[236:239], v[116:119]
    v_exp_f32 v18, v102
    v_mfma_f32_16x16x32_bf16 v[120:123], v[40:43], v[192:195], v[120:123]
    ds_read_b128 v[36:39], v1 offset:13056
    v_add_f32 v5, v5, v16
    v_mfma_f32_16x16x32_bf16 v[120:123], v[44:47], v[196:199], v[120:123]
    v_add_f32 v5, v5, v17
    v_mfma_f32_16x16x32_bf16 v[124:127], v[40:43], v[216:219], v[124:127]
    v_exp_f32 v19, v103
    v_mfma_f32_16x16x32_bf16 v[124:127], v[44:47], v[220:223], v[124:127]
    s_waitcnt lgkmcnt(2)
    v_cvt_pk_bf16_f32 v70, v16, v17
    v_add_f32 v5, v5, v18
    v_add_f32 v5, v5, v19
    v_cvt_pk_bf16_f32 v71, v18, v19
    s_mov_b32 s31, 2
.p2align 6
L_loop2:
    v_mfma_f32_16x16x32_bf16 a[0:3], v[160:163], v[24:27], a[0:3]
    s_mov_b32 m0, s56
    ds_read_b128 v[40:43], v1 offset:1536
    v_mfma_f32_16x16x32_bf16 a[0:3], v[176:179], v[28:31], a[0:3]
    v_exp_f32 v16, v72
    v_mfma_f32_16x16x32_bf16 a[48:51], v[164:167], v[24:27], a[48:51]
    v_exp_f32 v17, v73
    v_mfma_f32_16x16x32_bf16 a[48:51], v[180:183], v[28:31], a[48:51]
    v_exp_f32 v18, v74
    v_mfma_f32_16x16x32_bf16 a[96:99], v[168:171], v[24:27], a[96:99]
    ds_read_b128 v[44:47], v1 offset:13824
    v_add_f32 v6, v6, v16
    v_mfma_f32_16x16x32_bf16 a[96:99], v[184:187], v[28:31], a[96:99]
    buffer_load_dwordx4 v8, s[4:7], s27 offen offset:0 sc1 lds
    v_mfma_f32_16x16x32_bf16 a[144:147], v[172:175], v[24:27], a[144:147]
    v_add_f32 v6, v6, v17
    v_mfma_f32_16x16x32_bf16 a[144:147], v[188:191], v[28:31], a[144:147]
    s_waitcnt lgkmcnt(2)
    v_exp_f32 v19, v75
    v_mfma_f32_16x16x32_bf16 a[4:7], v[160:163], v[32:35], a[4:7]
    ds_read_b128 v[24:27], v1 offset:2304
    v_cvt_pk_bf16_f32 v72, v16, v17
    v_mfma_f32_16x16x32_bf16 a[4:7], v[176:179], v[36:39], a[4:7]
    v_exp_f32 v16, v104
    v_mfma_f32_16x16x32_bf16 a[52:55], v[164:167], v[32:35], a[52:55]
    v_add_f32 v6, v6, v18
    v_mfma_f32_16x16x32_bf16 a[52:55], v[180:183], v[36:39], a[52:55]
    v_add_f32 v6, v6, v19
    v_mfma_f32_16x16x32_bf16 a[100:103], v[168:171], v[32:35], a[100:103]
    ds_read_b128 v[28:31], v1 offset:14592
    v_mfma_f32_16x16x32_bf16 a[100:103], v[184:187], v[36:39], a[100:103]
    v_exp_f32 v17, v105
    v_mfma_f32_16x16x32_bf16 a[148:151], v[172:175], v[32:35], a[148:151]
    v_cvt_pk_bf16_f32 v73, v18, v19
    v_mfma_f32_16x16x32_bf16 a[148:151], v[188:191], v[36:39], a[148:151]
    s_waitcnt lgkmcnt(2)
    buffer_load_dwordx4 v8, s[4:7], s27 offen offset:1024 sc1 lds
    v_mfma_f32_16x16x32_bf16 a[8:11], v[160:163], v[40:43], a[8:11]
    ds_read_b128 v[32:35], v21 offset:0
    v_mfma_f32_16x16x32_bf16 a[8:11], v[176:179], v[44:47], a[8:11]
    v_exp_f32 v18, v106
    v_mfma_f32_16x16x32_bf16 a[56:59], v[164:167], v[40:43], a[56:59]
    v_add_f32 v6, v6, v16
    v_add_f32 v6, v6, v17
    v_mfma_f32_16x16x32_bf16 a[56:59], v[180:183], v[44:47], a[56:59]
    v_exp_f32 v19, v107
    v_mfma_f32_16x16x32_bf16 a[104:107], v[168:171], v[40:43], a[104:107]
    ds_read_b128 v[36:39], v21 offset:12288
    v_cvt_pk_bf16_f32 v74, v16, v17
    v_mfma_f32_16x16x32_bf16 a[104:107], v[184:187], v[44:47], a[104:107]
    v_exp_f32 v16, v76
    v_mfma_f32_16x16x32_bf16 a[152:155], v[172:175], v[40:43], a[152:155]
    v_add_f32 v6, v6, v18
    v_mfma_f32_16x16x32_bf16 a[152:155], v[188:191], v[44:47], a[152:155]
    s_waitcnt lgkmcnt(2)
    buffer_load_dwordx4 v8, s[4:7], s27 offen offset:2048 sc1 lds
    v_mfma_f32_16x16x32_bf16 a[12:15], v[160:163], v[24:27], a[12:15]
    ds_read_b128 v[40:43], v21 offset:768
    v_add_f32 v6, v6, v19
    v_mfma_f32_16x16x32_bf16 a[12:15], v[176:179], v[28:31], a[12:15]
    v_exp_f32 v17, v77
    v_mfma_f32_16x16x32_bf16 a[60:63], v[164:167], v[24:27], a[60:63]
    v_cvt_pk_bf16_f32 v75, v18, v19
    v_mfma_f32_16x16x32_bf16 a[60:63], v[180:183], v[28:31], a[60:63]
    v_exp_f32 v18, v78
    v_mfma_f32_16x16x32_bf16 a[108:111], v[168:171], v[24:27], a[108:111]
    ds_read_b128 v[44:47], v21 offset:13056
    v_add_f32 v7, v7, v16
    v_mfma_f32_16x16x32_bf16 a[108:111], v[184:187], v[28:31], a[108:111]
    v_add_f32 v7, v7, v17
    v_mfma_f32_16x16x32_bf16 a[156:159], v[172:175], v[24:27], a[156:159]
    s_add_u32 s29, s28, 49152
    v_exp_f32 v19, v79
    v_mfma_f32_16x16x32_bf16 a[156:159], v[188:191], v[28:31], a[156:159]
    s_waitcnt lgkmcnt(2)
    s_add_u32 s27, s27, 24576
    v_mfma_f32_16x16x32_bf16 a[16:19], v[160:163], v[32:35], a[16:19]
    ds_read_b128 v[24:27], v21 offset:1536
    v_cvt_pk_bf16_f32 v76, v16, v17
    v_mfma_f32_16x16x32_bf16 a[16:19], v[176:179], v[36:39], a[16:19]
    s_sub_u32 s3, s29, 147456
    v_exp_f32 v16, v108
    v_mfma_f32_16x16x32_bf16 a[64:67], v[164:167], v[32:35], a[64:67]
    v_add_f32 v7, v7, v18
    v_mfma_f32_16x16x32_bf16 a[64:67], v[180:183], v[36:39], a[64:67]
    s_add_u32 s56, s56, 12288
    v_add_f32 v7, v7, v19
    v_mfma_f32_16x16x32_bf16 a[112:115], v[168:171], v[32:35], a[112:115]
    ds_read_b128 v[28:31], v21 offset:13824
    v_mfma_f32_16x16x32_bf16 a[112:115], v[184:187], v[36:39], a[112:115]
    v_exp_f32 v17, v109
    v_mfma_f32_16x16x32_bf16 a[160:163], v[172:175], v[32:35], a[160:163]
    v_cvt_pk_bf16_f32 v77, v18, v19
    v_mfma_f32_16x16x32_bf16 a[160:163], v[188:191], v[36:39], a[160:163]
    s_waitcnt lgkmcnt(2)
    v_exp_f32 v18, v110
    v_mfma_f32_16x16x32_bf16 a[20:23], v[160:163], v[40:43], a[20:23]
    s_mov_b32 m0, s56
    ds_read_b128 v[32:35], v21 offset:2304
    v_add_f32 v7, v7, v16
    v_mfma_f32_16x16x32_bf16 a[20:23], v[176:179], v[44:47], a[20:23]
    s_min_u32 s29, s29, s3
    v_add_f32 v7, v7, v17
    v_mfma_f32_16x16x32_bf16 a[68:71], v[164:167], v[40:43], a[68:71]
    v_exp_f32 v19, v111
    v_mfma_f32_16x16x32_bf16 a[68:71], v[180:183], v[44:47], a[68:71]
    v_mfma_f32_16x16x32_bf16 a[116:119], v[168:171], v[40:43], a[116:119]
    ds_read_b128 v[36:39], v21 offset:14592
    v_cvt_pk_bf16_f32 v78, v16, v17
    v_mfma_f32_16x16x32_bf16 a[116:119], v[184:187], v[44:47], a[116:119]
    v_exp_f32 v16, v80
    v_mfma_f32_16x16x32_bf16 a[164:167], v[172:175], v[40:43], a[164:167]
    s_sub_u32 s3, s29, s28
    v_add_f32 v7, v7, v18
    v_mfma_f32_16x16x32_bf16 a[164:167], v[188:191], v[44:47], a[164:167]
    s_waitcnt lgkmcnt(2)
    buffer_load_dwordx4 v8, s[4:7], s27 offen offset:0 sc1 lds
    v_mfma_f32_16x16x32_bf16 a[24:27], v[160:163], v[24:27], a[24:27]
    ds_read_b128 v[40:43], v22 offset:0
    v_add_f32 v7, v7, v19
    v_mfma_f32_16x16x32_bf16 a[24:27], v[176:179], v[28:31], a[24:27]
    v_exp_f32 v17, v81
    v_mfma_f32_16x16x32_bf16 a[72:75], v[164:167], v[24:27], a[72:75]
    v_cvt_pk_bf16_f32 v79, v18, v19
    v_mfma_f32_16x16x32_bf16 a[72:75], v[180:183], v[28:31], a[72:75]
    v_exp_f32 v18, v82
    v_mfma_f32_16x16x32_bf16 a[120:123], v[168:171], v[24:27], a[120:123]
    ds_read_b128 v[44:47], v22 offset:12288
    v_add_f32 v4, v4, v16
    v_mfma_f32_16x16x32_bf16 a[120:123], v[184:187], v[28:31], a[120:123]
    s_mov_b32 s28, s29
    v_add_f32 v4, v4, v17
    v_mfma_f32_16x16x32_bf16 a[168:171], v[172:175], v[24:27], a[168:171]
    v_exp_f32 v19, v83
    v_mfma_f32_16x16x32_bf16 a[168:171], v[188:191], v[28:31], a[168:171]
    s_waitcnt lgkmcnt(2)
    v_mfma_f32_16x16x32_bf16 a[28:31], v[160:163], v[32:35], a[28:31]
    ds_read_b128 v[24:27], v22 offset:768
    v_cvt_pk_bf16_f32 v80, v16, v17
    v_mfma_f32_16x16x32_bf16 a[28:31], v[176:179], v[36:39], a[28:31]
    buffer_load_dwordx4 v8, s[4:7], s27 offen offset:1024 sc1 lds
    v_mfma_f32_16x16x32_bf16 a[76:79], v[164:167], v[32:35], a[76:79]
    v_exp_f32 v16, v112
    v_mfma_f32_16x16x32_bf16 a[76:79], v[180:183], v[36:39], a[76:79]
    v_add_f32 v4, v4, v18
    v_add_f32 v4, v4, v19
    v_mfma_f32_16x16x32_bf16 a[124:127], v[168:171], v[32:35], a[124:127]
    ds_read_b128 v[28:31], v22 offset:13056
    v_add_u32 v2, s3, v2
    v_mfma_f32_16x16x32_bf16 a[124:127], v[184:187], v[36:39], a[124:127]
    v_exp_f32 v17, v113
    v_mfma_f32_16x16x32_bf16 a[172:175], v[172:175], v[32:35], a[172:175]
    v_cvt_pk_bf16_f32 v81, v18, v19
    v_mfma_f32_16x16x32_bf16 a[172:175], v[188:191], v[36:39], a[172:175]
    s_waitcnt lgkmcnt(2)
    v_exp_f32 v18, v114
    v_mfma_f32_16x16x32_bf16 a[32:35], v[160:163], v[40:43], a[32:35]
    ds_read_b128 v[32:35], v22 offset:1536
    v_add_f32 v4, v4, v16
    v_mfma_f32_16x16x32_bf16 a[32:35], v[176:179], v[44:47], a[32:35]
    buffer_load_dwordx4 v8, s[4:7], s27 offen offset:2048 sc1 lds
    v_mfma_f32_16x16x32_bf16 a[80:83], v[164:167], v[40:43], a[80:83]
    v_add_f32 v4, v4, v17
    v_add_u32 v3, s3, v3
    v_mfma_f32_16x16x32_bf16 a[80:83], v[180:183], v[44:47], a[80:83]
    v_exp_f32 v19, v115
    v_mfma_f32_16x16x32_bf16 a[128:131], v[168:171], v[40:43], a[128:131]
    ds_read_b128 v[36:39], v22 offset:13824
    v_cvt_pk_bf16_f32 v82, v16, v17
    v_mfma_f32_16x16x32_bf16 a[128:131], v[184:187], v[44:47], a[128:131]
    v_exp_f32 v16, v84
    v_mfma_f32_16x16x32_bf16 a[176:179], v[172:175], v[40:43], a[176:179]
    v_add_f32 v4, v4, v18
    v_mfma_f32_16x16x32_bf16 a[176:179], v[188:191], v[44:47], a[176:179]
    s_waitcnt lgkmcnt(2)
    v_add_f32 v4, v4, v19
    v_mfma_f32_16x16x32_bf16 a[36:39], v[160:163], v[24:27], a[36:39]
    ds_read_b128 v[40:43], v22 offset:2304
    v_mfma_f32_16x16x32_bf16 a[36:39], v[176:179], v[28:31], a[36:39]
    v_exp_f32 v17, v85
    v_mfma_f32_16x16x32_bf16 a[84:87], v[164:167], v[24:27], a[84:87]
    v_cvt_pk_bf16_f32 v83, v18, v19
    v_mfma_f32_16x16x32_bf16 a[84:87], v[180:183], v[28:31], a[84:87]
    s_add_u32 s27, s27, 24576
    v_exp_f32 v18, v86
    v_mfma_f32_16x16x32_bf16 a[132:135], v[168:171], v[24:27], a[132:135]
    s_add_u32 s56, s56, 36864
    ds_read_b128 v[44:47], v22 offset:14592
    v_add_f32 v5, v5, v16
    v_mfma_f32_16x16x32_bf16 a[132:135], v[184:187], v[28:31], a[132:135]
    s_waitcnt lgkmcnt(2)
    v_add_f32 v5, v5, v17
    v_mfma_f32_16x16x32_bf16 a[180:183], v[172:175], v[24:27], a[180:183]
    s_waitcnt vmcnt(18)
    v_exp_f32 v19, v87
    v_mfma_f32_16x16x32_bf16 a[180:183], v[188:191], v[28:31], a[180:183]
    s_barrier
    s_sub_u32 s58, s56, 147456
    v_mfma_f32_16x16x32_bf16 a[40:43], v[160:163], v[32:35], a[40:43]
    ds_read_b128 v[24:27], v2 offset:0
    v_cvt_pk_bf16_f32 v84, v16, v17
    v_mfma_f32_16x16x32_bf16 a[40:43], v[176:179], v[36:39], a[40:43]
    v_exp_f32 v16, v116
    v_mfma_f32_16x16x32_bf16 a[88:91], v[164:167], v[32:35], a[88:91]
    s_min_u32 s56, s56, s58
    v_add_f32 v5, v5, v18
    v_mfma_f32_16x16x32_bf16 a[88:91], v[180:183], v[36:39], a[88:91]
    v_add_f32 v5, v5, v19
    v_mfma_f32_16x16x32_bf16 a[136:139], v[168:171], v[32:35], a[136:139]
    ds_read_b128 v[28:31], v3 offset:0
    v_mfma_f32_16x16x32_bf16 a[136:139], v[184:187], v[36:39], a[136:139]
    v_exp_f32 v17, v117
    v_mfma_f32_16x16x32_bf16 a[184:187], v[172:175], v[32:35], a[184:187]
    v_cvt_pk_bf16_f32 v85, v18, v19
    v_mfma_f32_16x16x32_bf16 a[184:187], v[188:191], v[36:39], a[184:187]
    s_waitcnt lgkmcnt(2)
    v_exp_f32 v18, v118
    v_mfma_f32_16x16x32_bf16 a[44:47], v[160:163], v[40:43], a[44:47]
    ds_read_b128 v[32:35], v2 offset:6144
    v_add_f32 v5, v5, v16
    v_mfma_f32_16x16x32_bf16 a[44:47], v[176:179], v[44:47], a[44:47]
    v_add_f32 v5, v5, v17
    v_mfma_f32_16x16x32_bf16 a[92:95], v[164:167], v[40:43], a[92:95]
    v_exp_f32 v19, v119
    v_mfma_f32_16x16x32_bf16 a[92:95], v[180:183], v[44:47], a[92:95]
    v_mfma_f32_16x16x32_bf16 a[140:143], v[168:171], v[40:43], a[140:143]
    ds_read_b128 v[36:39], v3 offset:6144
    v_cvt_pk_bf16_f32 v86, v16, v17
    v_mfma_f32_16x16x32_bf16 a[140:143], v[184:187], v[44:47], a[140:143]
    v_add_f32 v5, v5, v18
    v_add_f32 v5, v5, v19
    v_mfma_f32_16x16x32_bf16 a[188:191], v[172:175], v[40:43], a[188:191]
    v_cvt_pk_bf16_f32 v87, v18, v19
    v_mfma_f32_16x16x32_bf16 a[188:191], v[188:191], v[44:47], a[188:191]
    s_waitcnt lgkmcnt(2)
    v_mfma_f32_16x16x32_bf16 v[160:163], v[24:27], a[192:195], v[128:131]
    s_mov_b32 m0, s26
    ds_read_b128 v[40:43], v2 offset:128
    v_mfma_f32_16x16x32_bf16 v[160:163], v[28:31], a[196:199], v[160:163]
    v_exp_f32 v16, v88
    v_mfma_f32_16x16x32_bf16 v[164:167], v[24:27], a[216:219], v[132:135]
    v_exp_f32 v17, v89
    v_mfma_f32_16x16x32_bf16 v[164:167], v[28:31], a[220:223], v[164:167]
    v_bfe_u32 v53, v8, 4, 6
    v_mfma_f32_16x16x32_bf16 v[168:171], v[24:27], a[240:243], v[136:139]
    ds_read_b128 v[44:47], v3 offset:128
    v_lshlrev_b32 v53, 2, v53
    v_mfma_f32_16x16x32_bf16 v[168:171], v[28:31], a[244:247], v[168:171]
    buffer_load_dwordx4 v8, s[4:7], s32 offen offset:0 sc1 lds
    v_mfma_f32_16x16x32_bf16 v[172:175], v[24:27], v[200:203], v[140:143]
    v_exp_f32 v18, v90
    v_mfma_f32_16x16x32_bf16 v[172:175], v[28:31], v[204:207], v[172:175]
    s_waitcnt lgkmcnt(2)
    v_add_f32 v6, v6, v16
    v_add_f32 v6, v6, v17
    s_branch L_skip13
L_pad13:
    s_branch L_tb1_1
L_skip13:
    v_mfma_f32_16x16x32_bf16 v[96:99], v[32:35], a[192:195], v[128:131]
    ds_read_b128 v[24:27], v2 offset:6272
    v_mfma_f32_16x16x32_bf16 v[96:99], v[36:39], a[196:199], v[96:99]
    buffer_load_dword v52, v53, s[20:23], 0 offen sc1
    v_mfma_f32_16x16x32_bf16 v[100:103], v[32:35], a[216:219], v[132:135]
    v_exp_f32 v19, v91
    v_mfma_f32_16x16x32_bf16 v[100:103], v[36:39], a[220:223], v[100:103]
    v_cvt_pk_bf16_f32 v88, v16, v17
    v_mfma_f32_16x16x32_bf16 v[104:107], v[32:35], a[240:243], v[136:139]
    ds_read_b128 v[28:31], v3 offset:6272
    v_mfma_f32_16x16x32_bf16 v[104:107], v[36:39], a[244:247], v[104:107]
    v_exp_f32 v16, v120
    v_mfma_f32_16x16x32_bf16 v[108:111], v[32:35], v[200:203], v[140:143]
    v_add_f32 v6, v6, v18
    v_add_f32 v6, v6, v19
    v_mfma_f32_16x16x32_bf16 v[108:111], v[36:39], v[204:207], v[108:111]
    s_waitcnt lgkmcnt(2)
    buffer_load_dwordx4 v8, s[4:7], s32 offen offset:1024 sc1 lds
    v_mfma_f32_16x16x32_bf16 v[160:163], v[40:43], a[200:203], v[160:163]
    ds_read_b128 v[32:35], v2 offset:256
    v_mfma_f32_16x16x32_bf16 v[160:163], v[44:47], a[204:207], v[160:163]
    v_exp_f32 v17, v121
    v_mfma_f32_16x16x32_bf16 v[164:167], v[40:43], a[224:227], v[164:167]
    v_cvt_pk_bf16_f32 v89, v18, v19
    v_mfma_f32_16x16x32_bf16 v[164:167], v[44:47], a[228:231], v[164:167]
    v_exp_f32 v18, v122
    v_mfma_f32_16x16x32_bf16 v[168:171], v[40:43], a[248:251], v[168:171]
    ds_read_b128 v[36:39], v3 offset:256
    v_add_f32 v6, v6, v16
    v_mfma_f32_16x16x32_bf16 v[168:171], v[44:47], a[252:255], v[168:171]
    v_add_f32 v6, v6, v17
    v_mfma_f32_16x16x32_bf16 v[172:175], v[40:43], v[208:211], v[172:175]
    v_exp_f32 v19, v123
    v_mfma_f32_16x16x32_bf16 v[172:175], v[44:47], v[212:215], v[172:175]
    s_waitcnt lgkmcnt(2)
    buffer_load_dwordx4 v8, s[4:7], s32 offen offset:2048 sc1 lds
    v_mfma_f32_16x16x32_bf16 v[96:99], v[24:27], a[200:203], v[96:99]
    ds_read_b128 v[40:43], v2 offset:6400
    v_cvt_pk_bf16_f32 v90, v16, v17
    v_mfma_f32_16x16x32_bf16 v[96:99], v[28:31], a[204:207], v[96:99]
    v_exp_f32 v16, v92
    v_mfma_f32_16x16x32_bf16 v[100:103], v[24:27], a[224:227], v[100:103]
    v_add_f32 v6, v6, v18
    v_add_f32 v6, v6, v19
    v_mfma_f32_16x16x32_bf16 v[100:103], v[28:31], a[228:231], v[100:103]
    v_exp_f32 v17, v93
    v_mfma_f32_16x16x32_bf16 v[104:107], v[24:27], a[248:251], v[104:107]
    ds_read_b128 v[44:47], v3 offset:6400
    v_cvt_pk_bf16_f32 v91, v18, v19
    v_mfma_f32_16x16x32_bf16 v[104:107], v[28:31], a[252:255], v[104:107]
    v_exp_f32 v18, v94
    v_mfma_f32_16x16x32_bf16 v[108:111], v[24:27], v[208:211], v[108:111]
    s_add_u32 s29, s30, 49152
    v_add_f32 v7, v7, v16
    s_add_u32 s32, s32, 24576
    v_mfma_f32_16x16x32_bf16 v[108:111], v[28:31], v[212:215], v[108:111]
    s_waitcnt lgkmcnt(2)
    v_add_f32 v7, v7, v17
    v_mfma_f32_16x16x32_bf16 v[160:163], v[32:35], a[208:211], v[160:163]
    s_sub_u32 s3, s29, 147456
    ds_read_b128 v[24:27], v2 offset:12288
    v_mfma_f32_16x16x32_bf16 v[160:163], v[36:39], a[212:215], v[160:163]
    v_exp_f32 v19, v95
    v_mfma_f32_16x16x32_bf16 v[164:167], v[32:35], a[232:235], v[164:167]
    v_cvt_pk_bf16_f32 v92, v16, v17
    v_mfma_f32_16x16x32_bf16 v[164:167], v[36:39], a[236:239], v[164:167]
    s_add_u32 s26, s26, 12288
    v_exp_f32 v16, v124
    v_mfma_f32_16x16x32_bf16 v[168:171], v[32:35], v[192:195], v[168:171]
    ds_read_b128 v[28:31], v3 offset:12288
    v_add_f32 v7, v7, v18
    v_mfma_f32_16x16x32_bf16 v[168:171], v[36:39], v[196:199], v[168:171]
    v_add_f32 v7, v7, v19
    v_mfma_f32_16x16x32_bf16 v[172:175], v[32:35], v[216:219], v[172:175]
    s_min_u32 s29, s29, s3
    v_mfma_f32_16x16x32_bf16 v[172:175], v[36:39], v[220:223], v[172:175]
    s_waitcnt lgkmcnt(2)
    v_exp_f32 v17, v125
    v_mfma_f32_16x16x32_bf16 v[96:99], v[40:43], a[208:211], v[96:99]
    s_mov_b32 m0, s26
    ds_read_b128 v[32:35], v2 offset:18432
    v_cvt_pk_bf16_f32 v93, v18, v19
    v_mfma_f32_16x16x32_bf16 v[96:99], v[44:47], a[212:215], v[96:99]
    v_exp_f32 v18, v126
    v_mfma_f32_16x16x32_bf16 v[100:103], v[40:43], a[232:235], v[100:103]
    v_mfma_f32_16x16x32_bf16 v[100:103], v[44:47], a[236:239], v[100:103]
    v_add_f32 v7, v7, v16
    v_mfma_f32_16x16x32_bf16 v[104:107], v[40:43], v[192:195], v[104:107]
    s_sub_u32 s3, s29, s30
    ds_read_b128 v[36:39], v3 offset:18432
    v_add_f32 v7, v7, v17
    v_mfma_f32_16x16x32_bf16 v[104:107], v[44:47], v[196:199], v[104:107]
    v_exp_f32 v19, v127
    v_mfma_f32_16x16x32_bf16 v[108:111], v[40:43], v[216:219], v[108:111]
    v_cvt_pk_bf16_f32 v94, v16, v17
    v_mfma_f32_16x16x32_bf16 v[108:111], v[44:47], v[220:223], v[108:111]
    s_waitcnt lgkmcnt(2)
    buffer_load_dwordx4 v8, s[4:7], s32 offen offset:0 sc1 lds
    v_mfma_f32_16x16x32_bf16 v[176:179], v[24:27], a[192:195], v[128:131]
    ds_read_b128 v[40:43], v2 offset:12416
    v_add_f32 v7, v7, v18
    v_mfma_f32_16x16x32_bf16 v[176:179], v[28:31], a[196:199], v[176:179]
    v_add_f32 v7, v7, v19
    v_cvt_pk_bf16_f32 v95, v18, v19
    v_mfma_f32_16x16x32_bf16 v[180:183], v[24:27], a[216:219], v[132:135]
    s_mov_b32 s30, s29
    v_mfma_f32_16x16x32_bf16 v[180:183], v[28:31], a[220:223], v[180:183]
    v_mfma_f32_16x16x32_bf16 v[184:187], v[24:27], a[240:243], v[136:139]
    ds_read_b128 v[44:47], v3 offset:12416
    v_mfma_f32_16x16x32_bf16 v[184:187], v[28:31], a[244:247], v[184:187]
    v_exp_f32 v16, v160
    v_mfma_f32_16x16x32_bf16 v[188:191], v[24:27], v[200:203], v[140:143]
    v_exp_f32 v17, v161
    v_mfma_f32_16x16x32_bf16 v[188:191], v[28:31], v[204:207], v[188:191]
    s_waitcnt lgkmcnt(2)
    v_exp_f32 v18, v162
    v_mfma_f32_16x16x32_bf16 v[112:115], v[32:35], a[192:195], v[128:131]
    ds_read_b128 v[24:27], v2 offset:18560
    v_add_f32 v4, v4, v16
    v_mfma_f32_16x16x32_bf16 v[112:115], v[36:39], a[196:199], v[112:115]
    buffer_load_dwordx4 v8, s[4:7], s32 offen offset:1024 sc1 lds
    v_mfma_f32_16x16x32_bf16 v[116:119], v[32:35], a[216:219], v[132:135]
    v_add_f32 v4, v4, v17
    v_add_u32 v1, s3, v1
    v_mfma_f32_16x16x32_bf16 v[116:119], v[36:39], a[220:223], v[116:119]
    v_exp_f32 v19, v163
    v_mfma_f32_16x16x32_bf16 v[120:123], v[32:35], a[240:243], v[136:139]
    ds_read_b128 v[28:31], v3 offset:18560
    v_cvt_pk_bf16_f32 v160, v16, v17
    v_mfma_f32_16x16x32_bf16 v[120:123], v[36:39], a[244:247], v[120:123]
    buffer_load_dword v0, v8, s[88:91], s93 offen
    v_mfma_f32_16x16x32_bf16 v[124:127], v[32:35], v[200:203], v[140:143]
    v_exp_f32 v16, v96
    v_mfma_f32_16x16x32_bf16 v[124:127], v[36:39], v[204:207], v[124:127]
    s_waitcnt lgkmcnt(2)
    v_add_f32 v4, v4, v18
    v_add_f32 v4, v4, v19
    v_mfma_f32_16x16x32_bf16 v[176:179], v[40:43], a[200:203], v[176:179]
    ds_read_b128 v[32:35], v2 offset:12544
    v_add_u32 v21, s3, v21
    v_mfma_f32_16x16x32_bf16 v[176:179], v[44:47], a[204:207], v[176:179]
    buffer_load_dwordx4 v8, s[4:7], s32 offen offset:2048 sc1 lds
    v_mfma_f32_16x16x32_bf16 v[180:183], v[40:43], a[224:227], v[180:183]
    v_exp_f32 v17, v97
    v_mfma_f32_16x16x32_bf16 v[180:183], v[44:47], a[228:231], v[180:183]
    v_cvt_pk_bf16_f32 v161, v18, v19
    v_mfma_f32_16x16x32_bf16 v[184:187], v[40:43], a[248:251], v[184:187]
    ds_read_b128 v[36:39], v3 offset:12544
    v_add_u32 v22, s3, v22
    v_mfma_f32_16x16x32_bf16 v[184:187], v[44:47], a[252:255], v[184:187]
    v_exp_f32 v18, v98
    v_mfma_f32_16x16x32_bf16 v[188:191], v[40:43], v[208:211], v[188:191]
    v_add_f32 v4, v4, v16
    v_add_f32 v4, v4, v17
    v_mfma_f32_16x16x32_bf16 v[188:191], v[44:47], v[212:215], v[188:191]
    s_waitcnt lgkmcnt(2)
    v_exp_f32 v19, v99
    v_mfma_f32_16x16x32_bf16 v[112:115], v[24:27], a[200:203], v[112:115]
    ds_read_b128 v[40:43], v2 offset:18688
    v_cvt_pk_bf16_f32 v162, v16, v17
    v_mfma_f32_16x16x32_bf16 v[112:115], v[28:31], a[204:207], v[112:115]
    v_exp_f32 v16, v164
    v_mfma_f32_16x16x32_bf16 v[116:119], v[24:27], a[224:227], v[116:119]
    v_add_f32 v4, v4, v18
    v_add_f32 v4, v4, v19
    v_mfma_f32_16x16x32_bf16 v[116:119], v[28:31], a[228:231], v[116:119]
    s_add_u32 s32, s32, 24576
    v_exp_f32 v17, v165
    v_mfma_f32_16x16x32_bf16 v[120:123], v[24:27], a[248:251], v[120:123]
    s_add_u32 s26, s26, 36864
    ds_read_b128 v[44:47], v3 offset:18688
    v_cvt_pk_bf16_f32 v163, v18, v19
    v_mfma_f32_16x16x32_bf16 v[120:123], v[28:31], a[252:255], v[120:123]
    s_waitcnt lgkmcnt(2)
    v_exp_f32 v18, v166
    v_mfma_f32_16x16x32_bf16 v[124:127], v[24:27], v[208:211], v[124:127]
    s_waitcnt vmcnt(18)
    v_add_f32 v5, v5, v16
    v_mfma_f32_16x16x32_bf16 v[124:127], v[28:31], v[212:215], v[124:127]
    s_barrier
    v_add_f32 v5, v5, v17
    v_mfma_f32_16x16x32_bf16 v[176:179], v[32:35], a[208:211], v[176:179]
    s_sub_u32 s57, s26, 147456
    ds_read_b128 v[24:27], v1 offset:0
    v_mfma_f32_16x16x32_bf16 v[176:179], v[36:39], a[212:215], v[176:179]
    v_exp_f32 v19, v167
    v_mfma_f32_16x16x32_bf16 v[180:183], v[32:35], a[232:235], v[180:183]
    s_min_u32 s26, s26, s57
    v_cvt_pk_bf16_f32 v164, v16, v17
    v_mfma_f32_16x16x32_bf16 v[180:183], v[36:39], a[236:239], v[180:183]
    v_exp_f32 v16, v100
    v_mfma_f32_16x16x32_bf16 v[184:187], v[32:35], v[192:195], v[184:187]
    ds_read_b128 v[28:31], v1 offset:12288
    v_add_f32 v5, v5, v18
    v_mfma_f32_16x16x32_bf16 v[184:187], v[36:39], v[196:199], v[184:187]
    v_add_f32 v5, v5, v19
    v_mfma_f32_16x16x32_bf16 v[188:191], v[32:35], v[216:219], v[188:191]
    v_exp_f32 v17, v101
    v_mfma_f32_16x16x32_bf16 v[188:191], v[36:39], v[220:223], v[188:191]
    s_waitcnt lgkmcnt(2)
    v_cvt_pk_bf16_f32 v165, v18, v19
    v_mfma_f32_16x16x32_bf16 v[112:115], v[40:43], a[208:211], v[112:115]
    ds_read_b128 v[32:35], v1 offset:768
    v_mfma_f32_16x16x32_bf16 v[112:115], v[44:47], a[212:215], v[112:115]
    v_exp_f32 v18, v102
    v_mfma_f32_16x16x32_bf16 v[116:119], v[40:43], a[232:235], v[116:119]
    v_add_f32 v5, v5, v16
    v_add_f32 v5, v5, v17
    v_mfma_f32_16x16x32_bf16 v[116:119], v[44:47], a[236:239], v[116:119]
    v_exp_f32 v19, v103
    v_mfma_f32_16x16x32_bf16 v[120:123], v[40:43], v[192:195], v[120:123]
    ds_read_b128 v[36:39], v1 offset:13056
    v_cvt_pk_bf16_f32 v166, v16, v17
    v_mfma_f32_16x16x32_bf16 v[120:123], v[44:47], v[196:199], v[120:123]
    v_add_f32 v5, v5, v18
    v_mfma_f32_16x16x32_bf16 v[124:127], v[40:43], v[216:219], v[124:127]
    v_add_f32 v5, v5, v19
    v_cvt_pk_bf16_f32 v167, v18, v19
    v_mfma_f32_16x16x32_bf16 v[124:127], v[44:47], v[220:223], v[124:127]
    s_waitcnt lgkmcnt(2)
    v_mfma_f32_16x16x32_bf16 a[0:3], v[64:67], v[24:27], a[0:3]
    ds_read_b128 v[40:43], v1 offset:1536
    v_mfma_f32_16x16x32_bf16 a[0:3], v[80:83], v[28:31], a[0:3]
    v_exp_f32 v16, v168
    v_mfma_f32_16x16x32_bf16 a[48:51], v[68:71], v[24:27], a[48:51]
    v_exp_f32 v17, v169
    v_mfma_f32_16x16x32_bf16 a[48:51], v[84:87], v[28:31], a[48:51]
    v_exp_f32 v18, v170
    v_mfma_f32_16x16x32_bf16 a[96:99], v[72:75], v[24:27], a[96:99]
    ds_read_b128 v[44:47], v1 offset:13824
    v_add_f32 v6, v6, v16
    v_mfma_f32_16x16x32_bf16 a[96:99], v[88:91], v[28:31], a[96:99]
    v_add_f32 v6, v6, v17
    v_mfma_f32_16x16x32_bf16 a[144:147], v[76:79], v[24:27], a[144:147]
    v_exp_f32 v19, v171
    v_mfma_f32_16x16x32_bf16 a[144:147], v[92:95], v[28:31], a[144:147]
    s_waitcnt lgkmcnt(2)
    v_mfma_f32_16x16x32_bf16 a[4:7], v[64:67], v[32:35], a[4:7]
    ds_read_b128 v[24:27], v1 offset:2304
    v_cvt_pk_bf16_f32 v168, v16, v17
    v_mfma_f32_16x16x32_bf16 a[4:7], v[80:83], v[36:39], a[4:7]
    v_exp_f32 v16, v104
    v_mfma_f32_16x16x32_bf16 a[52:55], v[68:71], v[32:35], a[52:55]
    v_add_f32 v6, v6, v18
    v_mfma_f32_16x16x32_bf16 a[52:55], v[84:87], v[36:39], a[52:55]
    v_add_f32 v6, v6, v19
    v_mfma_f32_16x16x32_bf16 a[100:103], v[72:75], v[32:35], a[100:103]
    ds_read_b128 v[28:31], v1 offset:14592
    v_mfma_f32_16x16x32_bf16 a[100:103], v[88:91], v[36:39], a[100:103]
    v_exp_f32 v17, v105
    v_mfma_f32_16x16x32_bf16 a[148:151], v[76:79], v[32:35], a[148:151]
    v_cvt_pk_bf16_f32 v169, v18, v19
    v_mfma_f32_16x16x32_bf16 a[148:151], v[92:95], v[36:39], a[148:151]
    s_waitcnt lgkmcnt(2)
    v_exp_f32 v18, v106
    v_mfma_f32_16x16x32_bf16 a[8:11], v[64:67], v[40:43], a[8:11]
    ds_read_b128 v[32:35], v21 offset:0
    v_add_f32 v6, v6, v16
    v_mfma_f32_16x16x32_bf16 a[8:11], v[80:83], v[44:47], a[8:11]
    v_add_f32 v6, v6, v17
    v_mfma_f32_16x16x32_bf16 a[56:59], v[68:71], v[40:43], a[56:59]
    v_exp_f32 v19, v107
    v_mfma_f32_16x16x32_bf16 a[56:59], v[84:87], v[44:47], a[56:59]
    v_mfma_f32_16x16x32_bf16 a[104:107], v[72:75], v[40:43], a[104:107]
    ds_read_b128 v[36:39], v21 offset:12288
    v_cvt_pk_bf16_f32 v170, v16, v17
    v_mfma_f32_16x16x32_bf16 a[104:107], v[88:91], v[44:47], a[104:107]
    v_exp_f32 v16, v172
    v_mfma_f32_16x16x32_bf16 a[152:155], v[76:79], v[40:43], a[152:155]
    v_add_f32 v6, v6, v18
    v_mfma_f32_16x16x32_bf16 a[152:155], v[92:95], v[44:47], a[152:155]
    s_waitcnt lgkmcnt(2)
    v_add_f32 v6, v6, v19
    v_mfma_f32_16x16x32_bf16 a[12:15], v[64:67], v[24:27], a[12:15]
    ds_read_b128 v[40:43], v21 offset:768
    v_mfma_f32_16x16x32_bf16 a[12:15], v[80:83], v[28:31], a[12:15]
    v_exp_f32 v17, v173
    v_mfma_f32_16x16x32_bf16 a[60:63], v[68:71], v[24:27], a[60:63]
    v_cvt_pk_bf16_f32 v171, v18, v19
    v_mfma_f32_16x16x32_bf16 a[60:63], v[84:87], v[28:31], a[60:63]
    v_exp_f32 v18, v174
    v_mfma_f32_16x16x32_bf16 a[108:111], v[72:75], v[24:27], a[108:111]
    ds_read_b128 v[44:47], v21 offset:13056
    v_add_f32 v7, v7, v16
    v_mfma_f32_16x16x32_bf16 a[108:111], v[88:91], v[28:31], a[108:111]
    s_waitcnt vmcnt(6)
    v_subrev_u32 v52, s92, v52
    v_cmp_lt_u32 vcc, 15, v52
    v_mfma_f32_16x16x32_bf16 a[156:159], v[76:79], v[24:27], a[156:159]
    s_add_u32 s29, s28, 49152
    v_add_f32 v7, v7, v17
    v_mfma_f32_16x16x32_bf16 a[156:159], v[92:95], v[28:31], a[156:159]
    s_waitcnt lgkmcnt(2)
    v_exp_f32 v19, v175
    v_mfma_f32_16x16x32_bf16 a[16:19], v[64:67], v[32:35], a[16:19]
    s_and_b32 s59, vcc_lo, 0xff
    ds_read_b128 v[24:27], v21 offset:1536
    v_cvt_pk_bf16_f32 v172, v16, v17
    v_mfma_f32_16x16x32_bf16 a[16:19], v[80:83], v[36:39], a[16:19]
    s_cbranch_scc1 L_pollslow7
L_pollok7:
    v_mfma_f32_16x16x32_bf16 a[64:67], v[68:71], v[32:35], a[64:67]
    s_sub_u32 s3, s29, 147456
    v_exp_f32 v16, v108
    v_mfma_f32_16x16x32_bf16 a[64:67], v[84:87], v[36:39], a[64:67]
    v_add_f32 v7, v7, v18
    v_add_f32 v7, v7, v19
    v_mfma_f32_16x16x32_bf16 a[112:115], v[72:75], v[32:35], a[112:115]
    s_mov_b32 m0, s56
    ds_read_b128 v[28:31], v21 offset:13824
    v_mfma_f32_16x16x32_bf16 a[112:115], v[88:91], v[36:39], a[112:115]
    v_exp_f32 v17, v109
    v_mfma_f32_16x16x32_bf16 a[160:163], v[76:79], v[32:35], a[160:163]
    v_cvt_pk_bf16_f32 v173, v18, v19
    v_mfma_f32_16x16x32_bf16 a[160:163], v[92:95], v[36:39], a[160:163]
    s_waitcnt lgkmcnt(2)
    buffer_load_dwordx4 v8, s[4:7], s27 offen offset:0 sc1 lds
    v_mfma_f32_16x16x32_bf16 a[20:23], v[64:67], v[40:43], a[20:23]
    s_min_u32 s29, s29, s3
    ds_read_b128 v[32:35], v21 offset:2304
    v_mfma_f32_16x16x32_bf16 a[20:23], v[80:83], v[44:47], a[20:23]
    v_exp_f32 v18, v110
    v_mfma_f32_16x16x32_bf16 a[68:71], v[68:71], v[40:43], a[68:71]
    v_add_f32 v7, v7, v16
    v_add_f32 v7, v7, v17
    v_mfma_f32_16x16x32_bf16 a[68:71], v[84:87], v[44:47], a[68:71]
    buffer_load_dwordx4 v8, s[4:7], s27 offen offset:1024 sc1 lds
    v_mfma_f32_16x16x32_bf16 a[116:119], v[72:75], v[40:43], a[116:119]
    ds_read_b128 v[36:39], v21 offset:14592
    v_mfma_f32_16x16x32_bf16 a[116:119], v[88:91], v[44:47], a[116:119]
    v_exp_f32 v19, v111
    v_mfma_f32_16x16x32_bf16 a[164:167], v[76:79], v[40:43], a[164:167]
    s_sub_u32 s3, s29, s28
    v_cvt_pk_bf16_f32 v174, v16, v17
    v_mfma_f32_16x16x32_bf16 a[164:167], v[92:95], v[44:47], a[164:167]
    s_waitcnt lgkmcnt(2)
    v_exp_f32 v16, v176
    v_mfma_f32_16x16x32_bf16 a[24:27], v[64:67], v[24:27], a[24:27]
    ds_read_b128 v[40:43], v22 offset:0
    v_add_f32 v7, v7, v18
    v_mfma_f32_16x16x32_bf16 a[24:27], v[80:83], v[28:31], a[24:27]
    buffer_load_dwordx4 v8, s[4:7], s27 offen offset:2048 sc1 lds
    v_mfma_f32_16x16x32_bf16 a[72:75], v[68:71], v[24:27], a[72:75]
    v_add_f32 v7, v7, v19
    v_mfma_f32_16x16x32_bf16 a[72:75], v[84:87], v[28:31], a[72:75]
    v_exp_f32 v17, v177
    v_mfma_f32_16x16x32_bf16 a[120:123], v[72:75], v[24:27], a[120:123]
    s_add_u32 s27, s27, 24576
    ds_read_b128 v[44:47], v22 offset:12288
    v_cvt_pk_bf16_f32 v175, v18, v19
    v_mfma_f32_16x16x32_bf16 a[120:123], v[88:91], v[28:31], a[120:123]
    s_mov_b32 s28, s29
    v_exp_f32 v18, v178
    v_mfma_f32_16x16x32_bf16 a[168:171], v[76:79], v[24:27], a[168:171]
    v_add_f32 v4, v4, v16
    v_add_f32 v4, v4, v17
    v_mfma_f32_16x16x32_bf16 a[168:171], v[92:95], v[28:31], a[168:171]
    s_waitcnt lgkmcnt(2)
    v_exp_f32 v19, v179
    v_mfma_f32_16x16x32_bf16 a[28:31], v[64:67], v[32:35], a[28:31]
    s_add_u32 s56, s56, 12288
    ds_read_b128 v[24:27], v22 offset:768
    v_cvt_pk_bf16_f32 v176, v16, v17
    v_mfma_f32_16x16x32_bf16 a[28:31], v[80:83], v[36:39], a[28:31]
    s_mov_b32 m0, s56
    v_exp_f32 v16, v112
    v_mfma_f32_16x16x32_bf16 a[76:79], v[68:71], v[32:35], a[76:79]
    v_add_f32 v4, v4, v18
    v_mfma_f32_16x16x32_bf16 a[76:79], v[84:87], v[36:39], a[76:79]
    v_add_f32 v4, v4, v19
    v_mfma_f32_16x16x32_bf16 a[124:127], v[72:75], v[32:35], a[124:127]
    ds_read_b128 v[28:31], v22 offset:13056
    v_add_u32 v2, s3, v2
    v_mfma_f32_16x16x32_bf16 a[124:127], v[88:91], v[36:39], a[124:127]
    buffer_load_dwordx4 v8, s[4:7], s27 offen offset:0 sc1 lds
    v_mfma_f32_16x16x32_bf16 a[172:175], v[76:79], v[32:35], a[172:175]
    v_exp_f32 v17, v113
    v_mfma_f32_16x16x32_bf16 a[172:175], v[92:95], v[36:39], a[172:175]
    s_waitcnt lgkmcnt(2)
    v_cvt_pk_bf16_f32 v177, v18, v19
    v_mfma_f32_16x16x32_bf16 a[32:35], v[64:67], v[40:43], a[32:35]
    ds_read_b128 v[32:35], v22 offset:1536
    v_mfma_f32_16x16x32_bf16 a[32:35], v[80:83], v[44:47], a[32:35]
    v_exp_f32 v18, v114
    v_mfma_f32_16x16x32_bf16 a[80:83], v[68:71], v[40:43], a[80:83]
    v_add_f32 v4, v4, v16
    v_add_f32 v4, v4, v17
    v_mfma_f32_16x16x32_bf16 a[80:83], v[84:87], v[44:47], a[80:83]
    buffer_load_dwordx4 v8, s[4:7], s27 offen offset:1024 sc1 lds
    v_mfma_f32_16x16x32_bf16 a[128:131], v[72:75], v[40:43], a[128:131]
    ds_read_b128 v[36:39], v22 offset:13824
    v_add_u32 v3, s3, v3
    v_mfma_f32_16x16x32_bf16 a[128:131], v[88:91], v[44:47], a[128:131]
    v_exp_f32 v19, v115
    v_mfma_f32_16x16x32_bf16 a[176:179], v[76:79], v[40:43], a[176:179]
    v_cvt_pk_bf16_f32 v178, v16, v17
    v_mfma_f32_16x16x32_bf16 a[176:179], v[92:95], v[44:47], a[176:179]
    s_waitcnt lgkmcnt(2)
    buffer_load_dwordx4 v8, s[4:7], s27 offen offset:2048 sc1 lds
    v_mfma_f32_16x16x32_bf16 a[36:39], v[64:67], v[24:27], a[36:39]
    ds_read_b128 v[40:43], v22 offset:2304
    v_mfma_f32_16x16x32_bf16 a[36:39], v[80:83], v[28:31], a[36:39]
    v_exp_f32 v16, v180
    v_mfma_f32_16x16x32_bf16 a[84:87], v[68:71], v[24:27], a[84:87]
    v_add_f32 v4, v4, v18
    v_add_f32 v4, v4, v19
    v_mfma_f32_16x16x32_bf16 a[84:87], v[84:87], v[28:31], a[84:87]
    v_exp_f32 v17, v181
    v_mfma_f32_16x16x32_bf16 a[132:135], v[72:75], v[24:27], a[132:135]
    ds_read_b128 v[44:47], v22 offset:14592
    v_cvt_pk_bf16_f32 v179, v18, v19
    v_mfma_f32_16x16x32_bf16 a[132:135], v[88:91], v[28:31], a[132:135]
    s_waitcnt lgkmcnt(2)
    v_exp_f32 v18, v182
    v_mfma_f32_16x16x32_bf16 a[180:183], v[76:79], v[24:27], a[180:183]
    s_waitcnt vmcnt(18)
    v_add_f32 v5, v5, v16
    v_add_f32 v5, v5, v17
    v_mfma_f32_16x16x32_bf16 a[180:183], v[92:95], v[28:31], a[180:183]
    s_barrier
    s_add_u32 s27, s27, 24576
    v_mfma_f32_16x16x32_bf16 a[40:43], v[64:67], v[32:35], a[40:43]
    s_add_u32 s56, s56, 36864
    ds_read_b128 v[24:27], v2 offset:0
    v_mfma_f32_16x16x32_bf16 a[40:43], v[80:83], v[36:39], a[40:43]
    s_sub_u32 s58, s56, 147456
    v_exp_f32 v19, v183
    v_mfma_f32_16x16x32_bf16 a[88:91], v[68:71], v[32:35], a[88:91]
    v_cvt_pk_bf16_f32 v180, v16, v17
    v_mfma_f32_16x16x32_bf16 a[88:91], v[84:87], v[36:39], a[88:91]
    v_exp_f32 v16, v116
    v_mfma_f32_16x16x32_bf16 a[136:139], v[72:75], v[32:35], a[136:139]
    s_min_u32 s56, s56, s58
    ds_read_b128 v[28:31], v3 offset:0
    v_add_f32 v5, v5, v18
    v_mfma_f32_16x16x32_bf16 a[136:139], v[88:91], v[36:39], a[136:139]
    v_add_f32 v5, v5, v19
    v_mfma_f32_16x16x32_bf16 a[184:187], v[76:79], v[32:35], a[184:187]
    v_exp_f32 v17, v117
    v_mfma_f32_16x16x32_bf16 a[184:187], v[92:95], v[36:39], a[184:187]
    s_waitcnt lgkmcnt(2)
    v_cvt_pk_bf16_f32 v181, v18, v19
    v_mfma_f32_16x16x32_bf16 a[44:47], v[64:67], v[40:43], a[44:47]
    ds_read_b128 v[32:35], v2 offset:6144
    v_mfma_f32_16x16x32_bf16 a[44:47], v[80:83], v[44:47], a[44:47]
    v_exp_f32 v18, v118
    v_mfma_f32_16x16x32_bf16 a[92:95], v[68:71], v[40:43], a[92:95]
    v_add_f32 v5, v5, v16
    v_add_f32 v5, v5, v17
    v_mfma_f32_16x16x32_bf16 a[92:95], v[84:87], v[44:47], a[92:95]
    v_exp_f32 v19, v119
    v_mfma_f32_16x16x32_bf16 a[140:143], v[72:75], v[40:43], a[140:143]
    ds_read_b128 v[36:39], v3 offset:6144
    v_cvt_pk_bf16_f32 v182, v16, v17
    v_mfma_f32_16x16x32_bf16 a[140:143], v[88:91], v[44:47], a[140:143]
    v_add_f32 v5, v5, v18
    v_add_f32 v5, v5, v19
    v_mfma_f32_16x16x32_bf16 a[188:191], v[76:79], v[40:43], a[188:191]
    v_cvt_pk_bf16_f32 v183, v18, v19
    v_mfma_f32_16x16x32_bf16 a[188:191], v[92:95], v[44:47], a[188:191]
    s_waitcnt lgkmcnt(2)
    v_mfma_f32_16x16x32_bf16 v[64:67], v[24:27], a[192:195], v[128:131]
    s_mov_b32 m0, s26
    ds_read_b128 v[40:43], v2 offset:128
    v_mfma_f32_16x16x32_bf16 v[64:67], v[28:31], a[196:199], v[64:67]
    v_exp_f32 v16, v184
    v_mfma_f32_16x16x32_bf16 v[68:71], v[24:27], a[216:219], v[132:135]
    v_exp_f32 v17, v185
    v_mfma_f32_16x16x32_bf16 v[68:71], v[28:31], a[220:223], v[68:71]
    v_exp_f32 v18, v186
    v_mfma_f32_16x16x32_bf16 v[72:75], v[24:27], a[240:243], v[136:139]
    ds_read_b128 v[44:47], v3 offset:128
    v_mfma_f32_16x16x32_bf16 v[72:75], v[28:31], a[244:247], v[72:75]
    buffer_load_dwordx4 v8, s[4:7], s32 offen offset:0 sc1 lds
    v_mfma_f32_16x16x32_bf16 v[76:79], v[24:27], v[200:203], v[140:143]
    v_add_f32 v6, v6, v16
    v_add_f32 v6, v6, v17
    v_mfma_f32_16x16x32_bf16 v[76:79], v[28:31], v[204:207], v[76:79]
    s_waitcnt lgkmcnt(2)
    v_exp_f32 v19, v187
    v_mfma_f32_16x16x32_bf16 v[96:99], v[32:35], a[192:195], v[128:131]
    ds_read_b128 v[24:27], v2 offset:6272
    v_cvt_pk_bf16_f32 v184, v16, v17
    v_mfma_f32_16x16x32_bf16 v[96:99], v[36:39], a[196:199], v[96:99]
    v_mfma_f32_16x16x32_bf16 v[100:103], v[32:35], a[216:219], v[132:135]
    v_exp_f32 v16, v120
    v_mfma_f32_16x16x32_bf16 v[100:103], v[36:39], a[220:223], v[100:103]
    v_add_f32 v6, v6, v18
    v_mfma_f32_16x16x32_bf16 v[104:107], v[32:35], a[240:243], v[136:139]
    ds_read_b128 v[28:31], v3 offset:6272
    v_add_f32 v6, v6, v19
    v_mfma_f32_16x16x32_bf16 v[104:107], v[36:39], a[244:247], v[104:107]
    v_exp_f32 v17, v121
    v_mfma_f32_16x16x32_bf16 v[108:111], v[32:35], v[200:203], v[140:143]
    v_mfma_f32_16x16x32_bf16 v[108:111], v[36:39], v[204:207], v[108:111]
    s_waitcnt lgkmcnt(2)
    buffer_load_dwordx4 v8, s[4:7], s32 offen offset:1024 sc1 lds
    v_mfma_f32_16x16x32_bf16 v[64:67], v[40:43], a[200:203], v[64:67]
    ds_read_b128 v[32:35], v2 offset:256
    v_cvt_pk_bf16_f32 v185, v18, v19
    v_mfma_f32_16x16x32_bf16 v[64:67], v[44:47], a[204:207], v[64:67]
    v_exp_f32 v18, v122
    v_mfma_f32_16x16x32_bf16 v[68:71], v[40:43], a[224:227], v[68:71]
    v_add_f32 v6, v6, v16
    v_add_f32 v6, v6, v17
    v_mfma_f32_16x16x32_bf16 v[68:71], v[44:47], a[228:231], v[68:71]
    v_mfma_f32_16x16x32_bf16 v[72:75], v[40:43], a[248:251], v[72:75]
    ds_read_b128 v[36:39], v3 offset:256
    v_mfma_f32_16x16x32_bf16 v[72:75], v[44:47], a[252:255], v[72:75]
    v_exp_f32 v19, v123
    v_mfma_f32_16x16x32_bf16 v[76:79], v[40:43], v[208:211], v[76:79]
    v_cvt_pk_bf16_f32 v186, v16, v17
    v_mfma_f32_16x16x32_bf16 v[76:79], v[44:47], v[212:215], v[76:79]
    s_waitcnt lgkmcnt(2)
    buffer_load_dwordx4 v8, s[4:7], s32 offen offset:2048 sc1 lds
    v_mfma_f32_16x16x32_bf16 v[96:99], v[24:27], a[200:203], v[96:99]
    ds_read_b128 v[40:43], v2 offset:6400
    v_mfma_f32_16x16x32_bf16 v[96:99], v[28:31], a[204:207], v[96:99]
    v_exp_f32 v16, v188
    v_mfma_f32_16x16x32_bf16 v[100:103], v[24:27], a[224:227], v[100:103]
    v_add_f32 v6, v6, v18
    v_add_f32 v6, v6, v19
    v_mfma_f32_16x16x32_bf16 v[100:103], v[28:31], a[228:231], v[100:103]
    v_exp_f32 v17, v189
    v_mfma_f32_16x16x32_bf16 v[104:107], v[24:27], a[248:251], v[104:107]
    ds_read_b128 v[44:47], v3 offset:6400
    v_cvt_pk_bf16_f32 v187, v18, v19
    v_mfma_f32_16x16x32_bf16 v[104:107], v[28:31], a[252:255], v[104:107]
    v_exp_f32 v18, v190
    v_mfma_f32_16x16x32_bf16 v[108:111], v[24:27], v[208:211], v[108:111]
    s_add_u32 s29, s30, 49152
    v_add_f32 v7, v7, v16
    s_add_u32 s32, s32, 24576
    v_mfma_f32_16x16x32_bf16 v[108:111], v[28:31], v[212:215], v[108:111]
    s_waitcnt lgkmcnt(2)
    v_add_f32 v7, v7, v17
    v_mfma_f32_16x16x32_bf16 v[64:67], v[32:35], a[208:211], v[64:67]
    s_sub_u32 s3, s29, 147456
    ds_read_b128 v[24:27], v2 offset:12288
    v_mfma_f32_16x16x32_bf16 v[64:67], v[36:39], a[212:215], v[64:67]
    v_exp_f32 v19, v191
    v_mfma_f32_16x16x32_bf16 v[68:71], v[32:35], a[232:235], v[68:71]
    v_cvt_pk_bf16_f32 v188, v16, v17
    v_mfma_f32_16x16x32_bf16 v[68:71], v[36:39], a[236:239], v[68:71]
    s_add_u32 s26, s26, 12288
    v_exp_f32 v16, v124
    v_mfma_f32_16x16x32_bf16 v[72:75], v[32:35], v[192:195], v[72:75]
    ds_read_b128 v[28:31], v3 offset:12288
    v_add_f32 v7, v7, v18
    v_mfma_f32_16x16x32_bf16 v[72:75], v[36:39], v[196:199], v[72:75]
    v_add_f32 v7, v7, v19
    v_mfma_f32_16x16x32_bf16 v[76:79], v[32:35], v[216:219], v[76:79]
    s_min_u32 s29, s29, s3
    v_mfma_f32_16x16x32_bf16 v[76:79], v[36:39], v[220:223], v[76:79]
    s_waitcnt lgkmcnt(2)
    v_exp_f32 v17, v125
    v_mfma_f32_16x16x32_bf16 v[96:99], v[40:43], a[208:211], v[96:99]
    s_mov_b32 m0, s26
    ds_read_b128 v[32:35], v2 offset:18432
    v_cvt_pk_bf16_f32 v189, v18, v19
    v_mfma_f32_16x16x32_bf16 v[96:99], v[44:47], a[212:215], v[96:99]
    v_exp_f32 v18, v126
    v_mfma_f32_16x16x32_bf16 v[100:103], v[40:43], a[232:235], v[100:103]
    v_mfma_f32_16x16x32_bf16 v[100:103], v[44:47], a[236:239], v[100:103]
    v_add_f32 v7, v7, v16
    v_mfma_f32_16x16x32_bf16 v[104:107], v[40:43], v[192:195], v[104:107]
    s_sub_u32 s3, s29, s30
    ds_read_b128 v[36:39], v3 offset:18432
    v_add_f32 v7, v7, v17
    v_mfma_f32_16x16x32_bf16 v[104:107], v[44:47], v[196:199], v[104:107]
    v_exp_f32 v19, v127
    v_mfma_f32_16x16x32_bf16 v[108:111], v[40:43], v[216:219], v[108:111]
    v_cvt_pk_bf16_f32 v190, v16, v17
    v_mfma_f32_16x16x32_bf16 v[108:111], v[44:47], v[220:223], v[108:111]
    s_waitcnt lgkmcnt(2)
    buffer_load_dwordx4 v8, s[4:7], s32 offen offset:0 sc1 lds
    v_mfma_f32_16x16x32_bf16 v[80:83], v[24:27], a[192:195], v[128:131]
    ds_read_b128 v[40:43], v2 offset:12416
    v_add_f32 v7, v7, v18
    v_mfma_f32_16x16x32_bf16 v[80:83], v[28:31], a[196:199], v[80:83]
    v_add_f32 v7, v7, v19
    v_cvt_pk_bf16_f32 v191, v18, v19
    v_mfma_f32_16x16x32_bf16 v[84:87], v[24:27], a[216:219], v[132:135]
    s_mov_b32 s30, s29
    v_mfma_f32_16x16x32_bf16 v[84:87], v[28:31], a[220:223], v[84:87]
    v_mfma_f32_16x16x32_bf16 v[88:91], v[24:27], a[240:243], v[136:139]
    ds_read_b128 v[44:47], v3 offset:12416
    v_mfma_f32_16x16x32_bf16 v[88:91], v[28:31], a[244:247], v[88:91]
    v_exp_f32 v16, v64
    v_mfma_f32_16x16x32_bf16 v[92:95], v[24:27], v[200:203], v[140:143]
    v_exp_f32 v17, v65
    v_mfma_f32_16x16x32_bf16 v[92:95], v[28:31], v[204:207], v[92:95]
    s_waitcnt lgkmcnt(2)
    v_exp_f32 v18, v66
    v_mfma_f32_16x16x32_bf16 v[112:115], v[32:35], a[192:195], v[128:131]
    ds_read_b128 v[24:27], v2 offset:18560
    v_add_f32 v4, v4, v16
    v_mfma_f32_16x16x32_bf16 v[112:115], v[36:39], a[196:199], v[112:115]
    buffer_load_dwordx4 v8, s[4:7], s32 offen offset:1024 sc1 lds
    v_mfma_f32_16x16x32_bf16 v[116:119], v[32:35], a[216:219], v[132:135]
    v_add_f32 v4, v4, v17
    v_add_u32 v1, s3, v1
    v_mfma_f32_16x16x32_bf16 v[116:119], v[36:39], a[220:223], v[116:119]
    v_exp_f32 v19, v67
    v_mfma_f32_16x16x32_bf16 v[120:123], v[32:35], a[240:243], v[136:139]
    ds_read_b128 v[28:31], v3 offset:18560
    v_cvt_pk_bf16_f32 v64, v16, v17
    v_mfma_f32_16x16x32_bf16 v[120:123], v[36:39], a[244:247], v[120:123]
    v_exp_f32 v16, v96
    v_mfma_f32_16x16x32_bf16 v[124:127], v[32:35], v[200:203], v[140:143]
    v_add_f32 v4, v4, v18
    v_add_f32 v4, v4, v19
    v_mfma_f32_16x16x32_bf16 v[124:127], v[36:39], v[204:207], v[124:127]
    s_waitcnt lgkmcnt(2)
    v_exp_f32 v17, v97
    v_mfma_f32_16x16x32_bf16 v[80:83], v[40:43], a[200:203], v[80:83]
    ds_read_b128 v[32:35], v2 offset:12544
    v_add_u32 v21, s3, v21
    v_mfma_f32_16x16x32_bf16 v[80:83], v[44:47], a[204:207], v[80:83]
    buffer_load_dwordx4 v8, s[4:7], s32 offen offset:2048 sc1 lds
    v_mfma_f32_16x16x32_bf16 v[84:87], v[40:43], a[224:227], v[84:87]
    v_cvt_pk_bf16_f32 v65, v18, v19
    v_mfma_f32_16x16x32_bf16 v[84:87], v[44:47], a[228:231], v[84:87]
    v_exp_f32 v18, v98
    v_mfma_f32_16x16x32_bf16 v[88:91], v[40:43], a[248:251], v[88:91]
    ds_read_b128 v[36:39], v3 offset:12544
    v_add_f32 v4, v4, v16
    v_mfma_f32_16x16x32_bf16 v[88:91], v[44:47], a[252:255], v[88:91]
    v_add_f32 v4, v4, v17
    v_add_u32 v22, s3, v22
    s_branch L_skip14
L_pad14:
    s_branch L_tb1_0
L_skip14:
    v_mfma_f32_16x16x32_bf16 v[92:95], v[40:43], v[208:211], v[92:95]
    v_exp_f32 v19, v99
    v_mfma_f32_16x16x32_bf16 v[92:95], v[44:47], v[212:215], v[92:95]
    s_waitcnt lgkmcnt(2)
    v_cvt_pk_bf16_f32 v66, v16, v17
    v_mfma_f32_16x16x32_bf16 v[112:115], v[24:27], a[200:203], v[112:115]
    ds_read_b128 v[40:43], v2 offset:18688
    v_mfma_f32_16x16x32_bf16 v[112:115], v[28:31], a[204:207], v[112:115]
    v_exp_f32 v16, v68
    v_mfma_f32_16x16x32_bf16 v[116:119], v[24:27], a[224:227], v[116:119]
    v_add_f32 v4, v4, v18
    v_add_f32 v4, v4, v19
    v_mfma_f32_16x16x32_bf16 v[116:119], v[28:31], a[228:231], v[116:119]
    s_add_u32 s32, s32, 24576
    v_exp_f32 v17, v69
    v_mfma_f32_16x16x32_bf16 v[120:123], v[24:27], a[248:251], v[120:123]
    s_add_u32 s26, s26, 36864
    ds_read_b128 v[44:47], v3 offset:18688
    v_cvt_pk_bf16_f32 v67, v18, v19
    v_mfma_f32_16x16x32_bf16 v[120:123], v[28:31], a[252:255], v[120:123]
    s_waitcnt lgkmcnt(2)
    v_exp_f32 v18, v70
    v_mfma_f32_16x16x32_bf16 v[124:127], v[24:27], v[208:211], v[124:127]
    s_waitcnt vmcnt(18)
    v_add_f32 v5, v5, v16
    v_add_f32 v5, v5, v17
    v_mfma_f32_16x16x32_bf16 v[124:127], v[28:31], v[212:215], v[124:127]
    s_barrier
    s_sub_u32 s57, s26, 147456
    v_mfma_f32_16x16x32_bf16 v[80:83], v[32:35], a[208:211], v[80:83]
    ds_read_b128 v[24:27], v1 offset:0
    v_mfma_f32_16x16x32_bf16 v[80:83], v[36:39], a[212:215], v[80:83]
    v_exp_f32 v19, v71
    v_mfma_f32_16x16x32_bf16 v[84:87], v[32:35], a[232:235], v[84:87]
    s_min_u32 s26, s26, s57
    v_cvt_pk_bf16_f32 v68, v16, v17
    v_mfma_f32_16x16x32_bf16 v[84:87], v[36:39], a[236:239], v[84:87]
    v_exp_f32 v16, v100
    v_mfma_f32_16x16x32_bf16 v[88:91], v[32:35], v[192:195], v[88:91]
    ds_read_b128 v[28:31], v1 offset:12288
    v_add_f32 v5, v5, v18
    v_mfma_f32_16x16x32_bf16 v[88:91], v[36:39], v[196:199], v[88:91]
    v_add_f32 v5, v5, v19
    v_mfma_f32_16x16x32_bf16 v[92:95], v[32:35], v[216:219], v[92:95]
    v_exp_f32 v17, v101
    v_mfma_f32_16x16x32_bf16 v[92:95], v[36:39], v[220:223], v[92:95]
    s_waitcnt lgkmcnt(2)
    v_cvt_pk_bf16_f32 v69, v18, v19
    v_mfma_f32_16x16x32_bf16 v[112:115], v[40:43], a[208:211], v[112:115]
    ds_read_b128 v[32:35], v1 offset:768
    v_mfma_f32_16x16x32_bf16 v[112:115], v[44:47], a[212:215], v[112:115]
    v_exp_f32 v18, v102
    v_mfma_f32_16x16x32_bf16 v[116:119], v[40:43], a[232:235], v[116:119]
    v_add_f32 v5, v5, v16
    v_add_f32 v5, v5, v17
    v_mfma_f32_16x16x32_bf16 v[116:119], v[44:47], a[236:239], v[116:119]
    v_exp_f32 v19, v103
    v_mfma_f32_16x16x32_bf16 v[120:123], v[40:43], v[192:195], v[120:123]
    s_sub_u32 s31, s31, 1
    ds_read_b128 v[36:39], v1 offset:13056
    v_cvt_pk_bf16_f32 v70, v16, v17
    v_mfma_f32_16x16x32_bf16 v[120:123], v[44:47], v[196:199], v[120:123]
    v_add_f32 v5, v5, v18
    v_add_f32 v5, v5, v19
    v_mfma_f32_16x16x32_bf16 v[124:127], v[40:43], v[216:219], v[124:127]
    s_waitcnt lgkmcnt(2)
    s_cmp_lg_u32 s31, 0
    v_cvt_pk_bf16_f32 v71, v18, v19
    v_mfma_f32_16x16x32_bf16 v[124:127], v[44:47], v[220:223], v[124:127]
    s_cbranch_scc1 L_loop2
    v_mfma_f32_16x16x32_bf16 a[0:3], v[160:163], v[24:27], a[0:3]
    ds_read_b128 v[40:43], v1 offset:1536
    ds_read_b128 v[44:47], v1 offset:13824
    v_mfma_f32_16x16x32_bf16 a[0:3], v[176:179], v[28:31], a[0:3]
    s_mov_b32 m0, s56
    s_add_u32 s29, s28, 49152
    s_sub_u32 s3, s29, 147456
    v_mfma_f32_16x16x32_bf16 a[48:51], v[164:167], v[24:27], a[48:51]
    ds_read_b128 v[240:243], v1 offset:2304
    s_min_u32 s29, s29, s3
    v_mfma_f32_16x16x32_bf16 a[48:51], v[180:183], v[28:31], a[48:51]
    s_waitcnt lgkmcnt(3)
    s_sub_u32 s3, s29, s28
    s_mov_b32 s28, s29
    v_mfma_f32_16x16x32_bf16 a[4:7], v[160:163], v[32:35], a[4:7]
    ds_read_b128 v[244:247], v1 offset:14592
    ds_read_b128 v[248:251], v21 offset:0
    v_mfma_f32_16x16x32_bf16 a[4:7], v[176:179], v[36:39], a[4:7]
    buffer_load_dwordx4 v8, s[4:7], s27 offen offset:0 sc1 lds
    v_mfma_f32_16x16x32_bf16 a[52:55], v[164:167], v[32:35], a[52:55]
    ds_read_b128 v[252:255], v21 offset:12288
    v_add_u32 v2, s3, v2
    v_mfma_f32_16x16x32_bf16 a[52:55], v[180:183], v[36:39], a[52:55]
    s_waitcnt lgkmcnt(4)
    v_add_u32 v3, s3, v3
    v_mfma_f32_16x16x32_bf16 a[8:11], v[160:163], v[40:43], a[8:11]
    ds_read_b128 v[24:27], v21 offset:768
    v_mfma_f32_16x16x32_bf16 a[8:11], v[176:179], v[44:47], a[8:11]
    buffer_load_dwordx4 v8, s[4:7], s27 offen offset:1024 sc1 lds
    v_mfma_f32_16x16x32_bf16 a[56:59], v[164:167], v[40:43], a[56:59]
    ds_read_b128 v[28:31], v21 offset:13056
    v_mfma_f32_16x16x32_bf16 a[56:59], v[180:183], v[44:47], a[56:59]
    s_waitcnt lgkmcnt(4)
    v_exp_f32 v16, v80
    v_mfma_f32_16x16x32_bf16 a[12:15], v[160:163], v[240:243], a[12:15]
    ds_read_b128 v[32:35], v21 offset:1536
    v_mfma_f32_16x16x32_bf16 a[12:15], v[176:179], v[244:247], a[12:15]
    buffer_load_dwordx4 v8, s[4:7], s27 offen offset:2048 sc1 lds
    v_mfma_f32_16x16x32_bf16 a[60:63], v[164:167], v[240:243], a[60:63]
    ds_read_b128 v[36:39], v21 offset:13824
    v_mfma_f32_16x16x32_bf16 a[60:63], v[180:183], v[244:247], a[60:63]
    s_waitcnt lgkmcnt(4)
    v_exp_f32 v17, v81
    v_mfma_f32_16x16x32_bf16 a[16:19], v[160:163], v[248:251], a[16:19]
    ds_read_b128 v[40:43], v21 offset:2304
    v_mfma_f32_16x16x32_bf16 a[16:19], v[176:179], v[252:255], a[16:19]
    s_add_u32 s27, s27, 24576
    s_add_u32 s56, s56, 12288
    s_mov_b32 m0, s56
    v_mfma_f32_16x16x32_bf16 a[64:67], v[164:167], v[248:251], a[64:67]
    ds_read_b128 v[44:47], v21 offset:14592
    v_mfma_f32_16x16x32_bf16 a[64:67], v[180:183], v[252:255], a[64:67]
    s_waitcnt lgkmcnt(4)
    v_exp_f32 v18, v82
    v_mfma_f32_16x16x32_bf16 a[20:23], v[160:163], v[24:27], a[20:23]
    ds_read_b128 v[240:243], v22 offset:0
    v_add_f32 v4, v4, v16
    v_mfma_f32_16x16x32_bf16 a[20:23], v[176:179], v[28:31], a[20:23]
    buffer_load_dwordx4 v8, s[4:7], s27 offen offset:0 sc1 lds
    v_mfma_f32_16x16x32_bf16 a[68:71], v[164:167], v[24:27], a[68:71]
    ds_read_b128 v[244:247], v22 offset:12288
    v_add_f32 v4, v4, v17
    v_mfma_f32_16x16x32_bf16 a[68:71], v[180:183], v[28:31], a[68:71]
    s_waitcnt lgkmcnt(4)
    v_exp_f32 v19, v83
    v_mfma_f32_16x16x32_bf16 a[24:27], v[160:163], v[32:35], a[24:27]
    ds_read_b128 v[248:251], v22 offset:768
    v_cvt_pk_bf16_f32 v80, v16, v17
    v_mfma_f32_16x16x32_bf16 a[24:27], v[176:179], v[36:39], a[24:27]
    buffer_load_dwordx4 v8, s[4:7], s27 offen offset:1024 sc1 lds
    v_mfma_f32_16x16x32_bf16 a[72:75], v[164:167], v[32:35], a[72:75]
    ds_read_b128 v[252:255], v22 offset:13056
    v_mfma_f32_16x16x32_bf16 a[72:75], v[180:183], v[36:39], a[72:75]
    s_waitcnt lgkmcnt(4)
    v_exp_f32 v16, v112
    v_mfma_f32_16x16x32_bf16 a[28:31], v[160:163], v[40:43], a[28:31]
    ds_read_b128 v[24:27], v22 offset:1536
    v_add_f32 v4, v4, v18
    v_mfma_f32_16x16x32_bf16 a[28:31], v[176:179], v[44:47], a[28:31]
    s_waitcnt vmcnt(17)
    s_barrier
    v_mfma_f32_16x16x32_bf16 a[76:79], v[164:167], v[40:43], a[76:79]
    ds_read_b128 v[28:31], v22 offset:13824
    v_add_f32 v4, v4, v19
    v_mfma_f32_16x16x32_bf16 a[76:79], v[180:183], v[44:47], a[76:79]
    s_waitcnt lgkmcnt(4)
    v_exp_f32 v17, v113
    v_mfma_f32_16x16x32_bf16 a[32:35], v[160:163], v[240:243], a[32:35]
    ds_read_b128 v[32:35], v22 offset:2304
    v_cvt_pk_bf16_f32 v81, v18, v19
    v_mfma_f32_16x16x32_bf16 a[32:35], v[176:179], v[244:247], a[32:35]
    buffer_load_dwordx4 v8, s[4:7], s27 offen offset:2048 sc1 lds
    v_mfma_f32_16x16x32_bf16 a[80:83], v[164:167], v[240:243], a[80:83]
    ds_read_b128 v[36:39], v22 offset:14592
    v_mfma_f32_16x16x32_bf16 a[80:83], v[180:183], v[244:247], a[80:83]
    s_waitcnt lgkmcnt(4)
    v_exp_f32 v18, v114
    v_mfma_f32_16x16x32_bf16 a[36:39], v[160:163], v[248:251], a[36:39]
    ds_read_b128 v[40:43], v2 offset:0
    v_add_f32 v4, v4, v16
    v_mfma_f32_16x16x32_bf16 a[36:39], v[176:179], v[252:255], a[36:39]
    v_add_f32 v4, v4, v17
    v_mfma_f32_16x16x32_bf16 a[84:87], v[164:167], v[248:251], a[84:87]
    ds_read_b128 v[44:47], v3 offset:0
    v_mfma_f32_16x16x32_bf16 a[84:87], v[180:183], v[252:255], a[84:87]
    s_waitcnt lgkmcnt(4)
    v_exp_f32 v19, v115
    v_mfma_f32_16x16x32_bf16 a[40:43], v[160:163], v[24:27], a[40:43]
    ds_read_b128 v[240:243], v2 offset:6144
    v_cvt_pk_bf16_f32 v82, v16, v17
    v_mfma_f32_16x16x32_bf16 a[40:43], v[176:179], v[28:31], a[40:43]
    v_exp_f32 v16, v84
    v_mfma_f32_16x16x32_bf16 a[88:91], v[164:167], v[24:27], a[88:91]
    ds_read_b128 v[244:247], v3 offset:6144
    v_add_f32 v4, v4, v18
    v_mfma_f32_16x16x32_bf16 a[88:91], v[180:183], v[28:31], a[88:91]
    s_waitcnt lgkmcnt(4)
    v_add_f32 v4, v4, v19
    v_mfma_f32_16x16x32_bf16 a[44:47], v[160:163], v[32:35], a[44:47]
    ds_read_b128 v[248:251], v2 offset:128
    v_mfma_f32_16x16x32_bf16 a[44:47], v[176:179], v[36:39], a[44:47]
    v_exp_f32 v17, v85
    v_mfma_f32_16x16x32_bf16 a[92:95], v[164:167], v[32:35], a[92:95]
    ds_read_b128 v[252:255], v3 offset:128
    v_cvt_pk_bf16_f32 v83, v18, v19
    v_mfma_f32_16x16x32_bf16 a[92:95], v[180:183], v[36:39], a[92:95]
    s_waitcnt lgkmcnt(4)
    v_exp_f32 v18, v86
    v_add_f32 v5, v5, v16
    v_add_f32 v5, v5, v17
    v_exp_f32 v19, v87
    v_cvt_pk_bf16_f32 v84, v16, v17
    v_exp_f32 v16, v116
    v_add_f32 v5, v5, v18
    v_add_f32 v5, v5, v19
    v_exp_f32 v17, v117
    v_cvt_pk_bf16_f32 v85, v18, v19
    v_exp_f32 v18, v118
    v_add_f32 v5, v5, v16
    v_add_f32 v5, v5, v17
    v_exp_f32 v19, v119
    v_cvt_pk_bf16_f32 v86, v16, v17
    v_add_f32 v5, v5, v18
    v_add_f32 v5, v5, v19
    v_cvt_pk_bf16_f32 v87, v18, v19
    v_mfma_f32_16x16x32_bf16 v[160:163], v[40:43], a[192:195], v[128:131]
    ds_read_b128 v[24:27], v2 offset:6272
    v_subrev_u32 v9, 98304, v1
    v_mfma_f32_16x16x32_bf16 v[160:163], v[44:47], a[196:199], v[160:163]
    v_subrev_u32 v10, 98304, v21
    v_subrev_u32 v11, 98304, v22
    v_mfma_f32_16x16x32_bf16 v[164:167], v[40:43], a[216:219], v[132:135]
    ds_read_b128 v[28:31], v3 offset:6272
    v_subrev_u32 v12, 49152, v1
    v_mfma_f32_16x16x32_bf16 v[164:167], v[44:47], a[220:223], v[164:167]
    s_waitcnt lgkmcnt(4)
    v_subrev_u32 v13, 49152, v21
    v_subrev_u32 v0, 49152, v22
    v_mfma_f32_16x16x32_bf16 v[96:99], v[240:243], a[192:195], v[128:131]
    ds_read_b128 v[32:35], v2 offset:256
    v_bfe_u32 v63, v8, 4, 6
    v_mfma_f32_16x16x32_bf16 v[96:99], v[244:247], a[196:199], v[96:99]
    v_and_b32 v62, 48, v63
    v_and_b32 v63, 15, v63
    v_mfma_f32_16x16x32_bf16 v[100:103], v[240:243], a[216:219], v[132:135]
    ds_read_b128 v[36:39], v3 offset:256
    v_mul_u32_u24 v61, 96, v62
    v_mfma_f32_16x16x32_bf16 v[100:103], v[244:247], a[220:223], v[100:103]
    s_waitcnt lgkmcnt(4)
    v_lshl_add_u32 v60, v63, 4, v61
    v_lshl_add_u32 v61, v63, 3, v61
    v_mfma_f32_16x16x32_bf16 v[160:163], v[248:251], a[200:203], v[160:163]
    ds_read_b128 v[40:43], v2 offset:6400
    s_lshl_b32 s24, s95, 2
    v_mfma_f32_16x16x32_bf16 v[160:163], v[252:255], a[204:207], v[160:163]
    s_add_u32 s24, s24, s25
    s_mul_i32 s24, s24, 24576
    v_mov_b32 v63, 1.0
    v_mfma_f32_16x16x32_bf16 v[164:167], v[248:251], a[224:227], v[164:167]
    ds_read_b128 v[44:47], v3 offset:6400
    s_add_u32 s33, s24, 0
    v_mfma_f32_16x16x32_bf16 v[164:167], v[252:255], a[228:231], v[164:167]
    s_waitcnt lgkmcnt(4)
    s_add_u32 s34, s24, 6144
    s_add_u32 s35, s24, 12288
    v_mfma_f32_16x16x32_bf16 v[96:99], v[24:27], a[200:203], v[96:99]
    ds_read_b128 v[240:243], v2 offset:12288
    s_add_u32 s36, s24, 18432
    v_mfma_f32_16x16x32_bf16 v[96:99], v[28:31], a[204:207], v[96:99]
    v_mfma_f32_16x16x32_bf16 v[100:103], v[24:27], a[224:227], v[100:103]
    ds_read_b128 v[244:247], v3 offset:12288
    v_mfma_f32_16x16x32_bf16 v[100:103], v[28:31], a[228:231], v[100:103]
    s_waitcnt lgkmcnt(4)
    v_mfma_f32_16x16x32_bf16 v[160:163], v[32:35], a[208:211], v[160:163]
    ds_read_b128 v[248:251], v2 offset:18432
    v_mfma_f32_16x16x32_bf16 v[160:163], v[36:39], a[212:215], v[160:163]
    v_mfma_f32_16x16x32_bf16 v[164:167], v[32:35], a[232:235], v[164:167]
    ds_read_b128 v[252:255], v3 offset:18432
    v_mfma_f32_16x16x32_bf16 v[164:167], v[36:39], a[236:239], v[164:167]
    s_waitcnt lgkmcnt(4)
    v_mfma_f32_16x16x32_bf16 v[96:99], v[40:43], a[208:211], v[96:99]
    ds_read_b128 v[24:27], v2 offset:12416
    v_mfma_f32_16x16x32_bf16 v[96:99], v[44:47], a[212:215], v[96:99]
    v_mfma_f32_16x16x32_bf16 v[100:103], v[40:43], a[232:235], v[100:103]
    ds_read_b128 v[28:31], v3 offset:12416
    v_mfma_f32_16x16x32_bf16 v[100:103], v[44:47], a[236:239], v[100:103]
    s_waitcnt lgkmcnt(4)
    v_mfma_f32_16x16x32_bf16 v[176:179], v[240:243], a[192:195], v[128:131]
    ds_read_b128 v[32:35], v2 offset:18560
    v_mfma_f32_16x16x32_bf16 v[176:179], v[244:247], a[196:199], v[176:179]
    v_mfma_f32_16x16x32_bf16 v[180:183], v[240:243], a[216:219], v[132:135]
    ds_read_b128 v[36:39], v3 offset:18560
    v_mfma_f32_16x16x32_bf16 v[180:183], v[244:247], a[220:223], v[180:183]
    s_waitcnt lgkmcnt(4)
    v_mfma_f32_16x16x32_bf16 v[112:115], v[248:251], a[192:195], v[128:131]
    ds_read_b128 v[40:43], v2 offset:12544
    v_mfma_f32_16x16x32_bf16 v[112:115], v[252:255], a[196:199], v[112:115]
    s_waitcnt vmcnt(12)
    s_barrier
    v_mfma_f32_16x16x32_bf16 v[116:119], v[248:251], a[216:219], v[132:135]
    ds_read_b128 v[44:47], v3 offset:12544
    v_mfma_f32_16x16x32_bf16 v[116:119], v[252:255], a[220:223], v[116:119]
    s_waitcnt lgkmcnt(4)
    v_exp_f32 v16, v160
    v_mfma_f32_16x16x32_bf16 v[176:179], v[24:27], a[200:203], v[176:179]
    ds_read_b128 v[240:243], v2 offset:18688
    v_mfma_f32_16x16x32_bf16 v[176:179], v[28:31], a[204:207], v[176:179]
    v_exp_f32 v17, v161
    v_mfma_f32_16x16x32_bf16 v[180:183], v[24:27], a[224:227], v[180:183]
    ds_read_b128 v[244:247], v3 offset:18688
    v_mfma_f32_16x16x32_bf16 v[180:183], v[28:31], a[228:231], v[180:183]
    s_waitcnt lgkmcnt(4)
    v_exp_f32 v18, v162
    v_mfma_f32_16x16x32_bf16 v[112:115], v[32:35], a[200:203], v[112:115]
    ds_read_b128 v[248:251], v9 offset:0
    v_add_f32 v4, v4, v16
    v_mfma_f32_16x16x32_bf16 v[112:115], v[36:39], a[204:207], v[112:115]
    v_add_f32 v4, v4, v17
    v_mfma_f32_16x16x32_bf16 v[116:119], v[32:35], a[224:227], v[116:119]
    ds_read_b128 v[252:255], v9 offset:12288
    v_mfma_f32_16x16x32_bf16 v[116:119], v[36:39], a[228:231], v[116:119]
    s_waitcnt lgkmcnt(4)
    v_exp_f32 v19, v163
    v_mfma_f32_16x16x32_bf16 v[176:179], v[40:43], a[208:211], v[176:179]
    ds_read_b128 v[24:27], v9 offset:768
    v_cvt_pk_bf16_f32 v160, v16, v17
    v_mfma_f32_16x16x32_bf16 v[176:179], v[44:47], a[212:215], v[176:179]
    v_exp_f32 v16, v96
    v_mfma_f32_16x16x32_bf16 v[180:183], v[40:43], a[232:235], v[180:183]
    ds_read_b128 v[28:31], v9 offset:13056
    v_add_f32 v4, v4, v18
    v_mfma_f32_16x16x32_bf16 v[180:183], v[44:47], a[236:239], v[180:183]
    s_waitcnt lgkmcnt(4)
    v_add_f32 v4, v4, v19
    v_mfma_f32_16x16x32_bf16 v[112:115], v[240:243], a[208:211], v[112:115]
    ds_read_b128 v[32:35], v9 offset:1536
    v_mfma_f32_16x16x32_bf16 v[112:115], v[244:247], a[212:215], v[112:115]
    v_exp_f32 v17, v97
    v_mfma_f32_16x16x32_bf16 v[116:119], v[240:243], a[232:235], v[116:119]
    ds_read_b128 v[36:39], v9 offset:13824
    v_cvt_pk_bf16_f32 v161, v18, v19
    v_mfma_f32_16x16x32_bf16 v[116:119], v[244:247], a[236:239], v[116:119]
    s_waitcnt lgkmcnt(4)
    v_exp_f32 v18, v98
    v_mfma_f32_16x16x32_bf16 a[0:3], v[64:67], v[248:251], a[0:3]
    ds_read_b128 v[40:43], v9 offset:2304
    s_mov_b32 s29, 0x5f800000
    v_mfma_f32_16x16x32_bf16 a[0:3], v[80:83], v[252:255], a[0:3]
    v_add_f32 v4, v4, v16
    v_add_f32 v4, v4, v17
    v_mfma_f32_16x16x32_bf16 a[48:51], v[68:71], v[248:251], a[48:51]
    ds_read_b128 v[44:47], v9 offset:14592
    v_mfma_f32_16x16x32_bf16 a[48:51], v[84:87], v[252:255], a[48:51]
    s_waitcnt lgkmcnt(4)
    v_exp_f32 v19, v99
    v_mfma_f32_16x16x32_bf16 a[4:7], v[64:67], v[24:27], a[4:7]
    ds_read_b128 v[240:243], v10 offset:0
    v_cvt_pk_bf16_f32 v162, v16, v17
    v_mfma_f32_16x16x32_bf16 a[4:7], v[80:83], v[28:31], a[4:7]
    v_exp_f32 v16, v164
    v_mfma_f32_16x16x32_bf16 a[52:55], v[68:71], v[24:27], a[52:55]
    ds_read_b128 v[244:247], v10 offset:12288
    v_add_f32 v4, v4, v18
    v_mfma_f32_16x16x32_bf16 a[52:55], v[84:87], v[28:31], a[52:55]
    s_waitcnt lgkmcnt(4)
    v_add_f32 v4, v4, v19
    v_mfma_f32_16x16x32_bf16 a[8:11], v[64:67], v[32:35], a[8:11]
    ds_read_b128 v[248:251], v10 offset:768
    v_mfma_f32_16x16x32_bf16 a[8:11], v[80:83], v[36:39], a[8:11]
    v_exp_f32 v17, v165
    v_mfma_f32_16x16x32_bf16 a[56:59], v[68:71], v[32:35], a[56:59]
    ds_read_b128 v[252:255], v10 offset:13056
    v_cvt_pk_bf16_f32 v163, v18, v19
    v_mfma_f32_16x16x32_bf16 a[56:59], v[84:87], v[36:39], a[56:59]
    s_waitcnt lgkmcnt(4)
    v_exp_f32 v18, v166
    v_mfma_f32_16x16x32_bf16 a[12:15], v[64:67], v[40:43], a[12:15]
    ds_read_b128 v[24:27], v10 offset:1536
    v_add_f32 v5, v5, v16
    v_mfma_f32_16x16x32_bf16 a[12:15], v[80:83], v[44:47], a[12:15]
    v_add_f32 v5, v5, v17
    v_mfma_f32_16x16x32_bf16 a[60:63], v[68:71], v[40:43], a[60:63]
    ds_read_b128 v[28:31], v10 offset:13824
    v_mfma_f32_16x16x32_bf16 a[60:63], v[84:87], v[44:47], a[60:63]
    s_waitcnt lgkmcnt(4)
    v_exp_f32 v19, v167
    v_mfma_f32_16x16x32_bf16 a[16:19], v[64:67], v[240:243], a[16:19]
    ds_read_b128 v[32:35], v10 offset:2304
    v_cvt_pk_bf16_f32 v164, v16, v17
    v_mfma_f32_16x16x32_bf16 a[16:19], v[80:83], v[244:247], a[16:19]
    v_exp_f32 v16, v100
    v_mfma_f32_16x16x32_bf16 a[64:67], v[68:71], v[240:243], a[64:67]
    ds_read_b128 v[36:39], v10 offset:14592
    v_add_f32 v5, v5, v18
    v_mfma_f32_16x16x32_bf16 a[64:67], v[84:87], v[244:247], a[64:67]
    s_waitcnt lgkmcnt(4)
    v_add_f32 v5, v5, v19
    v_mfma_f32_16x16x32_bf16 a[20:23], v[64:67], v[248:251], a[20:23]
    ds_read_b128 v[40:43], v11 offset:0
    v_mfma_f32_16x16x32_bf16 a[20:23], v[80:83], v[252:255], a[20:23]
    v_exp_f32 v17, v101
    v_mfma_f32_16x16x32_bf16 a[68:71], v[68:71], v[248:251], a[68:71]
    ds_read_b128 v[44:47], v11 offset:12288
    v_cvt_pk_bf16_f32 v165, v18, v19
    v_mfma_f32_16x16x32_bf16 a[68:71], v[84:87], v[252:255], a[68:71]
    s_waitcnt lgkmcnt(4)
    v_exp_f32 v18, v102
    v_mfma_f32_16x16x32_bf16 a[24:27], v[64:67], v[24:27], a[24:27]
    ds_read_b128 v[240:243], v11 offset:768
    v_add_f32 v5, v5, v16
    v_mfma_f32_16x16x32_bf16 a[24:27], v[80:83], v[28:31], a[24:27]
    v_add_f32 v5, v5, v17
    v_mfma_f32_16x16x32_bf16 a[72:75], v[68:71], v[24:27], a[72:75]
    ds_read_b128 v[244:247], v11 offset:13056
    v_mfma_f32_16x16x32_bf16 a[72:75], v[84:87], v[28:31], a[72:75]
    s_waitcnt lgkmcnt(4)
    v_exp_f32 v19, v103
    v_mfma_f32_16x16x32_bf16 a[28:31], v[64:67], v[32:35], a[28:31]
    ds_read_b128 v[248:251], v11 offset:1536
    v_cvt_pk_bf16_f32 v166, v16, v17
    v_mfma_f32_16x16x32_bf16 a[28:31], v[80:83], v[36:39], a[28:31]
    s_waitcnt vmcnt(0)
    s_barrier
    v_mfma_f32_16x16x32_bf16 a[76:79], v[68:71], v[32:35], a[76:79]
    ds_read_b128 v[252:255], v11 offset:13824
    v_add_f32 v5, v5, v18
    v_mfma_f32_16x16x32_bf16 a[76:79], v[84:87], v[36:39], a[76:79]
    s_waitcnt lgkmcnt(4)
    v_add_f32 v5, v5, v19
    v_cvt_pk_bf16_f32 v167, v18, v19
    v_mfma_f32_16x16x32_bf16 a[32:35], v[64:67], v[40:43], a[32:35]
    ds_read_b128 v[24:27], v11 offset:2304
    v_mfma_f32_16x16x32_bf16 a[32:35], v[80:83], v[44:47], a[32:35]
    v_exp_f32 v16, v176
    v_mfma_f32_16x16x32_bf16 a[80:83], v[68:71], v[40:43], a[80:83]
    ds_read_b128 v[28:31], v11 offset:14592
    v_mfma_f32_16x16x32_bf16 a[80:83], v[84:87], v[44:47], a[80:83]
    s_waitcnt lgkmcnt(4)
    v_exp_f32 v17, v177
    v_mfma_f32_16x16x32_bf16 a[36:39], v[64:67], v[240:243], a[36:39]
    ds_read_b128 v[32:35], v12 offset:0
    v_mfma_f32_16x16x32_bf16 a[36:39], v[80:83], v[244:247], a[36:39]
    v_exp_f32 v18, v178
    v_mfma_f32_16x16x32_bf16 a[84:87], v[68:71], v[240:243], a[84:87]
    ds_read_b128 v[36:39], v12 offset:12288
    v_add_f32 v4, v4, v16
    v_mfma_f32_16x16x32_bf16 a[84:87], v[84:87], v[244:247], a[84:87]
    s_waitcnt lgkmcnt(4)
    v_add_f32 v4, v4, v17
    v_mfma_f32_16x16x32_bf16 a[40:43], v[64:67], v[248:251], a[40:43]
    ds_read_b128 v[40:43], v12 offset:768
    v_mfma_f32_16x16x32_bf16 a[40:43], v[80:83], v[252:255], a[40:43]
    v_exp_f32 v19, v179
    v_mfma_f32_16x16x32_bf16 a[88:91], v[68:71], v[248:251], a[88:91]
    ds_read_b128 v[44:47], v12 offset:13056
    v_cvt_pk_bf16_f32 v176, v16, v17
    v_mfma_f32_16x16x32_bf16 a[88:91], v[84:87], v[252:255], a[88:91]
    s_waitcnt lgkmcnt(4)
    v_exp_f32 v16, v112
    v_mfma_f32_16x16x32_bf16 a[44:47], v[64:67], v[24:27], a[44:47]
    ds_read_b128 v[240:243], v12 offset:1536
    v_add_f32 v4, v4, v18
    v_mfma_f32_16x16x32_bf16 a[44:47], v[80:83], v[28:31], a[44:47]
    v_add_f32 v4, v4, v19
    v_mfma_f32_16x16x32_bf16 a[92:95], v[68:71], v[24:27], a[92:95]
    ds_read_b128 v[244:247], v12 offset:13824
    v_mfma_f32_16x16x32_bf16 a[92:95], v[84:87], v[28:31], a[92:95]
    s_waitcnt lgkmcnt(4)
    v_exp_f32 v17, v113
    v_cvt_pk_bf16_f32 v177, v18, v19
    v_exp_f32 v18, v114
    v_add_f32 v4, v4, v16
    v_add_f32 v4, v4, v17
    v_exp_f32 v19, v115
    v_cvt_pk_bf16_f32 v178, v16, v17
    v_exp_f32 v16, v180
    v_add_f32 v4, v4, v18
    v_add_f32 v4, v4, v19
    v_exp_f32 v17, v181
    v_cvt_pk_bf16_f32 v179, v18, v19
    v_exp_f32 v18, v182
    v_add_f32 v5, v5, v16
    v_add_f32 v5, v5, v17
    v_exp_f32 v19, v183
    v_cvt_pk_bf16_f32 v180, v16, v17
    v_exp_f32 v16, v116
    v_add_f32 v5, v5, v18
    v_add_f32 v5, v5, v19
    v_exp_f32 v17, v117
    v_cvt_pk_bf16_f32 v181, v18, v19
    v_exp_f32 v18, v118
    v_add_f32 v5, v5, v16
    v_add_f32 v5, v5, v17
    v_exp_f32 v19, v119
    v_cvt_pk_bf16_f32 v182, v16, v17
    v_add_f32 v5, v5, v18
    v_add_f32 v5, v5, v19
    v_cvt_pk_bf16_f32 v183, v18, v19
    s_nop 4
    v_cmp_nge_f32 vcc, s29, v4
    v_cmp_nge_f32_e64 s[56:57], s29, v5
    s_nop 0
    s_or_b64 vcc, vcc, s[56:57]
    v_mfma_f32_16x16x4_f32 v[48:51], v4, v63, 0
    v_mfma_f32_16x16x4_f32 v[52:55], v5, v63, 0
    s_cbranch_vccnz L_slow
    v_mfma_f32_16x16x32_bf16 a[0:3], v[160:163], v[32:35], a[0:3]
    ds_read_b128 v[248:251], v12 offset:2304
    v_mfma_f32_16x16x32_bf16 a[0:3], v[176:179], v[36:39], a[0:3]
    v_exp_f32 v16, v72
    v_mfma_f32_16x16x32_bf16 a[48:51], v[164:167], v[32:35], a[48:51]
    ds_read_b128 v[252:255], v12 offset:14592
    v_mfma_f32_16x16x32_bf16 a[48:51], v[180:183], v[36:39], a[48:51]
    s_waitcnt lgkmcnt(4)
    v_exp_f32 v17, v73
    v_mfma_f32_16x16x32_bf16 a[4:7], v[160:163], v[40:43], a[4:7]
    ds_read_b128 v[24:27], v13 offset:0
    v_mfma_f32_16x16x32_bf16 a[4:7], v[176:179], v[44:47], a[4:7]
    v_exp_f32 v18, v74
    v_mfma_f32_16x16x32_bf16 a[52:55], v[164:167], v[40:43], a[52:55]
    ds_read_b128 v[28:31], v13 offset:12288
    v_add_f32 v6, v6, v16
    v_mfma_f32_16x16x32_bf16 a[52:55], v[180:183], v[44:47], a[52:55]
    s_waitcnt lgkmcnt(4)
    v_add_f32 v6, v6, v17
    v_mfma_f32_16x16x32_bf16 a[8:11], v[160:163], v[240:243], a[8:11]
    ds_read_b128 v[32:35], v13 offset:768
    v_mfma_f32_16x16x32_bf16 a[8:11], v[176:179], v[244:247], a[8:11]
    v_exp_f32 v19, v75
    v_mfma_f32_16x16x32_bf16 a[56:59], v[164:167], v[240:243], a[56:59]
    ds_read_b128 v[36:39], v13 offset:13056
    v_cvt_pk_bf16_f32 v72, v16, v17
    v_mfma_f32_16x16x32_bf16 a[56:59], v[180:183], v[244:247], a[56:59]
    s_waitcnt lgkmcnt(4)
    v_exp_f32 v16, v104
    v_mfma_f32_16x16x32_bf16 a[12:15], v[160:163], v[248:251], a[12:15]
    ds_read_b128 v[40:43], v13 offset:1536
    v_add_f32 v6, v6, v18
    v_mfma_f32_16x16x32_bf16 a[12:15], v[176:179], v[252:255], a[12:15]
    v_add_f32 v6, v6, v19
    v_mfma_f32_16x16x32_bf16 a[60:63], v[164:167], v[248:251], a[60:63]
    ds_read_b128 v[44:47], v13 offset:13824
    v_mfma_f32_16x16x32_bf16 a[60:63], v[180:183], v[252:255], a[60:63]
    s_waitcnt lgkmcnt(4)
    v_exp_f32 v17, v105
    v_mfma_f32_16x16x32_bf16 a[16:19], v[160:163], v[24:27], a[16:19]
    ds_read_b128 v[240:243], v13 offset:2304
    v_cvt_pk_bf16_f32 v73, v18, v19
    v_mfma_f32_16x16x32_bf16 a[16:19], v[176:179], v[28:31], a[16:19]
    v_exp_f32 v18, v106
    v_mfma_f32_16x16x32_bf16 a[64:67], v[164:167], v[24:27], a[64:67]
    ds_read_b128 v[244:247], v13 offset:14592
    v_add_f32 v6, v6, v16
    v_mfma_f32_16x16x32_bf16 a[64:67], v[180:183], v[28:31], a[64:67]
    s_waitcnt lgkmcnt(4)
    v_add_f32 v6, v6, v17
    v_mfma_f32_16x16x32_bf16 a[20:23], v[160:163], v[32:35], a[20:23]
    ds_read_b128 v[248:251], v0 offset:0
    v_mfma_f32_16x16x32_bf16 a[20:23], v[176:179], v[36:39], a[20:23]
    v_exp_f32 v19, v107
    v_mfma_f32_16x16x32_bf16 a[68:71], v[164:167], v[32:35], a[68:71]
    ds_read_b128 v[252:255], v0 offset:12288
    v_cvt_pk_bf16_f32 v74, v16, v17
    v_mfma_f32_16x16x32_bf16 a[68:71], v[180:183], v[36:39], a[68:71]
    s_waitcnt lgkmcnt(4)
    v_exp_f32 v16, v76
    v_mfma_f32_16x16x32_bf16 a[24:27], v[160:163], v[40:43], a[24:27]
    ds_read_b128 v[24:27], v0 offset:768
    v_add_f32 v6, v6, v18
    v_mfma_f32_16x16x32_bf16 a[24:27], v[176:179], v[44:47], a[24:27]
    v_add_f32 v6, v6, v19
    v_mfma_f32_16x16x32_bf16 a[72:75], v[164:167], v[40:43], a[72:75]
    ds_read_b128 v[28:31], v0 offset:13056
    v_mfma_f32_16x16x32_bf16 a[72:75], v[180:183], v[44:47], a[72:75]
    s_waitcnt lgkmcnt(4)
    v_exp_f32 v17, v77
    v_mfma_f32_16x16x32_bf16 a[28:31], v[160:163], v[240:243], a[28:31]
    ds_read_b128 v[32:35], v0 offset:1536
    v_cvt_pk_bf16_f32 v75, v18, v19
    v_mfma_f32_16x16x32_bf16 a[28:31], v[176:179], v[244:247], a[28:31]
    v_exp_f32 v18, v78
    v_mfma_f32_16x16x32_bf16 a[76:79], v[164:167], v[240:243], a[76:79]
    ds_read_b128 v[36:39], v0 offset:13824
    v_add_f32 v7, v7, v16
    v_mfma_f32_16x16x32_bf16 a[76:79], v[180:183], v[244:247], a[76:79]
    s_waitcnt lgkmcnt(4)
    v_add_f32 v7, v7, v17
    v_mfma_f32_16x16x32_bf16 a[32:35], v[160:163], v[248:251], a[32:35]
    ds_read_b128 v[40:43], v0 offset:2304
    v_mfma_f32_16x16x32_bf16 a[32:35], v[176:179], v[252:255], a[32:35]
    v_exp_f32 v19, v79
    v_mfma_f32_16x16x32_bf16 a[80:83], v[164:167], v[248:251], a[80:83]
    ds_read_b128 v[44:47], v0 offset:14592
    v_cvt_pk_bf16_f32 v76, v16, v17
    v_mfma_f32_16x16x32_bf16 a[80:83], v[180:183], v[252:255], a[80:83]
    s_waitcnt lgkmcnt(4)
    v_exp_f32 v16, v108
    v_mfma_f32_16x16x32_bf16 a[36:39], v[160:163], v[24:27], a[36:39]
    ds_read_b128 v[240:243], v1 offset:0
    v_add_f32 v7, v7, v18
    v_mfma_f32_16x16x32_bf16 a[36:39], v[176:179], v[28:31], a[36:39]
    v_add_f32 v7, v7, v19
    v_mfma_f32_16x16x32_bf16 a[84:87], v[164:167], v[24:27], a[84:87]
    ds_read_b128 v[244:247], v1 offset:12288
    v_mfma_f32_16x16x32_bf16 a[84:87], v[180:183], v[28:31], a[84:87]
    s_waitcnt lgkmcnt(4)
    v_exp_f32 v17, v109
    v_mfma_f32_16x16x32_bf16 a[40:43], v[160:163], v[32:35], a[40:43]
    ds_read_b128 v[248:251], v1 offset:768
    v_cvt_pk_bf16_f32 v77, v18, v19
    v_mfma_f32_16x16x32_bf16 a[40:43], v[176:179], v[36:39], a[40:43]
    v_exp_f32 v18, v110
    v_mfma_f32_16x16x32_bf16 a[88:91], v[164:167], v[32:35], a[88:91]
    ds_read_b128 v[252:255], v1 offset:13056
    v_add_f32 v7, v7, v16
    v_mfma_f32_16x16x32_bf16 a[88:91], v[180:183], v[36:39], a[88:91]
    s_waitcnt lgkmcnt(4)
    v_add_f32 v7, v7, v17
    v_mfma_f32_16x16x32_bf16 a[44:47], v[160:163], v[40:43], a[44:47]
    ds_read_b128 v[24:27], v1 offset:1536
    v_mfma_f32_16x16x32_bf16 a[44:47], v[176:179], v[44:47], a[44:47]
    v_exp_f32 v19, v111
    v_mfma_f32_16x16x32_bf16 a[92:95], v[164:167], v[40:43], a[92:95]
    ds_read_b128 v[28:31], v1 offset:13824
    v_cvt_pk_bf16_f32 v78, v16, v17
    v_mfma_f32_16x16x32_bf16 a[92:95], v[180:183], v[44:47], a[92:95]
    s_waitcnt lgkmcnt(4)
    v_add_f32 v7, v7, v18
    v_add_f32 v7, v7, v19
    v_cvt_pk_bf16_f32 v79, v18, v19
    v_rcp_f32 v48, v48
    v_rcp_f32 v49, v49
    v_rcp_f32 v50, v50
    v_rcp_f32 v51, v51
    v_rcp_f32 v52, v52
    v_rcp_f32 v53, v53
    v_rcp_f32 v54, v54
    v_rcp_f32 v55, v55
    s_branch L_skip15
L_pad15:
    s_branch L_tb2_0
L_skip15:
    v_mfma_f32_16x16x32_bf16 a[96:99], v[168:171], v[240:243], a[96:99]
    ds_read_b128 v[32:35], v1 offset:2304
    v_accvgpr_read_b32 v224, a0
    v_mfma_f32_16x16x32_bf16 a[96:99], v[184:187], v[244:247], a[96:99]
    s_nop 3
    v_accvgpr_read_b32 v225, a4
    v_accvgpr_read_b32 v226, a8
    v_accvgpr_read_b32 v227, a12
    v_mfma_f32_16x16x32_bf16 a[144:147], v[172:175], v[240:243], a[144:147]
    ds_read_b128 v[36:39], v1 offset:14592
    v_accvgpr_read_b32 v228, a16
    v_mfma_f32_16x16x32_bf16 a[144:147], v[188:191], v[244:247], a[144:147]
    s_waitcnt lgkmcnt(4)
    v_accvgpr_read_b32 v229, a20
    v_accvgpr_read_b32 v230, a24
    v_accvgpr_read_b32 v231, a28
    v_accvgpr_read_b32 v232, a32
    v_accvgpr_read_b32 v233, a36
    v_accvgpr_read_b32 v234, a40
    v_mfma_f32_16x16x32_bf16 a[100:103], v[168:171], v[248:251], a[100:103]
    ds_read_b128 v[40:43], v21 offset:0
    v_accvgpr_read_b32 v235, a44
    v_mfma_f32_16x16x32_bf16 a[100:103], v[184:187], v[252:255], a[100:103]
    v_mul_f32 v224, v224, v48
    v_mul_f32 v225, v225, v48
    v_mul_f32 v226, v226, v48
    v_mul_f32 v227, v227, v48
    v_mul_f32 v228, v228, v48
    v_mul_f32 v229, v229, v48
    v_mfma_f32_16x16x32_bf16 a[148:151], v[172:175], v[248:251], a[148:151]
    ds_read_b128 v[44:47], v21 offset:12288
    v_mul_f32 v230, v230, v48
    v_mfma_f32_16x16x32_bf16 a[148:151], v[188:191], v[252:255], a[148:151]
    s_waitcnt lgkmcnt(4)
    v_mul_f32 v231, v231, v48
    v_mul_f32 v232, v232, v48
    v_mul_f32 v233, v233, v48
    v_mul_f32 v234, v234, v48
    v_mul_f32 v235, v235, v48
    v_cvt_pk_bf16_f32 v224, v224, v225
    v_mfma_f32_16x16x32_bf16 a[104:107], v[168:171], v[24:27], a[104:107]
    ds_read_b128 v[240:243], v21 offset:768
    v_cvt_pk_bf16_f32 v225, v226, v227
    v_mfma_f32_16x16x32_bf16 a[104:107], v[184:187], v[28:31], a[104:107]
    v_cvt_pk_bf16_f32 v226, v228, v229
    v_cvt_pk_bf16_f32 v227, v230, v231
    v_cvt_pk_bf16_f32 v228, v232, v233
    v_cvt_pk_bf16_f32 v229, v234, v235
    v_mfma_f32_16x16x32_bf16 a[152:155], v[172:175], v[24:27], a[152:155]
    ds_read_b128 v[244:247], v21 offset:13056
    v_mfma_f32_16x16x32_bf16 a[152:155], v[188:191], v[28:31], a[152:155]
    s_waitcnt lgkmcnt(4)
    buffer_store_dwordx4 v[224:227], v60, s[12:15], s33 offen offset:0 sc0 sc1
    buffer_store_dwordx2 v[228:229], v61, s[12:15], s33 offen offset:256 sc0 sc1
    v_mfma_f32_16x16x32_bf16 a[108:111], v[168:171], v[32:35], a[108:111]
    ds_read_b128 v[248:251], v21 offset:1536
    v_accvgpr_read_b32 v144, a1
    v_mfma_f32_16x16x32_bf16 a[108:111], v[184:187], v[36:39], a[108:111]
    v_accvgpr_read_b32 v145, a5
    v_accvgpr_read_b32 v146, a9
    v_accvgpr_read_b32 v147, a13
    v_accvgpr_read_b32 v148, a17
    v_accvgpr_read_b32 v149, a21
    v_accvgpr_read_b32 v150, a25
    v_mfma_f32_16x16x32_bf16 a[156:159], v[172:175], v[32:35], a[156:159]
    ds_read_b128 v[252:255], v21 offset:13824
    v_accvgpr_read_b32 v151, a29
    v_mfma_f32_16x16x32_bf16 a[156:159], v[188:191], v[36:39], a[156:159]
    s_waitcnt lgkmcnt(4)
    v_accvgpr_read_b32 v152, a33
    v_accvgpr_read_b32 v153, a37
    v_accvgpr_read_b32 v154, a41
    v_accvgpr_read_b32 v155, a45
    v_mul_f32 v144, v144, v49
    v_mul_f32 v145, v145, v49
    v_mfma_f32_16x16x32_bf16 a[112:115], v[168:171], v[40:43], a[112:115]
    ds_read_b128 v[24:27], v21 offset:2304
    v_mul_f32 v146, v146, v49
    v_mfma_f32_16x16x32_bf16 a[112:115], v[184:187], v[44:47], a[112:115]
    v_mul_f32 v147, v147, v49
    v_mul_f32 v148, v148, v49
    v_mul_f32 v149, v149, v49
    v_mul_f32 v150, v150, v49
    v_mul_f32 v151, v151, v49
    v_mul_f32 v152, v152, v49
    v_mfma_f32_16x16x32_bf16 a[160:163], v[172:175], v[40:43], a[160:163]
    ds_read_b128 v[28:31], v21 offset:14592
    v_mul_f32 v153, v153, v49
    v_mfma_f32_16x16x32_bf16 a[160:163], v[188:191], v[44:47], a[160:163]
    s_waitcnt lgkmcnt(4)
    v_mul_f32 v154, v154, v49
    v_mul_f32 v155, v155, v49
    v_cvt_pk_bf16_f32 v144, v144, v145
    v_cvt_pk_bf16_f32 v145, v146, v147
    v_cvt_pk_bf16_f32 v146, v148, v149
    v_cvt_pk_bf16_f32 v147, v150, v151
    v_mfma_f32_16x16x32_bf16 a[116:119], v[168:171], v[240:243], a[116:119]
    ds_read_b128 v[32:35], v22 offset:0
    v_cvt_pk_bf16_f32 v148, v152, v153
    v_mfma_f32_16x16x32_bf16 a[116:119], v[184:187], v[244:247], a[116:119]
    v_cvt_pk_bf16_f32 v149, v154, v155
    buffer_store_dwordx4 v[144:147], v60, s[12:15], s33 offen offset:384 sc0 sc1
    v_mfma_f32_16x16x32_bf16 a[164:167], v[172:175], v[240:243], a[164:167]
    ds_read_b128 v[36:39], v22 offset:12288
    v_mfma_f32_16x16x32_bf16 a[164:167], v[188:191], v[244:247], a[164:167]
    s_waitcnt lgkmcnt(4)
    buffer_store_dwordx2 v[148:149], v61, s[12:15], s33 offen offset:640 sc0 sc1
    v_accvgpr_read_b32 v224, a2
    v_accvgpr_read_b32 v225, a6
    v_accvgpr_read_b32 v226, a10
    v_mfma_f32_16x16x32_bf16 a[120:123], v[168:171], v[248:251], a[120:123]
    ds_read_b128 v[40:43], v22 offset:768
    v_accvgpr_read_b32 v227, a14
    v_mfma_f32_16x16x32_bf16 a[120:123], v[184:187], v[252:255], a[120:123]
    v_accvgpr_read_b32 v228, a18
    v_accvgpr_read_b32 v229, a22
    v_accvgpr_read_b32 v230, a26
    v_accvgpr_read_b32 v231, a30
    v_accvgpr_read_b32 v232, a34
    v_accvgpr_read_b32 v233, a38
    v_mfma_f32_16x16x32_bf16 a[168:171], v[172:175], v[248:251], a[168:171]
    ds_read_b128 v[44:47], v22 offset:13056
    v_accvgpr_read_b32 v234, a42
    v_mfma_f32_16x16x32_bf16 a[168:171], v[188:191], v[252:255], a[168:171]
    s_waitcnt lgkmcnt(4)
    v_accvgpr_read_b32 v235, a46
    v_mul_f32 v224, v224, v50
    v_mul_f32 v225, v225, v50
    v_mul_f32 v226, v226, v50
    v_mul_f32 v227, v227, v50
    v_mul_f32 v228, v228, v50
    v_mfma_f32_16x16x32_bf16 a[124:127], v[168:171], v[24:27], a[124:127]
    ds_read_b128 v[240:243], v22 offset:1536
    v_mul_f32 v229, v229, v50
    v_mfma_f32_16x16x32_bf16 a[124:127], v[184:187], v[28:31], a[124:127]
    v_exp_f32 v16, v88
    v_exp_f32 v17, v89
    v_exp_f32 v18, v90
    v_mfma_f32_16x16x32_bf16 a[172:175], v[172:175], v[24:27], a[172:175]
    ds_read_b128 v[244:247], v22 offset:13824
    v_add_f32 v6, v6, v16
    v_mfma_f32_16x16x32_bf16 a[172:175], v[188:191], v[28:31], a[172:175]
    s_waitcnt lgkmcnt(4)
    v_add_f32 v6, v6, v17
    v_exp_f32 v19, v91
    v_cvt_pk_bf16_f32 v88, v16, v17
    v_exp_f32 v16, v120
    v_mfma_f32_16x16x32_bf16 a[128:131], v[168:171], v[32:35], a[128:131]
    ds_read_b128 v[248:251], v22 offset:2304
    v_add_f32 v6, v6, v18
    v_mfma_f32_16x16x32_bf16 a[128:131], v[184:187], v[36:39], a[128:131]
    v_add_f32 v6, v6, v19
    v_exp_f32 v17, v121
    v_cvt_pk_bf16_f32 v89, v18, v19
    v_exp_f32 v18, v122
    v_mfma_f32_16x16x32_bf16 a[176:179], v[172:175], v[32:35], a[176:179]
    ds_read_b128 v[252:255], v22 offset:14592
    v_add_f32 v6, v6, v16
    v_mfma_f32_16x16x32_bf16 a[176:179], v[188:191], v[36:39], a[176:179]
    s_waitcnt lgkmcnt(4)
    v_add_f32 v6, v6, v17
    v_exp_f32 v19, v123
    v_cvt_pk_bf16_f32 v90, v16, v17
    v_add_f32 v6, v6, v18
    v_add_f32 v6, v6, v19
    v_mfma_f32_16x16x32_bf16 a[132:135], v[168:171], v[40:43], a[132:135]
    ds_read_b128 v[24:27], v2 offset:0
    v_cvt_pk_bf16_f32 v91, v18, v19
    v_mfma_f32_16x16x32_bf16 a[132:135], v[184:187], v[44:47], a[132:135]
    v_mul_f32 v230, v230, v50
    v_mul_f32 v231, v231, v50
    v_mul_f32 v232, v232, v50
    v_mul_f32 v233, v233, v50
    v_mul_f32 v234, v234, v50
    v_mul_f32 v235, v235, v50
    v_mfma_f32_16x16x32_bf16 a[180:183], v[172:175], v[40:43], a[180:183]
    ds_read_b128 v[28:31], v3 offset:0
    v_cvt_pk_bf16_f32 v224, v224, v225
    v_mfma_f32_16x16x32_bf16 a[180:183], v[188:191], v[44:47], a[180:183]
    s_waitcnt lgkmcnt(4)
    v_cvt_pk_bf16_f32 v225, v226, v227
    v_cvt_pk_bf16_f32 v226, v228, v229
    v_cvt_pk_bf16_f32 v227, v230, v231
    v_cvt_pk_bf16_f32 v228, v232, v233
    v_cvt_pk_bf16_f32 v229, v234, v235
    v_mfma_f32_16x16x32_bf16 a[136:139], v[168:171], v[240:243], a[136:139]
    ds_read_b128 v[32:35], v2 offset:6144
    v_mfma_f32_16x16x32_bf16 a[136:139], v[184:187], v[244:247], a[136:139]
    buffer_store_dwordx4 v[224:227], v60, s[12:15], s33 offen offset:768 sc0 sc1
    buffer_store_dwordx2 v[228:229], v61, s[12:15], s33 offen offset:1024 sc0 sc1
    v_mfma_f32_16x16x32_bf16 a[184:187], v[172:175], v[240:243], a[184:187]
    ds_read_b128 v[36:39], v3 offset:6144
    v_accvgpr_read_b32 v144, a3
    v_mfma_f32_16x16x32_bf16 a[184:187], v[188:191], v[244:247], a[184:187]
    s_waitcnt lgkmcnt(4)
    v_accvgpr_read_b32 v145, a7
    v_accvgpr_read_b32 v146, a11
    v_accvgpr_read_b32 v147, a15
    v_accvgpr_read_b32 v148, a19
    v_accvgpr_read_b32 v149, a23
    v_accvgpr_read_b32 v150, a27
    v_mfma_f32_16x16x32_bf16 a[140:143], v[168:171], v[248:251], a[140:143]
    ds_read_b128 v[40:43], v2 offset:128
    v_accvgpr_read_b32 v151, a31
    v_mfma_f32_16x16x32_bf16 a[140:143], v[184:187], v[252:255], a[140:143]
    v_accvgpr_read_b32 v152, a35
    v_accvgpr_read_b32 v153, a39
    v_accvgpr_read_b32 v154, a43
    v_accvgpr_read_b32 v155, a47
    v_mul_f32 v144, v144, v51
    v_mul_f32 v145, v145, v51
    v_mfma_f32_16x16x32_bf16 a[188:191], v[172:175], v[248:251], a[188:191]
    ds_read_b128 v[44:47], v3 offset:128
    v_mul_f32 v146, v146, v51
    v_mfma_f32_16x16x32_bf16 a[188:191], v[188:191], v[252:255], a[188:191]
    s_waitcnt lgkmcnt(4)
    v_mul_f32 v147, v147, v51
    v_mul_f32 v148, v148, v51
    v_mul_f32 v149, v149, v51
    v_mul_f32 v150, v150, v51
    v_mul_f32 v151, v151, v51
    v_mul_f32 v152, v152, v51
    v_mfma_f32_16x16x32_bf16 v[168:171], v[24:27], a[240:243], v[136:139]
    ds_read_b128 v[240:243], v2 offset:6272
    v_mul_f32 v153, v153, v51
    v_mfma_f32_16x16x32_bf16 v[168:171], v[28:31], a[244:247], v[168:171]
    v_exp_f32 v16, v92
    v_exp_f32 v17, v93
    v_exp_f32 v18, v94
    v_mfma_f32_16x16x32_bf16 v[172:175], v[24:27], v[200:203], v[140:143]
    ds_read_b128 v[244:247], v3 offset:6272
    v_add_f32 v7, v7, v16
    v_mfma_f32_16x16x32_bf16 v[172:175], v[28:31], v[204:207], v[172:175]
    s_waitcnt lgkmcnt(4)
    v_add_f32 v7, v7, v17
    v_exp_f32 v19, v95
    v_cvt_pk_bf16_f32 v92, v16, v17
    v_exp_f32 v16, v124
    v_mfma_f32_16x16x32_bf16 v[104:107], v[32:35], a[240:243], v[136:139]
    ds_read_b128 v[248:251], v2 offset:256
    v_add_f32 v7, v7, v18
    v_mfma_f32_16x16x32_bf16 v[104:107], v[36:39], a[244:247], v[104:107]
    v_add_f32 v7, v7, v19
    v_exp_f32 v17, v125
    v_cvt_pk_bf16_f32 v93, v18, v19
    v_exp_f32 v18, v126
    v_mfma_f32_16x16x32_bf16 v[108:111], v[32:35], v[200:203], v[140:143]
    ds_read_b128 v[252:255], v3 offset:256
    v_add_f32 v7, v7, v16
    v_mfma_f32_16x16x32_bf16 v[108:111], v[36:39], v[204:207], v[108:111]
    s_waitcnt lgkmcnt(4)
    v_add_f32 v7, v7, v17
    v_exp_f32 v19, v127
    v_cvt_pk_bf16_f32 v94, v16, v17
    v_add_f32 v7, v7, v18
    v_add_f32 v7, v7, v19
    v_mfma_f32_16x16x32_bf16 v[168:171], v[40:43], a[248:251], v[168:171]
    ds_read_b128 v[24:27], v2 offset:6400
    v_cvt_pk_bf16_f32 v95, v18, v19
    v_mfma_f32_16x16x32_bf16 v[168:171], v[44:47], a[252:255], v[168:171]
    v_mul_f32 v154, v154, v51
    v_mul_f32 v155, v155, v51
    v_cvt_pk_bf16_f32 v144, v144, v145
    v_cvt_pk_bf16_f32 v145, v146, v147
    v_cvt_pk_bf16_f32 v146, v148, v149
    v_cvt_pk_bf16_f32 v147, v150, v151
    v_mfma_f32_16x16x32_bf16 v[172:175], v[40:43], v[208:211], v[172:175]
    ds_read_b128 v[28:31], v3 offset:6400
    v_cvt_pk_bf16_f32 v148, v152, v153
    v_mfma_f32_16x16x32_bf16 v[172:175], v[44:47], v[212:215], v[172:175]
    s_waitcnt lgkmcnt(4)
    v_cvt_pk_bf16_f32 v149, v154, v155
    buffer_store_dwordx4 v[144:147], v60, s[12:15], s33 offen offset:1152 sc0 sc1
    v_mfma_f32_16x16x32_bf16 v[104:107], v[240:243], a[248:251], v[104:107]
    ds_read_b128 v[32:35], v2 offset:12288
    v_mfma_f32_16x16x32_bf16 v[104:107], v[244:247], a[252:255], v[104:107]
    buffer_store_dwordx2 v[148:149], v61, s[12:15], s33 offen offset:1408 sc0 sc1
    v_accvgpr_read_b32 v224, a48
    v_accvgpr_read_b32 v225, a52
    v_accvgpr_read_b32 v226, a56
    v_mfma_f32_16x16x32_bf16 v[108:111], v[240:243], v[208:211], v[108:111]
    ds_read_b128 v[36:39], v3 offset:12288
    v_accvgpr_read_b32 v227, a60
    v_mfma_f32_16x16x32_bf16 v[108:111], v[244:247], v[212:215], v[108:111]
    s_waitcnt lgkmcnt(4)
    v_accvgpr_read_b32 v228, a64
    v_accvgpr_read_b32 v229, a68
    v_accvgpr_read_b32 v230, a72
    v_accvgpr_read_b32 v231, a76
    v_accvgpr_read_b32 v232, a80
    v_accvgpr_read_b32 v233, a84
    v_mfma_f32_16x16x32_bf16 v[168:171], v[248:251], v[192:195], v[168:171]
    ds_read_b128 v[40:43], v2 offset:18432
    v_accvgpr_read_b32 v234, a88
    v_mfma_f32_16x16x32_bf16 v[168:171], v[252:255], v[196:199], v[168:171]
    v_accvgpr_read_b32 v235, a92
    v_mul_f32 v224, v224, v52
    v_mul_f32 v225, v225, v52
    v_mul_f32 v226, v226, v52
    v_mul_f32 v227, v227, v52
    v_mul_f32 v228, v228, v52
    v_mfma_f32_16x16x32_bf16 v[172:175], v[248:251], v[216:219], v[172:175]
    ds_read_b128 v[44:47], v3 offset:18432
    v_mul_f32 v229, v229, v52
    v_mfma_f32_16x16x32_bf16 v[172:175], v[252:255], v[220:223], v[172:175]
    s_waitcnt lgkmcnt(4)
    v_mul_f32 v230, v230, v52
    v_mul_f32 v231, v231, v52
    v_mul_f32 v232, v232, v52
    v_mul_f32 v233, v233, v52
    v_mul_f32 v234, v234, v52
    v_mul_f32 v235, v235, v52
    v_mfma_f32_16x16x32_bf16 v[104:107], v[24:27], v[192:195], v[104:107]
    ds_read_b128 v[240:243], v2 offset:12416
    v_cvt_pk_bf16_f32 v224, v224, v225
    v_mfma_f32_16x16x32_bf16 v[104:107], v[28:31], v[196:199], v[104:107]
    v_cvt_pk_bf16_f32 v225, v226, v227
    v_cvt_pk_bf16_f32 v226, v228, v229
    v_cvt_pk_bf16_f32 v227, v230, v231
    v_cvt_pk_bf16_f32 v228, v232, v233
    v_cvt_pk_bf16_f32 v229, v234, v235
    v_mfma_f32_16x16x32_bf16 v[108:111], v[24:27], v[216:219], v[108:111]
    ds_read_b128 v[244:247], v3 offset:12416
    v_mfma_f32_16x16x32_bf16 v[108:111], v[28:31], v[220:223], v[108:111]
    s_waitcnt lgkmcnt(4)
    buffer_store_dwordx4 v[224:227], v60, s[12:15], s34 offen offset:0 sc0 sc1
    buffer_store_dwordx2 v[228:229], v61, s[12:15], s34 offen offset:256 sc0 sc1
    v_mfma_f32_16x16x32_bf16 v[184:187], v[32:35], a[240:243], v[136:139]
    ds_read_b128 v[248:251], v2 offset:18560
    v_accvgpr_read_b32 v144, a49
    v_mfma_f32_16x16x32_bf16 v[184:187], v[36:39], a[244:247], v[184:187]
    v_accvgpr_read_b32 v145, a53
    v_accvgpr_read_b32 v146, a57
    v_accvgpr_read_b32 v147, a61
    v_accvgpr_read_b32 v148, a65
    v_accvgpr_read_b32 v149, a69
    v_accvgpr_read_b32 v150, a73
    v_mfma_f32_16x16x32_bf16 v[188:191], v[32:35], v[200:203], v[140:143]
    ds_read_b128 v[252:255], v3 offset:18560
    v_accvgpr_read_b32 v151, a77
    v_mfma_f32_16x16x32_bf16 v[188:191], v[36:39], v[204:207], v[188:191]
    s_waitcnt lgkmcnt(4)
    v_accvgpr_read_b32 v152, a81
    v_accvgpr_read_b32 v153, a85
    v_accvgpr_read_b32 v154, a89
    v_accvgpr_read_b32 v155, a93
    v_mul_f32 v144, v144, v53
    v_mul_f32 v145, v145, v53
    v_mfma_f32_16x16x32_bf16 v[120:123], v[40:43], a[240:243], v[136:139]
    ds_read_b128 v[24:27], v2 offset:12544
    v_mul_f32 v146, v146, v53
    v_mfma_f32_16x16x32_bf16 v[120:123], v[44:47], a[244:247], v[120:123]
    v_exp_f32 v16, v168
    v_exp_f32 v17, v169
    v_exp_f32 v18, v170
    v_mfma_f32_16x16x32_bf16 v[124:127], v[40:43], v[200:203], v[140:143]
    ds_read_b128 v[28:31], v3 offset:12544
    v_add_f32 v6, v6, v16
    v_mfma_f32_16x16x32_bf16 v[124:127], v[44:47], v[204:207], v[124:127]
    s_waitcnt lgkmcnt(4)
    v_add_f32 v6, v6, v17
    v_exp_f32 v19, v171
    v_cvt_pk_bf16_f32 v168, v16, v17
    v_exp_f32 v16, v104
    v_mfma_f32_16x16x32_bf16 v[184:187], v[240:243], a[248:251], v[184:187]
    ds_read_b128 v[32:35], v2 offset:18688
    v_add_f32 v6, v6, v18
    v_mfma_f32_16x16x32_bf16 v[184:187], v[244:247], a[252:255], v[184:187]
    v_add_f32 v6, v6, v19
    v_exp_f32 v17, v105
    v_cvt_pk_bf16_f32 v169, v18, v19
    v_exp_f32 v18, v106
    v_mfma_f32_16x16x32_bf16 v[188:191], v[240:243], v[208:211], v[188:191]
    ds_read_b128 v[36:39], v3 offset:18688
    v_add_f32 v6, v6, v16
    v_mfma_f32_16x16x32_bf16 v[188:191], v[244:247], v[212:215], v[188:191]
    s_waitcnt lgkmcnt(4)
    v_add_f32 v6, v6, v17
    v_exp_f32 v19, v107
    v_cvt_pk_bf16_f32 v170, v16, v17
    v_exp_f32 v16, v172
    v_mfma_f32_16x16x32_bf16 v[120:123], v[248:251], a[248:251], v[120:123]
    ds_read_b128 v[40:43], v9 offset:0
    v_add_f32 v6, v6, v18
    v_mfma_f32_16x16x32_bf16 v[120:123], v[252:255], a[252:255], v[120:123]
    v_add_f32 v6, v6, v19
    v_exp_f32 v17, v173
    v_cvt_pk_bf16_f32 v171, v18, v19
    v_exp_f32 v18, v174
    v_mfma_f32_16x16x32_bf16 v[124:127], v[248:251], v[208:211], v[124:127]
    ds_read_b128 v[44:47], v9 offset:12288
    v_add_f32 v7, v7, v16
    v_mfma_f32_16x16x32_bf16 v[124:127], v[252:255], v[212:215], v[124:127]
    s_waitcnt lgkmcnt(4)
    v_add_f32 v7, v7, v17
    v_exp_f32 v19, v175
    v_cvt_pk_bf16_f32 v172, v16, v17
    v_exp_f32 v16, v108
    v_mfma_f32_16x16x32_bf16 v[184:187], v[24:27], v[192:195], v[184:187]
    ds_read_b128 v[240:243], v9 offset:768
    v_add_f32 v7, v7, v18
    v_mfma_f32_16x16x32_bf16 v[184:187], v[28:31], v[196:199], v[184:187]
    v_add_f32 v7, v7, v19
    v_exp_f32 v17, v109
    v_cvt_pk_bf16_f32 v173, v18, v19
    v_exp_f32 v18, v110
    v_mfma_f32_16x16x32_bf16 v[188:191], v[24:27], v[216:219], v[188:191]
    ds_read_b128 v[244:247], v9 offset:13056
    v_add_f32 v7, v7, v16
    v_mfma_f32_16x16x32_bf16 v[188:191], v[28:31], v[220:223], v[188:191]
    s_waitcnt lgkmcnt(4)
    v_add_f32 v7, v7, v17
    v_exp_f32 v19, v111
    v_cvt_pk_bf16_f32 v174, v16, v17
    v_add_f32 v7, v7, v18
    v_add_f32 v7, v7, v19
    v_mfma_f32_16x16x32_bf16 v[120:123], v[32:35], v[192:195], v[120:123]
    ds_read_b128 v[248:251], v9 offset:1536
    v_cvt_pk_bf16_f32 v175, v18, v19
    v_mfma_f32_16x16x32_bf16 v[120:123], v[36:39], v[196:199], v[120:123]
    v_mul_f32 v147, v147, v53
    v_mul_f32 v148, v148, v53
    v_mul_f32 v149, v149, v53
    v_mul_f32 v150, v150, v53
    v_mul_f32 v151, v151, v53
    v_mul_f32 v152, v152, v53
    v_mfma_f32_16x16x32_bf16 v[124:127], v[32:35], v[216:219], v[124:127]
    ds_read_b128 v[252:255], v9 offset:13824
    v_mul_f32 v153, v153, v53
    v_mfma_f32_16x16x32_bf16 v[124:127], v[36:39], v[220:223], v[124:127]
    s_waitcnt lgkmcnt(4)
    v_mul_f32 v154, v154, v53
    v_mul_f32 v155, v155, v53
    v_cvt_pk_bf16_f32 v144, v144, v145
    v_cvt_pk_bf16_f32 v145, v146, v147
    v_cvt_pk_bf16_f32 v146, v148, v149
    v_cvt_pk_bf16_f32 v147, v150, v151
    v_mfma_f32_16x16x32_bf16 a[96:99], v[72:75], v[40:43], a[96:99]
    ds_read_b128 v[24:27], v9 offset:2304
    v_cvt_pk_bf16_f32 v148, v152, v153
    v_mfma_f32_16x16x32_bf16 a[96:99], v[88:91], v[44:47], a[96:99]
    v_exp_f32 v16, v184
    v_exp_f32 v17, v185
    v_exp_f32 v18, v186
    v_mfma_f32_16x16x32_bf16 a[144:147], v[76:79], v[40:43], a[144:147]
    ds_read_b128 v[28:31], v9 offset:14592
    v_add_f32 v6, v6, v16
    v_mfma_f32_16x16x32_bf16 a[144:147], v[92:95], v[44:47], a[144:147]
    s_waitcnt lgkmcnt(4)
    v_add_f32 v6, v6, v17
    v_exp_f32 v19, v187
    v_cvt_pk_bf16_f32 v184, v16, v17
    v_exp_f32 v16, v120
    v_mfma_f32_16x16x32_bf16 a[100:103], v[72:75], v[240:243], a[100:103]
    ds_read_b128 v[32:35], v10 offset:0
    v_add_f32 v6, v6, v18
    v_mfma_f32_16x16x32_bf16 a[100:103], v[88:91], v[244:247], a[100:103]
    v_add_f32 v6, v6, v19
    v_exp_f32 v17, v121
    v_cvt_pk_bf16_f32 v185, v18, v19
    v_exp_f32 v18, v122
    v_mfma_f32_16x16x32_bf16 a[148:151], v[76:79], v[240:243], a[148:151]
    ds_read_b128 v[36:39], v10 offset:12288
    v_add_f32 v6, v6, v16
    v_mfma_f32_16x16x32_bf16 a[148:151], v[92:95], v[244:247], a[148:151]
    s_waitcnt lgkmcnt(4)
    v_add_f32 v6, v6, v17
    v_exp_f32 v19, v123
    v_cvt_pk_bf16_f32 v186, v16, v17
    v_exp_f32 v16, v188
    v_mfma_f32_16x16x32_bf16 a[104:107], v[72:75], v[248:251], a[104:107]
    ds_read_b128 v[40:43], v10 offset:768
    v_add_f32 v6, v6, v18
    v_mfma_f32_16x16x32_bf16 a[104:107], v[88:91], v[252:255], a[104:107]
    v_add_f32 v6, v6, v19
    v_exp_f32 v17, v189
    v_cvt_pk_bf16_f32 v187, v18, v19
    v_exp_f32 v18, v190
    v_mfma_f32_16x16x32_bf16 a[152:155], v[76:79], v[248:251], a[152:155]
    ds_read_b128 v[44:47], v10 offset:13056
    v_add_f32 v7, v7, v16
    v_mfma_f32_16x16x32_bf16 a[152:155], v[92:95], v[252:255], a[152:155]
    s_waitcnt lgkmcnt(4)
    v_add_f32 v7, v7, v17
    v_exp_f32 v19, v191
    v_cvt_pk_bf16_f32 v188, v16, v17
    v_exp_f32 v16, v124
    v_mfma_f32_16x16x32_bf16 a[108:111], v[72:75], v[24:27], a[108:111]
    ds_read_b128 v[240:243], v10 offset:1536
    v_add_f32 v7, v7, v18
    v_mfma_f32_16x16x32_bf16 a[108:111], v[88:91], v[28:31], a[108:111]
    v_add_f32 v7, v7, v19
    v_exp_f32 v17, v125
    v_cvt_pk_bf16_f32 v189, v18, v19
    v_exp_f32 v18, v126
    v_mfma_f32_16x16x32_bf16 a[156:159], v[76:79], v[24:27], a[156:159]
    ds_read_b128 v[244:247], v10 offset:13824
    v_add_f32 v7, v7, v16
    v_mfma_f32_16x16x32_bf16 a[156:159], v[92:95], v[28:31], a[156:159]
    s_waitcnt lgkmcnt(4)
    v_add_f32 v7, v7, v17
    v_exp_f32 v19, v127
    v_cvt_pk_bf16_f32 v190, v16, v17
    v_add_f32 v7, v7, v18
    v_add_f32 v7, v7, v19
    v_mfma_f32_16x16x32_bf16 a[112:115], v[72:75], v[32:35], a[112:115]
    ds_read_b128 v[248:251], v10 offset:2304
    v_cvt_pk_bf16_f32 v191, v18, v19
    v_mfma_f32_16x16x32_bf16 a[112:115], v[88:91], v[36:39], a[112:115]
    v_cvt_pk_bf16_f32 v149, v154, v155
    buffer_store_dwordx4 v[144:147], v60, s[12:15], s34 offen offset:384 sc0 sc1
    v_mfma_f32_16x16x32_bf16 a[160:163], v[76:79], v[32:35], a[160:163]
    ds_read_b128 v[252:255], v10 offset:14592
    v_mfma_f32_16x16x32_bf16 a[160:163], v[92:95], v[36:39], a[160:163]
    s_waitcnt lgkmcnt(4)
    buffer_store_dwordx2 v[148:149], v61, s[12:15], s34 offen offset:640 sc0 sc1
    v_accvgpr_read_b32 v224, a50
    v_accvgpr_read_b32 v225, a54
    v_accvgpr_read_b32 v226, a58
    v_mfma_f32_16x16x32_bf16 a[116:119], v[72:75], v[40:43], a[116:119]
    ds_read_b128 v[24:27], v11 offset:0
    v_accvgpr_read_b32 v227, a62
    v_mfma_f32_16x16x32_bf16 a[116:119], v[88:91], v[44:47], a[116:119]
    v_accvgpr_read_b32 v228, a66
    v_accvgpr_read_b32 v229, a70
    v_accvgpr_read_b32 v230, a74
    v_accvgpr_read_b32 v231, a78
    v_accvgpr_read_b32 v232, a82
    v_accvgpr_read_b32 v233, a86
    v_mfma_f32_16x16x32_bf16 a[164:167], v[76:79], v[40:43], a[164:167]
    ds_read_b128 v[28:31], v11 offset:12288
    v_accvgpr_read_b32 v234, a90
    v_mfma_f32_16x16x32_bf16 a[164:167], v[92:95], v[44:47], a[164:167]
    s_waitcnt lgkmcnt(4)
    v_accvgpr_read_b32 v235, a94
    v_mul_f32 v224, v224, v54
    v_mul_f32 v225, v225, v54
    v_mul_f32 v226, v226, v54
    v_mul_f32 v227, v227, v54
    v_mul_f32 v228, v228, v54
    v_mfma_f32_16x16x32_bf16 a[120:123], v[72:75], v[240:243], a[120:123]
    ds_read_b128 v[32:35], v11 offset:768
    v_mul_f32 v229, v229, v54
    v_mfma_f32_16x16x32_bf16 a[120:123], v[88:91], v[244:247], a[120:123]
    v_mul_f32 v230, v230, v54
    v_mul_f32 v231, v231, v54
    v_mul_f32 v232, v232, v54
    v_mul_f32 v233, v233, v54
    v_mul_f32 v234, v234, v54
    v_mul_f32 v235, v235, v54
    v_mfma_f32_16x16x32_bf16 a[168:171], v[76:79], v[240:243], a[168:171]
    ds_read_b128 v[36:39], v11 offset:13056
    v_cvt_pk_bf16_f32 v224, v224, v225
    v_mfma_f32_16x16x32_bf16 a[168:171], v[92:95], v[244:247], a[168:171]
    s_waitcnt lgkmcnt(4)
    v_cvt_pk_bf16_f32 v225, v226, v227
    v_cvt_pk_bf16_f32 v226, v228, v229
    v_cvt_pk_bf16_f32 v227, v230, v231
    v_cvt_pk_bf16_f32 v228, v232, v233
    v_cvt_pk_bf16_f32 v229, v234, v235
    v_mfma_f32_16x16x32_bf16 a[124:127], v[72:75], v[248:251], a[124:127]
    ds_read_b128 v[40:43], v11 offset:1536
    v_mfma_f32_16x16x32_bf16 a[124:127], v[88:91], v[252:255], a[124:127]
    buffer_store_dwordx4 v[224:227], v60, s[12:15], s34 offen offset:768 sc0 sc1
    buffer_store_dwordx2 v[228:229], v61, s[12:15], s34 offen offset:1024 sc0 sc1
    v_mfma_f32_16x16x32_bf16 a[172:175], v[76:79], v[248:251], a[172:175]
    ds_read_b128 v[44:47], v11 offset:13824
    v_accvgpr_read_b32 v144, a51
    v_mfma_f32_16x16x32_bf16 a[172:175], v[92:95], v[252:255], a[172:175]
    s_waitcnt lgkmcnt(4)
    v_accvgpr_read_b32 v145, a55
    v_accvgpr_read_b32 v146, a59
    v_accvgpr_read_b32 v147, a63
    v_accvgpr_read_b32 v148, a67
    v_accvgpr_read_b32 v149, a71
    v_accvgpr_read_b32 v150, a75
    v_mfma_f32_16x16x32_bf16 a[128:131], v[72:75], v[24:27], a[128:131]
    ds_read_b128 v[240:243], v11 offset:2304
    v_accvgpr_read_b32 v151, a79
    v_mfma_f32_16x16x32_bf16 a[128:131], v[88:91], v[28:31], a[128:131]
    v_accvgpr_read_b32 v152, a83
    v_accvgpr_read_b32 v153, a87
    v_accvgpr_read_b32 v154, a91
    v_accvgpr_read_b32 v155, a95
    v_mul_f32 v144, v144, v55
    v_mul_f32 v145, v145, v55
    v_mfma_f32_16x16x32_bf16 a[176:179], v[76:79], v[24:27], a[176:179]
    ds_read_b128 v[244:247], v11 offset:14592
    v_mul_f32 v146, v146, v55
    v_mfma_f32_16x16x32_bf16 a[176:179], v[92:95], v[28:31], a[176:179]
    s_waitcnt lgkmcnt(4)
    v_mul_f32 v147, v147, v55
    v_mul_f32 v148, v148, v55
    v_mul_f32 v149, v149, v55
    v_mul_f32 v150, v150, v55
    v_mul_f32 v151, v151, v55
    v_mul_f32 v152, v152, v55
    v_mfma_f32_16x16x32_bf16 a[132:135], v[72:75], v[32:35], a[132:135]
    ds_read_b128 v[248:251], v12 offset:0
    v_mul_f32 v153, v153, v55
    v_mfma_f32_16x16x32_bf16 a[132:135], v[88:91], v[36:39], a[132:135]
    v_mul_f32 v154, v154, v55
    v_mul_f32 v155, v155, v55
    v_cvt_pk_bf16_f32 v144, v144, v145
    v_cvt_pk_bf16_f32 v145, v146, v147
    v_cvt_pk_bf16_f32 v146, v148, v149
    v_cvt_pk_bf16_f32 v147, v150, v151
    v_mfma_f32_16x16x32_bf16 a[180:183], v[76:79], v[32:35], a[180:183]
    ds_read_b128 v[252:255], v12 offset:12288
    v_cvt_pk_bf16_f32 v148, v152, v153
    v_mfma_f32_16x16x32_bf16 a[180:183], v[92:95], v[36:39], a[180:183]
    s_waitcnt lgkmcnt(4)
    v_cvt_pk_bf16_f32 v149, v154, v155
    buffer_store_dwordx4 v[144:147], v60, s[12:15], s34 offen offset:1152 sc0 sc1
    v_mfma_f32_16x16x32_bf16 a[136:139], v[72:75], v[40:43], a[136:139]
    ds_read_b128 v[24:27], v12 offset:768
    v_mfma_f32_16x16x32_bf16 a[136:139], v[88:91], v[44:47], a[136:139]
    buffer_store_dwordx2 v[148:149], v61, s[12:15], s34 offen offset:1408 sc0 sc1
    v_mfma_f32_16x16x32_bf16 a[184:187], v[76:79], v[40:43], a[184:187]
    ds_read_b128 v[28:31], v12 offset:13056
    v_mfma_f32_16x16x32_bf16 a[184:187], v[92:95], v[44:47], a[184:187]
    s_waitcnt lgkmcnt(4)
    v_mfma_f32_16x16x32_bf16 a[140:143], v[72:75], v[240:243], a[140:143]
    ds_read_b128 v[32:35], v12 offset:1536
    v_mfma_f32_16x16x32_bf16 a[140:143], v[88:91], v[244:247], a[140:143]
    s_branch L_skip16
L_pad16:
    s_branch L_tb2_1
L_skip16:
    v_mfma_f32_16x16x32_bf16 a[188:191], v[76:79], v[240:243], a[188:191]
    ds_read_b128 v[36:39], v12 offset:13824
    v_mfma_f32_16x16x32_bf16 a[188:191], v[92:95], v[244:247], a[188:191]
    s_waitcnt lgkmcnt(4)
    s_nop 4
    v_cmp_nge_f32 vcc, s29, v6
    v_cmp_nge_f32_e64 s[56:57], s29, v7
    s_nop 0
    s_or_b64 vcc, vcc, s[56:57]
    v_mfma_f32_16x16x4_f32 v[56:59], v6, v63, 0
    v_mfma_f32_16x16x4_f32 v[128:131], v7, v63, 0
    s_cbranch_vccnz L_slow
    v_mfma_f32_16x16x32_bf16 a[96:99], v[168:171], v[248:251], a[96:99]
    ds_read_b128 v[40:43], v12 offset:2304
    ds_read_b128 v[44:47], v12 offset:14592
    v_mfma_f32_16x16x32_bf16 a[96:99], v[184:187], v[252:255], a[96:99]
    s_waitcnt lgkmcnt(4)
    s_nop 3
    v_rcp_f32 v56, v56
    v_rcp_f32 v57, v57
    v_mfma_f32_16x16x32_bf16 a[100:103], v[168:171], v[24:27], a[100:103]
    ds_read_b128 v[240:243], v13 offset:0
    ds_read_b128 v[244:247], v13 offset:12288
    v_mfma_f32_16x16x32_bf16 a[100:103], v[184:187], v[28:31], a[100:103]
    s_waitcnt lgkmcnt(4)
    v_rcp_f32 v58, v58
    v_rcp_f32 v59, v59
    v_rcp_f32 v128, v128
    v_rcp_f32 v129, v129
    v_rcp_f32 v130, v130
    v_rcp_f32 v131, v131
    v_mfma_f32_16x16x32_bf16 a[104:107], v[168:171], v[32:35], a[104:107]
    ds_read_b128 v[248:251], v13 offset:768
    ds_read_b128 v[252:255], v13 offset:13056
    v_mfma_f32_16x16x32_bf16 a[104:107], v[184:187], v[36:39], a[104:107]
    s_waitcnt lgkmcnt(4)
    v_mfma_f32_16x16x32_bf16 a[108:111], v[168:171], v[40:43], a[108:111]
    ds_read_b128 v[24:27], v13 offset:1536
    ds_read_b128 v[28:31], v13 offset:13824
    v_mfma_f32_16x16x32_bf16 a[108:111], v[184:187], v[44:47], a[108:111]
    s_waitcnt lgkmcnt(4)
    v_mfma_f32_16x16x32_bf16 a[112:115], v[168:171], v[240:243], a[112:115]
    ds_read_b128 v[32:35], v13 offset:2304
    ds_read_b128 v[36:39], v13 offset:14592
    v_mfma_f32_16x16x32_bf16 a[112:115], v[184:187], v[244:247], a[112:115]
    s_waitcnt lgkmcnt(4)
    v_mfma_f32_16x16x32_bf16 a[116:119], v[168:171], v[248:251], a[116:119]
    ds_read_b128 v[40:43], v0 offset:0
    ds_read_b128 v[44:47], v0 offset:12288
    v_mfma_f32_16x16x32_bf16 a[116:119], v[184:187], v[252:255], a[116:119]
    s_waitcnt lgkmcnt(4)
    v_mfma_f32_16x16x32_bf16 a[120:123], v[168:171], v[24:27], a[120:123]
    ds_read_b128 v[240:243], v0 offset:768
    ds_read_b128 v[244:247], v0 offset:13056
    v_mfma_f32_16x16x32_bf16 a[120:123], v[184:187], v[28:31], a[120:123]
    s_waitcnt lgkmcnt(4)
    v_mfma_f32_16x16x32_bf16 a[124:127], v[168:171], v[32:35], a[124:127]
    ds_read_b128 v[248:251], v0 offset:1536
    ds_read_b128 v[252:255], v0 offset:13824
    v_mfma_f32_16x16x32_bf16 a[124:127], v[184:187], v[36:39], a[124:127]
    s_waitcnt lgkmcnt(4)
    v_mfma_f32_16x16x32_bf16 a[128:131], v[168:171], v[40:43], a[128:131]
    ds_read_b128 v[24:27], v0 offset:2304
    ds_read_b128 v[28:31], v0 offset:14592
    v_mfma_f32_16x16x32_bf16 a[128:131], v[184:187], v[44:47], a[128:131]
    s_waitcnt lgkmcnt(4)
    v_mfma_f32_16x16x32_bf16 a[132:135], v[168:171], v[240:243], a[132:135]
    ds_read_b128 v[32:35], v12 offset:0
    ds_read_b128 v[36:39], v12 offset:12288
    v_mfma_f32_16x16x32_bf16 a[132:135], v[184:187], v[244:247], a[132:135]
    s_waitcnt lgkmcnt(4)
    v_mfma_f32_16x16x32_bf16 a[136:139], v[168:171], v[248:251], a[136:139]
    ds_read_b128 v[40:43], v12 offset:768
    ds_read_b128 v[44:47], v12 offset:13056
    v_mfma_f32_16x16x32_bf16 a[136:139], v[184:187], v[252:255], a[136:139]
    s_waitcnt lgkmcnt(4)
    v_mfma_f32_16x16x32_bf16 a[140:143], v[168:171], v[24:27], a[140:143]
    ds_read_b128 v[240:243], v12 offset:1536
    ds_read_b128 v[244:247], v12 offset:13824
    v_mfma_f32_16x16x32_bf16 a[140:143], v[184:187], v[28:31], a[140:143]
    s_waitcnt lgkmcnt(4)
    v_mfma_f32_16x16x32_bf16 a[144:147], v[172:175], v[32:35], a[144:147]
    ds_read_b128 v[248:251], v12 offset:2304
    ds_read_b128 v[252:255], v12 offset:14592
    v_mfma_f32_16x16x32_bf16 a[144:147], v[188:191], v[36:39], a[144:147]
    s_waitcnt lgkmcnt(4)
    s_nop 3
    v_accvgpr_read_b32 v224, a96
    v_accvgpr_read_b32 v225, a100
    v_mfma_f32_16x16x32_bf16 a[148:151], v[172:175], v[40:43], a[148:151]
    ds_read_b128 v[24:27], v13 offset:0
    ds_read_b128 v[28:31], v13 offset:12288
    v_mfma_f32_16x16x32_bf16 a[148:151], v[188:191], v[44:47], a[148:151]
    s_waitcnt lgkmcnt(4)
    v_accvgpr_read_b32 v226, a104
    v_accvgpr_read_b32 v227, a108
    v_accvgpr_read_b32 v228, a112
    v_accvgpr_read_b32 v229, a116
    v_accvgpr_read_b32 v230, a120
    v_accvgpr_read_b32 v231, a124
    v_mfma_f32_16x16x32_bf16 a[152:155], v[172:175], v[240:243], a[152:155]
    ds_read_b128 v[32:35], v13 offset:768
    ds_read_b128 v[36:39], v13 offset:13056
    v_mfma_f32_16x16x32_bf16 a[152:155], v[188:191], v[244:247], a[152:155]
    s_waitcnt lgkmcnt(4)
    v_accvgpr_read_b32 v232, a128
    v_accvgpr_read_b32 v233, a132
    v_accvgpr_read_b32 v234, a136
    v_accvgpr_read_b32 v235, a140
    v_mul_f32 v224, v224, v56
    v_mul_f32 v225, v225, v56
    v_mfma_f32_16x16x32_bf16 a[156:159], v[172:175], v[248:251], a[156:159]
    ds_read_b128 v[40:43], v13 offset:1536
    ds_read_b128 v[44:47], v13 offset:13824
    v_mfma_f32_16x16x32_bf16 a[156:159], v[188:191], v[252:255], a[156:159]
    s_waitcnt lgkmcnt(4)
    v_mul_f32 v226, v226, v56
    v_mul_f32 v227, v227, v56
    v_mul_f32 v228, v228, v56
    v_mul_f32 v229, v229, v56
    v_mul_f32 v230, v230, v56
    v_mul_f32 v231, v231, v56
    v_mfma_f32_16x16x32_bf16 a[160:163], v[172:175], v[24:27], a[160:163]
    ds_read_b128 v[240:243], v13 offset:2304
    ds_read_b128 v[244:247], v13 offset:14592
    v_mfma_f32_16x16x32_bf16 a[160:163], v[188:191], v[28:31], a[160:163]
    s_waitcnt lgkmcnt(4)
    v_mul_f32 v232, v232, v56
    v_mul_f32 v233, v233, v56
    v_mul_f32 v234, v234, v56
    v_mul_f32 v235, v235, v56
    v_cvt_pk_bf16_f32 v224, v224, v225
    v_cvt_pk_bf16_f32 v225, v226, v227
    v_mfma_f32_16x16x32_bf16 a[164:167], v[172:175], v[32:35], a[164:167]
    ds_read_b128 v[248:251], v0 offset:0
    ds_read_b128 v[252:255], v0 offset:12288
    v_mfma_f32_16x16x32_bf16 a[164:167], v[188:191], v[36:39], a[164:167]
    s_waitcnt lgkmcnt(4)
    v_cvt_pk_bf16_f32 v226, v228, v229
    v_cvt_pk_bf16_f32 v227, v230, v231
    v_cvt_pk_bf16_f32 v228, v232, v233
    v_cvt_pk_bf16_f32 v229, v234, v235
    v_mfma_f32_16x16x32_bf16 a[168:171], v[172:175], v[40:43], a[168:171]
    ds_read_b128 v[24:27], v0 offset:768
    ds_read_b128 v[28:31], v0 offset:13056
    v_mfma_f32_16x16x32_bf16 a[168:171], v[188:191], v[44:47], a[168:171]
    s_waitcnt lgkmcnt(4)
    buffer_store_dwordx4 v[224:227], v60, s[12:15], s35 offen offset:0 sc0 sc1
    buffer_store_dwordx2 v[228:229], v61, s[12:15], s35 offen offset:256 sc0 sc1
    v_mfma_f32_16x16x32_bf16 a[172:175], v[172:175], v[240:243], a[172:175]
    ds_read_b128 v[32:35], v0 offset:1536
    ds_read_b128 v[36:39], v0 offset:13824
    v_mfma_f32_16x16x32_bf16 a[172:175], v[188:191], v[244:247], a[172:175]
    s_waitcnt lgkmcnt(4)
    v_accvgpr_read_b32 v144, a97
    v_accvgpr_read_b32 v145, a101
    v_accvgpr_read_b32 v146, a105
    v_accvgpr_read_b32 v147, a109
    v_accvgpr_read_b32 v148, a113
    v_accvgpr_read_b32 v149, a117
    v_mfma_f32_16x16x32_bf16 a[176:179], v[172:175], v[248:251], a[176:179]
    ds_read_b128 v[40:43], v0 offset:2304
    ds_read_b128 v[44:47], v0 offset:14592
    v_mfma_f32_16x16x32_bf16 a[176:179], v[188:191], v[252:255], a[176:179]
    s_waitcnt lgkmcnt(4)
    v_accvgpr_read_b32 v150, a121
    v_accvgpr_read_b32 v151, a125
    v_accvgpr_read_b32 v152, a129
    v_accvgpr_read_b32 v153, a133
    v_accvgpr_read_b32 v154, a137
    v_accvgpr_read_b32 v155, a141
    v_mfma_f32_16x16x32_bf16 a[180:183], v[172:175], v[24:27], a[180:183]
    v_mul_f32 v144, v144, v57
    v_mul_f32 v145, v145, v57
    v_mfma_f32_16x16x32_bf16 a[180:183], v[188:191], v[28:31], a[180:183]
    s_waitcnt lgkmcnt(2)
    v_mul_f32 v146, v146, v57
    v_mul_f32 v147, v147, v57
    v_mul_f32 v148, v148, v57
    v_mul_f32 v149, v149, v57
    v_mul_f32 v150, v150, v57
    v_mul_f32 v151, v151, v57
    v_mfma_f32_16x16x32_bf16 a[184:187], v[172:175], v[32:35], a[184:187]
    v_mul_f32 v152, v152, v57
    v_mul_f32 v153, v153, v57
    v_mfma_f32_16x16x32_bf16 a[184:187], v[188:191], v[36:39], a[184:187]
    s_waitcnt lgkmcnt(0)
    v_mul_f32 v154, v154, v57
    v_mul_f32 v155, v155, v57
    v_cvt_pk_bf16_f32 v144, v144, v145
    v_cvt_pk_bf16_f32 v145, v146, v147
    v_cvt_pk_bf16_f32 v146, v148, v149
    v_cvt_pk_bf16_f32 v147, v150, v151
    v_mfma_f32_16x16x32_bf16 a[188:191], v[172:175], v[40:43], a[188:191]
    v_cvt_pk_bf16_f32 v148, v152, v153
    v_cvt_pk_bf16_f32 v149, v154, v155
    v_mfma_f32_16x16x32_bf16 a[188:191], v[188:191], v[44:47], a[188:191]
    buffer_store_dwordx4 v[144:147], v60, s[12:15], s35 offen offset:384 sc0 sc1
    buffer_store_dwordx2 v[148:149], v61, s[12:15], s35 offen offset:640 sc0 sc1
    v_accvgpr_read_b32 v224, a98
    v_accvgpr_read_b32 v225, a102
    v_accvgpr_read_b32 v226, a106
    v_accvgpr_read_b32 v227, a110
    v_accvgpr_read_b32 v228, a114
    v_accvgpr_read_b32 v229, a118
    v_accvgpr_read_b32 v230, a122
    v_accvgpr_read_b32 v231, a126
    v_accvgpr_read_b32 v232, a130
    v_accvgpr_read_b32 v233, a134
    v_accvgpr_read_b32 v234, a138
    v_accvgpr_read_b32 v235, a142
    v_mul_f32 v224, v224, v58
    v_mul_f32 v225, v225, v58
    v_mul_f32 v226, v226, v58
    v_mul_f32 v227, v227, v58
    v_mul_f32 v228, v228, v58
    v_mul_f32 v229, v229, v58
    v_mul_f32 v230, v230, v58
    v_mul_f32 v231, v231, v58
    v_mul_f32 v232, v232, v58
    v_mul_f32 v233, v233, v58
    v_mul_f32 v234, v234, v58
    v_mul_f32 v235, v235, v58
    v_cvt_pk_bf16_f32 v224, v224, v225
    v_cvt_pk_bf16_f32 v225, v226, v227
    v_cvt_pk_bf16_f32 v226, v228, v229
    v_cvt_pk_bf16_f32 v227, v230, v231
    v_cvt_pk_bf16_f32 v228, v232, v233
    v_cvt_pk_bf16_f32 v229, v234, v235
    buffer_store_dwordx4 v[224:227], v60, s[12:15], s35 offen offset:768 sc0 sc1
    buffer_store_dwordx2 v[228:229], v61, s[12:15], s35 offen offset:1024 sc0 sc1
    v_accvgpr_read_b32 v144, a99
    v_accvgpr_read_b32 v145, a103
    v_accvgpr_read_b32 v146, a107
    v_accvgpr_read_b32 v147, a111
    v_accvgpr_read_b32 v148, a115
    v_accvgpr_read_b32 v149, a119
    v_accvgpr_read_b32 v150, a123
    v_accvgpr_read_b32 v151, a127
    v_accvgpr_read_b32 v152, a131
    v_accvgpr_read_b32 v153, a135
    v_accvgpr_read_b32 v154, a139
    v_accvgpr_read_b32 v155, a143
    v_mul_f32 v144, v144, v59
    v_mul_f32 v145, v145, v59
    v_mul_f32 v146, v146, v59
    v_mul_f32 v147, v147, v59
    v_mul_f32 v148, v148, v59
    v_mul_f32 v149, v149, v59
    v_mul_f32 v150, v150, v59
    v_mul_f32 v151, v151, v59
    v_mul_f32 v152, v152, v59
    v_mul_f32 v153, v153, v59
    v_mul_f32 v154, v154, v59
    v_mul_f32 v155, v155, v59
    v_cvt_pk_bf16_f32 v144, v144, v145
    v_cvt_pk_bf16_f32 v145, v146, v147
    v_cvt_pk_bf16_f32 v146, v148, v149
    v_cvt_pk_bf16_f32 v147, v150, v151
    v_cvt_pk_bf16_f32 v148, v152, v153
    v_cvt_pk_bf16_f32 v149, v154, v155
    buffer_store_dwordx4 v[144:147], v60, s[12:15], s35 offen offset:1152 sc0 sc1
    buffer_store_dwordx2 v[148:149], v61, s[12:15], s35 offen offset:1408 sc0 sc1
    s_nop 4
    v_accvgpr_read_b32 v88, a144
    v_accvgpr_read_b32 v89, a148
    v_accvgpr_read_b32 v90, a152
    v_accvgpr_read_b32 v91, a156
    v_accvgpr_read_b32 v92, a160
    v_accvgpr_read_b32 v93, a164
    v_accvgpr_read_b32 v94, a168
    v_accvgpr_read_b32 v95, a172
    v_accvgpr_read_b32 v96, a176
    v_accvgpr_read_b32 v97, a180
    v_accvgpr_read_b32 v98, a184
    v_accvgpr_read_b32 v99, a188
    v_pk_mul_f32 v[88:89], v[88:89], v[128:129] op_sel:[0,0] op_sel_hi:[1,0]
    v_pk_mul_f32 v[90:91], v[90:91], v[128:129] op_sel:[0,0] op_sel_hi:[1,0]
    v_pk_mul_f32 v[92:93], v[92:93], v[128:129] op_sel:[0,0] op_sel_hi:[1,0]
    v_pk_mul_f32 v[94:95], v[94:95], v[128:129] op_sel:[0,0] op_sel_hi:[1,0]
    v_pk_mul_f32 v[96:97], v[96:97], v[128:129] op_sel:[0,0] op_sel_hi:[1,0]
    v_pk_mul_f32 v[98:99], v[98:99], v[128:129] op_sel:[0,0] op_sel_hi:[1,0]
    v_cvt_pk_bf16_f32 v88, v88, v89
    v_cvt_pk_bf16_f32 v89, v90, v91
    v_cvt_pk_bf16_f32 v90, v92, v93
    v_cvt_pk_bf16_f32 v91, v94, v95
    v_cvt_pk_bf16_f32 v92, v96, v97
    v_cvt_pk_bf16_f32 v93, v98, v99
    buffer_store_dwordx4 v[88:91], v60, s[12:15], s36 offen offset:0 sc0 sc1
    buffer_store_dwordx2 v[92:93], v61, s[12:15], s36 offen offset:256 sc0 sc1
    v_accvgpr_read_b32 v100, a145
    v_accvgpr_read_b32 v101, a149
    v_accvgpr_read_b32 v102, a153
    v_accvgpr_read_b32 v103, a157
    v_accvgpr_read_b32 v104, a161
    v_accvgpr_read_b32 v105, a165
    v_accvgpr_read_b32 v106, a169
    v_accvgpr_read_b32 v107, a173
    v_accvgpr_read_b32 v108, a177
    v_accvgpr_read_b32 v109, a181
    v_accvgpr_read_b32 v110, a185
    v_accvgpr_read_b32 v111, a189
    v_pk_mul_f32 v[100:101], v[100:101], v[128:129] op_sel:[0,1] op_sel_hi:[1,1]
    v_pk_mul_f32 v[102:103], v[102:103], v[128:129] op_sel:[0,1] op_sel_hi:[1,1]
    v_pk_mul_f32 v[104:105], v[104:105], v[128:129] op_sel:[0,1] op_sel_hi:[1,1]
    v_pk_mul_f32 v[106:107], v[106:107], v[128:129] op_sel:[0,1] op_sel_hi:[1,1]
    v_pk_mul_f32 v[108:109], v[108:109], v[128:129] op_sel:[0,1] op_sel_hi:[1,1]
    v_pk_mul_f32 v[110:111], v[110:111], v[128:129] op_sel:[0,1] op_sel_hi:[1,1]
    v_cvt_pk_bf16_f32 v100, v100, v101
    v_cvt_pk_bf16_f32 v101, v102, v103
    v_cvt_pk_bf16_f32 v102, v104, v105
    v_cvt_pk_bf16_f32 v103, v106, v107
    v_cvt_pk_bf16_f32 v104, v108, v109
    v_cvt_pk_bf16_f32 v105, v110, v111
    buffer_store_dwordx4 v[100:103], v60, s[12:15], s36 offen offset:384 sc0 sc1
    buffer_store_dwordx2 v[104:105], v61, s[12:15], s36 offen offset:640 sc0 sc1
    v_accvgpr_read_b32 v112, a146
    v_accvgpr_read_b32 v113, a150
    v_accvgpr_read_b32 v114, a154
    v_accvgpr_read_b32 v115, a158
    v_accvgpr_read_b32 v116, a162
    v_accvgpr_read_b32 v117, a166
    v_accvgpr_read_b32 v118, a170
    v_accvgpr_read_b32 v119, a174
    v_accvgpr_read_b32 v120, a178
    v_accvgpr_read_b32 v121, a182
    v_accvgpr_read_b32 v122, a186
    v_accvgpr_read_b32 v123, a190
    v_pk_mul_f32 v[112:113], v[112:113], v[130:131] op_sel:[0,0] op_sel_hi:[1,0]
    v_pk_mul_f32 v[114:115], v[114:115], v[130:131] op_sel:[0,0] op_sel_hi:[1,0]
    v_pk_mul_f32 v[116:117], v[116:117], v[130:131] op_sel:[0,0] op_sel_hi:[1,0]
    v_pk_mul_f32 v[118:119], v[118:119], v[130:131] op_sel:[0,0] op_sel_hi:[1,0]
    v_pk_mul_f32 v[120:121], v[120:121], v[130:131] op_sel:[0,0] op_sel_hi:[1,0]
    v_pk_mul_f32 v[122:123], v[122:123], v[130:131] op_sel:[0,0] op_sel_hi:[1,0]
    v_cvt_pk_bf16_f32 v112, v112, v113
    v_cvt_pk_bf16_f32 v113, v114, v115
    v_cvt_pk_bf16_f32 v114, v116, v117
    v_cvt_pk_bf16_f32 v115, v118, v119
    v_cvt_pk_bf16_f32 v116, v120, v121
    v_cvt_pk_bf16_f32 v117, v122, v123
    buffer_store_dwordx4 v[112:115], v60, s[12:15], s36 offen offset:768 sc0 sc1
    buffer_store_dwordx2 v[116:117], v61, s[12:15], s36 offen offset:1024 sc0 sc1
    v_accvgpr_read_b32 v64, a147
    v_accvgpr_read_b32 v65, a151
    v_accvgpr_read_b32 v66, a155
    v_accvgpr_read_b32 v67, a159
    v_accvgpr_read_b32 v68, a163
    v_accvgpr_read_b32 v69, a167
    v_accvgpr_read_b32 v70, a171
    v_accvgpr_read_b32 v71, a175
    v_accvgpr_read_b32 v72, a179
    v_accvgpr_read_b32 v73, a183
    v_accvgpr_read_b32 v74, a187
    v_accvgpr_read_b32 v75, a191
    v_pk_mul_f32 v[64:65], v[64:65], v[130:131] op_sel:[0,1] op_sel_hi:[1,1]
    v_pk_mul_f32 v[66:67], v[66:67], v[130:131] op_sel:[0,1] op_sel_hi:[1,1]
    v_pk_mul_f32 v[68:69], v[68:69], v[130:131] op_sel:[0,1] op_sel_hi:[1,1]
    v_pk_mul_f32 v[70:71], v[70:71], v[130:131] op_sel:[0,1] op_sel_hi:[1,1]
    v_pk_mul_f32 v[72:73], v[72:73], v[130:131] op_sel:[0,1] op_sel_hi:[1,1]
    v_pk_mul_f32 v[74:75], v[74:75], v[130:131] op_sel:[0,1] op_sel_hi:[1,1]
    v_cvt_pk_bf16_f32 v64, v64, v65
    v_cvt_pk_bf16_f32 v65, v66, v67
    v_cvt_pk_bf16_f32 v66, v68, v69
    v_cvt_pk_bf16_f32 v67, v70, v71
    v_cvt_pk_bf16_f32 v68, v72, v73
    v_cvt_pk_bf16_f32 v69, v74, v75
    buffer_store_dwordx4 v[64:67], v60, s[12:15], s36 offen offset:1152 sc0 sc1
    buffer_store_dwordx2 v[68:69], v61, s[12:15], s36 offen offset:1408 sc0 sc1
L_fin:
L_done:
    s_endpgm
L_pollslow0:
    s_mov_b32 s59, 200
L_pollsm0:
    s_buffer_load_dwordx8 s[48:55], s[20:23], 0 glc
    s_waitcnt lgkmcnt(0)
    s_sub_u32 s48, s48, s92
    s_sub_u32 s49, s49, s92
    s_sub_u32 s50, s50, s92
    s_sub_u32 s51, s51, s92
    s_sub_u32 s52, s52, s92
    s_sub_u32 s53, s53, s92
    s_sub_u32 s54, s54, s92
    s_sub_u32 s55, s55, s92
    s_max_u32 s48, s48, s49
    s_max_u32 s48, s48, s50
    s_max_u32 s48, s48, s51
    s_max_u32 s48, s48, s52
    s_max_u32 s48, s48, s53
    s_max_u32 s48, s48, s54
    s_max_u32 s48, s48, s55
    s_cmp_lt_u32 s48, 16
    s_cbranch_scc1 L_pollok0
    s_sub_u32 s59, s59, 1
    s_cbranch_scc1 L_pollvec0
    s_sleep 1
    s_branch L_pollsm0
L_pollvec0:
    s_sub_u32 s96, s96, 1
    s_cbranch_scc1 L_pollgiveup0
    s_sleep 2
    buffer_load_dword v52, v53, s[20:23], 0 offen sc1
    s_waitcnt vmcnt(0)
    v_subrev_u32 v52, s92, v52
    v_cmp_lt_u32 vcc, 15, v52
    s_nop 0
    s_and_b32 s59, vcc_lo, 0xff
    s_cbranch_scc1 L_pollvec0
    s_branch L_pollok0
L_pollgiveup0:
    s_mov_b32 s96, 0
    s_branch L_pollok0
L_pollslow1:
    s_mov_b32 s59, 200
L_pollsm1:
    s_buffer_load_dwordx8 s[48:55], s[20:23], 0 glc
    s_waitcnt lgkmcnt(0)
    s_sub_u32 s48, s48, s92
    s_sub_u32 s49, s49, s92
    s_sub_u32 s50, s50, s92
    s_sub_u32 s51, s51, s92
    s_sub_u32 s52, s52, s92
    s_sub_u32 s53, s53, s92
    s_sub_u32 s54, s54, s92
    s_sub_u32 s55, s55, s92
    s_max_u32 s48, s48, s49
    s_max_u32 s48, s48, s50
    s_max_u32 s48, s48, s51
    s_max_u32 s48, s48, s52
    s_max_u32 s48, s48, s53
    s_max_u32 s48, s48, s54
    s_max_u32 s48, s48, s55
    s_cmp_lt_u32 s48, 16
    s_cbranch_scc1 L_pollok1
    s_sub_u32 s59, s59, 1
    s_cbranch_scc1 L_pollvec1
    s_sleep 1
    s_branch L_pollsm1
L_pollvec1:
    s_sub_u32 s96, s96, 1
    s_cbranch_scc1 L_pollgiveup1
    s_sleep 2
    buffer_load_dword v52, v53, s[20:23], 0 offen sc1
    s_waitcnt vmcnt(0)
    v_subrev_u32 v52, s92, v52
    v_cmp_lt_u32 vcc, 15, v52
    s_nop 0
    s_and_b32 s59, vcc_lo, 0xff
    s_cbranch_scc1 L_pollvec1
    s_branch L_pollok1
L_pollgiveup1:
    s_mov_b32 s96, 0
    s_branch L_pollok1
L_pollslow2:
    s_mov_b32 s59, 200
L_pollsm2:
    s_buffer_load_dwordx8 s[48:55], s[20:23], 0 glc
    s_waitcnt lgkmcnt(0)
    s_sub_u32 s48, s48, s92
    s_sub_u32 s49, s49, s92
    s_sub_u32 s50, s50, s92
    s_sub_u32 s51, s51, s92
    s_sub_u32 s52, s52, s92
    s_sub_u32 s53, s53, s92
    s_sub_u32 s54, s54, s92
    s_sub_u32 s55, s55, s92
    s_max_u32 s48, s48, s49
    s_max_u32 s48, s48, s50
    s_max_u32 s48, s48, s51
    s_max_u32 s48, s48, s52
    s_max_u32 s48, s48, s53
    s_max_u32 s48, s48, s54
    s_max_u32 s48, s48, s55
    s_cmp_lt_u32 s48, 16
    s_cbranch_scc1 L_pollok2
    s_sub_u32 s59, s59, 1
    s_cbranch_scc1 L_pollvec2
    s_sleep 1
    s_branch L_pollsm2
L_pollvec2:
    s_sub_u32 s96, s96, 1
    s_cbranch_scc1 L_pollgiveup2
    s_sleep 2
    buffer_load_dword v52, v53, s[20:23], 0 offen sc1
    s_waitcnt vmcnt(0)
    v_subrev_u32 v52, s92, v52
    v_cmp_lt_u32 vcc, 15, v52
    s_nop 0
    s_and_b32 s59, vcc_lo, 0xff
    s_cbranch_scc1 L_pollvec2
    s_branch L_pollok2
L_pollgiveup2:
    s_mov_b32 s96, 0
    s_branch L_pollok2
L_pollslow3:
    s_mov_b32 s59, 200
L_pollsm3:
    s_buffer_load_dwordx8 s[48:55], s[20:23], 0 glc
    s_waitcnt lgkmcnt(0)
    s_sub_u32 s48, s48, s92
    s_sub_u32 s49, s49, s92
    s_sub_u32 s50, s50, s92
    s_sub_u32 s51, s51, s92
    s_sub_u32 s52, s52, s92
    s_sub_u32 s53, s53, s92
    s_sub_u32 s54, s54, s92
    s_sub_u32 s55, s55, s92
    s_max_u32 s48, s48, s49
    s_max_u32 s48, s48, s50
    s_max_u32 s48, s48, s51
    s_max_u32 s48, s48, s52
    s_max_u32 s48, s48, s53
    s_max_u32 s48, s48, s54
    s_max_u32 s48, s48, s55
    s_cmp_lt_u32 s48, 16
    s_cbranch_scc1 L_pollok3
    s_sub_u32 s59, s59, 1
    s_cbranch_scc1 L_pollvec3
    s_sleep 1
    s_branch L_pollsm3
L_pollvec3:
    s_sub_u32 s96, s96, 1
    s_cbranch_scc1 L_pollgiveup3
    s_sleep 2
    buffer_load_dword v52, v53, s[20:23], 0 offen sc1
    s_waitcnt vmcnt(0)
    v_subrev_u32 v52, s92, v52
    v_cmp_lt_u32 vcc, 15, v52
    s_nop 0
    s_and_b32 s59, vcc_lo, 0xff
    s_cbranch_scc1 L_pollvec3
    s_branch L_pollok3
L_pollgiveup3:
    s_mov_b32 s96, 0
    s_branch L_pollok3
L_pollslow4:
    s_mov_b32 s59, 200
L_pollsm4:
    s_buffer_load_dwordx8 s[48:55], s[20:23], 0 glc
    s_waitcnt lgkmcnt(0)
    s_sub_u32 s48, s48, s92
    s_sub_u32 s49, s49, s92
    s_sub_u32 s50, s50, s92
    s_sub_u32 s51, s51, s92
    s_sub_u32 s52, s52, s92
    s_sub_u32 s53, s53, s92
    s_sub_u32 s54, s54, s92
    s_sub_u32 s55, s55, s92
    s_max_u32 s48, s48, s49
    s_max_u32 s48, s48, s50
    s_max_u32 s48, s48, s51
    s_max_u32 s48, s48, s52
    s_max_u32 s48, s48, s53
    s_max_u32 s48, s48, s54
    s_max_u32 s48, s48, s55
    s_cmp_lt_u32 s48, 16
    s_cbranch_scc1 L_pollok4
    s_sub_u32 s59, s59, 1
    s_cbranch_scc1 L_pollvec4
    s_sleep 1
    s_branch L_pollsm4
L_pollvec4:
    s_sub_u32 s96, s96, 1
    s_cbranch_scc1 L_pollgiveup4
    s_sleep 2
    buffer_load_dword v52, v53, s[20:23], 0 offen sc1
    s_waitcnt vmcnt(0)
    v_subrev_u32 v52, s92, v52
    v_cmp_lt_u32 vcc, 15, v52
    s_nop 0
    s_and_b32 s59, vcc_lo, 0xff
    s_cbranch_scc1 L_pollvec4
    s_branch L_pollok4
L_pollgiveup4:
    s_mov_b32 s96, 0
    s_branch L_pollok4
L_pollslow5:
    s_mov_b32 s59, 200
L_pollsm5:
    s_buffer_load_dwordx8 s[48:55], s[20:23], 0 glc
    s_waitcnt lgkmcnt(0)
    s_sub_u32 s48, s48, s92
    s_sub_u32 s49, s49, s92
    s_sub_u32 s50, s50, s92
    s_sub_u32 s51, s51, s92
    s_sub_u32 s52, s52, s92
    s_sub_u32 s53, s53, s92
    s_sub_u32 s54, s54, s92
    s_sub_u32 s55, s55, s92
    s_max_u32 s48, s48, s49
    s_max_u32 s48, s48, s50
    s_max_u32 s48, s48, s51
    s_max_u32 s48, s48, s52
    s_max_u32 s48, s48, s53
    s_max_u32 s48, s48, s54
    s_max_u32 s48, s48, s55
    s_cmp_lt_u32 s48, 16
    s_cbranch_scc1 L_pollok5
    s_sub_u32 s59, s59, 1
    s_cbranch_scc1 L_pollvec5
    s_sleep 1
    s_branch L_pollsm5
L_pollvec5:
    s_sub_u32 s96, s96, 1
    s_cbranch_scc1 L_pollgiveup5
    s_sleep 2
    buffer_load_dword v52, v53, s[20:23], 0 offen sc1
    s_waitcnt vmcnt(0)
    v_subrev_u32 v52, s92, v52
    v_cmp_lt_u32 vcc, 15, v52
    s_nop 0
    s_and_b32 s59, vcc_lo, 0xff
    s_cbranch_scc1 L_pollvec5
    s_branch L_pollok5
L_pollgiveup5:
    s_mov_b32 s96, 0
    s_branch L_pollok5
L_pollslow6:
    s_mov_b32 s59, 200
L_pollsm6:
    s_buffer_load_dwordx8 s[48:55], s[20:23], 0 glc
    s_waitcnt lgkmcnt(0)
    s_sub_u32 s48, s48, s92
    s_sub_u32 s49, s49, s92
    s_sub_u32 s50, s50, s92
    s_sub_u32 s51, s51, s92
    s_sub_u32 s52, s52, s92
    s_sub_u32 s53, s53, s92
    s_sub_u32 s54, s54, s92
    s_sub_u32 s55, s55, s92
    s_max_u32 s48, s48, s49
    s_max_u32 s48, s48, s50
    s_max_u32 s48, s48, s51
    s_max_u32 s48, s48, s52
    s_max_u32 s48, s48, s53
    s_max_u32 s48, s48, s54
    s_max_u32 s48, s48, s55
    s_cmp_lt_u32 s48, 16
    s_cbranch_scc1 L_pollok6
    s_sub_u32 s59, s59, 1
    s_cbranch_scc1 L_pollvec6
    s_sleep 1
    s_branch L_pollsm6
L_pollvec6:
    s_sub_u32 s96, s96, 1
    s_cbranch_scc1 L_pollgiveup6
    s_sleep 2
    buffer_load_dword v52, v53, s[20:23], 0 offen sc1
    s_waitcnt vmcnt(0)
    v_subrev_u32 v52, s92, v52
    v_cmp_lt_u32 vcc, 15, v52
    s_nop 0
    s_and_b32 s59, vcc_lo, 0xff
    s_cbranch_scc1 L_pollvec6
    s_branch L_pollok6
L_pollgiveup6:
    s_mov_b32 s96, 0
    s_branch L_pollok6
L_pollslow7:
    s_mov_b32 s59, 200
L_pollsm7:
    s_buffer_load_dwordx8 s[48:55], s[20:23], 0 glc
    s_waitcnt lgkmcnt(0)
    s_sub_u32 s48, s48, s92
    s_sub_u32 s49, s49, s92
    s_sub_u32 s50, s50, s92
    s_sub_u32 s51, s51, s92
    s_sub_u32 s52, s52, s92
    s_sub_u32 s53, s53, s92
    s_sub_u32 s54, s54, s92
    s_sub_u32 s55, s55, s92
    s_max_u32 s48, s48, s49
    s_max_u32 s48, s48, s50
    s_max_u32 s48, s48, s51
    s_max_u32 s48, s48, s52
    s_max_u32 s48, s48, s53
    s_max_u32 s48, s48, s54
    s_max_u32 s48, s48, s55
    s_cmp_lt_u32 s48, 16
    s_cbranch_scc1 L_pollok7
    s_sub_u32 s59, s59, 1
    s_cbranch_scc1 L_pollvec7
    s_sleep 1
    s_branch L_pollsm7
L_pollvec7:
    s_sub_u32 s96, s96, 1
    s_cbranch_scc1 L_pollgiveup7
    s_sleep 2
    buffer_load_dword v52, v53, s[20:23], 0 offen sc1
    s_waitcnt vmcnt(0)
    v_subrev_u32 v52, s92, v52
    v_cmp_lt_u32 vcc, 15, v52
    s_nop 0
    s_and_b32 s59, vcc_lo, 0xff
    s_cbranch_scc1 L_pollvec7
    s_branch L_pollok7
L_pollgiveup7:
    s_mov_b32 s96, 0
    s_branch L_pollok7
L_pollslowP:
L_pollvecP:
    s_sub_u32 s96, s96, 1
    s_cbranch_scc1 L_pollgiveupP
    s_sleep 2
    buffer_load_dword v52, v53, s[20:23], 0 offen sc1
    s_waitcnt vmcnt(0)
    v_subrev_u32 v52, s92, v52
    v_cmp_lt_u32 vcc, 15, v52
    s_nop 0
    s_and_b32 s59, vcc_lo, 0xff
    s_cbranch_scc1 L_pollvecP
    s_branch L_pollokP
L_pollgiveupP:
    s_mov_b32 s96, 0
    s_branch L_pollokP
L_tagslow:
    s_sub_u32 s96, s96, 1
    s_cbranch_scc1 L_taggiveup
    s_sleep 2
    buffer_load_dword v52, off, s[88:91], s93 sc1
    s_waitcnt vmcnt(0)
    v_readfirstlane_b32 s92, v52
    s_nop 0
    s_cmp_eq_u32 s92, 0
    s_cbranch_scc1 L_tagslow
    s_branch L_tagok
L_taggiveup:
    s_mov_b32 s96, 0
    s_branch L_tagok
L_slow:
    s_waitcnt vmcnt(0) lgkmcnt(0)
    s_nop 15
    v_accvgpr_write_b32 a0, 0
    v_accvgpr_write_b32 a1, 0
    v_accvgpr_write_b32 a2, 0
    v_accvgpr_write_b32 a3, 0
    v_accvgpr_write_b32 a4, 0
    v_accvgpr_write_b32 a5, 0
    v_accvgpr_write_b32 a6, 0
    v_accvgpr_write_b32 a7, 0
    v_accvgpr_write_b32 a8, 0
    v_accvgpr_write_b32 a9, 0
    v_accvgpr_write_b32 a10, 0
    v_accvgpr_write_b32 a11, 0
    v_accvgpr_write_b32 a12, 0
    v_accvgpr_write_b32 a13, 0
    v_accvgpr_write_b32 a14, 0
    v_accvgpr_write_b32 a15, 0
    v_accvgpr_write_b32 a16, 0
    v_accvgpr_write_b32 a17, 0
    v_accvgpr_write_b32 a18, 0
    v_accvgpr_write_b32 a19, 0
    v_accvgpr_write_b32 a20, 0
    v_accvgpr_write_b32 a21, 0
    v_accvgpr_write_b32 a22, 0
    v_accvgpr_write_b32 a23, 0
    v_accvgpr_write_b32 a24, 0
    v_accvgpr_write_b32 a25, 0
    v_accvgpr_write_b32 a26, 0
    v_accvgpr_write_b32 a27, 0
    v_accvgpr_write_b32 a28, 0
    v_accvgpr_write_b32 a29, 0
    v_accvgpr_write_b32 a30, 0
    v_accvgpr_write_b32 a31, 0
    v_accvgpr_write_b32 a32, 0
    v_accvgpr_write_b32 a33, 0
    v_accvgpr_write_b32 a34, 0
    v_accvgpr_write_b32 a35, 0
    v_accvgpr_write_b32 a36, 0
    v_accvgpr_write_b32 a37, 0
    v_accvgpr_write_b32 a38, 0
    v_accvgpr_write_b32 a39, 0
    v_accvgpr_write_b32 a40, 0
    v_accvgpr_write_b32 a41, 0
    v_accvgpr_write_b32 a42, 0
    v_accvgpr_write_b32 a43, 0
    v_accvgpr_write_b32 a44, 0
    v_accvgpr_write_b32 a45, 0
    v_accvgpr_write_b32 a46, 0
    v_accvgpr_write_b32 a47, 0
    v_accvgpr_write_b32 a48, 0
    v_accvgpr_write_b32 a49, 0
    v_accvgpr_write_b32 a50, 0
    v_accvgpr_write_b32 a51, 0
    v_accvgpr_write_b32 a52, 0
    v_accvgpr_write_b32 a53, 0
    v_accvgpr_write_b32 a54, 0
    v_accvgpr_write_b32 a55, 0
    v_accvgpr_write_b32 a56, 0
    v_accvgpr_write_b32 a57, 0
    v_accvgpr_write_b32 a58, 0
    v_accvgpr_write_b32 a59, 0
    v_accvgpr_write_b32 a60, 0
    v_accvgpr_write_b32 a61, 0
    v_accvgpr_write_b32 a62, 0
    v_accvgpr_write_b32 a63, 0
    v_accvgpr_write_b32 a64, 0
    v_accvgpr_write_b32 a65, 0
    v_accvgpr_write_b32 a66, 0
    v_accvgpr_write_b32 a67, 0
    v_accvgpr_write_b32 a68, 0
    v_accvgpr_write_b32 a69, 0
    v_accvgpr_write_b32 a70, 0
    v_accvgpr_write_b32 a71, 0
    v_accvgpr_write_b32 a72, 0
    v_accvgpr_write_b32 a73, 0
    v_accvgpr_write_b32 a74, 0
    v_accvgpr_write_b32 a75, 0
    v_accvgpr_write_b32 a76, 0
    v_accvgpr_write_b32 a77, 0
    v_accvgpr_write_b32 a78, 0
    v_accvgpr_write_b32 a79, 0
    v_accvgpr_write_b32 a80, 0
    v_accvgpr_write_b32 a81, 0
    v_accvgpr_write_b32 a82, 0
    v_accvgpr_write_b32 a83, 0
    v_accvgpr_write_b32 a84, 0
    v_accvgpr_write_b32 a85, 0
    v_accvgpr_write_b32 a86, 0
    v_accvgpr_write_b32 a87, 0
    v_accvgpr_write_b32 a88, 0
    v_accvgpr_write_b32 a89, 0
    v_accvgpr_write_b32 a90, 0
    v_accvgpr_write_b32 a91, 0
    v_accvgpr_write_b32 a92, 0
    v_accvgpr_write_b32 a93, 0
    v_accvgpr_write_b32 a94, 0
    v_accvgpr_write_b32 a95, 0
    v_accvgpr_write_b32 a96, 0
    v_accvgpr_write_b32 a97, 0
    v_accvgpr_write_b32 a98, 0
    v_accvgpr_write_b32 a99, 0
    v_accvgpr_write_b32 a100, 0
    v_accvgpr_write_b32 a101, 0
    v_accvgpr_write_b32 a102, 0
    v_accvgpr_write_b32 a103, 0
    v_accvgpr_write_b32 a104, 0
    v_accvgpr_write_b32 a105, 0
    v_accvgpr_write_b32 a106, 0
    v_accvgpr_write_b32 a107, 0
    v_accvgpr_write_b32 a108, 0
    v_accvgpr_write_b32 a109, 0
    v_accvgpr_write_b32 a110, 0
    v_accvgpr_write_b32 a111, 0
    v_accvgpr_write_b32 a112, 0
    v_accvgpr_write_b32 a113, 0
    v_accvgpr_write_b32 a114, 0
    v_accvgpr_write_b32 a115, 0
    v_accvgpr_write_b32 a116, 0
    v_accvgpr_write_b32 a117, 0
    v_accvgpr_write_b32 a118, 0
    v_accvgpr_write_b32 a119, 0
    v_accvgpr_write_b32 a120, 0
    v_accvgpr_write_b32 a121, 0
    v_accvgpr_write_b32 a122, 0
    v_accvgpr_write_b32 a123, 0
    v_accvgpr_write_b32 a124, 0
    v_accvgpr_write_b32 a125, 0
    v_accvgpr_write_b32 a126, 0
    v_accvgpr_write_b32 a127, 0
    v_accvgpr_write_b32 a128, 0
    v_accvgpr_write_b32 a129, 0
    v_accvgpr_write_b32 a130, 0
    v_accvgpr_write_b32 a131, 0
    v_accvgpr_write_b32 a132, 0
    v_accvgpr_write_b32 a133, 0
    v_accvgpr_write_b32 a134, 0
    v_accvgpr_write_b32 a135, 0
    v_accvgpr_write_b32 a136, 0
    v_accvgpr_write_b32 a137, 0
    v_accvgpr_write_b32 a138, 0
    v_accvgpr_write_b32 a139, 0
    v_accvgpr_write_b32 a140, 0
    v_accvgpr_write_b32 a141, 0
    v_accvgpr_write_b32 a142, 0
    v_accvgpr_write_b32 a143, 0
    v_accvgpr_write_b32 a144, 0
    v_accvgpr_write_b32 a145, 0
    v_accvgpr_write_b32 a146, 0
    v_accvgpr_write_b32 a147, 0
    v_accvgpr_write_b32 a148, 0
    v_accvgpr_write_b32 a149, 0
    v_accvgpr_write_b32 a150, 0
    v_accvgpr_write_b32 a151, 0
    v_accvgpr_write_b32 a152, 0
    v_accvgpr_write_b32 a153, 0
    v_accvgpr_write_b32 a154, 0
    v_accvgpr_write_b32 a155, 0
    v_accvgpr_write_b32 a156, 0
    v_accvgpr_write_b32 a157, 0
    v_accvgpr_write_b32 a158, 0
    v_accvgpr_write_b32 a159, 0
    v_accvgpr_write_b32 a160, 0
    v_accvgpr_write_b32 a161, 0
    v_accvgpr_write_b32 a162, 0
    v_accvgpr_write_b32 a163, 0
    v_accvgpr_write_b32 a164, 0
    v_accvgpr_write_b32 a165, 0
    v_accvgpr_write_b32 a166, 0
    v_accvgpr_write_b32 a167, 0
    v_accvgpr_write_b32 a168, 0
    v_accvgpr_write_b32 a169, 0
    v_accvgpr_write_b32 a170, 0
    v_accvgpr_write_b32 a171, 0
    v_accvgpr_write_b32 a172, 0
    v_accvgpr_write_b32 a173, 0
    v_accvgpr_write_b32 a174, 0
    v_accvgpr_write_b32 a175, 0
    v_accvgpr_write_b32 a176, 0
    v_accvgpr_write_b32 a177, 0
    v_accvgpr_write_b32 a178, 0
    v_accvgpr_write_b32 a179, 0
    v_accvgpr_write_b32 a180, 0
    v_accvgpr_write_b32 a181, 0
    v_accvgpr_write_b32 a182, 0
    v_accvgpr_write_b32 a183, 0
    v_accvgpr_write_b32 a184, 0
    v_accvgpr_write_b32 a185, 0
    v_accvgpr_write_b32 a186, 0
    v_accvgpr_write_b32 a187, 0
    v_accvgpr_write_b32 a188, 0
    v_accvgpr_write_b32 a189, 0
    v_accvgpr_write_b32 a190, 0
    v_accvgpr_write_b32 a191, 0
    v_mov_b32 v4, 0
    v_mov_b32 v240, 0xff7fffff
    v_mov_b32 v5, 0
    v_mov_b32 v241, 0xff7fffff
    v_mov_b32 v6, 0
    v_mov_b32 v242, 0xff7fffff
    v_mov_b32 v7, 0
    v_mov_b32 v243, 0xff7fffff
    v_subrev_u32 v244, s28, v2
    v_subrev_u32 v245, s28, v3
    v_subrev_u32 v246, s30, v1
    v_subrev_u32 v247, s30, v21
    v_subrev_u32 v248, s30, v22
    s_mov_b32 s48, 0
L_slowloop:
    s_add_u32 s49, s48, 6144
    s_add_u32 s50, s48, 12288
    buffer_load_dwordx4 v[64:67], v244, s[4:7], s48 offen offset:0 sc1
    buffer_load_dwordx4 v[68:71], v245, s[4:7], s48 offen offset:0 sc1
    buffer_load_dwordx4 v[72:75], v244, s[4:7], s49 offen offset:0 sc1
    buffer_load_dwordx4 v[76:79], v245, s[4:7], s49 offen offset:0 sc1
    buffer_load_dwordx4 v[80:83], v244, s[4:7], s48 offen offset:128 sc1
    buffer_load_dwordx4 v[84:87], v245, s[4:7], s48 offen offset:128 sc1
    buffer_load_dwordx4 v[88:91], v244, s[4:7], s49 offen offset:128 sc1
    buffer_load_dwordx4 v[92:95], v245, s[4:7], s49 offen offset:128 sc1
    buffer_load_dwordx4 v[96:99], v244, s[4:7], s48 offen offset:256 sc1
    buffer_load_dwordx4 v[100:103], v245, s[4:7], s48 offen offset:256 sc1
    buffer_load_dwordx4 v[104:107], v244, s[4:7], s49 offen offset:256 sc1
    buffer_load_dwordx4 v[108:111], v245, s[4:7], s49 offen offset:256 sc1
    buffer_load_dwordx4 v[112:115], v246, s[4:7], s50 offen offset:0 sc1
    buffer_load_dwordx4 v[116:119], v246, s[4:7], s50 offen offset:768 sc1
    buffer_load_dwordx4 v[120:123], v246, s[4:7], s50 offen offset:1536 sc1
    buffer_load_dwordx4 v[124:127], v246, s[4:7], s50 offen offset:2304 sc1
    buffer_load_dwordx4 v[128:131], v247, s[4:7], s50 offen offset:0 sc1
    buffer_load_dwordx4 v[132:135], v247, s[4:7], s50 offen offset:768 sc1
    buffer_load_dwordx4 v[136:139], v247, s[4:7], s50 offen offset:1536 sc1
    buffer_load_dwordx4 v[140:143], v247, s[4:7], s50 offen offset:2304 sc1
    buffer_load_dwordx4 v[144:147], v248, s[4:7], s50 offen offset:0 sc1
    buffer_load_dwordx4 v[148:151], v248, s[4:7], s50 offen offset:768 sc1
    buffer_load_dwordx4 v[152:155], v248, s[4:7], s50 offen offset:1536 sc1
    buffer_load_dwordx4 v[156:159], v248, s[4:7], s50 offen offset:2304 sc1
    s_waitcnt vmcnt(12)
    v_mfma_f32_16x16x32_bf16 v[160:163], v[64:67], a[192:195], 0
    v_mfma_f32_16x16x32_bf16 v[168:171], v[64:67], a[216:219], 0
    v_mfma_f32_16x16x32_bf16 v[176:179], v[64:67], a[240:243], 0
    v_mfma_f32_16x16x32_bf16 v[184:187], v[64:67], v[200:203], 0
    v_mfma_f32_16x16x32_bf16 v[160:163], v[68:71], a[196:199], v[160:163]
    v_mfma_f32_16x16x32_bf16 v[168:171], v[68:71], a[220:223], v[168:171]
    v_mfma_f32_16x16x32_bf16 v[176:179], v[68:71], a[244:247], v[176:179]
    v_mfma_f32_16x16x32_bf16 v[184:187], v[68:71], v[204:207], v[184:187]
    v_mfma_f32_16x16x32_bf16 v[164:167], v[72:75], a[192:195], 0
    v_mfma_f32_16x16x32_bf16 v[172:175], v[72:75], a[216:219], 0
    v_mfma_f32_16x16x32_bf16 v[180:183], v[72:75], a[240:243], 0
    v_mfma_f32_16x16x32_bf16 v[188:191], v[72:75], v[200:203], 0
    v_mfma_f32_16x16x32_bf16 v[164:167], v[76:79], a[196:199], v[164:167]
    v_mfma_f32_16x16x32_bf16 v[172:175], v[76:79], a[220:223], v[172:175]
    v_mfma_f32_16x16x32_bf16 v[180:183], v[76:79], a[244:247], v[180:183]
    v_mfma_f32_16x16x32_bf16 v[188:191], v[76:79], v[204:207], v[188:191]
    v_mfma_f32_16x16x32_bf16 v[160:163], v[80:83], a[200:203], v[160:163]
    v_mfma_f32_16x16x32_bf16 v[168:171], v[80:83], a[224:227], v[168:171]
    v_mfma_f32_16x16x32_bf16 v[176:179], v[80:83], a[248:251], v[176:179]
    v_mfma_f32_16x16x32_bf16 v[184:187], v[80:83], v[208:211], v[184:187]
    v_mfma_f32_16x16x32_bf16 v[160:163], v[84:87], a[204:207], v[160:163]
    v_mfma_f32_16x16x32_bf16 v[168:171], v[84:87], a[228:231], v[168:171]
    v_mfma_f32_16x16x32_bf16 v[176:179], v[84:87], a[252:255], v[176:179]
    v_mfma_f32_16x16x32_bf16 v[184:187], v[84:87], v[212:215], v[184:187]
    v_mfma_f32_16x16x32_bf16 v[164:167], v[88:91], a[200:203], v[164:167]
    v_mfma_f32_16x16x32_bf16 v[172:175], v[88:91], a[224:227], v[172:175]
    v_mfma_f32_16x16x32_bf16 v[180:183], v[88:91], a[248:251], v[180:183]
    v_mfma_f32_16x16x32_bf16 v[188:191], v[88:91], v[208:211], v[188:191]
    v_mfma_f32_16x16x32_bf16 v[164:167], v[92:95], a[204:207], v[164:167]
    v_mfma_f32_16x16x32_bf16 v[172:175], v[92:95], a[228:231], v[172:175]
    v_mfma_f32_16x16x32_bf16 v[180:183], v[92:95], a[252:255], v[180:183]
    v_mfma_f32_16x16x32_bf16 v[188:191], v[92:95], v[212:215], v[188:191]
    v_mfma_f32_16x16x32_bf16 v[160:163], v[96:99], a[208:211], v[160:163]
    v_mfma_f32_16x16x32_bf16 v[168:171], v[96:99], a[232:235], v[168:171]
    v_mfma_f32_16x16x32_bf16 v[176:179], v[96:99], v[192:195], v[176:179]
    v_mfma_f32_16x16x32_bf16 v[184:187], v[96:99], v[216:219], v[184:187]
    v_mfma_f32_16x16x32_bf16 v[160:163], v[100:103], a[212:215], v[160:163]
    v_mfma_f32_16x16x32_bf16 v[168:171], v[100:103], a[236:239], v[168:171]
    v_mfma_f32_16x16x32_bf16 v[176:179], v[100:103], v[196:199], v[176:179]
    v_mfma_f32_16x16x32_bf16 v[184:187], v[100:103], v[220:223], v[184:187]
    v_mfma_f32_16x16x32_bf16 v[164:167], v[104:107], a[208:211], v[164:167]
    v_mfma_f32_16x16x32_bf16 v[172:175], v[104:107], a[232:235], v[172:175]
    v_mfma_f32_16x16x32_bf16 v[180:183], v[104:107], v[192:195], v[180:183]
    v_mfma_f32_16x16x32_bf16 v[188:191], v[104:107], v[216:219], v[188:191]
    v_mfma_f32_16x16x32_bf16 v[164:167], v[108:111], a[212:215], v[164:167]
    v_mfma_f32_16x16x32_bf16 v[172:175], v[108:111], a[236:239], v[172:175]
    v_mfma_f32_16x16x32_bf16 v[180:183], v[108:111], v[196:199], v[180:183]
    v_mfma_f32_16x16x32_bf16 v[188:191], v[108:111], v[220:223], v[188:191]
    s_nop 9
    v_max3_f32 v16, v160, v161, v162
    v_max3_f32 v16, v16, v163, v164
    v_max3_f32 v16, v16, v165, v166
    v_max3_f32 v16, v16, v167, v240
    v_mov_b32 v17, v16
    s_nop 1
    v_permlane16_swap_b32 v16, v17
    s_nop 1
    v_max_f32 v16, v16, v17
    v_mov_b32 v17, v16
    s_nop 1
    v_permlane32_swap_b32 v16, v17
    s_nop 1
    v_max_f32 v16, v16, v17
    v_sub_f32 v17, v240, v16
    v_exp_f32 v17, v17
    v_mov_b32 v240, v16
    ds_bpermute_b32 v250, v62, v17 offset:0
    ds_bpermute_b32 v251, v62, v17 offset:4
    ds_bpermute_b32 v252, v62, v17 offset:8
    ds_bpermute_b32 v253, v62, v17 offset:12
    v_sub_f32 v160, v160, v16
    v_sub_f32 v161, v161, v16
    v_sub_f32 v162, v162, v16
    v_sub_f32 v163, v163, v16
    v_sub_f32 v164, v164, v16
    v_sub_f32 v165, v165, v16
    v_sub_f32 v166, v166, v16
    v_sub_f32 v167, v167, v16
    v_exp_f32 v160, v160
    v_exp_f32 v161, v161
    v_exp_f32 v162, v162
    v_exp_f32 v163, v163
    v_exp_f32 v164, v164
    v_exp_f32 v165, v165
    v_exp_f32 v166, v166
    v_exp_f32 v167, v167
    v_mul_f32 v4, v4, v17
    v_add_f32 v4, v4, v160
    v_add_f32 v4, v4, v161
    v_add_f32 v4, v4, v162
    v_add_f32 v4, v4, v163
    v_add_f32 v4, v4, v164
    v_add_f32 v4, v4, v165
    v_add_f32 v4, v4, v166
    v_add_f32 v4, v4, v167
    v_cvt_pk_bf16_f32 v224, v160, v161
    v_cvt_pk_bf16_f32 v225, v162, v163
    v_cvt_pk_bf16_f32 v226, v164, v165
    v_cvt_pk_bf16_f32 v227, v166, v167
    s_waitcnt lgkmcnt(0)
    v_accvgpr_read_b32 v18, a0
    v_mul_f32 v18, v18, v250
    v_accvgpr_write_b32 a0, v18
    v_accvgpr_read_b32 v19, a1
    v_mul_f32 v19, v19, v251
    v_accvgpr_write_b32 a1, v19
    v_accvgpr_read_b32 v18, a2
    v_mul_f32 v18, v18, v252
    v_accvgpr_write_b32 a2, v18
    v_accvgpr_read_b32 v19, a3
    v_mul_f32 v19, v19, v253
    v_accvgpr_write_b32 a3, v19
    v_accvgpr_read_b32 v18, a4
    v_mul_f32 v18, v18, v250
    v_accvgpr_write_b32 a4, v18
    v_accvgpr_read_b32 v19, a5
    v_mul_f32 v19, v19, v251
    v_accvgpr_write_b32 a5, v19
    v_accvgpr_read_b32 v18, a6
    v_mul_f32 v18, v18, v252
    v_accvgpr_write_b32 a6, v18
    v_accvgpr_read_b32 v19, a7
    v_mul_f32 v19, v19, v253
    v_accvgpr_write_b32 a7, v19
    v_accvgpr_read_b32 v18, a8
    v_mul_f32 v18, v18, v250
    v_accvgpr_write_b32 a8, v18
    v_accvgpr_read_b32 v19, a9
    v_mul_f32 v19, v19, v251
    v_accvgpr_write_b32 a9, v19
    v_accvgpr_read_b32 v18, a10
    v_mul_f32 v18, v18, v252
    v_accvgpr_write_b32 a10, v18
    v_accvgpr_read_b32 v19, a11
    v_mul_f32 v19, v19, v253
    v_accvgpr_write_b32 a11, v19
    v_accvgpr_read_b32 v18, a12
    v_mul_f32 v18, v18, v250
    v_accvgpr_write_b32 a12, v18
    v_accvgpr_read_b32 v19, a13
    v_mul_f32 v19, v19, v251
    v_accvgpr_write_b32 a13, v19
    v_accvgpr_read_b32 v18, a14
    v_mul_f32 v18, v18, v252
    v_accvgpr_write_b32 a14, v18
    v_accvgpr_read_b32 v19, a15
    v_mul_f32 v19, v19, v253
    v_accvgpr_write_b32 a15, v19
    v_accvgpr_read_b32 v18, a16
    v_mul_f32 v18, v18, v250
    v_accvgpr_write_b32 a16, v18
    v_accvgpr_read_b32 v19, a17
    v_mul_f32 v19, v19, v251
    v_accvgpr_write_b32 a17, v19
    v_accvgpr_read_b32 v18, a18
    v_mul_f32 v18, v18, v252
    v_accvgpr_write_b32 a18, v18
    v_accvgpr_read_b32 v19, a19
    v_mul_f32 v19, v19, v253
    v_accvgpr_write_b32 a19, v19
    v_accvgpr_read_b32 v18, a20
    v_mul_f32 v18, v18, v250
    v_accvgpr_write_b32 a20, v18
    v_accvgpr_read_b32 v19, a21
    v_mul_f32 v19, v19, v251
    v_accvgpr_write_b32 a21, v19
    v_accvgpr_read_b32 v18, a22
    v_mul_f32 v18, v18, v252
    v_accvgpr_write_b32 a22, v18
    v_accvgpr_read_b32 v19, a23
    v_mul_f32 v19, v19, v253
    v_accvgpr_write_b32 a23, v19
    v_accvgpr_read_b32 v18, a24
    v_mul_f32 v18, v18, v250
    v_accvgpr_write_b32 a24, v18
    v_accvgpr_read_b32 v19, a25
    v_mul_f32 v19, v19, v251
    v_accvgpr_write_b32 a25, v19
    v_accvgpr_read_b32 v18, a26
    v_mul_f32 v18, v18, v252
    v_accvgpr_write_b32 a26, v18
    v_accvgpr_read_b32 v19, a27
    v_mul_f32 v19, v19, v253
    v_accvgpr_write_b32 a27, v19
    v_accvgpr_read_b32 v18, a28
    v_mul_f32 v18, v18, v250
    v_accvgpr_write_b32 a28, v18
    v_accvgpr_read_b32 v19, a29
    v_mul_f32 v19, v19, v251
    v_accvgpr_write_b32 a29, v19
    v_accvgpr_read_b32 v18, a30
    v_mul_f32 v18, v18, v252
    v_accvgpr_write_b32 a30, v18
    v_accvgpr_read_b32 v19, a31
    v_mul_f32 v19, v19, v253
    v_accvgpr_write_b32 a31, v19
    v_accvgpr_read_b32 v18, a32
    v_mul_f32 v18, v18, v250
    v_accvgpr_write_b32 a32, v18
    v_accvgpr_read_b32 v19, a33
    v_mul_f32 v19, v19, v251
    v_accvgpr_write_b32 a33, v19
    v_accvgpr_read_b32 v18, a34
    v_mul_f32 v18, v18, v252
    v_accvgpr_write_b32 a34, v18
    v_accvgpr_read_b32 v19, a35
    v_mul_f32 v19, v19, v253
    v_accvgpr_write_b32 a35, v19
    v_accvgpr_read_b32 v18, a36
    v_mul_f32 v18, v18, v250
    v_accvgpr_write_b32 a36, v18
    v_accvgpr_read_b32 v19, a37
    v_mul_f32 v19, v19, v251
    v_accvgpr_write_b32 a37, v19
    v_accvgpr_read_b32 v18, a38
    v_mul_f32 v18, v18, v252
    v_accvgpr_write_b32 a38, v18
    v_accvgpr_read_b32 v19, a39
    v_mul_f32 v19, v19, v253
    v_accvgpr_write_b32 a39, v19
    v_accvgpr_read_b32 v18, a40
    v_mul_f32 v18, v18, v250
    v_accvgpr_write_b32 a40, v18
    v_accvgpr_read_b32 v19, a41
    v_mul_f32 v19, v19, v251
    v_accvgpr_write_b32 a41, v19
    v_accvgpr_read_b32 v18, a42
    v_mul_f32 v18, v18, v252
    v_accvgpr_write_b32 a42, v18
    v_accvgpr_read_b32 v19, a43
    v_mul_f32 v19, v19, v253
    v_accvgpr_write_b32 a43, v19
    v_accvgpr_read_b32 v18, a44
    v_mul_f32 v18, v18, v250
    v_accvgpr_write_b32 a44, v18
    v_accvgpr_read_b32 v19, a45
    v_mul_f32 v19, v19, v251
    v_accvgpr_write_b32 a45, v19
    v_accvgpr_read_b32 v18, a46
    v_mul_f32 v18, v18, v252
    v_accvgpr_write_b32 a46, v18
    v_accvgpr_read_b32 v19, a47
    v_mul_f32 v19, v19, v253
    v_accvgpr_write_b32 a47, v19
    v_max3_f32 v16, v168, v169, v170
    v_max3_f32 v16, v16, v171, v172
    v_max3_f32 v16, v16, v173, v174
    v_max3_f32 v16, v16, v175, v241
    v_mov_b32 v17, v16
    s_nop 1
    v_permlane16_swap_b32 v16, v17
    s_nop 1
    v_max_f32 v16, v16, v17
    v_mov_b32 v17, v16
    s_nop 1
    v_permlane32_swap_b32 v16, v17
    s_nop 1
    v_max_f32 v16, v16, v17
    v_sub_f32 v17, v241, v16
    v_exp_f32 v17, v17
    v_mov_b32 v241, v16
    ds_bpermute_b32 v250, v62, v17 offset:0
    ds_bpermute_b32 v251, v62, v17 offset:4
    ds_bpermute_b32 v252, v62, v17 offset:8
    ds_bpermute_b32 v253, v62, v17 offset:12
    v_sub_f32 v168, v168, v16
    v_sub_f32 v169, v169, v16
    v_sub_f32 v170, v170, v16
    v_sub_f32 v171, v171, v16
    v_sub_f32 v172, v172, v16
    v_sub_f32 v173, v173, v16
    v_sub_f32 v174, v174, v16
    v_sub_f32 v175, v175, v16
    v_exp_f32 v168, v168
    v_exp_f32 v169, v169
    v_exp_f32 v170, v170
    v_exp_f32 v171, v171
    v_exp_f32 v172, v172
    v_exp_f32 v173, v173
    v_exp_f32 v174, v174
    v_exp_f32 v175, v175
    v_mul_f32 v5, v5, v17
    v_add_f32 v5, v5, v168
    v_add_f32 v5, v5, v169
    v_add_f32 v5, v5, v170
    v_add_f32 v5, v5, v171
    v_add_f32 v5, v5, v172
    v_add_f32 v5, v5, v173
    v_add_f32 v5, v5, v174
    v_add_f32 v5, v5, v175
    v_cvt_pk_bf16_f32 v228, v168, v169
    v_cvt_pk_bf16_f32 v229, v170, v171
    v_cvt_pk_bf16_f32 v230, v172, v173
    v_cvt_pk_bf16_f32 v231, v174, v175
    s_waitcnt lgkmcnt(0)
    v_accvgpr_read_b32 v18, a48
    v_mul_f32 v18, v18, v250
    v_accvgpr_write_b32 a48, v18
    v_accvgpr_read_b32 v19, a49
    v_mul_f32 v19, v19, v251
    v_accvgpr_write_b32 a49, v19
    v_accvgpr_read_b32 v18, a50
    v_mul_f32 v18, v18, v252
    v_accvgpr_write_b32 a50, v18
    v_accvgpr_read_b32 v19, a51
    v_mul_f32 v19, v19, v253
    v_accvgpr_write_b32 a51, v19
    v_accvgpr_read_b32 v18, a52
    v_mul_f32 v18, v18, v250
    v_accvgpr_write_b32 a52, v18
    v_accvgpr_read_b32 v19, a53
    v_mul_f32 v19, v19, v251
    v_accvgpr_write_b32 a53, v19
    v_accvgpr_read_b32 v18, a54
    v_mul_f32 v18, v18, v252
    v_accvgpr_write_b32 a54, v18
    v_accvgpr_read_b32 v19, a55
    v_mul_f32 v19, v19, v253
    v_accvgpr_write_b32 a55, v19
    v_accvgpr_read_b32 v18, a56
    v_mul_f32 v18, v18, v250
    v_accvgpr_write_b32 a56, v18
    v_accvgpr_read_b32 v19, a57
    v_mul_f32 v19, v19, v251
    v_accvgpr_write_b32 a57, v19
    v_accvgpr_read_b32 v18, a58
    v_mul_f32 v18, v18, v252
    v_accvgpr_write_b32 a58, v18
    v_accvgpr_read_b32 v19, a59
    v_mul_f32 v19, v19, v253
    v_accvgpr_write_b32 a59, v19
    v_accvgpr_read_b32 v18, a60
    v_mul_f32 v18, v18, v250
    v_accvgpr_write_b32 a60, v18
    v_accvgpr_read_b32 v19, a61
    v_mul_f32 v19, v19, v251
    v_accvgpr_write_b32 a61, v19
    v_accvgpr_read_b32 v18, a62
    v_mul_f32 v18, v18, v252
    v_accvgpr_write_b32 a62, v18
    v_accvgpr_read_b32 v19, a63
    v_mul_f32 v19, v19, v253
    v_accvgpr_write_b32 a63, v19
    v_accvgpr_read_b32 v18, a64
    v_mul_f32 v18, v18, v250
    v_accvgpr_write_b32 a64, v18
    v_accvgpr_read_b32 v19, a65
    v_mul_f32 v19, v19, v251
    v_accvgpr_write_b32 a65, v19
    v_accvgpr_read_b32 v18, a66
    v_mul_f32 v18, v18, v252
    v_accvgpr_write_b32 a66, v18
    v_accvgpr_read_b32 v19, a67
    v_mul_f32 v19, v19, v253
    v_accvgpr_write_b32 a67, v19
    v_accvgpr_read_b32 v18, a68
    v_mul_f32 v18, v18, v250
    v_accvgpr_write_b32 a68, v18
    v_accvgpr_read_b32 v19, a69
    v_mul_f32 v19, v19, v251
    v_accvgpr_write_b32 a69, v19
    v_accvgpr_read_b32 v18, a70
    v_mul_f32 v18, v18, v252
    v_accvgpr_write_b32 a70, v18
    v_accvgpr_read_b32 v19, a71
    v_mul_f32 v19, v19, v253
    v_accvgpr_write_b32 a71, v19
    v_accvgpr_read_b32 v18, a72
    v_mul_f32 v18, v18, v250
    v_accvgpr_write_b32 a72, v18
    v_accvgpr_read_b32 v19, a73
    v_mul_f32 v19, v19, v251
    v_accvgpr_write_b32 a73, v19
    v_accvgpr_read_b32 v18, a74
    v_mul_f32 v18, v18, v252
    v_accvgpr_write_b32 a74, v18
    v_accvgpr_read_b32 v19, a75
    v_mul_f32 v19, v19, v253
    v_accvgpr_write_b32 a75, v19
    v_accvgpr_read_b32 v18, a76
    v_mul_f32 v18, v18, v250
    v_accvgpr_write_b32 a76, v18
    v_accvgpr_read_b32 v19, a77
    v_mul_f32 v19, v19, v251
    v_accvgpr_write_b32 a77, v19
    v_accvgpr_read_b32 v18, a78
    v_mul_f32 v18, v18, v252
    v_accvgpr_write_b32 a78, v18
    v_accvgpr_read_b32 v19, a79
    v_mul_f32 v19, v19, v253
    v_accvgpr_write_b32 a79, v19
    v_accvgpr_read_b32 v18, a80
    v_mul_f32 v18, v18, v250
    v_accvgpr_write_b32 a80, v18
    v_accvgpr_read_b32 v19, a81
    v_mul_f32 v19, v19, v251
    v_accvgpr_write_b32 a81, v19
    v_accvgpr_read_b32 v18, a82
    v_mul_f32 v18, v18, v252
    v_accvgpr_write_b32 a82, v18
    v_accvgpr_read_b32 v19, a83
    v_mul_f32 v19, v19, v253
    v_accvgpr_write_b32 a83, v19
    v_accvgpr_read_b32 v18, a84
    v_mul_f32 v18, v18, v250
    v_accvgpr_write_b32 a84, v18
    v_accvgpr_read_b32 v19, a85
    v_mul_f32 v19, v19, v251
    v_accvgpr_write_b32 a85, v19
    v_accvgpr_read_b32 v18, a86
    v_mul_f32 v18, v18, v252
    v_accvgpr_write_b32 a86, v18
    v_accvgpr_read_b32 v19, a87
    v_mul_f32 v19, v19, v253
    v_accvgpr_write_b32 a87, v19
    v_accvgpr_read_b32 v18, a88
    v_mul_f32 v18, v18, v250
    v_accvgpr_write_b32 a88, v18
    v_accvgpr_read_b32 v19, a89
    v_mul_f32 v19, v19, v251
    v_accvgpr_write_b32 a89, v19
    v_accvgpr_read_b32 v18, a90
    v_mul_f32 v18, v18, v252
    v_accvgpr_write_b32 a90, v18
    v_accvgpr_read_b32 v19, a91
    v_mul_f32 v19, v19, v253
    v_accvgpr_write_b32 a91, v19
    v_accvgpr_read_b32 v18, a92
    v_mul_f32 v18, v18, v250
    v_accvgpr_write_b32 a92, v18
    v_accvgpr_read_b32 v19, a93
    v_mul_f32 v19, v19, v251
    v_accvgpr_write_b32 a93, v19
    v_accvgpr_read_b32 v18, a94
    v_mul_f32 v18, v18, v252
    v_accvgpr_write_b32 a94, v18
    v_accvgpr_read_b32 v19, a95
    v_mul_f32 v19, v19, v253
    v_accvgpr_write_b32 a95, v19
    v_max3_f32 v16, v176, v177, v178
    v_max3_f32 v16, v16, v179, v180
    v_max3_f32 v16, v16, v181, v182
    v_max3_f32 v16, v16, v183, v242
    v_mov_b32 v17, v16
    s_nop 1
    v_permlane16_swap_b32 v16, v17
    s_nop 1
    v_max_f32 v16, v16, v17
    v_mov_b32 v17, v16
    s_nop 1
    v_permlane32_swap_b32 v16, v17
    s_nop 1
    v_max_f32 v16, v16, v17
    v_sub_f32 v17, v242, v16
    v_exp_f32 v17, v17
    v_mov_b32 v242, v16
    ds_bpermute_b32 v250, v62, v17 offset:0
    ds_bpermute_b32 v251, v62, v17 offset:4
    ds_bpermute_b32 v252, v62, v17 offset:8
    ds_bpermute_b32 v253, v62, v17 offset:12
    v_sub_f32 v176, v176, v16
    v_sub_f32 v177, v177, v16
    v_sub_f32 v178, v178, v16
    v_sub_f32 v179, v179, v16
    v_sub_f32 v180, v180, v16
    v_sub_f32 v181, v181, v16
    v_sub_f32 v182, v182, v16
    v_sub_f32 v183, v183, v16
    v_exp_f32 v176, v176
    v_exp_f32 v177, v177
    v_exp_f32 v178, v178
    v_exp_f32 v179, v179
    v_exp_f32 v180, v180
    v_exp_f32 v181, v181
    v_exp_f32 v182, v182
    v_exp_f32 v183, v183
    v_mul_f32 v6, v6, v17
    v_add_f32 v6, v6, v176
    v_add_f32 v6, v6, v177
    v_add_f32 v6, v6, v178
    v_add_f32 v6, v6, v179
    v_add_f32 v6, v6, v180
    v_add_f32 v6, v6, v181
    v_add_f32 v6, v6, v182
    v_add_f32 v6, v6, v183
    v_cvt_pk_bf16_f32 v232, v176, v177
    v_cvt_pk_bf16_f32 v233, v178, v179
    v_cvt_pk_bf16_f32 v234, v180, v181
    v_cvt_pk_bf16_f32 v235, v182, v183
    s_waitcnt lgkmcnt(0)
    v_accvgpr_read_b32 v18, a96
    v_mul_f32 v18, v18, v250
    v_accvgpr_write_b32 a96, v18
    v_accvgpr_read_b32 v19, a97
    v_mul_f32 v19, v19, v251
    v_accvgpr_write_b32 a97, v19
    v_accvgpr_read_b32 v18, a98
    v_mul_f32 v18, v18, v252
    v_accvgpr_write_b32 a98, v18
    v_accvgpr_read_b32 v19, a99
    v_mul_f32 v19, v19, v253
    v_accvgpr_write_b32 a99, v19
    v_accvgpr_read_b32 v18, a100
    v_mul_f32 v18, v18, v250
    v_accvgpr_write_b32 a100, v18
    v_accvgpr_read_b32 v19, a101
    v_mul_f32 v19, v19, v251
    v_accvgpr_write_b32 a101, v19
    v_accvgpr_read_b32 v18, a102
    v_mul_f32 v18, v18, v252
    v_accvgpr_write_b32 a102, v18
    v_accvgpr_read_b32 v19, a103
    v_mul_f32 v19, v19, v253
    v_accvgpr_write_b32 a103, v19
    v_accvgpr_read_b32 v18, a104
    v_mul_f32 v18, v18, v250
    v_accvgpr_write_b32 a104, v18
    v_accvgpr_read_b32 v19, a105
    v_mul_f32 v19, v19, v251
    v_accvgpr_write_b32 a105, v19
    v_accvgpr_read_b32 v18, a106
    v_mul_f32 v18, v18, v252
    v_accvgpr_write_b32 a106, v18
    v_accvgpr_read_b32 v19, a107
    v_mul_f32 v19, v19, v253
    v_accvgpr_write_b32 a107, v19
    v_accvgpr_read_b32 v18, a108
    v_mul_f32 v18, v18, v250
    v_accvgpr_write_b32 a108, v18
    v_accvgpr_read_b32 v19, a109
    v_mul_f32 v19, v19, v251
    v_accvgpr_write_b32 a109, v19
    v_accvgpr_read_b32 v18, a110
    v_mul_f32 v18, v18, v252
    v_accvgpr_write_b32 a110, v18
    v_accvgpr_read_b32 v19, a111
    v_mul_f32 v19, v19, v253
    v_accvgpr_write_b32 a111, v19
    v_accvgpr_read_b32 v18, a112
    v_mul_f32 v18, v18, v250
    v_accvgpr_write_b32 a112, v18
    v_accvgpr_read_b32 v19, a113
    v_mul_f32 v19, v19, v251
    v_accvgpr_write_b32 a113, v19
    v_accvgpr_read_b32 v18, a114
    v_mul_f32 v18, v18, v252
    v_accvgpr_write_b32 a114, v18
    v_accvgpr_read_b32 v19, a115
    v_mul_f32 v19, v19, v253
    v_accvgpr_write_b32 a115, v19
    v_accvgpr_read_b32 v18, a116
    v_mul_f32 v18, v18, v250
    v_accvgpr_write_b32 a116, v18
    v_accvgpr_read_b32 v19, a117
    v_mul_f32 v19, v19, v251
    v_accvgpr_write_b32 a117, v19
    v_accvgpr_read_b32 v18, a118
    v_mul_f32 v18, v18, v252
    v_accvgpr_write_b32 a118, v18
    v_accvgpr_read_b32 v19, a119
    v_mul_f32 v19, v19, v253
    v_accvgpr_write_b32 a119, v19
    v_accvgpr_read_b32 v18, a120
    v_mul_f32 v18, v18, v250
    v_accvgpr_write_b32 a120, v18
    v_accvgpr_read_b32 v19, a121
    v_mul_f32 v19, v19, v251
    v_accvgpr_write_b32 a121, v19
    v_accvgpr_read_b32 v18, a122
    v_mul_f32 v18, v18, v252
    v_accvgpr_write_b32 a122, v18
    v_accvgpr_read_b32 v19, a123
    v_mul_f32 v19, v19, v253
    v_accvgpr_write_b32 a123, v19
    v_accvgpr_read_b32 v18, a124
    v_mul_f32 v18, v18, v250
    v_accvgpr_write_b32 a124, v18
    v_accvgpr_read_b32 v19, a125
    v_mul_f32 v19, v19, v251
    v_accvgpr_write_b32 a125, v19
    v_accvgpr_read_b32 v18, a126
    v_mul_f32 v18, v18, v252
    v_accvgpr_write_b32 a126, v18
    v_accvgpr_read_b32 v19, a127
    v_mul_f32 v19, v19, v253
    v_accvgpr_write_b32 a127, v19
    v_accvgpr_read_b32 v18, a128
    v_mul_f32 v18, v18, v250
    v_accvgpr_write_b32 a128, v18
    v_accvgpr_read_b32 v19, a129
    v_mul_f32 v19, v19, v251
    v_accvgpr_write_b32 a129, v19
    v_accvgpr_read_b32 v18, a130
    v_mul_f32 v18, v18, v252
    v_accvgpr_write_b32 a130, v18
    v_accvgpr_read_b32 v19, a131
    v_mul_f32 v19, v19, v253
    v_accvgpr_write_b32 a131, v19
    v_accvgpr_read_b32 v18, a132
    v_mul_f32 v18, v18, v250
    v_accvgpr_write_b32 a132, v18
    v_accvgpr_read_b32 v19, a133
    v_mul_f32 v19, v19, v251
    v_accvgpr_write_b32 a133, v19
    v_accvgpr_read_b32 v18, a134
    v_mul_f32 v18, v18, v252
    v_accvgpr_write_b32 a134, v18
    v_accvgpr_read_b32 v19, a135
    v_mul_f32 v19, v19, v253
    v_accvgpr_write_b32 a135, v19
    v_accvgpr_read_b32 v18, a136
    v_mul_f32 v18, v18, v250
    v_accvgpr_write_b32 a136, v18
    v_accvgpr_read_b32 v19, a137
    v_mul_f32 v19, v19, v251
    v_accvgpr_write_b32 a137, v19
    v_accvgpr_read_b32 v18, a138
    v_mul_f32 v18, v18, v252
    v_accvgpr_write_b32 a138, v18
    v_accvgpr_read_b32 v19, a139
    v_mul_f32 v19, v19, v253
    v_accvgpr_write_b32 a139, v19
    v_accvgpr_read_b32 v18, a140
    v_mul_f32 v18, v18, v250
    v_accvgpr_write_b32 a140, v18
    v_accvgpr_read_b32 v19, a141
    v_mul_f32 v19, v19, v251
    v_accvgpr_write_b32 a141, v19
    v_accvgpr_read_b32 v18, a142
    v_mul_f32 v18, v18, v252
    v_accvgpr_write_b32 a142, v18
    v_accvgpr_read_b32 v19, a143
    v_mul_f32 v19, v19, v253
    v_accvgpr_write_b32 a143, v19
    v_max3_f32 v16, v184, v185, v186
    v_max3_f32 v16, v16, v187, v188
    v_max3_f32 v16, v16, v189, v190
    v_max3_f32 v16, v16, v191, v243
    v_mov_b32 v17, v16
    s_nop 1
    v_permlane16_swap_b32 v16, v17
    s_nop 1
    v_max_f32 v16, v16, v17
    v_mov_b32 v17, v16
    s_nop 1
    v_permlane32_swap_b32 v16, v17
    s_nop 1
    v_max_f32 v16, v16, v17
    v_sub_f32 v17, v243, v16
    v_exp_f32 v17, v17
    v_mov_b32 v243, v16
    ds_bpermute_b32 v250, v62, v17 offset:0
    ds_bpermute_b32 v251, v62, v17 offset:4
    ds_bpermute_b32 v252, v62, v17 offset:8
    ds_bpermute_b32 v253, v62, v17 offset:12
    v_sub_f32 v184, v184, v16
    v_sub_f32 v185, v185, v16
    v_sub_f32 v186, v186, v16
    v_sub_f32 v187, v187, v16
    v_sub_f32 v188, v188, v16
    v_sub_f32 v189, v189, v16
    v_sub_f32 v190, v190, v16
    v_sub_f32 v191, v191, v16
    v_exp_f32 v184, v184
    v_exp_f32 v185, v185
    v_exp_f32 v186, v186
    v_exp_f32 v187, v187
    v_exp_f32 v188, v188
    v_exp_f32 v189, v189
    v_exp_f32 v190, v190
    v_exp_f32 v191, v191
    v_mul_f32 v7, v7, v17
    v_add_f32 v7, v7, v184
    v_add_f32 v7, v7, v185
    v_add_f32 v7, v7, v186
    v_add_f32 v7, v7, v187
    v_add_f32 v7, v7, v188
    v_add_f32 v7, v7, v189
    v_add_f32 v7, v7, v190
    v_add_f32 v7, v7, v191
    v_cvt_pk_bf16_f32 v236, v184, v185
    v_cvt_pk_bf16_f32 v237, v186, v187
    v_cvt_pk_bf16_f32 v238, v188, v189
    v_cvt_pk_bf16_f32 v239, v190, v191
    s_waitcnt lgkmcnt(0)
    v_accvgpr_read_b32 v18, a144
    v_mul_f32 v18, v18, v250
    v_accvgpr_write_b32 a144, v18
    v_accvgpr_read_b32 v19, a145
    v_mul_f32 v19, v19, v251
    v_accvgpr_write_b32 a145, v19
    v_accvgpr_read_b32 v18, a146
    v_mul_f32 v18, v18, v252
    v_accvgpr_write_b32 a146, v18
    v_accvgpr_read_b32 v19, a147
    v_mul_f32 v19, v19, v253
    v_accvgpr_write_b32 a147, v19
    v_accvgpr_read_b32 v18, a148
    v_mul_f32 v18, v18, v250
    v_accvgpr_write_b32 a148, v18
    v_accvgpr_read_b32 v19, a149
    v_mul_f32 v19, v19, v251
    v_accvgpr_write_b32 a149, v19
    v_accvgpr_read_b32 v18, a150
    v_mul_f32 v18, v18, v252
    v_accvgpr_write_b32 a150, v18
    v_accvgpr_read_b32 v19, a151
    v_mul_f32 v19, v19, v253
    v_accvgpr_write_b32 a151, v19
    v_accvgpr_read_b32 v18, a152
    v_mul_f32 v18, v18, v250
    v_accvgpr_write_b32 a152, v18
    v_accvgpr_read_b32 v19, a153
    v_mul_f32 v19, v19, v251
    v_accvgpr_write_b32 a153, v19
    v_accvgpr_read_b32 v18, a154
    v_mul_f32 v18, v18, v252
    v_accvgpr_write_b32 a154, v18
    v_accvgpr_read_b32 v19, a155
    v_mul_f32 v19, v19, v253
    v_accvgpr_write_b32 a155, v19
    v_accvgpr_read_b32 v18, a156
    v_mul_f32 v18, v18, v250
    v_accvgpr_write_b32 a156, v18
    v_accvgpr_read_b32 v19, a157
    v_mul_f32 v19, v19, v251
    v_accvgpr_write_b32 a157, v19
    v_accvgpr_read_b32 v18, a158
    v_mul_f32 v18, v18, v252
    v_accvgpr_write_b32 a158, v18
    v_accvgpr_read_b32 v19, a159
    v_mul_f32 v19, v19, v253
    v_accvgpr_write_b32 a159, v19
    v_accvgpr_read_b32 v18, a160
    v_mul_f32 v18, v18, v250
    v_accvgpr_write_b32 a160, v18
    v_accvgpr_read_b32 v19, a161
    v_mul_f32 v19, v19, v251
    v_accvgpr_write_b32 a161, v19
    v_accvgpr_read_b32 v18, a162
    v_mul_f32 v18, v18, v252
    v_accvgpr_write_b32 a162, v18
    v_accvgpr_read_b32 v19, a163
    v_mul_f32 v19, v19, v253
    v_accvgpr_write_b32 a163, v19
    v_accvgpr_read_b32 v18, a164
    v_mul_f32 v18, v18, v250
    v_accvgpr_write_b32 a164, v18
    v_accvgpr_read_b32 v19, a165
    v_mul_f32 v19, v19, v251
    v_accvgpr_write_b32 a165, v19
    v_accvgpr_read_b32 v18, a166
    v_mul_f32 v18, v18, v252
    v_accvgpr_write_b32 a166, v18
    v_accvgpr_read_b32 v19, a167
    v_mul_f32 v19, v19, v253
    v_accvgpr_write_b32 a167, v19
    v_accvgpr_read_b32 v18, a168
    v_mul_f32 v18, v18, v250
    v_accvgpr_write_b32 a168, v18
    v_accvgpr_read_b32 v19, a169
    v_mul_f32 v19, v19, v251
    v_accvgpr_write_b32 a169, v19
    v_accvgpr_read_b32 v18, a170
    v_mul_f32 v18, v18, v252
    v_accvgpr_write_b32 a170, v18
    v_accvgpr_read_b32 v19, a171
    v_mul_f32 v19, v19, v253
    v_accvgpr_write_b32 a171, v19
    v_accvgpr_read_b32 v18, a172
    v_mul_f32 v18, v18, v250
    v_accvgpr_write_b32 a172, v18
    v_accvgpr_read_b32 v19, a173
    v_mul_f32 v19, v19, v251
    v_accvgpr_write_b32 a173, v19
    v_accvgpr_read_b32 v18, a174
    v_mul_f32 v18, v18, v252
    v_accvgpr_write_b32 a174, v18
    v_accvgpr_read_b32 v19, a175
    v_mul_f32 v19, v19, v253
    v_accvgpr_write_b32 a175, v19
    v_accvgpr_read_b32 v18, a176
    v_mul_f32 v18, v18, v250
    v_accvgpr_write_b32 a176, v18
    v_accvgpr_read_b32 v19, a177
    v_mul_f32 v19, v19, v251
    v_accvgpr_write_b32 a177, v19
    v_accvgpr_read_b32 v18, a178
    v_mul_f32 v18, v18, v252
    v_accvgpr_write_b32 a178, v18
    v_accvgpr_read_b32 v19, a179
    v_mul_f32 v19, v19, v253
    v_accvgpr_write_b32 a179, v19
    v_accvgpr_read_b32 v18, a180
    v_mul_f32 v18, v18, v250
    v_accvgpr_write_b32 a180, v18
    v_accvgpr_read_b32 v19, a181
    v_mul_f32 v19, v19, v251
    v_accvgpr_write_b32 a181, v19
    v_accvgpr_read_b32 v18, a182
    v_mul_f32 v18, v18, v252
    v_accvgpr_write_b32 a182, v18
    v_accvgpr_read_b32 v19, a183
    v_mul_f32 v19, v19, v253
    v_accvgpr_write_b32 a183, v19
    v_accvgpr_read_b32 v18, a184
    v_mul_f32 v18, v18, v250
    v_accvgpr_write_b32 a184, v18
    v_accvgpr_read_b32 v19, a185
    v_mul_f32 v19, v19, v251
    v_accvgpr_write_b32 a185, v19
    v_accvgpr_read_b32 v18, a186
    v_mul_f32 v18, v18, v252
    v_accvgpr_write_b32 a186, v18
    v_accvgpr_read_b32 v19, a187
    v_mul_f32 v19, v19, v253
    v_accvgpr_write_b32 a187, v19
    v_accvgpr_read_b32 v18, a188
    v_mul_f32 v18, v18, v250
    v_accvgpr_write_b32 a188, v18
    v_accvgpr_read_b32 v19, a189
    v_mul_f32 v19, v19, v251
    v_accvgpr_write_b32 a189, v19
    v_accvgpr_read_b32 v18, a190
    v_mul_f32 v18, v18, v252
    v_accvgpr_write_b32 a190, v18
    v_accvgpr_read_b32 v19, a191
    v_mul_f32 v19, v19, v253
    v_accvgpr_write_b32 a191, v19
    s_waitcnt vmcnt(0)
    s_nop 1
    v_mfma_f32_16x16x32_bf16 a[0:3], v[224:227], v[112:115], a[0:3]
    v_mfma_f32_16x16x32_bf16 a[48:51], v[228:231], v[112:115], a[48:51]
    v_mfma_f32_16x16x32_bf16 a[96:99], v[232:235], v[112:115], a[96:99]
    v_mfma_f32_16x16x32_bf16 a[144:147], v[236:239], v[112:115], a[144:147]
    v_mfma_f32_16x16x32_bf16 a[4:7], v[224:227], v[116:119], a[4:7]
    v_mfma_f32_16x16x32_bf16 a[52:55], v[228:231], v[116:119], a[52:55]
    v_mfma_f32_16x16x32_bf16 a[100:103], v[232:235], v[116:119], a[100:103]
    v_mfma_f32_16x16x32_bf16 a[148:151], v[236:239], v[116:119], a[148:151]
    v_mfma_f32_16x16x32_bf16 a[8:11], v[224:227], v[120:123], a[8:11]
    v_mfma_f32_16x16x32_bf16 a[56:59], v[228:231], v[120:123], a[56:59]
    v_mfma_f32_16x16x32_bf16 a[104:107], v[232:235], v[120:123], a[104:107]
    v_mfma_f32_16x16x32_bf16 a[152:155], v[236:239], v[120:123], a[152:155]
    v_mfma_f32_16x16x32_bf16 a[12:15], v[224:227], v[124:127], a[12:15]
    v_mfma_f32_16x16x32_bf16 a[60:63], v[228:231], v[124:127], a[60:63]
    v_mfma_f32_16x16x32_bf16 a[108:111], v[232:235], v[124:127], a[108:111]
    v_mfma_f32_16x16x32_bf16 a[156:159], v[236:239], v[124:127], a[156:159]
    v_mfma_f32_16x16x32_bf16 a[16:19], v[224:227], v[128:131], a[16:19]
    v_mfma_f32_16x16x32_bf16 a[64:67], v[228:231], v[128:131], a[64:67]
    v_mfma_f32_16x16x32_bf16 a[112:115], v[232:235], v[128:131], a[112:115]
    v_mfma_f32_16x16x32_bf16 a[160:163], v[236:239], v[128:131], a[160:163]
    v_mfma_f32_16x16x32_bf16 a[20:23], v[224:227], v[132:135], a[20:23]
    v_mfma_f32_16x16x32_bf16 a[68:71], v[228:231], v[132:135], a[68:71]
    v_mfma_f32_16x16x32_bf16 a[116:119], v[232:235], v[132:135], a[116:119]
    v_mfma_f32_16x16x32_bf16 a[164:167], v[236:239], v[132:135], a[164:167]
    v_mfma_f32_16x16x32_bf16 a[24:27], v[224:227], v[136:139], a[24:27]
    v_mfma_f32_16x16x32_bf16 a[72:75], v[228:231], v[136:139], a[72:75]
    v_mfma_f32_16x16x32_bf16 a[120:123], v[232:235], v[136:139], a[120:123]
    v_mfma_f32_16x16x32_bf16 a[168:171], v[236:239], v[136:139], a[168:171]
    v_mfma_f32_16x16x32_bf16 a[28:31], v[224:227], v[140:143], a[28:31]
    v_mfma_f32_16x16x32_bf16 a[76:79], v[228:231], v[140:143], a[76:79]
    v_mfma_f32_16x16x32_bf16 a[124:127], v[232:235], v[140:143], a[124:127]
    v_mfma_f32_16x16x32_bf16 a[172:175], v[236:239], v[140:143], a[172:175]
    v_mfma_f32_16x16x32_bf16 a[32:35], v[224:227], v[144:147], a[32:35]
    v_mfma_f32_16x16x32_bf16 a[80:83], v[228:231], v[144:147], a[80:83]
    v_mfma_f32_16x16x32_bf16 a[128:131], v[232:235], v[144:147], a[128:131]
    v_mfma_f32_16x16x32_bf16 a[176:179], v[236:239], v[144:147], a[176:179]
    v_mfma_f32_16x16x32_bf16 a[36:39], v[224:227], v[148:151], a[36:39]
    v_mfma_f32_16x16x32_bf16 a[84:87], v[228:231], v[148:151], a[84:87]
    v_mfma_f32_16x16x32_bf16 a[132:135], v[232:235], v[148:151], a[132:135]
    v_mfma_f32_16x16x32_bf16 a[180:183], v[236:239], v[148:151], a[180:183]
    v_mfma_f32_16x16x32_bf16 a[40:43], v[224:227], v[152:155], a[40:43]
    v_mfma_f32_16x16x32_bf16 a[88:91], v[228:231], v[152:155], a[88:91]
    v_mfma_f32_16x16x32_bf16 a[136:139], v[232:235], v[152:155], a[136:139]
    v_mfma_f32_16x16x32_bf16 a[184:187], v[236:239], v[152:155], a[184:187]
    v_mfma_f32_16x16x32_bf16 a[44:47], v[224:227], v[156:159], a[44:47]
    v_mfma_f32_16x16x32_bf16 a[92:95], v[228:231], v[156:159], a[92:95]
    v_mfma_f32_16x16x32_bf16 a[140:143], v[232:235], v[156:159], a[140:143]
    v_mfma_f32_16x16x32_bf16 a[188:191], v[236:239], v[156:159], a[188:191]
    s_add_u32 s48, s48, 24576
    s_cmp_lt_u32 s48, 1572864
    s_nop 7
    s_cbranch_scc1 L_slowloop
    s_nop 1
    v_mfma_f32_16x16x4_f32 v[48:51], v4, v63, 0
    v_mfma_f32_16x16x4_f32 v[52:55], v5, v63, 0
    v_mfma_f32_16x16x4_f32 v[56:59], v6, v63, 0
    v_mfma_f32_16x16x4_f32 v[128:131], v7, v63, 0
    s_nop 10
    v_rcp_f32 v48, v48
    v_rcp_f32 v49, v49
    v_rcp_f32 v50, v50
    v_rcp_f32 v51, v51
    v_rcp_f32 v52, v52
    v_rcp_f32 v53, v53
    v_rcp_f32 v54, v54
    v_rcp_f32 v55, v55
    v_rcp_f32 v56, v56
    v_rcp_f32 v57, v57
    v_rcp_f32 v58, v58
    v_rcp_f32 v59, v59
    v_rcp_f32 v128, v128
    v_rcp_f32 v129, v129
    v_rcp_f32 v130, v130
    v_rcp_f32 v131, v131
    s_nop 0
    v_accvgpr_read_b32 v64, a0
    v_accvgpr_read_b32 v65, a4
    v_accvgpr_read_b32 v66, a8
    v_accvgpr_read_b32 v67, a12
    v_accvgpr_read_b32 v68, a16
    v_accvgpr_read_b32 v69, a20
    v_accvgpr_read_b32 v70, a24
    v_accvgpr_read_b32 v71, a28
    v_accvgpr_read_b32 v72, a32
    v_accvgpr_read_b32 v73, a36
    v_accvgpr_read_b32 v74, a40
    v_accvgpr_read_b32 v75, a44
    v_pk_mul_f32 v[64:65], v[64:65], v[48:49] op_sel:[0,0] op_sel_hi:[1,0]
    v_pk_mul_f32 v[66:67], v[66:67], v[48:49] op_sel:[0,0] op_sel_hi:[1,0]
    v_pk_mul_f32 v[68:69], v[68:69], v[48:49] op_sel:[0,0] op_sel_hi:[1,0]
    v_pk_mul_f32 v[70:71], v[70:71], v[48:49] op_sel:[0,0] op_sel_hi:[1,0]
    v_pk_mul_f32 v[72:73], v[72:73], v[48:49] op_sel:[0,0] op_sel_hi:[1,0]
    v_pk_mul_f32 v[74:75], v[74:75], v[48:49] op_sel:[0,0] op_sel_hi:[1,0]
    v_cvt_pk_bf16_f32 v64, v64, v65
    v_cvt_pk_bf16_f32 v65, v66, v67
    v_cvt_pk_bf16_f32 v66, v68, v69
    v_cvt_pk_bf16_f32 v67, v70, v71
    v_cvt_pk_bf16_f32 v68, v72, v73
    v_cvt_pk_bf16_f32 v69, v74, v75
    buffer_store_dwordx4 v[64:67], v60, s[12:15], s33 offen offset:0 sc0 sc1
    buffer_store_dwordx2 v[68:69], v61, s[12:15], s33 offen offset:256 sc0 sc1
    v_accvgpr_read_b32 v76, a1
    v_accvgpr_read_b32 v77, a5
    v_accvgpr_read_b32 v78, a9
    v_accvgpr_read_b32 v79, a13
    v_accvgpr_read_b32 v80, a17
    v_accvgpr_read_b32 v81, a21
    v_accvgpr_read_b32 v82, a25
    v_accvgpr_read_b32 v83, a29
    v_accvgpr_read_b32 v84, a33
    v_accvgpr_read_b32 v85, a37
    v_accvgpr_read_b32 v86, a41
    v_accvgpr_read_b32 v87, a45
    v_pk_mul_f32 v[76:77], v[76:77], v[48:49] op_sel:[0,1] op_sel_hi:[1,1]
    v_pk_mul_f32 v[78:79], v[78:79], v[48:49] op_sel:[0,1] op_sel_hi:[1,1]
    v_pk_mul_f32 v[80:81], v[80:81], v[48:49] op_sel:[0,1] op_sel_hi:[1,1]
    v_pk_mul_f32 v[82:83], v[82:83], v[48:49] op_sel:[0,1] op_sel_hi:[1,1]
    v_pk_mul_f32 v[84:85], v[84:85], v[48:49] op_sel:[0,1] op_sel_hi:[1,1]
    v_pk_mul_f32 v[86:87], v[86:87], v[48:49] op_sel:[0,1] op_sel_hi:[1,1]
    v_cvt_pk_bf16_f32 v76, v76, v77
    v_cvt_pk_bf16_f32 v77, v78, v79
    v_cvt_pk_bf16_f32 v78, v80, v81
    v_cvt_pk_bf16_f32 v79, v82, v83
    v_cvt_pk_bf16_f32 v80, v84, v85
    v_cvt_pk_bf16_f32 v81, v86, v87
    buffer_store_dwordx4 v[76:79], v60, s[12:15], s33 offen offset:384 sc0 sc1
    buffer_store_dwordx2 v[80:81], v61, s[12:15], s33 offen offset:640 sc0 sc1
    v_accvgpr_read_b32 v88, a2
    v_accvgpr_read_b32 v89, a6
    v_accvgpr_read_b32 v90, a10
    v_accvgpr_read_b32 v91, a14
    v_accvgpr_read_b32 v92, a18
    v_accvgpr_read_b32 v93, a22
    v_accvgpr_read_b32 v94, a26
    v_accvgpr_read_b32 v95, a30
    v_accvgpr_read_b32 v96, a34
    v_accvgpr_read_b32 v97, a38
    v_accvgpr_read_b32 v98, a42
    v_accvgpr_read_b32 v99, a46
    v_pk_mul_f32 v[88:89], v[88:89], v[50:51] op_sel:[0,0] op_sel_hi:[1,0]
    v_pk_mul_f32 v[90:91], v[90:91], v[50:51] op_sel:[0,0] op_sel_hi:[1,0]
    v_pk_mul_f32 v[92:93], v[92:93], v[50:51] op_sel:[0,0] op_sel_hi:[1,0]
    v_pk_mul_f32 v[94:95], v[94:95], v[50:51] op_sel:[0,0] op_sel_hi:[1,0]
    v_pk_mul_f32 v[96:97], v[96:97], v[50:51] op_sel:[0,0] op_sel_hi:[1,0]
    v_pk_mul_f32 v[98:99], v[98:99], v[50:51] op_sel:[0,0] op_sel_hi:[1,0]
    v_cvt_pk_bf16_f32 v88, v88, v89
    v_cvt_pk_bf16_f32 v89, v90, v91
    v_cvt_pk_bf16_f32 v90, v92, v93
    v_cvt_pk_bf16_f32 v91, v94, v95
    v_cvt_pk_bf16_f32 v92, v96, v97
    v_cvt_pk_bf16_f32 v93, v98, v99
    buffer_store_dwordx4 v[88:91], v60, s[12:15], s33 offen offset:768 sc0 sc1
    buffer_store_dwordx2 v[92:93], v61, s[12:15], s33 offen offset:1024 sc0 sc1
    v_accvgpr_read_b32 v100, a3
    v_accvgpr_read_b32 v101, a7
    v_accvgpr_read_b32 v102, a11
    v_accvgpr_read_b32 v103, a15
    v_accvgpr_read_b32 v104, a19
    v_accvgpr_read_b32 v105, a23
    v_accvgpr_read_b32 v106, a27
    v_accvgpr_read_b32 v107, a31
    v_accvgpr_read_b32 v108, a35
    v_accvgpr_read_b32 v109, a39
    v_accvgpr_read_b32 v110, a43
    v_accvgpr_read_b32 v111, a47
    v_pk_mul_f32 v[100:101], v[100:101], v[50:51] op_sel:[0,1] op_sel_hi:[1,1]
    v_pk_mul_f32 v[102:103], v[102:103], v[50:51] op_sel:[0,1] op_sel_hi:[1,1]
    v_pk_mul_f32 v[104:105], v[104:105], v[50:51] op_sel:[0,1] op_sel_hi:[1,1]
    v_pk_mul_f32 v[106:107], v[106:107], v[50:51] op_sel:[0,1] op_sel_hi:[1,1]
    v_pk_mul_f32 v[108:109], v[108:109], v[50:51] op_sel:[0,1] op_sel_hi:[1,1]
    v_pk_mul_f32 v[110:111], v[110:111], v[50:51] op_sel:[0,1] op_sel_hi:[1,1]
    v_cvt_pk_bf16_f32 v100, v100, v101
    v_cvt_pk_bf16_f32 v101, v102, v103
    v_cvt_pk_bf16_f32 v102, v104, v105
    v_cvt_pk_bf16_f32 v103, v106, v107
    v_cvt_pk_bf16_f32 v104, v108, v109
    v_cvt_pk_bf16_f32 v105, v110, v111
    buffer_store_dwordx4 v[100:103], v60, s[12:15], s33 offen offset:1152 sc0 sc1
    buffer_store_dwordx2 v[104:105], v61, s[12:15], s33 offen offset:1408 sc0 sc1
    v_accvgpr_read_b32 v112, a48
    v_accvgpr_read_b32 v113, a52
    v_accvgpr_read_b32 v114, a56
    v_accvgpr_read_b32 v115, a60
    v_accvgpr_read_b32 v116, a64
    v_accvgpr_read_b32 v117, a68
    v_accvgpr_read_b32 v118, a72
    v_accvgpr_read_b32 v119, a76
    v_accvgpr_read_b32 v120, a80
    v_accvgpr_read_b32 v121, a84
    v_accvgpr_read_b32 v122, a88
    v_accvgpr_read_b32 v123, a92
    v_pk_mul_f32 v[112:113], v[112:113], v[52:53] op_sel:[0,0] op_sel_hi:[1,0]
    v_pk_mul_f32 v[114:115], v[114:115], v[52:53] op_sel:[0,0] op_sel_hi:[1,0]
    v_pk_mul_f32 v[116:117], v[116:117], v[52:53] op_sel:[0,0] op_sel_hi:[1,0]
    v_pk_mul_f32 v[118:119], v[118:119], v[52:53] op_sel:[0,0] op_sel_hi:[1,0]
    v_pk_mul_f32 v[120:121], v[120:121], v[52:53] op_sel:[0,0] op_sel_hi:[1,0]
    v_pk_mul_f32 v[122:123], v[122:123], v[52:53] op_sel:[0,0] op_sel_hi:[1,0]
    v_cvt_pk_bf16_f32 v112, v112, v113
    v_cvt_pk_bf16_f32 v113, v114, v115
    v_cvt_pk_bf16_f32 v114, v116, v117
    v_cvt_pk_bf16_f32 v115, v118, v119
    v_cvt_pk_bf16_f32 v116, v120, v121
    v_cvt_pk_bf16_f32 v117, v122, v123
    buffer_store_dwordx4 v[112:115], v60, s[12:15], s34 offen offset:0 sc0 sc1
    buffer_store_dwordx2 v[116:117], v61, s[12:15], s34 offen offset:256 sc0 sc1
    v_accvgpr_read_b32 v64, a49
    v_accvgpr_read_b32 v65, a53
    v_accvgpr_read_b32 v66, a57
    v_accvgpr_read_b32 v67, a61
    v_accvgpr_read_b32 v68, a65
    v_accvgpr_read_b32 v69, a69
    v_accvgpr_read_b32 v70, a73
    v_accvgpr_read_b32 v71, a77
    v_accvgpr_read_b32 v72, a81
    v_accvgpr_read_b32 v73, a85
    v_accvgpr_read_b32 v74, a89
    v_accvgpr_read_b32 v75, a93
    v_pk_mul_f32 v[64:65], v[64:65], v[52:53] op_sel:[0,1] op_sel_hi:[1,1]
    v_pk_mul_f32 v[66:67], v[66:67], v[52:53] op_sel:[0,1] op_sel_hi:[1,1]
    v_pk_mul_f32 v[68:69], v[68:69], v[52:53] op_sel:[0,1] op_sel_hi:[1,1]
    v_pk_mul_f32 v[70:71], v[70:71], v[52:53] op_sel:[0,1] op_sel_hi:[1,1]
    v_pk_mul_f32 v[72:73], v[72:73], v[52:53] op_sel:[0,1] op_sel_hi:[1,1]
    v_pk_mul_f32 v[74:75], v[74:75], v[52:53] op_sel:[0,1] op_sel_hi:[1,1]
    v_cvt_pk_bf16_f32 v64, v64, v65
    v_cvt_pk_bf16_f32 v65, v66, v67
    v_cvt_pk_bf16_f32 v66, v68, v69
    v_cvt_pk_bf16_f32 v67, v70, v71
    v_cvt_pk_bf16_f32 v68, v72, v73
    v_cvt_pk_bf16_f32 v69, v74, v75
    buffer_store_dwordx4 v[64:67], v60, s[12:15], s34 offen offset:384 sc0 sc1
    buffer_store_dwordx2 v[68:69], v61, s[12:15], s34 offen offset:640 sc0 sc1
    v_accvgpr_read_b32 v76, a50
    v_accvgpr_read_b32 v77, a54
    v_accvgpr_read_b32 v78, a58
    v_accvgpr_read_b32 v79, a62
    v_accvgpr_read_b32 v80, a66
    v_accvgpr_read_b32 v81, a70
    v_accvgpr_read_b32 v82, a74
    v_accvgpr_read_b32 v83, a78
    v_accvgpr_read_b32 v84, a82
    v_accvgpr_read_b32 v85, a86
    v_accvgpr_read_b32 v86, a90
    v_accvgpr_read_b32 v87, a94
    v_pk_mul_f32 v[76:77], v[76:77], v[54:55] op_sel:[0,0] op_sel_hi:[1,0]
    v_pk_mul_f32 v[78:79], v[78:79], v[54:55] op_sel:[0,0] op_sel_hi:[1,0]
    v_pk_mul_f32 v[80:81], v[80:81], v[54:55] op_sel:[0,0] op_sel_hi:[1,0]
    v_pk_mul_f32 v[82:83], v[82:83], v[54:55] op_sel:[0,0] op_sel_hi:[1,0]
    v_pk_mul_f32 v[84:85], v[84:85], v[54:55] op_sel:[0,0] op_sel_hi:[1,0]
    v_pk_mul_f32 v[86:87], v[86:87], v[54:55] op_sel:[0,0] op_sel_hi:[1,0]
    v_cvt_pk_bf16_f32 v76, v76, v77
    v_cvt_pk_bf16_f32 v77, v78, v79
    v_cvt_pk_bf16_f32 v78, v80, v81
    v_cvt_pk_bf16_f32 v79, v82, v83
    v_cvt_pk_bf16_f32 v80, v84, v85
    v_cvt_pk_bf16_f32 v81, v86, v87
    buffer_store_dwordx4 v[76:79], v60, s[12:15], s34 offen offset:768 sc0 sc1
    buffer_store_dwordx2 v[80:81], v61, s[12:15], s34 offen offset:1024 sc0 sc1
    v_accvgpr_read_b32 v88, a51
    v_accvgpr_read_b32 v89, a55
    v_accvgpr_read_b32 v90, a59
    v_accvgpr_read_b32 v91, a63
    v_accvgpr_read_b32 v92, a67
    v_accvgpr_read_b32 v93, a71
    v_accvgpr_read_b32 v94, a75
    v_accvgpr_read_b32 v95, a79
    v_accvgpr_read_b32 v96, a83
    v_accvgpr_read_b32 v97, a87
    v_accvgpr_read_b32 v98, a91
    v_accvgpr_read_b32 v99, a95
    v_pk_mul_f32 v[88:89], v[88:89], v[54:55] op_sel:[0,1] op_sel_hi:[1,1]
    v_pk_mul_f32 v[90:91], v[90:91], v[54:55] op_sel:[0,1] op_sel_hi:[1,1]
    v_pk_mul_f32 v[92:93], v[92:93], v[54:55] op_sel:[0,1] op_sel_hi:[1,1]
    v_pk_mul_f32 v[94:95], v[94:95], v[54:55] op_sel:[0,1] op_sel_hi:[1,1]
    v_pk_mul_f32 v[96:97], v[96:97], v[54:55] op_sel:[0,1] op_sel_hi:[1,1]
    v_pk_mul_f32 v[98:99], v[98:99], v[54:55] op_sel:[0,1] op_sel_hi:[1,1]
    v_cvt_pk_bf16_f32 v88, v88, v89
    v_cvt_pk_bf16_f32 v89, v90, v91
    v_cvt_pk_bf16_f32 v90, v92, v93
    v_cvt_pk_bf16_f32 v91, v94, v95
    v_cvt_pk_bf16_f32 v92, v96, v97
    v_cvt_pk_bf16_f32 v93, v98, v99
    buffer_store_dwordx4 v[88:91], v60, s[12:15], s34 offen offset:1152 sc0 sc1
    buffer_store_dwordx2 v[92:93], v61, s[12:15], s34 offen offset:1408 sc0 sc1
    v_accvgpr_read_b32 v100, a96
    v_accvgpr_read_b32 v101, a100
    v_accvgpr_read_b32 v102, a104
    v_accvgpr_read_b32 v103, a108
    v_accvgpr_read_b32 v104, a112
    v_accvgpr_read_b32 v105, a116
    v_accvgpr_read_b32 v106, a120
    v_accvgpr_read_b32 v107, a124
    v_accvgpr_read_b32 v108, a128
    v_accvgpr_read_b32 v109, a132
    v_accvgpr_read_b32 v110, a136
    v_accvgpr_read_b32 v111, a140
    v_pk_mul_f32 v[100:101], v[100:101], v[56:57] op_sel:[0,0] op_sel_hi:[1,0]
    v_pk_mul_f32 v[102:103], v[102:103], v[56:57] op_sel:[0,0] op_sel_hi:[1,0]
    v_pk_mul_f32 v[104:105], v[104:105], v[56:57] op_sel:[0,0] op_sel_hi:[1,0]
    v_pk_mul_f32 v[106:107], v[106:107], v[56:57] op_sel:[0,0] op_sel_hi:[1,0]
    v_pk_mul_f32 v[108:109], v[108:109], v[56:57] op_sel:[0,0] op_sel_hi:[1,0]
    v_pk_mul_f32 v[110:111], v[110:111], v[56:57] op_sel:[0,0] op_sel_hi:[1,0]
    v_cvt_pk_bf16_f32 v100, v100, v101
    v_cvt_pk_bf16_f32 v101, v102, v103
    v_cvt_pk_bf16_f32 v102, v104, v105
    v_cvt_pk_bf16_f32 v103, v106, v107
    v_cvt_pk_bf16_f32 v104, v108, v109
    v_cvt_pk_bf16_f32 v105, v110, v111
    buffer_store_dwordx4 v[100:103], v60, s[12:15], s35 offen offset:0 sc0 sc1
    buffer_store_dwordx2 v[104:105], v61, s[12:15], s35 offen offset:256 sc0 sc1
    v_accvgpr_read_b32 v112, a97
    v_accvgpr_read_b32 v113, a101
    v_accvgpr_read_b32 v114, a105
    v_accvgpr_read_b32 v115, a109
    v_accvgpr_read_b32 v116, a113
    v_accvgpr_read_b32 v117, a117
    v_accvgpr_read_b32 v118, a121
    v_accvgpr_read_b32 v119, a125
    v_accvgpr_read_b32 v120, a129
    v_accvgpr_read_b32 v121, a133
    v_accvgpr_read_b32 v122, a137
    v_accvgpr_read_b32 v123, a141
    v_pk_mul_f32 v[112:113], v[112:113], v[56:57] op_sel:[0,1] op_sel_hi:[1,1]
    v_pk_mul_f32 v[114:115], v[114:115], v[56:57] op_sel:[0,1] op_sel_hi:[1,1]
    v_pk_mul_f32 v[116:117], v[116:117], v[56:57] op_sel:[0,1] op_sel_hi:[1,1]
    v_pk_mul_f32 v[118:119], v[118:119], v[56:57] op_sel:[0,1] op_sel_hi:[1,1]
    v_pk_mul_f32 v[120:121], v[120:121], v[56:57] op_sel:[0,1] op_sel_hi:[1,1]
    v_pk_mul_f32 v[122:123], v[122:123], v[56:57] op_sel:[0,1] op_sel_hi:[1,1]
    v_cvt_pk_bf16_f32 v112, v112, v113
    v_cvt_pk_bf16_f32 v113, v114, v115
    v_cvt_pk_bf16_f32 v114, v116, v117
    v_cvt_pk_bf16_f32 v115, v118, v119
    v_cvt_pk_bf16_f32 v116, v120, v121
    v_cvt_pk_bf16_f32 v117, v122, v123
    buffer_store_dwordx4 v[112:115], v60, s[12:15], s35 offen offset:384 sc0 sc1
    buffer_store_dwordx2 v[116:117], v61, s[12:15], s35 offen offset:640 sc0 sc1
    v_accvgpr_read_b32 v64, a98
    v_accvgpr_read_b32 v65, a102
    v_accvgpr_read_b32 v66, a106
    v_accvgpr_read_b32 v67, a110
    v_accvgpr_read_b32 v68, a114
    v_accvgpr_read_b32 v69, a118
    v_accvgpr_read_b32 v70, a122
    v_accvgpr_read_b32 v71, a126
    v_accvgpr_read_b32 v72, a130
    v_accvgpr_read_b32 v73, a134
    v_accvgpr_read_b32 v74, a138
    v_accvgpr_read_b32 v75, a142
    v_pk_mul_f32 v[64:65], v[64:65], v[58:59] op_sel:[0,0] op_sel_hi:[1,0]
    v_pk_mul_f32 v[66:67], v[66:67], v[58:59] op_sel:[0,0] op_sel_hi:[1,0]
    v_pk_mul_f32 v[68:69], v[68:69], v[58:59] op_sel:[0,0] op_sel_hi:[1,0]
    v_pk_mul_f32 v[70:71], v[70:71], v[58:59] op_sel:[0,0] op_sel_hi:[1,0]
    v_pk_mul_f32 v[72:73], v[72:73], v[58:59] op_sel:[0,0] op_sel_hi:[1,0]
    v_pk_mul_f32 v[74:75], v[74:75], v[58:59] op_sel:[0,0] op_sel_hi:[1,0]
    v_cvt_pk_bf16_f32 v64, v64, v65
    v_cvt_pk_bf16_f32 v65, v66, v67
    v_cvt_pk_bf16_f32 v66, v68, v69
    v_cvt_pk_bf16_f32 v67, v70, v71
    v_cvt_pk_bf16_f32 v68, v72, v73
    v_cvt_pk_bf16_f32 v69, v74, v75
    buffer_store_dwordx4 v[64:67], v60, s[12:15], s35 offen offset:768 sc0 sc1
    buffer_store_dwordx2 v[68:69], v61, s[12:15], s35 offen offset:1024 sc0 sc1
    v_accvgpr_read_b32 v76, a99
    v_accvgpr_read_b32 v77, a103
    v_accvgpr_read_b32 v78, a107
    v_accvgpr_read_b32 v79, a111
    v_accvgpr_read_b32 v80, a115
    v_accvgpr_read_b32 v81, a119
    v_accvgpr_read_b32 v82, a123
    v_accvgpr_read_b32 v83, a127
    v_accvgpr_read_b32 v84, a131
    v_accvgpr_read_b32 v85, a135
    v_accvgpr_read_b32 v86, a139
    v_accvgpr_read_b32 v87, a143
    v_pk_mul_f32 v[76:77], v[76:77], v[58:59] op_sel:[0,1] op_sel_hi:[1,1]
    v_pk_mul_f32 v[78:79], v[78:79], v[58:59] op_sel:[0,1] op_sel_hi:[1,1]
    v_pk_mul_f32 v[80:81], v[80:81], v[58:59] op_sel:[0,1] op_sel_hi:[1,1]
    v_pk_mul_f32 v[82:83], v[82:83], v[58:59] op_sel:[0,1] op_sel_hi:[1,1]
    v_pk_mul_f32 v[84:85], v[84:85], v[58:59] op_sel:[0,1] op_sel_hi:[1,1]
    v_pk_mul_f32 v[86:87], v[86:87], v[58:59] op_sel:[0,1] op_sel_hi:[1,1]
    v_cvt_pk_bf16_f32 v76, v76, v77
    v_cvt_pk_bf16_f32 v77, v78, v79
    v_cvt_pk_bf16_f32 v78, v80, v81
    v_cvt_pk_bf16_f32 v79, v82, v83
    v_cvt_pk_bf16_f32 v80, v84, v85
    v_cvt_pk_bf16_f32 v81, v86, v87
    buffer_store_dwordx4 v[76:79], v60, s[12:15], s35 offen offset:1152 sc0 sc1
    buffer_store_dwordx2 v[80:81], v61, s[12:15], s35 offen offset:1408 sc0 sc1
    v_accvgpr_read_b32 v88, a144
    v_accvgpr_read_b32 v89, a148
    v_accvgpr_read_b32 v90, a152
    v_accvgpr_read_b32 v91, a156
    v_accvgpr_read_b32 v92, a160
    v_accvgpr_read_b32 v93, a164
    v_accvgpr_read_b32 v94, a168
    v_accvgpr_read_b32 v95, a172
    v_accvgpr_read_b32 v96, a176
    v_accvgpr_read_b32 v97, a180
    v_accvgpr_read_b32 v98, a184
    v_accvgpr_read_b32 v99, a188
    v_pk_mul_f32 v[88:89], v[88:89], v[128:129] op_sel:[0,0] op_sel_hi:[1,0]
    v_pk_mul_f32 v[90:91], v[90:91], v[128:129] op_sel:[0,0] op_sel_hi:[1,0]
    v_pk_mul_f32 v[92:93], v[92:93], v[128:129] op_sel:[0,0] op_sel_hi:[1,0]
    v_pk_mul_f32 v[94:95], v[94:95], v[128:129] op_sel:[0,0] op_sel_hi:[1,0]
    v_pk_mul_f32 v[96:97], v[96:97], v[128:129] op_sel:[0,0] op_sel_hi:[1,0]
    v_pk_mul_f32 v[98:99], v[98:99], v[128:129] op_sel:[0,0] op_sel_hi:[1,0]
    v_cvt_pk_bf16_f32 v88, v88, v89
    v_cvt_pk_bf16_f32 v89, v90, v91
    v_cvt_pk_bf16_f32 v90, v92, v93
    v_cvt_pk_bf16_f32 v91, v94, v95
    v_cvt_pk_bf16_f32 v92, v96, v97
    v_cvt_pk_bf16_f32 v93, v98, v99
    buffer_store_dwordx4 v[88:91], v60, s[12:15], s36 offen offset:0 sc0 sc1
    buffer_store_dwordx2 v[92:93], v61, s[12:15], s36 offen offset:256 sc0 sc1
    v_accvgpr_read_b32 v100, a145
    v_accvgpr_read_b32 v101, a149
    v_accvgpr_read_b32 v102, a153
    v_accvgpr_read_b32 v103, a157
    v_accvgpr_read_b32 v104, a161
    v_accvgpr_read_b32 v105, a165
    v_accvgpr_read_b32 v106, a169
    v_accvgpr_read_b32 v107, a173
    v_accvgpr_read_b32 v108, a177
    v_accvgpr_read_b32 v109, a181
    v_accvgpr_read_b32 v110, a185
    v_accvgpr_read_b32 v111, a189
    v_pk_mul_f32 v[100:101], v[100:101], v[128:129] op_sel:[0,1] op_sel_hi:[1,1]
    v_pk_mul_f32 v[102:103], v[102:103], v[128:129] op_sel:[0,1] op_sel_hi:[1,1]
    v_pk_mul_f32 v[104:105], v[104:105], v[128:129] op_sel:[0,1] op_sel_hi:[1,1]
    v_pk_mul_f32 v[106:107], v[106:107], v[128:129] op_sel:[0,1] op_sel_hi:[1,1]
    v_pk_mul_f32 v[108:109], v[108:109], v[128:129] op_sel:[0,1] op_sel_hi:[1,1]
    v_pk_mul_f32 v[110:111], v[110:111], v[128:129] op_sel:[0,1] op_sel_hi:[1,1]
    v_cvt_pk_bf16_f32 v100, v100, v101
    v_cvt_pk_bf16_f32 v101, v102, v103
    v_cvt_pk_bf16_f32 v102, v104, v105
    v_cvt_pk_bf16_f32 v103, v106, v107
    v_cvt_pk_bf16_f32 v104, v108, v109
    v_cvt_pk_bf16_f32 v105, v110, v111
    buffer_store_dwordx4 v[100:103], v60, s[12:15], s36 offen offset:384 sc0 sc1
    buffer_store_dwordx2 v[104:105], v61, s[12:15], s36 offen offset:640 sc0 sc1
    v_accvgpr_read_b32 v112, a146
    v_accvgpr_read_b32 v113, a150
    v_accvgpr_read_b32 v114, a154
    v_accvgpr_read_b32 v115, a158
    v_accvgpr_read_b32 v116, a162
    v_accvgpr_read_b32 v117, a166
    v_accvgpr_read_b32 v118, a170
    v_accvgpr_read_b32 v119, a174
    v_accvgpr_read_b32 v120, a178
    v_accvgpr_read_b32 v121, a182
    v_accvgpr_read_b32 v122, a186
    v_accvgpr_read_b32 v123, a190
    v_pk_mul_f32 v[112:113], v[112:113], v[130:131] op_sel:[0,0] op_sel_hi:[1,0]
    v_pk_mul_f32 v[114:115], v[114:115], v[130:131] op_sel:[0,0] op_sel_hi:[1,0]
    v_pk_mul_f32 v[116:117], v[116:117], v[130:131] op_sel:[0,0] op_sel_hi:[1,0]
    v_pk_mul_f32 v[118:119], v[118:119], v[130:131] op_sel:[0,0] op_sel_hi:[1,0]
    v_pk_mul_f32 v[120:121], v[120:121], v[130:131] op_sel:[0,0] op_sel_hi:[1,0]
    v_pk_mul_f32 v[122:123], v[122:123], v[130:131] op_sel:[0,0] op_sel_hi:[1,0]
    v_cvt_pk_bf16_f32 v112, v112, v113
    v_cvt_pk_bf16_f32 v113, v114, v115
    v_cvt_pk_bf16_f32 v114, v116, v117
    v_cvt_pk_bf16_f32 v115, v118, v119
    v_cvt_pk_bf16_f32 v116, v120, v121
    v_cvt_pk_bf16_f32 v117, v122, v123
    buffer_store_dwordx4 v[112:115], v60, s[12:15], s36 offen offset:768 sc0 sc1
    buffer_store_dwordx2 v[116:117], v61, s[12:15], s36 offen offset:1024 sc0 sc1
    v_accvgpr_read_b32 v64, a147
    v_accvgpr_read_b32 v65, a151
    v_accvgpr_read_b32 v66, a155
    v_accvgpr_read_b32 v67, a159
    v_accvgpr_read_b32 v68, a163
    v_accvgpr_read_b32 v69, a167
    v_accvgpr_read_b32 v70, a171
    v_accvgpr_read_b32 v71, a175
    v_accvgpr_read_b32 v72, a179
    v_accvgpr_read_b32 v73, a183
    v_accvgpr_read_b32 v74, a187
    v_accvgpr_read_b32 v75, a191
    v_pk_mul_f32 v[64:65], v[64:65], v[130:131] op_sel:[0,1] op_sel_hi:[1,1]
    v_pk_mul_f32 v[66:67], v[66:67], v[130:131] op_sel:[0,1] op_sel_hi:[1,1]
    v_pk_mul_f32 v[68:69], v[68:69], v[130:131] op_sel:[0,1] op_sel_hi:[1,1]
    v_pk_mul_f32 v[70:71], v[70:71], v[130:131] op_sel:[0,1] op_sel_hi:[1,1]
    v_pk_mul_f32 v[72:73], v[72:73], v[130:131] op_sel:[0,1] op_sel_hi:[1,1]
    v_pk_mul_f32 v[74:75], v[74:75], v[130:131] op_sel:[0,1] op_sel_hi:[1,1]
    v_cvt_pk_bf16_f32 v64, v64, v65
    v_cvt_pk_bf16_f32 v65, v66, v67
    v_cvt_pk_bf16_f32 v66, v68, v69
    v_cvt_pk_bf16_f32 v67, v70, v71
    v_cvt_pk_bf16_f32 v68, v72, v73
    v_cvt_pk_bf16_f32 v69, v74, v75
    buffer_store_dwordx4 v[64:67], v60, s[12:15], s36 offen offset:1152 sc0 sc1
    buffer_store_dwordx2 v[68:69], v61, s[12:15], s36 offen offset:1408 sc0 sc1
    s_branch L_fin
.section .rodata,"a"
.p2align 6
.amdhsa_kernel standalone__kv_cache_quant_int4_int2_kv_with_per_channel_or_per_token_scales__prompt_kernel
  .amdhsa_next_free_vgpr 512
  .amdhsa_next_free_sgpr 102
  .amdhsa_accum_offset 256
  .amdhsa_group_segment_fixed_size 0
  .amdhsa_kernarg_size 80
  .amdhsa_user_sgpr_count 2
  .amdhsa_user_sgpr_kernarg_segment_ptr 1
  .amdhsa_system_sgpr_workgroup_id_x 1
.end_amdhsa_kernel
```
